```python
import torch

def _softmax(x, axis=-1):
    return torch.softmax(x, dim=axis)

def _gelu(x):
    return torch.nn.functional.gelu(x, approximate='tanh')

def _silu(x):
    return torch.nn.functional.silu(x)

def _sigmoid(x):
    return torch.sigmoid(x)

def _layernorm(x, axis=-1, eps=1e-05):
    m = x.mean(dim=axis, keepdim=True)
    v = x.var(dim=axis, keepdim=True, unbiased=False)
    return (x - m) / torch.sqrt(v + eps)

def _scatter_add(tgt, idx, src, axis=0):
    return tgt.clone().index_add_(axis, idx, src)

def _segment_sum(src, seg, n):
    out = torch.zeros((n,) + src.shape[1:], dtype=src.dtype)
    return out.index_add_(0, seg, src)

def _pad(x, pw):
    flat = tuple((v for pair in reversed(pw) for v in pair))
    return torch.nn.functional.pad(x, flat)
kernel_name = 'interleave_layers__memory_aug_recurrent_mem_tr__dense_activation_gelu__prompt'

def setup_inputs():

    _w = lambda a: (lambda t: t.to(torch.bfloat16) if t.is_floating_point() else t)(torch.as_tensor(a))

    def _A_setup():
        B, S, Dm = (1, 2048, 576)
        H, Dh = (32, 128)
        M, seg = (8, 32)
        seg = min(seg, S)
        S = S // seg * seg
        return {'x': _w((lambda *s: torch.randn(*s, dtype=torch.bfloat16) * 0.05)(B, S, Dm)), 'mem0': _w((lambda *s: torch.randn(*s, dtype=torch.bfloat16) * 0.2)(B, M, Dm)), 'Wq': _w((lambda *s: torch.randn(*s, dtype=torch.bfloat16) * 1.6)(Dm, H, Dh) * Dm ** (-0.5)), 'Wk': _w((lambda *s: torch.randn(*s, dtype=torch.bfloat16) * 1.6)(Dm, H, Dh) * Dm ** (-0.5)), 'Wv': _w((lambda *s: torch.randn(*s, dtype=torch.bfloat16) * 0.2)(Dm, H, Dh) * Dm ** (-0.5)), 'Wo': _w((lambda *s: torch.randn(*s, dtype=torch.bfloat16) * 0.2)(H, Dh, Dm) * (H * Dh) ** (-0.5)), 'seg_len': seg}
    _A_in = _A_setup()

    def _B_setup():
        B, S, D, F = (1, 2048, 576, 4608)
        return {'x': _w((lambda *s: torch.randn(*s, dtype=torch.bfloat16) * 0.05)(B, S, D)), 'w1': _w((lambda *s: torch.randn(*s, dtype=torch.bfloat16) * 0.4)(D, F) * D ** (-0.5)), 'b1': _w((lambda *s: torch.randn(*s, dtype=torch.bfloat16) * 12.8)(F) * 0.01), 'w2': _w((lambda *s: torch.randn(*s, dtype=torch.bfloat16) * 0.1)(F, D) * F ** (-0.5)), 'b2': _w((lambda *s: torch.randn(*s, dtype=torch.bfloat16) * 0.8)(D) * 0.01)}
    _B_in = _B_setup()
    return {'A_x': _A_in['x'], 'A_mem0': _A_in['mem0'], 'A_Wq': _A_in['Wq'], 'A_Wk': _A_in['Wk'], 'A_Wv': _A_in['Wv'], 'A_Wo': _A_in['Wo'], 'A_seg_len': _A_in['seg_len'], 'B_x': _B_in['x'], 'B_w1': _B_in['w1'], 'B_b1': _B_in['b1'], 'B_w2': _B_in['w2'], 'B_b2': _B_in['b2']}

def reference(A_x, A_mem0, A_Wq, A_Wk, A_Wv, A_Wo, A_seg_len, B_x, B_w1, B_b1, B_w2, B_b2):

    def _A_ref(x, mem0, Wq, Wk, Wv, Wo, seg_len):
        B, S, Dm = x.shape
        H, Dh = (Wq.shape[1], Wq.shape[2])
        M = mem0.shape[1]
        scale = Dh ** (-0.5)
        n_seg = S // seg_len
        L = M + seg_len
        idx = torch.arange(L)
        mask = (idx[:, None] < M) | (idx[:, None] >= idx[None, :])
        mem = mem0
        outs = []
        for s in range(n_seg):
            xs = x[:, s * seg_len:(s + 1) * seg_len, :].clone()
            h = torch.concatenate([mem, xs], axis=1)
            q = torch.einsum('btd,dhe->bhte', h, Wq)
            k = torch.einsum('btd,dhe->bhte', h, Wk)
            v = torch.einsum('btd,dhe->bhte', h, Wv)
            scores = torch.einsum('bhqe,bhke->bhqk', q, k) * scale
            scores = torch.where(mask[None, None], scores, -1000000000.0)
            p = _softmax(scores, axis=-1)
            o = torch.einsum('bhqk,bhke->bhqe', p, v)
            o = torch.einsum('bhte,hed->btd', o, Wo)
            mem = o[:, :M, :].clone()
            outs.append(o[:, M:, :])
        return torch.concatenate(outs, axis=1)

    def _B_ref(x, w1, b1, w2, b2):
        h = torch.einsum('bsd,df->bsf', x, w1) + b1
        h = _gelu(h)
        return torch.einsum('bsf,fd->bsd', h, w2) + b2
    x = A_x
    x = x + _A_ref(_layernorm(x, axis=-1), A_mem0, A_Wq, A_Wk, A_Wv, A_Wo, A_seg_len)
    x = x + _B_ref(_layernorm(x, axis=-1), B_w1, B_b1, B_w2, B_b2)
    x = x + _A_ref(_layernorm(x, axis=-1), A_mem0, A_Wq, A_Wk, A_Wv, A_Wo, A_seg_len)
    x = x + _B_ref(_layernorm(x, axis=-1), B_w1, B_b1, B_w2, B_b2)
    return x
```

```asm
; @launch grid=(256,1,1) block=(256,1,1) lds=163840
.amdgcn_target "amdgcn-amd-amdhsa--gfx950"
.text
.globl interleave_layers__memory_aug_recurrent_mem_tr__dense_activation_gelu__prompt_kernel
.p2align 8
.type interleave_layers__memory_aug_recurrent_mem_tr__dense_activation_gelu__prompt_kernel,@function
interleave_layers__memory_aug_recurrent_mem_tr__dense_activation_gelu__prompt_kernel:
  s_cmp_ge_u32 s2, 0x100
  s_cbranch_scc1 L_end0
  s_load_dwordx16 s[64:79], s[0:1], 0
  s_load_dwordx8 s[80:87], s[0:1], 64
  s_load_dwordx4 s[88:91], s[0:1], 96
  s_load_dwordx2 s[92:93], s[0:1], 112
  v_lshrrev_b32 v1, 6, v0
  v_and_b32 v0, 63, v0
  v_readfirstlane_b32 s24, v1
  s_getreg_b32 s25, hwreg(HW_REG_XCC_ID)
  s_and_b32 s25, s25, 7
  s_mov_b32 s60, 0
  s_mov_b32 s61, 0
  s_waitcnt lgkmcnt(0)
  s_mov_b32 s4, s92
  s_and_b32 s5, s93, 0xffff
  s_mov_b32 s6, 0x10000000
  s_mov_b32 s7, 0x20000
  s_mov_b32 s20, s90
  s_and_b32 s21, s91, 0xffff
  s_mov_b32 s22, 0x100
  s_mov_b32 s23, 0x20000
  s_mov_b32 s8, s92
  s_and_b32 s9, s93, 0xffff
  s_mov_b32 s10, 0x10000000
  s_mov_b32 s11, 0x20000
  s_mov_b32 s12, s92
  s_and_b32 s13, s93, 0xffff
  s_mov_b32 s14, 0x10000000
  s_mov_b32 s15, 0x20000
  s_mov_b32 s16, s92
  s_and_b32 s17, s93, 0xffff
  s_mov_b32 s18, 0x10000000
  s_mov_b32 s19, 0x20000
  s_cmp_eq_u32 s24, 0
  s_cbranch_scc1 L_ticket
  s_cmp_eq_u32 s24, 1
  s_cbranch_scc1 L_zero
  s_cmp_lg_u32 s25, 0
  s_cbranch_scc1 L_gotslot
  s_lshr_b32 s30, s2, 3
  s_lshl_b32 s30, s30, 1
  s_add_u32 s30, s30, s24
  s_sub_u32 s30, s30, 2
  s_lshl_b32 s30, s30, 13
  v_lshlrev_b32 v1, 7, v0
  s_mov_b32 s8, s68
  s_and_b32 s9, s69, 0xffff
  s_mov_b32 s10, 0x480000
  s_mov_b32 s11, 0x20000
  s_mov_b32 s12, s70
  s_and_b32 s13, s71, 0xffff
  s_mov_b32 s14, 0x480000
  s_mov_b32 s15, 0x20000
  s_add_u32 s31, s30, 0
  buffer_load_dword v77, v1, s[8:11], s31 offen
  buffer_load_dword v77, v1, s[12:15], s31 offen
  s_add_u32 s31, s30, 524288
  buffer_load_dword v77, v1, s[8:11], s31 offen
  buffer_load_dword v77, v1, s[12:15], s31 offen
  s_branch L_gotslot
L_zero:
  v_lshlrev_b32 v1, 4, v0
  v_mov_b32 v4, 0
  v_mov_b32 v5, 0
  v_mov_b32 v6, 0
  v_mov_b32 v7, 0
  s_lshl_b32 s30, s2, 10
  buffer_store_dwordx4 v[4:7], v1, s[4:7], s30 offen sc1
  s_mov_b64 exec, -1
  s_branch L_gotslot
L_ticket:
  s_mov_b64 exec, 1
  s_lshl_b32 s30, s25, 2
  v_mov_b32 v1, s30
  v_mov_b32 v2, 1
  buffer_atomic_add v2, v1, s[20:23], 0 offen sc0
  s_waitcnt vmcnt(0)
  v_readfirstlane_b32 s31, v2
  s_mov_b64 exec, -1
  s_lshl_b32 s26, s25, 5
  s_add_u32 s26, s26, s31
  s_cmp_lt_u32 s31, 32
  s_cbranch_scc1 L_slotok
  s_mov_b64 exec, 1
  v_mov_b32 v1, 32
  v_mov_b32 v2, 1
  buffer_atomic_add v2, v1, s[20:23], 0 offen sc0
  s_waitcnt vmcnt(0)
  v_readfirstlane_b32 s32, v2
  s_mov_b64 exec, -1
  v_and_b32 v1, 7, v0
  v_lshlrev_b32 v1, 2, v1
L_ovf_wait:
  buffer_load_dword v2, v1, s[20:23], 0 offen sc1
  s_waitcnt vmcnt(0)
  s_mov_b32 s33, 0
  v_readlane_b32 s40, v2, 0
  v_readlane_b32 s41, v2, 1
  v_readlane_b32 s42, v2, 2
  v_readlane_b32 s43, v2, 3
  v_readlane_b32 s44, v2, 4
  v_readlane_b32 s45, v2, 5
  v_readlane_b32 s46, v2, 6
  v_readlane_b32 s47, v2, 7
  s_add_u32 s33, s33, s40
  s_add_u32 s33, s33, s41
  s_add_u32 s33, s33, s42
  s_add_u32 s33, s33, s43
  s_add_u32 s33, s33, s44
  s_add_u32 s33, s33, s45
  s_add_u32 s33, s33, s46
  s_add_u32 s33, s33, s47
  s_cmp_ge_u32 s33, 0x100
  s_cbranch_scc1 L_ovf_go
  s_add_u32 s60, s60, 1
  s_cmp_gt_u32 s60, 262144
  s_cbranch_scc1 L_fail0
  s_sleep 4
  s_branch L_ovf_wait
L_ovf_go:
  s_min_u32 s34, s40, 32
  s_sub_u32 s35, 32, s34
  s_add_u32 s26, s34, s32
  s_add_u32 s26, s26, 0
  s_cmp_lt_u32 s32, s35
  s_cbranch_scc1 L_slotok
  s_sub_u32 s32, s32, s35
  s_min_u32 s34, s41, 32
  s_sub_u32 s35, 32, s34
  s_add_u32 s26, s34, s32
  s_add_u32 s26, s26, 32
  s_cmp_lt_u32 s32, s35
  s_cbranch_scc1 L_slotok
  s_sub_u32 s32, s32, s35
  s_min_u32 s34, s42, 32
  s_sub_u32 s35, 32, s34
  s_add_u32 s26, s34, s32
  s_add_u32 s26, s26, 64
  s_cmp_lt_u32 s32, s35
  s_cbranch_scc1 L_slotok
  s_sub_u32 s32, s32, s35
  s_min_u32 s34, s43, 32
  s_sub_u32 s35, 32, s34
  s_add_u32 s26, s34, s32
  s_add_u32 s26, s26, 96
  s_cmp_lt_u32 s32, s35
  s_cbranch_scc1 L_slotok
  s_sub_u32 s32, s32, s35
  s_min_u32 s34, s44, 32
  s_sub_u32 s35, 32, s34
  s_add_u32 s26, s34, s32
  s_add_u32 s26, s26, 128
  s_cmp_lt_u32 s32, s35
  s_cbranch_scc1 L_slotok
  s_sub_u32 s32, s32, s35
  s_min_u32 s34, s45, 32
  s_sub_u32 s35, 32, s34
  s_add_u32 s26, s34, s32
  s_add_u32 s26, s26, 160
  s_cmp_lt_u32 s32, s35
  s_cbranch_scc1 L_slotok
  s_sub_u32 s32, s32, s35
  s_min_u32 s34, s46, 32
  s_sub_u32 s35, 32, s34
  s_add_u32 s26, s34, s32
  s_add_u32 s26, s26, 192
  s_cmp_lt_u32 s32, s35
  s_cbranch_scc1 L_slotok
  s_sub_u32 s32, s32, s35
  s_min_u32 s34, s47, 32
  s_sub_u32 s35, 32, s34
  s_add_u32 s26, s34, s32
  s_add_u32 s26, s26, 224
  s_cmp_lt_u32 s32, s35
  s_cbranch_scc1 L_slotok
  s_sub_u32 s32, s32, s35
L_slotok:
  v_mov_b32 v1, 163776
  v_mov_b32 v2, s26
  ds_write_b32 v1, v2
  s_waitcnt lgkmcnt(0)
L_gotslot:
  s_barrier
  v_mov_b32 v1, 163776
  ds_read_b32 v2, v1
  s_waitcnt lgkmcnt(0)
  v_readfirstlane_b32 s26, v2
  s_and_b32 s26, s26, 0xff
  s_getpc_b64 s[30:31]
L_pc:
  s_add_u32 s30, s30, role_table-L_pc
  s_addc_u32 s31, s31, 0
  s_lshl_b32 s32, s26, 2
  s_load_dword s27, s[30:31], s32
  s_waitcnt lgkmcnt(0)
  s_bfe_u32 s28, s27, 0x80008
  s_bfe_u32 s29, s27, 0x80010
  s_lshr_b32 s62, s27, 24
  s_and_b32 s27, s27, 0xff
  s_cmp_eq_u32 s27, 0
  s_cbranch_scc1 L_rec
  s_cmp_eq_u32 s27, 1
  s_cbranch_scc1 L_qkv
  s_cmp_eq_u32 s27, 2
  s_cbranch_scc1 L_ffn1
  s_cmp_eq_u32 s27, 3
  s_cbranch_scc1 L_ffn2
  s_cmp_eq_u32 s27, 4
  s_cbranch_scc1 L_wo
  s_branch L_util
L_end0:
  s_endpgm
L_fail0:
  s_mov_b64 exec, 1
  v_mov_b32 v0, 64
  v_mov_b32 v1, 1
  buffer_atomic_add v1, v0, s[20:23], 0 offen
  s_endpgm
L_rec:
  s_mul_i32 s31, s28, 614400
  s_add_u32 s31, s31, 557056
  s_lshl_b32 s32, s28, 16
  s_add_u32 s32, s32, 1785856
  s_lshr_b32 s30, s29, 3
  s_lshl_b32 s30, s30, 1
  s_add_u32 s30, s30, s24
  s_lshl_b32 s30, s30, 3
  s_and_b32 s33, s29, 7
  s_add_u32 s30, s30, s33
  s_mul_i32 s37, s30, 4224
  s_mul_i32 s33, s29, 1152
  s_add_u32 s33, s33, 270336
  s_cmp_ge_u32 s24, 2
  s_cselect_b32 s37, s33, s37
  s_add_u32 s37, s37, s31
  v_lshlrev_b32 v1, 4, v0
  v_mov_b32 v20, -1
  v_mov_b32 v21, -1
  v_mov_b32 v22, -1
  v_mov_b32 v23, -1
  s_cmp_eq_u32 s24, 3
  s_cbranch_scc1 L_rec_w3init
  s_add_u32 s33, s37, 307200
  buffer_store_dwordx4 v[20:23], v1, s[4:7], s37 offen sc1
  buffer_store_dwordx4 v[20:23], v1, s[4:7], s33 offen sc1
  s_cmp_eq_u32 s24, 2
  s_cbranch_scc1 L_rec_noinit
  buffer_store_dwordx4 v[20:23], v1, s[4:7], s37 offen offset:1024 sc1
  buffer_store_dwordx4 v[20:23], v1, s[4:7], s33 offen offset:1024 sc1
  buffer_store_dwordx4 v[20:23], v1, s[4:7], s37 offen offset:2048 sc1
  buffer_store_dwordx4 v[20:23], v1, s[4:7], s33 offen offset:2048 sc1
  buffer_store_dwordx4 v[20:23], v1, s[4:7], s37 offen offset:3072 sc1
  buffer_store_dwordx4 v[20:23], v1, s[4:7], s33 offen offset:3072 sc1
  s_branch L_rec_noinit
L_rec_w3init:
  s_lshl_b32 s33, s29, 11
  s_add_u32 s33, s33, s32
  buffer_store_dwordx4 v[20:23], v1, s[4:7], s33 offen offset:0 sc1
  buffer_store_dwordx4 v[20:23], v1, s[4:7], s33 offen offset:1024 sc1
L_rec_noinit:
  s_cmp_eq_u32 s28, 0
  s_cbranch_scc1 L_rec_nogate
  s_waitcnt vmcnt(0)
  s_barrier
  s_cmp_lg_u32 s24, 0
  s_cbranch_scc1 Lsi_1
  s_mov_b64 exec, 1
  v_mov_b32 v1, 128
  v_mov_b32 v2, 1
  buffer_atomic_add v2, v1, s[20:23], 0 offen
  s_mov_b64 exec, -1
Lsi_1:
  v_mov_b32 v16, 128
Lwi_2:
  buffer_load_dword v17, v16, s[20:23], 0 offen sc1
  s_waitcnt vmcnt(0)
  v_cmp_gt_u32 vcc, 0x100, v17
  s_cbranch_vccz Lwiok_3
  s_add_u32 s60, s60, 1
  s_cmp_gt_u32 s60, 262144
  s_cbranch_scc1 L_fail_rec
  s_sleep 4
  s_branch Lwi_2
Lwiok_3:
  s_lshl_b32 s33, s29, 9
  s_add_u32 s33, s33, 0
  v_mov_b32 v16, 0
Lwf_4:
  s_mov_b64 exec, 15
  buffer_load_dword v17, v16, s[4:7], s33 offen sc1
  s_waitcnt vmcnt(0)
  v_cmp_ge_u32 vcc, 0, v17
  s_mov_b64 exec, -1
  s_cbranch_vccz Lwfok_5
  s_add_u32 s60, s60, 1
  s_cmp_gt_u32 s60, 262144
  s_cbranch_scc1 L_fail_rec
  s_sleep 32
  s_branch Lwf_4
Lwfok_5:
L_rec_nogate:
  v_lshlrev_b32 v1, 4, v0
  s_mov_b32 s8, s68
  s_and_b32 s9, s69, 0xffff
  s_mov_b32 s10, 0x480000
  s_mov_b32 s11, 0x20000
  s_mov_b32 s12, s70
  s_and_b32 s13, s71, 0xffff
  s_mov_b32 s14, 0x480000
  s_mov_b32 s15, 0x20000
  s_mov_b32 s16, s72
  s_and_b32 s17, s73, 0xffff
  s_mov_b32 s18, 0x480000
  s_mov_b32 s19, 0x20000
  s_mov_b32 s40, s74
  s_and_b32 s41, s75, 0xffff
  s_mov_b32 s42, 0x480000
  s_mov_b32 s43, 0x20000
  s_mov_b32 s44, s66
  s_and_b32 s45, s67, 0xffff
  s_mov_b32 s46, 0x2400
  s_mov_b32 s47, 0x20000
  v_lshrrev_b32 v8, 2, v0
  v_lshlrev_b32 v10, 13, v8
  v_and_b32 v9, 3, v0
  v_lshl_add_u32 v10, v9, 4, v10
  s_lshl_b32 s33, s29, 8
  s_lshl_b32 s34, s24, 6
  s_add_u32 s33, s33, s34
  v_add_u32 v10, s33, v10
  v_lshrrev_b32 v11, 1, v0
  v_mul_u32_u24 v11, 1152, v11
  v_and_b32 v12, 1, v0
  v_lshl_add_u32 v11, v12, 4, v11
  s_mul_i32 s33, s29, 147456
  s_mul_i32 s34, s24, 288
  s_add_u32 s33, s33, s34
  v_add_u32 v11, s33, v11
  s_mul_i32 s35, s24, 36864
  v_bfe_u32 v2, v0, 2, 1
  v_bfe_u32 v3, v0, 3, 1
  v_bfe_u32 v4, v0, 4, 1
  v_lshrrev_b32 v5, 5, v0
  v_lshlrev_b32 v6, 3, v9
  v_add_u32 v6, s35, v6
  v_lshl_add_u32 v2, v2, 1, v3
  v_lshl_add_u32 v12, v5, 4, v2
  v_lshl_add_u32 v12, v4, 3, v12
  v_lshl_add_u32 v13, v12, 6, v6
  v_lshl_add_u32 v12, v4, 5, v2
  v_lshl_add_u32 v12, v5, 3, v12
  v_lshl_add_u32 v7, v12, 6, v6
  v_lshl_add_u32 v12, v4, 5, v2
  v_lshl_add_u32 v12, v5, 4, v12
  v_lshl_add_u32 v14, v12, 5, v6
  v_add_u32 v15, s35, v1
  s_barrier
  s_add_u32 m0, s35, 0
  s_mov_b32 s36, 0
  buffer_load_dwordx4 v10, s[8:11], s36 offen lds
  s_add_u32 m0, s35, 1024
  s_mov_b32 s36, 131072
  buffer_load_dwordx4 v10, s[8:11], s36 offen lds
  s_add_u32 m0, s35, 2048
  s_mov_b32 s36, 262144
  buffer_load_dwordx4 v10, s[8:11], s36 offen lds
  s_add_u32 m0, s35, 3072
  s_mov_b32 s36, 393216
  buffer_load_dwordx4 v10, s[8:11], s36 offen lds
  s_barrier
  s_add_u32 m0, s35, 4096
  s_mov_b32 s36, 0
  buffer_load_dwordx4 v10, s[12:15], s36 offen lds
  s_add_u32 m0, s35, 5120
  s_mov_b32 s36, 131072
  buffer_load_dwordx4 v10, s[12:15], s36 offen lds
  s_add_u32 m0, s35, 6144
  s_mov_b32 s36, 262144
  buffer_load_dwordx4 v10, s[12:15], s36 offen lds
  s_add_u32 m0, s35, 7168
  s_mov_b32 s36, 393216
  buffer_load_dwordx4 v10, s[12:15], s36 offen lds
  s_barrier
  s_add_u32 m0, s35, 8192
  s_mov_b32 s36, 524288
  buffer_load_dwordx4 v10, s[8:11], s36 offen lds
  s_add_u32 m0, s35, 9216
  s_mov_b32 s36, 655360
  buffer_load_dwordx4 v10, s[8:11], s36 offen lds
  s_add_u32 m0, s35, 10240
  s_mov_b32 s36, 786432
  buffer_load_dwordx4 v10, s[8:11], s36 offen lds
  s_add_u32 m0, s35, 11264
  s_mov_b32 s36, 917504
  buffer_load_dwordx4 v10, s[8:11], s36 offen lds
  s_barrier
  s_add_u32 m0, s35, 12288
  s_mov_b32 s36, 524288
  buffer_load_dwordx4 v10, s[12:15], s36 offen lds
  s_add_u32 m0, s35, 13312
  s_mov_b32 s36, 655360
  buffer_load_dwordx4 v10, s[12:15], s36 offen lds
  s_add_u32 m0, s35, 14336
  s_mov_b32 s36, 786432
  buffer_load_dwordx4 v10, s[12:15], s36 offen lds
  s_add_u32 m0, s35, 15360
  s_mov_b32 s36, 917504
  buffer_load_dwordx4 v10, s[12:15], s36 offen lds
  s_barrier
  s_add_u32 m0, s35, 16384
  s_mov_b32 s36, 1179648
  buffer_load_dwordx4 v10, s[8:11], s36 offen lds
  s_add_u32 m0, s35, 17408
  s_mov_b32 s36, 1310720
  buffer_load_dwordx4 v10, s[8:11], s36 offen lds
  s_add_u32 m0, s35, 18432
  s_mov_b32 s36, 1441792
  buffer_load_dwordx4 v10, s[8:11], s36 offen lds
  s_add_u32 m0, s35, 19456
  s_mov_b32 s36, 1572864
  buffer_load_dwordx4 v10, s[8:11], s36 offen lds
  s_barrier
  s_add_u32 m0, s35, 20480
  s_mov_b32 s36, 1179648
  buffer_load_dwordx4 v10, s[12:15], s36 offen lds
  s_add_u32 m0, s35, 21504
  s_mov_b32 s36, 1310720
  buffer_load_dwordx4 v10, s[12:15], s36 offen lds
  s_add_u32 m0, s35, 22528
  s_mov_b32 s36, 1441792
  buffer_load_dwordx4 v10, s[12:15], s36 offen lds
  s_add_u32 m0, s35, 23552
  s_mov_b32 s36, 1572864
  buffer_load_dwordx4 v10, s[12:15], s36 offen lds
  s_barrier
  s_add_u32 m0, s35, 24576
  s_mov_b32 s36, 1703936
  buffer_load_dwordx4 v10, s[8:11], s36 offen lds
  s_add_u32 m0, s35, 25600
  s_mov_b32 s36, 1835008
  buffer_load_dwordx4 v10, s[8:11], s36 offen lds
  s_add_u32 m0, s35, 26624
  s_mov_b32 s36, 1966080
  buffer_load_dwordx4 v10, s[8:11], s36 offen lds
  s_add_u32 m0, s35, 27648
  s_mov_b32 s36, 2097152
  buffer_load_dwordx4 v10, s[8:11], s36 offen lds
  s_barrier
  s_add_u32 m0, s35, 28672
  s_mov_b32 s36, 1703936
  buffer_load_dwordx4 v10, s[12:15], s36 offen lds
  s_add_u32 m0, s35, 29696
  s_mov_b32 s36, 1835008
  buffer_load_dwordx4 v10, s[12:15], s36 offen lds
  s_add_u32 m0, s35, 30720
  s_mov_b32 s36, 1966080
  buffer_load_dwordx4 v10, s[12:15], s36 offen lds
  s_add_u32 m0, s35, 31744
  s_mov_b32 s36, 2097152
  buffer_load_dwordx4 v10, s[12:15], s36 offen lds
  s_cmp_lg_u32 s28, 0
  s_cbranch_scc1 L_rec_sigd
  s_waitcnt vmcnt(32)
  s_barrier
  s_cmp_lg_u32 s24, 0
  s_cbranch_scc1 Lsi_6
  s_mov_b64 exec, 1
  v_mov_b32 v30, 128
  v_mov_b32 v31, 1
  buffer_atomic_add v31, v30, s[20:23], 0 offen
  s_mov_b64 exec, -1
Lsi_6:
L_rec_sigd:
  s_waitcnt vmcnt(28)
  ds_read_b64_tr_b16 a[0:1], v7 offset:0
  ds_read_b64_tr_b16 a[2:3], v7 offset:256
  ds_read_b64_tr_b16 a[4:5], v7 offset:1024
  ds_read_b64_tr_b16 a[6:7], v7 offset:1280
  ds_read_b64_tr_b16 a[72:73], v7 offset:32
  ds_read_b64_tr_b16 a[74:75], v7 offset:288
  ds_read_b64_tr_b16 a[76:77], v7 offset:1056
  ds_read_b64_tr_b16 a[78:79], v7 offset:1312
  s_waitcnt lgkmcnt(8)
  s_barrier
  s_add_u32 m0, s35, 32768
  s_mov_b32 s36, 2359296
  buffer_load_dwordx4 v10, s[8:11], s36 offen lds
  s_add_u32 m0, s35, 33792
  s_mov_b32 s36, 2490368
  buffer_load_dwordx4 v10, s[8:11], s36 offen lds
  s_add_u32 m0, s35, 34816
  s_mov_b32 s36, 2621440
  buffer_load_dwordx4 v10, s[8:11], s36 offen lds
  s_add_u32 m0, s35, 35840
  s_mov_b32 s36, 2752512
  buffer_load_dwordx4 v10, s[8:11], s36 offen lds
  s_waitcnt vmcnt(28)
  ds_read_b64_tr_b16 a[144:145], v7 offset:4096
  ds_read_b64_tr_b16 a[146:147], v7 offset:4352
  ds_read_b64_tr_b16 a[148:149], v7 offset:5120
  ds_read_b64_tr_b16 a[150:151], v7 offset:5376
  ds_read_b64_tr_b16 a[216:217], v7 offset:4128
  ds_read_b64_tr_b16 a[218:219], v7 offset:4384
  ds_read_b64_tr_b16 a[220:221], v7 offset:5152
  ds_read_b64_tr_b16 a[222:223], v7 offset:5408
  s_waitcnt lgkmcnt(8)
  s_barrier
  s_add_u32 m0, s35, 0
  s_mov_b32 s36, 2359296
  buffer_load_dwordx4 v10, s[12:15], s36 offen lds
  s_add_u32 m0, s35, 1024
  s_mov_b32 s36, 2490368
  buffer_load_dwordx4 v10, s[12:15], s36 offen lds
  s_add_u32 m0, s35, 2048
  s_mov_b32 s36, 2621440
  buffer_load_dwordx4 v10, s[12:15], s36 offen lds
  s_add_u32 m0, s35, 3072
  s_mov_b32 s36, 2752512
  buffer_load_dwordx4 v10, s[12:15], s36 offen lds
  s_waitcnt vmcnt(28)
  ds_read_b64_tr_b16 a[8:9], v7 offset:8192
  ds_read_b64_tr_b16 a[10:11], v7 offset:8448
  ds_read_b64_tr_b16 a[12:13], v7 offset:9216
  ds_read_b64_tr_b16 a[14:15], v7 offset:9472
  ds_read_b64_tr_b16 a[80:81], v7 offset:8224
  ds_read_b64_tr_b16 a[82:83], v7 offset:8480
  ds_read_b64_tr_b16 a[84:85], v7 offset:9248
  ds_read_b64_tr_b16 a[86:87], v7 offset:9504
  s_waitcnt lgkmcnt(8)
  s_barrier
  s_add_u32 m0, s35, 4096
  s_mov_b32 s36, 2883584
  buffer_load_dwordx4 v10, s[8:11], s36 offen lds
  s_add_u32 m0, s35, 5120
  s_mov_b32 s36, 3014656
  buffer_load_dwordx4 v10, s[8:11], s36 offen lds
  s_add_u32 m0, s35, 6144
  s_mov_b32 s36, 3145728
  buffer_load_dwordx4 v10, s[8:11], s36 offen lds
  s_add_u32 m0, s35, 7168
  s_mov_b32 s36, 3276800
  buffer_load_dwordx4 v10, s[8:11], s36 offen lds
  s_waitcnt vmcnt(28)
  ds_read_b64_tr_b16 a[152:153], v7 offset:12288
  ds_read_b64_tr_b16 a[154:155], v7 offset:12544
  ds_read_b64_tr_b16 a[156:157], v7 offset:13312
  ds_read_b64_tr_b16 a[158:159], v7 offset:13568
  ds_read_b64_tr_b16 a[224:225], v7 offset:12320
  ds_read_b64_tr_b16 a[226:227], v7 offset:12576
  ds_read_b64_tr_b16 a[228:229], v7 offset:13344
  ds_read_b64_tr_b16 a[230:231], v7 offset:13600
  s_waitcnt lgkmcnt(8)
  s_barrier
  s_add_u32 m0, s35, 8192
  s_mov_b32 s36, 2883584
  buffer_load_dwordx4 v10, s[12:15], s36 offen lds
  s_add_u32 m0, s35, 9216
  s_mov_b32 s36, 3014656
  buffer_load_dwordx4 v10, s[12:15], s36 offen lds
  s_add_u32 m0, s35, 10240
  s_mov_b32 s36, 3145728
  buffer_load_dwordx4 v10, s[12:15], s36 offen lds
  s_add_u32 m0, s35, 11264
  s_mov_b32 s36, 3276800
  buffer_load_dwordx4 v10, s[12:15], s36 offen lds
  s_waitcnt vmcnt(28)
  ds_read_b64_tr_b16 a[16:17], v7 offset:16384
  ds_read_b64_tr_b16 a[18:19], v7 offset:16640
  ds_read_b64_tr_b16 a[20:21], v7 offset:17408
  ds_read_b64_tr_b16 a[22:23], v7 offset:17664
  ds_read_b64_tr_b16 a[88:89], v7 offset:16416
  ds_read_b64_tr_b16 a[90:91], v7 offset:16672
  ds_read_b64_tr_b16 a[92:93], v7 offset:17440
  ds_read_b64_tr_b16 a[94:95], v7 offset:17696
  s_waitcnt lgkmcnt(8)
  s_barrier
  s_add_u32 m0, s35, 12288
  s_mov_b32 s36, 3538944
  buffer_load_dwordx4 v10, s[8:11], s36 offen lds
  s_add_u32 m0, s35, 13312
  s_mov_b32 s36, 3670016
  buffer_load_dwordx4 v10, s[8:11], s36 offen lds
  s_add_u32 m0, s35, 14336
  s_mov_b32 s36, 3801088
  buffer_load_dwordx4 v10, s[8:11], s36 offen lds
  s_add_u32 m0, s35, 15360
  s_mov_b32 s36, 3932160
  buffer_load_dwordx4 v10, s[8:11], s36 offen lds
  s_waitcnt vmcnt(28)
  ds_read_b64_tr_b16 a[160:161], v7 offset:20480
  ds_read_b64_tr_b16 a[162:163], v7 offset:20736
  ds_read_b64_tr_b16 a[164:165], v7 offset:21504
  ds_read_b64_tr_b16 a[166:167], v7 offset:21760
  ds_read_b64_tr_b16 a[232:233], v7 offset:20512
  ds_read_b64_tr_b16 a[234:235], v7 offset:20768
  ds_read_b64_tr_b16 a[236:237], v7 offset:21536
  ds_read_b64_tr_b16 a[238:239], v7 offset:21792
  s_waitcnt lgkmcnt(8)
  s_barrier
  s_add_u32 m0, s35, 16384
  s_mov_b32 s36, 3538944
  buffer_load_dwordx4 v10, s[12:15], s36 offen lds
  s_add_u32 m0, s35, 17408
  s_mov_b32 s36, 3670016
  buffer_load_dwordx4 v10, s[12:15], s36 offen lds
  s_add_u32 m0, s35, 18432
  s_mov_b32 s36, 3801088
  buffer_load_dwordx4 v10, s[12:15], s36 offen lds
  s_add_u32 m0, s35, 19456
  s_mov_b32 s36, 3932160
  buffer_load_dwordx4 v10, s[12:15], s36 offen lds
  s_waitcnt vmcnt(28)
  ds_read_b64_tr_b16 a[24:25], v7 offset:24576
  ds_read_b64_tr_b16 a[26:27], v7 offset:24832
  ds_read_b64_tr_b16 a[28:29], v7 offset:25600
  ds_read_b64_tr_b16 a[30:31], v7 offset:25856
  ds_read_b64_tr_b16 a[96:97], v7 offset:24608
  ds_read_b64_tr_b16 a[98:99], v7 offset:24864
  ds_read_b64_tr_b16 a[100:101], v7 offset:25632
  ds_read_b64_tr_b16 a[102:103], v7 offset:25888
  s_waitcnt lgkmcnt(8)
  s_barrier
  s_add_u32 m0, s35, 20480
  s_mov_b32 s36, 4063232
  buffer_load_dwordx4 v10, s[8:11], s36 offen lds
  s_add_u32 m0, s35, 21504
  s_mov_b32 s36, 4194304
  buffer_load_dwordx4 v10, s[8:11], s36 offen lds
  s_add_u32 m0, s35, 22528
  s_mov_b32 s36, 4325376
  buffer_load_dwordx4 v10, s[8:11], s36 offen lds
  s_add_u32 m0, s35, 23552
  s_mov_b32 s36, 4456448
  buffer_load_dwordx4 v10, s[8:11], s36 offen lds
  s_waitcnt vmcnt(28)
  ds_read_b64_tr_b16 a[168:169], v7 offset:28672
  ds_read_b64_tr_b16 a[170:171], v7 offset:28928
  ds_read_b64_tr_b16 a[172:173], v7 offset:29696
  ds_read_b64_tr_b16 a[174:175], v7 offset:29952
  ds_read_b64_tr_b16 a[240:241], v7 offset:28704
  ds_read_b64_tr_b16 a[242:243], v7 offset:28960
  ds_read_b64_tr_b16 a[244:245], v7 offset:29728
  ds_read_b64_tr_b16 a[246:247], v7 offset:29984
  s_waitcnt lgkmcnt(8)
  s_barrier
  s_add_u32 m0, s35, 24576
  s_mov_b32 s36, 4063232
  buffer_load_dwordx4 v10, s[12:15], s36 offen lds
  s_add_u32 m0, s35, 25600
  s_mov_b32 s36, 4194304
  buffer_load_dwordx4 v10, s[12:15], s36 offen lds
  s_add_u32 m0, s35, 26624
  s_mov_b32 s36, 4325376
  buffer_load_dwordx4 v10, s[12:15], s36 offen lds
  s_add_u32 m0, s35, 27648
  s_mov_b32 s36, 4456448
  buffer_load_dwordx4 v10, s[12:15], s36 offen lds
  s_waitcnt vmcnt(28)
  ds_read_b64_tr_b16 a[32:33], v7 offset:32768
  ds_read_b64_tr_b16 a[34:35], v7 offset:33024
  ds_read_b64_tr_b16 a[36:37], v7 offset:33792
  ds_read_b64_tr_b16 a[38:39], v7 offset:34048
  ds_read_b64_tr_b16 a[104:105], v7 offset:32800
  ds_read_b64_tr_b16 a[106:107], v7 offset:33056
  ds_read_b64_tr_b16 a[108:109], v7 offset:33824
  ds_read_b64_tr_b16 a[110:111], v7 offset:34080
  s_waitcnt lgkmcnt(8)
  s_barrier
  s_add_u32 m0, s35, 28672
  s_mov_b32 s36, 1048576
  buffer_load_dwordx4 v10, s[8:11], s36 offen lds
  s_add_u32 m0, s35, 29696
  s_mov_b32 s36, 2228224
  buffer_load_dwordx4 v10, s[8:11], s36 offen lds
  s_add_u32 m0, s35, 30720
  s_mov_b32 s36, 3407872
  buffer_load_dwordx4 v10, s[8:11], s36 offen lds
  s_add_u32 m0, s35, 31744
  s_mov_b32 s36, 4587520
  buffer_load_dwordx4 v10, s[8:11], s36 offen lds
  s_waitcnt vmcnt(28)
  ds_read_b64_tr_b16 a[176:177], v7 offset:0
  ds_read_b64_tr_b16 a[178:179], v7 offset:256
  ds_read_b64_tr_b16 a[180:181], v7 offset:1024
  ds_read_b64_tr_b16 a[182:183], v7 offset:1280
  ds_read_b64_tr_b16 a[248:249], v7 offset:32
  ds_read_b64_tr_b16 a[250:251], v7 offset:288
  ds_read_b64_tr_b16 a[252:253], v7 offset:1056
  ds_read_b64_tr_b16 a[254:255], v7 offset:1312
  s_waitcnt lgkmcnt(8)
  s_barrier
  s_add_u32 m0, s35, 32768
  s_mov_b32 s36, 1048576
  buffer_load_dwordx4 v10, s[12:15], s36 offen lds
  s_add_u32 m0, s35, 33792
  s_mov_b32 s36, 2228224
  buffer_load_dwordx4 v10, s[12:15], s36 offen lds
  s_add_u32 m0, s35, 34816
  s_mov_b32 s36, 3407872
  buffer_load_dwordx4 v10, s[12:15], s36 offen lds
  s_add_u32 m0, s35, 35840
  s_mov_b32 s36, 4587520
  buffer_load_dwordx4 v10, s[12:15], s36 offen lds
  s_waitcnt vmcnt(28)
  ds_read_b64_tr_b16 a[40:41], v7 offset:4096
  ds_read_b64_tr_b16 a[42:43], v7 offset:4352
  ds_read_b64_tr_b16 a[44:45], v7 offset:5120
  ds_read_b64_tr_b16 a[46:47], v7 offset:5376
  ds_read_b64_tr_b16 a[112:113], v7 offset:4128
  ds_read_b64_tr_b16 a[114:115], v7 offset:4384
  ds_read_b64_tr_b16 a[116:117], v7 offset:5152
  ds_read_b64_tr_b16 a[118:119], v7 offset:5408
  s_waitcnt lgkmcnt(8)
  s_barrier
  s_add_u32 m0, s35, 0
  s_mov_b32 s36, 1048576
  buffer_load_dwordx4 v10, s[16:19], s36 offen lds
  s_add_u32 m0, s35, 1024
  s_mov_b32 s36, 2228224
  buffer_load_dwordx4 v10, s[16:19], s36 offen lds
  s_add_u32 m0, s35, 2048
  s_mov_b32 s36, 3407872
  buffer_load_dwordx4 v10, s[16:19], s36 offen lds
  s_add_u32 m0, s35, 3072
  s_mov_b32 s36, 4587520
  buffer_load_dwordx4 v10, s[16:19], s36 offen lds
  s_waitcnt vmcnt(28)
  ds_read_b64_tr_b16 a[184:185], v7 offset:8192
  ds_read_b64_tr_b16 a[186:187], v7 offset:8448
  ds_read_b64_tr_b16 a[188:189], v7 offset:9216
  ds_read_b64_tr_b16 a[190:191], v7 offset:9472
  ds_read_b64_tr_b16 v[80:81], v7 offset:8224
  ds_read_b64_tr_b16 v[82:83], v7 offset:8480
  ds_read_b64_tr_b16 v[84:85], v7 offset:9248
  ds_read_b64_tr_b16 v[86:87], v7 offset:9504
  s_waitcnt lgkmcnt(8)
  s_barrier
  s_add_u32 m0, s35, 4096
  s_mov_b32 s36, 32
  buffer_load_dwordx4 v11, s[40:43], s36 offen lds
  s_add_u32 m0, s35, 5120
  s_mov_b32 s36, 36896
  buffer_load_dwordx4 v11, s[40:43], s36 offen lds
  s_add_u32 m0, s35, 6144
  s_mov_b32 s36, 73760
  buffer_load_dwordx4 v11, s[40:43], s36 offen lds
  s_add_u32 m0, s35, 7168
  s_mov_b32 s36, 110624
  buffer_load_dwordx4 v11, s[40:43], s36 offen lds
  s_waitcnt vmcnt(28)
  ds_read_b64_tr_b16 a[48:49], v7 offset:12288
  ds_read_b64_tr_b16 a[50:51], v7 offset:12544
  ds_read_b64_tr_b16 a[52:53], v7 offset:13312
  ds_read_b64_tr_b16 a[54:55], v7 offset:13568
  ds_read_b64_tr_b16 a[120:121], v7 offset:12320
  ds_read_b64_tr_b16 a[122:123], v7 offset:12576
  ds_read_b64_tr_b16 a[124:125], v7 offset:13344
  ds_read_b64_tr_b16 a[126:127], v7 offset:13600
  s_waitcnt lgkmcnt(8)
  s_barrier
  s_add_u32 m0, s35, 8192
  s_mov_b32 s36, 64
  buffer_load_dwordx4 v11, s[40:43], s36 offen lds
  s_add_u32 m0, s35, 9216
  s_mov_b32 s36, 36928
  buffer_load_dwordx4 v11, s[40:43], s36 offen lds
  s_add_u32 m0, s35, 10240
  s_mov_b32 s36, 73792
  buffer_load_dwordx4 v11, s[40:43], s36 offen lds
  s_add_u32 m0, s35, 11264
  s_mov_b32 s36, 110656
  buffer_load_dwordx4 v11, s[40:43], s36 offen lds
  s_waitcnt vmcnt(28)
  ds_read_b64_tr_b16 a[192:193], v7 offset:16384
  ds_read_b64_tr_b16 a[194:195], v7 offset:16640
  ds_read_b64_tr_b16 a[196:197], v7 offset:17408
  ds_read_b64_tr_b16 a[198:199], v7 offset:17664
  ds_read_b64_tr_b16 v[88:89], v7 offset:16416
  ds_read_b64_tr_b16 v[90:91], v7 offset:16672
  ds_read_b64_tr_b16 v[92:93], v7 offset:17440
  ds_read_b64_tr_b16 v[94:95], v7 offset:17696
  s_waitcnt lgkmcnt(8)
  s_barrier
  s_add_u32 m0, s35, 12288
  s_mov_b32 s36, 96
  buffer_load_dwordx4 v11, s[40:43], s36 offen lds
  s_add_u32 m0, s35, 13312
  s_mov_b32 s36, 36960
  buffer_load_dwordx4 v11, s[40:43], s36 offen lds
  s_add_u32 m0, s35, 14336
  s_mov_b32 s36, 73824
  buffer_load_dwordx4 v11, s[40:43], s36 offen lds
  s_add_u32 m0, s35, 15360
  s_mov_b32 s36, 110688
  buffer_load_dwordx4 v11, s[40:43], s36 offen lds
  s_waitcnt vmcnt(28)
  ds_read_b64_tr_b16 a[56:57], v7 offset:20480
  ds_read_b64_tr_b16 a[58:59], v7 offset:20736
  ds_read_b64_tr_b16 a[60:61], v7 offset:21504
  ds_read_b64_tr_b16 a[62:63], v7 offset:21760
  ds_read_b64_tr_b16 a[128:129], v7 offset:20512
  ds_read_b64_tr_b16 a[130:131], v7 offset:20768
  ds_read_b64_tr_b16 a[132:133], v7 offset:21536
  ds_read_b64_tr_b16 a[134:135], v7 offset:21792
  s_waitcnt lgkmcnt(8)
  s_barrier
  s_add_u32 m0, s35, 16384
  s_mov_b32 s36, 128
  buffer_load_dwordx4 v11, s[40:43], s36 offen lds
  s_add_u32 m0, s35, 17408
  s_mov_b32 s36, 36992
  buffer_load_dwordx4 v11, s[40:43], s36 offen lds
  s_add_u32 m0, s35, 18432
  s_mov_b32 s36, 73856
  buffer_load_dwordx4 v11, s[40:43], s36 offen lds
  s_add_u32 m0, s35, 19456
  s_mov_b32 s36, 110720
  buffer_load_dwordx4 v11, s[40:43], s36 offen lds
  s_waitcnt vmcnt(28)
  ds_read_b64_tr_b16 a[200:201], v7 offset:24576
  ds_read_b64_tr_b16 a[202:203], v7 offset:24832
  ds_read_b64_tr_b16 a[204:205], v7 offset:25600
  ds_read_b64_tr_b16 a[206:207], v7 offset:25856
  ds_read_b64_tr_b16 v[96:97], v7 offset:24608
  ds_read_b64_tr_b16 v[98:99], v7 offset:24864
  ds_read_b64_tr_b16 v[100:101], v7 offset:25632
  ds_read_b64_tr_b16 v[102:103], v7 offset:25888
  s_waitcnt lgkmcnt(8)
  s_barrier
  s_add_u32 m0, s35, 20480
  s_mov_b32 s36, 160
  buffer_load_dwordx4 v11, s[40:43], s36 offen lds
  s_add_u32 m0, s35, 21504
  s_mov_b32 s36, 37024
  buffer_load_dwordx4 v11, s[40:43], s36 offen lds
  s_add_u32 m0, s35, 22528
  s_mov_b32 s36, 73888
  buffer_load_dwordx4 v11, s[40:43], s36 offen lds
  s_add_u32 m0, s35, 23552
  s_mov_b32 s36, 110752
  buffer_load_dwordx4 v11, s[40:43], s36 offen lds
  s_waitcnt vmcnt(28)
  ds_read_b64_tr_b16 a[64:65], v7 offset:28672
  ds_read_b64_tr_b16 a[66:67], v7 offset:28928
  ds_read_b64_tr_b16 a[68:69], v7 offset:29696
  ds_read_b64_tr_b16 a[70:71], v7 offset:29952
  ds_read_b64_tr_b16 a[136:137], v7 offset:28704
  ds_read_b64_tr_b16 a[138:139], v7 offset:28960
  ds_read_b64_tr_b16 a[140:141], v7 offset:29728
  ds_read_b64_tr_b16 a[142:143], v7 offset:29984
  s_waitcnt lgkmcnt(8)
  s_barrier
  s_add_u32 m0, s35, 24576
  s_mov_b32 s36, 192
  buffer_load_dwordx4 v11, s[40:43], s36 offen lds
  s_add_u32 m0, s35, 25600
  s_mov_b32 s36, 37056
  buffer_load_dwordx4 v11, s[40:43], s36 offen lds
  s_add_u32 m0, s35, 26624
  s_mov_b32 s36, 73920
  buffer_load_dwordx4 v11, s[40:43], s36 offen lds
  s_add_u32 m0, s35, 27648
  s_mov_b32 s36, 110784
  buffer_load_dwordx4 v11, s[40:43], s36 offen lds
  s_waitcnt vmcnt(28)
  ds_read_b64_tr_b16 a[208:209], v7 offset:32768
  ds_read_b64_tr_b16 a[210:211], v7 offset:33024
  ds_read_b64_tr_b16 a[212:213], v7 offset:33792
  ds_read_b64_tr_b16 a[214:215], v7 offset:34048
  ds_read_b64_tr_b16 v[104:105], v7 offset:32800
  ds_read_b64_tr_b16 v[106:107], v7 offset:33056
  ds_read_b64_tr_b16 v[108:109], v7 offset:33824
  ds_read_b64_tr_b16 v[110:111], v7 offset:34080
  s_waitcnt lgkmcnt(8)
  s_barrier
  s_add_u32 m0, s35, 28672
  s_mov_b32 s36, 224
  buffer_load_dwordx4 v11, s[40:43], s36 offen lds
  s_add_u32 m0, s35, 29696
  s_mov_b32 s36, 37088
  buffer_load_dwordx4 v11, s[40:43], s36 offen lds
  s_add_u32 m0, s35, 30720
  s_mov_b32 s36, 73952
  buffer_load_dwordx4 v11, s[40:43], s36 offen lds
  s_add_u32 m0, s35, 31744
  s_mov_b32 s36, 110816
  buffer_load_dwordx4 v11, s[40:43], s36 offen lds
  s_waitcnt vmcnt(28)
  ds_read_b64_tr_b16 v[112:113], v7 offset:0
  ds_read_b64_tr_b16 v[114:115], v7 offset:256
  ds_read_b64_tr_b16 v[116:117], v7 offset:1024
  ds_read_b64_tr_b16 v[118:119], v7 offset:1280
  ds_read_b64_tr_b16 v[120:121], v7 offset:32
  ds_read_b64_tr_b16 v[122:123], v7 offset:288
  ds_read_b64_tr_b16 v[124:125], v7 offset:1056
  ds_read_b64_tr_b16 v[126:127], v7 offset:1312
  s_waitcnt lgkmcnt(8)
  s_barrier
  s_add_u32 m0, s35, 32768
  s_mov_b32 s36, 256
  buffer_load_dwordx4 v11, s[40:43], s36 offen lds
  s_add_u32 m0, s35, 33792
  s_mov_b32 s36, 37120
  buffer_load_dwordx4 v11, s[40:43], s36 offen lds
  s_add_u32 m0, s35, 34816
  s_mov_b32 s36, 73984
  buffer_load_dwordx4 v11, s[40:43], s36 offen lds
  s_add_u32 m0, s35, 35840
  s_mov_b32 s36, 110848
  buffer_load_dwordx4 v11, s[40:43], s36 offen lds
  s_waitcnt vmcnt(28)
  ds_read_b64_tr_b16 v[128:129], v14 offset:4096
  ds_read_b64_tr_b16 v[130:131], v14 offset:4224
  ds_read_b64_tr_b16 v[132:133], v14 offset:4352
  ds_read_b64_tr_b16 v[134:135], v14 offset:4480
  ds_read_b64_tr_b16 v[136:137], v14 offset:6144
  ds_read_b64_tr_b16 v[138:139], v14 offset:6272
  ds_read_b64_tr_b16 v[140:141], v14 offset:6400
  ds_read_b64_tr_b16 v[142:143], v14 offset:6528
  s_waitcnt lgkmcnt(8)
  s_barrier
  s_add_u32 m0, s35, 0
  s_mov_b32 s36, 0
  buffer_load_dwordx4 v10, s[16:19], s36 offen lds
  s_add_u32 m0, s35, 1024
  s_mov_b32 s36, 131072
  buffer_load_dwordx4 v10, s[16:19], s36 offen lds
  s_add_u32 m0, s35, 2048
  s_mov_b32 s36, 262144
  buffer_load_dwordx4 v10, s[16:19], s36 offen lds
  s_add_u32 m0, s35, 3072
  s_mov_b32 s36, 393216
  buffer_load_dwordx4 v10, s[16:19], s36 offen lds
  s_waitcnt vmcnt(28)
  ds_read_b64_tr_b16 v[144:145], v14 offset:8192
  ds_read_b64_tr_b16 v[146:147], v14 offset:8320
  ds_read_b64_tr_b16 v[148:149], v14 offset:8448
  ds_read_b64_tr_b16 v[150:151], v14 offset:8576
  ds_read_b64_tr_b16 v[152:153], v14 offset:10240
  ds_read_b64_tr_b16 v[154:155], v14 offset:10368
  ds_read_b64_tr_b16 v[156:157], v14 offset:10496
  ds_read_b64_tr_b16 v[158:159], v14 offset:10624
  s_waitcnt lgkmcnt(8)
  s_barrier
  s_add_u32 m0, s35, 4096
  s_mov_b32 s36, 524288
  buffer_load_dwordx4 v10, s[16:19], s36 offen lds
  s_add_u32 m0, s35, 5120
  s_mov_b32 s36, 655360
  buffer_load_dwordx4 v10, s[16:19], s36 offen lds
  s_add_u32 m0, s35, 6144
  s_mov_b32 s36, 786432
  buffer_load_dwordx4 v10, s[16:19], s36 offen lds
  s_add_u32 m0, s35, 7168
  s_mov_b32 s36, 917504
  buffer_load_dwordx4 v10, s[16:19], s36 offen lds
  s_waitcnt vmcnt(28)
  ds_read_b64_tr_b16 v[160:161], v14 offset:12288
  ds_read_b64_tr_b16 v[162:163], v14 offset:12416
  ds_read_b64_tr_b16 v[164:165], v14 offset:12544
  ds_read_b64_tr_b16 v[166:167], v14 offset:12672
  ds_read_b64_tr_b16 v[168:169], v14 offset:14336
  ds_read_b64_tr_b16 v[170:171], v14 offset:14464
  ds_read_b64_tr_b16 v[172:173], v14 offset:14592
  ds_read_b64_tr_b16 v[174:175], v14 offset:14720
  s_waitcnt lgkmcnt(8)
  s_barrier
  s_add_u32 m0, s35, 8192
  s_mov_b32 s36, 1179648
  buffer_load_dwordx4 v10, s[16:19], s36 offen lds
  s_add_u32 m0, s35, 9216
  s_mov_b32 s36, 1310720
  buffer_load_dwordx4 v10, s[16:19], s36 offen lds
  s_add_u32 m0, s35, 10240
  s_mov_b32 s36, 1441792
  buffer_load_dwordx4 v10, s[16:19], s36 offen lds
  s_add_u32 m0, s35, 11264
  s_mov_b32 s36, 1572864
  buffer_load_dwordx4 v10, s[16:19], s36 offen lds
  s_waitcnt vmcnt(28)
  ds_read_b64_tr_b16 v[176:177], v14 offset:16384
  ds_read_b64_tr_b16 v[178:179], v14 offset:16512
  ds_read_b64_tr_b16 v[180:181], v14 offset:16640
  ds_read_b64_tr_b16 v[182:183], v14 offset:16768
  ds_read_b64_tr_b16 v[184:185], v14 offset:18432
  ds_read_b64_tr_b16 v[186:187], v14 offset:18560
  ds_read_b64_tr_b16 v[188:189], v14 offset:18688
  ds_read_b64_tr_b16 v[190:191], v14 offset:18816
  s_waitcnt lgkmcnt(8)
  s_barrier
  s_add_u32 m0, s35, 12288
  s_mov_b32 s36, 1703936
  buffer_load_dwordx4 v10, s[16:19], s36 offen lds
  s_add_u32 m0, s35, 13312
  s_mov_b32 s36, 1835008
  buffer_load_dwordx4 v10, s[16:19], s36 offen lds
  s_add_u32 m0, s35, 14336
  s_mov_b32 s36, 1966080
  buffer_load_dwordx4 v10, s[16:19], s36 offen lds
  s_add_u32 m0, s35, 15360
  s_mov_b32 s36, 2097152
  buffer_load_dwordx4 v10, s[16:19], s36 offen lds
  s_waitcnt vmcnt(28)
  ds_read_b64_tr_b16 v[192:193], v14 offset:20480
  ds_read_b64_tr_b16 v[194:195], v14 offset:20608
  ds_read_b64_tr_b16 v[196:197], v14 offset:20736
  ds_read_b64_tr_b16 v[198:199], v14 offset:20864
  ds_read_b64_tr_b16 v[200:201], v14 offset:22528
  ds_read_b64_tr_b16 v[202:203], v14 offset:22656
  ds_read_b64_tr_b16 v[204:205], v14 offset:22784
  ds_read_b64_tr_b16 v[206:207], v14 offset:22912
  s_waitcnt lgkmcnt(8)
  s_barrier
  s_add_u32 m0, s35, 16384
  s_mov_b32 s36, 2359296
  buffer_load_dwordx4 v10, s[16:19], s36 offen lds
  s_add_u32 m0, s35, 17408
  s_mov_b32 s36, 2490368
  buffer_load_dwordx4 v10, s[16:19], s36 offen lds
  s_add_u32 m0, s35, 18432
  s_mov_b32 s36, 2621440
  buffer_load_dwordx4 v10, s[16:19], s36 offen lds
  s_add_u32 m0, s35, 19456
  s_mov_b32 s36, 2752512
  buffer_load_dwordx4 v10, s[16:19], s36 offen lds
  s_waitcnt vmcnt(28)
  ds_read_b64_tr_b16 v[208:209], v14 offset:24576
  ds_read_b64_tr_b16 v[210:211], v14 offset:24704
  ds_read_b64_tr_b16 v[212:213], v14 offset:24832
  ds_read_b64_tr_b16 v[214:215], v14 offset:24960
  ds_read_b64_tr_b16 v[216:217], v14 offset:26624
  ds_read_b64_tr_b16 v[218:219], v14 offset:26752
  ds_read_b64_tr_b16 v[220:221], v14 offset:26880
  ds_read_b64_tr_b16 v[222:223], v14 offset:27008
  s_waitcnt lgkmcnt(8)
  s_barrier
  s_add_u32 m0, s35, 20480
  s_mov_b32 s36, 2883584
  buffer_load_dwordx4 v10, s[16:19], s36 offen lds
  s_add_u32 m0, s35, 21504
  s_mov_b32 s36, 3014656
  buffer_load_dwordx4 v10, s[16:19], s36 offen lds
  s_add_u32 m0, s35, 22528
  s_mov_b32 s36, 3145728
  buffer_load_dwordx4 v10, s[16:19], s36 offen lds
  s_add_u32 m0, s35, 23552
  s_mov_b32 s36, 3276800
  buffer_load_dwordx4 v10, s[16:19], s36 offen lds
  s_waitcnt vmcnt(28)
  ds_read_b64_tr_b16 v[224:225], v14 offset:28672
  ds_read_b64_tr_b16 v[226:227], v14 offset:28800
  ds_read_b64_tr_b16 v[228:229], v14 offset:28928
  ds_read_b64_tr_b16 v[230:231], v14 offset:29056
  ds_read_b64_tr_b16 v[232:233], v14 offset:30720
  ds_read_b64_tr_b16 v[234:235], v14 offset:30848
  ds_read_b64_tr_b16 v[236:237], v14 offset:30976
  ds_read_b64_tr_b16 v[238:239], v14 offset:31104
  s_waitcnt lgkmcnt(8)
  s_barrier
  s_add_u32 m0, s35, 24576
  s_mov_b32 s36, 3538944
  buffer_load_dwordx4 v10, s[16:19], s36 offen lds
  s_add_u32 m0, s35, 25600
  s_mov_b32 s36, 3670016
  buffer_load_dwordx4 v10, s[16:19], s36 offen lds
  s_add_u32 m0, s35, 26624
  s_mov_b32 s36, 3801088
  buffer_load_dwordx4 v10, s[16:19], s36 offen lds
  s_add_u32 m0, s35, 27648
  s_mov_b32 s36, 3932160
  buffer_load_dwordx4 v10, s[16:19], s36 offen lds
  s_waitcnt vmcnt(28)
  ds_read_b64_tr_b16 v[240:241], v14 offset:32768
  ds_read_b64_tr_b16 v[242:243], v14 offset:32896
  ds_read_b64_tr_b16 v[244:245], v14 offset:33024
  ds_read_b64_tr_b16 v[246:247], v14 offset:33152
  ds_read_b64_tr_b16 v[248:249], v14 offset:34816
  ds_read_b64_tr_b16 v[250:251], v14 offset:34944
  ds_read_b64_tr_b16 v[252:253], v14 offset:35072
  ds_read_b64_tr_b16 v[254:255], v14 offset:35200
  s_waitcnt lgkmcnt(8)
  s_barrier
  s_add_u32 m0, s35, 28672
  s_mov_b32 s36, 4063232
  buffer_load_dwordx4 v10, s[16:19], s36 offen lds
  s_add_u32 m0, s35, 29696
  s_mov_b32 s36, 4194304
  buffer_load_dwordx4 v10, s[16:19], s36 offen lds
  s_add_u32 m0, s35, 30720
  s_mov_b32 s36, 4325376
  buffer_load_dwordx4 v10, s[16:19], s36 offen lds
  s_add_u32 m0, s35, 31744
  s_mov_b32 s36, 4456448
  buffer_load_dwordx4 v10, s[16:19], s36 offen lds
  s_waitcnt vmcnt(28)
  ds_read_b64_tr_b16 v[16:17], v7 offset:0
  ds_read_b64_tr_b16 v[18:19], v7 offset:256
  ds_read_b64_tr_b16 v[20:21], v7 offset:1024
  ds_read_b64_tr_b16 v[22:23], v7 offset:1280
  ds_read_b64_tr_b16 v[24:25], v7 offset:32
  ds_read_b64_tr_b16 v[26:27], v7 offset:288
  ds_read_b64_tr_b16 v[28:29], v7 offset:1056
  ds_read_b64_tr_b16 v[30:31], v7 offset:1312
  s_waitcnt lgkmcnt(0)
  s_barrier
  s_add_u32 m0, s35, 32768
  s_mov_b32 s36, 0
  buffer_load_dwordx4 v11, s[40:43], s36 offen lds
  s_add_u32 m0, s35, 33792
  s_mov_b32 s36, 36864
  buffer_load_dwordx4 v11, s[40:43], s36 offen lds
  s_add_u32 m0, s35, 34816
  s_mov_b32 s36, 73728
  buffer_load_dwordx4 v11, s[40:43], s36 offen lds
  s_add_u32 m0, s35, 35840
  s_mov_b32 s36, 110592
  buffer_load_dwordx4 v11, s[40:43], s36 offen lds
  ds_write_b128 v15, v[16:19] offset:0
  ds_write_b128 v15, v[20:23] offset:1024
  ds_write_b128 v15, v[24:27] offset:2048
  ds_write_b128 v15, v[28:31] offset:3072
  s_waitcnt vmcnt(28)
  ds_read_b64_tr_b16 v[16:17], v7 offset:4096
  ds_read_b64_tr_b16 v[18:19], v7 offset:4352
  ds_read_b64_tr_b16 v[20:21], v7 offset:5120
  ds_read_b64_tr_b16 v[22:23], v7 offset:5376
  ds_read_b64_tr_b16 v[24:25], v7 offset:4128
  ds_read_b64_tr_b16 v[26:27], v7 offset:4384
  ds_read_b64_tr_b16 v[28:29], v7 offset:5152
  ds_read_b64_tr_b16 v[30:31], v7 offset:5408
  s_waitcnt lgkmcnt(0)
  ds_write_b128 v15, v[16:19] offset:4096
  ds_write_b128 v15, v[20:23] offset:5120
  ds_write_b128 v15, v[24:27] offset:6144
  ds_write_b128 v15, v[28:31] offset:7168
  s_waitcnt vmcnt(24)
  ds_read_b64_tr_b16 v[16:17], v7 offset:8192
  ds_read_b64_tr_b16 v[18:19], v7 offset:8448
  ds_read_b64_tr_b16 v[20:21], v7 offset:9216
  ds_read_b64_tr_b16 v[22:23], v7 offset:9472
  ds_read_b64_tr_b16 v[24:25], v7 offset:8224
  ds_read_b64_tr_b16 v[26:27], v7 offset:8480
  ds_read_b64_tr_b16 v[28:29], v7 offset:9248
  ds_read_b64_tr_b16 v[30:31], v7 offset:9504
  s_waitcnt lgkmcnt(0)
  ds_write_b128 v15, v[16:19] offset:8192
  ds_write_b128 v15, v[20:23] offset:9216
  ds_write_b128 v15, v[24:27] offset:10240
  ds_write_b128 v15, v[28:31] offset:11264
  s_waitcnt vmcnt(20)
  ds_read_b64_tr_b16 v[16:17], v7 offset:12288
  ds_read_b64_tr_b16 v[18:19], v7 offset:12544
  ds_read_b64_tr_b16 v[20:21], v7 offset:13312
  ds_read_b64_tr_b16 v[22:23], v7 offset:13568
  ds_read_b64_tr_b16 v[24:25], v7 offset:12320
  ds_read_b64_tr_b16 v[26:27], v7 offset:12576
  ds_read_b64_tr_b16 v[28:29], v7 offset:13344
  ds_read_b64_tr_b16 v[30:31], v7 offset:13600
  s_waitcnt lgkmcnt(0)
  ds_write_b128 v15, v[16:19] offset:12288
  ds_write_b128 v15, v[20:23] offset:13312
  ds_write_b128 v15, v[24:27] offset:14336
  ds_write_b128 v15, v[28:31] offset:15360
  s_waitcnt vmcnt(16)
  ds_read_b64_tr_b16 v[16:17], v7 offset:16384
  ds_read_b64_tr_b16 v[18:19], v7 offset:16640
  ds_read_b64_tr_b16 v[20:21], v7 offset:17408
  ds_read_b64_tr_b16 v[22:23], v7 offset:17664
  ds_read_b64_tr_b16 v[24:25], v7 offset:16416
  ds_read_b64_tr_b16 v[26:27], v7 offset:16672
  ds_read_b64_tr_b16 v[28:29], v7 offset:17440
  ds_read_b64_tr_b16 v[30:31], v7 offset:17696
  s_waitcnt lgkmcnt(0)
  ds_write_b128 v15, v[16:19] offset:16384
  ds_write_b128 v15, v[20:23] offset:17408
  ds_write_b128 v15, v[24:27] offset:18432
  ds_write_b128 v15, v[28:31] offset:19456
  s_waitcnt vmcnt(12)
  ds_read_b64_tr_b16 v[16:17], v7 offset:20480
  ds_read_b64_tr_b16 v[18:19], v7 offset:20736
  ds_read_b64_tr_b16 v[20:21], v7 offset:21504
  ds_read_b64_tr_b16 v[22:23], v7 offset:21760
  ds_read_b64_tr_b16 v[24:25], v7 offset:20512
  ds_read_b64_tr_b16 v[26:27], v7 offset:20768
  ds_read_b64_tr_b16 v[28:29], v7 offset:21536
  ds_read_b64_tr_b16 v[30:31], v7 offset:21792
  s_waitcnt lgkmcnt(0)
  ds_write_b128 v15, v[16:19] offset:20480
  ds_write_b128 v15, v[20:23] offset:21504
  ds_write_b128 v15, v[24:27] offset:22528
  ds_write_b128 v15, v[28:31] offset:23552
  s_waitcnt vmcnt(8)
  ds_read_b64_tr_b16 v[16:17], v7 offset:24576
  ds_read_b64_tr_b16 v[18:19], v7 offset:24832
  ds_read_b64_tr_b16 v[20:21], v7 offset:25600
  ds_read_b64_tr_b16 v[22:23], v7 offset:25856
  ds_read_b64_tr_b16 v[24:25], v7 offset:24608
  ds_read_b64_tr_b16 v[26:27], v7 offset:24864
  ds_read_b64_tr_b16 v[28:29], v7 offset:25632
  ds_read_b64_tr_b16 v[30:31], v7 offset:25888
  s_waitcnt lgkmcnt(0)
  ds_write_b128 v15, v[16:19] offset:24576
  ds_write_b128 v15, v[20:23] offset:25600
  ds_write_b128 v15, v[24:27] offset:26624
  ds_write_b128 v15, v[28:31] offset:27648
  s_waitcnt vmcnt(4)
  ds_read_b64_tr_b16 v[16:17], v7 offset:28672
  ds_read_b64_tr_b16 v[18:19], v7 offset:28928
  ds_read_b64_tr_b16 v[20:21], v7 offset:29696
  ds_read_b64_tr_b16 v[22:23], v7 offset:29952
  ds_read_b64_tr_b16 v[24:25], v7 offset:28704
  ds_read_b64_tr_b16 v[26:27], v7 offset:28960
  ds_read_b64_tr_b16 v[28:29], v7 offset:29728
  ds_read_b64_tr_b16 v[30:31], v7 offset:29984
  s_waitcnt lgkmcnt(0)
  ds_write_b128 v15, v[16:19] offset:28672
  ds_write_b128 v15, v[20:23] offset:29696
  ds_write_b128 v15, v[24:27] offset:30720
  ds_write_b128 v15, v[28:31] offset:31744
  s_waitcnt vmcnt(0)
  ds_read_b64_tr_b16 v[16:17], v14 offset:32768
  ds_read_b64_tr_b16 v[18:19], v14 offset:32896
  ds_read_b64_tr_b16 v[20:21], v14 offset:33024
  ds_read_b64_tr_b16 v[22:23], v14 offset:33152
  ds_read_b64_tr_b16 v[24:25], v14 offset:34816
  ds_read_b64_tr_b16 v[26:27], v14 offset:34944
  ds_read_b64_tr_b16 v[28:29], v14 offset:35072
  ds_read_b64_tr_b16 v[30:31], v14 offset:35200
  s_waitcnt lgkmcnt(0)
  ds_write_b128 v15, v[16:19] offset:32768
  ds_write_b128 v15, v[20:23] offset:33792
  ds_write_b128 v15, v[24:27] offset:34816
  ds_write_b128 v15, v[28:31] offset:35840
  v_lshlrev_b32 v8, 1, v0
  v_lshrrev_b32 v9, 4, v0
  v_lshl_add_u32 v12, v9, 8, v8
  s_mul_i32 s33, s24, 2304
  buffer_load_ushort v32, v8, s[44:47], s33 offen offset:0
  buffer_load_ushort v33, v8, s[44:47], s33 offen offset:128
  buffer_load_ushort v34, v8, s[44:47], s33 offen offset:288
  buffer_load_ushort v35, v8, s[44:47], s33 offen offset:416
  buffer_load_ushort v36, v8, s[44:47], s33 offen offset:576
  buffer_load_ushort v37, v8, s[44:47], s33 offen offset:704
  buffer_load_ushort v38, v8, s[44:47], s33 offen offset:864
  buffer_load_ushort v39, v8, s[44:47], s33 offen offset:992
  buffer_load_ushort v40, v12, s[44:47], s33 offen offset:256
  buffer_load_ushort v41, v8, s[44:47], s33 offen offset:1152
  buffer_load_ushort v42, v8, s[44:47], s33 offen offset:1280
  buffer_load_ushort v43, v8, s[44:47], s33 offen offset:1440
  buffer_load_ushort v44, v8, s[44:47], s33 offen offset:1568
  buffer_load_ushort v45, v8, s[44:47], s33 offen offset:1728
  buffer_load_ushort v46, v8, s[44:47], s33 offen offset:1856
  buffer_load_ushort v47, v8, s[44:47], s33 offen offset:2016
  buffer_load_ushort v48, v8, s[44:47], s33 offen offset:2144
  buffer_load_ushort v49, v12, s[44:47], s33 offen offset:1408
  v_bfe_u32 v8, v0, 3, 1
  v_lshlrev_b32 v8, 9, v8
  v_lshl_add_u32 v8, v9, 5, v8
  v_and_b32 v9, 7, v0
  v_lshl_add_u32 v8, v9, 2, v8
  v_lshrrev_b32 v12, 5, v0
  v_lshlrev_b32 v12, 9, v12
  v_and_b32 v9, 31, v0
  v_lshl_add_u32 v12, v9, 2, v12
  s_lshr_b32 s33, s24, 1
  s_lshl_b32 s33, s33, 6
  v_xor_b32 v8, s33, v8
  v_xor_b32 v12, s33, v12
  s_lshl_b32 s33, s24, 7
  s_add_u32 s33, s33, 147456
  v_add_u32 v8, s33, v8
  v_add_u32 v12, s33, v12
  s_waitcnt vmcnt(0)
  ds_write_b16 v12, v32 offset:0
  ds_write_b16 v12, v33 offset:1024
  ds_write_b16 v12, v34 offset:2048
  ds_write_b16 v12, v35 offset:3072
  ds_write_b16 v12, v36 offset:4096
  ds_write_b16 v12, v37 offset:5120
  ds_write_b16 v12, v38 offset:6144
  ds_write_b16 v12, v39 offset:7168
  ds_write_b16 v12, v40 offset:8192
  ds_write_b16 v12, v41 offset:2
  ds_write_b16 v12, v42 offset:1026
  ds_write_b16 v12, v43 offset:2050
  ds_write_b16 v12, v44 offset:3074
  ds_write_b16 v12, v45 offset:4098
  ds_write_b16 v12, v46 offset:5122
  ds_write_b16 v12, v47 offset:6146
  ds_write_b16 v12, v48 offset:7170
  ds_write_b16 v12, v49 offset:8194
  v_and_b32 v16, 3, v0
  v_bfe_u32 v17, v0, 2, 2
  v_lshrrev_b32 v18, 4, v0
  v_and_b32 v19, 15, v0
  v_and_b32 v20, 1, v0
  v_bfe_u32 v21, v0, 4, 1
  v_lshrrev_b32 v22, 5, v0
  v_bfe_u32 v23, v0, 3, 1
  v_and_b32 v24, 7, v0
  v_bfe_u32 v27, v0, 1, 1
  v_mov_b32 v2, 0xe4844444
  v_mov_b32 v25, 0xee9eeeee
  v_mov_b32 v26, 0x84e44444
  v_mov_b32 v28, 0x9eeeeeee
  v_cmp_eq_u32 vcc, 1, v27
  s_nop 1
  v_cndmask_b32 v2, v2, v25, vcc
  v_cndmask_b32 v26, v26, v28, vcc
  v_cmp_eq_u32 vcc, 1, v22
  s_nop 1
  v_cndmask_b32 v2, v2, v26, vcc
  v_lshrrev_b32 v3, 2, v0
  v_lshlrev_b32 v3, 3, v3
  v_lshlrev_b32 v25, 6, v27
  v_xor_b32 v3, v3, v25
  v_lshl_add_u32 v3, v16, 7, v3
  v_add_u32 v3, 147456, v3
  s_lshl_b32 s33, s24, 9
  s_mul_i32 s34, s24, 1280
  s_add_u32 s34, s34, 158720
  v_xor_b32 v25, v23, v22
  v_lshlrev_b32 v4, 6, v25
  v_lshl_add_u32 v4, v18, 7, v4
  v_lshl_add_u32 v4, v24, 2, v4
  s_add_u32 s35, s33, 156672
  v_add_u32 v4, s35, v4
  v_mul_u32_u24 v13, 4224, v22
  v_and_b32 v25, 31, v0
  v_lshl_add_u32 v13, v25, 2, v13
  s_lshl_b32 s35, s29, 7
  s_add_u32 s35, s35, s31
  v_add_u32 v13, s35, v13
  v_lshlrev_b32 v5, 4, v19
  v_lshl_add_u32 v5, v18, 2, v5
  v_add_u32 v5, s34, v5
  v_lshlrev_b32 v6, 7, v18
  v_lshl_add_u32 v6, v24, 4, v6
  v_add_u32 v6, s33, v6
  v_lshl_add_u32 v25, v21, 2, v17
  v_lshl_add_u32 v25, v22, 4, v25
  v_lshlrev_b32 v25, 4, v25
  v_lshl_add_u32 v25, v20, 3, v25
  v_add_u32 v7, s34, v25
  v_bfe_u32 v25, v0, 1, 2
  v_lshl_add_u32 v25, v25, 2, v20
  v_lshl_add_u32 v25, v23, 1, v25
  v_lshl_add_u32 v25, v18, 4, v25
  v_lshl_add_u32 v8, v25, 4, s34
  v_lshl_add_u32 v9, v25, 2, s34
  v_mov_b32 v10, v15
  v_bfe_u32 v25, v0, 2, 1
  v_lshl_add_u32 v25, v25, 4, v20
  v_lshl_add_u32 v25, v23, 3, v25
  v_lshl_add_u32 v25, v27, 2, v25
  v_lshlrev_b32 v26, 10, v22
  v_lshl_add_u32 v26, v21, 9, v26
  s_lshl_b32 s35, s24, 11
  s_add_u32 s35, s35, 8192
  v_add_u32 v26, s35, v26
  v_lshl_add_u32 v11, v25, 4, v26
  v_lshl_add_u32 v12, v19, 4, v26
  v_add_u32 v12, 8192, v12
  v_bfe_u32 v14, v0, 2, 1
  v_lshlrev_b32 v14, 7, v14
  v_lshl_add_u32 v14, v16, 4, v14
  v_lshl_add_u32 v14, v18, 2, v14
  s_lshr_b32 s35, s30, 2
  s_lshl_b32 s35, s35, 9
  s_and_b32 s36, s30, 1
  s_lshl_b32 s41, s36, 8
  s_add_u32 s35, s35, s41
  s_bfe_u32 s41, s30, 0x10001
  s_xor_b32 s36, s36, s41
  s_lshl_b32 s36, s36, 6
  s_add_u32 s35, s35, s36
  v_add_u32 v14, s35, v14
  s_cmp_lg_u32 s24, 2
  s_cbranch_scc1 L_rec_c0
  v_lshlrev_b32 v14, 4, v20
  v_lshl_add_u32 v14, v18, 2, v14
  s_bfe_u32 s35, s29, 0x10004
  s_lshl_b32 s35, s35, 9
  s_bfe_u32 s36, s29, 0x20001
  s_lshl_b32 s36, s36, 7
  s_add_u32 s35, s35, s36
  s_bfe_u32 s36, s29, 0x10003
  s_bfe_u32 s41, s29, 0x10002
  s_xor_b32 s36, s36, s41
  s_lshl_b32 s36, s36, 6
  s_add_u32 s35, s35, s36
  s_and_b32 s36, s29, 1
  s_lshl_b32 s36, s36, 5
  s_add_u32 s35, s35, s36
  s_add_u32 s35, s35, 8192
  v_add_u32 v14, s35, v14
L_rec_c0:
  v_mov_b32 v15, 0x3f80
  v_mov_b32 v25, 1.0
  v_cmp_eq_u32 vcc, 1, v20
  s_nop 1
  v_cndmask_b32 v15, v15, v25, vcc
  s_cmp_lg_u32 s24, 3
  s_cbranch_scc1 L_rec_c1
  v_lshlrev_b32 v14, 7, v0
  v_bfe_u32 v15, v0, 2, 1
  v_lshlrev_b32 v15, 14, v15
  v_lshl_add_u32 v15, v16, 7, v15
L_rec_c1:
  s_lshl_b32 s35, s29, 9
  s_lshl_b32 s36, s28, 2
  s_add_u32 s35, s35, s36
  s_add_u32 s35, s35, 0
  s_add_u32 s84, s92, s35
  s_addc_u32 s85, s93, 0
  s_mov_b32 s86, 0x30003
  s_mov_b32 s87, 0x30003
  s_mov_b32 s88, 0x300030
  s_mov_b32 s89, 0x300030
  s_mov_b32 s90, 0x3000300
  s_mov_b32 s91, 0x3000300
  s_mov_b32 s92, 0x30003000
  s_mov_b32 s93, 0x30003000
  s_add_u32 s52, s33, 2048
  s_mul_i32 s53, s24, 67584
  s_mul_i32 s54, s24, 9216
  s_add_u32 s54, s54, 270336
  s_lshl_b32 s35, s29, 5
  s_add_u32 s54, s54, s35
  s_add_u32 s54, s54, s31
  s_mov_b32 s83, 0x433c35a6
  s_mov_b32 s40, 0xbe0293ee
  s_mov_b32 s42, 0x3e0293ee
  s_mov_b32 s43, 0x3e0293ee
  s_mov_b32 s44, 0x3f803f80
  s_mov_b32 s45, 0x3f803f80
  s_mov_b32 s46, 0x3f803f80
  s_mov_b32 s47, 0
  s_mov_b32 s48, 0
  s_mov_b32 s49, -1
  s_mov_b32 s94, 0xff00ff00
  s_mov_b32 s95, 0xff00ff00
  s_lshl_b32 s39, s28, 6
  s_mov_b32 s51, 0
  v_mov_b32 v16, 128
Lwi_7:
  buffer_load_dword v17, v16, s[20:23], 0 offen sc1
  s_waitcnt vmcnt(0)
  v_cmp_gt_u32 vcc, 0x100, v17
  s_cbranch_vccz Lwiok_8
  s_add_u32 s60, s60, 1
  s_cmp_gt_u32 s60, 262144
  s_cbranch_scc1 L_fail_rec
  s_sleep 4
  s_branch Lwi_7
Lwiok_8:
  s_lshr_b32 s33, s26, 5
  s_lshl_b32 s33, s33, 2
  v_mov_b32 v16, s33
  buffer_load_dword v17, v16, s[20:23], 0 offen sc1
  s_waitcnt vmcnt(0)
  v_readfirstlane_b32 s33, v17
  s_lshl_b32 s62, s29, 9
  s_lshl_b32 s34, s28, 2
  s_add_u32 s62, s62, s34
  s_add_u32 s62, s62, 0
  s_lshl_b32 s63, s28, 9
  s_add_u32 s63, s63, 164864
  s_lshl_b32 s101, s28, 5
  s_add_u32 s101, s101, s29
  s_lshl_b32 s101, s101, 7
  s_add_u32 s101, s101, 32768
  s_lshl_b32 s63, s24, 11
  s_add_u32 s59, s63, 147456
  s_mov_b32 s2, 0
  s_mov_b32 s3, 0
  s_mul_i32 s57, s29, 129
  s_add_u32 s57, s57, 0
  s_mul_i32 s34, s57, 24576
  s_add_u32 s34, s34, 19480576
  s_lshl_b32 s57, s57, 12
  s_add_u32 s57, s57, 120930304
  s_mov_b32 s41, 0x40000000
  s_mov_b32 s99, 0x40000000
  v_and_b32 v16, 3, v0
  v_lshlrev_b32 v16, 7, v16
Lwf_9:
  s_mov_b64 exec, 15
  buffer_load_dword v17, v16, s[4:7], s62 offen sc1
  s_waitcnt vmcnt(0)
  v_cmp_ge_u32 vcc, 0, v17
  s_mov_b64 exec, -1
  s_cbranch_vccz Lwfok_10
  s_add_u32 s60, s60, 1
  s_cmp_gt_u32 s60, 262144
  s_cbranch_scc1 L_fail_rec
  s_sleep 1
  s_branch Lwf_9
Lwfok_10:
  s_cmp_ge_u32 s33, 32
  s_cbranch_scc0 L_rec_slow
  s_cmp_eq_u32 s24, 2
  s_cbranch_scc1 L_recf2_redo
  s_cmp_eq_u32 s24, 3
  s_cbranch_scc1 L_recf3_redo
L_recf0_redo:
  s_waitcnt lgkmcnt(0)
  v_mov_b64 v[24:25], 0
  v_mov_b64 v[26:27], 0
  v_mov_b64 v[28:29], 0
  v_mov_b64 v[30:31], 0
  v_mov_b64 v[32:33], 0
  v_mov_b64 v[34:35], 0
  v_mov_b64 v[36:37], 0
  v_mov_b64 v[38:39], 0
  v_mov_b64 v[40:41], 0
  v_mov_b64 v[42:43], 0
  v_mov_b64 v[44:45], 0
  v_mov_b64 v[46:47], 0
  ds_read_b128 v[48:51], v10 offset:0
  ds_read_b128 v[52:55], v10 offset:1024
  ds_read_b128 v[56:59], v10 offset:2048
  ds_read_b128 v[60:63], v10 offset:3072
  s_waitcnt lgkmcnt(0)
  s_branch L_recf0_step
L_recf0_g5:
  s_barrier
  buffer_load_dwordx4 v1, s[4:7], s33 offen offset:0 sc1 lds
  buffer_load_dwordx4 v1, s[4:7], s33 offen offset:1024 sc1 lds
L_recf0_g:
  s_waitcnt vmcnt(0)
  ds_read_b128 v[16:19], v0
  ds_read_b128 v[20:23], v0 offset:1024
  s_waitcnt lgkmcnt(1)
  v_max3_u32 v16, v16, v17, v18
  s_waitcnt lgkmcnt(0)
  v_max3_u32 v20, v20, v21, v22
  v_max3_u32 v16, v16, v19, v23
  v_max_u32 v16, v16, v20
  v_cmp_eq_u32 vcc, -1, v16
  s_cbranch_vccnz L_recf0_gr
L_recf0_step:
  s_barrier
  ds_read_b64_tr_b16 v[16:17], v3 offset:0
  ds_read_b64_tr_b16 v[18:19], v3 offset:512
  buffer_load_dwordx4 v[72:75], v11, s[4:7], s34 offen sc1
  buffer_load_dwordx4 v[76:79], v11, s[4:7], s34 offen offset:32 sc1
  s_waitcnt lgkmcnt(0)
  v_smfmac_f32_16x16x64_bf16 v[24:27], v[16:19], a[0:7], v2
  ds_read_b64_tr_b16 v[20:21], v3 offset:1024
  v_smfmac_f32_16x16x64_bf16 v[40:43], v[16:19], v[48:55], v2
  ds_read_b64_tr_b16 v[22:23], v3 offset:1536
  v_smfmac_f32_16x16x64_bf16 v[28:31], v[16:19], a[72:79], v2
  ds_read_b128 v[48:51], v10 offset:4096
  buffer_load_dwordx4 v[68:71], v12, s[4:7], s34 offen sc1
  v_smfmac_f32_16x16x64_bf16 v[32:35], v[16:19], a[144:151], v2
  ds_read_b128 v[52:55], v10 offset:5120
  v_smfmac_f32_16x16x64_bf16 v[44:47], v[16:19], v[56:63], v2
  buffer_load_dwordx4 v[64:67], v12, s[4:7], s34 offen offset:256 sc1
  v_smfmac_f32_16x16x64_bf16 v[36:39], v[16:19], a[216:223], v2
  ds_read_b128 v[56:59], v10 offset:6144
  s_waitcnt lgkmcnt(3)
  v_smfmac_f32_16x16x64_bf16 v[24:27], v[20:23], a[8:15], v2
  ds_read_b128 v[60:63], v10 offset:7168
  ds_read_b64_tr_b16 v[16:17], v3 offset:2048
  s_waitcnt lgkmcnt(3)
  v_smfmac_f32_16x16x64_bf16 v[40:43], v[20:23], v[48:55], v2
  ds_read_b64_tr_b16 v[18:19], v3 offset:2560
  v_smfmac_f32_16x16x64_bf16 v[28:31], v[20:23], a[80:87], v2
  ds_read_b128 v[48:51], v10 offset:8192
  v_mov_b32 v0, -1
  v_smfmac_f32_16x16x64_bf16 v[32:35], v[20:23], a[152:159], v2
  ds_read_b128 v[52:55], v10 offset:9216
  s_waitcnt lgkmcnt(4)
  v_smfmac_f32_16x16x64_bf16 v[44:47], v[20:23], v[56:63], v2
  v_smfmac_f32_16x16x64_bf16 v[36:39], v[20:23], a[224:231], v2
  ds_read_b128 v[56:59], v10 offset:10240
  s_waitcnt lgkmcnt(3)
  v_smfmac_f32_16x16x64_bf16 v[24:27], v[16:19], a[16:23], v2
  ds_read_b128 v[60:63], v10 offset:11264
  ds_read_b64_tr_b16 v[20:21], v3 offset:3072
  s_waitcnt lgkmcnt(3)
  v_smfmac_f32_16x16x64_bf16 v[40:43], v[16:19], v[48:55], v2
  ds_read_b64_tr_b16 v[22:23], v3 offset:3584
  v_smfmac_f32_16x16x64_bf16 v[28:31], v[16:19], a[88:95], v2
  ds_read_b128 v[48:51], v10 offset:12288
  v_smfmac_f32_16x16x64_bf16 v[32:35], v[16:19], a[160:167], v2
  ds_read_b128 v[52:55], v10 offset:13312
  s_waitcnt lgkmcnt(4)
  v_smfmac_f32_16x16x64_bf16 v[44:47], v[16:19], v[56:63], v2
  buffer_store_dword v0, v1, s[4:7], s41 offen offset:0
  v_smfmac_f32_16x16x64_bf16 v[36:39], v[16:19], a[232:239], v2
  ds_read_b128 v[56:59], v10 offset:14336
  s_waitcnt lgkmcnt(3)
  v_smfmac_f32_16x16x64_bf16 v[24:27], v[20:23], a[24:31], v2
  ds_read_b128 v[60:63], v10 offset:15360
  ds_read_b64_tr_b16 v[16:17], v3 offset:4096
  s_waitcnt lgkmcnt(3)
  v_smfmac_f32_16x16x64_bf16 v[40:43], v[20:23], v[48:55], v2
  ds_read_b64_tr_b16 v[18:19], v3 offset:4608
  v_smfmac_f32_16x16x64_bf16 v[28:31], v[20:23], a[96:103], v2
  ds_read_b128 v[48:51], v10 offset:16384
  v_smfmac_f32_16x16x64_bf16 v[32:35], v[20:23], a[168:175], v2
  ds_read_b128 v[52:55], v10 offset:17408
  s_waitcnt lgkmcnt(4)
  v_smfmac_f32_16x16x64_bf16 v[44:47], v[20:23], v[56:63], v2
  buffer_store_dword v0, v1, s[4:7], s41 offen offset:1024
  v_smfmac_f32_16x16x64_bf16 v[36:39], v[20:23], a[240:247], v2
  ds_read_b128 v[56:59], v10 offset:18432
  s_waitcnt lgkmcnt(3)
  v_smfmac_f32_16x16x64_bf16 v[24:27], v[16:19], a[32:39], v2
  ds_read_b128 v[60:63], v10 offset:19456
  ds_read_b64_tr_b16 v[20:21], v3 offset:5120
  s_waitcnt lgkmcnt(3)
  v_smfmac_f32_16x16x64_bf16 v[40:43], v[16:19], v[48:55], v2
  ds_read_b64_tr_b16 v[22:23], v3 offset:5632
  v_smfmac_f32_16x16x64_bf16 v[28:31], v[16:19], a[104:111], v2
  ds_read_b128 v[48:51], v10 offset:20480
  s_add_u32 s58, s57, s52
  s_add_u32 s35, s51, 1
  v_smfmac_f32_16x16x64_bf16 v[32:35], v[16:19], a[176:183], v2
  ds_read_b128 v[52:55], v10 offset:21504
  s_waitcnt lgkmcnt(4)
  v_smfmac_f32_16x16x64_bf16 v[44:47], v[16:19], v[56:63], v2
  buffer_store_dword v0, v1, s[4:7], s41 offen offset:2048
  v_smfmac_f32_16x16x64_bf16 v[36:39], v[16:19], a[248:255], v2
  ds_read_b128 v[56:59], v10 offset:22528
  s_waitcnt lgkmcnt(3)
  v_smfmac_f32_16x16x64_bf16 v[24:27], v[20:23], a[40:47], v2
  ds_read_b128 v[60:63], v10 offset:23552
  ds_read_b64_tr_b16 v[16:17], v3 offset:6144
  s_waitcnt lgkmcnt(3)
  v_smfmac_f32_16x16x64_bf16 v[40:43], v[20:23], v[48:55], v2
  ds_read_b64_tr_b16 v[18:19], v3 offset:6656
  v_smfmac_f32_16x16x64_bf16 v[28:31], v[20:23], a[112:119], v2
  ds_read_b128 v[48:51], v10 offset:24576
  s_and_b32 s36, s51, 1
  s_mul_i32 s36, s36, 307200
  v_smfmac_f32_16x16x64_bf16 v[32:35], v[20:23], a[184:191], v2
  ds_read_b128 v[52:55], v10 offset:25600
  s_waitcnt lgkmcnt(4)
  v_smfmac_f32_16x16x64_bf16 v[44:47], v[20:23], v[56:63], v2
  buffer_store_dword v0, v1, s[4:7], s41 offen offset:3072
  v_smfmac_f32_16x16x64_bf16 v[36:39], v[20:23], v[80:87], v2
  ds_read_b128 v[56:59], v10 offset:26624
  s_waitcnt lgkmcnt(3)
  v_smfmac_f32_16x16x64_bf16 v[24:27], v[16:19], a[48:55], v2
  ds_read_b128 v[60:63], v10 offset:27648
  ds_read_b64_tr_b16 v[20:21], v3 offset:7168
  s_waitcnt lgkmcnt(3)
  v_smfmac_f32_16x16x64_bf16 v[40:43], v[16:19], v[48:55], v2
  ds_read_b64_tr_b16 v[22:23], v3 offset:7680
  v_smfmac_f32_16x16x64_bf16 v[28:31], v[16:19], a[120:127], v2
  ds_read_b128 v[48:51], v10 offset:28672
  s_add_u32 s55, s53, s36
  s_add_u32 s56, s54, s36
  v_smfmac_f32_16x16x64_bf16 v[32:35], v[16:19], a[192:199], v2
  ds_read_b128 v[52:55], v10 offset:29696
  s_waitcnt lgkmcnt(4)
  v_smfmac_f32_16x16x64_bf16 v[44:47], v[16:19], v[56:63], v2
  buffer_store_dword v0, v14, s[4:7], s99 offen
  v_smfmac_f32_16x16x64_bf16 v[36:39], v[16:19], v[88:95], v2
  ds_read_b128 v[56:59], v10 offset:30720
  s_waitcnt lgkmcnt(3)
  v_smfmac_f32_16x16x64_bf16 v[24:27], v[20:23], a[56:63], v2
  ds_read_b128 v[60:63], v10 offset:31744
  ds_read_b64_tr_b16 v[16:17], v3 offset:8192
  s_waitcnt lgkmcnt(3)
  v_smfmac_f32_16x16x64_bf16 v[40:43], v[20:23], v[48:55], v2
  ds_read_b64_tr_b16 v[18:19], v3 offset:8704
  v_smfmac_f32_16x16x64_bf16 v[28:31], v[20:23], a[128:135], v2
  s_add_u32 s30, s37, s36
  v_smfmac_f32_16x16x64_bf16 v[32:35], v[20:23], a[200:207], v2
  s_waitcnt lgkmcnt(2)
  v_smfmac_f32_16x16x64_bf16 v[44:47], v[20:23], v[56:63], v2
  v_smfmac_f32_16x16x64_bf16 v[36:39], v[20:23], v[96:103], v2
  s_waitcnt lgkmcnt(0)
  v_smfmac_f32_16x16x64_bf16 v[24:27], v[16:19], a[64:71], v2
  s_waitcnt vmcnt(5)
  v_mov_b64 v[56:57], v[68:69]
  v_smfmac_f32_16x16x64_bf16 v[28:31], v[16:19], a[136:143], v2
  v_mov_b64 v[60:61], v[70:71]
  v_smfmac_f32_16x16x64_bf16 v[32:35], v[16:19], a[208:215], v2
  v_mov_b64 v[68:69], v[66:67]
  v_smfmac_f32_16x16x64_bf16 v[36:39], v[16:19], v[104:111], v2
  v_add_f32 v24, v24, v26
  v_smfmac_f32_16x16x64_bf16 v[40:43], v[16:19], v[112:119], v2
  v_add_f32 v25, v25, v27
  v_smfmac_f32_16x16x64_bf16 v[44:47], v[16:19], v[120:127], v2
  v_add_f32 v28, v28, v30
  v_add_f32 v29, v29, v31
  v_cvt_pk_bf16_f32 v24, v24, v25
  v_cvt_pk_bf16_f32 v25, v28, v29
  ds_write2_b32 v5, v24, v25 offset1:64
  ds_read_b64_tr_b16 v[28:29], v7 offset:0
  ds_read_b64_tr_b16 v[30:31], v7 offset:128
  v_pk_add_f32 v[32:33], v[32:33], v[34:35]
  v_pk_add_f32 v[36:37], v[36:37], v[38:39]
  v_cvt_pk_bf16_f32 v32, v32, v33
  v_cvt_pk_bf16_f32 v33, v36, v37
  ds_write2_b32 v5, v32, v33 offset0:128 offset1:192
  ds_read_b64_tr_b16 v[36:37], v7 offset:512
  ds_read_b64_tr_b16 v[38:39], v7 offset:640
  s_waitcnt lgkmcnt(3)
  v_mfma_f32_16x16x32_bf16 v[24:27], v[72:75], v[28:31], 0
  v_add_f32 v40, v40, v42
  v_add_f32 v41, v41, v43
  v_mfma_f32_16x16x32_bf16 v[16:19], v[76:79], v[28:31], 0
  v_add_f32 v44, v44, v46
  v_add_f32 v45, v45, v47
  s_waitcnt lgkmcnt(0)
  v_mfma_f32_16x16x32_bf16 v[20:23], v[36:39], v[28:31], 0
  v_cvt_pk_bf16_f32 v58, v40, v41
  v_cvt_pk_bf16_f32 v66, v44, v45
  v_lshrrev_b32 v47, 2, v1
  s_nop 0
  v_cndmask_b32 v24, v24, v16, s[94:95]
  v_cndmask_b32 v25, v25, v17, s[94:95]
  v_cndmask_b32 v26, v26, v18, s[94:95]
  v_cndmask_b32 v27, v27, v19, s[94:95]
  ds_write_b128 v8, v[24:27]
  v_cndmask_b32 v20, v20, v21, s[94:95]
  v_cndmask_b32 v22, v22, v23, s[94:95]
  v_cndmask_b32 v20, v20, v22, s[48:49]
  ds_write_b32 v9, v20 offset:1024
  s_mov_b64 exec, s[94:95]
  buffer_store_dwordx4 v[36:39], v6, s[4:7], s57 offen sc1
  s_mov_b64 exec, -1
  v_add_u32 v46, 158720, v1
  v_add_u32 v45, 159744, v47
  s_waitcnt lgkmcnt(0)
  s_barrier
  ds_read_b128 v[16:19], v46 offset:0
  ds_read_b32 v32, v45 offset:0
  ds_read_b128 v[20:23], v46 offset:1280
  ds_read_b32 v33, v45 offset:1280
  ds_read_b128 v[24:27], v46 offset:2560
  ds_read_b32 v34, v45 offset:2560
  ds_read_b128 v[28:31], v46 offset:3840
  ds_read_b32 v35, v45 offset:3840
  buffer_store_dword v58, v47, s[4:7], s58 offen offset:0 sc1
  buffer_store_dword v66, v47, s[4:7], s58 offen offset:256 sc1
  v_mov_b32 v59, 0
  v_mov_b64 v[62:63], v[58:59]
  v_mov_b32 v67, 0
  v_mov_b64 v[70:71], v[66:67]
  v_mov_b64 v[36:37], 0
  v_mov_b64 v[38:39], 0
  v_mov_b64 v[48:49], 0
  v_mov_b64 v[50:51], 0
  v_mov_b64 v[52:53], 0
  v_mov_b64 v[54:55], 0
  v_mov_b64 v[72:73], s[44:45]
  v_mov_b64 v[74:75], s[46:47]
  v_mov_b64 v[76:77], s[44:45]
  v_mov_b64 v[78:79], s[46:47]
  s_waitcnt lgkmcnt(4)
  v_pk_add_f32 v[16:17], v[16:17], v[20:21]
  v_pk_add_f32 v[18:19], v[18:19], v[22:23]
  s_waitcnt lgkmcnt(2)
  v_pk_add_f32 v[16:17], v[16:17], v[24:25]
  v_pk_add_f32 v[18:19], v[18:19], v[26:27]
  v_add_f32 v32, v32, v33
  v_add_f32 v32, v32, v34
  s_waitcnt lgkmcnt(0)
  v_pk_add_f32 v[16:17], v[16:17], v[28:29]
  v_pk_add_f32 v[18:19], v[18:19], v[30:31]
  v_add_f32 v20, v32, v35
  v_max3_f32 v22, |v20|, |v16|, |v17|
  v_max3_f32 v22, v22, |v18|, |v19|
  v_mul_f32 v28, s42, v20
  v_pk_mul_f32 v[30:31], v[16:17], s[42:43]
  v_pk_mul_f32 v[32:33], v[18:19], s[42:43]
  v_cmp_nle_f32 vcc, v22, s83
  v_exp_f32 v28, v28
  v_exp_f32 v30, v30
  v_exp_f32 v31, v31
  v_exp_f32 v32, v32
  v_exp_f32 v33, v33
  s_cbranch_vccnz L_recf0_max
L_recf0_maxok:
  v_cvt_pk_bf16_f32 v25, v28, v28
  v_cvt_pk_bf16_f32 v27, v28, v28
  v_cvt_pk_bf16_f32 v24, v30, v31
  v_cvt_pk_bf16_f32 v26, v32, v33
  v_mov_b64 v[28:29], 0
  v_mov_b64 v[30:31], 0
  v_smfmac_f32_16x16x64_bf16 v[36:39], v[24:27], v[72:79], v2 abid:1
  ds_read_b128 v[40:43], v10 offset:32768
  ds_read_b128 v[44:47], v10 offset:33792
  v_smfmac_f32_16x16x64_bf16 v[48:51], v[24:27], v[56:63], v2 abid:1
  ds_read_b128 v[72:75], v10 offset:34816
  ds_read_b128 v[76:79], v10 offset:35840
  v_smfmac_f32_16x16x64_bf16 v[52:55], v[24:27], v[64:71], v2 abid:1
  v_mov_b64 v[56:57], 0
  v_mov_b64 v[58:59], 0
  v_mov_b64 v[60:61], 0
  v_mov_b64 v[62:63], 0
  v_add_f32 v36, v36, v38
  v_add_f32 v37, v37, v39
  v_rcp_f32 v36, v36
  v_rcp_f32 v37, v37
  v_pk_add_f32 v[48:49], v[48:49], v[50:51]
  v_pk_add_f32 v[52:53], v[52:53], v[54:55]
  v_pk_mul_f32 v[48:49], v[48:49], v[36:37]
  v_pk_mul_f32 v[52:53], v[52:53], v[36:37]
  v_cvt_pk_bf16_f32 v16, v48, v49
  v_cvt_pk_bf16_f32 v17, v52, v53
  ds_write2_b32 v4, v16, v17 offset1:8
  v_mov_b64 v[64:65], 0
  v_mov_b64 v[66:67], 0
  v_mov_b64 v[68:69], 0
  v_mov_b64 v[70:71], 0
  v_mov_b64 v[24:25], 0
  v_mov_b64 v[26:27], 0
  v_mov_b64 v[48:49], 0
  v_mov_b64 v[50:51], 0
  v_mov_b64 v[52:53], 0
  v_mov_b64 v[54:55], 0
  v_mov_b64 v[32:33], 0
  v_mov_b64 v[34:35], 0
  s_waitcnt lgkmcnt(0)
  s_barrier
  ds_read_b64_tr_b16 v[16:17], v3 offset:9216
  ds_read_b64_tr_b16 v[18:19], v3 offset:9728
  ds_read_b64_tr_b16 v[20:21], v3 offset:10240
  ds_read_b64_tr_b16 v[22:23], v3 offset:10752
  v_lshrrev_b32 v36, 7, v1
  v_mul_u32_u24 v36, 1152, v36
  v_bfe_u32 v37, v1, 2, 5
  v_add_u32 v36, v36, v37
  s_waitcnt lgkmcnt(2)
  v_smfmac_f32_16x16x64_bf16 v[24:27], v[16:19], v[40:47], v2
  v_smfmac_f32_16x16x64_bf16 v[52:55], v[16:19], v[240:247], v2
  s_waitcnt lgkmcnt(0)
  v_smfmac_f32_16x16x64_bf16 v[24:27], v[20:23], v[72:79], v2
  v_smfmac_f32_16x16x64_bf16 v[52:55], v[20:23], v[248:255], v2
  v_smfmac_f32_16x16x64_bf16 v[28:31], v[16:19], v[128:135], v2
  v_add_f32 v24, v24, v26
  v_add_f32 v25, v25, v27
  v_smfmac_f32_16x16x64_bf16 v[28:31], v[20:23], v[136:143], v2
  v_cvt_pk_bf16_f32 v24, v24, v25
  v_smfmac_f32_16x16x64_bf16 v[32:35], v[16:19], v[144:151], v2
  s_add_u32 s50, s55, 0
  buffer_store_dword v24, v13, s[4:7], s50 offen
  v_add_f32 v52, v52, v54
  v_add_f32 v53, v53, v55
  v_smfmac_f32_16x16x64_bf16 v[32:35], v[20:23], v[152:159], v2
  v_cvt_pk_bf16_f32 v52, v52, v53
  v_smfmac_f32_16x16x64_bf16 v[56:59], v[16:19], v[160:167], v2
  buffer_store_dword v52, v36, s[4:7], s56 offen
  v_add_f32 v28, v28, v30
  v_add_f32 v29, v29, v31
  v_smfmac_f32_16x16x64_bf16 v[56:59], v[20:23], v[168:175], v2
  v_cvt_pk_bf16_f32 v28, v28, v29
  v_smfmac_f32_16x16x64_bf16 v[60:63], v[16:19], v[176:183], v2
  s_add_u32 s50, s55, 8448
  buffer_store_dword v28, v13, s[4:7], s50 offen
  v_add_f32 v32, v32, v34
  v_add_f32 v33, v33, v35
  v_smfmac_f32_16x16x64_bf16 v[60:63], v[20:23], v[184:191], v2
  v_cvt_pk_bf16_f32 v32, v32, v33
  v_smfmac_f32_16x16x64_bf16 v[64:67], v[16:19], v[192:199], v2
  s_add_u32 s50, s55, 16896
  buffer_store_dword v32, v13, s[4:7], s50 offen
  v_add_f32 v56, v56, v58
  v_add_f32 v57, v57, v59
  v_smfmac_f32_16x16x64_bf16 v[64:67], v[20:23], v[200:207], v2
  v_cvt_pk_bf16_f32 v56, v56, v57
  v_smfmac_f32_16x16x64_bf16 v[68:71], v[16:19], v[208:215], v2
  s_add_u32 s50, s55, 25344
  buffer_store_dword v56, v13, s[4:7], s50 offen
  v_add_f32 v60, v60, v62
  v_add_f32 v61, v61, v63
  v_smfmac_f32_16x16x64_bf16 v[68:71], v[20:23], v[216:223], v2
  v_cvt_pk_bf16_f32 v60, v60, v61
  v_smfmac_f32_16x16x64_bf16 v[48:51], v[16:19], v[224:231], v2
  s_add_u32 s50, s55, 33792
  buffer_store_dword v60, v13, s[4:7], s50 offen
  v_add_f32 v64, v64, v66
  v_add_f32 v65, v65, v67
  v_smfmac_f32_16x16x64_bf16 v[48:51], v[20:23], v[232:239], v2
  v_cvt_pk_bf16_f32 v64, v64, v65
  s_add_u32 s50, s55, 42240
  buffer_store_dword v64, v13, s[4:7], s50 offen
  v_add_f32 v68, v68, v70
  v_add_f32 v69, v69, v71
  v_cvt_pk_bf16_f32 v68, v68, v69
  s_add_u32 s50, s55, 50688
  buffer_store_dword v68, v13, s[4:7], s50 offen
  v_add_f32 v48, v48, v50
  v_add_f32 v49, v49, v51
  v_cvt_pk_bf16_f32 v48, v48, v49
  s_add_u32 s50, s55, 59136
  buffer_store_dword v48, v13, s[4:7], s50 offen
  s_cmp_eq_u32 s51, 63
  s_cbranch_scc1 L_recf0_done
  v_cndmask_b32 v16, 0, v15, s[86:87]
  v_cndmask_b32 v17, 0, v15, s[88:89]
  v_cndmask_b32 v18, 0, v15, s[90:91]
  v_cndmask_b32 v19, 0, v15, s[92:93]
  s_and_b32 s33, s35, 3
  s_lshl_b32 s33, s33, 14
  s_add_u32 s33, s33, s32
  s_mov_b32 s41, s30
  s_barrier
L_recf0_rpoll:
  buffer_load_dwordx4 v[48:51], v1, s[4:7], s41 offen offset:0 sc1
  buffer_load_dwordx4 v[52:55], v1, s[4:7], s41 offen offset:1024 sc1
  buffer_load_dwordx4 v[56:59], v1, s[4:7], s41 offen offset:2048 sc1
  buffer_load_dwordx4 v[60:63], v1, s[4:7], s41 offen offset:3072 sc1
L_recf0_rsum:
  v_mov_b64 v[24:25], 0
  v_mov_b64 v[26:27], 0
  v_mov_b64 v[28:29], 0
  v_mov_b64 v[30:31], 0
  v_mov_b64 v[32:33], 0
  v_mov_b64 v[34:35], 0
  v_mov_b64 v[36:37], 0
  v_mov_b64 v[38:39], 0
  v_mov_b64 v[40:41], 0
  v_mov_b64 v[42:43], 0
  v_mov_b64 v[44:45], 0
  v_mov_b64 v[46:47], 0
  s_waitcnt vmcnt(3)
  v_mfma_f32_16x16x32_bf16 v[20:23], v[16:19], v[48:51], 0
  s_waitcnt vmcnt(2)
  v_mfma_f32_16x16x32_bf16 v[20:23], v[16:19], v[52:55], v[20:23]
  s_waitcnt vmcnt(1)
  v_mfma_f32_16x16x32_bf16 v[20:23], v[16:19], v[56:59], v[20:23]
  s_waitcnt vmcnt(0)
  v_mfma_f32_16x16x32_bf16 v[20:23], v[16:19], v[60:63], v[20:23]
  s_nop 7
  v_cmp_u_f32 vcc, v20, v20
  v_add_f32_dpp v22, v20, v20 row_ror:8 row_mask:0xf bank_mask:0xf
  v_add_f32_dpp v23, v21, v21 row_ror:8 row_mask:0xf bank_mask:0xf
  v_cvt_pk_bf16_f32 v22, v22, v23
  s_cbranch_vccnz L_recf0_rB
L_recf0_rgo:
  buffer_store_dword v22, v14, s[4:7], s33 offen
  s_and_b32 s99, s51, 3
  s_lshl_b32 s99, s99, 14
  s_add_u32 s99, s99, s32
  s_add_u32 s33, s33, s63
  s_mov_b32 m0, s59
  ds_read_b128 v[48:51], v10 offset:0
  ds_read_b128 v[52:55], v10 offset:1024
  ds_read_b128 v[56:59], v10 offset:2048
  ds_read_b128 v[60:63], v10 offset:3072
  s_add_u32 s51, s51, 1
  s_add_u32 s39, s39, 1
  s_add_u32 s34, s34, 24576
  s_add_u32 s57, s57, 4096
  v_add_u32 v0, s59, v1
  s_branch L_recf0_g5
L_recf0_gr:
  buffer_load_dwordx4 v1, s[4:7], s33 offen offset:0 sc1 lds
  buffer_load_dwordx4 v1, s[4:7], s33 offen offset:1024 sc1 lds
  s_add_u32 s60, s60, 1
  s_cmp_gt_u32 s60, 262144
  s_cbranch_scc1 L_fail_rec
  s_branch L_recf0_g
L_recf0_rB:
  v_max3_u32 v20, v48, v49, v50
  v_max3_u32 v20, v20, v51, v52
  v_max3_u32 v20, v20, v53, v54
  v_max3_u32 v20, v20, v55, v56
  v_max3_u32 v20, v20, v57, v58
  v_max3_u32 v20, v20, v59, v60
  v_max3_u32 v20, v20, v61, v62
  v_max_u32 v20, v20, v63
  v_min_u32 v22, -2, v22
  v_cmp_eq_u32 vcc, -1, v20
  s_cbranch_vccz L_recf0_rgo
  s_add_u32 s60, s60, 1
  s_cmp_gt_u32 s60, 262144
  s_cbranch_scc1 L_fail_rec
  s_branch L_recf0_rpoll
L_recf0_max:
  v_max3_f32 v22, v20, v16, v17
  v_max3_f32 v22, v22, v18, v19
  s_nop 1
  v_max_f32_dpp v22, v22, v22 quad_perm:[2,3,0,1] row_mask:0xf bank_mask:0xf
  v_mov_b32 v23, v22
  s_nop 1
  v_permlane16_swap_b32 v22, v23
  v_max_f32 v22, v22, v23
  v_mov_b32 v23, v22
  s_nop 1
  v_permlane32_swap_b32 v22, v23
  v_max_f32 v22, v22, v23
  v_sub_f32 v28, v20, v22
  v_sub_f32 v30, v16, v22
  v_sub_f32 v31, v17, v22
  v_sub_f32 v32, v18, v22
  v_sub_f32 v33, v19, v22
  v_mul_f32 v28, s42, v28
  v_mul_f32 v30, s42, v30
  v_mul_f32 v31, s42, v31
  v_mul_f32 v32, s42, v32
  v_mul_f32 v33, s42, v33
  v_exp_f32 v28, v28
  v_exp_f32 v30, v30
  v_exp_f32 v31, v31
  v_exp_f32 v32, v32
  v_exp_f32 v33, v33
  s_nop 0
  s_branch L_recf0_maxok
L_recf0_done:
  s_waitcnt vmcnt(0)
  s_barrier
  s_endpgm
L_recf2_redo:
  s_waitcnt lgkmcnt(0)
  v_mov_b64 v[24:25], 0
  v_mov_b64 v[26:27], 0
  v_mov_b64 v[28:29], 0
  v_mov_b64 v[30:31], 0
  v_mov_b64 v[32:33], 0
  v_mov_b64 v[34:35], 0
  v_mov_b64 v[36:37], 0
  v_mov_b64 v[38:39], 0
  v_mov_b64 v[40:41], 0
  v_mov_b64 v[42:43], 0
  v_mov_b64 v[44:45], 0
  v_mov_b64 v[46:47], 0
  ds_read_b128 v[48:51], v10 offset:0
  ds_read_b128 v[52:55], v10 offset:1024
  ds_read_b128 v[56:59], v10 offset:2048
  ds_read_b128 v[60:63], v10 offset:3072
  s_waitcnt lgkmcnt(0)
  s_branch L_recf2_step
L_recf2_g5:
  s_barrier
  buffer_load_dwordx4 v1, s[4:7], s33 offen offset:0 sc1 lds
  buffer_load_dwordx4 v1, s[4:7], s33 offen offset:1024 sc1 lds
L_recf2_g:
  s_waitcnt vmcnt(0)
  ds_read_b128 v[16:19], v0
  ds_read_b128 v[20:23], v0 offset:1024
  s_waitcnt lgkmcnt(1)
  v_max3_u32 v16, v16, v17, v18
  s_waitcnt lgkmcnt(0)
  v_max3_u32 v20, v20, v21, v22
  v_max3_u32 v16, v16, v19, v23
  v_max_u32 v16, v16, v20
  v_cmp_eq_u32 vcc, -1, v16
  s_cbranch_vccnz L_recf2_gr
L_recf2_step:
  s_barrier
  ds_read_b64_tr_b16 v[16:17], v3 offset:0
  ds_read_b64_tr_b16 v[18:19], v3 offset:512
  buffer_load_dwordx4 v[72:75], v11, s[4:7], s34 offen sc1
  buffer_load_dwordx4 v[76:79], v11, s[4:7], s34 offen offset:32 sc1
  s_waitcnt lgkmcnt(0)
  v_smfmac_f32_16x16x64_bf16 v[24:27], v[16:19], a[0:7], v2
  ds_read_b64_tr_b16 v[20:21], v3 offset:1024
  v_smfmac_f32_16x16x64_bf16 v[40:43], v[16:19], v[48:55], v2
  ds_read_b64_tr_b16 v[22:23], v3 offset:1536
  v_smfmac_f32_16x16x64_bf16 v[28:31], v[16:19], a[72:79], v2
  ds_read_b128 v[48:51], v10 offset:4096
  buffer_load_dwordx4 v[68:71], v12, s[4:7], s34 offen sc1
  v_smfmac_f32_16x16x64_bf16 v[32:35], v[16:19], a[144:151], v2
  ds_read_b128 v[52:55], v10 offset:5120
  v_smfmac_f32_16x16x64_bf16 v[44:47], v[16:19], v[56:63], v2
  buffer_load_dwordx4 v[64:67], v12, s[4:7], s34 offen offset:256 sc1
  v_smfmac_f32_16x16x64_bf16 v[36:39], v[16:19], a[216:223], v2
  ds_read_b128 v[56:59], v10 offset:6144
  s_waitcnt lgkmcnt(3)
  v_smfmac_f32_16x16x64_bf16 v[24:27], v[20:23], a[8:15], v2
  ds_read_b128 v[60:63], v10 offset:7168
  ds_read_b64_tr_b16 v[16:17], v3 offset:2048
  s_waitcnt lgkmcnt(3)
  v_smfmac_f32_16x16x64_bf16 v[40:43], v[20:23], v[48:55], v2
  ds_read_b64_tr_b16 v[18:19], v3 offset:2560
  v_smfmac_f32_16x16x64_bf16 v[28:31], v[20:23], a[80:87], v2
  ds_read_b128 v[48:51], v10 offset:8192
  v_mov_b32 v0, s51
  v_smfmac_f32_16x16x64_bf16 v[32:35], v[20:23], a[152:159], v2
  ds_read_b128 v[52:55], v10 offset:9216
  s_waitcnt lgkmcnt(4)
  v_smfmac_f32_16x16x64_bf16 v[44:47], v[20:23], v[56:63], v2
  s_mov_b64 exec, 1
  buffer_store_dword v0, v1, s[4:7], s101 offen sc1
  s_mov_b64 exec, -1
  v_smfmac_f32_16x16x64_bf16 v[36:39], v[20:23], a[224:231], v2
  ds_read_b128 v[56:59], v10 offset:10240
  s_waitcnt lgkmcnt(3)
  v_smfmac_f32_16x16x64_bf16 v[24:27], v[16:19], a[16:23], v2
  ds_read_b128 v[60:63], v10 offset:11264
  ds_read_b64_tr_b16 v[20:21], v3 offset:3072
  s_waitcnt lgkmcnt(3)
  v_smfmac_f32_16x16x64_bf16 v[40:43], v[16:19], v[48:55], v2
  ds_read_b64_tr_b16 v[22:23], v3 offset:3584
  v_smfmac_f32_16x16x64_bf16 v[28:31], v[16:19], a[88:95], v2
  ds_read_b128 v[48:51], v10 offset:12288
  v_smfmac_f32_16x16x64_bf16 v[32:35], v[16:19], a[160:167], v2
  ds_read_b128 v[52:55], v10 offset:13312
  s_waitcnt lgkmcnt(4)
  v_smfmac_f32_16x16x64_bf16 v[44:47], v[16:19], v[56:63], v2
  v_smfmac_f32_16x16x64_bf16 v[36:39], v[16:19], a[232:239], v2
  ds_read_b128 v[56:59], v10 offset:14336
  s_waitcnt lgkmcnt(3)
  v_smfmac_f32_16x16x64_bf16 v[24:27], v[20:23], a[24:31], v2
  ds_read_b128 v[60:63], v10 offset:15360
  ds_read_b64_tr_b16 v[16:17], v3 offset:4096
  s_waitcnt lgkmcnt(3)
  v_smfmac_f32_16x16x64_bf16 v[40:43], v[20:23], v[48:55], v2
  ds_read_b64_tr_b16 v[18:19], v3 offset:4608
  v_smfmac_f32_16x16x64_bf16 v[28:31], v[20:23], a[96:103], v2
  ds_read_b128 v[48:51], v10 offset:16384
  v_mov_b32 v0, -1
  v_smfmac_f32_16x16x64_bf16 v[32:35], v[20:23], a[168:175], v2
  ds_read_b128 v[52:55], v10 offset:17408
  s_waitcnt lgkmcnt(4)
  v_smfmac_f32_16x16x64_bf16 v[44:47], v[20:23], v[56:63], v2
  buffer_store_dword v0, v1, s[4:7], s41 offen
  v_smfmac_f32_16x16x64_bf16 v[36:39], v[20:23], a[240:247], v2
  ds_read_b128 v[56:59], v10 offset:18432
  s_waitcnt lgkmcnt(3)
  v_smfmac_f32_16x16x64_bf16 v[24:27], v[16:19], a[32:39], v2
  ds_read_b128 v[60:63], v10 offset:19456
  ds_read_b64_tr_b16 v[20:21], v3 offset:5120
  s_waitcnt lgkmcnt(3)
  v_smfmac_f32_16x16x64_bf16 v[40:43], v[16:19], v[48:55], v2
  ds_read_b64_tr_b16 v[22:23], v3 offset:5632
  v_smfmac_f32_16x16x64_bf16 v[28:31], v[16:19], a[104:111], v2
  ds_read_b128 v[48:51], v10 offset:20480
  s_add_u32 s58, s57, s52
  s_add_u32 s35, s51, 1
  v_smfmac_f32_16x16x64_bf16 v[32:35], v[16:19], a[176:183], v2
  ds_read_b128 v[52:55], v10 offset:21504
  s_waitcnt lgkmcnt(4)
  v_smfmac_f32_16x16x64_bf16 v[44:47], v[16:19], v[56:63], v2
  buffer_store_dword v0, v14, s[4:7], s99 offen
  v_smfmac_f32_16x16x64_bf16 v[36:39], v[16:19], a[248:255], v2
  ds_read_b128 v[56:59], v10 offset:22528
  s_waitcnt lgkmcnt(3)
  v_smfmac_f32_16x16x64_bf16 v[24:27], v[20:23], a[40:47], v2
  ds_read_b128 v[60:63], v10 offset:23552
  ds_read_b64_tr_b16 v[16:17], v3 offset:6144
  s_waitcnt lgkmcnt(3)
  v_smfmac_f32_16x16x64_bf16 v[40:43], v[20:23], v[48:55], v2
  ds_read_b64_tr_b16 v[18:19], v3 offset:6656
  v_smfmac_f32_16x16x64_bf16 v[28:31], v[20:23], a[112:119], v2
  ds_read_b128 v[48:51], v10 offset:24576
  s_and_b32 s36, s51, 1
  s_mul_i32 s36, s36, 307200
  v_smfmac_f32_16x16x64_bf16 v[32:35], v[20:23], a[184:191], v2
  ds_read_b128 v[52:55], v10 offset:25600
  s_waitcnt lgkmcnt(4)
  v_smfmac_f32_16x16x64_bf16 v[44:47], v[20:23], v[56:63], v2
  v_smfmac_f32_16x16x64_bf16 v[36:39], v[20:23], v[80:87], v2
  ds_read_b128 v[56:59], v10 offset:26624
  s_waitcnt lgkmcnt(3)
  v_smfmac_f32_16x16x64_bf16 v[24:27], v[16:19], a[48:55], v2
  ds_read_b128 v[60:63], v10 offset:27648
  ds_read_b64_tr_b16 v[20:21], v3 offset:7168
  s_waitcnt lgkmcnt(3)
  v_smfmac_f32_16x16x64_bf16 v[40:43], v[16:19], v[48:55], v2
  ds_read_b64_tr_b16 v[22:23], v3 offset:7680
  v_smfmac_f32_16x16x64_bf16 v[28:31], v[16:19], a[120:127], v2
  ds_read_b128 v[48:51], v10 offset:28672
  s_add_u32 s55, s53, s36
  s_add_u32 s56, s54, s36
  v_smfmac_f32_16x16x64_bf16 v[32:35], v[16:19], a[192:199], v2
  ds_read_b128 v[52:55], v10 offset:29696
  s_waitcnt lgkmcnt(4)
  v_smfmac_f32_16x16x64_bf16 v[44:47], v[16:19], v[56:63], v2
  v_smfmac_f32_16x16x64_bf16 v[36:39], v[16:19], v[88:95], v2
  ds_read_b128 v[56:59], v10 offset:30720
  s_waitcnt lgkmcnt(3)
  v_smfmac_f32_16x16x64_bf16 v[24:27], v[20:23], a[56:63], v2
  ds_read_b128 v[60:63], v10 offset:31744
  ds_read_b64_tr_b16 v[16:17], v3 offset:8192
  s_waitcnt lgkmcnt(3)
  v_smfmac_f32_16x16x64_bf16 v[40:43], v[20:23], v[48:55], v2
  ds_read_b64_tr_b16 v[18:19], v3 offset:8704
  v_smfmac_f32_16x16x64_bf16 v[28:31], v[20:23], a[128:135], v2
  s_add_u32 s30, s37, s36
  v_smfmac_f32_16x16x64_bf16 v[32:35], v[20:23], a[200:207], v2
  s_waitcnt lgkmcnt(2)
  v_smfmac_f32_16x16x64_bf16 v[44:47], v[20:23], v[56:63], v2
  v_smfmac_f32_16x16x64_bf16 v[36:39], v[20:23], v[96:103], v2
  s_waitcnt lgkmcnt(0)
  v_smfmac_f32_16x16x64_bf16 v[24:27], v[16:19], a[64:71], v2
  s_waitcnt vmcnt(3)
  v_mov_b64 v[56:57], v[68:69]
  v_smfmac_f32_16x16x64_bf16 v[28:31], v[16:19], a[136:143], v2
  v_mov_b64 v[60:61], v[70:71]
  v_smfmac_f32_16x16x64_bf16 v[32:35], v[16:19], a[208:215], v2
  v_mov_b64 v[68:69], v[66:67]
  v_smfmac_f32_16x16x64_bf16 v[36:39], v[16:19], v[104:111], v2
  v_add_f32 v24, v24, v26
  v_smfmac_f32_16x16x64_bf16 v[40:43], v[16:19], v[112:119], v2
  v_add_f32 v25, v25, v27
  v_smfmac_f32_16x16x64_bf16 v[44:47], v[16:19], v[120:127], v2
  v_add_f32 v28, v28, v30
  v_add_f32 v29, v29, v31
  v_cvt_pk_bf16_f32 v24, v24, v25
  v_cvt_pk_bf16_f32 v25, v28, v29
  ds_write2_b32 v5, v24, v25 offset1:64
  ds_read_b64_tr_b16 v[28:29], v7 offset:0
  ds_read_b64_tr_b16 v[30:31], v7 offset:128
  v_pk_add_f32 v[32:33], v[32:33], v[34:35]
  v_pk_add_f32 v[36:37], v[36:37], v[38:39]
  v_cvt_pk_bf16_f32 v32, v32, v33
  v_cvt_pk_bf16_f32 v33, v36, v37
  ds_write2_b32 v5, v32, v33 offset0:128 offset1:192
  ds_read_b64_tr_b16 v[36:37], v7 offset:512
  ds_read_b64_tr_b16 v[38:39], v7 offset:640
  s_waitcnt lgkmcnt(3)
  v_mfma_f32_16x16x32_bf16 v[24:27], v[72:75], v[28:31], 0
  v_add_f32 v40, v40, v42
  v_add_f32 v41, v41, v43
  v_mfma_f32_16x16x32_bf16 v[16:19], v[76:79], v[28:31], 0
  v_add_f32 v44, v44, v46
  v_add_f32 v45, v45, v47
  s_waitcnt lgkmcnt(0)
  v_mfma_f32_16x16x32_bf16 v[20:23], v[36:39], v[28:31], 0
  v_cvt_pk_bf16_f32 v58, v40, v41
  v_cvt_pk_bf16_f32 v66, v44, v45
  v_lshrrev_b32 v47, 2, v1
  s_nop 0
  v_cndmask_b32 v24, v24, v16, s[94:95]
  v_cndmask_b32 v25, v25, v17, s[94:95]
  v_cndmask_b32 v26, v26, v18, s[94:95]
  v_cndmask_b32 v27, v27, v19, s[94:95]
  ds_write_b128 v8, v[24:27]
  v_cndmask_b32 v20, v20, v21, s[94:95]
  v_cndmask_b32 v22, v22, v23, s[94:95]
  v_cndmask_b32 v20, v20, v22, s[48:49]
  ds_write_b32 v9, v20 offset:1024
  s_mov_b64 exec, s[94:95]
  buffer_store_dwordx4 v[36:39], v6, s[4:7], s57 offen sc1
  s_mov_b64 exec, -1
  v_add_u32 v46, 158720, v1
  v_add_u32 v45, 159744, v47
  s_waitcnt lgkmcnt(0)
  s_barrier
  ds_read_b128 v[16:19], v46 offset:0
  ds_read_b32 v32, v45 offset:0
  ds_read_b128 v[20:23], v46 offset:1280
  ds_read_b32 v33, v45 offset:1280
  ds_read_b128 v[24:27], v46 offset:2560
  ds_read_b32 v34, v45 offset:2560
  ds_read_b128 v[28:31], v46 offset:3840
  ds_read_b32 v35, v45 offset:3840
  buffer_store_dword v58, v47, s[4:7], s58 offen offset:0 sc1
  buffer_store_dword v66, v47, s[4:7], s58 offen offset:256 sc1
  v_mov_b32 v59, 0
  v_mov_b64 v[62:63], v[58:59]
  v_mov_b32 v67, 0
  v_mov_b64 v[70:71], v[66:67]
  v_mov_b64 v[36:37], 0
  v_mov_b64 v[38:39], 0
  v_mov_b64 v[48:49], 0
  v_mov_b64 v[50:51], 0
  v_mov_b64 v[52:53], 0
  v_mov_b64 v[54:55], 0
  v_mov_b64 v[72:73], s[44:45]
  v_mov_b64 v[74:75], s[46:47]
  v_mov_b64 v[76:77], s[44:45]
  v_mov_b64 v[78:79], s[46:47]
  s_waitcnt lgkmcnt(4)
  v_pk_add_f32 v[16:17], v[16:17], v[20:21]
  v_pk_add_f32 v[18:19], v[18:19], v[22:23]
  s_waitcnt lgkmcnt(2)
  v_pk_add_f32 v[16:17], v[16:17], v[24:25]
  v_pk_add_f32 v[18:19], v[18:19], v[26:27]
  v_add_f32 v32, v32, v33
  v_add_f32 v32, v32, v34
  s_waitcnt lgkmcnt(0)
  v_pk_add_f32 v[16:17], v[16:17], v[28:29]
  v_pk_add_f32 v[18:19], v[18:19], v[30:31]
  v_add_f32 v20, v32, v35
  v_max3_f32 v22, |v20|, |v16|, |v17|
  v_max3_f32 v22, v22, |v18|, |v19|
  v_mul_f32 v28, s42, v20
  v_pk_mul_f32 v[30:31], v[16:17], s[42:43]
  v_pk_mul_f32 v[32:33], v[18:19], s[42:43]
  v_cmp_nle_f32 vcc, v22, s83
  v_exp_f32 v28, v28
  v_exp_f32 v30, v30
  v_exp_f32 v31, v31
  v_exp_f32 v32, v32
  v_exp_f32 v33, v33
  s_cbranch_vccnz L_recf2_max
L_recf2_maxok:
  v_cvt_pk_bf16_f32 v25, v28, v28
  v_cvt_pk_bf16_f32 v27, v28, v28
  v_cvt_pk_bf16_f32 v24, v30, v31
  v_cvt_pk_bf16_f32 v26, v32, v33
  v_mov_b64 v[28:29], 0
  v_mov_b64 v[30:31], 0
  v_smfmac_f32_16x16x64_bf16 v[36:39], v[24:27], v[72:79], v2 abid:1
  ds_read_b128 v[40:43], v10 offset:32768
  ds_read_b128 v[44:47], v10 offset:33792
  v_smfmac_f32_16x16x64_bf16 v[48:51], v[24:27], v[56:63], v2 abid:1
  ds_read_b128 v[72:75], v10 offset:34816
  ds_read_b128 v[76:79], v10 offset:35840
  v_smfmac_f32_16x16x64_bf16 v[52:55], v[24:27], v[64:71], v2 abid:1
  v_mov_b64 v[56:57], 0
  v_mov_b64 v[58:59], 0
  v_mov_b64 v[60:61], 0
  v_mov_b64 v[62:63], 0
  v_add_f32 v36, v36, v38
  v_add_f32 v37, v37, v39
  v_rcp_f32 v36, v36
  v_rcp_f32 v37, v37
  v_pk_add_f32 v[48:49], v[48:49], v[50:51]
  v_pk_add_f32 v[52:53], v[52:53], v[54:55]
  v_pk_mul_f32 v[48:49], v[48:49], v[36:37]
  v_pk_mul_f32 v[52:53], v[52:53], v[36:37]
  v_cvt_pk_bf16_f32 v16, v48, v49
  v_cvt_pk_bf16_f32 v17, v52, v53
  ds_write2_b32 v4, v16, v17 offset1:8
  v_mov_b64 v[64:65], 0
  v_mov_b64 v[66:67], 0
  v_mov_b64 v[68:69], 0
  v_mov_b64 v[70:71], 0
  v_mov_b64 v[24:25], 0
  v_mov_b64 v[26:27], 0
  v_mov_b64 v[48:49], 0
  v_mov_b64 v[50:51], 0
  v_mov_b64 v[52:53], 0
  v_mov_b64 v[54:55], 0
  v_mov_b64 v[32:33], 0
  v_mov_b64 v[34:35], 0
  s_waitcnt lgkmcnt(0)
  s_barrier
  ds_read_b64_tr_b16 v[16:17], v3 offset:9216
  ds_read_b64_tr_b16 v[18:19], v3 offset:9728
  ds_read_b64_tr_b16 v[20:21], v3 offset:10240
  ds_read_b64_tr_b16 v[22:23], v3 offset:10752
  v_lshrrev_b32 v36, 7, v1
  v_mul_u32_u24 v36, 1152, v36
  v_bfe_u32 v37, v1, 2, 5
  v_add_u32 v36, v36, v37
  s_waitcnt lgkmcnt(2)
  v_smfmac_f32_16x16x64_bf16 v[24:27], v[16:19], v[40:47], v2
  v_smfmac_f32_16x16x64_bf16 v[52:55], v[16:19], v[240:247], v2
  s_waitcnt lgkmcnt(0)
  v_smfmac_f32_16x16x64_bf16 v[24:27], v[20:23], v[72:79], v2
  v_smfmac_f32_16x16x64_bf16 v[52:55], v[20:23], v[248:255], v2
  v_smfmac_f32_16x16x64_bf16 v[28:31], v[16:19], v[128:135], v2
  v_add_f32 v24, v24, v26
  v_add_f32 v25, v25, v27
  v_smfmac_f32_16x16x64_bf16 v[28:31], v[20:23], v[136:143], v2
  v_cvt_pk_bf16_f32 v24, v24, v25
  v_smfmac_f32_16x16x64_bf16 v[32:35], v[16:19], v[144:151], v2
  s_add_u32 s50, s55, 0
  buffer_store_dword v24, v13, s[4:7], s50 offen
  v_add_f32 v52, v52, v54
  v_add_f32 v53, v53, v55
  v_smfmac_f32_16x16x64_bf16 v[32:35], v[20:23], v[152:159], v2
  v_cvt_pk_bf16_f32 v52, v52, v53
  v_smfmac_f32_16x16x64_bf16 v[56:59], v[16:19], v[160:167], v2
  buffer_store_dword v52, v36, s[4:7], s56 offen
  v_add_f32 v28, v28, v30
  v_add_f32 v29, v29, v31
  v_smfmac_f32_16x16x64_bf16 v[56:59], v[20:23], v[168:175], v2
  v_cvt_pk_bf16_f32 v28, v28, v29
  v_smfmac_f32_16x16x64_bf16 v[60:63], v[16:19], v[176:183], v2
  s_add_u32 s50, s55, 8448
  buffer_store_dword v28, v13, s[4:7], s50 offen
  v_add_f32 v32, v32, v34
  v_add_f32 v33, v33, v35
  v_smfmac_f32_16x16x64_bf16 v[60:63], v[20:23], v[184:191], v2
  v_cvt_pk_bf16_f32 v32, v32, v33
  v_smfmac_f32_16x16x64_bf16 v[64:67], v[16:19], v[192:199], v2
  s_add_u32 s50, s55, 16896
  buffer_store_dword v32, v13, s[4:7], s50 offen
  v_add_f32 v56, v56, v58
  v_add_f32 v57, v57, v59
  v_smfmac_f32_16x16x64_bf16 v[64:67], v[20:23], v[200:207], v2
  v_cvt_pk_bf16_f32 v56, v56, v57
  v_smfmac_f32_16x16x64_bf16 v[68:71], v[16:19], v[208:215], v2
  s_add_u32 s50, s55, 25344
  buffer_store_dword v56, v13, s[4:7], s50 offen
  v_add_f32 v60, v60, v62
  v_add_f32 v61, v61, v63
  v_smfmac_f32_16x16x64_bf16 v[68:71], v[20:23], v[216:223], v2
  v_cvt_pk_bf16_f32 v60, v60, v61
  v_smfmac_f32_16x16x64_bf16 v[48:51], v[16:19], v[224:231], v2
  s_add_u32 s50, s55, 33792
  buffer_store_dword v60, v13, s[4:7], s50 offen
  v_add_f32 v64, v64, v66
  v_add_f32 v65, v65, v67
  v_smfmac_f32_16x16x64_bf16 v[48:51], v[20:23], v[232:239], v2
  v_cvt_pk_bf16_f32 v64, v64, v65
  s_add_u32 s50, s55, 42240
  buffer_store_dword v64, v13, s[4:7], s50 offen
  v_add_f32 v68, v68, v70
  v_add_f32 v69, v69, v71
  v_cvt_pk_bf16_f32 v68, v68, v69
  s_add_u32 s50, s55, 50688
  buffer_store_dword v68, v13, s[4:7], s50 offen
  v_add_f32 v48, v48, v50
  v_add_f32 v49, v49, v51
  v_cvt_pk_bf16_f32 v48, v48, v49
  s_add_u32 s50, s55, 59136
  buffer_store_dword v48, v13, s[4:7], s50 offen
  s_cmp_eq_u32 s51, 63
  s_cbranch_scc1 L_recf2_done
  v_cndmask_b32 v16, 0, v15, s[86:87]
  v_cndmask_b32 v17, 0, v15, s[88:89]
  v_cndmask_b32 v18, 0, v15, s[90:91]
  v_cndmask_b32 v19, 0, v15, s[92:93]
  s_and_b32 s33, s35, 3
  s_lshl_b32 s33, s33, 14
  s_add_u32 s33, s33, s32
  s_mov_b32 s41, s30
  s_barrier
L_recf2_rpoll:
  buffer_load_dwordx4 v[48:51], v1, s[4:7], s41 offen offset:0 sc1
L_recf2_rsum:
  v_mov_b64 v[24:25], 0
  v_mov_b64 v[26:27], 0
  v_mov_b64 v[28:29], 0
  v_mov_b64 v[30:31], 0
  v_mov_b64 v[32:33], 0
  v_mov_b64 v[34:35], 0
  v_mov_b64 v[36:37], 0
  v_mov_b64 v[38:39], 0
  v_mov_b64 v[40:41], 0
  v_mov_b64 v[42:43], 0
  v_mov_b64 v[44:45], 0
  v_mov_b64 v[46:47], 0
  s_waitcnt vmcnt(0)
  v_mfma_f32_16x16x32_bf16 v[20:23], v[16:19], v[48:51], 0
  s_nop 7
  v_cmp_u_f32 vcc, v20, v20
  v_add_f32_dpp v22, v20, v20 row_ror:8 row_mask:0xf bank_mask:0xf
  v_add_f32_dpp v23, v21, v21 row_ror:8 row_mask:0xf bank_mask:0xf
  s_nop 0
  v_add_f32_dpp v22, v22, v22 row_ror:4 row_mask:0xf bank_mask:0xf
  v_add_f32_dpp v23, v23, v23 row_ror:4 row_mask:0xf bank_mask:0xf
  s_nop 0
  v_add_f32_dpp v22, v22, v22 row_ror:2 row_mask:0xf bank_mask:0xf
  v_add_f32_dpp v23, v23, v23 row_ror:2 row_mask:0xf bank_mask:0xf
  v_cvt_pk_bf16_f32 v22, v22, v23
  s_cbranch_vccnz L_recf2_rB
L_recf2_rgo:
  buffer_store_dword v22, v14, s[4:7], s33 offen
  s_and_b32 s99, s51, 3
  s_lshl_b32 s99, s99, 14
  s_add_u32 s99, s99, s32
  s_add_u32 s33, s33, s63
  s_mov_b32 m0, s59
  ds_read_b128 v[48:51], v10 offset:0
  ds_read_b128 v[52:55], v10 offset:1024
  ds_read_b128 v[56:59], v10 offset:2048
  ds_read_b128 v[60:63], v10 offset:3072
  s_add_u32 s51, s51, 1
  s_add_u32 s39, s39, 1
  s_add_u32 s34, s34, 24576
  s_add_u32 s57, s57, 4096
  v_add_u32 v0, s59, v1
  s_branch L_recf2_g5
L_recf2_gr:
  buffer_load_dwordx4 v1, s[4:7], s33 offen offset:0 sc1 lds
  buffer_load_dwordx4 v1, s[4:7], s33 offen offset:1024 sc1 lds
  s_add_u32 s60, s60, 1
  s_cmp_gt_u32 s60, 262144
  s_cbranch_scc1 L_fail_rec
  s_branch L_recf2_g
L_recf2_rB:
  v_max3_u32 v20, v48, v49, v50
  v_max_u32 v20, v20, v51
  v_min_u32 v22, -2, v22
  v_cmp_eq_u32 vcc, -1, v20
  s_cbranch_vccz L_recf2_rgo
  s_add_u32 s60, s60, 1
  s_cmp_gt_u32 s60, 262144
  s_cbranch_scc1 L_fail_rec
  s_branch L_recf2_rpoll
L_recf2_max:
  v_max3_f32 v22, v20, v16, v17
  v_max3_f32 v22, v22, v18, v19
  s_nop 1
  v_max_f32_dpp v22, v22, v22 quad_perm:[2,3,0,1] row_mask:0xf bank_mask:0xf
  v_mov_b32 v23, v22
  s_nop 1
  v_permlane16_swap_b32 v22, v23
  v_max_f32 v22, v22, v23
  v_mov_b32 v23, v22
  s_nop 1
  v_permlane32_swap_b32 v22, v23
  v_max_f32 v22, v22, v23
  v_sub_f32 v28, v20, v22
  v_sub_f32 v30, v16, v22
  v_sub_f32 v31, v17, v22
  v_sub_f32 v32, v18, v22
  v_sub_f32 v33, v19, v22
  v_mul_f32 v28, s42, v28
  v_mul_f32 v30, s42, v30
  v_mul_f32 v31, s42, v31
  v_mul_f32 v32, s42, v32
  v_mul_f32 v33, s42, v33
  v_exp_f32 v28, v28
  v_exp_f32 v30, v30
  v_exp_f32 v31, v31
  v_exp_f32 v32, v32
  v_exp_f32 v33, v33
  s_nop 0
  s_branch L_recf2_maxok
L_recf2_done:
  s_waitcnt vmcnt(0)
  s_barrier
  v_mov_b32 v0, 64
  s_mov_b64 exec, 1
  buffer_store_dword v0, v1, s[4:7], s101 offen sc1
  s_mov_b64 exec, -1
  s_endpgm
L_recf3_redo:
  s_waitcnt lgkmcnt(0)
  v_mov_b64 v[24:25], 0
  v_mov_b64 v[26:27], 0
  v_mov_b64 v[28:29], 0
  v_mov_b64 v[30:31], 0
  v_mov_b64 v[32:33], 0
  v_mov_b64 v[34:35], 0
  v_mov_b64 v[36:37], 0
  v_mov_b64 v[38:39], 0
  v_mov_b64 v[40:41], 0
  v_mov_b64 v[42:43], 0
  v_mov_b64 v[44:45], 0
  v_mov_b64 v[46:47], 0
  ds_read_b128 v[48:51], v10 offset:0
  ds_read_b128 v[52:55], v10 offset:1024
  ds_read_b128 v[56:59], v10 offset:2048
  ds_read_b128 v[60:63], v10 offset:3072
  s_add_u32 s35, s51, 1
  s_bitcmp1_b32 s35, 0
  s_cselect_b32 s36, s3, s2
  s_add_u32 s100, s34, 32768
  s_cmp_gt_u32 s36, s35
  s_cselect_b32 s100, s100, 0x40000000
  s_add_u32 s38, s100, 8192
  s_waitcnt lgkmcnt(0)
  s_branch L_recf3_step
L_recf3_g5:
  s_barrier
  buffer_load_dwordx4 v1, s[4:7], s33 offen offset:0 sc1 lds
  buffer_load_dwordx4 v1, s[4:7], s33 offen offset:1024 sc1 lds
  buffer_load_dwordx4 v1, s[4:7], s33 offen offset:2048 sc1 lds
  s_add_u32 s35, s51, 1
  s_bitcmp1_b32 s35, 0
  s_cselect_b32 s36, s3, s2
  s_add_u32 s100, s34, 32768
  s_cmp_gt_u32 s36, s35
  s_cselect_b32 s100, s100, 0x40000000
  s_add_u32 s38, s100, 8192
L_recf3_g:
  s_waitcnt vmcnt(0)
  ds_read_b128 v[16:19], v0
  ds_read_b128 v[20:23], v0 offset:1024
  ds_read_b128 v[64:67], v0 offset:2048
  s_waitcnt lgkmcnt(2)
  v_max3_u32 v16, v16, v17, v18
  s_waitcnt lgkmcnt(1)
  v_max3_u32 v20, v20, v21, v22
  v_max3_u32 v16, v16, v19, v23
  s_waitcnt lgkmcnt(0)
  v_max3_u32 v20, v20, v64, v65
  v_max3_u32 v16, v16, v66, v67
  v_max3_u32 v16, v16, v20, s98
  v_cmp_eq_u32 vcc, -1, v16
  s_cbranch_vccnz L_recf3_gr
L_recf3_step:
  s_barrier
  ds_read_b64_tr_b16 v[16:17], v3 offset:0
  ds_read_b64_tr_b16 v[18:19], v3 offset:512
  buffer_load_dwordx4 v[72:75], v11, s[4:7], s34 offen sc1
  buffer_load_dwordx4 v[76:79], v11, s[4:7], s34 offen offset:32 sc1
  s_waitcnt lgkmcnt(0)
  v_smfmac_f32_16x16x64_bf16 v[24:27], v[16:19], a[0:7], v2
  ds_read_b64_tr_b16 v[20:21], v3 offset:1024
  v_smfmac_f32_16x16x64_bf16 v[40:43], v[16:19], v[48:55], v2
  ds_read_b64_tr_b16 v[22:23], v3 offset:1536
  v_smfmac_f32_16x16x64_bf16 v[28:31], v[16:19], a[72:79], v2
  ds_read_b128 v[48:51], v10 offset:4096
  buffer_load_dwordx4 v[68:71], v12, s[4:7], s34 offen sc1
  v_smfmac_f32_16x16x64_bf16 v[32:35], v[16:19], a[144:151], v2
  ds_read_b128 v[52:55], v10 offset:5120
  v_smfmac_f32_16x16x64_bf16 v[44:47], v[16:19], v[56:63], v2
  buffer_load_dwordx4 v[64:67], v12, s[4:7], s34 offen offset:256 sc1
  v_smfmac_f32_16x16x64_bf16 v[36:39], v[16:19], a[216:223], v2
  ds_read_b128 v[56:59], v10 offset:6144
  s_waitcnt lgkmcnt(3)
  v_smfmac_f32_16x16x64_bf16 v[24:27], v[20:23], a[8:15], v2
  ds_read_b128 v[60:63], v10 offset:7168
  ds_read_b64_tr_b16 v[16:17], v3 offset:2048
  s_waitcnt lgkmcnt(3)
  v_smfmac_f32_16x16x64_bf16 v[40:43], v[20:23], v[48:55], v2
  ds_read_b64_tr_b16 v[18:19], v3 offset:2560
  v_smfmac_f32_16x16x64_bf16 v[28:31], v[20:23], a[80:87], v2
  ds_read_b128 v[48:51], v10 offset:8192
  buffer_load_dword v0, v14, s[4:7], s100 offen sc1
  v_smfmac_f32_16x16x64_bf16 v[32:35], v[20:23], a[152:159], v2
  ds_read_b128 v[52:55], v10 offset:9216
  s_waitcnt lgkmcnt(4)
  v_smfmac_f32_16x16x64_bf16 v[44:47], v[20:23], v[56:63], v2
  buffer_load_dword v0, v14, s[4:7], s38 offen sc1
  v_smfmac_f32_16x16x64_bf16 v[36:39], v[20:23], a[224:231], v2
  ds_read_b128 v[56:59], v10 offset:10240
  s_waitcnt lgkmcnt(3)
  v_smfmac_f32_16x16x64_bf16 v[24:27], v[16:19], a[16:23], v2
  ds_read_b128 v[60:63], v10 offset:11264
  ds_read_b64_tr_b16 v[20:21], v3 offset:3072
  s_waitcnt lgkmcnt(3)
  v_smfmac_f32_16x16x64_bf16 v[40:43], v[16:19], v[48:55], v2
  ds_read_b64_tr_b16 v[22:23], v3 offset:3584
  v_smfmac_f32_16x16x64_bf16 v[28:31], v[16:19], a[88:95], v2
  ds_read_b128 v[48:51], v10 offset:12288
  v_smfmac_f32_16x16x64_bf16 v[32:35], v[16:19], a[160:167], v2
  ds_read_b128 v[52:55], v10 offset:13312
  s_waitcnt lgkmcnt(4)
  v_smfmac_f32_16x16x64_bf16 v[44:47], v[16:19], v[56:63], v2
  v_smfmac_f32_16x16x64_bf16 v[36:39], v[16:19], a[232:239], v2
  ds_read_b128 v[56:59], v10 offset:14336
  s_waitcnt lgkmcnt(3)
  v_smfmac_f32_16x16x64_bf16 v[24:27], v[20:23], a[24:31], v2
  ds_read_b128 v[60:63], v10 offset:15360
  ds_read_b64_tr_b16 v[16:17], v3 offset:4096
  s_waitcnt lgkmcnt(3)
  v_smfmac_f32_16x16x64_bf16 v[40:43], v[20:23], v[48:55], v2
  ds_read_b64_tr_b16 v[18:19], v3 offset:4608
  v_smfmac_f32_16x16x64_bf16 v[28:31], v[20:23], a[96:103], v2
  ds_read_b128 v[48:51], v10 offset:16384
  v_smfmac_f32_16x16x64_bf16 v[32:35], v[20:23], a[168:175], v2
  ds_read_b128 v[52:55], v10 offset:17408
  s_waitcnt lgkmcnt(4)
  v_smfmac_f32_16x16x64_bf16 v[44:47], v[20:23], v[56:63], v2
  v_smfmac_f32_16x16x64_bf16 v[36:39], v[20:23], a[240:247], v2
  ds_read_b128 v[56:59], v10 offset:18432
  s_waitcnt lgkmcnt(3)
  v_smfmac_f32_16x16x64_bf16 v[24:27], v[16:19], a[32:39], v2
  ds_read_b128 v[60:63], v10 offset:19456
  ds_read_b64_tr_b16 v[20:21], v3 offset:5120
  s_waitcnt lgkmcnt(3)
  v_smfmac_f32_16x16x64_bf16 v[40:43], v[16:19], v[48:55], v2
  ds_read_b64_tr_b16 v[22:23], v3 offset:5632
  v_smfmac_f32_16x16x64_bf16 v[28:31], v[16:19], a[104:111], v2
  ds_read_b128 v[48:51], v10 offset:20480
  s_add_u32 s58, s57, s52
  s_add_u32 s35, s51, 1
  v_smfmac_f32_16x16x64_bf16 v[32:35], v[16:19], a[176:183], v2
  ds_read_b128 v[52:55], v10 offset:21504
  s_waitcnt lgkmcnt(4)
  v_smfmac_f32_16x16x64_bf16 v[44:47], v[16:19], v[56:63], v2
  v_smfmac_f32_16x16x64_bf16 v[36:39], v[16:19], a[248:255], v2
  ds_read_b128 v[56:59], v10 offset:22528
  s_waitcnt lgkmcnt(3)
  v_smfmac_f32_16x16x64_bf16 v[24:27], v[20:23], a[40:47], v2
  ds_read_b128 v[60:63], v10 offset:23552
  ds_read_b64_tr_b16 v[16:17], v3 offset:6144
  s_waitcnt lgkmcnt(3)
  v_smfmac_f32_16x16x64_bf16 v[40:43], v[20:23], v[48:55], v2
  ds_read_b64_tr_b16 v[18:19], v3 offset:6656
  v_smfmac_f32_16x16x64_bf16 v[28:31], v[20:23], a[112:119], v2
  ds_read_b128 v[48:51], v10 offset:24576
  s_and_b32 s36, s51, 1
  s_mul_i32 s36, s36, 307200
  v_smfmac_f32_16x16x64_bf16 v[32:35], v[20:23], a[184:191], v2
  ds_read_b128 v[52:55], v10 offset:25600
  s_waitcnt lgkmcnt(4)
  v_smfmac_f32_16x16x64_bf16 v[44:47], v[20:23], v[56:63], v2
  v_smfmac_f32_16x16x64_bf16 v[36:39], v[20:23], v[80:87], v2
  ds_read_b128 v[56:59], v10 offset:26624
  s_waitcnt lgkmcnt(3)
  v_smfmac_f32_16x16x64_bf16 v[24:27], v[16:19], a[48:55], v2
  ds_read_b128 v[60:63], v10 offset:27648
  ds_read_b64_tr_b16 v[20:21], v3 offset:7168
  s_waitcnt lgkmcnt(3)
  v_smfmac_f32_16x16x64_bf16 v[40:43], v[16:19], v[48:55], v2
  ds_read_b64_tr_b16 v[22:23], v3 offset:7680
  v_smfmac_f32_16x16x64_bf16 v[28:31], v[16:19], a[120:127], v2
  ds_read_b128 v[48:51], v10 offset:28672
  s_add_u32 s55, s53, s36
  s_add_u32 s56, s54, s36
  v_smfmac_f32_16x16x64_bf16 v[32:35], v[16:19], a[192:199], v2
  ds_read_b128 v[52:55], v10 offset:29696
  s_waitcnt lgkmcnt(4)
  v_smfmac_f32_16x16x64_bf16 v[44:47], v[16:19], v[56:63], v2
  v_smfmac_f32_16x16x64_bf16 v[36:39], v[16:19], v[88:95], v2
  ds_read_b128 v[56:59], v10 offset:30720
  s_waitcnt lgkmcnt(3)
  v_smfmac_f32_16x16x64_bf16 v[24:27], v[20:23], a[56:63], v2
  ds_read_b128 v[60:63], v10 offset:31744
  ds_read_b64_tr_b16 v[16:17], v3 offset:8192
  s_waitcnt lgkmcnt(3)
  v_smfmac_f32_16x16x64_bf16 v[40:43], v[20:23], v[48:55], v2
  ds_read_b64_tr_b16 v[18:19], v3 offset:8704
  v_smfmac_f32_16x16x64_bf16 v[28:31], v[20:23], a[128:135], v2
  s_add_u32 s30, s37, s36
  v_smfmac_f32_16x16x64_bf16 v[32:35], v[20:23], a[200:207], v2
  s_waitcnt lgkmcnt(2)
  v_smfmac_f32_16x16x64_bf16 v[44:47], v[20:23], v[56:63], v2
  v_smfmac_f32_16x16x64_bf16 v[36:39], v[20:23], v[96:103], v2
  s_waitcnt lgkmcnt(0)
  v_smfmac_f32_16x16x64_bf16 v[24:27], v[16:19], a[64:71], v2
  s_waitcnt vmcnt(2)
  v_mov_b64 v[56:57], v[68:69]
  v_smfmac_f32_16x16x64_bf16 v[28:31], v[16:19], a[136:143], v2
  v_mov_b64 v[60:61], v[70:71]
  v_smfmac_f32_16x16x64_bf16 v[32:35], v[16:19], a[208:215], v2
  v_mov_b64 v[68:69], v[66:67]
  v_smfmac_f32_16x16x64_bf16 v[36:39], v[16:19], v[104:111], v2
  v_add_f32 v24, v24, v26
  v_smfmac_f32_16x16x64_bf16 v[40:43], v[16:19], v[112:119], v2
  v_add_f32 v25, v25, v27
  v_smfmac_f32_16x16x64_bf16 v[44:47], v[16:19], v[120:127], v2
  v_add_f32 v28, v28, v30
  v_add_f32 v29, v29, v31
  v_cvt_pk_bf16_f32 v24, v24, v25
  v_cvt_pk_bf16_f32 v25, v28, v29
  ds_write2_b32 v5, v24, v25 offset1:64
  ds_read_b64_tr_b16 v[28:29], v7 offset:0
  ds_read_b64_tr_b16 v[30:31], v7 offset:128
  v_pk_add_f32 v[32:33], v[32:33], v[34:35]
  v_pk_add_f32 v[36:37], v[36:37], v[38:39]
  v_cvt_pk_bf16_f32 v32, v32, v33
  v_cvt_pk_bf16_f32 v33, v36, v37
  ds_write2_b32 v5, v32, v33 offset0:128 offset1:192
  ds_read_b64_tr_b16 v[36:37], v7 offset:512
  ds_read_b64_tr_b16 v[38:39], v7 offset:640
  s_waitcnt lgkmcnt(3)
  v_mfma_f32_16x16x32_bf16 v[24:27], v[72:75], v[28:31], 0
  v_add_f32 v40, v40, v42
  v_add_f32 v41, v41, v43
  v_mfma_f32_16x16x32_bf16 v[16:19], v[76:79], v[28:31], 0
  v_add_f32 v44, v44, v46
  v_add_f32 v45, v45, v47
  s_waitcnt lgkmcnt(0)
  v_mfma_f32_16x16x32_bf16 v[20:23], v[36:39], v[28:31], 0
  v_cvt_pk_bf16_f32 v58, v40, v41
  v_cvt_pk_bf16_f32 v66, v44, v45
  v_lshrrev_b32 v47, 2, v1
  s_nop 0
  v_cndmask_b32 v24, v24, v16, s[94:95]
  v_cndmask_b32 v25, v25, v17, s[94:95]
  v_cndmask_b32 v26, v26, v18, s[94:95]
  v_cndmask_b32 v27, v27, v19, s[94:95]
  ds_write_b128 v8, v[24:27]
  v_cndmask_b32 v20, v20, v21, s[94:95]
  v_cndmask_b32 v22, v22, v23, s[94:95]
  v_cndmask_b32 v20, v20, v22, s[48:49]
  ds_write_b32 v9, v20 offset:1024
  s_mov_b64 exec, s[94:95]
  buffer_store_dwordx4 v[36:39], v6, s[4:7], s57 offen sc1
  s_mov_b64 exec, -1
  v_add_u32 v46, 158720, v1
  v_add_u32 v45, 159744, v47
  s_waitcnt lgkmcnt(0)
  s_barrier
  ds_read_b128 v[16:19], v46 offset:0
  ds_read_b32 v32, v45 offset:0
  ds_read_b128 v[20:23], v46 offset:1280
  ds_read_b32 v33, v45 offset:1280
  ds_read_b128 v[24:27], v46 offset:2560
  ds_read_b32 v34, v45 offset:2560
  ds_read_b128 v[28:31], v46 offset:3840
  ds_read_b32 v35, v45 offset:3840
  buffer_store_dword v58, v47, s[4:7], s58 offen offset:0 sc1
  buffer_store_dword v66, v47, s[4:7], s58 offen offset:256 sc1
  v_mov_b32 v59, 0
  v_mov_b64 v[62:63], v[58:59]
  v_mov_b32 v67, 0
  v_mov_b64 v[70:71], v[66:67]
  v_mov_b64 v[36:37], 0
  v_mov_b64 v[38:39], 0
  v_mov_b64 v[48:49], 0
  v_mov_b64 v[50:51], 0
  v_mov_b64 v[52:53], 0
  v_mov_b64 v[54:55], 0
  v_mov_b64 v[72:73], s[44:45]
  v_mov_b64 v[74:75], s[46:47]
  v_mov_b64 v[76:77], s[44:45]
  v_mov_b64 v[78:79], s[46:47]
  s_waitcnt lgkmcnt(4)
  v_pk_add_f32 v[16:17], v[16:17], v[20:21]
  v_pk_add_f32 v[18:19], v[18:19], v[22:23]
  s_waitcnt lgkmcnt(2)
  v_pk_add_f32 v[16:17], v[16:17], v[24:25]
  v_pk_add_f32 v[18:19], v[18:19], v[26:27]
  v_add_f32 v32, v32, v33
  v_add_f32 v32, v32, v34
  s_waitcnt lgkmcnt(0)
  v_pk_add_f32 v[16:17], v[16:17], v[28:29]
  v_pk_add_f32 v[18:19], v[18:19], v[30:31]
  v_add_f32 v20, v32, v35
  v_max3_f32 v22, |v20|, |v16|, |v17|
  v_max3_f32 v22, v22, |v18|, |v19|
  v_mul_f32 v28, s42, v20
  v_pk_mul_f32 v[30:31], v[16:17], s[42:43]
  v_pk_mul_f32 v[32:33], v[18:19], s[42:43]
  v_cmp_nle_f32 vcc, v22, s83
  v_exp_f32 v28, v28
  v_exp_f32 v30, v30
  v_exp_f32 v31, v31
  v_exp_f32 v32, v32
  v_exp_f32 v33, v33
  s_cbranch_vccnz L_recf3_max
L_recf3_maxok:
  v_cvt_pk_bf16_f32 v25, v28, v28
  v_cvt_pk_bf16_f32 v27, v28, v28
  v_cvt_pk_bf16_f32 v24, v30, v31
  v_cvt_pk_bf16_f32 v26, v32, v33
  v_mov_b64 v[28:29], 0
  v_mov_b64 v[30:31], 0
  v_smfmac_f32_16x16x64_bf16 v[36:39], v[24:27], v[72:79], v2 abid:1
  ds_read_b128 v[40:43], v10 offset:32768
  ds_read_b128 v[44:47], v10 offset:33792
  v_smfmac_f32_16x16x64_bf16 v[48:51], v[24:27], v[56:63], v2 abid:1
  ds_read_b128 v[72:75], v10 offset:34816
  ds_read_b128 v[76:79], v10 offset:35840
  v_smfmac_f32_16x16x64_bf16 v[52:55], v[24:27], v[64:71], v2 abid:1
  v_mov_b64 v[56:57], 0
  v_mov_b64 v[58:59], 0
  v_mov_b64 v[60:61], 0
  v_mov_b64 v[62:63], 0
  v_add_f32 v36, v36, v38
  v_add_f32 v37, v37, v39
  v_rcp_f32 v36, v36
  v_rcp_f32 v37, v37
  v_pk_add_f32 v[48:49], v[48:49], v[50:51]
  v_pk_add_f32 v[52:53], v[52:53], v[54:55]
  v_pk_mul_f32 v[48:49], v[48:49], v[36:37]
  v_pk_mul_f32 v[52:53], v[52:53], v[36:37]
  v_cvt_pk_bf16_f32 v16, v48, v49
  v_cvt_pk_bf16_f32 v17, v52, v53
  ds_write2_b32 v4, v16, v17 offset1:8
  v_mov_b64 v[64:65], 0
  v_mov_b64 v[66:67], 0
  v_mov_b64 v[68:69], 0
  v_mov_b64 v[70:71], 0
  v_mov_b64 v[24:25], 0
  v_mov_b64 v[26:27], 0
  v_mov_b64 v[48:49], 0
  v_mov_b64 v[50:51], 0
  v_mov_b64 v[52:53], 0
  v_mov_b64 v[54:55], 0
  v_mov_b64 v[32:33], 0
  v_mov_b64 v[34:35], 0
  s_waitcnt lgkmcnt(0)
  s_barrier
  ds_read_b64_tr_b16 v[16:17], v3 offset:9216
  ds_read_b64_tr_b16 v[18:19], v3 offset:9728
  ds_read_b64_tr_b16 v[20:21], v3 offset:10240
  ds_read_b64_tr_b16 v[22:23], v3 offset:10752
  v_lshrrev_b32 v36, 7, v1
  v_mul_u32_u24 v36, 1152, v36
  v_bfe_u32 v37, v1, 2, 5
  v_add_u32 v36, v36, v37
  v_mov_b32 v38, -1
  s_waitcnt lgkmcnt(2)
  v_smfmac_f32_16x16x64_bf16 v[24:27], v[16:19], v[40:47], v2
  v_smfmac_f32_16x16x64_bf16 v[52:55], v[16:19], v[240:247], v2
  s_waitcnt lgkmcnt(0)
  v_smfmac_f32_16x16x64_bf16 v[24:27], v[20:23], v[72:79], v2
  v_smfmac_f32_16x16x64_bf16 v[52:55], v[20:23], v[248:255], v2
  v_smfmac_f32_16x16x64_bf16 v[28:31], v[16:19], v[128:135], v2
  v_add_f32 v24, v24, v26
  v_add_f32 v25, v25, v27
  v_smfmac_f32_16x16x64_bf16 v[28:31], v[20:23], v[136:143], v2
  v_cvt_pk_bf16_f32 v24, v24, v25
  v_smfmac_f32_16x16x64_bf16 v[32:35], v[16:19], v[144:151], v2
  s_add_u32 s50, s55, 0
  buffer_store_dword v24, v13, s[4:7], s50 offen
  v_add_f32 v52, v52, v54
  v_add_f32 v53, v53, v55
  v_smfmac_f32_16x16x64_bf16 v[32:35], v[20:23], v[152:159], v2
  v_cvt_pk_bf16_f32 v52, v52, v53
  v_smfmac_f32_16x16x64_bf16 v[56:59], v[16:19], v[160:167], v2
  buffer_store_dword v52, v36, s[4:7], s56 offen
  v_add_f32 v28, v28, v30
  v_add_f32 v29, v29, v31
  v_smfmac_f32_16x16x64_bf16 v[56:59], v[20:23], v[168:175], v2
  v_cvt_pk_bf16_f32 v28, v28, v29
  v_smfmac_f32_16x16x64_bf16 v[60:63], v[16:19], v[176:183], v2
  s_add_u32 s50, s55, 8448
  buffer_store_dword v28, v13, s[4:7], s50 offen
  v_add_f32 v32, v32, v34
  v_add_f32 v33, v33, v35
  v_smfmac_f32_16x16x64_bf16 v[60:63], v[20:23], v[184:191], v2
  v_cvt_pk_bf16_f32 v32, v32, v33
  v_smfmac_f32_16x16x64_bf16 v[64:67], v[16:19], v[192:199], v2
  s_add_u32 s50, s55, 16896
  buffer_store_dword v32, v13, s[4:7], s50 offen
  v_add_f32 v56, v56, v58
  v_add_f32 v57, v57, v59
  v_smfmac_f32_16x16x64_bf16 v[64:67], v[20:23], v[200:207], v2
  buffer_load_dwordx2 v[38:39], v1, s[4:7], s30 offen sc1
  v_cvt_pk_bf16_f32 v56, v56, v57
  v_smfmac_f32_16x16x64_bf16 v[68:71], v[16:19], v[208:215], v2
  s_add_u32 s50, s55, 25344
  buffer_store_dword v56, v13, s[4:7], s50 offen
  v_add_f32 v60, v60, v62
  v_add_f32 v61, v61, v63
  v_smfmac_f32_16x16x64_bf16 v[68:71], v[20:23], v[216:223], v2
  buffer_load_dwordx2 v[38:39], v1, s[4:7], s30 offen sc1
  v_cvt_pk_bf16_f32 v60, v60, v61
  v_smfmac_f32_16x16x64_bf16 v[48:51], v[16:19], v[224:231], v2
  s_add_u32 s50, s55, 33792
  buffer_store_dword v60, v13, s[4:7], s50 offen
  v_add_f32 v64, v64, v66
  v_add_f32 v65, v65, v67
  v_smfmac_f32_16x16x64_bf16 v[48:51], v[20:23], v[232:239], v2
  buffer_load_dwordx2 v[38:39], v1, s[4:7], s30 offen sc1
  v_cvt_pk_bf16_f32 v64, v64, v65
  s_add_u32 s50, s55, 42240
  buffer_store_dword v64, v13, s[4:7], s50 offen
  v_add_f32 v68, v68, v70
  v_add_f32 v69, v69, v71
  v_cvt_pk_bf16_f32 v68, v68, v69
  s_add_u32 s50, s55, 50688
  buffer_store_dword v68, v13, s[4:7], s50 offen
  v_add_f32 v48, v48, v50
  v_add_f32 v49, v49, v51
  v_cvt_pk_bf16_f32 v48, v48, v49
  s_add_u32 s50, s55, 59136
  buffer_store_dword v48, v13, s[4:7], s50 offen
  s_cmp_eq_u32 s51, 63
  s_cbranch_scc1 L_recf3_done
  s_load_dword s86, s[84:85], 0 glc
  s_load_dword s87, s[84:85], 128 glc
  s_load_dword s88, s[84:85], 256 glc
  s_load_dword s89, s[84:85], 384 glc
  s_load_dword s90, s[84:85], 16384 glc
  s_load_dword s91, s[84:85], 16512 glc
  s_load_dword s92, s[84:85], 16640 glc
  s_load_dword s93, s[84:85], 16768 glc
L_recf3_pA:
  v_cmp_eq_u32 vcc, -1, v38
  buffer_load_dwordx2 v[38:39], v1, s[4:7], s30 offen sc1
  s_add_u32 s60, s60, 1
  s_cmp_gt_u32 s60, 262144
  s_cselect_b64 s[96:97], 0, -1
  s_waitcnt vmcnt(10)
  s_and_b64 vcc, vcc, s[96:97]
  s_cbranch_scc1 L_recf3_pA
  s_barrier
  s_and_b32 s33, s35, 3
  s_lshl_b32 s33, s33, 14
  s_add_u32 s33, s33, s32
  s_add_u32 s51, s51, 1
  s_add_u32 s39, s39, 1
  s_add_u32 s34, s34, 24576
  s_add_u32 s57, s57, 4096
  s_add_u32 s33, s33, s63
  s_mov_b32 m0, s59
  ds_read_b128 v[48:51], v10 offset:0
  ds_read_b128 v[52:55], v10 offset:1024
  ds_read_b128 v[56:59], v10 offset:2048
  ds_read_b128 v[60:63], v10 offset:3072
  v_mov_b64 v[24:25], 0
  v_mov_b64 v[26:27], 0
  v_mov_b64 v[28:29], 0
  v_mov_b64 v[30:31], 0
  v_mov_b64 v[32:33], 0
  v_mov_b64 v[34:35], 0
  v_mov_b64 v[36:37], 0
  v_mov_b64 v[40:41], 0
  v_mov_b64 v[42:43], 0
  v_mov_b64 v[44:45], 0
  v_mov_b64 v[46:47], 0
  s_waitcnt vmcnt(0)
  v_mov_b64 v[38:39], 0
  v_add_u32 v0, s59, v1
  s_sleep 5
  s_waitcnt lgkmcnt(0)
  s_min_u32 s2, s86, s87
  s_min_u32 s88, s88, s89
  s_min_u32 s2, s2, s88
  s_min_u32 s3, s90, s91
  s_min_u32 s92, s92, s93
  s_min_u32 s3, s3, s92
  s_bitcmp1_b32 s35, 0
  s_cselect_b32 s38, s3, s2
  s_cmp_le_u32 s38, s35
  s_cselect_b32 s98, -1, 0
  s_branch L_recf3_g5
L_recf3_gr:
  buffer_load_dwordx4 v1, s[4:7], s33 offen offset:0 sc1 lds
  buffer_load_dwordx4 v1, s[4:7], s33 offen offset:1024 sc1 lds
  buffer_load_dwordx4 v1, s[4:7], s33 offen offset:2048 sc1 lds
  s_add_u32 s60, s60, 1
  s_cmp_gt_u32 s60, 262144
  s_cbranch_scc1 L_fail_rec
  s_cmp_eq_u32 s98, 0
  s_cbranch_scc1 L_recf3_g
  s_and_b32 s36, s51, 1
  s_lshl_b32 s36, s36, 14
  s_add_u32 s36, s36, s62
  v_lshlrev_b32 v16, 3, v1
Lwf_11:
  s_mov_b64 exec, 15
  buffer_load_dword v17, v16, s[4:7], s36 offen sc1
  s_waitcnt vmcnt(0)
  v_cmp_ge_u32 vcc, s51, v17
  s_mov_b64 exec, -1
  s_cbranch_vccz Lwfok_12
  s_add_u32 s60, s60, 1
  s_cmp_gt_u32 s60, 262144
  s_cbranch_scc1 L_fail_rec
  s_branch Lwf_11
Lwfok_12:
  s_mov_b32 s98, 0
  s_branch L_recf3_g
L_recf3_max:
  v_max3_f32 v22, v20, v16, v17
  v_max3_f32 v22, v22, v18, v19
  s_nop 1
  v_max_f32_dpp v22, v22, v22 quad_perm:[2,3,0,1] row_mask:0xf bank_mask:0xf
  v_mov_b32 v23, v22
  s_nop 1
  v_permlane16_swap_b32 v22, v23
  v_max_f32 v22, v22, v23
  v_mov_b32 v23, v22
  s_nop 1
  v_permlane32_swap_b32 v22, v23
  v_max_f32 v22, v22, v23
  v_sub_f32 v28, v20, v22
  v_sub_f32 v30, v16, v22
  v_sub_f32 v31, v17, v22
  v_sub_f32 v32, v18, v22
  v_sub_f32 v33, v19, v22
  v_mul_f32 v28, s42, v28
  v_mul_f32 v30, s42, v30
  v_mul_f32 v31, s42, v31
  v_mul_f32 v32, s42, v32
  v_mul_f32 v33, s42, v33
  v_exp_f32 v28, v28
  v_exp_f32 v30, v30
  v_exp_f32 v31, v31
  v_exp_f32 v32, v32
  v_exp_f32 v33, v33
  s_nop 0
  s_branch L_recf3_maxok
L_recf3_done:
  s_waitcnt vmcnt(0)
  s_barrier
  s_endpgm
L_rec_slow:
  s_cmp_eq_u32 s24, 2
  s_cbranch_scc1 L_recs2_redo
  s_cmp_eq_u32 s24, 3
  s_cbranch_scc1 L_recs3_redo
L_recs0_redo:
  s_waitcnt lgkmcnt(0)
  v_mov_b64 v[24:25], 0
  v_mov_b64 v[26:27], 0
  v_mov_b64 v[28:29], 0
  v_mov_b64 v[30:31], 0
  v_mov_b64 v[32:33], 0
  v_mov_b64 v[34:35], 0
  v_mov_b64 v[36:37], 0
  v_mov_b64 v[38:39], 0
  v_mov_b64 v[40:41], 0
  v_mov_b64 v[42:43], 0
  v_mov_b64 v[44:45], 0
  v_mov_b64 v[46:47], 0
  ds_read_b128 v[48:51], v10 offset:0
  ds_read_b128 v[52:55], v10 offset:1024
  ds_read_b128 v[56:59], v10 offset:2048
  ds_read_b128 v[60:63], v10 offset:3072
  s_waitcnt lgkmcnt(0)
  s_branch L_recs0_step
L_recs0_g5:
  s_barrier
  buffer_load_dwordx4 v1, s[4:7], s33 offen offset:0 sc1 lds
  buffer_load_dwordx4 v1, s[4:7], s33 offen offset:1024 sc1 lds
L_recs0_g:
  s_waitcnt vmcnt(0)
  ds_read_b128 v[16:19], v0
  ds_read_b128 v[20:23], v0 offset:1024
  s_waitcnt lgkmcnt(1)
  v_max3_u32 v16, v16, v17, v18
  s_waitcnt lgkmcnt(0)
  v_max3_u32 v20, v20, v21, v22
  v_max3_u32 v16, v16, v19, v23
  v_max_u32 v16, v16, v20
  v_cmp_eq_u32 vcc, -1, v16
  s_cbranch_vccnz L_recs0_gr
L_recs0_step:
  s_barrier
  ds_read_b64_tr_b16 v[16:17], v3 offset:0
  ds_read_b64_tr_b16 v[18:19], v3 offset:512
  buffer_load_dwordx4 v[72:75], v11, s[4:7], s34 offen sc1
  buffer_load_dwordx4 v[76:79], v11, s[4:7], s34 offen offset:32 sc1
  s_waitcnt lgkmcnt(0)
  v_smfmac_f32_16x16x64_bf16 v[24:27], v[16:19], a[0:7], v2
  ds_read_b64_tr_b16 v[20:21], v3 offset:1024
  v_smfmac_f32_16x16x64_bf16 v[40:43], v[16:19], v[48:55], v2
  ds_read_b64_tr_b16 v[22:23], v3 offset:1536
  v_smfmac_f32_16x16x64_bf16 v[28:31], v[16:19], a[72:79], v2
  ds_read_b128 v[48:51], v10 offset:4096
  buffer_load_dwordx4 v[68:71], v12, s[4:7], s34 offen sc1
  v_smfmac_f32_16x16x64_bf16 v[32:35], v[16:19], a[144:151], v2
  ds_read_b128 v[52:55], v10 offset:5120
  v_smfmac_f32_16x16x64_bf16 v[44:47], v[16:19], v[56:63], v2
  buffer_load_dwordx4 v[64:67], v12, s[4:7], s34 offen offset:256 sc1
  v_smfmac_f32_16x16x64_bf16 v[36:39], v[16:19], a[216:223], v2
  ds_read_b128 v[56:59], v10 offset:6144
  s_waitcnt lgkmcnt(3)
  v_smfmac_f32_16x16x64_bf16 v[24:27], v[20:23], a[8:15], v2
  ds_read_b128 v[60:63], v10 offset:7168
  ds_read_b64_tr_b16 v[16:17], v3 offset:2048
  s_waitcnt lgkmcnt(3)
  v_smfmac_f32_16x16x64_bf16 v[40:43], v[20:23], v[48:55], v2
  ds_read_b64_tr_b16 v[18:19], v3 offset:2560
  v_smfmac_f32_16x16x64_bf16 v[28:31], v[20:23], a[80:87], v2
  ds_read_b128 v[48:51], v10 offset:8192
  v_mov_b32 v0, -1
  v_smfmac_f32_16x16x64_bf16 v[32:35], v[20:23], a[152:159], v2
  ds_read_b128 v[52:55], v10 offset:9216
  s_waitcnt lgkmcnt(4)
  v_smfmac_f32_16x16x64_bf16 v[44:47], v[20:23], v[56:63], v2
  v_smfmac_f32_16x16x64_bf16 v[36:39], v[20:23], a[224:231], v2
  ds_read_b128 v[56:59], v10 offset:10240
  s_waitcnt lgkmcnt(3)
  v_smfmac_f32_16x16x64_bf16 v[24:27], v[16:19], a[16:23], v2
  ds_read_b128 v[60:63], v10 offset:11264
  ds_read_b64_tr_b16 v[20:21], v3 offset:3072
  s_waitcnt lgkmcnt(3)
  v_smfmac_f32_16x16x64_bf16 v[40:43], v[16:19], v[48:55], v2
  ds_read_b64_tr_b16 v[22:23], v3 offset:3584
  v_smfmac_f32_16x16x64_bf16 v[28:31], v[16:19], a[88:95], v2
  ds_read_b128 v[48:51], v10 offset:12288
  v_smfmac_f32_16x16x64_bf16 v[32:35], v[16:19], a[160:167], v2
  ds_read_b128 v[52:55], v10 offset:13312
  s_waitcnt lgkmcnt(4)
  v_smfmac_f32_16x16x64_bf16 v[44:47], v[16:19], v[56:63], v2
  buffer_store_dword v0, v1, s[4:7], s41 offen offset:0 sc1
  v_smfmac_f32_16x16x64_bf16 v[36:39], v[16:19], a[232:239], v2
  ds_read_b128 v[56:59], v10 offset:14336
  s_waitcnt lgkmcnt(3)
  v_smfmac_f32_16x16x64_bf16 v[24:27], v[20:23], a[24:31], v2
  ds_read_b128 v[60:63], v10 offset:15360
  ds_read_b64_tr_b16 v[16:17], v3 offset:4096
  s_waitcnt lgkmcnt(3)
  v_smfmac_f32_16x16x64_bf16 v[40:43], v[20:23], v[48:55], v2
  ds_read_b64_tr_b16 v[18:19], v3 offset:4608
  v_smfmac_f32_16x16x64_bf16 v[28:31], v[20:23], a[96:103], v2
  ds_read_b128 v[48:51], v10 offset:16384
  v_smfmac_f32_16x16x64_bf16 v[32:35], v[20:23], a[168:175], v2
  ds_read_b128 v[52:55], v10 offset:17408
  s_waitcnt lgkmcnt(4)
  v_smfmac_f32_16x16x64_bf16 v[44:47], v[20:23], v[56:63], v2
  buffer_store_dword v0, v1, s[4:7], s41 offen offset:1024 sc1
  v_smfmac_f32_16x16x64_bf16 v[36:39], v[20:23], a[240:247], v2
  ds_read_b128 v[56:59], v10 offset:18432
  s_waitcnt lgkmcnt(3)
  v_smfmac_f32_16x16x64_bf16 v[24:27], v[16:19], a[32:39], v2
  ds_read_b128 v[60:63], v10 offset:19456
  ds_read_b64_tr_b16 v[20:21], v3 offset:5120
  s_waitcnt lgkmcnt(3)
  v_smfmac_f32_16x16x64_bf16 v[40:43], v[16:19], v[48:55], v2
  ds_read_b64_tr_b16 v[22:23], v3 offset:5632
  v_smfmac_f32_16x16x64_bf16 v[28:31], v[16:19], a[104:111], v2
  ds_read_b128 v[48:51], v10 offset:20480
  s_add_u32 s58, s57, s52
  s_add_u32 s35, s51, 1
  v_smfmac_f32_16x16x64_bf16 v[32:35], v[16:19], a[176:183], v2
  ds_read_b128 v[52:55], v10 offset:21504
  s_waitcnt lgkmcnt(4)
  v_smfmac_f32_16x16x64_bf16 v[44:47], v[16:19], v[56:63], v2
  buffer_store_dword v0, v1, s[4:7], s41 offen offset:2048 sc1
  v_smfmac_f32_16x16x64_bf16 v[36:39], v[16:19], a[248:255], v2
  ds_read_b128 v[56:59], v10 offset:22528
  s_waitcnt lgkmcnt(3)
  v_smfmac_f32_16x16x64_bf16 v[24:27], v[20:23], a[40:47], v2
  ds_read_b128 v[60:63], v10 offset:23552
  ds_read_b64_tr_b16 v[16:17], v3 offset:6144
  s_waitcnt lgkmcnt(3)
  v_smfmac_f32_16x16x64_bf16 v[40:43], v[20:23], v[48:55], v2
  ds_read_b64_tr_b16 v[18:19], v3 offset:6656
  v_smfmac_f32_16x16x64_bf16 v[28:31], v[20:23], a[112:119], v2
  ds_read_b128 v[48:51], v10 offset:24576
  s_and_b32 s36, s51, 1
  s_mul_i32 s36, s36, 307200
  v_smfmac_f32_16x16x64_bf16 v[32:35], v[20:23], a[184:191], v2
  ds_read_b128 v[52:55], v10 offset:25600
  s_waitcnt lgkmcnt(4)
  v_smfmac_f32_16x16x64_bf16 v[44:47], v[20:23], v[56:63], v2
  buffer_store_dword v0, v1, s[4:7], s41 offen offset:3072 sc1
  v_smfmac_f32_16x16x64_bf16 v[36:39], v[20:23], v[80:87], v2
  ds_read_b128 v[56:59], v10 offset:26624
  s_waitcnt lgkmcnt(3)
  v_smfmac_f32_16x16x64_bf16 v[24:27], v[16:19], a[48:55], v2
  ds_read_b128 v[60:63], v10 offset:27648
  ds_read_b64_tr_b16 v[20:21], v3 offset:7168
  s_waitcnt lgkmcnt(3)
  v_smfmac_f32_16x16x64_bf16 v[40:43], v[16:19], v[48:55], v2
  ds_read_b64_tr_b16 v[22:23], v3 offset:7680
  v_smfmac_f32_16x16x64_bf16 v[28:31], v[16:19], a[120:127], v2
  ds_read_b128 v[48:51], v10 offset:28672
  s_add_u32 s55, s53, s36
  s_add_u32 s56, s54, s36
  v_smfmac_f32_16x16x64_bf16 v[32:35], v[16:19], a[192:199], v2
  ds_read_b128 v[52:55], v10 offset:29696
  s_waitcnt lgkmcnt(4)
  v_smfmac_f32_16x16x64_bf16 v[44:47], v[16:19], v[56:63], v2
  buffer_store_dword v0, v14, s[4:7], s99 offen sc1
  v_smfmac_f32_16x16x64_bf16 v[36:39], v[16:19], v[88:95], v2
  ds_read_b128 v[56:59], v10 offset:30720
  s_waitcnt lgkmcnt(3)
  v_smfmac_f32_16x16x64_bf16 v[24:27], v[20:23], a[56:63], v2
  ds_read_b128 v[60:63], v10 offset:31744
  ds_read_b64_tr_b16 v[16:17], v3 offset:8192
  s_waitcnt lgkmcnt(3)
  v_smfmac_f32_16x16x64_bf16 v[40:43], v[20:23], v[48:55], v2
  ds_read_b64_tr_b16 v[18:19], v3 offset:8704
  v_smfmac_f32_16x16x64_bf16 v[28:31], v[20:23], a[128:135], v2
  s_add_u32 s30, s37, s36
  v_smfmac_f32_16x16x64_bf16 v[32:35], v[20:23], a[200:207], v2
  s_waitcnt lgkmcnt(2)
  v_smfmac_f32_16x16x64_bf16 v[44:47], v[20:23], v[56:63], v2
  v_smfmac_f32_16x16x64_bf16 v[36:39], v[20:23], v[96:103], v2
  s_waitcnt lgkmcnt(0)
  v_smfmac_f32_16x16x64_bf16 v[24:27], v[16:19], a[64:71], v2
  s_waitcnt vmcnt(5)
  v_mov_b64 v[56:57], v[68:69]
  v_smfmac_f32_16x16x64_bf16 v[28:31], v[16:19], a[136:143], v2
  v_mov_b64 v[60:61], v[70:71]
  v_smfmac_f32_16x16x64_bf16 v[32:35], v[16:19], a[208:215], v2
  v_mov_b64 v[68:69], v[66:67]
  v_smfmac_f32_16x16x64_bf16 v[36:39], v[16:19], v[104:111], v2
  v_add_f32 v24, v24, v26
  v_smfmac_f32_16x16x64_bf16 v[40:43], v[16:19], v[112:119], v2
  v_add_f32 v25, v25, v27
  v_smfmac_f32_16x16x64_bf16 v[44:47], v[16:19], v[120:127], v2
  v_add_f32 v28, v28, v30
  v_add_f32 v29, v29, v31
  v_cvt_pk_bf16_f32 v24, v24, v25
  v_cvt_pk_bf16_f32 v25, v28, v29
  ds_write2_b32 v5, v24, v25 offset1:64
  ds_read_b64_tr_b16 v[28:29], v7 offset:0
  ds_read_b64_tr_b16 v[30:31], v7 offset:128
  v_pk_add_f32 v[32:33], v[32:33], v[34:35]
  v_pk_add_f32 v[36:37], v[36:37], v[38:39]
  v_cvt_pk_bf16_f32 v32, v32, v33
  v_cvt_pk_bf16_f32 v33, v36, v37
  ds_write2_b32 v5, v32, v33 offset0:128 offset1:192
  ds_read_b64_tr_b16 v[36:37], v7 offset:512
  ds_read_b64_tr_b16 v[38:39], v7 offset:640
  s_waitcnt lgkmcnt(3)
  v_mfma_f32_16x16x32_bf16 v[24:27], v[72:75], v[28:31], 0
  v_add_f32 v40, v40, v42
  v_add_f32 v41, v41, v43
  v_mfma_f32_16x16x32_bf16 v[16:19], v[76:79], v[28:31], 0
  v_add_f32 v44, v44, v46
  v_add_f32 v45, v45, v47
  s_waitcnt lgkmcnt(0)
  v_mfma_f32_16x16x32_bf16 v[20:23], v[36:39], v[28:31], 0
  v_cvt_pk_bf16_f32 v58, v40, v41
  v_cvt_pk_bf16_f32 v66, v44, v45
  v_lshrrev_b32 v47, 2, v1
  s_nop 0
  v_cndmask_b32 v24, v24, v16, s[94:95]
  v_cndmask_b32 v25, v25, v17, s[94:95]
  v_cndmask_b32 v26, v26, v18, s[94:95]
  v_cndmask_b32 v27, v27, v19, s[94:95]
  ds_write_b128 v8, v[24:27]
  v_cndmask_b32 v20, v20, v21, s[94:95]
  v_cndmask_b32 v22, v22, v23, s[94:95]
  v_cndmask_b32 v20, v20, v22, s[48:49]
  ds_write_b32 v9, v20 offset:1024
  s_mov_b64 exec, s[94:95]
  buffer_store_dwordx4 v[36:39], v6, s[4:7], s57 offen sc1
  s_mov_b64 exec, -1
  v_add_u32 v46, 158720, v1
  v_add_u32 v45, 159744, v47
  s_waitcnt lgkmcnt(0)
  s_barrier
  ds_read_b128 v[16:19], v46 offset:0
  ds_read_b32 v32, v45 offset:0
  ds_read_b128 v[20:23], v46 offset:1280
  ds_read_b32 v33, v45 offset:1280
  ds_read_b128 v[24:27], v46 offset:2560
  ds_read_b32 v34, v45 offset:2560
  ds_read_b128 v[28:31], v46 offset:3840
  ds_read_b32 v35, v45 offset:3840
  buffer_store_dword v58, v47, s[4:7], s58 offen offset:0 sc1
  buffer_store_dword v66, v47, s[4:7], s58 offen offset:256 sc1
  v_mov_b32 v59, 0
  v_mov_b64 v[62:63], v[58:59]
  v_mov_b32 v67, 0
  v_mov_b64 v[70:71], v[66:67]
  v_mov_b64 v[36:37], 0
  v_mov_b64 v[38:39], 0
  v_mov_b64 v[48:49], 0
  v_mov_b64 v[50:51], 0
  v_mov_b64 v[52:53], 0
  v_mov_b64 v[54:55], 0
  v_mov_b64 v[72:73], s[44:45]
  v_mov_b64 v[74:75], s[46:47]
  v_mov_b64 v[76:77], s[44:45]
  v_mov_b64 v[78:79], s[46:47]
  s_waitcnt lgkmcnt(4)
  v_pk_add_f32 v[16:17], v[16:17], v[20:21]
  v_pk_add_f32 v[18:19], v[18:19], v[22:23]
  s_waitcnt lgkmcnt(2)
  v_pk_add_f32 v[16:17], v[16:17], v[24:25]
  v_pk_add_f32 v[18:19], v[18:19], v[26:27]
  v_add_f32 v32, v32, v33
  v_add_f32 v32, v32, v34
  s_waitcnt lgkmcnt(0)
  v_pk_add_f32 v[16:17], v[16:17], v[28:29]
  v_pk_add_f32 v[18:19], v[18:19], v[30:31]
  v_add_f32 v20, v32, v35
  v_max3_f32 v22, |v20|, |v16|, |v17|
  v_max3_f32 v22, v22, |v18|, |v19|
  v_mul_f32 v28, s42, v20
  v_pk_mul_f32 v[30:31], v[16:17], s[42:43]
  v_pk_mul_f32 v[32:33], v[18:19], s[42:43]
  v_cmp_nle_f32 vcc, v22, s83
  v_exp_f32 v28, v28
  v_exp_f32 v30, v30
  v_exp_f32 v31, v31
  v_exp_f32 v32, v32
  v_exp_f32 v33, v33
  s_cbranch_vccnz L_recs0_max
L_recs0_maxok:
  v_cvt_pk_bf16_f32 v25, v28, v28
  v_cvt_pk_bf16_f32 v27, v28, v28
  v_cvt_pk_bf16_f32 v24, v30, v31
  v_cvt_pk_bf16_f32 v26, v32, v33
  v_mov_b64 v[28:29], 0
  v_mov_b64 v[30:31], 0
  v_smfmac_f32_16x16x64_bf16 v[36:39], v[24:27], v[72:79], v2 abid:1
  ds_read_b128 v[40:43], v10 offset:32768
  ds_read_b128 v[44:47], v10 offset:33792
  v_smfmac_f32_16x16x64_bf16 v[48:51], v[24:27], v[56:63], v2 abid:1
  ds_read_b128 v[72:75], v10 offset:34816
  ds_read_b128 v[76:79], v10 offset:35840
  v_smfmac_f32_16x16x64_bf16 v[52:55], v[24:27], v[64:71], v2 abid:1
  v_mov_b64 v[56:57], 0
  v_mov_b64 v[58:59], 0
  v_mov_b64 v[60:61], 0
  v_mov_b64 v[62:63], 0
  v_add_f32 v36, v36, v38
  v_add_f32 v37, v37, v39
  v_rcp_f32 v36, v36
  v_rcp_f32 v37, v37
  v_pk_add_f32 v[48:49], v[48:49], v[50:51]
  v_pk_add_f32 v[52:53], v[52:53], v[54:55]
  v_pk_mul_f32 v[48:49], v[48:49], v[36:37]
  v_pk_mul_f32 v[52:53], v[52:53], v[36:37]
  v_cvt_pk_bf16_f32 v16, v48, v49
  v_cvt_pk_bf16_f32 v17, v52, v53
  ds_write2_b32 v4, v16, v17 offset1:8
  v_mov_b64 v[64:65], 0
  v_mov_b64 v[66:67], 0
  v_mov_b64 v[68:69], 0
  v_mov_b64 v[70:71], 0
  v_mov_b64 v[24:25], 0
  v_mov_b64 v[26:27], 0
  v_mov_b64 v[48:49], 0
  v_mov_b64 v[50:51], 0
  v_mov_b64 v[52:53], 0
  v_mov_b64 v[54:55], 0
  v_mov_b64 v[32:33], 0
  v_mov_b64 v[34:35], 0
  s_waitcnt lgkmcnt(0)
  s_barrier
  ds_read_b64_tr_b16 v[16:17], v3 offset:9216
  ds_read_b64_tr_b16 v[18:19], v3 offset:9728
  ds_read_b64_tr_b16 v[20:21], v3 offset:10240
  ds_read_b64_tr_b16 v[22:23], v3 offset:10752
  v_lshrrev_b32 v36, 7, v1
  v_mul_u32_u24 v36, 1152, v36
  v_bfe_u32 v37, v1, 2, 5
  v_add_u32 v36, v36, v37
  s_waitcnt lgkmcnt(2)
  v_smfmac_f32_16x16x64_bf16 v[24:27], v[16:19], v[40:47], v2
  v_smfmac_f32_16x16x64_bf16 v[52:55], v[16:19], v[240:247], v2
  s_waitcnt lgkmcnt(0)
  v_smfmac_f32_16x16x64_bf16 v[24:27], v[20:23], v[72:79], v2
  v_smfmac_f32_16x16x64_bf16 v[52:55], v[20:23], v[248:255], v2
  v_smfmac_f32_16x16x64_bf16 v[28:31], v[16:19], v[128:135], v2
  v_add_f32 v24, v24, v26
  v_add_f32 v25, v25, v27
  v_smfmac_f32_16x16x64_bf16 v[28:31], v[20:23], v[136:143], v2
  v_cvt_pk_bf16_f32 v24, v24, v25
  v_smfmac_f32_16x16x64_bf16 v[32:35], v[16:19], v[144:151], v2
  s_add_u32 s50, s55, 0
  buffer_store_dword v24, v13, s[4:7], s50 offen sc1
  v_add_f32 v52, v52, v54
  v_add_f32 v53, v53, v55
  v_smfmac_f32_16x16x64_bf16 v[32:35], v[20:23], v[152:159], v2
  v_cvt_pk_bf16_f32 v52, v52, v53
  v_smfmac_f32_16x16x64_bf16 v[56:59], v[16:19], v[160:167], v2
  buffer_store_dword v52, v36, s[4:7], s56 offen sc1
  v_add_f32 v28, v28, v30
  v_add_f32 v29, v29, v31
  v_smfmac_f32_16x16x64_bf16 v[56:59], v[20:23], v[168:175], v2
  v_cvt_pk_bf16_f32 v28, v28, v29
  v_smfmac_f32_16x16x64_bf16 v[60:63], v[16:19], v[176:183], v2
  s_add_u32 s50, s55, 8448
  buffer_store_dword v28, v13, s[4:7], s50 offen sc1
  v_add_f32 v32, v32, v34
  v_add_f32 v33, v33, v35
  v_smfmac_f32_16x16x64_bf16 v[60:63], v[20:23], v[184:191], v2
  v_cvt_pk_bf16_f32 v32, v32, v33
  v_smfmac_f32_16x16x64_bf16 v[64:67], v[16:19], v[192:199], v2
  s_add_u32 s50, s55, 16896
  buffer_store_dword v32, v13, s[4:7], s50 offen sc1
  v_add_f32 v56, v56, v58
  v_add_f32 v57, v57, v59
  v_smfmac_f32_16x16x64_bf16 v[64:67], v[20:23], v[200:207], v2
  v_cvt_pk_bf16_f32 v56, v56, v57
  v_smfmac_f32_16x16x64_bf16 v[68:71], v[16:19], v[208:215], v2
  s_add_u32 s50, s55, 25344
  buffer_store_dword v56, v13, s[4:7], s50 offen sc1
  v_add_f32 v60, v60, v62
  v_add_f32 v61, v61, v63
  v_smfmac_f32_16x16x64_bf16 v[68:71], v[20:23], v[216:223], v2
  v_cvt_pk_bf16_f32 v60, v60, v61
  v_smfmac_f32_16x16x64_bf16 v[48:51], v[16:19], v[224:231], v2
  s_add_u32 s50, s55, 33792
  buffer_store_dword v60, v13, s[4:7], s50 offen sc1
  v_add_f32 v64, v64, v66
  v_add_f32 v65, v65, v67
  v_smfmac_f32_16x16x64_bf16 v[48:51], v[20:23], v[232:239], v2
  v_cvt_pk_bf16_f32 v64, v64, v65
  s_add_u32 s50, s55, 42240
  buffer_store_dword v64, v13, s[4:7], s50 offen sc1
  v_add_f32 v68, v68, v70
  v_add_f32 v69, v69, v71
  v_cvt_pk_bf16_f32 v68, v68, v69
  s_add_u32 s50, s55, 50688
  buffer_store_dword v68, v13, s[4:7], s50 offen sc1
  v_add_f32 v48, v48, v50
  v_add_f32 v49, v49, v51
  v_cvt_pk_bf16_f32 v48, v48, v49
  s_add_u32 s50, s55, 59136
  buffer_store_dword v48, v13, s[4:7], s50 offen sc1
  s_cmp_eq_u32 s51, 63
  s_cbranch_scc1 L_recs0_done
  v_cndmask_b32 v16, 0, v15, s[86:87]
  v_cndmask_b32 v17, 0, v15, s[88:89]
  v_cndmask_b32 v18, 0, v15, s[90:91]
  v_cndmask_b32 v19, 0, v15, s[92:93]
  s_and_b32 s33, s35, 3
  s_lshl_b32 s33, s33, 14
  s_add_u32 s33, s33, s32
  s_mov_b32 s41, s30
  s_barrier
L_recs0_rpoll:
  buffer_load_dwordx4 v[48:51], v1, s[4:7], s41 offen offset:0 sc1
  buffer_load_dwordx4 v[52:55], v1, s[4:7], s41 offen offset:1024 sc1
  buffer_load_dwordx4 v[56:59], v1, s[4:7], s41 offen offset:2048 sc1
  buffer_load_dwordx4 v[60:63], v1, s[4:7], s41 offen offset:3072 sc1
L_recs0_rsum:
  v_mov_b64 v[24:25], 0
  v_mov_b64 v[26:27], 0
  v_mov_b64 v[28:29], 0
  v_mov_b64 v[30:31], 0
  v_mov_b64 v[32:33], 0
  v_mov_b64 v[34:35], 0
  v_mov_b64 v[36:37], 0
  v_mov_b64 v[38:39], 0
  v_mov_b64 v[40:41], 0
  v_mov_b64 v[42:43], 0
  v_mov_b64 v[44:45], 0
  v_mov_b64 v[46:47], 0
  s_waitcnt vmcnt(3)
  v_mfma_f32_16x16x32_bf16 v[20:23], v[16:19], v[48:51], 0
  s_waitcnt vmcnt(2)
  v_mfma_f32_16x16x32_bf16 v[20:23], v[16:19], v[52:55], v[20:23]
  s_waitcnt vmcnt(1)
  v_mfma_f32_16x16x32_bf16 v[20:23], v[16:19], v[56:59], v[20:23]
  s_waitcnt vmcnt(0)
  v_mfma_f32_16x16x32_bf16 v[20:23], v[16:19], v[60:63], v[20:23]
  s_nop 7
  v_cmp_u_f32 vcc, v20, v20
  v_add_f32_dpp v22, v20, v20 row_ror:8 row_mask:0xf bank_mask:0xf
  v_add_f32_dpp v23, v21, v21 row_ror:8 row_mask:0xf bank_mask:0xf
  v_cvt_pk_bf16_f32 v22, v22, v23
  s_cbranch_vccnz L_recs0_rB
L_recs0_rgo:
  buffer_store_dword v22, v14, s[4:7], s33 offen sc1
  s_and_b32 s99, s51, 3
  s_lshl_b32 s99, s99, 14
  s_add_u32 s99, s99, s32
  s_add_u32 s33, s33, s63
  s_mov_b32 m0, s59
  ds_read_b128 v[48:51], v10 offset:0
  ds_read_b128 v[52:55], v10 offset:1024
  ds_read_b128 v[56:59], v10 offset:2048
  ds_read_b128 v[60:63], v10 offset:3072
  s_add_u32 s51, s51, 1
  s_add_u32 s39, s39, 1
  s_add_u32 s34, s34, 24576
  s_add_u32 s57, s57, 4096
  v_add_u32 v0, s59, v1
  s_branch L_recs0_g5
L_recs0_gr:
  buffer_load_dwordx4 v1, s[4:7], s33 offen offset:0 sc1 lds
  buffer_load_dwordx4 v1, s[4:7], s33 offen offset:1024 sc1 lds
  s_add_u32 s60, s60, 1
  s_cmp_gt_u32 s60, 262144
  s_cbranch_scc1 L_fail_rec
  s_branch L_recs0_g
L_recs0_rB:
  v_max3_u32 v20, v48, v49, v50
  v_max3_u32 v20, v20, v51, v52
  v_max3_u32 v20, v20, v53, v54
  v_max3_u32 v20, v20, v55, v56
  v_max3_u32 v20, v20, v57, v58
  v_max3_u32 v20, v20, v59, v60
  v_max3_u32 v20, v20, v61, v62
  v_max_u32 v20, v20, v63
  v_min_u32 v22, -2, v22
  v_cmp_eq_u32 vcc, -1, v20
  s_cbranch_vccz L_recs0_rgo
  s_add_u32 s60, s60, 1
  s_cmp_gt_u32 s60, 262144
  s_cbranch_scc1 L_fail_rec
  s_branch L_recs0_rpoll
L_recs0_max:
  v_max3_f32 v22, v20, v16, v17
  v_max3_f32 v22, v22, v18, v19
  s_nop 1
  v_max_f32_dpp v22, v22, v22 quad_perm:[2,3,0,1] row_mask:0xf bank_mask:0xf
  v_mov_b32 v23, v22
  s_nop 1
  v_permlane16_swap_b32 v22, v23
  v_max_f32 v22, v22, v23
  v_mov_b32 v23, v22
  s_nop 1
  v_permlane32_swap_b32 v22, v23
  v_max_f32 v22, v22, v23
  v_sub_f32 v28, v20, v22
  v_sub_f32 v30, v16, v22
  v_sub_f32 v31, v17, v22
  v_sub_f32 v32, v18, v22
  v_sub_f32 v33, v19, v22
  v_mul_f32 v28, s42, v28
  v_mul_f32 v30, s42, v30
  v_mul_f32 v31, s42, v31
  v_mul_f32 v32, s42, v32
  v_mul_f32 v33, s42, v33
  v_exp_f32 v28, v28
  v_exp_f32 v30, v30
  v_exp_f32 v31, v31
  v_exp_f32 v32, v32
  v_exp_f32 v33, v33
  s_nop 0
  s_branch L_recs0_maxok
L_recs0_done:
  s_waitcnt vmcnt(0)
  s_barrier
  s_endpgm
L_recs2_redo:
  s_waitcnt lgkmcnt(0)
  v_mov_b64 v[24:25], 0
  v_mov_b64 v[26:27], 0
  v_mov_b64 v[28:29], 0
  v_mov_b64 v[30:31], 0
  v_mov_b64 v[32:33], 0
  v_mov_b64 v[34:35], 0
  v_mov_b64 v[36:37], 0
  v_mov_b64 v[38:39], 0
  v_mov_b64 v[40:41], 0
  v_mov_b64 v[42:43], 0
  v_mov_b64 v[44:45], 0
  v_mov_b64 v[46:47], 0
  ds_read_b128 v[48:51], v10 offset:0
  ds_read_b128 v[52:55], v10 offset:1024
  ds_read_b128 v[56:59], v10 offset:2048
  ds_read_b128 v[60:63], v10 offset:3072
  s_waitcnt lgkmcnt(0)
  s_branch L_recs2_step
L_recs2_g5:
  s_barrier
  buffer_load_dwordx4 v1, s[4:7], s33 offen offset:0 sc1 lds
  buffer_load_dwordx4 v1, s[4:7], s33 offen offset:1024 sc1 lds
L_recs2_g:
  s_waitcnt vmcnt(0)
  ds_read_b128 v[16:19], v0
  ds_read_b128 v[20:23], v0 offset:1024
  s_waitcnt lgkmcnt(1)
  v_max3_u32 v16, v16, v17, v18
  s_waitcnt lgkmcnt(0)
  v_max3_u32 v20, v20, v21, v22
  v_max3_u32 v16, v16, v19, v23
  v_max_u32 v16, v16, v20
  v_cmp_eq_u32 vcc, -1, v16
  s_cbranch_vccnz L_recs2_gr
L_recs2_step:
  s_barrier
  ds_read_b64_tr_b16 v[16:17], v3 offset:0
  ds_read_b64_tr_b16 v[18:19], v3 offset:512
  buffer_load_dwordx4 v[72:75], v11, s[4:7], s34 offen sc1
  buffer_load_dwordx4 v[76:79], v11, s[4:7], s34 offen offset:32 sc1
  s_waitcnt lgkmcnt(0)
  v_smfmac_f32_16x16x64_bf16 v[24:27], v[16:19], a[0:7], v2
  ds_read_b64_tr_b16 v[20:21], v3 offset:1024
  v_smfmac_f32_16x16x64_bf16 v[40:43], v[16:19], v[48:55], v2
  ds_read_b64_tr_b16 v[22:23], v3 offset:1536
  v_smfmac_f32_16x16x64_bf16 v[28:31], v[16:19], a[72:79], v2
  ds_read_b128 v[48:51], v10 offset:4096
  buffer_load_dwordx4 v[68:71], v12, s[4:7], s34 offen sc1
  v_smfmac_f32_16x16x64_bf16 v[32:35], v[16:19], a[144:151], v2
  ds_read_b128 v[52:55], v10 offset:5120
  v_smfmac_f32_16x16x64_bf16 v[44:47], v[16:19], v[56:63], v2
  buffer_load_dwordx4 v[64:67], v12, s[4:7], s34 offen offset:256 sc1
  v_smfmac_f32_16x16x64_bf16 v[36:39], v[16:19], a[216:223], v2
  ds_read_b128 v[56:59], v10 offset:6144
  s_waitcnt lgkmcnt(3)
  v_smfmac_f32_16x16x64_bf16 v[24:27], v[20:23], a[8:15], v2
  ds_read_b128 v[60:63], v10 offset:7168
  ds_read_b64_tr_b16 v[16:17], v3 offset:2048
  s_waitcnt lgkmcnt(3)
  v_smfmac_f32_16x16x64_bf16 v[40:43], v[20:23], v[48:55], v2
  ds_read_b64_tr_b16 v[18:19], v3 offset:2560
  v_smfmac_f32_16x16x64_bf16 v[28:31], v[20:23], a[80:87], v2
  ds_read_b128 v[48:51], v10 offset:8192
  v_mov_b32 v0, s51
  v_smfmac_f32_16x16x64_bf16 v[32:35], v[20:23], a[152:159], v2
  ds_read_b128 v[52:55], v10 offset:9216
  s_waitcnt lgkmcnt(4)
  v_smfmac_f32_16x16x64_bf16 v[44:47], v[20:23], v[56:63], v2
  s_mov_b64 exec, 1
  buffer_store_dword v0, v1, s[4:7], s101 offen sc1
  s_mov_b64 exec, -1
  v_smfmac_f32_16x16x64_bf16 v[36:39], v[20:23], a[224:231], v2
  ds_read_b128 v[56:59], v10 offset:10240
  s_waitcnt lgkmcnt(3)
  v_smfmac_f32_16x16x64_bf16 v[24:27], v[16:19], a[16:23], v2
  ds_read_b128 v[60:63], v10 offset:11264
  ds_read_b64_tr_b16 v[20:21], v3 offset:3072
  s_waitcnt lgkmcnt(3)
  v_smfmac_f32_16x16x64_bf16 v[40:43], v[16:19], v[48:55], v2
  ds_read_b64_tr_b16 v[22:23], v3 offset:3584
  v_smfmac_f32_16x16x64_bf16 v[28:31], v[16:19], a[88:95], v2
  ds_read_b128 v[48:51], v10 offset:12288
  v_smfmac_f32_16x16x64_bf16 v[32:35], v[16:19], a[160:167], v2
  ds_read_b128 v[52:55], v10 offset:13312
  s_waitcnt lgkmcnt(4)
  v_smfmac_f32_16x16x64_bf16 v[44:47], v[16:19], v[56:63], v2
  v_smfmac_f32_16x16x64_bf16 v[36:39], v[16:19], a[232:239], v2
  ds_read_b128 v[56:59], v10 offset:14336
  s_waitcnt lgkmcnt(3)
  v_smfmac_f32_16x16x64_bf16 v[24:27], v[20:23], a[24:31], v2
  ds_read_b128 v[60:63], v10 offset:15360
  ds_read_b64_tr_b16 v[16:17], v3 offset:4096
  s_waitcnt lgkmcnt(3)
  v_smfmac_f32_16x16x64_bf16 v[40:43], v[20:23], v[48:55], v2
  ds_read_b64_tr_b16 v[18:19], v3 offset:4608
  v_smfmac_f32_16x16x64_bf16 v[28:31], v[20:23], a[96:103], v2
  ds_read_b128 v[48:51], v10 offset:16384
  v_mov_b32 v0, -1
  v_smfmac_f32_16x16x64_bf16 v[32:35], v[20:23], a[168:175], v2
  ds_read_b128 v[52:55], v10 offset:17408
  s_waitcnt lgkmcnt(4)
  v_smfmac_f32_16x16x64_bf16 v[44:47], v[20:23], v[56:63], v2
  buffer_store_dword v0, v1, s[4:7], s41 offen sc1
  v_smfmac_f32_16x16x64_bf16 v[36:39], v[20:23], a[240:247], v2
  ds_read_b128 v[56:59], v10 offset:18432
  s_waitcnt lgkmcnt(3)
  v_smfmac_f32_16x16x64_bf16 v[24:27], v[16:19], a[32:39], v2
  ds_read_b128 v[60:63], v10 offset:19456
  ds_read_b64_tr_b16 v[20:21], v3 offset:5120
  s_waitcnt lgkmcnt(3)
  v_smfmac_f32_16x16x64_bf16 v[40:43], v[16:19], v[48:55], v2
  ds_read_b64_tr_b16 v[22:23], v3 offset:5632
  v_smfmac_f32_16x16x64_bf16 v[28:31], v[16:19], a[104:111], v2
  ds_read_b128 v[48:51], v10 offset:20480
  s_add_u32 s58, s57, s52
  s_add_u32 s35, s51, 1
  v_smfmac_f32_16x16x64_bf16 v[32:35], v[16:19], a[176:183], v2
  ds_read_b128 v[52:55], v10 offset:21504
  s_waitcnt lgkmcnt(4)
  v_smfmac_f32_16x16x64_bf16 v[44:47], v[16:19], v[56:63], v2
  buffer_store_dword v0, v14, s[4:7], s99 offen sc1
  v_smfmac_f32_16x16x64_bf16 v[36:39], v[16:19], a[248:255], v2
  ds_read_b128 v[56:59], v10 offset:22528
  s_waitcnt lgkmcnt(3)
  v_smfmac_f32_16x16x64_bf16 v[24:27], v[20:23], a[40:47], v2
  ds_read_b128 v[60:63], v10 offset:23552
  ds_read_b64_tr_b16 v[16:17], v3 offset:6144
  s_waitcnt lgkmcnt(3)
  v_smfmac_f32_16x16x64_bf16 v[40:43], v[20:23], v[48:55], v2
  ds_read_b64_tr_b16 v[18:19], v3 offset:6656
  v_smfmac_f32_16x16x64_bf16 v[28:31], v[20:23], a[112:119], v2
  ds_read_b128 v[48:51], v10 offset:24576
  s_and_b32 s36, s51, 1
  s_mul_i32 s36, s36, 307200
  v_smfmac_f32_16x16x64_bf16 v[32:35], v[20:23], a[184:191], v2
  ds_read_b128 v[52:55], v10 offset:25600
  s_waitcnt lgkmcnt(4)
  v_smfmac_f32_16x16x64_bf16 v[44:47], v[20:23], v[56:63], v2
  v_smfmac_f32_16x16x64_bf16 v[36:39], v[20:23], v[80:87], v2
  ds_read_b128 v[56:59], v10 offset:26624
  s_waitcnt lgkmcnt(3)
  v_smfmac_f32_16x16x64_bf16 v[24:27], v[16:19], a[48:55], v2
  ds_read_b128 v[60:63], v10 offset:27648
  ds_read_b64_tr_b16 v[20:21], v3 offset:7168
  s_waitcnt lgkmcnt(3)
  v_smfmac_f32_16x16x64_bf16 v[40:43], v[16:19], v[48:55], v2
  ds_read_b64_tr_b16 v[22:23], v3 offset:7680
  v_smfmac_f32_16x16x64_bf16 v[28:31], v[16:19], a[120:127], v2
  ds_read_b128 v[48:51], v10 offset:28672
  s_add_u32 s55, s53, s36
  s_add_u32 s56, s54, s36
  v_smfmac_f32_16x16x64_bf16 v[32:35], v[16:19], a[192:199], v2
  ds_read_b128 v[52:55], v10 offset:29696
  s_waitcnt lgkmcnt(4)
  v_smfmac_f32_16x16x64_bf16 v[44:47], v[16:19], v[56:63], v2
  v_smfmac_f32_16x16x64_bf16 v[36:39], v[16:19], v[88:95], v2
  ds_read_b128 v[56:59], v10 offset:30720
  s_waitcnt lgkmcnt(3)
  v_smfmac_f32_16x16x64_bf16 v[24:27], v[20:23], a[56:63], v2
  ds_read_b128 v[60:63], v10 offset:31744
  ds_read_b64_tr_b16 v[16:17], v3 offset:8192
  s_waitcnt lgkmcnt(3)
  v_smfmac_f32_16x16x64_bf16 v[40:43], v[20:23], v[48:55], v2
  ds_read_b64_tr_b16 v[18:19], v3 offset:8704
  v_smfmac_f32_16x16x64_bf16 v[28:31], v[20:23], a[128:135], v2
  s_add_u32 s30, s37, s36
  v_smfmac_f32_16x16x64_bf16 v[32:35], v[20:23], a[200:207], v2
  s_waitcnt lgkmcnt(2)
  v_smfmac_f32_16x16x64_bf16 v[44:47], v[20:23], v[56:63], v2
  v_smfmac_f32_16x16x64_bf16 v[36:39], v[20:23], v[96:103], v2
  s_waitcnt lgkmcnt(0)
  v_smfmac_f32_16x16x64_bf16 v[24:27], v[16:19], a[64:71], v2
  s_waitcnt vmcnt(3)
  v_mov_b64 v[56:57], v[68:69]
  v_smfmac_f32_16x16x64_bf16 v[28:31], v[16:19], a[136:143], v2
  v_mov_b64 v[60:61], v[70:71]
  v_smfmac_f32_16x16x64_bf16 v[32:35], v[16:19], a[208:215], v2
  v_mov_b64 v[68:69], v[66:67]
  v_smfmac_f32_16x16x64_bf16 v[36:39], v[16:19], v[104:111], v2
  v_add_f32 v24, v24, v26
  v_smfmac_f32_16x16x64_bf16 v[40:43], v[16:19], v[112:119], v2
  v_add_f32 v25, v25, v27
  v_smfmac_f32_16x16x64_bf16 v[44:47], v[16:19], v[120:127], v2
  v_add_f32 v28, v28, v30
  v_add_f32 v29, v29, v31
  v_cvt_pk_bf16_f32 v24, v24, v25
  v_cvt_pk_bf16_f32 v25, v28, v29
  ds_write2_b32 v5, v24, v25 offset1:64
  ds_read_b64_tr_b16 v[28:29], v7 offset:0
  ds_read_b64_tr_b16 v[30:31], v7 offset:128
  v_pk_add_f32 v[32:33], v[32:33], v[34:35]
  v_pk_add_f32 v[36:37], v[36:37], v[38:39]
  v_cvt_pk_bf16_f32 v32, v32, v33
  v_cvt_pk_bf16_f32 v33, v36, v37
  ds_write2_b32 v5, v32, v33 offset0:128 offset1:192
  ds_read_b64_tr_b16 v[36:37], v7 offset:512
  ds_read_b64_tr_b16 v[38:39], v7 offset:640
  s_waitcnt lgkmcnt(3)
  v_mfma_f32_16x16x32_bf16 v[24:27], v[72:75], v[28:31], 0
  v_add_f32 v40, v40, v42
  v_add_f32 v41, v41, v43
  v_mfma_f32_16x16x32_bf16 v[16:19], v[76:79], v[28:31], 0
  v_add_f32 v44, v44, v46
  v_add_f32 v45, v45, v47
  s_waitcnt lgkmcnt(0)
  v_mfma_f32_16x16x32_bf16 v[20:23], v[36:39], v[28:31], 0
  v_cvt_pk_bf16_f32 v58, v40, v41
  v_cvt_pk_bf16_f32 v66, v44, v45
  v_lshrrev_b32 v47, 2, v1
  s_nop 0
  v_cndmask_b32 v24, v24, v16, s[94:95]
  v_cndmask_b32 v25, v25, v17, s[94:95]
  v_cndmask_b32 v26, v26, v18, s[94:95]
  v_cndmask_b32 v27, v27, v19, s[94:95]
  ds_write_b128 v8, v[24:27]
  v_cndmask_b32 v20, v20, v21, s[94:95]
  v_cndmask_b32 v22, v22, v23, s[94:95]
  v_cndmask_b32 v20, v20, v22, s[48:49]
  ds_write_b32 v9, v20 offset:1024
  s_mov_b64 exec, s[94:95]
  buffer_store_dwordx4 v[36:39], v6, s[4:7], s57 offen sc1
  s_mov_b64 exec, -1
  v_add_u32 v46, 158720, v1
  v_add_u32 v45, 159744, v47
  s_waitcnt lgkmcnt(0)
  s_barrier
  ds_read_b128 v[16:19], v46 offset:0
  ds_read_b32 v32, v45 offset:0
  ds_read_b128 v[20:23], v46 offset:1280
  ds_read_b32 v33, v45 offset:1280
  ds_read_b128 v[24:27], v46 offset:2560
  ds_read_b32 v34, v45 offset:2560
  ds_read_b128 v[28:31], v46 offset:3840
  ds_read_b32 v35, v45 offset:3840
  buffer_store_dword v58, v47, s[4:7], s58 offen offset:0 sc1
  buffer_store_dword v66, v47, s[4:7], s58 offen offset:256 sc1
  v_mov_b32 v59, 0
  v_mov_b64 v[62:63], v[58:59]
  v_mov_b32 v67, 0
  v_mov_b64 v[70:71], v[66:67]
  v_mov_b64 v[36:37], 0
  v_mov_b64 v[38:39], 0
  v_mov_b64 v[48:49], 0
  v_mov_b64 v[50:51], 0
  v_mov_b64 v[52:53], 0
  v_mov_b64 v[54:55], 0
  v_mov_b64 v[72:73], s[44:45]
  v_mov_b64 v[74:75], s[46:47]
  v_mov_b64 v[76:77], s[44:45]
  v_mov_b64 v[78:79], s[46:47]
  s_waitcnt lgkmcnt(4)
  v_pk_add_f32 v[16:17], v[16:17], v[20:21]
  v_pk_add_f32 v[18:19], v[18:19], v[22:23]
  s_waitcnt lgkmcnt(2)
  v_pk_add_f32 v[16:17], v[16:17], v[24:25]
  v_pk_add_f32 v[18:19], v[18:19], v[26:27]
  v_add_f32 v32, v32, v33
  v_add_f32 v32, v32, v34
  s_waitcnt lgkmcnt(0)
  v_pk_add_f32 v[16:17], v[16:17], v[28:29]
  v_pk_add_f32 v[18:19], v[18:19], v[30:31]
  v_add_f32 v20, v32, v35
  v_max3_f32 v22, |v20|, |v16|, |v17|
  v_max3_f32 v22, v22, |v18|, |v19|
  v_mul_f32 v28, s42, v20
  v_pk_mul_f32 v[30:31], v[16:17], s[42:43]
  v_pk_mul_f32 v[32:33], v[18:19], s[42:43]
  v_cmp_nle_f32 vcc, v22, s83
  v_exp_f32 v28, v28
  v_exp_f32 v30, v30
  v_exp_f32 v31, v31
  v_exp_f32 v32, v32
  v_exp_f32 v33, v33
  s_cbranch_vccnz L_recs2_max
L_recs2_maxok:
  v_cvt_pk_bf16_f32 v25, v28, v28
  v_cvt_pk_bf16_f32 v27, v28, v28
  v_cvt_pk_bf16_f32 v24, v30, v31
  v_cvt_pk_bf16_f32 v26, v32, v33
  v_mov_b64 v[28:29], 0
  v_mov_b64 v[30:31], 0
  v_smfmac_f32_16x16x64_bf16 v[36:39], v[24:27], v[72:79], v2 abid:1
  ds_read_b128 v[40:43], v10 offset:32768
  ds_read_b128 v[44:47], v10 offset:33792
  v_smfmac_f32_16x16x64_bf16 v[48:51], v[24:27], v[56:63], v2 abid:1
  ds_read_b128 v[72:75], v10 offset:34816
  ds_read_b128 v[76:79], v10 offset:35840
  v_smfmac_f32_16x16x64_bf16 v[52:55], v[24:27], v[64:71], v2 abid:1
  v_mov_b64 v[56:57], 0
  v_mov_b64 v[58:59], 0
  v_mov_b64 v[60:61], 0
  v_mov_b64 v[62:63], 0
  v_add_f32 v36, v36, v38
  v_add_f32 v37, v37, v39
  v_rcp_f32 v36, v36
  v_rcp_f32 v37, v37
  v_pk_add_f32 v[48:49], v[48:49], v[50:51]
  v_pk_add_f32 v[52:53], v[52:53], v[54:55]
  v_pk_mul_f32 v[48:49], v[48:49], v[36:37]
  v_pk_mul_f32 v[52:53], v[52:53], v[36:37]
  v_cvt_pk_bf16_f32 v16, v48, v49
  v_cvt_pk_bf16_f32 v17, v52, v53
  ds_write2_b32 v4, v16, v17 offset1:8
  v_mov_b64 v[64:65], 0
  v_mov_b64 v[66:67], 0
  v_mov_b64 v[68:69], 0
  v_mov_b64 v[70:71], 0
  v_mov_b64 v[24:25], 0
  v_mov_b64 v[26:27], 0
  v_mov_b64 v[48:49], 0
  v_mov_b64 v[50:51], 0
  v_mov_b64 v[52:53], 0
  v_mov_b64 v[54:55], 0
  v_mov_b64 v[32:33], 0
  v_mov_b64 v[34:35], 0
  s_waitcnt lgkmcnt(0)
  s_barrier
  ds_read_b64_tr_b16 v[16:17], v3 offset:9216
  ds_read_b64_tr_b16 v[18:19], v3 offset:9728
  ds_read_b64_tr_b16 v[20:21], v3 offset:10240
  ds_read_b64_tr_b16 v[22:23], v3 offset:10752
  v_lshrrev_b32 v36, 7, v1
  v_mul_u32_u24 v36, 1152, v36
  v_bfe_u32 v37, v1, 2, 5
  v_add_u32 v36, v36, v37
  s_waitcnt lgkmcnt(2)
  v_smfmac_f32_16x16x64_bf16 v[24:27], v[16:19], v[40:47], v2
  v_smfmac_f32_16x16x64_bf16 v[52:55], v[16:19], v[240:247], v2
  s_waitcnt lgkmcnt(0)
  v_smfmac_f32_16x16x64_bf16 v[24:27], v[20:23], v[72:79], v2
  v_smfmac_f32_16x16x64_bf16 v[52:55], v[20:23], v[248:255], v2
  v_smfmac_f32_16x16x64_bf16 v[28:31], v[16:19], v[128:135], v2
  v_add_f32 v24, v24, v26
  v_add_f32 v25, v25, v27
  v_smfmac_f32_16x16x64_bf16 v[28:31], v[20:23], v[136:143], v2
  v_cvt_pk_bf16_f32 v24, v24, v25
  v_smfmac_f32_16x16x64_bf16 v[32:35], v[16:19], v[144:151], v2
  s_add_u32 s50, s55, 0
  buffer_store_dword v24, v13, s[4:7], s50 offen sc1
  v_add_f32 v52, v52, v54
  v_add_f32 v53, v53, v55
  v_smfmac_f32_16x16x64_bf16 v[32:35], v[20:23], v[152:159], v2
  v_cvt_pk_bf16_f32 v52, v52, v53
  v_smfmac_f32_16x16x64_bf16 v[56:59], v[16:19], v[160:167], v2
  buffer_store_dword v52, v36, s[4:7], s56 offen sc1
  v_add_f32 v28, v28, v30
  v_add_f32 v29, v29, v31
  v_smfmac_f32_16x16x64_bf16 v[56:59], v[20:23], v[168:175], v2
  v_cvt_pk_bf16_f32 v28, v28, v29
  v_smfmac_f32_16x16x64_bf16 v[60:63], v[16:19], v[176:183], v2
  s_add_u32 s50, s55, 8448
  buffer_store_dword v28, v13, s[4:7], s50 offen sc1
  v_add_f32 v32, v32, v34
  v_add_f32 v33, v33, v35
  v_smfmac_f32_16x16x64_bf16 v[60:63], v[20:23], v[184:191], v2
  v_cvt_pk_bf16_f32 v32, v32, v33
  v_smfmac_f32_16x16x64_bf16 v[64:67], v[16:19], v[192:199], v2
  s_add_u32 s50, s55, 16896
  buffer_store_dword v32, v13, s[4:7], s50 offen sc1
  v_add_f32 v56, v56, v58
  v_add_f32 v57, v57, v59
  v_smfmac_f32_16x16x64_bf16 v[64:67], v[20:23], v[200:207], v2
  v_cvt_pk_bf16_f32 v56, v56, v57
  v_smfmac_f32_16x16x64_bf16 v[68:71], v[16:19], v[208:215], v2
  s_add_u32 s50, s55, 25344
  buffer_store_dword v56, v13, s[4:7], s50 offen sc1
  v_add_f32 v60, v60, v62
  v_add_f32 v61, v61, v63
  v_smfmac_f32_16x16x64_bf16 v[68:71], v[20:23], v[216:223], v2
  v_cvt_pk_bf16_f32 v60, v60, v61
  v_smfmac_f32_16x16x64_bf16 v[48:51], v[16:19], v[224:231], v2
  s_add_u32 s50, s55, 33792
  buffer_store_dword v60, v13, s[4:7], s50 offen sc1
  v_add_f32 v64, v64, v66
  v_add_f32 v65, v65, v67
  v_smfmac_f32_16x16x64_bf16 v[48:51], v[20:23], v[232:239], v2
  v_cvt_pk_bf16_f32 v64, v64, v65
  s_add_u32 s50, s55, 42240
  buffer_store_dword v64, v13, s[4:7], s50 offen sc1
  v_add_f32 v68, v68, v70
  v_add_f32 v69, v69, v71
  v_cvt_pk_bf16_f32 v68, v68, v69
  s_add_u32 s50, s55, 50688
  buffer_store_dword v68, v13, s[4:7], s50 offen sc1
  v_add_f32 v48, v48, v50
  v_add_f32 v49, v49, v51
  v_cvt_pk_bf16_f32 v48, v48, v49
  s_add_u32 s50, s55, 59136
  buffer_store_dword v48, v13, s[4:7], s50 offen sc1
  s_cmp_eq_u32 s51, 63
  s_cbranch_scc1 L_recs2_done
  v_cndmask_b32 v16, 0, v15, s[86:87]
  v_cndmask_b32 v17, 0, v15, s[88:89]
  v_cndmask_b32 v18, 0, v15, s[90:91]
  v_cndmask_b32 v19, 0, v15, s[92:93]
  s_and_b32 s33, s35, 3
  s_lshl_b32 s33, s33, 14
  s_add_u32 s33, s33, s32
  s_mov_b32 s41, s30
  s_barrier
L_recs2_rpoll:
  buffer_load_dwordx4 v[48:51], v1, s[4:7], s41 offen offset:0 sc1
L_recs2_rsum:
  v_mov_b64 v[24:25], 0
  v_mov_b64 v[26:27], 0
  v_mov_b64 v[28:29], 0
  v_mov_b64 v[30:31], 0
  v_mov_b64 v[32:33], 0
  v_mov_b64 v[34:35], 0
  v_mov_b64 v[36:37], 0
  v_mov_b64 v[38:39], 0
  v_mov_b64 v[40:41], 0
  v_mov_b64 v[42:43], 0
  v_mov_b64 v[44:45], 0
  v_mov_b64 v[46:47], 0
  s_waitcnt vmcnt(0)
  v_mfma_f32_16x16x32_bf16 v[20:23], v[16:19], v[48:51], 0
  s_nop 7
  v_cmp_u_f32 vcc, v20, v20
  v_add_f32_dpp v22, v20, v20 row_ror:8 row_mask:0xf bank_mask:0xf
  v_add_f32_dpp v23, v21, v21 row_ror:8 row_mask:0xf bank_mask:0xf
  s_nop 0
  v_add_f32_dpp v22, v22, v22 row_ror:4 row_mask:0xf bank_mask:0xf
  v_add_f32_dpp v23, v23, v23 row_ror:4 row_mask:0xf bank_mask:0xf
  s_nop 0
  v_add_f32_dpp v22, v22, v22 row_ror:2 row_mask:0xf bank_mask:0xf
  v_add_f32_dpp v23, v23, v23 row_ror:2 row_mask:0xf bank_mask:0xf
  v_cvt_pk_bf16_f32 v22, v22, v23
  s_cbranch_vccnz L_recs2_rB
L_recs2_rgo:
  buffer_store_dword v22, v14, s[4:7], s33 offen sc1
  s_and_b32 s99, s51, 3
  s_lshl_b32 s99, s99, 14
  s_add_u32 s99, s99, s32
  s_add_u32 s33, s33, s63
  s_mov_b32 m0, s59
  ds_read_b128 v[48:51], v10 offset:0
  ds_read_b128 v[52:55], v10 offset:1024
  ds_read_b128 v[56:59], v10 offset:2048
  ds_read_b128 v[60:63], v10 offset:3072
  s_add_u32 s51, s51, 1
  s_add_u32 s39, s39, 1
  s_add_u32 s34, s34, 24576
  s_add_u32 s57, s57, 4096
  v_add_u32 v0, s59, v1
  s_branch L_recs2_g5
L_recs2_gr:
  buffer_load_dwordx4 v1, s[4:7], s33 offen offset:0 sc1 lds
  buffer_load_dwordx4 v1, s[4:7], s33 offen offset:1024 sc1 lds
  s_add_u32 s60, s60, 1
  s_cmp_gt_u32 s60, 262144
  s_cbranch_scc1 L_fail_rec
  s_branch L_recs2_g
L_recs2_rB:
  v_max3_u32 v20, v48, v49, v50
  v_max_u32 v20, v20, v51
  v_min_u32 v22, -2, v22
  v_cmp_eq_u32 vcc, -1, v20
  s_cbranch_vccz L_recs2_rgo
  s_add_u32 s60, s60, 1
  s_cmp_gt_u32 s60, 262144
  s_cbranch_scc1 L_fail_rec
  s_branch L_recs2_rpoll
L_recs2_max:
  v_max3_f32 v22, v20, v16, v17
  v_max3_f32 v22, v22, v18, v19
  s_nop 1
  v_max_f32_dpp v22, v22, v22 quad_perm:[2,3,0,1] row_mask:0xf bank_mask:0xf
  v_mov_b32 v23, v22
  s_nop 1
  v_permlane16_swap_b32 v22, v23
  v_max_f32 v22, v22, v23
  v_mov_b32 v23, v22
  s_nop 1
  v_permlane32_swap_b32 v22, v23
  v_max_f32 v22, v22, v23
  v_sub_f32 v28, v20, v22
  v_sub_f32 v30, v16, v22
  v_sub_f32 v31, v17, v22
  v_sub_f32 v32, v18, v22
  v_sub_f32 v33, v19, v22
  v_mul_f32 v28, s42, v28
  v_mul_f32 v30, s42, v30
  v_mul_f32 v31, s42, v31
  v_mul_f32 v32, s42, v32
  v_mul_f32 v33, s42, v33
  v_exp_f32 v28, v28
  v_exp_f32 v30, v30
  v_exp_f32 v31, v31
  v_exp_f32 v32, v32
  v_exp_f32 v33, v33
  s_nop 0
  s_branch L_recs2_maxok
L_recs2_done:
  s_waitcnt vmcnt(0)
  s_barrier
  v_mov_b32 v0, 64
  s_mov_b64 exec, 1
  buffer_store_dword v0, v1, s[4:7], s101 offen sc1
  s_mov_b64 exec, -1
  s_endpgm
L_recs3_redo:
  s_waitcnt lgkmcnt(0)
  v_mov_b64 v[24:25], 0
  v_mov_b64 v[26:27], 0
  v_mov_b64 v[28:29], 0
  v_mov_b64 v[30:31], 0
  v_mov_b64 v[32:33], 0
  v_mov_b64 v[34:35], 0
  v_mov_b64 v[36:37], 0
  v_mov_b64 v[38:39], 0
  v_mov_b64 v[40:41], 0
  v_mov_b64 v[42:43], 0
  v_mov_b64 v[44:45], 0
  v_mov_b64 v[46:47], 0
  ds_read_b128 v[48:51], v10 offset:0
  ds_read_b128 v[52:55], v10 offset:1024
  ds_read_b128 v[56:59], v10 offset:2048
  ds_read_b128 v[60:63], v10 offset:3072
  s_add_u32 s35, s51, 1
  s_bitcmp1_b32 s35, 0
  s_cselect_b32 s36, s3, s2
  s_add_u32 s100, s34, 32768
  s_cmp_gt_u32 s36, s35
  s_cselect_b32 s100, s100, 0x40000000
  s_add_u32 s38, s100, 8192
  s_waitcnt lgkmcnt(0)
  s_branch L_recs3_step
L_recs3_g5:
  s_barrier
  buffer_load_dwordx4 v1, s[4:7], s33 offen offset:0 sc1 lds
  buffer_load_dwordx4 v1, s[4:7], s33 offen offset:1024 sc1 lds
  buffer_load_dwordx4 v1, s[4:7], s33 offen offset:2048 sc1 lds
  s_add_u32 s35, s51, 1
  s_bitcmp1_b32 s35, 0
  s_cselect_b32 s36, s3, s2
  s_add_u32 s100, s34, 32768
  s_cmp_gt_u32 s36, s35
  s_cselect_b32 s100, s100, 0x40000000
  s_add_u32 s38, s100, 8192
L_recs3_g:
  s_waitcnt vmcnt(0)
  ds_read_b128 v[16:19], v0
  ds_read_b128 v[20:23], v0 offset:1024
  ds_read_b128 v[64:67], v0 offset:2048
  s_waitcnt lgkmcnt(2)
  v_max3_u32 v16, v16, v17, v18
  s_waitcnt lgkmcnt(1)
  v_max3_u32 v20, v20, v21, v22
  v_max3_u32 v16, v16, v19, v23
  s_waitcnt lgkmcnt(0)
  v_max3_u32 v20, v20, v64, v65
  v_max3_u32 v16, v16, v66, v67
  v_max3_u32 v16, v16, v20, s98
  v_cmp_eq_u32 vcc, -1, v16
  s_cbranch_vccnz L_recs3_gr
L_recs3_step:
  s_barrier
  ds_read_b64_tr_b16 v[16:17], v3 offset:0
  ds_read_b64_tr_b16 v[18:19], v3 offset:512
  buffer_load_dwordx4 v[72:75], v11, s[4:7], s34 offen sc1
  buffer_load_dwordx4 v[76:79], v11, s[4:7], s34 offen offset:32 sc1
  s_waitcnt lgkmcnt(0)
  v_smfmac_f32_16x16x64_bf16 v[24:27], v[16:19], a[0:7], v2
  ds_read_b64_tr_b16 v[20:21], v3 offset:1024
  v_smfmac_f32_16x16x64_bf16 v[40:43], v[16:19], v[48:55], v2
  ds_read_b64_tr_b16 v[22:23], v3 offset:1536
  v_smfmac_f32_16x16x64_bf16 v[28:31], v[16:19], a[72:79], v2
  ds_read_b128 v[48:51], v10 offset:4096
  buffer_load_dwordx4 v[68:71], v12, s[4:7], s34 offen sc1
  v_smfmac_f32_16x16x64_bf16 v[32:35], v[16:19], a[144:151], v2
  ds_read_b128 v[52:55], v10 offset:5120
  v_smfmac_f32_16x16x64_bf16 v[44:47], v[16:19], v[56:63], v2
  buffer_load_dwordx4 v[64:67], v12, s[4:7], s34 offen offset:256 sc1
  v_smfmac_f32_16x16x64_bf16 v[36:39], v[16:19], a[216:223], v2
  ds_read_b128 v[56:59], v10 offset:6144
  s_waitcnt lgkmcnt(3)
  v_smfmac_f32_16x16x64_bf16 v[24:27], v[20:23], a[8:15], v2
  ds_read_b128 v[60:63], v10 offset:7168
  ds_read_b64_tr_b16 v[16:17], v3 offset:2048
  s_waitcnt lgkmcnt(3)
  v_smfmac_f32_16x16x64_bf16 v[40:43], v[20:23], v[48:55], v2
  ds_read_b64_tr_b16 v[18:19], v3 offset:2560
  v_smfmac_f32_16x16x64_bf16 v[28:31], v[20:23], a[80:87], v2
  ds_read_b128 v[48:51], v10 offset:8192
  buffer_load_dword v0, v14, s[4:7], s100 offen sc1
  v_smfmac_f32_16x16x64_bf16 v[32:35], v[20:23], a[152:159], v2
  ds_read_b128 v[52:55], v10 offset:9216
  s_waitcnt lgkmcnt(4)
  v_smfmac_f32_16x16x64_bf16 v[44:47], v[20:23], v[56:63], v2
  buffer_load_dword v0, v14, s[4:7], s38 offen sc1
  v_smfmac_f32_16x16x64_bf16 v[36:39], v[20:23], a[224:231], v2
  ds_read_b128 v[56:59], v10 offset:10240
  s_waitcnt lgkmcnt(3)
  v_smfmac_f32_16x16x64_bf16 v[24:27], v[16:19], a[16:23], v2
  ds_read_b128 v[60:63], v10 offset:11264
  ds_read_b64_tr_b16 v[20:21], v3 offset:3072
  s_waitcnt lgkmcnt(3)
  v_smfmac_f32_16x16x64_bf16 v[40:43], v[16:19], v[48:55], v2
  ds_read_b64_tr_b16 v[22:23], v3 offset:3584
  v_smfmac_f32_16x16x64_bf16 v[28:31], v[16:19], a[88:95], v2
  ds_read_b128 v[48:51], v10 offset:12288
  v_smfmac_f32_16x16x64_bf16 v[32:35], v[16:19], a[160:167], v2
  ds_read_b128 v[52:55], v10 offset:13312
  s_waitcnt lgkmcnt(4)
  v_smfmac_f32_16x16x64_bf16 v[44:47], v[16:19], v[56:63], v2
  v_smfmac_f32_16x16x64_bf16 v[36:39], v[16:19], a[232:239], v2
  ds_read_b128 v[56:59], v10 offset:14336
  s_waitcnt lgkmcnt(3)
  v_smfmac_f32_16x16x64_bf16 v[24:27], v[20:23], a[24:31], v2
  ds_read_b128 v[60:63], v10 offset:15360
  ds_read_b64_tr_b16 v[16:17], v3 offset:4096
  s_waitcnt lgkmcnt(3)
  v_smfmac_f32_16x16x64_bf16 v[40:43], v[20:23], v[48:55], v2
  ds_read_b64_tr_b16 v[18:19], v3 offset:4608
  v_smfmac_f32_16x16x64_bf16 v[28:31], v[20:23], a[96:103], v2
  ds_read_b128 v[48:51], v10 offset:16384
  v_smfmac_f32_16x16x64_bf16 v[32:35], v[20:23], a[168:175], v2
  ds_read_b128 v[52:55], v10 offset:17408
  s_waitcnt lgkmcnt(4)
  v_smfmac_f32_16x16x64_bf16 v[44:47], v[20:23], v[56:63], v2
  v_smfmac_f32_16x16x64_bf16 v[36:39], v[20:23], a[240:247], v2
  ds_read_b128 v[56:59], v10 offset:18432
  s_waitcnt lgkmcnt(3)
  v_smfmac_f32_16x16x64_bf16 v[24:27], v[16:19], a[32:39], v2
  ds_read_b128 v[60:63], v10 offset:19456
  ds_read_b64_tr_b16 v[20:21], v3 offset:5120
  s_waitcnt lgkmcnt(3)
  v_smfmac_f32_16x16x64_bf16 v[40:43], v[16:19], v[48:55], v2
  ds_read_b64_tr_b16 v[22:23], v3 offset:5632
  v_smfmac_f32_16x16x64_bf16 v[28:31], v[16:19], a[104:111], v2
  ds_read_b128 v[48:51], v10 offset:20480
  s_add_u32 s58, s57, s52
  s_add_u32 s35, s51, 1
  v_smfmac_f32_16x16x64_bf16 v[32:35], v[16:19], a[176:183], v2
  ds_read_b128 v[52:55], v10 offset:21504
  s_waitcnt lgkmcnt(4)
  v_smfmac_f32_16x16x64_bf16 v[44:47], v[16:19], v[56:63], v2
  v_smfmac_f32_16x16x64_bf16 v[36:39], v[16:19], a[248:255], v2
  ds_read_b128 v[56:59], v10 offset:22528
  s_waitcnt lgkmcnt(3)
  v_smfmac_f32_16x16x64_bf16 v[24:27], v[20:23], a[40:47], v2
  ds_read_b128 v[60:63], v10 offset:23552
  ds_read_b64_tr_b16 v[16:17], v3 offset:6144
  s_waitcnt lgkmcnt(3)
  v_smfmac_f32_16x16x64_bf16 v[40:43], v[20:23], v[48:55], v2
  ds_read_b64_tr_b16 v[18:19], v3 offset:6656
  v_smfmac_f32_16x16x64_bf16 v[28:31], v[20:23], a[112:119], v2
  ds_read_b128 v[48:51], v10 offset:24576
  s_and_b32 s36, s51, 1
  s_mul_i32 s36, s36, 307200
  v_smfmac_f32_16x16x64_bf16 v[32:35], v[20:23], a[184:191], v2
  ds_read_b128 v[52:55], v10 offset:25600
  s_waitcnt lgkmcnt(4)
  v_smfmac_f32_16x16x64_bf16 v[44:47], v[20:23], v[56:63], v2
  v_smfmac_f32_16x16x64_bf16 v[36:39], v[20:23], v[80:87], v2
  ds_read_b128 v[56:59], v10 offset:26624
  s_waitcnt lgkmcnt(3)
  v_smfmac_f32_16x16x64_bf16 v[24:27], v[16:19], a[48:55], v2
  ds_read_b128 v[60:63], v10 offset:27648
  ds_read_b64_tr_b16 v[20:21], v3 offset:7168
  s_waitcnt lgkmcnt(3)
  v_smfmac_f32_16x16x64_bf16 v[40:43], v[16:19], v[48:55], v2
  ds_read_b64_tr_b16 v[22:23], v3 offset:7680
  v_smfmac_f32_16x16x64_bf16 v[28:31], v[16:19], a[120:127], v2
  ds_read_b128 v[48:51], v10 offset:28672
  s_add_u32 s55, s53, s36
  s_add_u32 s56, s54, s36
  v_smfmac_f32_16x16x64_bf16 v[32:35], v[16:19], a[192:199], v2
  ds_read_b128 v[52:55], v10 offset:29696
  s_waitcnt lgkmcnt(4)
  v_smfmac_f32_16x16x64_bf16 v[44:47], v[16:19], v[56:63], v2
  v_smfmac_f32_16x16x64_bf16 v[36:39], v[16:19], v[88:95], v2
  ds_read_b128 v[56:59], v10 offset:30720
  s_waitcnt lgkmcnt(3)
  v_smfmac_f32_16x16x64_bf16 v[24:27], v[20:23], a[56:63], v2
  ds_read_b128 v[60:63], v10 offset:31744
  ds_read_b64_tr_b16 v[16:17], v3 offset:8192
  s_waitcnt lgkmcnt(3)
  v_smfmac_f32_16x16x64_bf16 v[40:43], v[20:23], v[48:55], v2
  ds_read_b64_tr_b16 v[18:19], v3 offset:8704
  v_smfmac_f32_16x16x64_bf16 v[28:31], v[20:23], a[128:135], v2
  s_add_u32 s30, s37, s36
  v_smfmac_f32_16x16x64_bf16 v[32:35], v[20:23], a[200:207], v2
  s_waitcnt lgkmcnt(2)
  v_smfmac_f32_16x16x64_bf16 v[44:47], v[20:23], v[56:63], v2
  v_smfmac_f32_16x16x64_bf16 v[36:39], v[20:23], v[96:103], v2
  s_waitcnt lgkmcnt(0)
  v_smfmac_f32_16x16x64_bf16 v[24:27], v[16:19], a[64:71], v2
  s_waitcnt vmcnt(2)
  v_mov_b64 v[56:57], v[68:69]
  v_smfmac_f32_16x16x64_bf16 v[28:31], v[16:19], a[136:143], v2
  v_mov_b64 v[60:61], v[70:71]
  v_smfmac_f32_16x16x64_bf16 v[32:35], v[16:19], a[208:215], v2
  v_mov_b64 v[68:69], v[66:67]
  v_smfmac_f32_16x16x64_bf16 v[36:39], v[16:19], v[104:111], v2
  v_add_f32 v24, v24, v26
  v_smfmac_f32_16x16x64_bf16 v[40:43], v[16:19], v[112:119], v2
  v_add_f32 v25, v25, v27
  v_smfmac_f32_16x16x64_bf16 v[44:47], v[16:19], v[120:127], v2
  v_add_f32 v28, v28, v30
  v_add_f32 v29, v29, v31
  v_cvt_pk_bf16_f32 v24, v24, v25
  v_cvt_pk_bf16_f32 v25, v28, v29
  ds_write2_b32 v5, v24, v25 offset1:64
  ds_read_b64_tr_b16 v[28:29], v7 offset:0
  ds_read_b64_tr_b16 v[30:31], v7 offset:128
  v_pk_add_f32 v[32:33], v[32:33], v[34:35]
  v_pk_add_f32 v[36:37], v[36:37], v[38:39]
  v_cvt_pk_bf16_f32 v32, v32, v33
  v_cvt_pk_bf16_f32 v33, v36, v37
  ds_write2_b32 v5, v32, v33 offset0:128 offset1:192
  ds_read_b64_tr_b16 v[36:37], v7 offset:512
  ds_read_b64_tr_b16 v[38:39], v7 offset:640
  s_waitcnt lgkmcnt(3)
  v_mfma_f32_16x16x32_bf16 v[24:27], v[72:75], v[28:31], 0
  v_add_f32 v40, v40, v42
  v_add_f32 v41, v41, v43
  v_mfma_f32_16x16x32_bf16 v[16:19], v[76:79], v[28:31], 0
  v_add_f32 v44, v44, v46
  v_add_f32 v45, v45, v47
  s_waitcnt lgkmcnt(0)
  v_mfma_f32_16x16x32_bf16 v[20:23], v[36:39], v[28:31], 0
  v_cvt_pk_bf16_f32 v58, v40, v41
  v_cvt_pk_bf16_f32 v66, v44, v45
  v_lshrrev_b32 v47, 2, v1
  s_nop 0
  v_cndmask_b32 v24, v24, v16, s[94:95]
  v_cndmask_b32 v25, v25, v17, s[94:95]
  v_cndmask_b32 v26, v26, v18, s[94:95]
  v_cndmask_b32 v27, v27, v19, s[94:95]
  ds_write_b128 v8, v[24:27]
  v_cndmask_b32 v20, v20, v21, s[94:95]
  v_cndmask_b32 v22, v22, v23, s[94:95]
  v_cndmask_b32 v20, v20, v22, s[48:49]
  ds_write_b32 v9, v20 offset:1024
  s_mov_b64 exec, s[94:95]
  buffer_store_dwordx4 v[36:39], v6, s[4:7], s57 offen sc1
  s_mov_b64 exec, -1
  v_add_u32 v46, 158720, v1
  v_add_u32 v45, 159744, v47
  s_waitcnt lgkmcnt(0)
  s_barrier
  ds_read_b128 v[16:19], v46 offset:0
  ds_read_b32 v32, v45 offset:0
  ds_read_b128 v[20:23], v46 offset:1280
  ds_read_b32 v33, v45 offset:1280
  ds_read_b128 v[24:27], v46 offset:2560
  ds_read_b32 v34, v45 offset:2560
  ds_read_b128 v[28:31], v46 offset:3840
  ds_read_b32 v35, v45 offset:3840
  buffer_store_dword v58, v47, s[4:7], s58 offen offset:0 sc1
  buffer_store_dword v66, v47, s[4:7], s58 offen offset:256 sc1
  v_mov_b32 v59, 0
  v_mov_b64 v[62:63], v[58:59]
  v_mov_b32 v67, 0
  v_mov_b64 v[70:71], v[66:67]
  v_mov_b64 v[36:37], 0
  v_mov_b64 v[38:39], 0
  v_mov_b64 v[48:49], 0
  v_mov_b64 v[50:51], 0
  v_mov_b64 v[52:53], 0
  v_mov_b64 v[54:55], 0
  v_mov_b64 v[72:73], s[44:45]
  v_mov_b64 v[74:75], s[46:47]
  v_mov_b64 v[76:77], s[44:45]
  v_mov_b64 v[78:79], s[46:47]
  s_waitcnt lgkmcnt(4)
  v_pk_add_f32 v[16:17], v[16:17], v[20:21]
  v_pk_add_f32 v[18:19], v[18:19], v[22:23]
  s_waitcnt lgkmcnt(2)
  v_pk_add_f32 v[16:17], v[16:17], v[24:25]
  v_pk_add_f32 v[18:19], v[18:19], v[26:27]
  v_add_f32 v32, v32, v33
  v_add_f32 v32, v32, v34
  s_waitcnt lgkmcnt(0)
  v_pk_add_f32 v[16:17], v[16:17], v[28:29]
  v_pk_add_f32 v[18:19], v[18:19], v[30:31]
  v_add_f32 v20, v32, v35
  v_max3_f32 v22, |v20|, |v16|, |v17|
  v_max3_f32 v22, v22, |v18|, |v19|
  v_mul_f32 v28, s42, v20
  v_pk_mul_f32 v[30:31], v[16:17], s[42:43]
  v_pk_mul_f32 v[32:33], v[18:19], s[42:43]
  v_cmp_nle_f32 vcc, v22, s83
  v_exp_f32 v28, v28
  v_exp_f32 v30, v30
  v_exp_f32 v31, v31
  v_exp_f32 v32, v32
  v_exp_f32 v33, v33
  s_cbranch_vccnz L_recs3_max
L_recs3_maxok:
  v_cvt_pk_bf16_f32 v25, v28, v28
  v_cvt_pk_bf16_f32 v27, v28, v28
  v_cvt_pk_bf16_f32 v24, v30, v31
  v_cvt_pk_bf16_f32 v26, v32, v33
  v_mov_b64 v[28:29], 0
  v_mov_b64 v[30:31], 0
  v_smfmac_f32_16x16x64_bf16 v[36:39], v[24:27], v[72:79], v2 abid:1
  ds_read_b128 v[40:43], v10 offset:32768
  ds_read_b128 v[44:47], v10 offset:33792
  v_smfmac_f32_16x16x64_bf16 v[48:51], v[24:27], v[56:63], v2 abid:1
  ds_read_b128 v[72:75], v10 offset:34816
  ds_read_b128 v[76:79], v10 offset:35840
  v_smfmac_f32_16x16x64_bf16 v[52:55], v[24:27], v[64:71], v2 abid:1
  v_mov_b64 v[56:57], 0
  v_mov_b64 v[58:59], 0
  v_mov_b64 v[60:61], 0
  v_mov_b64 v[62:63], 0
  v_add_f32 v36, v36, v38
  v_add_f32 v37, v37, v39
  v_rcp_f32 v36, v36
  v_rcp_f32 v37, v37
  v_pk_add_f32 v[48:49], v[48:49], v[50:51]
  v_pk_add_f32 v[52:53], v[52:53], v[54:55]
  v_pk_mul_f32 v[48:49], v[48:49], v[36:37]
  v_pk_mul_f32 v[52:53], v[52:53], v[36:37]
  v_cvt_pk_bf16_f32 v16, v48, v49
  v_cvt_pk_bf16_f32 v17, v52, v53
  ds_write2_b32 v4, v16, v17 offset1:8
  v_mov_b64 v[64:65], 0
  v_mov_b64 v[66:67], 0
  v_mov_b64 v[68:69], 0
  v_mov_b64 v[70:71], 0
  v_mov_b64 v[24:25], 0
  v_mov_b64 v[26:27], 0
  v_mov_b64 v[48:49], 0
  v_mov_b64 v[50:51], 0
  v_mov_b64 v[52:53], 0
  v_mov_b64 v[54:55], 0
  v_mov_b64 v[32:33], 0
  v_mov_b64 v[34:35], 0
  s_waitcnt lgkmcnt(0)
  s_barrier
  ds_read_b64_tr_b16 v[16:17], v3 offset:9216
  ds_read_b64_tr_b16 v[18:19], v3 offset:9728
  ds_read_b64_tr_b16 v[20:21], v3 offset:10240
  ds_read_b64_tr_b16 v[22:23], v3 offset:10752
  v_lshrrev_b32 v36, 7, v1
  v_mul_u32_u24 v36, 1152, v36
  v_bfe_u32 v37, v1, 2, 5
  v_add_u32 v36, v36, v37
  v_mov_b32 v38, -1
  s_waitcnt lgkmcnt(2)
  v_smfmac_f32_16x16x64_bf16 v[24:27], v[16:19], v[40:47], v2
  v_smfmac_f32_16x16x64_bf16 v[52:55], v[16:19], v[240:247], v2
  s_waitcnt lgkmcnt(0)
  v_smfmac_f32_16x16x64_bf16 v[24:27], v[20:23], v[72:79], v2
  v_smfmac_f32_16x16x64_bf16 v[52:55], v[20:23], v[248:255], v2
  v_smfmac_f32_16x16x64_bf16 v[28:31], v[16:19], v[128:135], v2
  v_add_f32 v24, v24, v26
  v_add_f32 v25, v25, v27
  v_smfmac_f32_16x16x64_bf16 v[28:31], v[20:23], v[136:143], v2
  v_cvt_pk_bf16_f32 v24, v24, v25
  v_smfmac_f32_16x16x64_bf16 v[32:35], v[16:19], v[144:151], v2
  s_add_u32 s50, s55, 0
  buffer_store_dword v24, v13, s[4:7], s50 offen sc1
  v_add_f32 v52, v52, v54
  v_add_f32 v53, v53, v55
  v_smfmac_f32_16x16x64_bf16 v[32:35], v[20:23], v[152:159], v2
  v_cvt_pk_bf16_f32 v52, v52, v53
  v_smfmac_f32_16x16x64_bf16 v[56:59], v[16:19], v[160:167], v2
  buffer_store_dword v52, v36, s[4:7], s56 offen sc1
  v_add_f32 v28, v28, v30
  v_add_f32 v29, v29, v31
  v_smfmac_f32_16x16x64_bf16 v[56:59], v[20:23], v[168:175], v2
  v_cvt_pk_bf16_f32 v28, v28, v29
  v_smfmac_f32_16x16x64_bf16 v[60:63], v[16:19], v[176:183], v2
  s_add_u32 s50, s55, 8448
  buffer_store_dword v28, v13, s[4:7], s50 offen sc1
  v_add_f32 v32, v32, v34
  v_add_f32 v33, v33, v35
  v_smfmac_f32_16x16x64_bf16 v[60:63], v[20:23], v[184:191], v2
  v_cvt_pk_bf16_f32 v32, v32, v33
  v_smfmac_f32_16x16x64_bf16 v[64:67], v[16:19], v[192:199], v2
  s_add_u32 s50, s55, 16896
  buffer_store_dword v32, v13, s[4:7], s50 offen sc1
  v_add_f32 v56, v56, v58
  v_add_f32 v57, v57, v59
  v_smfmac_f32_16x16x64_bf16 v[64:67], v[20:23], v[200:207], v2
  buffer_load_dwordx2 v[38:39], v1, s[4:7], s30 offen sc1
  v_cvt_pk_bf16_f32 v56, v56, v57
  v_smfmac_f32_16x16x64_bf16 v[68:71], v[16:19], v[208:215], v2
  s_add_u32 s50, s55, 25344
  buffer_store_dword v56, v13, s[4:7], s50 offen sc1
  v_add_f32 v60, v60, v62
  v_add_f32 v61, v61, v63
  v_smfmac_f32_16x16x64_bf16 v[68:71], v[20:23], v[216:223], v2
  buffer_load_dwordx2 v[38:39], v1, s[4:7], s30 offen sc1
  v_cvt_pk_bf16_f32 v60, v60, v61
  v_smfmac_f32_16x16x64_bf16 v[48:51], v[16:19], v[224:231], v2
  s_add_u32 s50, s55, 33792
  buffer_store_dword v60, v13, s[4:7], s50 offen sc1
  v_add_f32 v64, v64, v66
  v_add_f32 v65, v65, v67
  v_smfmac_f32_16x16x64_bf16 v[48:51], v[20:23], v[232:239], v2
  buffer_load_dwordx2 v[38:39], v1, s[4:7], s30 offen sc1
  v_cvt_pk_bf16_f32 v64, v64, v65
  s_add_u32 s50, s55, 42240
  buffer_store_dword v64, v13, s[4:7], s50 offen sc1
  v_add_f32 v68, v68, v70
  v_add_f32 v69, v69, v71
  v_cvt_pk_bf16_f32 v68, v68, v69
  s_add_u32 s50, s55, 50688
  buffer_store_dword v68, v13, s[4:7], s50 offen sc1
  v_add_f32 v48, v48, v50
  v_add_f32 v49, v49, v51
  v_cvt_pk_bf16_f32 v48, v48, v49
  s_add_u32 s50, s55, 59136
  buffer_store_dword v48, v13, s[4:7], s50 offen sc1
  s_cmp_eq_u32 s51, 63
  s_cbranch_scc1 L_recs3_done
  s_load_dword s86, s[84:85], 0 glc
  s_load_dword s87, s[84:85], 128 glc
  s_load_dword s88, s[84:85], 256 glc
  s_load_dword s89, s[84:85], 384 glc
  s_load_dword s90, s[84:85], 16384 glc
  s_load_dword s91, s[84:85], 16512 glc
  s_load_dword s92, s[84:85], 16640 glc
  s_load_dword s93, s[84:85], 16768 glc
L_recs3_pA:
  v_cmp_eq_u32 vcc, -1, v38
  buffer_load_dwordx2 v[38:39], v1, s[4:7], s30 offen sc1
  s_add_u32 s60, s60, 1
  s_cmp_gt_u32 s60, 262144
  s_cselect_b64 s[96:97], 0, -1
  s_waitcnt vmcnt(10)
  s_and_b64 vcc, vcc, s[96:97]
  s_cbranch_scc1 L_recs3_pA
  s_barrier
  s_and_b32 s33, s35, 3
  s_lshl_b32 s33, s33, 14
  s_add_u32 s33, s33, s32
  s_add_u32 s51, s51, 1
  s_add_u32 s39, s39, 1
  s_add_u32 s34, s34, 24576
  s_add_u32 s57, s57, 4096
  s_add_u32 s33, s33, s63
  s_mov_b32 m0, s59
  ds_read_b128 v[48:51], v10 offset:0
  ds_read_b128 v[52:55], v10 offset:1024
  ds_read_b128 v[56:59], v10 offset:2048
  ds_read_b128 v[60:63], v10 offset:3072
  v_mov_b64 v[24:25], 0
  v_mov_b64 v[26:27], 0
  v_mov_b64 v[28:29], 0
  v_mov_b64 v[30:31], 0
  v_mov_b64 v[32:33], 0
  v_mov_b64 v[34:35], 0
  v_mov_b64 v[36:37], 0
  v_mov_b64 v[40:41], 0
  v_mov_b64 v[42:43], 0
  v_mov_b64 v[44:45], 0
  v_mov_b64 v[46:47], 0
  s_waitcnt vmcnt(0)
  v_mov_b64 v[38:39], 0
  v_add_u32 v0, s59, v1
  s_sleep 5
  s_waitcnt lgkmcnt(0)
  s_min_u32 s2, s86, s87
  s_min_u32 s88, s88, s89
  s_min_u32 s2, s2, s88
  s_min_u32 s3, s90, s91
  s_min_u32 s92, s92, s93
  s_min_u32 s3, s3, s92
  s_bitcmp1_b32 s35, 0
  s_cselect_b32 s38, s3, s2
  s_cmp_le_u32 s38, s35
  s_cselect_b32 s98, -1, 0
  s_branch L_recs3_g5
L_recs3_gr:
  buffer_load_dwordx4 v1, s[4:7], s33 offen offset:0 sc1 lds
  buffer_load_dwordx4 v1, s[4:7], s33 offen offset:1024 sc1 lds
  buffer_load_dwordx4 v1, s[4:7], s33 offen offset:2048 sc1 lds
  s_add_u32 s60, s60, 1
  s_cmp_gt_u32 s60, 262144
  s_cbranch_scc1 L_fail_rec
  s_cmp_eq_u32 s98, 0
  s_cbranch_scc1 L_recs3_g
  s_and_b32 s36, s51, 1
  s_lshl_b32 s36, s36, 14
  s_add_u32 s36, s36, s62
  v_lshlrev_b32 v16, 3, v1
Lwf_13:
  s_mov_b64 exec, 15
  buffer_load_dword v17, v16, s[4:7], s36 offen sc1
  s_waitcnt vmcnt(0)
  v_cmp_ge_u32 vcc, s51, v17
  s_mov_b64 exec, -1
  s_cbranch_vccz Lwfok_14
  s_add_u32 s60, s60, 1
  s_cmp_gt_u32 s60, 262144
  s_cbranch_scc1 L_fail_rec
  s_branch Lwf_13
Lwfok_14:
  s_mov_b32 s98, 0
  s_branch L_recs3_g
L_recs3_max:
  v_max3_f32 v22, v20, v16, v17
  v_max3_f32 v22, v22, v18, v19
  s_nop 1
  v_max_f32_dpp v22, v22, v22 quad_perm:[2,3,0,1] row_mask:0xf bank_mask:0xf
  v_mov_b32 v23, v22
  s_nop 1
  v_permlane16_swap_b32 v22, v23
  v_max_f32 v22, v22, v23
  v_mov_b32 v23, v22
  s_nop 1
  v_permlane32_swap_b32 v22, v23
  v_max_f32 v22, v22, v23
  v_sub_f32 v28, v20, v22
  v_sub_f32 v30, v16, v22
  v_sub_f32 v31, v17, v22
  v_sub_f32 v32, v18, v22
  v_sub_f32 v33, v19, v22
  v_mul_f32 v28, s42, v28
  v_mul_f32 v30, s42, v30
  v_mul_f32 v31, s42, v31
  v_mul_f32 v32, s42, v32
  v_mul_f32 v33, s42, v33
  v_exp_f32 v28, v28
  v_exp_f32 v30, v30
  v_exp_f32 v31, v31
  v_exp_f32 v32, v32
  v_exp_f32 v33, v33
  s_nop 0
  s_branch L_recs3_maxok
L_recs3_done:
  s_waitcnt vmcnt(0)
  s_barrier
  s_endpgm
L_fail_rec:
  s_mov_b64 exec, 1
  v_mov_b32 v0, 92
  v_mov_b32 v1, 1
  buffer_atomic_add v1, v0, s[20:23], 0 offen
  s_endpgm
L_qkv:
  s_waitcnt vmcnt(0)
  s_barrier
  s_cmp_lg_u32 s24, 0
  s_cbranch_scc1 Lsi_15
  s_mov_b64 exec, 1
  v_mov_b32 v1, 128
  v_mov_b32 v2, 1
  buffer_atomic_add v2, v1, s[20:23], 0 offen
  s_mov_b64 exec, -1
Lsi_15:
  v_lshrrev_b32 v8, 2, v0
  v_mul_u32_u24 v10, 8192, v8
  v_and_b32 v9, 3, v0
  v_lshl_add_u32 v10, v9, 4, v10
  s_mov_b32 s8, s68
  s_and_b32 s9, s69, 0xffff
  s_mov_b32 s10, 0x480000
  s_mov_b32 s11, 0x20000
  s_mov_b32 s12, s70
  s_and_b32 s13, s71, 0xffff
  s_mov_b32 s14, 0x480000
  s_mov_b32 s15, 0x20000
  s_mov_b32 s16, s72
  s_and_b32 s17, s73, 0xffff
  s_mov_b32 s18, 0x480000
  s_mov_b32 s19, 0x20000
  s_lshl_b32 s33, s29, 8
  s_lshl_b32 s34, s24, 6
  s_add_u32 s33, s33, s34
  v_add_u32 v10, s33, v10
  s_mul_i32 s35, s24, 40960
  v_lshrrev_b32 v11, 5, v0
  v_lshlrev_b32 v11, 9, v11
  v_and_b32 v8, 3, v8
  v_lshl_add_u32 v11, v8, 6, v11
  v_bfe_u32 v8, v0, 4, 1
  v_lshl_add_u32 v11, v8, 5, v11
  v_lshl_add_u32 v11, v9, 3, v11
  v_add_u32 v11, s35, v11
  s_barrier
  s_add_u32 m0, s35, 0
  s_mov_b32 s36, 0
  buffer_load_dwordx4 v10, s[8:11], s36 offen lds
  s_barrier
  s_add_u32 m0, s35, 1024
  s_mov_b32 s36, 0
  buffer_load_dwordx4 v10, s[12:15], s36 offen lds
  s_barrier
  s_add_u32 m0, s35, 2048
  s_mov_b32 s36, 0
  buffer_load_dwordx4 v10, s[16:19], s36 offen lds
  s_barrier
  s_add_u32 m0, s35, 3072
  s_mov_b32 s36, 131072
  buffer_load_dwordx4 v10, s[8:11], s36 offen lds
  s_barrier
  s_add_u32 m0, s35, 4096
  s_mov_b32 s36, 131072
  buffer_load_dwordx4 v10, s[12:15], s36 offen lds
  s_barrier
  s_add_u32 m0, s35, 5120
  s_mov_b32 s36, 131072
  buffer_load_dwordx4 v10, s[16:19], s36 offen lds
  s_barrier
  s_add_u32 m0, s35, 6144
  s_mov_b32 s36, 262144
  buffer_load_dwordx4 v10, s[8:11], s36 offen lds
  s_barrier
  s_add_u32 m0, s35, 7168
  s_mov_b32 s36, 262144
  buffer_load_dwordx4 v10, s[12:15], s36 offen lds
  s_barrier
  s_add_u32 m0, s35, 8192
  s_mov_b32 s36, 262144
  buffer_load_dwordx4 v10, s[16:19], s36 offen lds
  s_barrier
  s_add_u32 m0, s35, 9216
  s_mov_b32 s36, 393216
  buffer_load_dwordx4 v10, s[8:11], s36 offen lds
  s_barrier
  s_add_u32 m0, s35, 10240
  s_mov_b32 s36, 393216
  buffer_load_dwordx4 v10, s[12:15], s36 offen lds
  s_barrier
  s_add_u32 m0, s35, 11264
  s_mov_b32 s36, 393216
  buffer_load_dwordx4 v10, s[16:19], s36 offen lds
  s_barrier
  s_add_u32 m0, s35, 12288
  s_mov_b32 s36, 524288
  buffer_load_dwordx4 v10, s[8:11], s36 offen lds
  s_barrier
  s_add_u32 m0, s35, 13312
  s_mov_b32 s36, 524288
  buffer_load_dwordx4 v10, s[12:15], s36 offen lds
  s_barrier
  s_add_u32 m0, s35, 14336
  s_mov_b32 s36, 524288
  buffer_load_dwordx4 v10, s[16:19], s36 offen lds
  s_barrier
  s_add_u32 m0, s35, 15360
  s_mov_b32 s36, 655360
  buffer_load_dwordx4 v10, s[8:11], s36 offen lds
  s_barrier
  s_add_u32 m0, s35, 16384
  s_mov_b32 s36, 655360
  buffer_load_dwordx4 v10, s[12:15], s36 offen lds
  s_barrier
  s_add_u32 m0, s35, 17408
  s_mov_b32 s36, 655360
  buffer_load_dwordx4 v10, s[16:19], s36 offen lds
  s_barrier
  s_add_u32 m0, s35, 18432
  s_mov_b32 s36, 786432
  buffer_load_dwordx4 v10, s[8:11], s36 offen lds
  s_barrier
  s_add_u32 m0, s35, 19456
  s_mov_b32 s36, 786432
  buffer_load_dwordx4 v10, s[12:15], s36 offen lds
  s_barrier
  s_add_u32 m0, s35, 20480
  s_mov_b32 s36, 786432
  buffer_load_dwordx4 v10, s[16:19], s36 offen lds
  s_barrier
  s_add_u32 m0, s35, 21504
  s_mov_b32 s36, 917504
  buffer_load_dwordx4 v10, s[8:11], s36 offen lds
  s_barrier
  s_add_u32 m0, s35, 22528
  s_mov_b32 s36, 917504
  buffer_load_dwordx4 v10, s[12:15], s36 offen lds
  s_barrier
  s_add_u32 m0, s35, 23552
  s_mov_b32 s36, 917504
  buffer_load_dwordx4 v10, s[16:19], s36 offen lds
  s_barrier
  s_add_u32 m0, s35, 24576
  s_mov_b32 s36, 1048576
  buffer_load_dwordx4 v10, s[8:11], s36 offen lds
  s_barrier
  s_add_u32 m0, s35, 25600
  s_mov_b32 s36, 1048576
  buffer_load_dwordx4 v10, s[12:15], s36 offen lds
  s_barrier
  s_add_u32 m0, s35, 26624
  s_mov_b32 s36, 1048576
  buffer_load_dwordx4 v10, s[16:19], s36 offen lds
  s_barrier
  s_add_u32 m0, s35, 27648
  s_mov_b32 s36, 1179648
  buffer_load_dwordx4 v10, s[8:11], s36 offen lds
  s_barrier
  s_add_u32 m0, s35, 28672
  s_mov_b32 s36, 1179648
  buffer_load_dwordx4 v10, s[12:15], s36 offen lds
  s_barrier
  s_add_u32 m0, s35, 29696
  s_mov_b32 s36, 1179648
  buffer_load_dwordx4 v10, s[16:19], s36 offen lds
  s_barrier
  s_add_u32 m0, s35, 30720
  s_mov_b32 s36, 1310720
  buffer_load_dwordx4 v10, s[8:11], s36 offen lds
  s_barrier
  s_add_u32 m0, s35, 31744
  s_mov_b32 s36, 1310720
  buffer_load_dwordx4 v10, s[12:15], s36 offen lds
  s_waitcnt vmcnt(31)
  ds_read_b64_tr_b16 a[0:1], v11 offset:0
  ds_read_b64_tr_b16 a[2:3], v11 offset:256
  s_waitcnt lgkmcnt(8)
  s_barrier
  s_add_u32 m0, s35, 32768
  s_mov_b32 s36, 1310720
  buffer_load_dwordx4 v10, s[16:19], s36 offen lds
  s_waitcnt vmcnt(31)
  ds_read_b64_tr_b16 a[144:145], v11 offset:1024
  ds_read_b64_tr_b16 a[146:147], v11 offset:1280
  s_waitcnt lgkmcnt(8)
  s_barrier
  s_add_u32 m0, s35, 33792
  s_mov_b32 s36, 1441792
  buffer_load_dwordx4 v10, s[8:11], s36 offen lds
  s_waitcnt vmcnt(31)
  ds_read_b64_tr_b16 v[112:113], v11 offset:2048
  ds_read_b64_tr_b16 v[114:115], v11 offset:2304
  s_waitcnt lgkmcnt(8)
  s_barrier
  s_add_u32 m0, s35, 34816
  s_mov_b32 s36, 1441792
  buffer_load_dwordx4 v10, s[12:15], s36 offen lds
  s_waitcnt vmcnt(31)
  ds_read_b64_tr_b16 a[4:5], v11 offset:3072
  ds_read_b64_tr_b16 a[6:7], v11 offset:3328
  s_waitcnt lgkmcnt(8)
  s_barrier
  s_add_u32 m0, s35, 35840
  s_mov_b32 s36, 1441792
  buffer_load_dwordx4 v10, s[16:19], s36 offen lds
  s_waitcnt vmcnt(31)
  ds_read_b64_tr_b16 a[148:149], v11 offset:4096
  ds_read_b64_tr_b16 a[150:151], v11 offset:4352
  s_waitcnt lgkmcnt(8)
  s_barrier
  s_add_u32 m0, s35, 36864
  s_mov_b32 s36, 1572864
  buffer_load_dwordx4 v10, s[8:11], s36 offen lds
  s_waitcnt vmcnt(31)
  ds_read_b64_tr_b16 v[116:117], v11 offset:5120
  ds_read_b64_tr_b16 v[118:119], v11 offset:5376
  s_waitcnt lgkmcnt(8)
  s_barrier
  s_add_u32 m0, s35, 37888
  s_mov_b32 s36, 1572864
  buffer_load_dwordx4 v10, s[12:15], s36 offen lds
  s_waitcnt vmcnt(31)
  ds_read_b64_tr_b16 a[8:9], v11 offset:6144
  ds_read_b64_tr_b16 a[10:11], v11 offset:6400
  s_waitcnt lgkmcnt(8)
  s_barrier
  s_add_u32 m0, s35, 38912
  s_mov_b32 s36, 1572864
  buffer_load_dwordx4 v10, s[16:19], s36 offen lds
  s_waitcnt vmcnt(31)
  ds_read_b64_tr_b16 a[152:153], v11 offset:7168
  ds_read_b64_tr_b16 a[154:155], v11 offset:7424
  s_waitcnt lgkmcnt(8)
  s_barrier
  s_add_u32 m0, s35, 39936
  s_mov_b32 s36, 1703936
  buffer_load_dwordx4 v10, s[8:11], s36 offen lds
  s_waitcnt vmcnt(31)
  ds_read_b64_tr_b16 v[120:121], v11 offset:8192
  ds_read_b64_tr_b16 v[122:123], v11 offset:8448
  s_waitcnt lgkmcnt(8)
  s_barrier
  s_add_u32 m0, s35, 0
  s_mov_b32 s36, 1703936
  buffer_load_dwordx4 v10, s[12:15], s36 offen lds
  s_waitcnt vmcnt(31)
  ds_read_b64_tr_b16 a[12:13], v11 offset:9216
  ds_read_b64_tr_b16 a[14:15], v11 offset:9472
  s_waitcnt lgkmcnt(8)
  s_barrier
  s_add_u32 m0, s35, 1024
  s_mov_b32 s36, 1703936
  buffer_load_dwordx4 v10, s[16:19], s36 offen lds
  s_waitcnt vmcnt(31)
  ds_read_b64_tr_b16 a[156:157], v11 offset:10240
  ds_read_b64_tr_b16 a[158:159], v11 offset:10496
  s_waitcnt lgkmcnt(8)
  s_barrier
  s_add_u32 m0, s35, 2048
  s_mov_b32 s36, 1835008
  buffer_load_dwordx4 v10, s[8:11], s36 offen lds
  s_waitcnt vmcnt(31)
  ds_read_b64_tr_b16 v[124:125], v11 offset:11264
  ds_read_b64_tr_b16 v[126:127], v11 offset:11520
  s_waitcnt lgkmcnt(8)
  s_barrier
  s_add_u32 m0, s35, 3072
  s_mov_b32 s36, 1835008
  buffer_load_dwordx4 v10, s[12:15], s36 offen lds
  s_waitcnt vmcnt(31)
  ds_read_b64_tr_b16 a[16:17], v11 offset:12288
  ds_read_b64_tr_b16 a[18:19], v11 offset:12544
  s_waitcnt lgkmcnt(8)
  s_barrier
  s_add_u32 m0, s35, 4096
  s_mov_b32 s36, 1835008
  buffer_load_dwordx4 v10, s[16:19], s36 offen lds
  s_waitcnt vmcnt(31)
  ds_read_b64_tr_b16 a[160:161], v11 offset:13312
  ds_read_b64_tr_b16 a[162:163], v11 offset:13568
  s_waitcnt lgkmcnt(8)
  s_barrier
  s_add_u32 m0, s35, 5120
  s_mov_b32 s36, 1966080
  buffer_load_dwordx4 v10, s[8:11], s36 offen lds
  s_waitcnt vmcnt(31)
  ds_read_b64_tr_b16 v[128:129], v11 offset:14336
  ds_read_b64_tr_b16 v[130:131], v11 offset:14592
  s_waitcnt lgkmcnt(8)
  s_barrier
  s_add_u32 m0, s35, 6144
  s_mov_b32 s36, 1966080
  buffer_load_dwordx4 v10, s[12:15], s36 offen lds
  s_waitcnt vmcnt(31)
  ds_read_b64_tr_b16 a[20:21], v11 offset:15360
  ds_read_b64_tr_b16 a[22:23], v11 offset:15616
  s_waitcnt lgkmcnt(8)
  s_barrier
  s_add_u32 m0, s35, 7168
  s_mov_b32 s36, 1966080
  buffer_load_dwordx4 v10, s[16:19], s36 offen lds
  s_waitcnt vmcnt(31)
  ds_read_b64_tr_b16 a[164:165], v11 offset:16384
  ds_read_b64_tr_b16 a[166:167], v11 offset:16640
  s_waitcnt lgkmcnt(8)
  s_barrier
  s_add_u32 m0, s35, 8192
  s_mov_b32 s36, 2097152
  buffer_load_dwordx4 v10, s[8:11], s36 offen lds
  s_waitcnt vmcnt(31)
  ds_read_b64_tr_b16 v[132:133], v11 offset:17408
  ds_read_b64_tr_b16 v[134:135], v11 offset:17664
  s_waitcnt lgkmcnt(8)
  s_barrier
  s_add_u32 m0, s35, 9216
  s_mov_b32 s36, 2097152
  buffer_load_dwordx4 v10, s[12:15], s36 offen lds
  s_waitcnt vmcnt(31)
  ds_read_b64_tr_b16 a[24:25], v11 offset:18432
  ds_read_b64_tr_b16 a[26:27], v11 offset:18688
  s_waitcnt lgkmcnt(8)
  s_barrier
  s_add_u32 m0, s35, 10240
  s_mov_b32 s36, 2097152
  buffer_load_dwordx4 v10, s[16:19], s36 offen lds
  s_waitcnt vmcnt(31)
  ds_read_b64_tr_b16 a[168:169], v11 offset:19456
  ds_read_b64_tr_b16 a[170:171], v11 offset:19712
  s_waitcnt lgkmcnt(8)
  s_barrier
  s_add_u32 m0, s35, 11264
  s_mov_b32 s36, 2228224
  buffer_load_dwordx4 v10, s[8:11], s36 offen lds
  s_waitcnt vmcnt(31)
  ds_read_b64_tr_b16 v[136:137], v11 offset:20480
  ds_read_b64_tr_b16 v[138:139], v11 offset:20736
  s_waitcnt lgkmcnt(8)
  s_barrier
  s_add_u32 m0, s35, 12288
  s_mov_b32 s36, 2228224
  buffer_load_dwordx4 v10, s[12:15], s36 offen lds
  s_waitcnt vmcnt(31)
  ds_read_b64_tr_b16 a[28:29], v11 offset:21504
  ds_read_b64_tr_b16 a[30:31], v11 offset:21760
  s_waitcnt lgkmcnt(8)
  s_barrier
  s_add_u32 m0, s35, 13312
  s_mov_b32 s36, 2228224
  buffer_load_dwordx4 v10, s[16:19], s36 offen lds
  s_waitcnt vmcnt(31)
  ds_read_b64_tr_b16 a[172:173], v11 offset:22528
  ds_read_b64_tr_b16 a[174:175], v11 offset:22784
  s_waitcnt lgkmcnt(8)
  s_barrier
  s_add_u32 m0, s35, 14336
  s_mov_b32 s36, 2359296
  buffer_load_dwordx4 v10, s[8:11], s36 offen lds
  s_waitcnt vmcnt(31)
  ds_read_b64_tr_b16 v[140:141], v11 offset:23552
  ds_read_b64_tr_b16 v[142:143], v11 offset:23808
  s_waitcnt lgkmcnt(8)
  s_barrier
  s_add_u32 m0, s35, 15360
  s_mov_b32 s36, 2359296
  buffer_load_dwordx4 v10, s[12:15], s36 offen lds
  s_waitcnt vmcnt(31)
  ds_read_b64_tr_b16 a[32:33], v11 offset:24576
  ds_read_b64_tr_b16 a[34:35], v11 offset:24832
  s_waitcnt lgkmcnt(8)
  s_barrier
  s_add_u32 m0, s35, 16384
  s_mov_b32 s36, 2359296
  buffer_load_dwordx4 v10, s[16:19], s36 offen lds
  s_waitcnt vmcnt(31)
  ds_read_b64_tr_b16 a[176:177], v11 offset:25600
  ds_read_b64_tr_b16 a[178:179], v11 offset:25856
  s_waitcnt lgkmcnt(8)
  s_barrier
  s_add_u32 m0, s35, 17408
  s_mov_b32 s36, 2490368
  buffer_load_dwordx4 v10, s[8:11], s36 offen lds
  s_waitcnt vmcnt(31)
  ds_read_b64_tr_b16 v[144:145], v11 offset:26624
  ds_read_b64_tr_b16 v[146:147], v11 offset:26880
  s_waitcnt lgkmcnt(8)
  s_barrier
  s_add_u32 m0, s35, 18432
  s_mov_b32 s36, 2490368
  buffer_load_dwordx4 v10, s[12:15], s36 offen lds
  s_waitcnt vmcnt(31)
  ds_read_b64_tr_b16 a[36:37], v11 offset:27648
  ds_read_b64_tr_b16 a[38:39], v11 offset:27904
  s_waitcnt lgkmcnt(8)
  s_barrier
  s_add_u32 m0, s35, 19456
  s_mov_b32 s36, 2490368
  buffer_load_dwordx4 v10, s[16:19], s36 offen lds
  s_waitcnt vmcnt(31)
  ds_read_b64_tr_b16 a[180:181], v11 offset:28672
  ds_read_b64_tr_b16 a[182:183], v11 offset:28928
  s_waitcnt lgkmcnt(8)
  s_barrier
  s_add_u32 m0, s35, 20480
  s_mov_b32 s36, 2621440
  buffer_load_dwordx4 v10, s[8:11], s36 offen lds
  s_waitcnt vmcnt(31)
  ds_read_b64_tr_b16 v[148:149], v11 offset:29696
  ds_read_b64_tr_b16 v[150:151], v11 offset:29952
  s_waitcnt lgkmcnt(8)
  s_barrier
  s_add_u32 m0, s35, 21504
  s_mov_b32 s36, 2621440
  buffer_load_dwordx4 v10, s[12:15], s36 offen lds
  s_waitcnt vmcnt(31)
  ds_read_b64_tr_b16 a[40:41], v11 offset:30720
  ds_read_b64_tr_b16 a[42:43], v11 offset:30976
  s_waitcnt lgkmcnt(8)
  s_barrier
  s_add_u32 m0, s35, 22528
  s_mov_b32 s36, 2621440
  buffer_load_dwordx4 v10, s[16:19], s36 offen lds
  s_waitcnt vmcnt(31)
  ds_read_b64_tr_b16 a[184:185], v11 offset:31744
  ds_read_b64_tr_b16 a[186:187], v11 offset:32000
  s_waitcnt lgkmcnt(8)
  s_barrier
  s_add_u32 m0, s35, 23552
  s_mov_b32 s36, 2752512
  buffer_load_dwordx4 v10, s[8:11], s36 offen lds
  s_waitcnt vmcnt(31)
  ds_read_b64_tr_b16 v[152:153], v11 offset:32768
  ds_read_b64_tr_b16 v[154:155], v11 offset:33024
  s_waitcnt lgkmcnt(8)
  s_barrier
  s_add_u32 m0, s35, 24576
  s_mov_b32 s36, 2752512
  buffer_load_dwordx4 v10, s[12:15], s36 offen lds
  s_waitcnt vmcnt(31)
  ds_read_b64_tr_b16 a[44:45], v11 offset:33792
  ds_read_b64_tr_b16 a[46:47], v11 offset:34048
  s_waitcnt lgkmcnt(8)
  s_barrier
  s_add_u32 m0, s35, 25600
  s_mov_b32 s36, 2752512
  buffer_load_dwordx4 v10, s[16:19], s36 offen lds
  s_waitcnt vmcnt(31)
  ds_read_b64_tr_b16 a[188:189], v11 offset:34816
  ds_read_b64_tr_b16 a[190:191], v11 offset:35072
  s_waitcnt lgkmcnt(8)
  s_barrier
  s_add_u32 m0, s35, 26624
  s_mov_b32 s36, 2883584
  buffer_load_dwordx4 v10, s[8:11], s36 offen lds
  s_waitcnt vmcnt(31)
  ds_read_b64_tr_b16 v[156:157], v11 offset:35840
  ds_read_b64_tr_b16 v[158:159], v11 offset:36096
  s_waitcnt lgkmcnt(8)
  s_barrier
  s_add_u32 m0, s35, 27648
  s_mov_b32 s36, 2883584
  buffer_load_dwordx4 v10, s[12:15], s36 offen lds
  s_waitcnt vmcnt(31)
  ds_read_b64_tr_b16 a[48:49], v11 offset:36864
  ds_read_b64_tr_b16 a[50:51], v11 offset:37120
  s_waitcnt lgkmcnt(8)
  s_barrier
  s_add_u32 m0, s35, 28672
  s_mov_b32 s36, 2883584
  buffer_load_dwordx4 v10, s[16:19], s36 offen lds
  s_waitcnt vmcnt(31)
  ds_read_b64_tr_b16 a[192:193], v11 offset:37888
  ds_read_b64_tr_b16 a[194:195], v11 offset:38144
  s_waitcnt lgkmcnt(8)
  s_barrier
  s_add_u32 m0, s35, 29696
  s_mov_b32 s36, 3014656
  buffer_load_dwordx4 v10, s[8:11], s36 offen lds
  s_waitcnt vmcnt(31)
  ds_read_b64_tr_b16 v[160:161], v11 offset:38912
  ds_read_b64_tr_b16 v[162:163], v11 offset:39168
  s_waitcnt lgkmcnt(8)
  s_barrier
  s_add_u32 m0, s35, 30720
  s_mov_b32 s36, 3014656
  buffer_load_dwordx4 v10, s[12:15], s36 offen lds
  s_waitcnt vmcnt(31)
  ds_read_b64_tr_b16 a[52:53], v11 offset:39936
  ds_read_b64_tr_b16 a[54:55], v11 offset:40192
  s_waitcnt lgkmcnt(8)
  s_barrier
  s_add_u32 m0, s35, 31744
  s_mov_b32 s36, 3014656
  buffer_load_dwordx4 v10, s[16:19], s36 offen lds
  s_waitcnt vmcnt(31)
  ds_read_b64_tr_b16 a[196:197], v11 offset:0
  ds_read_b64_tr_b16 a[198:199], v11 offset:256
  s_waitcnt lgkmcnt(8)
  s_barrier
  s_add_u32 m0, s35, 32768
  s_mov_b32 s36, 3145728
  buffer_load_dwordx4 v10, s[8:11], s36 offen lds
  s_waitcnt vmcnt(31)
  ds_read_b64_tr_b16 v[164:165], v11 offset:1024
  ds_read_b64_tr_b16 v[166:167], v11 offset:1280
  s_waitcnt lgkmcnt(8)
  s_barrier
  s_add_u32 m0, s35, 33792
  s_mov_b32 s36, 3145728
  buffer_load_dwordx4 v10, s[12:15], s36 offen lds
  s_waitcnt vmcnt(31)
  ds_read_b64_tr_b16 a[56:57], v11 offset:2048
  ds_read_b64_tr_b16 a[58:59], v11 offset:2304
  s_waitcnt lgkmcnt(8)
  s_barrier
  s_add_u32 m0, s35, 34816
  s_mov_b32 s36, 3145728
  buffer_load_dwordx4 v10, s[16:19], s36 offen lds
  s_waitcnt vmcnt(31)
  ds_read_b64_tr_b16 a[200:201], v11 offset:3072
  ds_read_b64_tr_b16 a[202:203], v11 offset:3328
  s_waitcnt lgkmcnt(8)
  s_barrier
  s_add_u32 m0, s35, 35840
  s_mov_b32 s36, 3276800
  buffer_load_dwordx4 v10, s[8:11], s36 offen lds
  s_waitcnt vmcnt(31)
  ds_read_b64_tr_b16 v[168:169], v11 offset:4096
  ds_read_b64_tr_b16 v[170:171], v11 offset:4352
  s_waitcnt lgkmcnt(8)
  s_barrier
  s_add_u32 m0, s35, 36864
  s_mov_b32 s36, 3276800
  buffer_load_dwordx4 v10, s[12:15], s36 offen lds
  s_waitcnt vmcnt(31)
  ds_read_b64_tr_b16 a[60:61], v11 offset:5120
  ds_read_b64_tr_b16 a[62:63], v11 offset:5376
  s_waitcnt lgkmcnt(8)
  s_barrier
  s_add_u32 m0, s35, 37888
  s_mov_b32 s36, 3276800
  buffer_load_dwordx4 v10, s[16:19], s36 offen lds
  s_waitcnt vmcnt(31)
  ds_read_b64_tr_b16 a[204:205], v11 offset:6144
  ds_read_b64_tr_b16 a[206:207], v11 offset:6400
  s_waitcnt lgkmcnt(8)
  s_barrier
  s_add_u32 m0, s35, 38912
  s_mov_b32 s36, 3407872
  buffer_load_dwordx4 v10, s[8:11], s36 offen lds
  s_waitcnt vmcnt(31)
  ds_read_b64_tr_b16 v[172:173], v11 offset:7168
  ds_read_b64_tr_b16 v[174:175], v11 offset:7424
  s_waitcnt lgkmcnt(8)
  s_barrier
  s_add_u32 m0, s35, 39936
  s_mov_b32 s36, 3407872
  buffer_load_dwordx4 v10, s[12:15], s36 offen lds
  s_waitcnt vmcnt(31)
  ds_read_b64_tr_b16 a[64:65], v11 offset:8192
  ds_read_b64_tr_b16 a[66:67], v11 offset:8448
  s_waitcnt lgkmcnt(8)
  s_barrier
  s_add_u32 m0, s35, 0
  s_mov_b32 s36, 3407872
  buffer_load_dwordx4 v10, s[16:19], s36 offen lds
  s_waitcnt vmcnt(31)
  ds_read_b64_tr_b16 a[208:209], v11 offset:9216
  ds_read_b64_tr_b16 a[210:211], v11 offset:9472
  s_waitcnt lgkmcnt(8)
  s_barrier
  s_add_u32 m0, s35, 1024
  s_mov_b32 s36, 3538944
  buffer_load_dwordx4 v10, s[8:11], s36 offen lds
  s_waitcnt vmcnt(31)
  ds_read_b64_tr_b16 v[176:177], v11 offset:10240
  ds_read_b64_tr_b16 v[178:179], v11 offset:10496
  s_waitcnt lgkmcnt(8)
  s_barrier
  s_add_u32 m0, s35, 2048
  s_mov_b32 s36, 3538944
  buffer_load_dwordx4 v10, s[12:15], s36 offen lds
  s_waitcnt vmcnt(31)
  ds_read_b64_tr_b16 a[68:69], v11 offset:11264
  ds_read_b64_tr_b16 a[70:71], v11 offset:11520
  s_waitcnt lgkmcnt(8)
  s_barrier
  s_add_u32 m0, s35, 3072
  s_mov_b32 s36, 3538944
  buffer_load_dwordx4 v10, s[16:19], s36 offen lds
  s_waitcnt vmcnt(31)
  ds_read_b64_tr_b16 a[212:213], v11 offset:12288
  ds_read_b64_tr_b16 a[214:215], v11 offset:12544
  s_waitcnt lgkmcnt(8)
  s_barrier
  s_add_u32 m0, s35, 4096
  s_mov_b32 s36, 3670016
  buffer_load_dwordx4 v10, s[8:11], s36 offen lds
  s_waitcnt vmcnt(31)
  ds_read_b64_tr_b16 v[180:181], v11 offset:13312
  ds_read_b64_tr_b16 v[182:183], v11 offset:13568
  s_waitcnt lgkmcnt(8)
  s_barrier
  s_add_u32 m0, s35, 5120
  s_mov_b32 s36, 3670016
  buffer_load_dwordx4 v10, s[12:15], s36 offen lds
  s_waitcnt vmcnt(31)
  ds_read_b64_tr_b16 a[72:73], v11 offset:14336
  ds_read_b64_tr_b16 a[74:75], v11 offset:14592
  s_waitcnt lgkmcnt(8)
  s_barrier
  s_add_u32 m0, s35, 6144
  s_mov_b32 s36, 3670016
  buffer_load_dwordx4 v10, s[16:19], s36 offen lds
  s_waitcnt vmcnt(31)
  ds_read_b64_tr_b16 a[216:217], v11 offset:15360
  ds_read_b64_tr_b16 a[218:219], v11 offset:15616
  s_waitcnt lgkmcnt(8)
  s_barrier
  s_add_u32 m0, s35, 7168
  s_mov_b32 s36, 3801088
  buffer_load_dwordx4 v10, s[8:11], s36 offen lds
  s_waitcnt vmcnt(31)
  ds_read_b64_tr_b16 v[184:185], v11 offset:16384
  ds_read_b64_tr_b16 v[186:187], v11 offset:16640
  s_waitcnt lgkmcnt(8)
  s_barrier
  s_add_u32 m0, s35, 8192
  s_mov_b32 s36, 3801088
  buffer_load_dwordx4 v10, s[12:15], s36 offen lds
  s_waitcnt vmcnt(31)
  ds_read_b64_tr_b16 a[76:77], v11 offset:17408
  ds_read_b64_tr_b16 a[78:79], v11 offset:17664
  s_waitcnt lgkmcnt(8)
  s_barrier
  s_add_u32 m0, s35, 9216
  s_mov_b32 s36, 3801088
  buffer_load_dwordx4 v10, s[16:19], s36 offen lds
  s_waitcnt vmcnt(31)
  ds_read_b64_tr_b16 a[220:221], v11 offset:18432
  ds_read_b64_tr_b16 a[222:223], v11 offset:18688
  s_waitcnt lgkmcnt(8)
  s_barrier
  s_add_u32 m0, s35, 10240
  s_mov_b32 s36, 3932160
  buffer_load_dwordx4 v10, s[8:11], s36 offen lds
  s_waitcnt vmcnt(31)
  ds_read_b64_tr_b16 v[188:189], v11 offset:19456
  ds_read_b64_tr_b16 v[190:191], v11 offset:19712
  s_waitcnt lgkmcnt(8)
  s_barrier
  s_add_u32 m0, s35, 11264
  s_mov_b32 s36, 3932160
  buffer_load_dwordx4 v10, s[12:15], s36 offen lds
  s_waitcnt vmcnt(31)
  ds_read_b64_tr_b16 a[80:81], v11 offset:20480
  ds_read_b64_tr_b16 a[82:83], v11 offset:20736
  s_waitcnt lgkmcnt(8)
  s_barrier
  s_add_u32 m0, s35, 12288
  s_mov_b32 s36, 3932160
  buffer_load_dwordx4 v10, s[16:19], s36 offen lds
  s_waitcnt vmcnt(31)
  ds_read_b64_tr_b16 a[224:225], v11 offset:21504
  ds_read_b64_tr_b16 a[226:227], v11 offset:21760
  s_waitcnt lgkmcnt(8)
  s_barrier
  s_add_u32 m0, s35, 13312
  s_mov_b32 s36, 4063232
  buffer_load_dwordx4 v10, s[8:11], s36 offen lds
  s_waitcnt vmcnt(31)
  ds_read_b64_tr_b16 v[192:193], v11 offset:22528
  ds_read_b64_tr_b16 v[194:195], v11 offset:22784
  s_waitcnt lgkmcnt(8)
  s_barrier
  s_add_u32 m0, s35, 14336
  s_mov_b32 s36, 4063232
  buffer_load_dwordx4 v10, s[12:15], s36 offen lds
  s_waitcnt vmcnt(31)
  ds_read_b64_tr_b16 a[84:85], v11 offset:23552
  ds_read_b64_tr_b16 a[86:87], v11 offset:23808
  s_waitcnt lgkmcnt(8)
  s_barrier
  s_add_u32 m0, s35, 15360
  s_mov_b32 s36, 4063232
  buffer_load_dwordx4 v10, s[16:19], s36 offen lds
  s_waitcnt vmcnt(31)
  ds_read_b64_tr_b16 a[228:229], v11 offset:24576
  ds_read_b64_tr_b16 a[230:231], v11 offset:24832
  s_waitcnt lgkmcnt(8)
  s_barrier
  s_add_u32 m0, s35, 16384
  s_mov_b32 s36, 4194304
  buffer_load_dwordx4 v10, s[8:11], s36 offen lds
  s_waitcnt vmcnt(31)
  ds_read_b64_tr_b16 v[196:197], v11 offset:25600
  ds_read_b64_tr_b16 v[198:199], v11 offset:25856
  s_waitcnt lgkmcnt(8)
  s_barrier
  s_add_u32 m0, s35, 17408
  s_mov_b32 s36, 4194304
  buffer_load_dwordx4 v10, s[12:15], s36 offen lds
  s_waitcnt vmcnt(31)
  ds_read_b64_tr_b16 a[88:89], v11 offset:26624
  ds_read_b64_tr_b16 a[90:91], v11 offset:26880
  s_waitcnt lgkmcnt(8)
  s_barrier
  s_add_u32 m0, s35, 18432
  s_mov_b32 s36, 4194304
  buffer_load_dwordx4 v10, s[16:19], s36 offen lds
  s_waitcnt vmcnt(31)
  ds_read_b64_tr_b16 a[232:233], v11 offset:27648
  ds_read_b64_tr_b16 a[234:235], v11 offset:27904
  s_waitcnt lgkmcnt(8)
  s_barrier
  s_add_u32 m0, s35, 19456
  s_mov_b32 s36, 4325376
  buffer_load_dwordx4 v10, s[8:11], s36 offen lds
  s_waitcnt vmcnt(31)
  ds_read_b64_tr_b16 v[200:201], v11 offset:28672
  ds_read_b64_tr_b16 v[202:203], v11 offset:28928
  s_waitcnt lgkmcnt(8)
  s_barrier
  s_add_u32 m0, s35, 20480
  s_mov_b32 s36, 4325376
  buffer_load_dwordx4 v10, s[12:15], s36 offen lds
  s_waitcnt vmcnt(31)
  ds_read_b64_tr_b16 a[92:93], v11 offset:29696
  ds_read_b64_tr_b16 a[94:95], v11 offset:29952
  s_waitcnt lgkmcnt(8)
  s_barrier
  s_add_u32 m0, s35, 21504
  s_mov_b32 s36, 4325376
  buffer_load_dwordx4 v10, s[16:19], s36 offen lds
  s_waitcnt vmcnt(31)
  ds_read_b64_tr_b16 a[236:237], v11 offset:30720
  ds_read_b64_tr_b16 a[238:239], v11 offset:30976
  s_waitcnt lgkmcnt(8)
  s_barrier
  s_add_u32 m0, s35, 22528
  s_mov_b32 s36, 4456448
  buffer_load_dwordx4 v10, s[8:11], s36 offen lds
  s_waitcnt vmcnt(31)
  ds_read_b64_tr_b16 v[204:205], v11 offset:31744
  ds_read_b64_tr_b16 v[206:207], v11 offset:32000
  s_waitcnt lgkmcnt(8)
  s_barrier
  s_add_u32 m0, s35, 23552
  s_mov_b32 s36, 4456448
  buffer_load_dwordx4 v10, s[12:15], s36 offen lds
  s_waitcnt vmcnt(31)
  ds_read_b64_tr_b16 a[96:97], v11 offset:32768
  ds_read_b64_tr_b16 a[98:99], v11 offset:33024
  s_waitcnt lgkmcnt(8)
  s_barrier
  s_add_u32 m0, s35, 24576
  s_mov_b32 s36, 4456448
  buffer_load_dwordx4 v10, s[16:19], s36 offen lds
  s_waitcnt vmcnt(31)
  ds_read_b64_tr_b16 a[240:241], v11 offset:33792
  ds_read_b64_tr_b16 a[242:243], v11 offset:34048
  s_waitcnt lgkmcnt(8)
  s_barrier
  s_add_u32 m0, s35, 25600
  s_mov_b32 s36, 4587520
  buffer_load_dwordx4 v10, s[8:11], s36 offen lds
  s_waitcnt vmcnt(31)
  ds_read_b64_tr_b16 v[208:209], v11 offset:34816
  ds_read_b64_tr_b16 v[210:211], v11 offset:35072
  s_waitcnt lgkmcnt(8)
  s_barrier
  s_add_u32 m0, s35, 26624
  s_mov_b32 s36, 4587520
  buffer_load_dwordx4 v10, s[12:15], s36 offen lds
  s_waitcnt vmcnt(31)
  ds_read_b64_tr_b16 a[100:101], v11 offset:35840
  ds_read_b64_tr_b16 a[102:103], v11 offset:36096
  s_waitcnt lgkmcnt(8)
  s_barrier
  s_add_u32 m0, s35, 27648
  s_mov_b32 s36, 4587520
  buffer_load_dwordx4 v10, s[16:19], s36 offen lds
  s_waitcnt vmcnt(31)
  ds_read_b64_tr_b16 a[244:245], v11 offset:36864
  ds_read_b64_tr_b16 a[246:247], v11 offset:37120
  s_waitcnt vmcnt(30)
  ds_read_b64_tr_b16 v[212:213], v11 offset:37888
  ds_read_b64_tr_b16 v[214:215], v11 offset:38144
  s_waitcnt vmcnt(29)
  ds_read_b64_tr_b16 a[104:105], v11 offset:38912
  ds_read_b64_tr_b16 a[106:107], v11 offset:39168
  s_waitcnt vmcnt(28)
  ds_read_b64_tr_b16 a[248:249], v11 offset:39936
  ds_read_b64_tr_b16 a[250:251], v11 offset:40192
  s_waitcnt vmcnt(27)
  ds_read_b64_tr_b16 v[216:217], v11 offset:0
  ds_read_b64_tr_b16 v[218:219], v11 offset:256
  s_waitcnt vmcnt(26)
  ds_read_b64_tr_b16 a[108:109], v11 offset:1024
  ds_read_b64_tr_b16 a[110:111], v11 offset:1280
  s_waitcnt vmcnt(25)
  ds_read_b64_tr_b16 a[252:253], v11 offset:2048
  ds_read_b64_tr_b16 a[254:255], v11 offset:2304
  s_waitcnt vmcnt(24)
  ds_read_b64_tr_b16 v[220:221], v11 offset:3072
  ds_read_b64_tr_b16 v[222:223], v11 offset:3328
  s_waitcnt vmcnt(23)
  ds_read_b64_tr_b16 a[112:113], v11 offset:4096
  ds_read_b64_tr_b16 a[114:115], v11 offset:4352
  s_waitcnt vmcnt(22)
  ds_read_b64_tr_b16 v[80:81], v11 offset:5120
  ds_read_b64_tr_b16 v[82:83], v11 offset:5376
  s_waitcnt vmcnt(21)
  ds_read_b64_tr_b16 v[224:225], v11 offset:6144
  ds_read_b64_tr_b16 v[226:227], v11 offset:6400
  s_waitcnt vmcnt(20)
  ds_read_b64_tr_b16 a[116:117], v11 offset:7168
  ds_read_b64_tr_b16 a[118:119], v11 offset:7424
  s_waitcnt vmcnt(19)
  ds_read_b64_tr_b16 v[84:85], v11 offset:8192
  ds_read_b64_tr_b16 v[86:87], v11 offset:8448
  s_waitcnt vmcnt(18)
  ds_read_b64_tr_b16 v[228:229], v11 offset:9216
  ds_read_b64_tr_b16 v[230:231], v11 offset:9472
  s_waitcnt vmcnt(17)
  ds_read_b64_tr_b16 a[120:121], v11 offset:10240
  ds_read_b64_tr_b16 a[122:123], v11 offset:10496
  s_waitcnt vmcnt(16)
  ds_read_b64_tr_b16 v[88:89], v11 offset:11264
  ds_read_b64_tr_b16 v[90:91], v11 offset:11520
  s_waitcnt vmcnt(15)
  ds_read_b64_tr_b16 v[232:233], v11 offset:12288
  ds_read_b64_tr_b16 v[234:235], v11 offset:12544
  s_waitcnt vmcnt(14)
  ds_read_b64_tr_b16 a[124:125], v11 offset:13312
  ds_read_b64_tr_b16 a[126:127], v11 offset:13568
  s_waitcnt vmcnt(13)
  ds_read_b64_tr_b16 v[92:93], v11 offset:14336
  ds_read_b64_tr_b16 v[94:95], v11 offset:14592
  s_waitcnt vmcnt(12)
  ds_read_b64_tr_b16 v[236:237], v11 offset:15360
  ds_read_b64_tr_b16 v[238:239], v11 offset:15616
  s_waitcnt vmcnt(11)
  ds_read_b64_tr_b16 a[128:129], v11 offset:16384
  ds_read_b64_tr_b16 a[130:131], v11 offset:16640
  s_waitcnt vmcnt(10)
  ds_read_b64_tr_b16 v[96:97], v11 offset:17408
  ds_read_b64_tr_b16 v[98:99], v11 offset:17664
  s_waitcnt vmcnt(9)
  ds_read_b64_tr_b16 v[240:241], v11 offset:18432
  ds_read_b64_tr_b16 v[242:243], v11 offset:18688
  s_waitcnt vmcnt(8)
  ds_read_b64_tr_b16 a[132:133], v11 offset:19456
  ds_read_b64_tr_b16 a[134:135], v11 offset:19712
  s_waitcnt vmcnt(7)
  ds_read_b64_tr_b16 v[100:101], v11 offset:20480
  ds_read_b64_tr_b16 v[102:103], v11 offset:20736
  s_waitcnt vmcnt(6)
  ds_read_b64_tr_b16 v[244:245], v11 offset:21504
  ds_read_b64_tr_b16 v[246:247], v11 offset:21760
  s_waitcnt vmcnt(5)
  ds_read_b64_tr_b16 a[136:137], v11 offset:22528
  ds_read_b64_tr_b16 a[138:139], v11 offset:22784
  s_waitcnt vmcnt(4)
  ds_read_b64_tr_b16 v[104:105], v11 offset:23552
  ds_read_b64_tr_b16 v[106:107], v11 offset:23808
  s_waitcnt vmcnt(3)
  ds_read_b64_tr_b16 v[248:249], v11 offset:24576
  ds_read_b64_tr_b16 v[250:251], v11 offset:24832
  s_waitcnt vmcnt(2)
  ds_read_b64_tr_b16 a[140:141], v11 offset:25600
  ds_read_b64_tr_b16 a[142:143], v11 offset:25856
  s_waitcnt vmcnt(1)
  ds_read_b64_tr_b16 v[108:109], v11 offset:26624
  ds_read_b64_tr_b16 v[110:111], v11 offset:26880
  s_waitcnt vmcnt(0)
  ds_read_b64_tr_b16 v[252:253], v11 offset:27648
  ds_read_b64_tr_b16 v[254:255], v11 offset:27904
  s_waitcnt lgkmcnt(0)
  s_barrier
  v_mov_b32 v5, 0
  v_mov_b32 v6, 1
  v_lshlrev_b32 v1, 4, v0
  s_mov_b32 s48, 0
  s_mov_b32 s49, -1
  v_and_b32 v7, 7, v0
  v_lshlrev_b32 v7, 7, v7
  s_and_b32 s33, s24, 1
  s_lshl_b32 s33, s33, 10
  s_add_u32 s33, s33, 49152
  s_and_b32 s34, s26, 7
  s_mul_i32 s34, s34, 8320
  s_add_u32 s33, s33, s34
  v_add_u32 v7, s33, v7
  v_bfe_u32 v8, v0, 3, 1
  v_lshlrev_b32 v8, 12, v8
  s_lshl_b32 s33, s28, 11
  s_add_u32 s33, s33, 4
  v_add3_u32 v8, v8, v7, s33
  v_add_u32 v7, 4096, v7
  v_cndmask_b32 v7, v7, v8, s[48:49]
  s_lshl_b32 s46, s28, 5
  s_add_u32 s46, s46, s29
  s_lshl_b32 s46, s46, 9
  s_lshl_b32 s34, s24, 7
  s_add_u32 s46, s46, s34
  s_add_u32 s46, s46, 0
  v_lshrrev_b32 v8, 3, v0
  s_lshl_b32 s33, s24, 3
  v_add_u32 v8, s33, v8
  v_bfe_u32 v9, v8, 1, 3
  v_and_b32 v10, 7, v0
  v_xor_b32 v9, v9, v10
  v_mul_u32_u24 v2, 1152, v8
  v_lshl_add_u32 v2, v9, 4, v2
  v_and_b32 v8, 31, v0
  v_bfe_u32 v9, v0, 1, 3
  v_lshrrev_b32 v14, 5, v0
  v_xor_b32 v9, v9, v14
  v_xor_b32 v14, 0, v9
  v_lshlrev_b32 v14, 4, v14
  v_lshl_add_u32 v10, v8, 7, v14
  v_xor_b32 v14, 2, v9
  v_lshlrev_b32 v14, 4, v14
  v_lshl_add_u32 v11, v8, 7, v14
  v_xor_b32 v14, 4, v9
  v_lshlrev_b32 v14, 4, v14
  v_lshl_add_u32 v12, v8, 7, v14
  v_xor_b32 v14, 6, v9
  v_lshlrev_b32 v14, 4, v14
  v_lshl_add_u32 v13, v8, 7, v14
  v_mov_b32 v8, 128
Lwi_16:
  buffer_load_dword v9, v8, s[20:23], 0 offen sc1
  s_waitcnt vmcnt(0)
  v_cmp_gt_u32 vcc, 0x100, v9
  s_cbranch_vccz Lwiok_17
  s_add_u32 s60, s60, 1
  s_cmp_gt_u32 s60, 262144
  s_cbranch_scc1 L_fail_qkv
  s_sleep 4
  s_branch Lwi_16
Lwiok_17:
  s_mov_b32 s30, s28
  s_mov_b32 s31, s28
  s_mov_b32 s44, 0
  s_mov_b32 s45, 36864
  s_mov_b32 s47, 0x40000000
  s_mov_b32 s50, 0
  s_mov_b32 s58, -1
  s_mov_b32 s38, 0x40000000
  s_lshl_b32 s51, s29, 2
  s_add_u32 s51, s51, s24
  s_lshl_b32 s40, s24, 10
  s_mul_i32 s41, s29, 3170304
  s_lshl_b32 s34, s24, 11
  s_add_u32 s41, s41, s34
  s_add_u32 s41, s41, 19480576
  s_mov_b32 s39, 2965504
  s_mov_b32 s48, 0xff
  s_mov_b32 s49, 0xffff
  v_mov_b32 v9, 0
  s_mul_i32 s33, s31, 20
  s_lshr_b32 s33, s33, 4
  s_add_i32 s33, s33, -38
  s_cmp_le_i32 s33, s30
  s_cselect_b32 s34, 1, 0
  s_cmp_ge_u32 s30, 64
  s_cselect_b32 s34, 1, s34
  s_cmp_ge_u32 s31, 64
  s_cselect_b32 s34, 0, s34
  s_cmp_eq_u32 s34, 1
  s_cselect_b32 s59, s31, s30
  s_cselect_b32 s43, 0, 64
  s_cmp_eq_u32 s34, 1
  s_cselect_b32 s35, 2, 0
  s_cselect_b32 s36, 0, 2
  s_add_u32 s31, s31, s35
  s_add_u32 s30, s30, s36
  s_add_u32 s43, s43, s59
  s_bitcmp1_b32 s59, 1
  s_cselect_b32 s35, 0xff00, s48
  s_cmp_eq_u32 s34, 1
  s_cselect_b32 s62, 0, 0xff
  s_cselect_b32 s63, s35, 0
  s_mul_i32 s33, s59, 36864
  s_add_u32 s33, s33, s39
  s_add_u32 s34, s40, s44
  s_cmp_ge_u32 s59, 64
  s_cselect_b32 s43, -1, s43
  s_cselect_b32 s42, 1, 0
L_qkv_fetch:
  s_mov_b64 exec, s[62:63]
  buffer_load_dword v9, v7, s[4:7], 0 offen sc1
  s_mov_b64 exec, -1
  s_waitcnt vmcnt(0)
  v_cmp_ge_u32 vcc, s59, v9
  s_and_b64 vcc, vcc, s[62:63]
  s_cbranch_scc0 L_qkv_fgo
  s_add_u32 s60, s60, 1
  s_cmp_gt_u32 s60, 262144
  s_cbranch_scc1 L_fail_qkv
  s_sleep 2
  s_branch L_qkv_fetch
L_qkv_fgo:
  s_add_u32 m0, s34, 0
  s_add_u32 s35, s33, 0
  buffer_load_dwordx4 v2, s[4:7], s35 offen sc1 lds
  s_add_u32 m0, s34, 4096
  s_add_u32 s35, s33, 128
  buffer_load_dwordx4 v2, s[4:7], s35 offen sc1 lds
  s_add_u32 m0, s34, 8192
  s_add_u32 s35, s33, 256
  buffer_load_dwordx4 v2, s[4:7], s35 offen sc1 lds
  s_add_u32 m0, s34, 12288
  s_add_u32 s35, s33, 384
  buffer_load_dwordx4 v2, s[4:7], s35 offen sc1 lds
  s_add_u32 m0, s34, 16384
  s_add_u32 s35, s33, 512
  buffer_load_dwordx4 v2, s[4:7], s35 offen sc1 lds
  s_add_u32 m0, s34, 20480
  s_add_u32 s35, s33, 640
  buffer_load_dwordx4 v2, s[4:7], s35 offen sc1 lds
  s_add_u32 m0, s34, 24576
  s_add_u32 s35, s33, 768
  buffer_load_dwordx4 v2, s[4:7], s35 offen sc1 lds
  s_add_u32 m0, s34, 28672
  s_add_u32 s35, s33, 896
  buffer_load_dwordx4 v2, s[4:7], s35 offen sc1 lds
  s_add_u32 m0, s34, 32768
  s_add_u32 s35, s33, 1024
  buffer_load_dwordx4 v2, s[4:7], s35 offen sc1 lds
  s_waitcnt vmcnt(0)
L_qkv_run:
  s_mov_b32 s32, s43
  s_add_u32 s44, s44, s45
  s_mul_i32 s37, s59, 24576
  s_add_u32 s37, s37, s41
  s_barrier
  ds_read_b128 v[48:51], v10 offset:0
  ds_read_b128 v[52:55], v11 offset:0
  ds_read_b128 v[56:59], v12 offset:0
  ds_read_b128 v[60:63], v13 offset:0
  s_waitcnt lgkmcnt(2)
  v_mfma_f32_32x32x16_bf16 v[16:31], a[0:3], v[48:51], 0
  ds_read_b128 v[64:67], v10 offset:4096
  s_mul_i32 s33, s31, 20
  s_lshr_b32 s33, s33, 4
  v_mfma_f32_32x32x16_bf16 v[16:31], a[4:7], v[52:55], v[16:31]
  ds_read_b128 v[48:51], v11 offset:4096
  s_add_i32 s33, s33, -38
  s_cmp_le_i32 s33, s30
  s_cselect_b32 s34, 1, 0
  s_waitcnt lgkmcnt(2)
  v_mfma_f32_32x32x16_bf16 v[16:31], a[8:11], v[56:59], v[16:31]
  ds_read_b128 v[52:55], v12 offset:4096
  s_cmp_ge_u32 s30, 64
  s_cselect_b32 s34, 1, s34
  v_mfma_f32_32x32x16_bf16 v[16:31], a[12:15], v[60:63], v[16:31]
  ds_read_b128 v[56:59], v13 offset:4096
  s_cmp_ge_u32 s31, 64
  s_cselect_b32 s34, 0, s34
  s_waitcnt lgkmcnt(2)
  v_mfma_f32_32x32x16_bf16 v[16:31], a[16:19], v[64:67], v[16:31]
  ds_read_b128 v[60:63], v10 offset:8192
  s_cmp_eq_u32 s34, 1
  s_cselect_b32 s59, s31, s30
  s_cselect_b32 s43, 0, 64
  v_mfma_f32_32x32x16_bf16 v[16:31], a[20:23], v[48:51], v[16:31]
  ds_read_b128 v[64:67], v11 offset:8192
  s_cmp_eq_u32 s34, 1
  s_cselect_b32 s35, 2, 0
  s_cselect_b32 s36, 0, 2
  s_waitcnt lgkmcnt(2)
  v_mfma_f32_32x32x16_bf16 v[16:31], a[24:27], v[52:55], v[16:31]
  ds_read_b128 v[48:51], v12 offset:8192
  s_add_u32 s31, s31, s35
  s_add_u32 s30, s30, s36
  s_add_u32 s43, s43, s59
  v_mfma_f32_32x32x16_bf16 v[16:31], a[28:31], v[56:59], v[16:31]
  ds_read_b128 v[52:55], v13 offset:8192
  s_bitcmp1_b32 s59, 1
  s_cselect_b32 s35, 0xff00, s48
  s_waitcnt lgkmcnt(2)
  v_mfma_f32_32x32x16_bf16 v[16:31], a[32:35], v[60:63], v[16:31]
  ds_read_b128 v[56:59], v10 offset:12288
  s_cmp_eq_u32 s34, 1
  s_cselect_b32 s62, 0, 0xff
  s_cselect_b32 s63, s35, 0
  v_mfma_f32_32x32x16_bf16 v[16:31], a[36:39], v[64:67], v[16:31]
  ds_read_b128 v[60:63], v11 offset:12288
  s_mul_i32 s33, s59, 36864
  s_add_u32 s33, s33, s39
  s_add_u32 s34, s40, s44
  s_waitcnt lgkmcnt(2)
  v_mfma_f32_32x32x16_bf16 v[16:31], a[40:43], v[48:51], v[16:31]
  ds_read_b128 v[64:67], v12 offset:12288
  s_cmp_ge_u32 s59, 64
  s_cselect_b32 s43, -1, s43
  s_cselect_b32 s42, 1, 0
  v_cmp_ge_u32 vcc, s59, v9
  v_mfma_f32_32x32x16_bf16 v[16:31], a[44:47], v[52:55], v[16:31]
  ds_read_b128 v[48:51], v13 offset:12288
  s_waitcnt lgkmcnt(2)
  s_and_b64 vcc, vcc, s[62:63]
  s_cbranch_scc0 L_qkv_w12
  v_mfma_f32_32x32x16_bf16 v[16:31], a[48:51], v[56:59], v[16:31]
  ds_read_b128 v[52:55], v10 offset:16384
  v_mfma_f32_32x32x16_bf16 v[16:31], a[52:55], v[60:63], v[16:31]
  ds_read_b128 v[56:59], v11 offset:16384
  s_waitcnt lgkmcnt(2)
  v_mfma_f32_32x32x16_bf16 v[16:31], a[56:59], v[64:67], v[16:31]
  ds_read_b128 v[60:63], v12 offset:16384
  v_mfma_f32_32x32x16_bf16 v[16:31], a[60:63], v[48:51], v[16:31]
  ds_read_b128 v[64:67], v13 offset:16384
  s_waitcnt lgkmcnt(2)
  v_mfma_f32_32x32x16_bf16 v[16:31], a[64:67], v[52:55], v[16:31]
  ds_read_b128 v[48:51], v10 offset:20480
  v_mfma_f32_32x32x16_bf16 v[16:31], a[68:71], v[56:59], v[16:31]
  ds_read_b128 v[52:55], v11 offset:20480
  s_waitcnt lgkmcnt(2)
  v_mfma_f32_32x32x16_bf16 v[16:31], a[72:75], v[60:63], v[16:31]
  ds_read_b128 v[56:59], v12 offset:20480
  v_mfma_f32_32x32x16_bf16 v[16:31], a[76:79], v[64:67], v[16:31]
  ds_read_b128 v[60:63], v13 offset:20480
  s_waitcnt lgkmcnt(2)
  v_mfma_f32_32x32x16_bf16 v[16:31], a[80:83], v[48:51], v[16:31]
  ds_read_b128 v[64:67], v10 offset:24576
  s_mov_b64 exec, s[48:49]
  buffer_load_dword v9, v7, s[4:7], 0 offen sc1
  s_mov_b64 exec, -1
  v_mfma_f32_32x32x16_bf16 v[16:31], a[84:87], v[52:55], v[16:31]
  ds_read_b128 v[48:51], v11 offset:24576
  s_waitcnt lgkmcnt(2)
  v_mfma_f32_32x32x16_bf16 v[16:31], a[88:91], v[56:59], v[16:31]
  ds_read_b128 v[52:55], v12 offset:24576
  v_mfma_f32_32x32x16_bf16 v[16:31], a[92:95], v[60:63], v[16:31]
  ds_read_b128 v[56:59], v13 offset:24576
  s_waitcnt lgkmcnt(2)
  v_mfma_f32_32x32x16_bf16 v[16:31], a[96:99], v[64:67], v[16:31]
  ds_read_b128 v[60:63], v10 offset:28672
  s_waitcnt vmcnt(1)
  v_mov_b32 v6, s50
  s_mov_b64 exec, 1
  buffer_store_dword v6, v5, s[4:7], s47 offen sc1
  s_mov_b64 exec, -1
  v_mfma_f32_32x32x16_bf16 v[16:31], a[100:103], v[48:51], v[16:31]
  ds_read_b128 v[64:67], v11 offset:28672
  s_waitcnt lgkmcnt(2)
  v_mfma_f32_32x32x16_bf16 v[16:31], a[104:107], v[52:55], v[16:31]
  ds_read_b128 v[48:51], v12 offset:28672
  v_mfma_f32_32x32x16_bf16 v[16:31], a[108:111], v[56:59], v[16:31]
  ds_read_b128 v[52:55], v13 offset:28672
  s_waitcnt lgkmcnt(2)
  v_mfma_f32_32x32x16_bf16 v[16:31], a[112:115], v[60:63], v[16:31]
  ds_read_b128 v[56:59], v10 offset:32768
  v_mfma_f32_32x32x16_bf16 v[16:31], a[116:119], v[64:67], v[16:31]
  ds_read_b128 v[60:63], v11 offset:32768
  s_waitcnt lgkmcnt(2)
  v_mfma_f32_32x32x16_bf16 v[16:31], a[120:123], v[48:51], v[16:31]
  ds_read_b128 v[64:67], v12 offset:32768
  v_mfma_f32_32x32x16_bf16 v[16:31], a[124:127], v[52:55], v[16:31]
  ds_read_b128 v[48:51], v13 offset:32768
  s_waitcnt lgkmcnt(2)
  v_mfma_f32_32x32x16_bf16 v[16:31], a[128:131], v[56:59], v[16:31]
  ds_read_b128 v[52:55], v10 offset:0
  v_mfma_f32_32x32x16_bf16 v[16:31], a[132:135], v[60:63], v[16:31]
  ds_read_b128 v[56:59], v11 offset:0
  s_waitcnt lgkmcnt(2)
  v_mfma_f32_32x32x16_bf16 v[16:31], a[136:139], v[64:67], v[16:31]
  ds_read_b128 v[60:63], v12 offset:0
  v_cmp_ge_u32 vcc, s59, v9
  v_mfma_f32_32x32x16_bf16 v[16:31], a[140:143], v[48:51], v[16:31]
  ds_read_b128 v[64:67], v13 offset:0
  s_waitcnt lgkmcnt(2)
  s_and_b64 vcc, vcc, s[62:63]
  s_cbranch_scc0 L_qkv_w36
  v_mfma_f32_32x32x16_bf16 v[32:47], a[144:147], v[52:55], 0
  ds_read_b128 v[48:51], v10 offset:4096
  v_mfma_f32_32x32x16_bf16 v[32:47], a[148:151], v[56:59], v[32:47]
  ds_read_b128 v[52:55], v11 offset:4096
  s_waitcnt lgkmcnt(2)
  v_mfma_f32_32x32x16_bf16 v[32:47], a[152:155], v[60:63], v[32:47]
  ds_read_b128 v[56:59], v12 offset:4096
  v_mfma_f32_32x32x16_bf16 v[32:47], a[156:159], v[64:67], v[32:47]
  ds_read_b128 v[60:63], v13 offset:4096
  v_cvt_pk_bf16_f32 v68, v16, v17
  v_cvt_pk_bf16_f32 v69, v18, v19
  s_waitcnt lgkmcnt(2)
  v_mfma_f32_32x32x16_bf16 v[32:47], a[160:163], v[48:51], v[32:47]
  ds_read_b128 v[64:67], v10 offset:8192
  v_cvt_pk_bf16_f32 v70, v20, v21
  v_cvt_pk_bf16_f32 v71, v22, v23
  v_mfma_f32_32x32x16_bf16 v[32:47], a[164:167], v[52:55], v[32:47]
  ds_read_b128 v[48:51], v11 offset:8192
  v_cvt_pk_bf16_f32 v72, v24, v25
  v_cvt_pk_bf16_f32 v73, v26, v27
  s_waitcnt lgkmcnt(2)
  v_mfma_f32_32x32x16_bf16 v[32:47], a[168:171], v[56:59], v[32:47]
  ds_read_b128 v[52:55], v12 offset:8192
  v_cvt_pk_bf16_f32 v74, v28, v29
  v_cvt_pk_bf16_f32 v75, v30, v31
  v_mfma_f32_32x32x16_bf16 v[32:47], a[172:175], v[60:63], v[32:47]
  ds_read_b128 v[56:59], v13 offset:8192
  s_add_u32 s38, s37, 0
  buffer_store_dwordx4 v[68:71], v1, s[4:7], s38 offen sc1
  s_waitcnt lgkmcnt(2)
  v_mfma_f32_32x32x16_bf16 v[32:47], a[176:179], v[64:67], v[32:47]
  ds_read_b128 v[60:63], v10 offset:12288
  buffer_store_dwordx4 v[72:75], v1, s[4:7], s38 offen offset:1024 sc1
  s_mov_b64 exec, s[48:49]
  buffer_load_dword v9, v7, s[4:7], 0 offen sc1
  s_mov_b64 exec, -1
  v_mfma_f32_32x32x16_bf16 v[32:47], a[180:183], v[48:51], v[32:47]
  ds_read_b128 v[64:67], v11 offset:12288
  s_waitcnt lgkmcnt(2)
  v_mfma_f32_32x32x16_bf16 v[32:47], a[184:187], v[52:55], v[32:47]
  ds_read_b128 v[48:51], v12 offset:12288
  v_mfma_f32_32x32x16_bf16 v[32:47], a[188:191], v[56:59], v[32:47]
  ds_read_b128 v[52:55], v13 offset:12288
  s_waitcnt lgkmcnt(2)
  v_mfma_f32_32x32x16_bf16 v[32:47], a[192:195], v[60:63], v[32:47]
  ds_read_b128 v[56:59], v10 offset:16384
  v_mfma_f32_32x32x16_bf16 v[32:47], a[196:199], v[64:67], v[32:47]
  ds_read_b128 v[60:63], v11 offset:16384
  s_waitcnt lgkmcnt(2)
  v_mfma_f32_32x32x16_bf16 v[32:47], a[200:203], v[48:51], v[32:47]
  ds_read_b128 v[64:67], v12 offset:16384
  v_mfma_f32_32x32x16_bf16 v[32:47], a[204:207], v[52:55], v[32:47]
  ds_read_b128 v[48:51], v13 offset:16384
  s_waitcnt lgkmcnt(2)
  v_mfma_f32_32x32x16_bf16 v[32:47], a[208:211], v[56:59], v[32:47]
  ds_read_b128 v[52:55], v10 offset:20480
  v_mfma_f32_32x32x16_bf16 v[32:47], a[212:215], v[60:63], v[32:47]
  ds_read_b128 v[56:59], v11 offset:20480
  s_waitcnt lgkmcnt(2)
  v_mfma_f32_32x32x16_bf16 v[32:47], a[216:219], v[64:67], v[32:47]
  ds_read_b128 v[60:63], v12 offset:20480
  v_mfma_f32_32x32x16_bf16 v[32:47], a[220:223], v[48:51], v[32:47]
  ds_read_b128 v[64:67], v13 offset:20480
  s_waitcnt lgkmcnt(2)
  v_mfma_f32_32x32x16_bf16 v[32:47], a[224:227], v[52:55], v[32:47]
  ds_read_b128 v[48:51], v10 offset:24576
  v_mfma_f32_32x32x16_bf16 v[32:47], a[228:231], v[56:59], v[32:47]
  ds_read_b128 v[52:55], v11 offset:24576
  s_waitcnt lgkmcnt(2)
  v_mfma_f32_32x32x16_bf16 v[32:47], a[232:235], v[60:63], v[32:47]
  ds_read_b128 v[56:59], v12 offset:24576
  v_cmp_ge_u32 vcc, s59, v9
  v_mfma_f32_32x32x16_bf16 v[32:47], a[236:239], v[64:67], v[32:47]
  ds_read_b128 v[60:63], v13 offset:24576
  s_waitcnt lgkmcnt(2)
  s_and_b64 vcc, vcc, s[62:63]
  s_cbranch_scc0 L_qkv_w60
  v_mfma_f32_32x32x16_bf16 v[32:47], a[240:243], v[48:51], v[32:47]
  ds_read_b128 v[64:67], v10 offset:28672
  v_mfma_f32_32x32x16_bf16 v[32:47], a[244:247], v[52:55], v[32:47]
  ds_read_b128 v[48:51], v11 offset:28672
  s_waitcnt lgkmcnt(2)
  v_mfma_f32_32x32x16_bf16 v[32:47], a[248:251], v[56:59], v[32:47]
  ds_read_b128 v[52:55], v12 offset:28672
  v_mfma_f32_32x32x16_bf16 v[32:47], a[252:255], v[60:63], v[32:47]
  ds_read_b128 v[56:59], v13 offset:28672
  s_waitcnt lgkmcnt(2)
  v_mfma_f32_32x32x16_bf16 v[32:47], v[80:83], v[64:67], v[32:47]
  ds_read_b128 v[60:63], v10 offset:32768
  v_mfma_f32_32x32x16_bf16 v[32:47], v[84:87], v[48:51], v[32:47]
  ds_read_b128 v[64:67], v11 offset:32768
  s_waitcnt lgkmcnt(2)
  v_mfma_f32_32x32x16_bf16 v[32:47], v[88:91], v[52:55], v[32:47]
  ds_read_b128 v[48:51], v12 offset:32768
  v_mfma_f32_32x32x16_bf16 v[32:47], v[92:95], v[56:59], v[32:47]
  ds_read_b128 v[52:55], v13 offset:32768
  s_waitcnt lgkmcnt(2)
  v_mfma_f32_32x32x16_bf16 v[32:47], v[96:99], v[60:63], v[32:47]
  ds_read_b128 v[56:59], v10 offset:0
  s_mov_b64 exec, s[48:49]
  buffer_load_dword v9, v7, s[4:7], 0 offen sc1
  s_mov_b64 exec, -1
  v_mfma_f32_32x32x16_bf16 v[32:47], v[100:103], v[64:67], v[32:47]
  ds_read_b128 v[60:63], v11 offset:0
  s_waitcnt lgkmcnt(2)
  v_mfma_f32_32x32x16_bf16 v[32:47], v[104:107], v[48:51], v[32:47]
  ds_read_b128 v[64:67], v12 offset:0
  v_mfma_f32_32x32x16_bf16 v[32:47], v[108:111], v[52:55], v[32:47]
  ds_read_b128 v[48:51], v13 offset:0
  s_waitcnt lgkmcnt(2)
  v_mfma_f32_32x32x16_bf16 v[16:31], v[56:59], v[112:115], 0
  ds_read_b128 v[52:55], v10 offset:4096
  v_mfma_f32_32x32x16_bf16 v[16:31], v[60:63], v[116:119], v[16:31]
  ds_read_b128 v[56:59], v11 offset:4096
  s_waitcnt lgkmcnt(2)
  v_mfma_f32_32x32x16_bf16 v[16:31], v[64:67], v[120:123], v[16:31]
  ds_read_b128 v[60:63], v12 offset:4096
  v_mfma_f32_32x32x16_bf16 v[16:31], v[48:51], v[124:127], v[16:31]
  ds_read_b128 v[64:67], v13 offset:4096
  v_cvt_pk_bf16_f32 v68, v32, v33
  v_cvt_pk_bf16_f32 v69, v34, v35
  s_waitcnt lgkmcnt(2)
  v_mfma_f32_32x32x16_bf16 v[16:31], v[52:55], v[128:131], v[16:31]
  ds_read_b128 v[48:51], v10 offset:8192
  v_cvt_pk_bf16_f32 v70, v36, v37
  v_cvt_pk_bf16_f32 v71, v38, v39
  v_mfma_f32_32x32x16_bf16 v[16:31], v[56:59], v[132:135], v[16:31]
  ds_read_b128 v[52:55], v11 offset:8192
  v_cvt_pk_bf16_f32 v72, v40, v41
  v_cvt_pk_bf16_f32 v73, v42, v43
  s_waitcnt lgkmcnt(2)
  v_mfma_f32_32x32x16_bf16 v[16:31], v[60:63], v[136:139], v[16:31]
  ds_read_b128 v[56:59], v12 offset:8192
  v_cvt_pk_bf16_f32 v74, v44, v45
  v_cvt_pk_bf16_f32 v75, v46, v47
  v_mfma_f32_32x32x16_bf16 v[16:31], v[64:67], v[140:143], v[16:31]
  ds_read_b128 v[60:63], v13 offset:8192
  s_add_u32 s38, s37, 8192
  buffer_store_dwordx4 v[68:71], v1, s[4:7], s38 offen sc1
  s_waitcnt lgkmcnt(2)
  v_mfma_f32_32x32x16_bf16 v[16:31], v[48:51], v[144:147], v[16:31]
  ds_read_b128 v[64:67], v10 offset:12288
  buffer_store_dwordx4 v[72:75], v1, s[4:7], s38 offen offset:1024 sc1
  v_mfma_f32_32x32x16_bf16 v[16:31], v[52:55], v[148:151], v[16:31]
  ds_read_b128 v[48:51], v11 offset:12288
  s_waitcnt lgkmcnt(2)
  v_mfma_f32_32x32x16_bf16 v[16:31], v[56:59], v[152:155], v[16:31]
  ds_read_b128 v[52:55], v12 offset:12288
  v_cmp_ge_u32 vcc, s59, v9
  v_mfma_f32_32x32x16_bf16 v[16:31], v[60:63], v[156:159], v[16:31]
  ds_read_b128 v[56:59], v13 offset:12288
  s_waitcnt lgkmcnt(2)
  s_and_b64 vcc, vcc, s[62:63]
  s_cbranch_scc0 L_qkv_w84
  v_mfma_f32_32x32x16_bf16 v[16:31], v[64:67], v[160:163], v[16:31]
  ds_read_b128 v[60:63], v10 offset:16384
  v_mfma_f32_32x32x16_bf16 v[16:31], v[48:51], v[164:167], v[16:31]
  ds_read_b128 v[64:67], v11 offset:16384
  s_waitcnt lgkmcnt(2)
  v_mfma_f32_32x32x16_bf16 v[16:31], v[52:55], v[168:171], v[16:31]
  ds_read_b128 v[48:51], v12 offset:16384
  v_mfma_f32_32x32x16_bf16 v[16:31], v[56:59], v[172:175], v[16:31]
  ds_read_b128 v[52:55], v13 offset:16384
  s_waitcnt lgkmcnt(2)
  v_mfma_f32_32x32x16_bf16 v[16:31], v[60:63], v[176:179], v[16:31]
  ds_read_b128 v[56:59], v10 offset:20480
  v_mfma_f32_32x32x16_bf16 v[16:31], v[64:67], v[180:183], v[16:31]
  ds_read_b128 v[60:63], v11 offset:20480
  s_waitcnt lgkmcnt(2)
  v_mfma_f32_32x32x16_bf16 v[16:31], v[48:51], v[184:187], v[16:31]
  ds_read_b128 v[64:67], v12 offset:20480
  v_mfma_f32_32x32x16_bf16 v[16:31], v[52:55], v[188:191], v[16:31]
  ds_read_b128 v[48:51], v13 offset:20480
  s_waitcnt lgkmcnt(2)
  v_mfma_f32_32x32x16_bf16 v[16:31], v[56:59], v[192:195], v[16:31]
  ds_read_b128 v[52:55], v10 offset:24576
  s_mov_b64 exec, s[48:49]
  buffer_load_dword v9, v7, s[4:7], 0 offen sc1
  s_mov_b64 exec, -1
  v_mfma_f32_32x32x16_bf16 v[16:31], v[60:63], v[196:199], v[16:31]
  ds_read_b128 v[56:59], v11 offset:24576
  s_waitcnt lgkmcnt(2)
  v_mfma_f32_32x32x16_bf16 v[16:31], v[64:67], v[200:203], v[16:31]
  ds_read_b128 v[60:63], v12 offset:24576
  v_mfma_f32_32x32x16_bf16 v[16:31], v[48:51], v[204:207], v[16:31]
  ds_read_b128 v[64:67], v13 offset:24576
  s_waitcnt lgkmcnt(2)
  v_mfma_f32_32x32x16_bf16 v[16:31], v[52:55], v[208:211], v[16:31]
  ds_read_b128 v[48:51], v10 offset:28672
  v_mfma_f32_32x32x16_bf16 v[16:31], v[56:59], v[212:215], v[16:31]
  ds_read_b128 v[52:55], v11 offset:28672
  s_waitcnt lgkmcnt(2)
  v_mfma_f32_32x32x16_bf16 v[16:31], v[60:63], v[216:219], v[16:31]
  ds_read_b128 v[56:59], v12 offset:28672
  v_mfma_f32_32x32x16_bf16 v[16:31], v[64:67], v[220:223], v[16:31]
  ds_read_b128 v[60:63], v13 offset:28672
  s_waitcnt lgkmcnt(2)
  v_mfma_f32_32x32x16_bf16 v[16:31], v[48:51], v[224:227], v[16:31]
  ds_read_b128 v[64:67], v10 offset:32768
  v_mfma_f32_32x32x16_bf16 v[16:31], v[52:55], v[228:231], v[16:31]
  ds_read_b128 v[48:51], v11 offset:32768
  s_waitcnt lgkmcnt(2)
  v_mfma_f32_32x32x16_bf16 v[16:31], v[56:59], v[232:235], v[16:31]
  ds_read_b128 v[52:55], v12 offset:32768
  v_mfma_f32_32x32x16_bf16 v[16:31], v[60:63], v[236:239], v[16:31]
  ds_read_b128 v[56:59], v13 offset:32768
  s_waitcnt lgkmcnt(2)
  v_mfma_f32_32x32x16_bf16 v[16:31], v[64:67], v[240:243], v[16:31]
  v_mfma_f32_32x32x16_bf16 v[16:31], v[48:51], v[244:247], v[16:31]
  s_waitcnt lgkmcnt(0)
  v_mfma_f32_32x32x16_bf16 v[16:31], v[52:55], v[248:251], v[16:31]
  v_mfma_f32_32x32x16_bf16 v[16:31], v[56:59], v[252:255], v[16:31]
  s_add_u32 s38, s37, 16384
  s_nop 10
  v_cvt_pk_bf16_f32 v68, v16, v17
  v_cvt_pk_bf16_f32 v69, v18, v19
  v_cvt_pk_bf16_f32 v70, v20, v21
  v_cvt_pk_bf16_f32 v71, v22, v23
  buffer_store_dwordx4 v[68:71], v1, s[4:7], s38 offen sc1
  v_cvt_pk_bf16_f32 v72, v24, v25
  v_cvt_pk_bf16_f32 v73, v26, v27
  v_cvt_pk_bf16_f32 v74, v28, v29
  v_cvt_pk_bf16_f32 v75, v30, v31
  buffer_store_dwordx4 v[72:75], v1, s[4:7], s38 offen offset:1024 sc1
  v_add_u32 v10, s45, v10
  v_add_u32 v11, s45, v11
  v_add_u32 v12, s45, v12
  v_add_u32 v13, s45, v13
  s_sub_u32 s45, 0, s45
  s_bfe_u32 s35, s32, 0x10006
  s_lshl_b32 s35, s35, 2
  s_add_u32 s47, s46, s35
  s_and_b32 s50, s32, 63
  s_add_u32 s50, s50, 1
  s_waitcnt vmcnt(2)
  v_cmp_ge_u32 vcc, s59, v9
  s_and_b64 vcc, vcc, s[62:63]
  s_cbranch_scc1 L_qkv_drain
  s_add_u32 m0, s34, 0
  s_add_u32 s35, s33, 0
  buffer_load_dwordx4 v2, s[4:7], s35 offen sc1 lds
  s_add_u32 m0, s34, 4096
  s_add_u32 s35, s33, 128
  buffer_load_dwordx4 v2, s[4:7], s35 offen sc1 lds
  s_add_u32 m0, s34, 8192
  s_add_u32 s35, s33, 256
  buffer_load_dwordx4 v2, s[4:7], s35 offen sc1 lds
  s_add_u32 m0, s34, 12288
  s_add_u32 s35, s33, 384
  buffer_load_dwordx4 v2, s[4:7], s35 offen sc1 lds
  s_add_u32 m0, s34, 16384
  s_add_u32 s35, s33, 512
  buffer_load_dwordx4 v2, s[4:7], s35 offen sc1 lds
  s_add_u32 m0, s34, 20480
  s_add_u32 s35, s33, 640
  buffer_load_dwordx4 v2, s[4:7], s35 offen sc1 lds
  s_add_u32 m0, s34, 24576
  s_add_u32 s35, s33, 768
  buffer_load_dwordx4 v2, s[4:7], s35 offen sc1 lds
  s_add_u32 m0, s34, 28672
  s_add_u32 s35, s33, 896
  buffer_load_dwordx4 v2, s[4:7], s35 offen sc1 lds
  s_add_u32 m0, s34, 32768
  s_add_u32 s35, s33, 1024
  buffer_load_dwordx4 v2, s[4:7], s35 offen sc1 lds
  s_waitcnt vmcnt(9)
  v_mov_b32 v6, s50
  s_mov_b64 exec, 1
  buffer_store_dword v6, v5, s[4:7], s47 offen sc1
  s_mov_b64 exec, -1
  s_mov_b32 s47, 0x40000000
  s_waitcnt vmcnt(1)
  s_branch L_qkv_run
L_qkv_drain:
  s_waitcnt vmcnt(0)
  v_mov_b32 v6, s50
  s_mov_b64 exec, 1
  buffer_store_dword v6, v5, s[4:7], s47 offen sc1
  s_mov_b64 exec, -1
  s_mov_b32 s47, 0x40000000
  s_cmp_eq_u32 s42, 0
  s_cbranch_scc1 L_qkv_fetch
  s_endpgm
L_qkv_w12:
  v_mfma_f32_32x32x16_bf16 v[16:31], a[48:51], v[56:59], v[16:31]
  ds_read_b128 v[52:55], v10 offset:16384
  s_add_u32 m0, s34, 0
  s_add_u32 s35, s33, 0
  buffer_load_dwordx4 v2, s[4:7], s35 offen sc1 lds
  v_mfma_f32_32x32x16_bf16 v[16:31], a[52:55], v[60:63], v[16:31]
  ds_read_b128 v[56:59], v11 offset:16384
  s_waitcnt lgkmcnt(2)
  v_mfma_f32_32x32x16_bf16 v[16:31], a[56:59], v[64:67], v[16:31]
  ds_read_b128 v[60:63], v12 offset:16384
  v_mfma_f32_32x32x16_bf16 v[16:31], a[60:63], v[48:51], v[16:31]
  ds_read_b128 v[64:67], v13 offset:16384
  s_waitcnt lgkmcnt(2)
  v_mfma_f32_32x32x16_bf16 v[16:31], a[64:67], v[52:55], v[16:31]
  ds_read_b128 v[48:51], v10 offset:20480
  s_add_u32 m0, s34, 4096
  s_add_u32 s35, s33, 128
  buffer_load_dwordx4 v2, s[4:7], s35 offen sc1 lds
  v_mfma_f32_32x32x16_bf16 v[16:31], a[68:71], v[56:59], v[16:31]
  ds_read_b128 v[52:55], v11 offset:20480
  s_waitcnt lgkmcnt(2)
  v_mfma_f32_32x32x16_bf16 v[16:31], a[72:75], v[60:63], v[16:31]
  ds_read_b128 v[56:59], v12 offset:20480
  v_mfma_f32_32x32x16_bf16 v[16:31], a[76:79], v[64:67], v[16:31]
  ds_read_b128 v[60:63], v13 offset:20480
  s_waitcnt lgkmcnt(2)
  v_mfma_f32_32x32x16_bf16 v[16:31], a[80:83], v[48:51], v[16:31]
  ds_read_b128 v[64:67], v10 offset:24576
  s_add_u32 m0, s34, 8192
  s_add_u32 s35, s33, 256
  buffer_load_dwordx4 v2, s[4:7], s35 offen sc1 lds
  v_mfma_f32_32x32x16_bf16 v[16:31], a[84:87], v[52:55], v[16:31]
  ds_read_b128 v[48:51], v11 offset:24576
  s_waitcnt lgkmcnt(2)
  v_mfma_f32_32x32x16_bf16 v[16:31], a[88:91], v[56:59], v[16:31]
  ds_read_b128 v[52:55], v12 offset:24576
  v_mfma_f32_32x32x16_bf16 v[16:31], a[92:95], v[60:63], v[16:31]
  ds_read_b128 v[56:59], v13 offset:24576
  s_waitcnt lgkmcnt(2)
  v_mfma_f32_32x32x16_bf16 v[16:31], a[96:99], v[64:67], v[16:31]
  ds_read_b128 v[60:63], v10 offset:28672
  s_add_u32 m0, s34, 12288
  s_add_u32 s35, s33, 384
  buffer_load_dwordx4 v2, s[4:7], s35 offen sc1 lds
  s_waitcnt vmcnt(4)
  v_mov_b32 v6, s50
  s_mov_b64 exec, 1
  buffer_store_dword v6, v5, s[4:7], s47 offen sc1
  s_mov_b64 exec, -1
  v_mfma_f32_32x32x16_bf16 v[16:31], a[100:103], v[48:51], v[16:31]
  ds_read_b128 v[64:67], v11 offset:28672
  s_waitcnt lgkmcnt(2)
  v_mfma_f32_32x32x16_bf16 v[16:31], a[104:107], v[52:55], v[16:31]
  ds_read_b128 v[48:51], v12 offset:28672
  v_mfma_f32_32x32x16_bf16 v[16:31], a[108:111], v[56:59], v[16:31]
  ds_read_b128 v[52:55], v13 offset:28672
  s_waitcnt lgkmcnt(2)
  v_mfma_f32_32x32x16_bf16 v[16:31], a[112:115], v[60:63], v[16:31]
  ds_read_b128 v[56:59], v10 offset:32768
  s_add_u32 m0, s34, 16384
  s_add_u32 s35, s33, 512
  buffer_load_dwordx4 v2, s[4:7], s35 offen sc1 lds
  v_mfma_f32_32x32x16_bf16 v[16:31], a[116:119], v[64:67], v[16:31]
  ds_read_b128 v[60:63], v11 offset:32768
  s_waitcnt lgkmcnt(2)
  v_mfma_f32_32x32x16_bf16 v[16:31], a[120:123], v[48:51], v[16:31]
  ds_read_b128 v[64:67], v12 offset:32768
  v_mfma_f32_32x32x16_bf16 v[16:31], a[124:127], v[52:55], v[16:31]
  ds_read_b128 v[48:51], v13 offset:32768
  s_waitcnt lgkmcnt(2)
  v_mfma_f32_32x32x16_bf16 v[16:31], a[128:131], v[56:59], v[16:31]
  ds_read_b128 v[52:55], v10 offset:0
  s_add_u32 m0, s34, 20480
  s_add_u32 s35, s33, 640
  buffer_load_dwordx4 v2, s[4:7], s35 offen sc1 lds
  v_mfma_f32_32x32x16_bf16 v[16:31], a[132:135], v[60:63], v[16:31]
  ds_read_b128 v[56:59], v11 offset:0
  s_waitcnt lgkmcnt(2)
  v_mfma_f32_32x32x16_bf16 v[16:31], a[136:139], v[64:67], v[16:31]
  ds_read_b128 v[60:63], v12 offset:0
  v_mfma_f32_32x32x16_bf16 v[16:31], a[140:143], v[48:51], v[16:31]
  ds_read_b128 v[64:67], v13 offset:0
  s_waitcnt lgkmcnt(2)
  v_mfma_f32_32x32x16_bf16 v[32:47], a[144:147], v[52:55], 0
  ds_read_b128 v[48:51], v10 offset:4096
  s_add_u32 m0, s34, 24576
  s_add_u32 s35, s33, 768
  buffer_load_dwordx4 v2, s[4:7], s35 offen sc1 lds
  v_mfma_f32_32x32x16_bf16 v[32:47], a[148:151], v[56:59], v[32:47]
  ds_read_b128 v[52:55], v11 offset:4096
  s_waitcnt lgkmcnt(2)
  v_mfma_f32_32x32x16_bf16 v[32:47], a[152:155], v[60:63], v[32:47]
  ds_read_b128 v[56:59], v12 offset:4096
  v_mfma_f32_32x32x16_bf16 v[32:47], a[156:159], v[64:67], v[32:47]
  ds_read_b128 v[60:63], v13 offset:4096
  v_cvt_pk_bf16_f32 v68, v16, v17
  v_cvt_pk_bf16_f32 v69, v18, v19
  s_waitcnt lgkmcnt(2)
  v_mfma_f32_32x32x16_bf16 v[32:47], a[160:163], v[48:51], v[32:47]
  ds_read_b128 v[64:67], v10 offset:8192
  s_add_u32 m0, s34, 28672
  s_add_u32 s35, s33, 896
  buffer_load_dwordx4 v2, s[4:7], s35 offen sc1 lds
  v_cvt_pk_bf16_f32 v70, v20, v21
  v_cvt_pk_bf16_f32 v71, v22, v23
  v_mfma_f32_32x32x16_bf16 v[32:47], a[164:167], v[52:55], v[32:47]
  ds_read_b128 v[48:51], v11 offset:8192
  v_cvt_pk_bf16_f32 v72, v24, v25
  v_cvt_pk_bf16_f32 v73, v26, v27
  s_waitcnt lgkmcnt(2)
  v_mfma_f32_32x32x16_bf16 v[32:47], a[168:171], v[56:59], v[32:47]
  ds_read_b128 v[52:55], v12 offset:8192
  v_cvt_pk_bf16_f32 v74, v28, v29
  v_cvt_pk_bf16_f32 v75, v30, v31
  v_mfma_f32_32x32x16_bf16 v[32:47], a[172:175], v[60:63], v[32:47]
  ds_read_b128 v[56:59], v13 offset:8192
  s_add_u32 s38, s37, 0
  buffer_store_dwordx4 v[68:71], v1, s[4:7], s38 offen sc1
  s_waitcnt lgkmcnt(2)
  v_mfma_f32_32x32x16_bf16 v[32:47], a[176:179], v[64:67], v[32:47]
  ds_read_b128 v[60:63], v10 offset:12288
  buffer_store_dwordx4 v[72:75], v1, s[4:7], s38 offen offset:1024 sc1
  s_add_u32 m0, s34, 32768
  s_add_u32 s35, s33, 1024
  buffer_load_dwordx4 v2, s[4:7], s35 offen sc1 lds
  v_mfma_f32_32x32x16_bf16 v[32:47], a[180:183], v[48:51], v[32:47]
  ds_read_b128 v[64:67], v11 offset:12288
  s_waitcnt lgkmcnt(2)
  v_mfma_f32_32x32x16_bf16 v[32:47], a[184:187], v[52:55], v[32:47]
  ds_read_b128 v[48:51], v12 offset:12288
  v_mfma_f32_32x32x16_bf16 v[32:47], a[188:191], v[56:59], v[32:47]
  ds_read_b128 v[52:55], v13 offset:12288
  s_waitcnt lgkmcnt(2)
  v_mfma_f32_32x32x16_bf16 v[32:47], a[192:195], v[60:63], v[32:47]
  ds_read_b128 v[56:59], v10 offset:16384
  v_mfma_f32_32x32x16_bf16 v[32:47], a[196:199], v[64:67], v[32:47]
  ds_read_b128 v[60:63], v11 offset:16384
  s_waitcnt lgkmcnt(2)
  v_mfma_f32_32x32x16_bf16 v[32:47], a[200:203], v[48:51], v[32:47]
  ds_read_b128 v[64:67], v12 offset:16384
  v_mfma_f32_32x32x16_bf16 v[32:47], a[204:207], v[52:55], v[32:47]
  ds_read_b128 v[48:51], v13 offset:16384
  s_waitcnt lgkmcnt(2)
  v_mfma_f32_32x32x16_bf16 v[32:47], a[208:211], v[56:59], v[32:47]
  ds_read_b128 v[52:55], v10 offset:20480
  v_mfma_f32_32x32x16_bf16 v[32:47], a[212:215], v[60:63], v[32:47]
  ds_read_b128 v[56:59], v11 offset:20480
  s_waitcnt lgkmcnt(2)
  v_mfma_f32_32x32x16_bf16 v[32:47], a[216:219], v[64:67], v[32:47]
  ds_read_b128 v[60:63], v12 offset:20480
  v_mfma_f32_32x32x16_bf16 v[32:47], a[220:223], v[48:51], v[32:47]
  ds_read_b128 v[64:67], v13 offset:20480
  s_waitcnt lgkmcnt(2)
  v_mfma_f32_32x32x16_bf16 v[32:47], a[224:227], v[52:55], v[32:47]
  ds_read_b128 v[48:51], v10 offset:24576
  v_mfma_f32_32x32x16_bf16 v[32:47], a[228:231], v[56:59], v[32:47]
  ds_read_b128 v[52:55], v11 offset:24576
  s_waitcnt lgkmcnt(2)
  v_mfma_f32_32x32x16_bf16 v[32:47], a[232:235], v[60:63], v[32:47]
  ds_read_b128 v[56:59], v12 offset:24576
  v_mfma_f32_32x32x16_bf16 v[32:47], a[236:239], v[64:67], v[32:47]
  ds_read_b128 v[60:63], v13 offset:24576
  s_waitcnt lgkmcnt(2)
  v_mfma_f32_32x32x16_bf16 v[32:47], a[240:243], v[48:51], v[32:47]
  ds_read_b128 v[64:67], v10 offset:28672
  v_mfma_f32_32x32x16_bf16 v[32:47], a[244:247], v[52:55], v[32:47]
  ds_read_b128 v[48:51], v11 offset:28672
  s_waitcnt lgkmcnt(2)
  v_mfma_f32_32x32x16_bf16 v[32:47], a[248:251], v[56:59], v[32:47]
  ds_read_b128 v[52:55], v12 offset:28672
  v_mfma_f32_32x32x16_bf16 v[32:47], a[252:255], v[60:63], v[32:47]
  ds_read_b128 v[56:59], v13 offset:28672
  s_waitcnt lgkmcnt(2)
  v_mfma_f32_32x32x16_bf16 v[32:47], v[80:83], v[64:67], v[32:47]
  ds_read_b128 v[60:63], v10 offset:32768
  v_mfma_f32_32x32x16_bf16 v[32:47], v[84:87], v[48:51], v[32:47]
  ds_read_b128 v[64:67], v11 offset:32768
  s_waitcnt lgkmcnt(2)
  v_mfma_f32_32x32x16_bf16 v[32:47], v[88:91], v[52:55], v[32:47]
  ds_read_b128 v[48:51], v12 offset:32768
  v_mfma_f32_32x32x16_bf16 v[32:47], v[92:95], v[56:59], v[32:47]
  ds_read_b128 v[52:55], v13 offset:32768
  s_waitcnt lgkmcnt(2)
  v_mfma_f32_32x32x16_bf16 v[32:47], v[96:99], v[60:63], v[32:47]
  ds_read_b128 v[56:59], v10 offset:0
  v_mfma_f32_32x32x16_bf16 v[32:47], v[100:103], v[64:67], v[32:47]
  ds_read_b128 v[60:63], v11 offset:0
  s_waitcnt lgkmcnt(2)
  v_mfma_f32_32x32x16_bf16 v[32:47], v[104:107], v[48:51], v[32:47]
  ds_read_b128 v[64:67], v12 offset:0
  v_mfma_f32_32x32x16_bf16 v[32:47], v[108:111], v[52:55], v[32:47]
  ds_read_b128 v[48:51], v13 offset:0
  s_waitcnt lgkmcnt(2)
  v_mfma_f32_32x32x16_bf16 v[16:31], v[56:59], v[112:115], 0
  ds_read_b128 v[52:55], v10 offset:4096
  v_mfma_f32_32x32x16_bf16 v[16:31], v[60:63], v[116:119], v[16:31]
  ds_read_b128 v[56:59], v11 offset:4096
  s_waitcnt lgkmcnt(2)
  v_mfma_f32_32x32x16_bf16 v[16:31], v[64:67], v[120:123], v[16:31]
  ds_read_b128 v[60:63], v12 offset:4096
  v_mfma_f32_32x32x16_bf16 v[16:31], v[48:51], v[124:127], v[16:31]
  ds_read_b128 v[64:67], v13 offset:4096
  v_cvt_pk_bf16_f32 v68, v32, v33
  v_cvt_pk_bf16_f32 v69, v34, v35
  s_waitcnt lgkmcnt(2)
  v_mfma_f32_32x32x16_bf16 v[16:31], v[52:55], v[128:131], v[16:31]
  ds_read_b128 v[48:51], v10 offset:8192
  v_cvt_pk_bf16_f32 v70, v36, v37
  v_cvt_pk_bf16_f32 v71, v38, v39
  v_mfma_f32_32x32x16_bf16 v[16:31], v[56:59], v[132:135], v[16:31]
  ds_read_b128 v[52:55], v11 offset:8192
  v_cvt_pk_bf16_f32 v72, v40, v41
  v_cvt_pk_bf16_f32 v73, v42, v43
  s_waitcnt lgkmcnt(2)
  v_mfma_f32_32x32x16_bf16 v[16:31], v[60:63], v[136:139], v[16:31]
  ds_read_b128 v[56:59], v12 offset:8192
  v_cvt_pk_bf16_f32 v74, v44, v45
  v_cvt_pk_bf16_f32 v75, v46, v47
  v_mfma_f32_32x32x16_bf16 v[16:31], v[64:67], v[140:143], v[16:31]
  ds_read_b128 v[60:63], v13 offset:8192
  s_add_u32 s38, s37, 8192
  buffer_store_dwordx4 v[68:71], v1, s[4:7], s38 offen sc1
  s_waitcnt lgkmcnt(2)
  v_mfma_f32_32x32x16_bf16 v[16:31], v[48:51], v[144:147], v[16:31]
  ds_read_b128 v[64:67], v10 offset:12288
  buffer_store_dwordx4 v[72:75], v1, s[4:7], s38 offen offset:1024 sc1
  v_mfma_f32_32x32x16_bf16 v[16:31], v[52:55], v[148:151], v[16:31]
  ds_read_b128 v[48:51], v11 offset:12288
  s_waitcnt lgkmcnt(2)
  v_mfma_f32_32x32x16_bf16 v[16:31], v[56:59], v[152:155], v[16:31]
  ds_read_b128 v[52:55], v12 offset:12288
  v_mfma_f32_32x32x16_bf16 v[16:31], v[60:63], v[156:159], v[16:31]
  ds_read_b128 v[56:59], v13 offset:12288
  s_waitcnt lgkmcnt(2)
  v_mfma_f32_32x32x16_bf16 v[16:31], v[64:67], v[160:163], v[16:31]
  ds_read_b128 v[60:63], v10 offset:16384
  v_mfma_f32_32x32x16_bf16 v[16:31], v[48:51], v[164:167], v[16:31]
  ds_read_b128 v[64:67], v11 offset:16384
  s_waitcnt lgkmcnt(2)
  v_mfma_f32_32x32x16_bf16 v[16:31], v[52:55], v[168:171], v[16:31]
  ds_read_b128 v[48:51], v12 offset:16384
  v_mfma_f32_32x32x16_bf16 v[16:31], v[56:59], v[172:175], v[16:31]
  ds_read_b128 v[52:55], v13 offset:16384
  s_waitcnt lgkmcnt(2)
  v_mfma_f32_32x32x16_bf16 v[16:31], v[60:63], v[176:179], v[16:31]
  ds_read_b128 v[56:59], v10 offset:20480
  v_mfma_f32_32x32x16_bf16 v[16:31], v[64:67], v[180:183], v[16:31]
  ds_read_b128 v[60:63], v11 offset:20480
  s_waitcnt lgkmcnt(2)
  v_mfma_f32_32x32x16_bf16 v[16:31], v[48:51], v[184:187], v[16:31]
  ds_read_b128 v[64:67], v12 offset:20480
  v_mfma_f32_32x32x16_bf16 v[16:31], v[52:55], v[188:191], v[16:31]
  ds_read_b128 v[48:51], v13 offset:20480
  s_waitcnt lgkmcnt(2)
  v_mfma_f32_32x32x16_bf16 v[16:31], v[56:59], v[192:195], v[16:31]
  ds_read_b128 v[52:55], v10 offset:24576
  s_mov_b64 exec, s[48:49]
  buffer_load_dword v9, v7, s[4:7], 0 offen sc1
  s_mov_b64 exec, -1
  v_mfma_f32_32x32x16_bf16 v[16:31], v[60:63], v[196:199], v[16:31]
  ds_read_b128 v[56:59], v11 offset:24576
  s_waitcnt lgkmcnt(2)
  v_mfma_f32_32x32x16_bf16 v[16:31], v[64:67], v[200:203], v[16:31]
  ds_read_b128 v[60:63], v12 offset:24576
  v_mfma_f32_32x32x16_bf16 v[16:31], v[48:51], v[204:207], v[16:31]
  ds_read_b128 v[64:67], v13 offset:24576
  s_waitcnt lgkmcnt(2)
  v_mfma_f32_32x32x16_bf16 v[16:31], v[52:55], v[208:211], v[16:31]
  ds_read_b128 v[48:51], v10 offset:28672
  v_mfma_f32_32x32x16_bf16 v[16:31], v[56:59], v[212:215], v[16:31]
  ds_read_b128 v[52:55], v11 offset:28672
  s_waitcnt lgkmcnt(2)
  v_mfma_f32_32x32x16_bf16 v[16:31], v[60:63], v[216:219], v[16:31]
  ds_read_b128 v[56:59], v12 offset:28672
  v_mfma_f32_32x32x16_bf16 v[16:31], v[64:67], v[220:223], v[16:31]
  ds_read_b128 v[60:63], v13 offset:28672
  s_waitcnt lgkmcnt(2)
  v_mfma_f32_32x32x16_bf16 v[16:31], v[48:51], v[224:227], v[16:31]
  ds_read_b128 v[64:67], v10 offset:32768
  v_mfma_f32_32x32x16_bf16 v[16:31], v[52:55], v[228:231], v[16:31]
  ds_read_b128 v[48:51], v11 offset:32768
  s_waitcnt lgkmcnt(2)
  v_mfma_f32_32x32x16_bf16 v[16:31], v[56:59], v[232:235], v[16:31]
  ds_read_b128 v[52:55], v12 offset:32768
  v_mfma_f32_32x32x16_bf16 v[16:31], v[60:63], v[236:239], v[16:31]
  ds_read_b128 v[56:59], v13 offset:32768
  s_waitcnt lgkmcnt(2)
  v_mfma_f32_32x32x16_bf16 v[16:31], v[64:67], v[240:243], v[16:31]
  v_mfma_f32_32x32x16_bf16 v[16:31], v[48:51], v[244:247], v[16:31]
  s_waitcnt lgkmcnt(0)
  v_mfma_f32_32x32x16_bf16 v[16:31], v[52:55], v[248:251], v[16:31]
  v_mfma_f32_32x32x16_bf16 v[16:31], v[56:59], v[252:255], v[16:31]
  s_add_u32 s38, s37, 16384
  s_nop 10
  v_cvt_pk_bf16_f32 v68, v16, v17
  v_cvt_pk_bf16_f32 v69, v18, v19
  v_cvt_pk_bf16_f32 v70, v20, v21
  v_cvt_pk_bf16_f32 v71, v22, v23
  buffer_store_dwordx4 v[68:71], v1, s[4:7], s38 offen sc1
  v_cvt_pk_bf16_f32 v72, v24, v25
  v_cvt_pk_bf16_f32 v73, v26, v27
  v_cvt_pk_bf16_f32 v74, v28, v29
  v_cvt_pk_bf16_f32 v75, v30, v31
  buffer_store_dwordx4 v[72:75], v1, s[4:7], s38 offen offset:1024 sc1
  v_add_u32 v10, s45, v10
  v_add_u32 v11, s45, v11
  v_add_u32 v12, s45, v12
  v_add_u32 v13, s45, v13
  s_sub_u32 s45, 0, s45
  s_bfe_u32 s35, s32, 0x10006
  s_lshl_b32 s35, s35, 2
  s_add_u32 s47, s46, s35
  s_and_b32 s50, s32, 63
  s_add_u32 s50, s50, 1
  s_waitcnt vmcnt(5)
  s_branch L_qkv_run
L_qkv_w36:
  v_mfma_f32_32x32x16_bf16 v[32:47], a[144:147], v[52:55], 0
  ds_read_b128 v[48:51], v10 offset:4096
  s_add_u32 m0, s34, 0
  s_add_u32 s35, s33, 0
  buffer_load_dwordx4 v2, s[4:7], s35 offen sc1 lds
  v_mfma_f32_32x32x16_bf16 v[32:47], a[148:151], v[56:59], v[32:47]
  ds_read_b128 v[52:55], v11 offset:4096
  s_waitcnt lgkmcnt(2)
  v_mfma_f32_32x32x16_bf16 v[32:47], a[152:155], v[60:63], v[32:47]
  ds_read_b128 v[56:59], v12 offset:4096
  v_mfma_f32_32x32x16_bf16 v[32:47], a[156:159], v[64:67], v[32:47]
  ds_read_b128 v[60:63], v13 offset:4096
  s_add_u32 m0, s34, 4096
  s_add_u32 s35, s33, 128
  buffer_load_dwordx4 v2, s[4:7], s35 offen sc1 lds
  v_cvt_pk_bf16_f32 v68, v16, v17
  v_cvt_pk_bf16_f32 v69, v18, v19
  s_waitcnt lgkmcnt(2)
  v_mfma_f32_32x32x16_bf16 v[32:47], a[160:163], v[48:51], v[32:47]
  ds_read_b128 v[64:67], v10 offset:8192
  v_cvt_pk_bf16_f32 v70, v20, v21
  v_cvt_pk_bf16_f32 v71, v22, v23
  v_mfma_f32_32x32x16_bf16 v[32:47], a[164:167], v[52:55], v[32:47]
  ds_read_b128 v[48:51], v11 offset:8192
  v_cvt_pk_bf16_f32 v72, v24, v25
  v_cvt_pk_bf16_f32 v73, v26, v27
  s_waitcnt lgkmcnt(2)
  v_mfma_f32_32x32x16_bf16 v[32:47], a[168:171], v[56:59], v[32:47]
  ds_read_b128 v[52:55], v12 offset:8192
  s_add_u32 m0, s34, 8192
  s_add_u32 s35, s33, 256
  buffer_load_dwordx4 v2, s[4:7], s35 offen sc1 lds
  v_cvt_pk_bf16_f32 v74, v28, v29
  v_cvt_pk_bf16_f32 v75, v30, v31
  v_mfma_f32_32x32x16_bf16 v[32:47], a[172:175], v[60:63], v[32:47]
  ds_read_b128 v[56:59], v13 offset:8192
  s_add_u32 s38, s37, 0
  buffer_store_dwordx4 v[68:71], v1, s[4:7], s38 offen sc1
  s_waitcnt lgkmcnt(2)
  v_mfma_f32_32x32x16_bf16 v[32:47], a[176:179], v[64:67], v[32:47]
  ds_read_b128 v[60:63], v10 offset:12288
  buffer_store_dwordx4 v[72:75], v1, s[4:7], s38 offen offset:1024 sc1
  v_mfma_f32_32x32x16_bf16 v[32:47], a[180:183], v[48:51], v[32:47]
  ds_read_b128 v[64:67], v11 offset:12288
  s_add_u32 m0, s34, 12288
  s_add_u32 s35, s33, 384
  buffer_load_dwordx4 v2, s[4:7], s35 offen sc1 lds
  s_waitcnt lgkmcnt(2)
  v_mfma_f32_32x32x16_bf16 v[32:47], a[184:187], v[52:55], v[32:47]
  ds_read_b128 v[48:51], v12 offset:12288
  v_mfma_f32_32x32x16_bf16 v[32:47], a[188:191], v[56:59], v[32:47]
  ds_read_b128 v[52:55], v13 offset:12288
  s_waitcnt lgkmcnt(2)
  v_mfma_f32_32x32x16_bf16 v[32:47], a[192:195], v[60:63], v[32:47]
  ds_read_b128 v[56:59], v10 offset:16384
  s_add_u32 m0, s34, 16384
  s_add_u32 s35, s33, 512
  buffer_load_dwordx4 v2, s[4:7], s35 offen sc1 lds
  v_mfma_f32_32x32x16_bf16 v[32:47], a[196:199], v[64:67], v[32:47]
  ds_read_b128 v[60:63], v11 offset:16384
  s_waitcnt lgkmcnt(2)
  v_mfma_f32_32x32x16_bf16 v[32:47], a[200:203], v[48:51], v[32:47]
  ds_read_b128 v[64:67], v12 offset:16384
  v_mfma_f32_32x32x16_bf16 v[32:47], a[204:207], v[52:55], v[32:47]
  ds_read_b128 v[48:51], v13 offset:16384
  s_add_u32 m0, s34, 20480
  s_add_u32 s35, s33, 640
  buffer_load_dwordx4 v2, s[4:7], s35 offen sc1 lds
  s_waitcnt lgkmcnt(2)
  v_mfma_f32_32x32x16_bf16 v[32:47], a[208:211], v[56:59], v[32:47]
  ds_read_b128 v[52:55], v10 offset:20480
  v_mfma_f32_32x32x16_bf16 v[32:47], a[212:215], v[60:63], v[32:47]
  ds_read_b128 v[56:59], v11 offset:20480
  s_waitcnt lgkmcnt(2)
  v_mfma_f32_32x32x16_bf16 v[32:47], a[216:219], v[64:67], v[32:47]
  ds_read_b128 v[60:63], v12 offset:20480
  s_add_u32 m0, s34, 24576
  s_add_u32 s35, s33, 768
  buffer_load_dwordx4 v2, s[4:7], s35 offen sc1 lds
  v_mfma_f32_32x32x16_bf16 v[32:47], a[220:223], v[48:51], v[32:47]
  ds_read_b128 v[64:67], v13 offset:20480
  s_waitcnt lgkmcnt(2)
  v_mfma_f32_32x32x16_bf16 v[32:47], a[224:227], v[52:55], v[32:47]
  ds_read_b128 v[48:51], v10 offset:24576
  v_mfma_f32_32x32x16_bf16 v[32:47], a[228:231], v[56:59], v[32:47]
  ds_read_b128 v[52:55], v11 offset:24576
  s_add_u32 m0, s34, 28672
  s_add_u32 s35, s33, 896
  buffer_load_dwordx4 v2, s[4:7], s35 offen sc1 lds
  s_waitcnt lgkmcnt(2)
  v_mfma_f32_32x32x16_bf16 v[32:47], a[232:235], v[60:63], v[32:47]
  ds_read_b128 v[56:59], v12 offset:24576
  v_mfma_f32_32x32x16_bf16 v[32:47], a[236:239], v[64:67], v[32:47]
  ds_read_b128 v[60:63], v13 offset:24576
  s_waitcnt lgkmcnt(2)
  v_mfma_f32_32x32x16_bf16 v[32:47], a[240:243], v[48:51], v[32:47]
  ds_read_b128 v[64:67], v10 offset:28672
  s_add_u32 m0, s34, 32768
  s_add_u32 s35, s33, 1024
  buffer_load_dwordx4 v2, s[4:7], s35 offen sc1 lds
  v_mfma_f32_32x32x16_bf16 v[32:47], a[244:247], v[52:55], v[32:47]
  ds_read_b128 v[48:51], v11 offset:28672
  s_waitcnt lgkmcnt(2)
  v_mfma_f32_32x32x16_bf16 v[32:47], a[248:251], v[56:59], v[32:47]
  ds_read_b128 v[52:55], v12 offset:28672
  v_mfma_f32_32x32x16_bf16 v[32:47], a[252:255], v[60:63], v[32:47]
  ds_read_b128 v[56:59], v13 offset:28672
  s_waitcnt lgkmcnt(2)
  v_mfma_f32_32x32x16_bf16 v[32:47], v[80:83], v[64:67], v[32:47]
  ds_read_b128 v[60:63], v10 offset:32768
  v_mfma_f32_32x32x16_bf16 v[32:47], v[84:87], v[48:51], v[32:47]
  ds_read_b128 v[64:67], v11 offset:32768
  s_waitcnt lgkmcnt(2)
  v_mfma_f32_32x32x16_bf16 v[32:47], v[88:91], v[52:55], v[32:47]
  ds_read_b128 v[48:51], v12 offset:32768
  v_mfma_f32_32x32x16_bf16 v[32:47], v[92:95], v[56:59], v[32:47]
  ds_read_b128 v[52:55], v13 offset:32768
  s_waitcnt lgkmcnt(2)
  v_mfma_f32_32x32x16_bf16 v[32:47], v[96:99], v[60:63], v[32:47]
  ds_read_b128 v[56:59], v10 offset:0
  v_mfma_f32_32x32x16_bf16 v[32:47], v[100:103], v[64:67], v[32:47]
  ds_read_b128 v[60:63], v11 offset:0
  s_waitcnt lgkmcnt(2)
  v_mfma_f32_32x32x16_bf16 v[32:47], v[104:107], v[48:51], v[32:47]
  ds_read_b128 v[64:67], v12 offset:0
  v_mfma_f32_32x32x16_bf16 v[32:47], v[108:111], v[52:55], v[32:47]
  ds_read_b128 v[48:51], v13 offset:0
  s_waitcnt lgkmcnt(2)
  v_mfma_f32_32x32x16_bf16 v[16:31], v[56:59], v[112:115], 0
  ds_read_b128 v[52:55], v10 offset:4096
  v_mfma_f32_32x32x16_bf16 v[16:31], v[60:63], v[116:119], v[16:31]
  ds_read_b128 v[56:59], v11 offset:4096
  s_waitcnt lgkmcnt(2)
  v_mfma_f32_32x32x16_bf16 v[16:31], v[64:67], v[120:123], v[16:31]
  ds_read_b128 v[60:63], v12 offset:4096
  v_mfma_f32_32x32x16_bf16 v[16:31], v[48:51], v[124:127], v[16:31]
  ds_read_b128 v[64:67], v13 offset:4096
  v_cvt_pk_bf16_f32 v68, v32, v33
  v_cvt_pk_bf16_f32 v69, v34, v35
  s_waitcnt lgkmcnt(2)
  v_mfma_f32_32x32x16_bf16 v[16:31], v[52:55], v[128:131], v[16:31]
  ds_read_b128 v[48:51], v10 offset:8192
  v_cvt_pk_bf16_f32 v70, v36, v37
  v_cvt_pk_bf16_f32 v71, v38, v39
  v_mfma_f32_32x32x16_bf16 v[16:31], v[56:59], v[132:135], v[16:31]
  ds_read_b128 v[52:55], v11 offset:8192
  v_cvt_pk_bf16_f32 v72, v40, v41
  v_cvt_pk_bf16_f32 v73, v42, v43
  s_waitcnt lgkmcnt(2)
  v_mfma_f32_32x32x16_bf16 v[16:31], v[60:63], v[136:139], v[16:31]
  ds_read_b128 v[56:59], v12 offset:8192
  v_cvt_pk_bf16_f32 v74, v44, v45
  v_cvt_pk_bf16_f32 v75, v46, v47
  v_mfma_f32_32x32x16_bf16 v[16:31], v[64:67], v[140:143], v[16:31]
  ds_read_b128 v[60:63], v13 offset:8192
  s_add_u32 s38, s37, 8192
  buffer_store_dwordx4 v[68:71], v1, s[4:7], s38 offen sc1
  s_waitcnt lgkmcnt(2)
  v_mfma_f32_32x32x16_bf16 v[16:31], v[48:51], v[144:147], v[16:31]
  ds_read_b128 v[64:67], v10 offset:12288
  buffer_store_dwordx4 v[72:75], v1, s[4:7], s38 offen offset:1024 sc1
  v_mfma_f32_32x32x16_bf16 v[16:31], v[52:55], v[148:151], v[16:31]
  ds_read_b128 v[48:51], v11 offset:12288
  s_waitcnt lgkmcnt(2)
  v_mfma_f32_32x32x16_bf16 v[16:31], v[56:59], v[152:155], v[16:31]
  ds_read_b128 v[52:55], v12 offset:12288
  v_mfma_f32_32x32x16_bf16 v[16:31], v[60:63], v[156:159], v[16:31]
  ds_read_b128 v[56:59], v13 offset:12288
  s_waitcnt lgkmcnt(2)
  v_mfma_f32_32x32x16_bf16 v[16:31], v[64:67], v[160:163], v[16:31]
  ds_read_b128 v[60:63], v10 offset:16384
  v_mfma_f32_32x32x16_bf16 v[16:31], v[48:51], v[164:167], v[16:31]
  ds_read_b128 v[64:67], v11 offset:16384
  s_waitcnt lgkmcnt(2)
  v_mfma_f32_32x32x16_bf16 v[16:31], v[52:55], v[168:171], v[16:31]
  ds_read_b128 v[48:51], v12 offset:16384
  v_mfma_f32_32x32x16_bf16 v[16:31], v[56:59], v[172:175], v[16:31]
  ds_read_b128 v[52:55], v13 offset:16384
  s_waitcnt lgkmcnt(2)
  v_mfma_f32_32x32x16_bf16 v[16:31], v[60:63], v[176:179], v[16:31]
  ds_read_b128 v[56:59], v10 offset:20480
  v_mfma_f32_32x32x16_bf16 v[16:31], v[64:67], v[180:183], v[16:31]
  ds_read_b128 v[60:63], v11 offset:20480
  s_waitcnt lgkmcnt(2)
  v_mfma_f32_32x32x16_bf16 v[16:31], v[48:51], v[184:187], v[16:31]
  ds_read_b128 v[64:67], v12 offset:20480
  v_mfma_f32_32x32x16_bf16 v[16:31], v[52:55], v[188:191], v[16:31]
  ds_read_b128 v[48:51], v13 offset:20480
  s_waitcnt lgkmcnt(2)
  v_mfma_f32_32x32x16_bf16 v[16:31], v[56:59], v[192:195], v[16:31]
  ds_read_b128 v[52:55], v10 offset:24576
  s_mov_b64 exec, s[48:49]
  buffer_load_dword v9, v7, s[4:7], 0 offen sc1
  s_mov_b64 exec, -1
  v_mfma_f32_32x32x16_bf16 v[16:31], v[60:63], v[196:199], v[16:31]
  ds_read_b128 v[56:59], v11 offset:24576
  s_waitcnt lgkmcnt(2)
  v_mfma_f32_32x32x16_bf16 v[16:31], v[64:67], v[200:203], v[16:31]
  ds_read_b128 v[60:63], v12 offset:24576
  v_mfma_f32_32x32x16_bf16 v[16:31], v[48:51], v[204:207], v[16:31]
  ds_read_b128 v[64:67], v13 offset:24576
  s_waitcnt lgkmcnt(2)
  v_mfma_f32_32x32x16_bf16 v[16:31], v[52:55], v[208:211], v[16:31]
  ds_read_b128 v[48:51], v10 offset:28672
  v_mfma_f32_32x32x16_bf16 v[16:31], v[56:59], v[212:215], v[16:31]
  ds_read_b128 v[52:55], v11 offset:28672
  s_waitcnt lgkmcnt(2)
  v_mfma_f32_32x32x16_bf16 v[16:31], v[60:63], v[216:219], v[16:31]
  ds_read_b128 v[56:59], v12 offset:28672
  v_mfma_f32_32x32x16_bf16 v[16:31], v[64:67], v[220:223], v[16:31]
  ds_read_b128 v[60:63], v13 offset:28672
  s_waitcnt lgkmcnt(2)
  v_mfma_f32_32x32x16_bf16 v[16:31], v[48:51], v[224:227], v[16:31]
  ds_read_b128 v[64:67], v10 offset:32768
  v_mfma_f32_32x32x16_bf16 v[16:31], v[52:55], v[228:231], v[16:31]
  ds_read_b128 v[48:51], v11 offset:32768
  s_waitcnt lgkmcnt(2)
  v_mfma_f32_32x32x16_bf16 v[16:31], v[56:59], v[232:235], v[16:31]
  ds_read_b128 v[52:55], v12 offset:32768
  v_mfma_f32_32x32x16_bf16 v[16:31], v[60:63], v[236:239], v[16:31]
  ds_read_b128 v[56:59], v13 offset:32768
  s_waitcnt lgkmcnt(2)
  v_mfma_f32_32x32x16_bf16 v[16:31], v[64:67], v[240:243], v[16:31]
  v_mfma_f32_32x32x16_bf16 v[16:31], v[48:51], v[244:247], v[16:31]
  s_waitcnt lgkmcnt(0)
  v_mfma_f32_32x32x16_bf16 v[16:31], v[52:55], v[248:251], v[16:31]
  v_mfma_f32_32x32x16_bf16 v[16:31], v[56:59], v[252:255], v[16:31]
  s_add_u32 s38, s37, 16384
  s_nop 10
  v_cvt_pk_bf16_f32 v68, v16, v17
  v_cvt_pk_bf16_f32 v69, v18, v19
  v_cvt_pk_bf16_f32 v70, v20, v21
  v_cvt_pk_bf16_f32 v71, v22, v23
  buffer_store_dwordx4 v[68:71], v1, s[4:7], s38 offen sc1
  v_cvt_pk_bf16_f32 v72, v24, v25
  v_cvt_pk_bf16_f32 v73, v26, v27
  v_cvt_pk_bf16_f32 v74, v28, v29
  v_cvt_pk_bf16_f32 v75, v30, v31
  buffer_store_dwordx4 v[72:75], v1, s[4:7], s38 offen offset:1024 sc1
  v_add_u32 v10, s45, v10
  v_add_u32 v11, s45, v11
  v_add_u32 v12, s45, v12
  v_add_u32 v13, s45, v13
  s_sub_u32 s45, 0, s45
  s_bfe_u32 s35, s32, 0x10006
  s_lshl_b32 s35, s35, 2
  s_add_u32 s47, s46, s35
  s_and_b32 s50, s32, 63
  s_add_u32 s50, s50, 1
  s_waitcnt vmcnt(5)
  s_branch L_qkv_run
L_qkv_w60:
  v_mfma_f32_32x32x16_bf16 v[32:47], a[240:243], v[48:51], v[32:47]
  ds_read_b128 v[64:67], v10 offset:28672
  s_add_u32 m0, s34, 0
  s_add_u32 s35, s33, 0
  buffer_load_dwordx4 v2, s[4:7], s35 offen sc1 lds
  v_mfma_f32_32x32x16_bf16 v[32:47], a[244:247], v[52:55], v[32:47]
  ds_read_b128 v[48:51], v11 offset:28672
  s_waitcnt lgkmcnt(2)
  v_mfma_f32_32x32x16_bf16 v[32:47], a[248:251], v[56:59], v[32:47]
  ds_read_b128 v[52:55], v12 offset:28672
  v_mfma_f32_32x32x16_bf16 v[32:47], a[252:255], v[60:63], v[32:47]
  ds_read_b128 v[56:59], v13 offset:28672
  s_add_u32 m0, s34, 4096
  s_add_u32 s35, s33, 128
  buffer_load_dwordx4 v2, s[4:7], s35 offen sc1 lds
  s_waitcnt lgkmcnt(2)
  v_mfma_f32_32x32x16_bf16 v[32:47], v[80:83], v[64:67], v[32:47]
  ds_read_b128 v[60:63], v10 offset:32768
  v_mfma_f32_32x32x16_bf16 v[32:47], v[84:87], v[48:51], v[32:47]
  ds_read_b128 v[64:67], v11 offset:32768
  s_waitcnt lgkmcnt(2)
  v_mfma_f32_32x32x16_bf16 v[32:47], v[88:91], v[52:55], v[32:47]
  ds_read_b128 v[48:51], v12 offset:32768
  s_add_u32 m0, s34, 8192
  s_add_u32 s35, s33, 256
  buffer_load_dwordx4 v2, s[4:7], s35 offen sc1 lds
  v_mfma_f32_32x32x16_bf16 v[32:47], v[92:95], v[56:59], v[32:47]
  ds_read_b128 v[52:55], v13 offset:32768
  s_waitcnt lgkmcnt(2)
  v_mfma_f32_32x32x16_bf16 v[32:47], v[96:99], v[60:63], v[32:47]
  ds_read_b128 v[56:59], v10 offset:0
  v_mfma_f32_32x32x16_bf16 v[32:47], v[100:103], v[64:67], v[32:47]
  ds_read_b128 v[60:63], v11 offset:0
  s_add_u32 m0, s34, 12288
  s_add_u32 s35, s33, 384
  buffer_load_dwordx4 v2, s[4:7], s35 offen sc1 lds
  s_waitcnt lgkmcnt(2)
  v_mfma_f32_32x32x16_bf16 v[32:47], v[104:107], v[48:51], v[32:47]
  ds_read_b128 v[64:67], v12 offset:0
  v_mfma_f32_32x32x16_bf16 v[32:47], v[108:111], v[52:55], v[32:47]
  ds_read_b128 v[48:51], v13 offset:0
  s_waitcnt lgkmcnt(2)
  v_mfma_f32_32x32x16_bf16 v[16:31], v[56:59], v[112:115], 0
  ds_read_b128 v[52:55], v10 offset:4096
  s_add_u32 m0, s34, 16384
  s_add_u32 s35, s33, 512
  buffer_load_dwordx4 v2, s[4:7], s35 offen sc1 lds
  v_mfma_f32_32x32x16_bf16 v[16:31], v[60:63], v[116:119], v[16:31]
  ds_read_b128 v[56:59], v11 offset:4096
  s_waitcnt lgkmcnt(2)
  v_mfma_f32_32x32x16_bf16 v[16:31], v[64:67], v[120:123], v[16:31]
  ds_read_b128 v[60:63], v12 offset:4096
  v_mfma_f32_32x32x16_bf16 v[16:31], v[48:51], v[124:127], v[16:31]
  ds_read_b128 v[64:67], v13 offset:4096
  s_add_u32 m0, s34, 20480
  s_add_u32 s35, s33, 640
  buffer_load_dwordx4 v2, s[4:7], s35 offen sc1 lds
  v_cvt_pk_bf16_f32 v68, v32, v33
  v_cvt_pk_bf16_f32 v69, v34, v35
  s_waitcnt lgkmcnt(2)
  v_mfma_f32_32x32x16_bf16 v[16:31], v[52:55], v[128:131], v[16:31]
  ds_read_b128 v[48:51], v10 offset:8192
  v_cvt_pk_bf16_f32 v70, v36, v37
  v_cvt_pk_bf16_f32 v71, v38, v39
  v_mfma_f32_32x32x16_bf16 v[16:31], v[56:59], v[132:135], v[16:31]
  ds_read_b128 v[52:55], v11 offset:8192
  v_cvt_pk_bf16_f32 v72, v40, v41
  v_cvt_pk_bf16_f32 v73, v42, v43
  s_waitcnt lgkmcnt(2)
  v_mfma_f32_32x32x16_bf16 v[16:31], v[60:63], v[136:139], v[16:31]
  ds_read_b128 v[56:59], v12 offset:8192
  s_add_u32 m0, s34, 24576
  s_add_u32 s35, s33, 768
  buffer_load_dwordx4 v2, s[4:7], s35 offen sc1 lds
  v_cvt_pk_bf16_f32 v74, v44, v45
  v_cvt_pk_bf16_f32 v75, v46, v47
  v_mfma_f32_32x32x16_bf16 v[16:31], v[64:67], v[140:143], v[16:31]
  ds_read_b128 v[60:63], v13 offset:8192
  s_add_u32 s38, s37, 8192
  buffer_store_dwordx4 v[68:71], v1, s[4:7], s38 offen sc1
  s_waitcnt lgkmcnt(2)
  v_mfma_f32_32x32x16_bf16 v[16:31], v[48:51], v[144:147], v[16:31]
  ds_read_b128 v[64:67], v10 offset:12288
  buffer_store_dwordx4 v[72:75], v1, s[4:7], s38 offen offset:1024 sc1
  v_mfma_f32_32x32x16_bf16 v[16:31], v[52:55], v[148:151], v[16:31]
  ds_read_b128 v[48:51], v11 offset:12288
  s_add_u32 m0, s34, 28672
  s_add_u32 s35, s33, 896
  buffer_load_dwordx4 v2, s[4:7], s35 offen sc1 lds
  s_waitcnt lgkmcnt(2)
  v_mfma_f32_32x32x16_bf16 v[16:31], v[56:59], v[152:155], v[16:31]
  ds_read_b128 v[52:55], v12 offset:12288
  v_mfma_f32_32x32x16_bf16 v[16:31], v[60:63], v[156:159], v[16:31]
  ds_read_b128 v[56:59], v13 offset:12288
  s_waitcnt lgkmcnt(2)
  v_mfma_f32_32x32x16_bf16 v[16:31], v[64:67], v[160:163], v[16:31]
  ds_read_b128 v[60:63], v10 offset:16384
  s_add_u32 m0, s34, 32768
  s_add_u32 s35, s33, 1024
  buffer_load_dwordx4 v2, s[4:7], s35 offen sc1 lds
  v_mfma_f32_32x32x16_bf16 v[16:31], v[48:51], v[164:167], v[16:31]
  ds_read_b128 v[64:67], v11 offset:16384
  s_waitcnt lgkmcnt(2)
  v_mfma_f32_32x32x16_bf16 v[16:31], v[52:55], v[168:171], v[16:31]
  ds_read_b128 v[48:51], v12 offset:16384
  v_mfma_f32_32x32x16_bf16 v[16:31], v[56:59], v[172:175], v[16:31]
  ds_read_b128 v[52:55], v13 offset:16384
  s_waitcnt lgkmcnt(2)
  v_mfma_f32_32x32x16_bf16 v[16:31], v[60:63], v[176:179], v[16:31]
  ds_read_b128 v[56:59], v10 offset:20480
  v_mfma_f32_32x32x16_bf16 v[16:31], v[64:67], v[180:183], v[16:31]
  ds_read_b128 v[60:63], v11 offset:20480
  s_waitcnt lgkmcnt(2)
  v_mfma_f32_32x32x16_bf16 v[16:31], v[48:51], v[184:187], v[16:31]
  ds_read_b128 v[64:67], v12 offset:20480
  v_mfma_f32_32x32x16_bf16 v[16:31], v[52:55], v[188:191], v[16:31]
  ds_read_b128 v[48:51], v13 offset:20480
  s_waitcnt lgkmcnt(2)
  v_mfma_f32_32x32x16_bf16 v[16:31], v[56:59], v[192:195], v[16:31]
  ds_read_b128 v[52:55], v10 offset:24576
  s_mov_b64 exec, s[48:49]
  buffer_load_dword v9, v7, s[4:7], 0 offen sc1
  s_mov_b64 exec, -1
  v_mfma_f32_32x32x16_bf16 v[16:31], v[60:63], v[196:199], v[16:31]
  ds_read_b128 v[56:59], v11 offset:24576
  s_waitcnt lgkmcnt(2)
  v_mfma_f32_32x32x16_bf16 v[16:31], v[64:67], v[200:203], v[16:31]
  ds_read_b128 v[60:63], v12 offset:24576
  v_mfma_f32_32x32x16_bf16 v[16:31], v[48:51], v[204:207], v[16:31]
  ds_read_b128 v[64:67], v13 offset:24576
  s_waitcnt lgkmcnt(2)
  v_mfma_f32_32x32x16_bf16 v[16:31], v[52:55], v[208:211], v[16:31]
  ds_read_b128 v[48:51], v10 offset:28672
  v_mfma_f32_32x32x16_bf16 v[16:31], v[56:59], v[212:215], v[16:31]
  ds_read_b128 v[52:55], v11 offset:28672
  s_waitcnt lgkmcnt(2)
  v_mfma_f32_32x32x16_bf16 v[16:31], v[60:63], v[216:219], v[16:31]
  ds_read_b128 v[56:59], v12 offset:28672
  v_mfma_f32_32x32x16_bf16 v[16:31], v[64:67], v[220:223], v[16:31]
  ds_read_b128 v[60:63], v13 offset:28672
  s_waitcnt lgkmcnt(2)
  v_mfma_f32_32x32x16_bf16 v[16:31], v[48:51], v[224:227], v[16:31]
  ds_read_b128 v[64:67], v10 offset:32768
  v_mfma_f32_32x32x16_bf16 v[16:31], v[52:55], v[228:231], v[16:31]
  ds_read_b128 v[48:51], v11 offset:32768
  s_waitcnt lgkmcnt(2)
  v_mfma_f32_32x32x16_bf16 v[16:31], v[56:59], v[232:235], v[16:31]
  ds_read_b128 v[52:55], v12 offset:32768
  v_mfma_f32_32x32x16_bf16 v[16:31], v[60:63], v[236:239], v[16:31]
  ds_read_b128 v[56:59], v13 offset:32768
  s_waitcnt lgkmcnt(2)
  v_mfma_f32_32x32x16_bf16 v[16:31], v[64:67], v[240:243], v[16:31]
  v_mfma_f32_32x32x16_bf16 v[16:31], v[48:51], v[244:247], v[16:31]
  s_waitcnt lgkmcnt(0)
  v_mfma_f32_32x32x16_bf16 v[16:31], v[52:55], v[248:251], v[16:31]
  v_mfma_f32_32x32x16_bf16 v[16:31], v[56:59], v[252:255], v[16:31]
  s_add_u32 s38, s37, 16384
  s_nop 10
  v_cvt_pk_bf16_f32 v68, v16, v17
  v_cvt_pk_bf16_f32 v69, v18, v19
  v_cvt_pk_bf16_f32 v70, v20, v21
  v_cvt_pk_bf16_f32 v71, v22, v23
  buffer_store_dwordx4 v[68:71], v1, s[4:7], s38 offen sc1
  v_cvt_pk_bf16_f32 v72, v24, v25
  v_cvt_pk_bf16_f32 v73, v26, v27
  v_cvt_pk_bf16_f32 v74, v28, v29
  v_cvt_pk_bf16_f32 v75, v30, v31
  buffer_store_dwordx4 v[72:75], v1, s[4:7], s38 offen offset:1024 sc1
  v_add_u32 v10, s45, v10
  v_add_u32 v11, s45, v11
  v_add_u32 v12, s45, v12
  v_add_u32 v13, s45, v13
  s_sub_u32 s45, 0, s45
  s_bfe_u32 s35, s32, 0x10006
  s_lshl_b32 s35, s35, 2
  s_add_u32 s47, s46, s35
  s_and_b32 s50, s32, 63
  s_add_u32 s50, s50, 1
  s_waitcnt vmcnt(3)
  s_branch L_qkv_run
L_qkv_w84:
  v_mfma_f32_32x32x16_bf16 v[16:31], v[64:67], v[160:163], v[16:31]
  ds_read_b128 v[60:63], v10 offset:16384
  s_add_u32 m0, s34, 0
  s_add_u32 s35, s33, 0
  buffer_load_dwordx4 v2, s[4:7], s35 offen sc1 lds
  v_mfma_f32_32x32x16_bf16 v[16:31], v[48:51], v[164:167], v[16:31]
  ds_read_b128 v[64:67], v11 offset:16384
  s_waitcnt lgkmcnt(2)
  v_mfma_f32_32x32x16_bf16 v[16:31], v[52:55], v[168:171], v[16:31]
  ds_read_b128 v[48:51], v12 offset:16384
  s_add_u32 m0, s34, 4096
  s_add_u32 s35, s33, 128
  buffer_load_dwordx4 v2, s[4:7], s35 offen sc1 lds
  v_mfma_f32_32x32x16_bf16 v[16:31], v[56:59], v[172:175], v[16:31]
  ds_read_b128 v[52:55], v13 offset:16384
  s_waitcnt lgkmcnt(2)
  v_mfma_f32_32x32x16_bf16 v[16:31], v[60:63], v[176:179], v[16:31]
  ds_read_b128 v[56:59], v10 offset:20480
  s_add_u32 m0, s34, 8192
  s_add_u32 s35, s33, 256
  buffer_load_dwordx4 v2, s[4:7], s35 offen sc1 lds
  v_mfma_f32_32x32x16_bf16 v[16:31], v[64:67], v[180:183], v[16:31]
  ds_read_b128 v[60:63], v11 offset:20480
  s_waitcnt lgkmcnt(2)
  v_mfma_f32_32x32x16_bf16 v[16:31], v[48:51], v[184:187], v[16:31]
  ds_read_b128 v[64:67], v12 offset:20480
  s_add_u32 m0, s34, 12288
  s_add_u32 s35, s33, 384
  buffer_load_dwordx4 v2, s[4:7], s35 offen sc1 lds
  v_mfma_f32_32x32x16_bf16 v[16:31], v[52:55], v[188:191], v[16:31]
  ds_read_b128 v[48:51], v13 offset:20480
  s_waitcnt lgkmcnt(2)
  v_mfma_f32_32x32x16_bf16 v[16:31], v[56:59], v[192:195], v[16:31]
  ds_read_b128 v[52:55], v10 offset:24576
  s_add_u32 m0, s34, 16384
  s_add_u32 s35, s33, 512
  buffer_load_dwordx4 v2, s[4:7], s35 offen sc1 lds
  s_mov_b64 exec, s[48:49]
  buffer_load_dword v9, v7, s[4:7], 0 offen sc1
  s_mov_b64 exec, -1
  v_mfma_f32_32x32x16_bf16 v[16:31], v[60:63], v[196:199], v[16:31]
  ds_read_b128 v[56:59], v11 offset:24576
  s_waitcnt lgkmcnt(2)
  v_mfma_f32_32x32x16_bf16 v[16:31], v[64:67], v[200:203], v[16:31]
  ds_read_b128 v[60:63], v12 offset:24576
  s_add_u32 m0, s34, 20480
  s_add_u32 s35, s33, 640
  buffer_load_dwordx4 v2, s[4:7], s35 offen sc1 lds
  v_mfma_f32_32x32x16_bf16 v[16:31], v[48:51], v[204:207], v[16:31]
  ds_read_b128 v[64:67], v13 offset:24576
  s_waitcnt lgkmcnt(2)
  v_mfma_f32_32x32x16_bf16 v[16:31], v[52:55], v[208:211], v[16:31]
  ds_read_b128 v[48:51], v10 offset:28672
  s_add_u32 m0, s34, 24576
  s_add_u32 s35, s33, 768
  buffer_load_dwordx4 v2, s[4:7], s35 offen sc1 lds
  v_mfma_f32_32x32x16_bf16 v[16:31], v[56:59], v[212:215], v[16:31]
  ds_read_b128 v[52:55], v11 offset:28672
  s_waitcnt lgkmcnt(2)
  v_mfma_f32_32x32x16_bf16 v[16:31], v[60:63], v[216:219], v[16:31]
  ds_read_b128 v[56:59], v12 offset:28672
  s_add_u32 m0, s34, 28672
  s_add_u32 s35, s33, 896
  buffer_load_dwordx4 v2, s[4:7], s35 offen sc1 lds
  v_mfma_f32_32x32x16_bf16 v[16:31], v[64:67], v[220:223], v[16:31]
  ds_read_b128 v[60:63], v13 offset:28672
  s_waitcnt lgkmcnt(2)
  v_mfma_f32_32x32x16_bf16 v[16:31], v[48:51], v[224:227], v[16:31]
  ds_read_b128 v[64:67], v10 offset:32768
  s_add_u32 m0, s34, 32768
  s_add_u32 s35, s33, 1024
  buffer_load_dwordx4 v2, s[4:7], s35 offen sc1 lds
  v_mfma_f32_32x32x16_bf16 v[16:31], v[52:55], v[228:231], v[16:31]
  ds_read_b128 v[48:51], v11 offset:32768
  s_waitcnt lgkmcnt(2)
  v_mfma_f32_32x32x16_bf16 v[16:31], v[56:59], v[232:235], v[16:31]
  ds_read_b128 v[52:55], v12 offset:32768
  v_mfma_f32_32x32x16_bf16 v[16:31], v[60:63], v[236:239], v[16:31]
  ds_read_b128 v[56:59], v13 offset:32768
  s_waitcnt lgkmcnt(2)
  v_mfma_f32_32x32x16_bf16 v[16:31], v[64:67], v[240:243], v[16:31]
  v_mfma_f32_32x32x16_bf16 v[16:31], v[48:51], v[244:247], v[16:31]
  s_waitcnt lgkmcnt(0)
  v_mfma_f32_32x32x16_bf16 v[16:31], v[52:55], v[248:251], v[16:31]
  v_mfma_f32_32x32x16_bf16 v[16:31], v[56:59], v[252:255], v[16:31]
  s_add_u32 s38, s37, 16384
  s_nop 10
  v_cvt_pk_bf16_f32 v68, v16, v17
  v_cvt_pk_bf16_f32 v69, v18, v19
  v_cvt_pk_bf16_f32 v70, v20, v21
  v_cvt_pk_bf16_f32 v71, v22, v23
  buffer_store_dwordx4 v[68:71], v1, s[4:7], s38 offen sc1
  v_cvt_pk_bf16_f32 v72, v24, v25
  v_cvt_pk_bf16_f32 v73, v26, v27
  v_cvt_pk_bf16_f32 v74, v28, v29
  v_cvt_pk_bf16_f32 v75, v30, v31
  buffer_store_dwordx4 v[72:75], v1, s[4:7], s38 offen offset:1024 sc1
  v_add_u32 v10, s45, v10
  v_add_u32 v11, s45, v11
  v_add_u32 v12, s45, v12
  v_add_u32 v13, s45, v13
  s_sub_u32 s45, 0, s45
  s_bfe_u32 s35, s32, 0x10006
  s_lshl_b32 s35, s35, 2
  s_add_u32 s47, s46, s35
  s_and_b32 s50, s32, 63
  s_add_u32 s50, s50, 1
  s_waitcnt vmcnt(2)
  s_branch L_qkv_run
L_fail_qkv:
  s_mov_b64 exec, 1
  v_mov_b32 v0, 76
  v_mov_b32 v1, 1
  buffer_atomic_add v1, v0, s[20:23], 0 offen
  s_endpgm
L_ffn1:
  s_waitcnt vmcnt(0)
  s_barrier
  s_cmp_lg_u32 s24, 0
  s_cbranch_scc1 Lsi_18
  s_mov_b64 exec, 1
  v_mov_b32 v1, 128
  v_mov_b32 v2, 1
  buffer_atomic_add v2, v1, s[20:23], 0 offen
  s_mov_b64 exec, -1
Lsi_18:
  s_mul_i32 s30, s28, 12
  s_add_u32 s30, s30, s29
  s_lshl_b32 s30, s30, 2
  s_add_u32 s30, s30, s24
  s_lshl_b32 s30, s30, 13
  v_lshlrev_b32 v1, 7, v0
  s_mov_b32 s8, s68
  s_and_b32 s9, s69, 0xffff
  s_mov_b32 s10, 0x480000
  s_mov_b32 s11, 0x20000
  s_add_u32 s31, s30, 0
  buffer_load_dword v3, v1, s[8:11], s31 offen
  s_mov_b32 s8, s70
  s_and_b32 s9, s71, 0xffff
  s_mov_b32 s10, 0x480000
  s_mov_b32 s11, 0x20000
  s_add_u32 s31, s30, 0
  buffer_load_dword v3, v1, s[8:11], s31 offen
  s_mov_b32 s8, s72
  s_and_b32 s9, s73, 0xffff
  s_mov_b32 s10, 0x480000
  s_mov_b32 s11, 0x20000
  s_add_u32 s31, s30, 0
  buffer_load_dword v3, v1, s[8:11], s31 offen
  s_mov_b32 s8, s74
  s_and_b32 s9, s75, 0xffff
  s_mov_b32 s10, 0x480000
  s_mov_b32 s11, 0x20000
  s_add_u32 s31, s30, 0
  buffer_load_dword v3, v1, s[8:11], s31 offen
  s_mov_b32 s8, s68
  s_and_b32 s9, s69, 0xffff
  s_mov_b32 s10, 0x480000
  s_mov_b32 s11, 0x20000
  s_add_u32 s31, s30, 2359296
  buffer_load_dword v3, v1, s[8:11], s31 offen
  s_mov_b32 s8, s70
  s_and_b32 s9, s71, 0xffff
  s_mov_b32 s10, 0x480000
  s_mov_b32 s11, 0x20000
  s_add_u32 s31, s30, 2359296
  buffer_load_dword v3, v1, s[8:11], s31 offen
  s_mov_b32 s8, s72
  s_and_b32 s9, s73, 0xffff
  s_mov_b32 s10, 0x480000
  s_mov_b32 s11, 0x20000
  s_add_u32 s31, s30, 2359296
  buffer_load_dword v3, v1, s[8:11], s31 offen
  s_mov_b32 s8, s74
  s_and_b32 s9, s75, 0xffff
  s_mov_b32 s10, 0x480000
  s_mov_b32 s11, 0x20000
  s_add_u32 s31, s30, 2359296
  buffer_load_dword v3, v1, s[8:11], s31 offen
  s_waitcnt vmcnt(0)
  v_lshrrev_b32 v8, 2, v0
  v_mul_u32_u24 v10, 9216, v8
  v_and_b32 v9, 3, v0
  v_lshl_add_u32 v10, v9, 4, v10
  s_mov_b32 s8, s80
  s_and_b32 s9, s81, 0xffff
  s_mov_b32 s10, 0x510000
  s_mov_b32 s11, 0x20000
  s_mov_b32 s12, s82
  s_and_b32 s13, s83, 0xffff
  s_mov_b32 s14, 0x2400
  s_mov_b32 s15, 0x20000
  s_mul_i32 s33, s29, 768
  s_mul_i32 s34, s24, 192
  s_add_u32 s33, s33, s34
  v_add_u32 v10, s33, v10
  s_mul_i32 s35, s24, 40960
  v_lshrrev_b32 v11, 5, v0
  v_lshlrev_b32 v11, 9, v11
  v_and_b32 v8, 3, v8
  v_lshl_add_u32 v11, v8, 6, v11
  v_bfe_u32 v8, v0, 4, 1
  v_lshl_add_u32 v11, v8, 5, v11
  v_lshl_add_u32 v11, v9, 3, v11
  v_add_u32 v11, s35, v11
  s_barrier
  s_add_u32 m0, s35, 0
  s_mov_b32 s36, 0
  buffer_load_dwordx4 v10, s[8:11], s36 offen lds
  s_barrier
  s_add_u32 m0, s35, 1024
  s_mov_b32 s36, 64
  buffer_load_dwordx4 v10, s[8:11], s36 offen lds
  s_barrier
  s_add_u32 m0, s35, 2048
  s_mov_b32 s36, 128
  buffer_load_dwordx4 v10, s[8:11], s36 offen lds
  s_barrier
  s_add_u32 m0, s35, 3072
  s_mov_b32 s36, 147456
  buffer_load_dwordx4 v10, s[8:11], s36 offen lds
  s_barrier
  s_add_u32 m0, s35, 4096
  s_mov_b32 s36, 147520
  buffer_load_dwordx4 v10, s[8:11], s36 offen lds
  s_barrier
  s_add_u32 m0, s35, 5120
  s_mov_b32 s36, 147584
  buffer_load_dwordx4 v10, s[8:11], s36 offen lds
  s_barrier
  s_add_u32 m0, s35, 6144
  s_mov_b32 s36, 294912
  buffer_load_dwordx4 v10, s[8:11], s36 offen lds
  s_barrier
  s_add_u32 m0, s35, 7168
  s_mov_b32 s36, 294976
  buffer_load_dwordx4 v10, s[8:11], s36 offen lds
  s_barrier
  s_add_u32 m0, s35, 8192
  s_mov_b32 s36, 295040
  buffer_load_dwordx4 v10, s[8:11], s36 offen lds
  s_barrier
  s_add_u32 m0, s35, 9216
  s_mov_b32 s36, 442368
  buffer_load_dwordx4 v10, s[8:11], s36 offen lds
  s_barrier
  s_add_u32 m0, s35, 10240
  s_mov_b32 s36, 442432
  buffer_load_dwordx4 v10, s[8:11], s36 offen lds
  s_barrier
  s_add_u32 m0, s35, 11264
  s_mov_b32 s36, 442496
  buffer_load_dwordx4 v10, s[8:11], s36 offen lds
  s_barrier
  s_add_u32 m0, s35, 12288
  s_mov_b32 s36, 589824
  buffer_load_dwordx4 v10, s[8:11], s36 offen lds
  s_barrier
  s_add_u32 m0, s35, 13312
  s_mov_b32 s36, 589888
  buffer_load_dwordx4 v10, s[8:11], s36 offen lds
  s_barrier
  s_add_u32 m0, s35, 14336
  s_mov_b32 s36, 589952
  buffer_load_dwordx4 v10, s[8:11], s36 offen lds
  s_barrier
  s_add_u32 m0, s35, 15360
  s_mov_b32 s36, 737280
  buffer_load_dwordx4 v10, s[8:11], s36 offen lds
  s_barrier
  s_add_u32 m0, s35, 16384
  s_mov_b32 s36, 737344
  buffer_load_dwordx4 v10, s[8:11], s36 offen lds
  s_barrier
  s_add_u32 m0, s35, 17408
  s_mov_b32 s36, 737408
  buffer_load_dwordx4 v10, s[8:11], s36 offen lds
  s_barrier
  s_add_u32 m0, s35, 18432
  s_mov_b32 s36, 884736
  buffer_load_dwordx4 v10, s[8:11], s36 offen lds
  s_barrier
  s_add_u32 m0, s35, 19456
  s_mov_b32 s36, 884800
  buffer_load_dwordx4 v10, s[8:11], s36 offen lds
  s_barrier
  s_add_u32 m0, s35, 20480
  s_mov_b32 s36, 884864
  buffer_load_dwordx4 v10, s[8:11], s36 offen lds
  s_barrier
  s_add_u32 m0, s35, 21504
  s_mov_b32 s36, 1032192
  buffer_load_dwordx4 v10, s[8:11], s36 offen lds
  s_barrier
  s_add_u32 m0, s35, 22528
  s_mov_b32 s36, 1032256
  buffer_load_dwordx4 v10, s[8:11], s36 offen lds
  s_barrier
  s_add_u32 m0, s35, 23552
  s_mov_b32 s36, 1032320
  buffer_load_dwordx4 v10, s[8:11], s36 offen lds
  s_barrier
  s_add_u32 m0, s35, 24576
  s_mov_b32 s36, 1179648
  buffer_load_dwordx4 v10, s[8:11], s36 offen lds
  s_barrier
  s_add_u32 m0, s35, 25600
  s_mov_b32 s36, 1179712
  buffer_load_dwordx4 v10, s[8:11], s36 offen lds
  s_barrier
  s_add_u32 m0, s35, 26624
  s_mov_b32 s36, 1179776
  buffer_load_dwordx4 v10, s[8:11], s36 offen lds
  s_barrier
  s_add_u32 m0, s35, 27648
  s_mov_b32 s36, 1327104
  buffer_load_dwordx4 v10, s[8:11], s36 offen lds
  s_barrier
  s_add_u32 m0, s35, 28672
  s_mov_b32 s36, 1327168
  buffer_load_dwordx4 v10, s[8:11], s36 offen lds
  s_barrier
  s_add_u32 m0, s35, 29696
  s_mov_b32 s36, 1327232
  buffer_load_dwordx4 v10, s[8:11], s36 offen lds
  s_barrier
  s_add_u32 m0, s35, 30720
  s_mov_b32 s36, 1474560
  buffer_load_dwordx4 v10, s[8:11], s36 offen lds
  s_barrier
  s_add_u32 m0, s35, 31744
  s_mov_b32 s36, 1474624
  buffer_load_dwordx4 v10, s[8:11], s36 offen lds
  s_waitcnt vmcnt(31)
  ds_read_b64_tr_b16 a[0:1], v11 offset:0
  ds_read_b64_tr_b16 a[2:3], v11 offset:256
  s_waitcnt lgkmcnt(8)
  s_barrier
  s_add_u32 m0, s35, 32768
  s_mov_b32 s36, 1474688
  buffer_load_dwordx4 v10, s[8:11], s36 offen lds
  s_waitcnt vmcnt(31)
  ds_read_b64_tr_b16 a[144:145], v11 offset:1024
  ds_read_b64_tr_b16 a[146:147], v11 offset:1280
  s_waitcnt lgkmcnt(8)
  s_barrier
  s_add_u32 m0, s35, 33792
  s_mov_b32 s36, 1622016
  buffer_load_dwordx4 v10, s[8:11], s36 offen lds
  s_waitcnt vmcnt(31)
  ds_read_b64_tr_b16 v[112:113], v11 offset:2048
  ds_read_b64_tr_b16 v[114:115], v11 offset:2304
  s_waitcnt lgkmcnt(8)
  s_barrier
  s_add_u32 m0, s35, 34816
  s_mov_b32 s36, 1622080
  buffer_load_dwordx4 v10, s[8:11], s36 offen lds
  s_waitcnt vmcnt(31)
  ds_read_b64_tr_b16 a[4:5], v11 offset:3072
  ds_read_b64_tr_b16 a[6:7], v11 offset:3328
  s_waitcnt lgkmcnt(8)
  s_barrier
  s_add_u32 m0, s35, 35840
  s_mov_b32 s36, 1622144
  buffer_load_dwordx4 v10, s[8:11], s36 offen lds
  s_waitcnt vmcnt(31)
  ds_read_b64_tr_b16 a[148:149], v11 offset:4096
  ds_read_b64_tr_b16 a[150:151], v11 offset:4352
  s_waitcnt lgkmcnt(8)
  s_barrier
  s_add_u32 m0, s35, 36864
  s_mov_b32 s36, 1769472
  buffer_load_dwordx4 v10, s[8:11], s36 offen lds
  s_waitcnt vmcnt(31)
  ds_read_b64_tr_b16 v[116:117], v11 offset:5120
  ds_read_b64_tr_b16 v[118:119], v11 offset:5376
  s_waitcnt lgkmcnt(8)
  s_barrier
  s_add_u32 m0, s35, 37888
  s_mov_b32 s36, 1769536
  buffer_load_dwordx4 v10, s[8:11], s36 offen lds
  s_waitcnt vmcnt(31)
  ds_read_b64_tr_b16 a[8:9], v11 offset:6144
  ds_read_b64_tr_b16 a[10:11], v11 offset:6400
  s_waitcnt lgkmcnt(8)
  s_barrier
  s_add_u32 m0, s35, 38912
  s_mov_b32 s36, 1769600
  buffer_load_dwordx4 v10, s[8:11], s36 offen lds
  s_waitcnt vmcnt(31)
  ds_read_b64_tr_b16 a[152:153], v11 offset:7168
  ds_read_b64_tr_b16 a[154:155], v11 offset:7424
  s_waitcnt lgkmcnt(8)
  s_barrier
  s_add_u32 m0, s35, 39936
  s_mov_b32 s36, 1916928
  buffer_load_dwordx4 v10, s[8:11], s36 offen lds
  s_waitcnt vmcnt(31)
  ds_read_b64_tr_b16 v[120:121], v11 offset:8192
  ds_read_b64_tr_b16 v[122:123], v11 offset:8448
  s_waitcnt lgkmcnt(8)
  s_barrier
  s_add_u32 m0, s35, 0
  s_mov_b32 s36, 1916992
  buffer_load_dwordx4 v10, s[8:11], s36 offen lds
  s_waitcnt vmcnt(31)
  ds_read_b64_tr_b16 a[12:13], v11 offset:9216
  ds_read_b64_tr_b16 a[14:15], v11 offset:9472
  s_waitcnt lgkmcnt(8)
  s_barrier
  s_add_u32 m0, s35, 1024
  s_mov_b32 s36, 1917056
  buffer_load_dwordx4 v10, s[8:11], s36 offen lds
  s_waitcnt vmcnt(31)
  ds_read_b64_tr_b16 a[156:157], v11 offset:10240
  ds_read_b64_tr_b16 a[158:159], v11 offset:10496
  s_waitcnt lgkmcnt(8)
  s_barrier
  s_add_u32 m0, s35, 2048
  s_mov_b32 s36, 2064384
  buffer_load_dwordx4 v10, s[8:11], s36 offen lds
  s_waitcnt vmcnt(31)
  ds_read_b64_tr_b16 v[124:125], v11 offset:11264
  ds_read_b64_tr_b16 v[126:127], v11 offset:11520
  s_waitcnt lgkmcnt(8)
  s_barrier
  s_add_u32 m0, s35, 3072
  s_mov_b32 s36, 2064448
  buffer_load_dwordx4 v10, s[8:11], s36 offen lds
  s_waitcnt vmcnt(31)
  ds_read_b64_tr_b16 a[16:17], v11 offset:12288
  ds_read_b64_tr_b16 a[18:19], v11 offset:12544
  s_waitcnt lgkmcnt(8)
  s_barrier
  s_add_u32 m0, s35, 4096
  s_mov_b32 s36, 2064512
  buffer_load_dwordx4 v10, s[8:11], s36 offen lds
  s_waitcnt vmcnt(31)
  ds_read_b64_tr_b16 a[160:161], v11 offset:13312
  ds_read_b64_tr_b16 a[162:163], v11 offset:13568
  s_waitcnt lgkmcnt(8)
  s_barrier
  s_add_u32 m0, s35, 5120
  s_mov_b32 s36, 2211840
  buffer_load_dwordx4 v10, s[8:11], s36 offen lds
  s_waitcnt vmcnt(31)
  ds_read_b64_tr_b16 v[128:129], v11 offset:14336
  ds_read_b64_tr_b16 v[130:131], v11 offset:14592
  s_waitcnt lgkmcnt(8)
  s_barrier
  s_add_u32 m0, s35, 6144
  s_mov_b32 s36, 2211904
  buffer_load_dwordx4 v10, s[8:11], s36 offen lds
  s_waitcnt vmcnt(31)
  ds_read_b64_tr_b16 a[20:21], v11 offset:15360
  ds_read_b64_tr_b16 a[22:23], v11 offset:15616
  s_waitcnt lgkmcnt(8)
  s_barrier
  s_add_u32 m0, s35, 7168
  s_mov_b32 s36, 2211968
  buffer_load_dwordx4 v10, s[8:11], s36 offen lds
  s_waitcnt vmcnt(31)
  ds_read_b64_tr_b16 a[164:165], v11 offset:16384
  ds_read_b64_tr_b16 a[166:167], v11 offset:16640
  s_waitcnt lgkmcnt(8)
  s_barrier
  s_add_u32 m0, s35, 8192
  s_mov_b32 s36, 2359296
  buffer_load_dwordx4 v10, s[8:11], s36 offen lds
  s_waitcnt vmcnt(31)
  ds_read_b64_tr_b16 v[132:133], v11 offset:17408
  ds_read_b64_tr_b16 v[134:135], v11 offset:17664
  s_waitcnt lgkmcnt(8)
  s_barrier
  s_add_u32 m0, s35, 9216
  s_mov_b32 s36, 2359360
  buffer_load_dwordx4 v10, s[8:11], s36 offen lds
  s_waitcnt vmcnt(31)
  ds_read_b64_tr_b16 a[24:25], v11 offset:18432
  ds_read_b64_tr_b16 a[26:27], v11 offset:18688
  s_waitcnt lgkmcnt(8)
  s_barrier
  s_add_u32 m0, s35, 10240
  s_mov_b32 s36, 2359424
  buffer_load_dwordx4 v10, s[8:11], s36 offen lds
  s_waitcnt vmcnt(31)
  ds_read_b64_tr_b16 a[168:169], v11 offset:19456
  ds_read_b64_tr_b16 a[170:171], v11 offset:19712
  s_waitcnt lgkmcnt(8)
  s_barrier
  s_add_u32 m0, s35, 11264
  s_mov_b32 s36, 2506752
  buffer_load_dwordx4 v10, s[8:11], s36 offen lds
  s_waitcnt vmcnt(31)
  ds_read_b64_tr_b16 v[136:137], v11 offset:20480
  ds_read_b64_tr_b16 v[138:139], v11 offset:20736
  s_waitcnt lgkmcnt(8)
  s_barrier
  s_add_u32 m0, s35, 12288
  s_mov_b32 s36, 2506816
  buffer_load_dwordx4 v10, s[8:11], s36 offen lds
  s_waitcnt vmcnt(31)
  ds_read_b64_tr_b16 a[28:29], v11 offset:21504
  ds_read_b64_tr_b16 a[30:31], v11 offset:21760
  s_waitcnt lgkmcnt(8)
  s_barrier
  s_add_u32 m0, s35, 13312
  s_mov_b32 s36, 2506880
  buffer_load_dwordx4 v10, s[8:11], s36 offen lds
  s_waitcnt vmcnt(31)
  ds_read_b64_tr_b16 a[172:173], v11 offset:22528
  ds_read_b64_tr_b16 a[174:175], v11 offset:22784
  s_waitcnt lgkmcnt(8)
  s_barrier
  s_add_u32 m0, s35, 14336
  s_mov_b32 s36, 2654208
  buffer_load_dwordx4 v10, s[8:11], s36 offen lds
  s_waitcnt vmcnt(31)
  ds_read_b64_tr_b16 v[140:141], v11 offset:23552
  ds_read_b64_tr_b16 v[142:143], v11 offset:23808
  s_waitcnt lgkmcnt(8)
  s_barrier
  s_add_u32 m0, s35, 15360
  s_mov_b32 s36, 2654272
  buffer_load_dwordx4 v10, s[8:11], s36 offen lds
  s_waitcnt vmcnt(31)
  ds_read_b64_tr_b16 a[32:33], v11 offset:24576
  ds_read_b64_tr_b16 a[34:35], v11 offset:24832
  s_waitcnt lgkmcnt(8)
  s_barrier
  s_add_u32 m0, s35, 16384
  s_mov_b32 s36, 2654336
  buffer_load_dwordx4 v10, s[8:11], s36 offen lds
  s_waitcnt vmcnt(31)
  ds_read_b64_tr_b16 a[176:177], v11 offset:25600
  ds_read_b64_tr_b16 a[178:179], v11 offset:25856
  s_waitcnt lgkmcnt(8)
  s_barrier
  s_add_u32 m0, s35, 17408
  s_mov_b32 s36, 2801664
  buffer_load_dwordx4 v10, s[8:11], s36 offen lds
  s_waitcnt vmcnt(31)
  ds_read_b64_tr_b16 v[144:145], v11 offset:26624
  ds_read_b64_tr_b16 v[146:147], v11 offset:26880
  s_waitcnt lgkmcnt(8)
  s_barrier
  s_add_u32 m0, s35, 18432
  s_mov_b32 s36, 2801728
  buffer_load_dwordx4 v10, s[8:11], s36 offen lds
  s_waitcnt vmcnt(31)
  ds_read_b64_tr_b16 a[36:37], v11 offset:27648
  ds_read_b64_tr_b16 a[38:39], v11 offset:27904
  s_waitcnt lgkmcnt(8)
  s_barrier
  s_add_u32 m0, s35, 19456
  s_mov_b32 s36, 2801792
  buffer_load_dwordx4 v10, s[8:11], s36 offen lds
  s_waitcnt vmcnt(31)
  ds_read_b64_tr_b16 a[180:181], v11 offset:28672
  ds_read_b64_tr_b16 a[182:183], v11 offset:28928
  s_waitcnt lgkmcnt(8)
  s_barrier
  s_add_u32 m0, s35, 20480
  s_mov_b32 s36, 2949120
  buffer_load_dwordx4 v10, s[8:11], s36 offen lds
  s_waitcnt vmcnt(31)
  ds_read_b64_tr_b16 v[148:149], v11 offset:29696
  ds_read_b64_tr_b16 v[150:151], v11 offset:29952
  s_waitcnt lgkmcnt(8)
  s_barrier
  s_add_u32 m0, s35, 21504
  s_mov_b32 s36, 2949184
  buffer_load_dwordx4 v10, s[8:11], s36 offen lds
  s_waitcnt vmcnt(31)
  ds_read_b64_tr_b16 a[40:41], v11 offset:30720
  ds_read_b64_tr_b16 a[42:43], v11 offset:30976
  s_waitcnt lgkmcnt(8)
  s_barrier
  s_add_u32 m0, s35, 22528
  s_mov_b32 s36, 2949248
  buffer_load_dwordx4 v10, s[8:11], s36 offen lds
  s_waitcnt vmcnt(31)
  ds_read_b64_tr_b16 a[184:185], v11 offset:31744
  ds_read_b64_tr_b16 a[186:187], v11 offset:32000
  s_waitcnt lgkmcnt(8)
  s_barrier
  s_add_u32 m0, s35, 23552
  s_mov_b32 s36, 3096576
  buffer_load_dwordx4 v10, s[8:11], s36 offen lds
  s_waitcnt vmcnt(31)
  ds_read_b64_tr_b16 v[152:153], v11 offset:32768
  ds_read_b64_tr_b16 v[154:155], v11 offset:33024
  s_waitcnt lgkmcnt(8)
  s_barrier
  s_add_u32 m0, s35, 24576
  s_mov_b32 s36, 3096640
  buffer_load_dwordx4 v10, s[8:11], s36 offen lds
  s_waitcnt vmcnt(31)
  ds_read_b64_tr_b16 a[44:45], v11 offset:33792
  ds_read_b64_tr_b16 a[46:47], v11 offset:34048
  s_waitcnt lgkmcnt(8)
  s_barrier
  s_add_u32 m0, s35, 25600
  s_mov_b32 s36, 3096704
  buffer_load_dwordx4 v10, s[8:11], s36 offen lds
  s_waitcnt vmcnt(31)
  ds_read_b64_tr_b16 a[188:189], v11 offset:34816
  ds_read_b64_tr_b16 a[190:191], v11 offset:35072
  s_waitcnt lgkmcnt(8)
  s_barrier
  s_add_u32 m0, s35, 26624
  s_mov_b32 s36, 3244032
  buffer_load_dwordx4 v10, s[8:11], s36 offen lds
  s_waitcnt vmcnt(31)
  ds_read_b64_tr_b16 v[156:157], v11 offset:35840
  ds_read_b64_tr_b16 v[158:159], v11 offset:36096
  s_waitcnt lgkmcnt(8)
  s_barrier
  s_add_u32 m0, s35, 27648
  s_mov_b32 s36, 3244096
  buffer_load_dwordx4 v10, s[8:11], s36 offen lds
  s_waitcnt vmcnt(31)
  ds_read_b64_tr_b16 a[48:49], v11 offset:36864
  ds_read_b64_tr_b16 a[50:51], v11 offset:37120
  s_waitcnt lgkmcnt(8)
  s_barrier
  s_add_u32 m0, s35, 28672
  s_mov_b32 s36, 3244160
  buffer_load_dwordx4 v10, s[8:11], s36 offen lds
  s_waitcnt vmcnt(31)
  ds_read_b64_tr_b16 a[192:193], v11 offset:37888
  ds_read_b64_tr_b16 a[194:195], v11 offset:38144
  s_waitcnt lgkmcnt(8)
  s_barrier
  s_add_u32 m0, s35, 29696
  s_mov_b32 s36, 3391488
  buffer_load_dwordx4 v10, s[8:11], s36 offen lds
  s_waitcnt vmcnt(31)
  ds_read_b64_tr_b16 v[160:161], v11 offset:38912
  ds_read_b64_tr_b16 v[162:163], v11 offset:39168
  s_waitcnt lgkmcnt(8)
  s_barrier
  s_add_u32 m0, s35, 30720
  s_mov_b32 s36, 3391552
  buffer_load_dwordx4 v10, s[8:11], s36 offen lds
  s_waitcnt vmcnt(31)
  ds_read_b64_tr_b16 a[52:53], v11 offset:39936
  ds_read_b64_tr_b16 a[54:55], v11 offset:40192
  s_waitcnt lgkmcnt(8)
  s_barrier
  s_add_u32 m0, s35, 31744
  s_mov_b32 s36, 3391616
  buffer_load_dwordx4 v10, s[8:11], s36 offen lds
  s_waitcnt vmcnt(31)
  ds_read_b64_tr_b16 a[196:197], v11 offset:0
  ds_read_b64_tr_b16 a[198:199], v11 offset:256
  s_waitcnt lgkmcnt(8)
  s_barrier
  s_add_u32 m0, s35, 32768
  s_mov_b32 s36, 3538944
  buffer_load_dwordx4 v10, s[8:11], s36 offen lds
  s_waitcnt vmcnt(31)
  ds_read_b64_tr_b16 v[164:165], v11 offset:1024
  ds_read_b64_tr_b16 v[166:167], v11 offset:1280
  s_waitcnt lgkmcnt(8)
  s_barrier
  s_add_u32 m0, s35, 33792
  s_mov_b32 s36, 3539008
  buffer_load_dwordx4 v10, s[8:11], s36 offen lds
  s_waitcnt vmcnt(31)
  ds_read_b64_tr_b16 a[56:57], v11 offset:2048
  ds_read_b64_tr_b16 a[58:59], v11 offset:2304
  s_waitcnt lgkmcnt(8)
  s_barrier
  s_add_u32 m0, s35, 34816
  s_mov_b32 s36, 3539072
  buffer_load_dwordx4 v10, s[8:11], s36 offen lds
  s_waitcnt vmcnt(31)
  ds_read_b64_tr_b16 a[200:201], v11 offset:3072
  ds_read_b64_tr_b16 a[202:203], v11 offset:3328
  s_waitcnt lgkmcnt(8)
  s_barrier
  s_add_u32 m0, s35, 35840
  s_mov_b32 s36, 3686400
  buffer_load_dwordx4 v10, s[8:11], s36 offen lds
  s_waitcnt vmcnt(31)
  ds_read_b64_tr_b16 v[168:169], v11 offset:4096
  ds_read_b64_tr_b16 v[170:171], v11 offset:4352
  s_waitcnt lgkmcnt(8)
  s_barrier
  s_add_u32 m0, s35, 36864
  s_mov_b32 s36, 3686464
  buffer_load_dwordx4 v10, s[8:11], s36 offen lds
  s_waitcnt vmcnt(31)
  ds_read_b64_tr_b16 a[60:61], v11 offset:5120
  ds_read_b64_tr_b16 a[62:63], v11 offset:5376
  s_waitcnt lgkmcnt(8)
  s_barrier
  s_add_u32 m0, s35, 37888
  s_mov_b32 s36, 3686528
  buffer_load_dwordx4 v10, s[8:11], s36 offen lds
  s_waitcnt vmcnt(31)
  ds_read_b64_tr_b16 a[204:205], v11 offset:6144
  ds_read_b64_tr_b16 a[206:207], v11 offset:6400
  s_waitcnt lgkmcnt(8)
  s_barrier
  s_add_u32 m0, s35, 38912
  s_mov_b32 s36, 3833856
  buffer_load_dwordx4 v10, s[8:11], s36 offen lds
  s_waitcnt vmcnt(31)
  ds_read_b64_tr_b16 v[172:173], v11 offset:7168
  ds_read_b64_tr_b16 v[174:175], v11 offset:7424
  s_waitcnt lgkmcnt(8)
  s_barrier
  s_add_u32 m0, s35, 39936
  s_mov_b32 s36, 3833920
  buffer_load_dwordx4 v10, s[8:11], s36 offen lds
  s_waitcnt vmcnt(31)
  ds_read_b64_tr_b16 a[64:65], v11 offset:8192
  ds_read_b64_tr_b16 a[66:67], v11 offset:8448
  s_waitcnt lgkmcnt(8)
  s_barrier
  s_add_u32 m0, s35, 0
  s_mov_b32 s36, 3833984
  buffer_load_dwordx4 v10, s[8:11], s36 offen lds
  s_waitcnt vmcnt(31)
  ds_read_b64_tr_b16 a[208:209], v11 offset:9216
  ds_read_b64_tr_b16 a[210:211], v11 offset:9472
  s_waitcnt lgkmcnt(8)
  s_barrier
  s_add_u32 m0, s35, 1024
  s_mov_b32 s36, 3981312
  buffer_load_dwordx4 v10, s[8:11], s36 offen lds
  s_waitcnt vmcnt(31)
  ds_read_b64_tr_b16 v[176:177], v11 offset:10240
  ds_read_b64_tr_b16 v[178:179], v11 offset:10496
  s_waitcnt lgkmcnt(8)
  s_barrier
  s_add_u32 m0, s35, 2048
  s_mov_b32 s36, 3981376
  buffer_load_dwordx4 v10, s[8:11], s36 offen lds
  s_waitcnt vmcnt(31)
  ds_read_b64_tr_b16 a[68:69], v11 offset:11264
  ds_read_b64_tr_b16 a[70:71], v11 offset:11520
  s_waitcnt lgkmcnt(8)
  s_barrier
  s_add_u32 m0, s35, 3072
  s_mov_b32 s36, 3981440
  buffer_load_dwordx4 v10, s[8:11], s36 offen lds
  s_waitcnt vmcnt(31)
  ds_read_b64_tr_b16 a[212:213], v11 offset:12288
  ds_read_b64_tr_b16 a[214:215], v11 offset:12544
  s_waitcnt lgkmcnt(8)
  s_barrier
  s_add_u32 m0, s35, 4096
  s_mov_b32 s36, 4128768
  buffer_load_dwordx4 v10, s[8:11], s36 offen lds
  s_waitcnt vmcnt(31)
  ds_read_b64_tr_b16 v[180:181], v11 offset:13312
  ds_read_b64_tr_b16 v[182:183], v11 offset:13568
  s_waitcnt lgkmcnt(8)
  s_barrier
  s_add_u32 m0, s35, 5120
  s_mov_b32 s36, 4128832
  buffer_load_dwordx4 v10, s[8:11], s36 offen lds
  s_waitcnt vmcnt(31)
  ds_read_b64_tr_b16 a[72:73], v11 offset:14336
  ds_read_b64_tr_b16 a[74:75], v11 offset:14592
  s_waitcnt lgkmcnt(8)
  s_barrier
  s_add_u32 m0, s35, 6144
  s_mov_b32 s36, 4128896
  buffer_load_dwordx4 v10, s[8:11], s36 offen lds
  s_waitcnt vmcnt(31)
  ds_read_b64_tr_b16 a[216:217], v11 offset:15360
  ds_read_b64_tr_b16 a[218:219], v11 offset:15616
  s_waitcnt lgkmcnt(8)
  s_barrier
  s_add_u32 m0, s35, 7168
  s_mov_b32 s36, 4276224
  buffer_load_dwordx4 v10, s[8:11], s36 offen lds
  s_waitcnt vmcnt(31)
  ds_read_b64_tr_b16 v[184:185], v11 offset:16384
  ds_read_b64_tr_b16 v[186:187], v11 offset:16640
  s_waitcnt lgkmcnt(8)
  s_barrier
  s_add_u32 m0, s35, 8192
  s_mov_b32 s36, 4276288
  buffer_load_dwordx4 v10, s[8:11], s36 offen lds
  s_waitcnt vmcnt(31)
  ds_read_b64_tr_b16 a[76:77], v11 offset:17408
  ds_read_b64_tr_b16 a[78:79], v11 offset:17664
  s_waitcnt lgkmcnt(8)
  s_barrier
  s_add_u32 m0, s35, 9216
  s_mov_b32 s36, 4276352
  buffer_load_dwordx4 v10, s[8:11], s36 offen lds
  s_waitcnt vmcnt(31)
  ds_read_b64_tr_b16 a[220:221], v11 offset:18432
  ds_read_b64_tr_b16 a[222:223], v11 offset:18688
  s_waitcnt lgkmcnt(8)
  s_barrier
  s_add_u32 m0, s35, 10240
  s_mov_b32 s36, 4423680
  buffer_load_dwordx4 v10, s[8:11], s36 offen lds
  s_waitcnt vmcnt(31)
  ds_read_b64_tr_b16 v[188:189], v11 offset:19456
  ds_read_b64_tr_b16 v[190:191], v11 offset:19712
  s_waitcnt lgkmcnt(8)
  s_barrier
  s_add_u32 m0, s35, 11264
  s_mov_b32 s36, 4423744
  buffer_load_dwordx4 v10, s[8:11], s36 offen lds
  s_waitcnt vmcnt(31)
  ds_read_b64_tr_b16 a[80:81], v11 offset:20480
  ds_read_b64_tr_b16 a[82:83], v11 offset:20736
  s_waitcnt lgkmcnt(8)
  s_barrier
  s_add_u32 m0, s35, 12288
  s_mov_b32 s36, 4423808
  buffer_load_dwordx4 v10, s[8:11], s36 offen lds
  s_waitcnt vmcnt(31)
  ds_read_b64_tr_b16 a[224:225], v11 offset:21504
  ds_read_b64_tr_b16 a[226:227], v11 offset:21760
  s_waitcnt lgkmcnt(8)
  s_barrier
  s_add_u32 m0, s35, 13312
  s_mov_b32 s36, 4571136
  buffer_load_dwordx4 v10, s[8:11], s36 offen lds
  s_waitcnt vmcnt(31)
  ds_read_b64_tr_b16 v[192:193], v11 offset:22528
  ds_read_b64_tr_b16 v[194:195], v11 offset:22784
  s_waitcnt lgkmcnt(8)
  s_barrier
  s_add_u32 m0, s35, 14336
  s_mov_b32 s36, 4571200
  buffer_load_dwordx4 v10, s[8:11], s36 offen lds
  s_waitcnt vmcnt(31)
  ds_read_b64_tr_b16 a[84:85], v11 offset:23552
  ds_read_b64_tr_b16 a[86:87], v11 offset:23808
  s_waitcnt lgkmcnt(8)
  s_barrier
  s_add_u32 m0, s35, 15360
  s_mov_b32 s36, 4571264
  buffer_load_dwordx4 v10, s[8:11], s36 offen lds
  s_waitcnt vmcnt(31)
  ds_read_b64_tr_b16 a[228:229], v11 offset:24576
  ds_read_b64_tr_b16 a[230:231], v11 offset:24832
  s_waitcnt lgkmcnt(8)
  s_barrier
  s_add_u32 m0, s35, 16384
  s_mov_b32 s36, 4718592
  buffer_load_dwordx4 v10, s[8:11], s36 offen lds
  s_waitcnt vmcnt(31)
  ds_read_b64_tr_b16 v[196:197], v11 offset:25600
  ds_read_b64_tr_b16 v[198:199], v11 offset:25856
  s_waitcnt lgkmcnt(8)
  s_barrier
  s_add_u32 m0, s35, 17408
  s_mov_b32 s36, 4718656
  buffer_load_dwordx4 v10, s[8:11], s36 offen lds
  s_waitcnt vmcnt(31)
  ds_read_b64_tr_b16 a[88:89], v11 offset:26624
  ds_read_b64_tr_b16 a[90:91], v11 offset:26880
  s_waitcnt lgkmcnt(8)
  s_barrier
  s_add_u32 m0, s35, 18432
  s_mov_b32 s36, 4718720
  buffer_load_dwordx4 v10, s[8:11], s36 offen lds
  s_waitcnt vmcnt(31)
  ds_read_b64_tr_b16 a[232:233], v11 offset:27648
  ds_read_b64_tr_b16 a[234:235], v11 offset:27904
  s_waitcnt lgkmcnt(8)
  s_barrier
  s_add_u32 m0, s35, 19456
  s_mov_b32 s36, 4866048
  buffer_load_dwordx4 v10, s[8:11], s36 offen lds
  s_waitcnt vmcnt(31)
  ds_read_b64_tr_b16 v[200:201], v11 offset:28672
  ds_read_b64_tr_b16 v[202:203], v11 offset:28928
  s_waitcnt lgkmcnt(8)
  s_barrier
  s_add_u32 m0, s35, 20480
  s_mov_b32 s36, 4866112
  buffer_load_dwordx4 v10, s[8:11], s36 offen lds
  s_waitcnt vmcnt(31)
  ds_read_b64_tr_b16 a[92:93], v11 offset:29696
  ds_read_b64_tr_b16 a[94:95], v11 offset:29952
  s_waitcnt lgkmcnt(8)
  s_barrier
  s_add_u32 m0, s35, 21504
  s_mov_b32 s36, 4866176
  buffer_load_dwordx4 v10, s[8:11], s36 offen lds
  s_waitcnt vmcnt(31)
  ds_read_b64_tr_b16 a[236:237], v11 offset:30720
  ds_read_b64_tr_b16 a[238:239], v11 offset:30976
  s_waitcnt lgkmcnt(8)
  s_barrier
  s_add_u32 m0, s35, 22528
  s_mov_b32 s36, 5013504
  buffer_load_dwordx4 v10, s[8:11], s36 offen lds
  s_waitcnt vmcnt(31)
  ds_read_b64_tr_b16 v[204:205], v11 offset:31744
  ds_read_b64_tr_b16 v[206:207], v11 offset:32000
  s_waitcnt lgkmcnt(8)
  s_barrier
  s_add_u32 m0, s35, 23552
  s_mov_b32 s36, 5013568
  buffer_load_dwordx4 v10, s[8:11], s36 offen lds
  s_waitcnt vmcnt(31)
  ds_read_b64_tr_b16 a[96:97], v11 offset:32768
  ds_read_b64_tr_b16 a[98:99], v11 offset:33024
  s_waitcnt lgkmcnt(8)
  s_barrier
  s_add_u32 m0, s35, 24576
  s_mov_b32 s36, 5013632
  buffer_load_dwordx4 v10, s[8:11], s36 offen lds
  s_waitcnt vmcnt(31)
  ds_read_b64_tr_b16 a[240:241], v11 offset:33792
  ds_read_b64_tr_b16 a[242:243], v11 offset:34048
  s_waitcnt lgkmcnt(8)
  s_barrier
  s_add_u32 m0, s35, 25600
  s_mov_b32 s36, 5160960
  buffer_load_dwordx4 v10, s[8:11], s36 offen lds
  s_waitcnt vmcnt(31)
  ds_read_b64_tr_b16 v[208:209], v11 offset:34816
  ds_read_b64_tr_b16 v[210:211], v11 offset:35072
  s_waitcnt lgkmcnt(8)
  s_barrier
  s_add_u32 m0, s35, 26624
  s_mov_b32 s36, 5161024
  buffer_load_dwordx4 v10, s[8:11], s36 offen lds
  s_waitcnt vmcnt(31)
  ds_read_b64_tr_b16 a[100:101], v11 offset:35840
  ds_read_b64_tr_b16 a[102:103], v11 offset:36096
  s_waitcnt lgkmcnt(8)
  s_barrier
  s_add_u32 m0, s35, 27648
  s_mov_b32 s36, 5161088
  buffer_load_dwordx4 v10, s[8:11], s36 offen lds
  s_waitcnt vmcnt(31)
  ds_read_b64_tr_b16 a[244:245], v11 offset:36864
  ds_read_b64_tr_b16 a[246:247], v11 offset:37120
  s_waitcnt vmcnt(30)
  ds_read_b64_tr_b16 v[212:213], v11 offset:37888
  ds_read_b64_tr_b16 v[214:215], v11 offset:38144
  s_waitcnt vmcnt(29)
  ds_read_b64_tr_b16 a[104:105], v11 offset:38912
  ds_read_b64_tr_b16 a[106:107], v11 offset:39168
  s_waitcnt vmcnt(28)
  ds_read_b64_tr_b16 a[248:249], v11 offset:39936
  ds_read_b64_tr_b16 a[250:251], v11 offset:40192
  s_waitcnt vmcnt(27)
  ds_read_b64_tr_b16 v[216:217], v11 offset:0
  ds_read_b64_tr_b16 v[218:219], v11 offset:256
  s_waitcnt vmcnt(26)
  ds_read_b64_tr_b16 a[108:109], v11 offset:1024
  ds_read_b64_tr_b16 a[110:111], v11 offset:1280
  s_waitcnt vmcnt(25)
  ds_read_b64_tr_b16 a[252:253], v11 offset:2048
  ds_read_b64_tr_b16 a[254:255], v11 offset:2304
  s_waitcnt vmcnt(24)
  ds_read_b64_tr_b16 v[220:221], v11 offset:3072
  ds_read_b64_tr_b16 v[222:223], v11 offset:3328
  s_waitcnt vmcnt(23)
  ds_read_b64_tr_b16 a[112:113], v11 offset:4096
  ds_read_b64_tr_b16 a[114:115], v11 offset:4352
  s_waitcnt vmcnt(22)
  ds_read_b64_tr_b16 v[80:81], v11 offset:5120
  ds_read_b64_tr_b16 v[82:83], v11 offset:5376
  s_waitcnt vmcnt(21)
  ds_read_b64_tr_b16 v[224:225], v11 offset:6144
  ds_read_b64_tr_b16 v[226:227], v11 offset:6400
  s_waitcnt vmcnt(20)
  ds_read_b64_tr_b16 a[116:117], v11 offset:7168
  ds_read_b64_tr_b16 a[118:119], v11 offset:7424
  s_waitcnt vmcnt(19)
  ds_read_b64_tr_b16 v[84:85], v11 offset:8192
  ds_read_b64_tr_b16 v[86:87], v11 offset:8448
  s_waitcnt vmcnt(18)
  ds_read_b64_tr_b16 v[228:229], v11 offset:9216
  ds_read_b64_tr_b16 v[230:231], v11 offset:9472
  s_waitcnt vmcnt(17)
  ds_read_b64_tr_b16 a[120:121], v11 offset:10240
  ds_read_b64_tr_b16 a[122:123], v11 offset:10496
  s_waitcnt vmcnt(16)
  ds_read_b64_tr_b16 v[88:89], v11 offset:11264
  ds_read_b64_tr_b16 v[90:91], v11 offset:11520
  s_waitcnt vmcnt(15)
  ds_read_b64_tr_b16 v[232:233], v11 offset:12288
  ds_read_b64_tr_b16 v[234:235], v11 offset:12544
  s_waitcnt vmcnt(14)
  ds_read_b64_tr_b16 a[124:125], v11 offset:13312
  ds_read_b64_tr_b16 a[126:127], v11 offset:13568
  s_waitcnt vmcnt(13)
  ds_read_b64_tr_b16 v[92:93], v11 offset:14336
  ds_read_b64_tr_b16 v[94:95], v11 offset:14592
  s_waitcnt vmcnt(12)
  ds_read_b64_tr_b16 v[236:237], v11 offset:15360
  ds_read_b64_tr_b16 v[238:239], v11 offset:15616
  s_waitcnt vmcnt(11)
  ds_read_b64_tr_b16 a[128:129], v11 offset:16384
  ds_read_b64_tr_b16 a[130:131], v11 offset:16640
  s_waitcnt vmcnt(10)
  ds_read_b64_tr_b16 v[96:97], v11 offset:17408
  ds_read_b64_tr_b16 v[98:99], v11 offset:17664
  s_waitcnt vmcnt(9)
  ds_read_b64_tr_b16 v[240:241], v11 offset:18432
  ds_read_b64_tr_b16 v[242:243], v11 offset:18688
  s_waitcnt vmcnt(8)
  ds_read_b64_tr_b16 a[132:133], v11 offset:19456
  ds_read_b64_tr_b16 a[134:135], v11 offset:19712
  s_waitcnt vmcnt(7)
  ds_read_b64_tr_b16 v[100:101], v11 offset:20480
  ds_read_b64_tr_b16 v[102:103], v11 offset:20736
  s_waitcnt vmcnt(6)
  ds_read_b64_tr_b16 v[244:245], v11 offset:21504
  ds_read_b64_tr_b16 v[246:247], v11 offset:21760
  s_waitcnt vmcnt(5)
  ds_read_b64_tr_b16 a[136:137], v11 offset:22528
  ds_read_b64_tr_b16 a[138:139], v11 offset:22784
  s_waitcnt vmcnt(4)
  ds_read_b64_tr_b16 v[104:105], v11 offset:23552
  ds_read_b64_tr_b16 v[106:107], v11 offset:23808
  s_waitcnt vmcnt(3)
  ds_read_b64_tr_b16 v[248:249], v11 offset:24576
  ds_read_b64_tr_b16 v[250:251], v11 offset:24832
  s_waitcnt vmcnt(2)
  ds_read_b64_tr_b16 a[140:141], v11 offset:25600
  ds_read_b64_tr_b16 a[142:143], v11 offset:25856
  s_waitcnt vmcnt(1)
  ds_read_b64_tr_b16 v[108:109], v11 offset:26624
  ds_read_b64_tr_b16 v[110:111], v11 offset:26880
  s_waitcnt vmcnt(0)
  ds_read_b64_tr_b16 v[252:253], v11 offset:27648
  ds_read_b64_tr_b16 v[254:255], v11 offset:27904
  s_waitcnt lgkmcnt(0)
  s_barrier
  v_mov_b32 v5, 0
  v_mov_b32 v6, 1
  v_lshlrev_b32 v1, 4, v0
  s_mov_b32 s48, 0
  s_mov_b32 s49, -1
  v_and_b32 v7, 7, v0
  v_lshlrev_b32 v7, 7, v7
  s_and_b32 s33, s24, 1
  s_lshl_b32 s33, s33, 10
  s_add_u32 s33, s33, 49152
  s_and_b32 s34, s26, 7
  s_mul_i32 s34, s34, 8320
  s_add_u32 s33, s33, s34
  v_add_u32 v7, s33, v7
  v_add_u32 v8, 2048, v7
  v_cndmask_b32 v7, v7, v8, s[48:49]
  s_mul_i32 s46, s28, 12
  s_add_u32 s46, s46, s29
  s_lshl_b32 s46, s46, 9
  s_lshl_b32 s34, s24, 7
  s_add_u32 s46, s46, s34
  s_add_u32 s46, s46, 128000
  v_lshrrev_b32 v8, 3, v0
  s_lshl_b32 s33, s24, 3
  v_add_u32 v8, s33, v8
  v_bfe_u32 v9, v8, 1, 3
  v_and_b32 v10, 7, v0
  v_xor_b32 v9, v9, v10
  v_mul_u32_u24 v2, 1152, v8
  v_lshl_add_u32 v2, v9, 4, v2
  v_and_b32 v8, 31, v0
  v_bfe_u32 v9, v0, 1, 3
  v_lshrrev_b32 v14, 5, v0
  v_xor_b32 v9, v9, v14
  v_xor_b32 v14, 0, v9
  v_lshlrev_b32 v14, 4, v14
  v_lshl_add_u32 v10, v8, 7, v14
  v_xor_b32 v14, 2, v9
  v_lshlrev_b32 v14, 4, v14
  v_lshl_add_u32 v11, v8, 7, v14
  v_xor_b32 v14, 4, v9
  v_lshlrev_b32 v14, 4, v14
  v_lshl_add_u32 v12, v8, 7, v14
  v_xor_b32 v14, 6, v9
  v_lshlrev_b32 v14, 4, v14
  v_lshl_add_u32 v13, v8, 7, v14
  s_mul_i32 s33, s29, 768
  s_mul_i32 s34, s24, 192
  s_add_u32 s33, s33, s34
  v_lshlrev_b32 v8, 2, v0
  buffer_load_dword v9, v8, s[12:15], s33 offen
  s_mul_i32 s34, s24, 512
  s_add_u32 s34, s34, 155648
  v_lshlrev_b32 v8, 3, v0
  v_add_u32 v8, s34, v8
  s_waitcnt vmcnt(0)
  v_lshlrev_b32 v16, 16, v9
  v_and_b32 v17, 0xffff0000, v9
  ds_write_b64 v8, v[16:17]
  v_lshrrev_b32 v8, 5, v0
  v_lshlrev_b32 v3, 4, v8
  v_add_u32 v3, s34, v3
  v_mov_b32 v15, 0xc0135761
  s_mov_b32 s53, 0xbdd2d3e8
  s_mov_b32 s54, s53
  s_mov_b32 s55, s53
  s_mov_b32 s56, 1.0
  s_mov_b32 s57, 1.0
  s_waitcnt lgkmcnt(0)
  v_mov_b32 v8, 128
Lwi_19:
  buffer_load_dword v9, v8, s[20:23], 0 offen sc1
  s_waitcnt vmcnt(0)
  v_cmp_gt_u32 vcc, 0x100, v9
  s_cbranch_vccz Lwiok_20
  s_add_u32 s60, s60, 1
  s_cmp_gt_u32 s60, 262144
  s_cbranch_scc1 L_fail_ffn1
  s_sleep 4
  s_branch Lwi_19
Lwiok_20:
  s_mov_b32 s30, s28
  s_mov_b32 s31, s28
  s_mov_b32 s44, 0
  s_mov_b32 s45, 36864
  s_mov_b32 s47, 0x40000000
  s_mov_b32 s50, 0
  s_mov_b32 s58, -1
  s_mov_b32 s38, 0x40000000
  s_lshl_b32 s51, s29, 2
  s_add_u32 s51, s51, s24
  s_lshl_b32 s40, s24, 10
  s_mul_i32 s34, s29, 43
  s_lshr_b32 s34, s34, 7
  s_mul_i32 s41, s34, 9437184
  s_mul_i32 s34, s29, 24576
  s_add_u32 s41, s41, s34
  s_mul_i32 s34, s24, 6144
  s_add_u32 s41, s41, s34
  s_add_u32 s41, s41, 209403904
  s_mov_b32 s39, 7684096
  s_mov_b32 s48, 0xff
  s_mov_b32 s49, 0xff
  v_mov_b32 v9, 0
  s_mul_i32 s33, s31, 18
  s_lshr_b32 s33, s33, 4
  s_add_i32 s33, s33, 20
  s_cmp_le_i32 s33, s30
  s_cselect_b32 s34, 1, 0
  s_cmp_ge_u32 s30, 64
  s_cselect_b32 s34, 1, s34
  s_cmp_ge_u32 s31, 64
  s_cselect_b32 s34, 0, s34
  s_cmp_eq_u32 s34, 1
  s_cselect_b32 s59, s31, s30
  s_cselect_b32 s43, 64, 0
  s_cmp_eq_u32 s34, 1
  s_cselect_b32 s35, 3, 0
  s_cselect_b32 s36, 0, 3
  s_add_u32 s31, s31, s35
  s_add_u32 s30, s30, s36
  s_add_u32 s43, s43, s59
  s_cmp_eq_u32 s34, 1
  s_cselect_b32 s62, 0, 0xff
  s_cselect_b32 s63, 0xff, 0
  s_mul_i32 s33, s59, 36864
  s_add_u32 s33, s33, s39
  s_add_u32 s34, s40, s44
  s_cmp_ge_u32 s59, 64
  s_cselect_b32 s43, -1, s43
  s_cselect_b32 s42, 1, 0
L_ffn1_fetch:
  s_mov_b64 exec, s[62:63]
  buffer_load_dword v9, v7, s[4:7], 0 offen sc1
  s_mov_b64 exec, -1
  s_waitcnt vmcnt(0)
  v_cmp_ge_u32 vcc, s59, v9
  s_and_b64 vcc, vcc, s[62:63]
  s_cbranch_scc0 L_ffn1_fgo
  s_add_u32 s60, s60, 1
  s_cmp_gt_u32 s60, 262144
  s_cbranch_scc1 L_fail_ffn1
  s_sleep 2
  s_branch L_ffn1_fetch
L_ffn1_fgo:
  s_add_u32 m0, s34, 0
  s_add_u32 s35, s33, 0
  buffer_load_dwordx4 v2, s[4:7], s35 offen sc1 lds
  s_add_u32 m0, s34, 4096
  s_add_u32 s35, s33, 128
  buffer_load_dwordx4 v2, s[4:7], s35 offen sc1 lds
  s_add_u32 m0, s34, 8192
  s_add_u32 s35, s33, 256
  buffer_load_dwordx4 v2, s[4:7], s35 offen sc1 lds
  s_add_u32 m0, s34, 12288
  s_add_u32 s35, s33, 384
  buffer_load_dwordx4 v2, s[4:7], s35 offen sc1 lds
  s_add_u32 m0, s34, 16384
  s_add_u32 s35, s33, 512
  buffer_load_dwordx4 v2, s[4:7], s35 offen sc1 lds
  s_add_u32 m0, s34, 20480
  s_add_u32 s35, s33, 640
  buffer_load_dwordx4 v2, s[4:7], s35 offen sc1 lds
  s_add_u32 m0, s34, 24576
  s_add_u32 s35, s33, 768
  buffer_load_dwordx4 v2, s[4:7], s35 offen sc1 lds
  s_add_u32 m0, s34, 28672
  s_add_u32 s35, s33, 896
  buffer_load_dwordx4 v2, s[4:7], s35 offen sc1 lds
  s_add_u32 m0, s34, 32768
  s_add_u32 s35, s33, 1024
  buffer_load_dwordx4 v2, s[4:7], s35 offen sc1 lds
  s_waitcnt vmcnt(0)
L_ffn1_run:
  s_mov_b32 s32, s43
  s_add_u32 s44, s44, s45
  s_mul_i32 s37, s59, 73728
  s_add_u32 s37, s37, s41
  s_barrier
  ds_read_b128 v[16:19], v3 offset:0
  ds_read_b128 v[20:23], v3 offset:32
  ds_read_b128 v[24:27], v3 offset:64
  ds_read_b128 v[28:31], v3 offset:96
  ds_read_b128 v[48:51], v10 offset:0
  ds_read_b128 v[52:55], v11 offset:0
  ds_read_b128 v[56:59], v12 offset:0
  ds_read_b128 v[60:63], v13 offset:0
  s_waitcnt lgkmcnt(2)
  v_mfma_f32_32x32x16_bf16 v[16:31], a[0:3], v[48:51], v[16:31]
  ds_read_b128 v[64:67], v10 offset:4096
  s_mul_i32 s33, s31, 18
  s_lshr_b32 s33, s33, 4
  v_mfma_f32_32x32x16_bf16 v[16:31], a[4:7], v[52:55], v[16:31]
  ds_read_b128 v[48:51], v11 offset:4096
  s_add_i32 s33, s33, 20
  s_cmp_le_i32 s33, s30
  s_cselect_b32 s34, 1, 0
  s_waitcnt lgkmcnt(2)
  v_mfma_f32_32x32x16_bf16 v[16:31], a[8:11], v[56:59], v[16:31]
  ds_read_b128 v[52:55], v12 offset:4096
  s_cmp_ge_u32 s30, 64
  s_cselect_b32 s34, 1, s34
  v_mfma_f32_32x32x16_bf16 v[16:31], a[12:15], v[60:63], v[16:31]
  ds_read_b128 v[56:59], v13 offset:4096
  s_cmp_ge_u32 s31, 64
  s_cselect_b32 s34, 0, s34
  s_waitcnt lgkmcnt(2)
  v_mfma_f32_32x32x16_bf16 v[16:31], a[16:19], v[64:67], v[16:31]
  ds_read_b128 v[60:63], v10 offset:8192
  s_cmp_eq_u32 s34, 1
  s_cselect_b32 s59, s31, s30
  s_cselect_b32 s43, 64, 0
  v_mfma_f32_32x32x16_bf16 v[16:31], a[20:23], v[48:51], v[16:31]
  ds_read_b128 v[64:67], v11 offset:8192
  s_cmp_eq_u32 s34, 1
  s_cselect_b32 s35, 3, 0
  s_cselect_b32 s36, 0, 3
  s_waitcnt lgkmcnt(2)
  v_mfma_f32_32x32x16_bf16 v[16:31], a[24:27], v[52:55], v[16:31]
  ds_read_b128 v[48:51], v12 offset:8192
  s_add_u32 s31, s31, s35
  s_add_u32 s30, s30, s36
  s_add_u32 s43, s43, s59
  v_mfma_f32_32x32x16_bf16 v[16:31], a[28:31], v[56:59], v[16:31]
  ds_read_b128 v[52:55], v13 offset:8192
  s_cmp_eq_u32 s34, 1
  s_cselect_b32 s62, 0, 0xff
  s_cselect_b32 s63, 0xff, 0
  s_waitcnt lgkmcnt(2)
  v_mfma_f32_32x32x16_bf16 v[16:31], a[32:35], v[60:63], v[16:31]
  ds_read_b128 v[56:59], v10 offset:12288
  s_mul_i32 s33, s59, 36864
  s_add_u32 s33, s33, s39
  s_add_u32 s34, s40, s44
  v_mfma_f32_32x32x16_bf16 v[16:31], a[36:39], v[64:67], v[16:31]
  ds_read_b128 v[60:63], v11 offset:12288
  s_cmp_ge_u32 s59, 64
  s_cselect_b32 s43, -1, s43
  s_cselect_b32 s42, 1, 0
  s_waitcnt lgkmcnt(2)
  v_mfma_f32_32x32x16_bf16 v[16:31], a[40:43], v[48:51], v[16:31]
  ds_read_b128 v[64:67], v12 offset:12288
  v_cmp_ge_u32 vcc, s59, v9
  v_mfma_f32_32x32x16_bf16 v[16:31], a[44:47], v[52:55], v[16:31]
  ds_read_b128 v[48:51], v13 offset:12288
  s_waitcnt lgkmcnt(2)
  s_and_b64 vcc, vcc, s[62:63]
  s_cbranch_scc0 L_ffn1_w12
  v_mfma_f32_32x32x16_bf16 v[16:31], a[48:51], v[56:59], v[16:31]
  ds_read_b128 v[52:55], v10 offset:16384
  v_mfma_f32_32x32x16_bf16 v[16:31], a[52:55], v[60:63], v[16:31]
  ds_read_b128 v[56:59], v11 offset:16384
  s_waitcnt lgkmcnt(2)
  v_mfma_f32_32x32x16_bf16 v[16:31], a[56:59], v[64:67], v[16:31]
  ds_read_b128 v[60:63], v12 offset:16384
  v_mfma_f32_32x32x16_bf16 v[16:31], a[60:63], v[48:51], v[16:31]
  ds_read_b128 v[64:67], v13 offset:16384
  s_waitcnt lgkmcnt(2)
  v_mfma_f32_32x32x16_bf16 v[16:31], a[64:67], v[52:55], v[16:31]
  ds_read_b128 v[48:51], v10 offset:20480
  v_mfma_f32_32x32x16_bf16 v[16:31], a[68:71], v[56:59], v[16:31]
  ds_read_b128 v[52:55], v11 offset:20480
  s_waitcnt lgkmcnt(2)
  v_mfma_f32_32x32x16_bf16 v[16:31], a[72:75], v[60:63], v[16:31]
  ds_read_b128 v[56:59], v12 offset:20480
  v_mfma_f32_32x32x16_bf16 v[16:31], a[76:79], v[64:67], v[16:31]
  ds_read_b128 v[60:63], v13 offset:20480
  s_waitcnt lgkmcnt(2)
  v_mfma_f32_32x32x16_bf16 v[16:31], a[80:83], v[48:51], v[16:31]
  ds_read_b128 v[64:67], v10 offset:24576
  s_mov_b64 exec, s[48:49]
  buffer_load_dword v9, v7, s[4:7], 0 offen sc1
  s_mov_b64 exec, -1
  v_mfma_f32_32x32x16_bf16 v[16:31], a[84:87], v[52:55], v[16:31]
  ds_read_b128 v[48:51], v11 offset:24576
  s_waitcnt lgkmcnt(2)
  v_mfma_f32_32x32x16_bf16 v[16:31], a[88:91], v[56:59], v[16:31]
  ds_read_b128 v[52:55], v12 offset:24576
  v_mfma_f32_32x32x16_bf16 v[16:31], a[92:95], v[60:63], v[16:31]
  ds_read_b128 v[56:59], v13 offset:24576
  s_waitcnt lgkmcnt(2)
  v_mfma_f32_32x32x16_bf16 v[16:31], a[96:99], v[64:67], v[16:31]
  ds_read_b128 v[60:63], v10 offset:28672
  s_waitcnt vmcnt(1)
  v_mov_b32 v6, s50
  s_mov_b64 exec, 1
  buffer_store_dword v6, v5, s[4:7], s47 offen sc1
  s_mov_b64 exec, -1
  v_mfma_f32_32x32x16_bf16 v[16:31], a[100:103], v[48:51], v[16:31]
  ds_read_b128 v[64:67], v11 offset:28672
  s_waitcnt lgkmcnt(2)
  v_mfma_f32_32x32x16_bf16 v[16:31], a[104:107], v[52:55], v[16:31]
  ds_read_b128 v[48:51], v12 offset:28672
  v_mfma_f32_32x32x16_bf16 v[16:31], a[108:111], v[56:59], v[16:31]
  ds_read_b128 v[52:55], v13 offset:28672
  s_waitcnt lgkmcnt(2)
  v_mfma_f32_32x32x16_bf16 v[16:31], a[112:115], v[60:63], v[16:31]
  ds_read_b128 v[56:59], v10 offset:32768
  v_mfma_f32_32x32x16_bf16 v[16:31], a[116:119], v[64:67], v[16:31]
  ds_read_b128 v[60:63], v11 offset:32768
  s_waitcnt lgkmcnt(2)
  v_mfma_f32_32x32x16_bf16 v[16:31], a[120:123], v[48:51], v[16:31]
  ds_read_b128 v[64:67], v12 offset:32768
  v_mfma_f32_32x32x16_bf16 v[16:31], a[124:127], v[52:55], v[16:31]
  ds_read_b128 v[48:51], v13 offset:32768
  s_waitcnt lgkmcnt(2)
  v_mfma_f32_32x32x16_bf16 v[16:31], a[128:131], v[56:59], v[16:31]
  ds_read_b128 v[52:55], v10 offset:0
  v_mfma_f32_32x32x16_bf16 v[16:31], a[132:135], v[60:63], v[16:31]
  ds_read_b128 v[56:59], v11 offset:0
  s_waitcnt lgkmcnt(2)
  v_mfma_f32_32x32x16_bf16 v[16:31], a[136:139], v[64:67], v[16:31]
  ds_read_b128 v[60:63], v12 offset:0
  ds_read_b128 v[32:35], v3 offset:128
  ds_read_b128 v[36:39], v3 offset:160
  ds_read_b128 v[40:43], v3 offset:192
  ds_read_b128 v[44:47], v3 offset:224
  v_cmp_ge_u32 vcc, s59, v9
  v_mfma_f32_32x32x16_bf16 v[16:31], a[140:143], v[48:51], v[16:31]
  ds_read_b128 v[64:67], v13 offset:0
  s_waitcnt lgkmcnt(1)
  s_and_b64 vcc, vcc, s[62:63]
  s_cbranch_scc0 L_ffn1_w36
  v_mfma_f32_32x32x16_bf16 v[32:47], a[144:147], v[52:55], v[32:47]
  ds_read_b128 v[48:51], v10 offset:4096
  v_mfma_f32_32x32x16_bf16 v[32:47], a[148:151], v[56:59], v[32:47]
  ds_read_b128 v[52:55], v11 offset:4096
  s_waitcnt lgkmcnt(2)
  v_mfma_f32_32x32x16_bf16 v[32:47], a[152:155], v[60:63], v[32:47]
  ds_read_b128 v[56:59], v12 offset:4096
  v_mul_f32 v76, v16, v16
  v_fma_f32 v76, v76, s53, v15
  v_mul_f32 v76, v76, v16
  v_mul_f32 v77, v17, v17
  v_mfma_f32_32x32x16_bf16 v[32:47], a[156:159], v[64:67], v[32:47]
  ds_read_b128 v[60:63], v13 offset:4096
  v_exp_f32 v76, v76
  v_fma_f32 v77, v77, s53, v15
  v_add_f32 v76, 1.0, v76
  v_mul_f32 v77, v77, v17
  s_waitcnt lgkmcnt(2)
  v_mfma_f32_32x32x16_bf16 v[32:47], a[160:163], v[48:51], v[32:47]
  ds_read_b128 v[64:67], v10 offset:8192
  v_mul_f32 v78, v18, v18
  v_rcp_f32 v76, v76
  v_exp_f32 v77, v77
  v_mfma_f32_32x32x16_bf16 v[32:47], a[164:167], v[52:55], v[32:47]
  ds_read_b128 v[48:51], v11 offset:8192
  v_fma_f32 v78, v78, s53, v15
  v_mul_f32 v16, v16, v76
  v_add_f32 v77, 1.0, v77
  v_mul_f32 v78, v78, v18
  v_mul_f32 v79, v19, v19
  s_waitcnt lgkmcnt(2)
  v_mfma_f32_32x32x16_bf16 v[32:47], a[168:171], v[56:59], v[32:47]
  ds_read_b128 v[52:55], v12 offset:8192
  v_rcp_f32 v77, v77
  v_exp_f32 v78, v78
  v_fma_f32 v79, v79, s53, v15
  v_mfma_f32_32x32x16_bf16 v[32:47], a[172:175], v[60:63], v[32:47]
  ds_read_b128 v[56:59], v13 offset:8192
  v_mul_f32 v17, v17, v77
  v_add_f32 v78, 1.0, v78
  v_mul_f32 v79, v79, v19
  v_mul_f32 v76, v20, v20
  s_waitcnt lgkmcnt(2)
  v_mfma_f32_32x32x16_bf16 v[32:47], a[176:179], v[64:67], v[32:47]
  ds_read_b128 v[60:63], v10 offset:12288
  s_mov_b64 exec, s[48:49]
  buffer_load_dword v9, v7, s[4:7], 0 offen sc1
  s_mov_b64 exec, -1
  v_cvt_pk_bf16_f32 v68, v16, v17
  v_rcp_f32 v78, v78
  v_exp_f32 v79, v79
  v_mfma_f32_32x32x16_bf16 v[32:47], a[180:183], v[48:51], v[32:47]
  ds_read_b128 v[64:67], v11 offset:12288
  v_fma_f32 v76, v76, s53, v15
  v_mul_f32 v18, v18, v78
  v_add_f32 v79, 1.0, v79
  v_mul_f32 v76, v76, v20
  v_mul_f32 v77, v21, v21
  s_waitcnt lgkmcnt(2)
  v_mfma_f32_32x32x16_bf16 v[32:47], a[184:187], v[52:55], v[32:47]
  ds_read_b128 v[48:51], v12 offset:12288
  v_rcp_f32 v79, v79
  v_exp_f32 v76, v76
  v_fma_f32 v77, v77, s53, v15
  v_mfma_f32_32x32x16_bf16 v[32:47], a[188:191], v[56:59], v[32:47]
  ds_read_b128 v[52:55], v13 offset:12288
  v_mul_f32 v19, v19, v79
  v_add_f32 v76, 1.0, v76
  v_mul_f32 v77, v77, v21
  v_mul_f32 v78, v22, v22
  s_waitcnt lgkmcnt(2)
  v_mfma_f32_32x32x16_bf16 v[32:47], a[192:195], v[60:63], v[32:47]
  ds_read_b128 v[56:59], v10 offset:16384
  v_cvt_pk_bf16_f32 v69, v18, v19
  v_rcp_f32 v76, v76
  v_exp_f32 v77, v77
  v_mfma_f32_32x32x16_bf16 v[32:47], a[196:199], v[64:67], v[32:47]
  ds_read_b128 v[60:63], v11 offset:16384
  v_fma_f32 v78, v78, s53, v15
  v_mul_f32 v20, v20, v76
  v_add_f32 v77, 1.0, v77
  v_mul_f32 v78, v78, v22
  v_mul_f32 v79, v23, v23
  s_waitcnt lgkmcnt(2)
  v_mfma_f32_32x32x16_bf16 v[32:47], a[200:203], v[48:51], v[32:47]
  ds_read_b128 v[64:67], v12 offset:16384
  v_rcp_f32 v77, v77
  v_exp_f32 v78, v78
  v_fma_f32 v79, v79, s53, v15
  v_mfma_f32_32x32x16_bf16 v[32:47], a[204:207], v[52:55], v[32:47]
  ds_read_b128 v[48:51], v13 offset:16384
  v_mul_f32 v21, v21, v77
  v_add_f32 v78, 1.0, v78
  v_mul_f32 v79, v79, v23
  v_mul_f32 v76, v24, v24
  s_waitcnt lgkmcnt(2)
  v_mfma_f32_32x32x16_bf16 v[32:47], a[208:211], v[56:59], v[32:47]
  ds_read_b128 v[52:55], v10 offset:20480
  v_cvt_pk_bf16_f32 v70, v20, v21
  v_rcp_f32 v78, v78
  v_exp_f32 v79, v79
  v_mfma_f32_32x32x16_bf16 v[32:47], a[212:215], v[60:63], v[32:47]
  ds_read_b128 v[56:59], v11 offset:20480
  v_fma_f32 v76, v76, s53, v15
  v_mul_f32 v22, v22, v78
  v_add_f32 v79, 1.0, v79
  v_mul_f32 v76, v76, v24
  v_mul_f32 v77, v25, v25
  s_waitcnt lgkmcnt(2)
  v_mfma_f32_32x32x16_bf16 v[32:47], a[216:219], v[64:67], v[32:47]
  ds_read_b128 v[60:63], v12 offset:20480
  v_rcp_f32 v79, v79
  v_exp_f32 v76, v76
  v_fma_f32 v77, v77, s53, v15
  v_mfma_f32_32x32x16_bf16 v[32:47], a[220:223], v[48:51], v[32:47]
  ds_read_b128 v[64:67], v13 offset:20480
  v_mul_f32 v23, v23, v79
  v_add_f32 v76, 1.0, v76
  v_mul_f32 v77, v77, v25
  v_mul_f32 v78, v26, v26
  s_waitcnt lgkmcnt(2)
  v_mfma_f32_32x32x16_bf16 v[32:47], a[224:227], v[52:55], v[32:47]
  ds_read_b128 v[48:51], v10 offset:24576
  v_cvt_pk_bf16_f32 v71, v22, v23
  v_rcp_f32 v76, v76
  v_exp_f32 v77, v77
  v_mfma_f32_32x32x16_bf16 v[32:47], a[228:231], v[56:59], v[32:47]
  ds_read_b128 v[52:55], v11 offset:24576
  v_fma_f32 v78, v78, s53, v15
  v_mul_f32 v24, v24, v76
  v_add_f32 v77, 1.0, v77
  v_mul_f32 v78, v78, v26
  v_mul_f32 v79, v27, v27
  s_waitcnt lgkmcnt(2)
  v_mfma_f32_32x32x16_bf16 v[32:47], a[232:235], v[60:63], v[32:47]
  ds_read_b128 v[56:59], v12 offset:24576
  v_cmp_ge_u32 vcc, s59, v9
  v_rcp_f32 v77, v77
  v_exp_f32 v78, v78
  v_fma_f32 v79, v79, s53, v15
  v_mfma_f32_32x32x16_bf16 v[32:47], a[236:239], v[64:67], v[32:47]
  ds_read_b128 v[60:63], v13 offset:24576
  v_mul_f32 v25, v25, v77
  v_add_f32 v78, 1.0, v78
  v_mul_f32 v79, v79, v27
  v_mul_f32 v76, v28, v28
  s_waitcnt lgkmcnt(2)
  s_and_b64 vcc, vcc, s[62:63]
  s_cbranch_scc0 L_ffn1_w60
  v_mfma_f32_32x32x16_bf16 v[32:47], a[240:243], v[48:51], v[32:47]
  ds_read_b128 v[64:67], v10 offset:28672
  v_cvt_pk_bf16_f32 v72, v24, v25
  v_rcp_f32 v78, v78
  v_exp_f32 v79, v79
  v_mfma_f32_32x32x16_bf16 v[32:47], a[244:247], v[52:55], v[32:47]
  ds_read_b128 v[48:51], v11 offset:28672
  v_fma_f32 v76, v76, s53, v15
  v_mul_f32 v26, v26, v78
  v_add_f32 v79, 1.0, v79
  v_mul_f32 v76, v76, v28
  v_mul_f32 v77, v29, v29
  s_waitcnt lgkmcnt(2)
  v_mfma_f32_32x32x16_bf16 v[32:47], a[248:251], v[56:59], v[32:47]
  ds_read_b128 v[52:55], v12 offset:28672
  v_rcp_f32 v79, v79
  v_exp_f32 v76, v76
  v_fma_f32 v77, v77, s53, v15
  v_mfma_f32_32x32x16_bf16 v[32:47], a[252:255], v[60:63], v[32:47]
  ds_read_b128 v[56:59], v13 offset:28672
  v_mul_f32 v27, v27, v79
  v_add_f32 v76, 1.0, v76
  v_mul_f32 v77, v77, v29
  v_mul_f32 v78, v30, v30
  s_waitcnt lgkmcnt(2)
  v_mfma_f32_32x32x16_bf16 v[32:47], v[80:83], v[64:67], v[32:47]
  ds_read_b128 v[60:63], v10 offset:32768
  v_cvt_pk_bf16_f32 v73, v26, v27
  v_rcp_f32 v76, v76
  v_exp_f32 v77, v77
  v_mfma_f32_32x32x16_bf16 v[32:47], v[84:87], v[48:51], v[32:47]
  ds_read_b128 v[64:67], v11 offset:32768
  v_fma_f32 v78, v78, s53, v15
  v_mul_f32 v28, v28, v76
  v_add_f32 v77, 1.0, v77
  v_mul_f32 v78, v78, v30
  v_mul_f32 v79, v31, v31
  s_waitcnt lgkmcnt(2)
  v_mfma_f32_32x32x16_bf16 v[32:47], v[88:91], v[52:55], v[32:47]
  ds_read_b128 v[48:51], v12 offset:32768
  v_rcp_f32 v77, v77
  v_exp_f32 v78, v78
  v_fma_f32 v79, v79, s53, v15
  v_mfma_f32_32x32x16_bf16 v[32:47], v[92:95], v[56:59], v[32:47]
  ds_read_b128 v[52:55], v13 offset:32768
  v_mul_f32 v29, v29, v77
  v_add_f32 v78, 1.0, v78
  v_mul_f32 v79, v79, v31
  v_cvt_pk_bf16_f32 v74, v28, v29
  s_waitcnt lgkmcnt(2)
  v_mfma_f32_32x32x16_bf16 v[32:47], v[96:99], v[60:63], v[32:47]
  ds_read_b128 v[56:59], v10 offset:0
  s_mov_b64 exec, s[48:49]
  buffer_load_dword v9, v7, s[4:7], 0 offen sc1
  s_mov_b64 exec, -1
  v_rcp_f32 v78, v78
  v_exp_f32 v79, v79
  v_mul_f32 v30, v30, v78
  v_mfma_f32_32x32x16_bf16 v[32:47], v[100:103], v[64:67], v[32:47]
  ds_read_b128 v[60:63], v11 offset:0
  v_add_f32 v79, 1.0, v79
  v_rcp_f32 v79, v79
  s_nop 0
  v_mul_f32 v31, v31, v79
  v_cvt_pk_bf16_f32 v75, v30, v31
  s_waitcnt lgkmcnt(2)
  v_mfma_f32_32x32x16_bf16 v[32:47], v[104:107], v[48:51], v[32:47]
  ds_read_b128 v[64:67], v12 offset:0
  s_add_u32 s38, s37, 0
  buffer_store_dwordx4 v[68:71], v1, s[4:7], s38 offen sc1
  ds_read_b128 v[16:19], v3 offset:256
  ds_read_b128 v[20:23], v3 offset:288
  ds_read_b128 v[24:27], v3 offset:320
  ds_read_b128 v[28:31], v3 offset:352
  v_mfma_f32_32x32x16_bf16 v[32:47], v[108:111], v[52:55], v[32:47]
  ds_read_b128 v[48:51], v13 offset:0
  buffer_store_dwordx4 v[72:75], v1, s[4:7], s38 offen offset:1024 sc1
  s_waitcnt lgkmcnt(1)
  v_mfma_f32_32x32x16_bf16 v[16:31], v[112:115], v[56:59], v[16:31]
  ds_read_b128 v[52:55], v10 offset:4096
  v_mfma_f32_32x32x16_bf16 v[16:31], v[116:119], v[60:63], v[16:31]
  ds_read_b128 v[56:59], v11 offset:4096
  s_waitcnt lgkmcnt(2)
  v_mfma_f32_32x32x16_bf16 v[16:31], v[120:123], v[64:67], v[16:31]
  ds_read_b128 v[60:63], v12 offset:4096
  v_mul_f32 v76, v32, v32
  v_fma_f32 v76, v76, s53, v15
  v_mul_f32 v76, v76, v32
  v_mul_f32 v77, v33, v33
  v_mfma_f32_32x32x16_bf16 v[16:31], v[124:127], v[48:51], v[16:31]
  ds_read_b128 v[64:67], v13 offset:4096
  v_exp_f32 v76, v76
  v_fma_f32 v77, v77, s53, v15
  v_add_f32 v76, 1.0, v76
  v_mul_f32 v77, v77, v33
  s_waitcnt lgkmcnt(2)
  v_mfma_f32_32x32x16_bf16 v[16:31], v[128:131], v[52:55], v[16:31]
  ds_read_b128 v[48:51], v10 offset:8192
  v_mul_f32 v78, v34, v34
  v_rcp_f32 v76, v76
  v_exp_f32 v77, v77
  v_mfma_f32_32x32x16_bf16 v[16:31], v[132:135], v[56:59], v[16:31]
  ds_read_b128 v[52:55], v11 offset:8192
  v_fma_f32 v78, v78, s53, v15
  v_mul_f32 v32, v32, v76
  v_add_f32 v77, 1.0, v77
  v_mul_f32 v78, v78, v34
  v_mul_f32 v79, v35, v35
  s_waitcnt lgkmcnt(2)
  v_mfma_f32_32x32x16_bf16 v[16:31], v[136:139], v[60:63], v[16:31]
  ds_read_b128 v[56:59], v12 offset:8192
  v_rcp_f32 v77, v77
  v_exp_f32 v78, v78
  v_fma_f32 v79, v79, s53, v15
  v_mfma_f32_32x32x16_bf16 v[16:31], v[140:143], v[64:67], v[16:31]
  ds_read_b128 v[60:63], v13 offset:8192
  v_mul_f32 v33, v33, v77
  v_add_f32 v78, 1.0, v78
  v_mul_f32 v79, v79, v35
  v_mul_f32 v76, v36, v36
  s_waitcnt lgkmcnt(2)
  v_mfma_f32_32x32x16_bf16 v[16:31], v[144:147], v[48:51], v[16:31]
  ds_read_b128 v[64:67], v10 offset:12288
  v_cvt_pk_bf16_f32 v68, v32, v33
  v_rcp_f32 v78, v78
  v_exp_f32 v79, v79
  v_mfma_f32_32x32x16_bf16 v[16:31], v[148:151], v[52:55], v[16:31]
  ds_read_b128 v[48:51], v11 offset:12288
  v_fma_f32 v76, v76, s53, v15
  v_mul_f32 v34, v34, v78
  v_add_f32 v79, 1.0, v79
  v_mul_f32 v76, v76, v36
  v_mul_f32 v77, v37, v37
  s_waitcnt lgkmcnt(2)
  v_mfma_f32_32x32x16_bf16 v[16:31], v[152:155], v[56:59], v[16:31]
  ds_read_b128 v[52:55], v12 offset:12288
  v_cmp_ge_u32 vcc, s59, v9
  v_rcp_f32 v79, v79
  v_exp_f32 v76, v76
  v_fma_f32 v77, v77, s53, v15
  v_mfma_f32_32x32x16_bf16 v[16:31], v[156:159], v[60:63], v[16:31]
  ds_read_b128 v[56:59], v13 offset:12288
  v_mul_f32 v35, v35, v79
  v_add_f32 v76, 1.0, v76
  v_mul_f32 v77, v77, v37
  v_mul_f32 v78, v38, v38
  s_waitcnt lgkmcnt(2)
  s_and_b64 vcc, vcc, s[62:63]
  s_cbranch_scc0 L_ffn1_w84
  v_mfma_f32_32x32x16_bf16 v[16:31], v[160:163], v[64:67], v[16:31]
  ds_read_b128 v[60:63], v10 offset:16384
  v_cvt_pk_bf16_f32 v69, v34, v35
  v_rcp_f32 v76, v76
  v_exp_f32 v77, v77
  v_mfma_f32_32x32x16_bf16 v[16:31], v[164:167], v[48:51], v[16:31]
  ds_read_b128 v[64:67], v11 offset:16384
  v_fma_f32 v78, v78, s53, v15
  v_mul_f32 v36, v36, v76
  v_add_f32 v77, 1.0, v77
  v_mul_f32 v78, v78, v38
  v_mul_f32 v79, v39, v39
  s_waitcnt lgkmcnt(2)
  v_mfma_f32_32x32x16_bf16 v[16:31], v[168:171], v[52:55], v[16:31]
  ds_read_b128 v[48:51], v12 offset:16384
  v_rcp_f32 v77, v77
  v_exp_f32 v78, v78
  v_fma_f32 v79, v79, s53, v15
  v_mfma_f32_32x32x16_bf16 v[16:31], v[172:175], v[56:59], v[16:31]
  ds_read_b128 v[52:55], v13 offset:16384
  v_mul_f32 v37, v37, v77
  v_add_f32 v78, 1.0, v78
  v_mul_f32 v79, v79, v39
  v_mul_f32 v76, v40, v40
  s_waitcnt lgkmcnt(2)
  v_mfma_f32_32x32x16_bf16 v[16:31], v[176:179], v[60:63], v[16:31]
  ds_read_b128 v[56:59], v10 offset:20480
  v_cvt_pk_bf16_f32 v70, v36, v37
  v_rcp_f32 v78, v78
  v_exp_f32 v79, v79
  v_mfma_f32_32x32x16_bf16 v[16:31], v[180:183], v[64:67], v[16:31]
  ds_read_b128 v[60:63], v11 offset:20480
  v_fma_f32 v76, v76, s53, v15
  v_mul_f32 v38, v38, v78
  v_add_f32 v79, 1.0, v79
  v_mul_f32 v76, v76, v40
  v_mul_f32 v77, v41, v41
  s_waitcnt lgkmcnt(2)
  v_mfma_f32_32x32x16_bf16 v[16:31], v[184:187], v[48:51], v[16:31]
  ds_read_b128 v[64:67], v12 offset:20480
  v_rcp_f32 v79, v79
  v_exp_f32 v76, v76
  v_fma_f32 v77, v77, s53, v15
  v_mfma_f32_32x32x16_bf16 v[16:31], v[188:191], v[52:55], v[16:31]
  ds_read_b128 v[48:51], v13 offset:20480
  v_mul_f32 v39, v39, v79
  v_add_f32 v76, 1.0, v76
  v_mul_f32 v77, v77, v41
  v_mul_f32 v78, v42, v42
  s_waitcnt lgkmcnt(2)
  v_mfma_f32_32x32x16_bf16 v[16:31], v[192:195], v[56:59], v[16:31]
  ds_read_b128 v[52:55], v10 offset:24576
  s_mov_b64 exec, s[48:49]
  buffer_load_dword v9, v7, s[4:7], 0 offen sc1
  s_mov_b64 exec, -1
  v_cvt_pk_bf16_f32 v71, v38, v39
  v_rcp_f32 v76, v76
  v_exp_f32 v77, v77
  v_mfma_f32_32x32x16_bf16 v[16:31], v[196:199], v[60:63], v[16:31]
  ds_read_b128 v[56:59], v11 offset:24576
  v_fma_f32 v78, v78, s53, v15
  v_mul_f32 v40, v40, v76
  v_add_f32 v77, 1.0, v77
  v_mul_f32 v78, v78, v42
  v_mul_f32 v79, v43, v43
  s_waitcnt lgkmcnt(2)
  v_mfma_f32_32x32x16_bf16 v[16:31], v[200:203], v[64:67], v[16:31]
  ds_read_b128 v[60:63], v12 offset:24576
  v_rcp_f32 v77, v77
  v_exp_f32 v78, v78
  v_fma_f32 v79, v79, s53, v15
  v_mfma_f32_32x32x16_bf16 v[16:31], v[204:207], v[48:51], v[16:31]
  ds_read_b128 v[64:67], v13 offset:24576
  v_mul_f32 v41, v41, v77
  v_add_f32 v78, 1.0, v78
  v_mul_f32 v79, v79, v43
  v_mul_f32 v76, v44, v44
  s_waitcnt lgkmcnt(2)
  v_mfma_f32_32x32x16_bf16 v[16:31], v[208:211], v[52:55], v[16:31]
  ds_read_b128 v[48:51], v10 offset:28672
  v_cvt_pk_bf16_f32 v72, v40, v41
  v_rcp_f32 v78, v78
  v_exp_f32 v79, v79
  v_mfma_f32_32x32x16_bf16 v[16:31], v[212:215], v[56:59], v[16:31]
  ds_read_b128 v[52:55], v11 offset:28672
  v_fma_f32 v76, v76, s53, v15
  v_mul_f32 v42, v42, v78
  v_add_f32 v79, 1.0, v79
  v_mul_f32 v76, v76, v44
  v_mul_f32 v77, v45, v45
  s_waitcnt lgkmcnt(2)
  v_mfma_f32_32x32x16_bf16 v[16:31], v[216:219], v[60:63], v[16:31]
  ds_read_b128 v[56:59], v12 offset:28672
  v_rcp_f32 v79, v79
  v_exp_f32 v76, v76
  v_fma_f32 v77, v77, s53, v15
  v_mfma_f32_32x32x16_bf16 v[16:31], v[220:223], v[64:67], v[16:31]
  ds_read_b128 v[60:63], v13 offset:28672
  v_mul_f32 v43, v43, v79
  v_add_f32 v76, 1.0, v76
  v_mul_f32 v77, v77, v45
  v_mul_f32 v78, v46, v46
  s_waitcnt lgkmcnt(2)
  v_mfma_f32_32x32x16_bf16 v[16:31], v[224:227], v[48:51], v[16:31]
  ds_read_b128 v[64:67], v10 offset:32768
  v_cvt_pk_bf16_f32 v73, v42, v43
  v_rcp_f32 v76, v76
  v_exp_f32 v77, v77
  v_mfma_f32_32x32x16_bf16 v[16:31], v[228:231], v[52:55], v[16:31]
  ds_read_b128 v[48:51], v11 offset:32768
  v_fma_f32 v78, v78, s53, v15
  v_mul_f32 v44, v44, v76
  v_add_f32 v77, 1.0, v77
  v_mul_f32 v78, v78, v46
  v_mul_f32 v79, v47, v47
  s_waitcnt lgkmcnt(2)
  v_mfma_f32_32x32x16_bf16 v[16:31], v[232:235], v[56:59], v[16:31]
  ds_read_b128 v[52:55], v12 offset:32768
  v_rcp_f32 v77, v77
  v_exp_f32 v78, v78
  v_fma_f32 v79, v79, s53, v15
  v_mfma_f32_32x32x16_bf16 v[16:31], v[236:239], v[60:63], v[16:31]
  ds_read_b128 v[56:59], v13 offset:32768
  v_mul_f32 v45, v45, v77
  v_add_f32 v78, 1.0, v78
  v_mul_f32 v79, v79, v47
  v_cvt_pk_bf16_f32 v74, v44, v45
  s_waitcnt lgkmcnt(2)
  v_mfma_f32_32x32x16_bf16 v[16:31], v[240:243], v[64:67], v[16:31]
  v_rcp_f32 v78, v78
  v_exp_f32 v79, v79
  v_mul_f32 v46, v46, v78
  v_mfma_f32_32x32x16_bf16 v[16:31], v[244:247], v[48:51], v[16:31]
  v_add_f32 v79, 1.0, v79
  v_rcp_f32 v79, v79
  s_nop 0
  v_mul_f32 v47, v47, v79
  v_cvt_pk_bf16_f32 v75, v46, v47
  s_waitcnt lgkmcnt(0)
  v_mfma_f32_32x32x16_bf16 v[16:31], v[248:251], v[52:55], v[16:31]
  s_add_u32 s38, s37, 2048
  buffer_store_dwordx4 v[68:71], v1, s[4:7], s38 offen sc1
  v_mfma_f32_32x32x16_bf16 v[16:31], v[252:255], v[56:59], v[16:31]
  buffer_store_dwordx4 v[72:75], v1, s[4:7], s38 offen offset:1024 sc1
  s_nop 10
  v_pk_mul_f32 v[48:49], v[16:17], v[16:17]
  v_pk_mul_f32 v[50:51], v[18:19], v[18:19]
  v_pk_mul_f32 v[52:53], v[20:21], v[20:21]
  v_pk_mul_f32 v[54:55], v[22:23], v[22:23]
  v_pk_fma_f32 v[48:49], v[48:49], s[54:55], v[14:15] op_sel:[0,0,1] op_sel_hi:[1,1,1]
  v_pk_fma_f32 v[50:51], v[50:51], s[54:55], v[14:15] op_sel:[0,0,1] op_sel_hi:[1,1,1]
  v_pk_fma_f32 v[52:53], v[52:53], s[54:55], v[14:15] op_sel:[0,0,1] op_sel_hi:[1,1,1]
  v_pk_fma_f32 v[54:55], v[54:55], s[54:55], v[14:15] op_sel:[0,0,1] op_sel_hi:[1,1,1]
  v_pk_mul_f32 v[48:49], v[48:49], v[16:17]
  v_pk_mul_f32 v[50:51], v[50:51], v[18:19]
  v_pk_mul_f32 v[52:53], v[52:53], v[20:21]
  v_pk_mul_f32 v[54:55], v[54:55], v[22:23]
  v_exp_f32 v48, v48
  v_exp_f32 v49, v49
  v_exp_f32 v50, v50
  v_exp_f32 v51, v51
  v_exp_f32 v52, v52
  v_exp_f32 v53, v53
  v_exp_f32 v54, v54
  v_exp_f32 v55, v55
  v_pk_add_f32 v[48:49], v[48:49], s[56:57]
  v_pk_add_f32 v[50:51], v[50:51], s[56:57]
  v_pk_add_f32 v[52:53], v[52:53], s[56:57]
  v_pk_add_f32 v[54:55], v[54:55], s[56:57]
  v_rcp_f32 v48, v48
  v_rcp_f32 v49, v49
  v_rcp_f32 v50, v50
  v_rcp_f32 v51, v51
  v_rcp_f32 v52, v52
  v_rcp_f32 v53, v53
  v_rcp_f32 v54, v54
  v_rcp_f32 v55, v55
  v_pk_mul_f32 v[16:17], v[16:17], v[48:49]
  v_pk_mul_f32 v[18:19], v[18:19], v[50:51]
  v_pk_mul_f32 v[20:21], v[20:21], v[52:53]
  v_pk_mul_f32 v[22:23], v[22:23], v[54:55]
  v_cvt_pk_bf16_f32 v68, v16, v17
  v_cvt_pk_bf16_f32 v69, v18, v19
  v_cvt_pk_bf16_f32 v70, v20, v21
  v_cvt_pk_bf16_f32 v71, v22, v23
  s_add_u32 s38, s37, 4096
  buffer_store_dwordx4 v[68:71], v1, s[4:7], s38 offen offset:0 sc1
  v_pk_mul_f32 v[48:49], v[24:25], v[24:25]
  v_pk_mul_f32 v[50:51], v[26:27], v[26:27]
  v_pk_mul_f32 v[52:53], v[28:29], v[28:29]
  v_pk_mul_f32 v[54:55], v[30:31], v[30:31]
  v_pk_fma_f32 v[48:49], v[48:49], s[54:55], v[14:15] op_sel:[0,0,1] op_sel_hi:[1,1,1]
  v_pk_fma_f32 v[50:51], v[50:51], s[54:55], v[14:15] op_sel:[0,0,1] op_sel_hi:[1,1,1]
  v_pk_fma_f32 v[52:53], v[52:53], s[54:55], v[14:15] op_sel:[0,0,1] op_sel_hi:[1,1,1]
  v_pk_fma_f32 v[54:55], v[54:55], s[54:55], v[14:15] op_sel:[0,0,1] op_sel_hi:[1,1,1]
  v_pk_mul_f32 v[48:49], v[48:49], v[24:25]
  v_pk_mul_f32 v[50:51], v[50:51], v[26:27]
  v_pk_mul_f32 v[52:53], v[52:53], v[28:29]
  v_pk_mul_f32 v[54:55], v[54:55], v[30:31]
  v_exp_f32 v48, v48
  v_exp_f32 v49, v49
  v_exp_f32 v50, v50
  v_exp_f32 v51, v51
  v_exp_f32 v52, v52
  v_exp_f32 v53, v53
  v_exp_f32 v54, v54
  v_exp_f32 v55, v55
  v_pk_add_f32 v[48:49], v[48:49], s[56:57]
  v_pk_add_f32 v[50:51], v[50:51], s[56:57]
  v_pk_add_f32 v[52:53], v[52:53], s[56:57]
  v_pk_add_f32 v[54:55], v[54:55], s[56:57]
  v_rcp_f32 v48, v48
  v_rcp_f32 v49, v49
  v_rcp_f32 v50, v50
  v_rcp_f32 v51, v51
  v_rcp_f32 v52, v52
  v_rcp_f32 v53, v53
  v_rcp_f32 v54, v54
  v_rcp_f32 v55, v55
  v_pk_mul_f32 v[24:25], v[24:25], v[48:49]
  v_pk_mul_f32 v[26:27], v[26:27], v[50:51]
  v_pk_mul_f32 v[28:29], v[28:29], v[52:53]
  v_pk_mul_f32 v[30:31], v[30:31], v[54:55]
  v_cvt_pk_bf16_f32 v72, v24, v25
  v_cvt_pk_bf16_f32 v73, v26, v27
  v_cvt_pk_bf16_f32 v74, v28, v29
  v_cvt_pk_bf16_f32 v75, v30, v31
  buffer_store_dwordx4 v[72:75], v1, s[4:7], s38 offen offset:1024 sc1
  v_add_u32 v10, s45, v10
  v_add_u32 v11, s45, v11
  v_add_u32 v12, s45, v12
  v_add_u32 v13, s45, v13
  s_sub_u32 s45, 0, s45
  s_bfe_u32 s35, s32, 0x10006
  s_lshl_b32 s35, s35, 2
  s_add_u32 s47, s46, s35
  s_and_b32 s50, s32, 63
  s_add_u32 s50, s50, 1
  s_waitcnt vmcnt(4)
  v_cmp_ge_u32 vcc, s59, v9
  s_and_b64 vcc, vcc, s[62:63]
  s_cbranch_scc1 L_ffn1_drain
  s_add_u32 m0, s34, 0
  s_add_u32 s35, s33, 0
  buffer_load_dwordx4 v2, s[4:7], s35 offen sc1 lds
  s_add_u32 m0, s34, 4096
  s_add_u32 s35, s33, 128
  buffer_load_dwordx4 v2, s[4:7], s35 offen sc1 lds
  s_add_u32 m0, s34, 8192
  s_add_u32 s35, s33, 256
  buffer_load_dwordx4 v2, s[4:7], s35 offen sc1 lds
  s_add_u32 m0, s34, 12288
  s_add_u32 s35, s33, 384
  buffer_load_dwordx4 v2, s[4:7], s35 offen sc1 lds
  s_add_u32 m0, s34, 16384
  s_add_u32 s35, s33, 512
  buffer_load_dwordx4 v2, s[4:7], s35 offen sc1 lds
  s_add_u32 m0, s34, 20480
  s_add_u32 s35, s33, 640
  buffer_load_dwordx4 v2, s[4:7], s35 offen sc1 lds
  s_add_u32 m0, s34, 24576
  s_add_u32 s35, s33, 768
  buffer_load_dwordx4 v2, s[4:7], s35 offen sc1 lds
  s_add_u32 m0, s34, 28672
  s_add_u32 s35, s33, 896
  buffer_load_dwordx4 v2, s[4:7], s35 offen sc1 lds
  s_add_u32 m0, s34, 32768
  s_add_u32 s35, s33, 1024
  buffer_load_dwordx4 v2, s[4:7], s35 offen sc1 lds
  s_waitcnt vmcnt(9)
  v_mov_b32 v6, s50
  s_mov_b64 exec, 1
  buffer_store_dword v6, v5, s[4:7], s47 offen sc1
  s_mov_b64 exec, -1
  s_mov_b32 s47, 0x40000000
  s_waitcnt vmcnt(1)
  s_branch L_ffn1_run
L_ffn1_drain:
  s_waitcnt vmcnt(0)
  v_mov_b32 v6, s50
  s_mov_b64 exec, 1
  buffer_store_dword v6, v5, s[4:7], s47 offen sc1
  s_mov_b64 exec, -1
  s_mov_b32 s47, 0x40000000
  s_cmp_eq_u32 s42, 0
  s_cbranch_scc1 L_ffn1_fetch
  s_endpgm
L_ffn1_w12:
  v_mfma_f32_32x32x16_bf16 v[16:31], a[48:51], v[56:59], v[16:31]
  ds_read_b128 v[52:55], v10 offset:16384
  s_add_u32 m0, s34, 0
  s_add_u32 s35, s33, 0
  buffer_load_dwordx4 v2, s[4:7], s35 offen sc1 lds
  v_mfma_f32_32x32x16_bf16 v[16:31], a[52:55], v[60:63], v[16:31]
  ds_read_b128 v[56:59], v11 offset:16384
  s_waitcnt lgkmcnt(2)
  v_mfma_f32_32x32x16_bf16 v[16:31], a[56:59], v[64:67], v[16:31]
  ds_read_b128 v[60:63], v12 offset:16384
  v_mfma_f32_32x32x16_bf16 v[16:31], a[60:63], v[48:51], v[16:31]
  ds_read_b128 v[64:67], v13 offset:16384
  s_waitcnt lgkmcnt(2)
  v_mfma_f32_32x32x16_bf16 v[16:31], a[64:67], v[52:55], v[16:31]
  ds_read_b128 v[48:51], v10 offset:20480
  s_add_u32 m0, s34, 4096
  s_add_u32 s35, s33, 128
  buffer_load_dwordx4 v2, s[4:7], s35 offen sc1 lds
  v_mfma_f32_32x32x16_bf16 v[16:31], a[68:71], v[56:59], v[16:31]
  ds_read_b128 v[52:55], v11 offset:20480
  s_waitcnt lgkmcnt(2)
  v_mfma_f32_32x32x16_bf16 v[16:31], a[72:75], v[60:63], v[16:31]
  ds_read_b128 v[56:59], v12 offset:20480
  v_mfma_f32_32x32x16_bf16 v[16:31], a[76:79], v[64:67], v[16:31]
  ds_read_b128 v[60:63], v13 offset:20480
  s_waitcnt lgkmcnt(2)
  v_mfma_f32_32x32x16_bf16 v[16:31], a[80:83], v[48:51], v[16:31]
  ds_read_b128 v[64:67], v10 offset:24576
  s_add_u32 m0, s34, 8192
  s_add_u32 s35, s33, 256
  buffer_load_dwordx4 v2, s[4:7], s35 offen sc1 lds
  v_mfma_f32_32x32x16_bf16 v[16:31], a[84:87], v[52:55], v[16:31]
  ds_read_b128 v[48:51], v11 offset:24576
  s_waitcnt lgkmcnt(2)
  v_mfma_f32_32x32x16_bf16 v[16:31], a[88:91], v[56:59], v[16:31]
  ds_read_b128 v[52:55], v12 offset:24576
  v_mfma_f32_32x32x16_bf16 v[16:31], a[92:95], v[60:63], v[16:31]
  ds_read_b128 v[56:59], v13 offset:24576
  s_waitcnt lgkmcnt(2)
  v_mfma_f32_32x32x16_bf16 v[16:31], a[96:99], v[64:67], v[16:31]
  ds_read_b128 v[60:63], v10 offset:28672
  s_add_u32 m0, s34, 12288
  s_add_u32 s35, s33, 384
  buffer_load_dwordx4 v2, s[4:7], s35 offen sc1 lds
  s_waitcnt vmcnt(4)
  v_mov_b32 v6, s50
  s_mov_b64 exec, 1
  buffer_store_dword v6, v5, s[4:7], s47 offen sc1
  s_mov_b64 exec, -1
  v_mfma_f32_32x32x16_bf16 v[16:31], a[100:103], v[48:51], v[16:31]
  ds_read_b128 v[64:67], v11 offset:28672
  s_waitcnt lgkmcnt(2)
  v_mfma_f32_32x32x16_bf16 v[16:31], a[104:107], v[52:55], v[16:31]
  ds_read_b128 v[48:51], v12 offset:28672
  v_mfma_f32_32x32x16_bf16 v[16:31], a[108:111], v[56:59], v[16:31]
  ds_read_b128 v[52:55], v13 offset:28672
  s_waitcnt lgkmcnt(2)
  v_mfma_f32_32x32x16_bf16 v[16:31], a[112:115], v[60:63], v[16:31]
  ds_read_b128 v[56:59], v10 offset:32768
  s_add_u32 m0, s34, 16384
  s_add_u32 s35, s33, 512
  buffer_load_dwordx4 v2, s[4:7], s35 offen sc1 lds
  v_mfma_f32_32x32x16_bf16 v[16:31], a[116:119], v[64:67], v[16:31]
  ds_read_b128 v[60:63], v11 offset:32768
  s_waitcnt lgkmcnt(2)
  v_mfma_f32_32x32x16_bf16 v[16:31], a[120:123], v[48:51], v[16:31]
  ds_read_b128 v[64:67], v12 offset:32768
  v_mfma_f32_32x32x16_bf16 v[16:31], a[124:127], v[52:55], v[16:31]
  ds_read_b128 v[48:51], v13 offset:32768
  s_waitcnt lgkmcnt(2)
  v_mfma_f32_32x32x16_bf16 v[16:31], a[128:131], v[56:59], v[16:31]
  ds_read_b128 v[52:55], v10 offset:0
  s_add_u32 m0, s34, 20480
  s_add_u32 s35, s33, 640
  buffer_load_dwordx4 v2, s[4:7], s35 offen sc1 lds
  v_mfma_f32_32x32x16_bf16 v[16:31], a[132:135], v[60:63], v[16:31]
  ds_read_b128 v[56:59], v11 offset:0
  s_waitcnt lgkmcnt(2)
  v_mfma_f32_32x32x16_bf16 v[16:31], a[136:139], v[64:67], v[16:31]
  ds_read_b128 v[60:63], v12 offset:0
  ds_read_b128 v[32:35], v3 offset:128
  ds_read_b128 v[36:39], v3 offset:160
  ds_read_b128 v[40:43], v3 offset:192
  ds_read_b128 v[44:47], v3 offset:224
  v_mfma_f32_32x32x16_bf16 v[16:31], a[140:143], v[48:51], v[16:31]
  ds_read_b128 v[64:67], v13 offset:0
  s_waitcnt lgkmcnt(1)
  v_mfma_f32_32x32x16_bf16 v[32:47], a[144:147], v[52:55], v[32:47]
  ds_read_b128 v[48:51], v10 offset:4096
  s_add_u32 m0, s34, 24576
  s_add_u32 s35, s33, 768
  buffer_load_dwordx4 v2, s[4:7], s35 offen sc1 lds
  v_mfma_f32_32x32x16_bf16 v[32:47], a[148:151], v[56:59], v[32:47]
  ds_read_b128 v[52:55], v11 offset:4096
  s_waitcnt lgkmcnt(2)
  v_mfma_f32_32x32x16_bf16 v[32:47], a[152:155], v[60:63], v[32:47]
  ds_read_b128 v[56:59], v12 offset:4096
  v_mul_f32 v76, v16, v16
  v_fma_f32 v76, v76, s53, v15
  v_mul_f32 v76, v76, v16
  v_mul_f32 v77, v17, v17
  v_mfma_f32_32x32x16_bf16 v[32:47], a[156:159], v[64:67], v[32:47]
  ds_read_b128 v[60:63], v13 offset:4096
  v_exp_f32 v76, v76
  v_fma_f32 v77, v77, s53, v15
  v_add_f32 v76, 1.0, v76
  v_mul_f32 v77, v77, v17
  s_waitcnt lgkmcnt(2)
  v_mfma_f32_32x32x16_bf16 v[32:47], a[160:163], v[48:51], v[32:47]
  ds_read_b128 v[64:67], v10 offset:8192
  s_add_u32 m0, s34, 28672
  s_add_u32 s35, s33, 896
  buffer_load_dwordx4 v2, s[4:7], s35 offen sc1 lds
  v_mul_f32 v78, v18, v18
  v_rcp_f32 v76, v76
  v_exp_f32 v77, v77
  v_mfma_f32_32x32x16_bf16 v[32:47], a[164:167], v[52:55], v[32:47]
  ds_read_b128 v[48:51], v11 offset:8192
  v_fma_f32 v78, v78, s53, v15
  v_mul_f32 v16, v16, v76
  v_add_f32 v77, 1.0, v77
  v_mul_f32 v78, v78, v18
  v_mul_f32 v79, v19, v19
  s_waitcnt lgkmcnt(2)
  v_mfma_f32_32x32x16_bf16 v[32:47], a[168:171], v[56:59], v[32:47]
  ds_read_b128 v[52:55], v12 offset:8192
  v_rcp_f32 v77, v77
  v_exp_f32 v78, v78
  v_fma_f32 v79, v79, s53, v15
  v_mfma_f32_32x32x16_bf16 v[32:47], a[172:175], v[60:63], v[32:47]
  ds_read_b128 v[56:59], v13 offset:8192
  v_mul_f32 v17, v17, v77
  v_add_f32 v78, 1.0, v78
  v_mul_f32 v79, v79, v19
  v_mul_f32 v76, v20, v20
  s_waitcnt lgkmcnt(2)
  v_mfma_f32_32x32x16_bf16 v[32:47], a[176:179], v[64:67], v[32:47]
  ds_read_b128 v[60:63], v10 offset:12288
  s_add_u32 m0, s34, 32768
  s_add_u32 s35, s33, 1024
  buffer_load_dwordx4 v2, s[4:7], s35 offen sc1 lds
  v_cvt_pk_bf16_f32 v68, v16, v17
  v_rcp_f32 v78, v78
  v_exp_f32 v79, v79
  v_mfma_f32_32x32x16_bf16 v[32:47], a[180:183], v[48:51], v[32:47]
  ds_read_b128 v[64:67], v11 offset:12288
  v_fma_f32 v76, v76, s53, v15
  v_mul_f32 v18, v18, v78
  v_add_f32 v79, 1.0, v79
  v_mul_f32 v76, v76, v20
  v_mul_f32 v77, v21, v21
  s_waitcnt lgkmcnt(2)
  v_mfma_f32_32x32x16_bf16 v[32:47], a[184:187], v[52:55], v[32:47]
  ds_read_b128 v[48:51], v12 offset:12288
  v_rcp_f32 v79, v79
  v_exp_f32 v76, v76
  v_fma_f32 v77, v77, s53, v15
  v_mfma_f32_32x32x16_bf16 v[32:47], a[188:191], v[56:59], v[32:47]
  ds_read_b128 v[52:55], v13 offset:12288
  v_mul_f32 v19, v19, v79
  v_add_f32 v76, 1.0, v76
  v_mul_f32 v77, v77, v21
  v_mul_f32 v78, v22, v22
  s_waitcnt lgkmcnt(2)
  v_mfma_f32_32x32x16_bf16 v[32:47], a[192:195], v[60:63], v[32:47]
  ds_read_b128 v[56:59], v10 offset:16384
  v_cvt_pk_bf16_f32 v69, v18, v19
  v_rcp_f32 v76, v76
  v_exp_f32 v77, v77
  v_mfma_f32_32x32x16_bf16 v[32:47], a[196:199], v[64:67], v[32:47]
  ds_read_b128 v[60:63], v11 offset:16384
  v_fma_f32 v78, v78, s53, v15
  v_mul_f32 v20, v20, v76
  v_add_f32 v77, 1.0, v77
  v_mul_f32 v78, v78, v22
  v_mul_f32 v79, v23, v23
  s_waitcnt lgkmcnt(2)
  v_mfma_f32_32x32x16_bf16 v[32:47], a[200:203], v[48:51], v[32:47]
  ds_read_b128 v[64:67], v12 offset:16384
  v_rcp_f32 v77, v77
  v_exp_f32 v78, v78
  v_fma_f32 v79, v79, s53, v15
  v_mfma_f32_32x32x16_bf16 v[32:47], a[204:207], v[52:55], v[32:47]
  ds_read_b128 v[48:51], v13 offset:16384
  v_mul_f32 v21, v21, v77
  v_add_f32 v78, 1.0, v78
  v_mul_f32 v79, v79, v23
  v_mul_f32 v76, v24, v24
  s_waitcnt lgkmcnt(2)
  v_mfma_f32_32x32x16_bf16 v[32:47], a[208:211], v[56:59], v[32:47]
  ds_read_b128 v[52:55], v10 offset:20480
  v_cvt_pk_bf16_f32 v70, v20, v21
  v_rcp_f32 v78, v78
  v_exp_f32 v79, v79
  v_mfma_f32_32x32x16_bf16 v[32:47], a[212:215], v[60:63], v[32:47]
  ds_read_b128 v[56:59], v11 offset:20480
  v_fma_f32 v76, v76, s53, v15
  v_mul_f32 v22, v22, v78
  v_add_f32 v79, 1.0, v79
  v_mul_f32 v76, v76, v24
  v_mul_f32 v77, v25, v25
  s_waitcnt lgkmcnt(2)
  v_mfma_f32_32x32x16_bf16 v[32:47], a[216:219], v[64:67], v[32:47]
  ds_read_b128 v[60:63], v12 offset:20480
  v_rcp_f32 v79, v79
  v_exp_f32 v76, v76
  v_fma_f32 v77, v77, s53, v15
  v_mfma_f32_32x32x16_bf16 v[32:47], a[220:223], v[48:51], v[32:47]
  ds_read_b128 v[64:67], v13 offset:20480
  v_mul_f32 v23, v23, v79
  v_add_f32 v76, 1.0, v76
  v_mul_f32 v77, v77, v25
  v_mul_f32 v78, v26, v26
  s_waitcnt lgkmcnt(2)
  v_mfma_f32_32x32x16_bf16 v[32:47], a[224:227], v[52:55], v[32:47]
  ds_read_b128 v[48:51], v10 offset:24576
  v_cvt_pk_bf16_f32 v71, v22, v23
  v_rcp_f32 v76, v76
  v_exp_f32 v77, v77
  v_mfma_f32_32x32x16_bf16 v[32:47], a[228:231], v[56:59], v[32:47]
  ds_read_b128 v[52:55], v11 offset:24576
  v_fma_f32 v78, v78, s53, v15
  v_mul_f32 v24, v24, v76
  v_add_f32 v77, 1.0, v77
  v_mul_f32 v78, v78, v26
  v_mul_f32 v79, v27, v27
  s_waitcnt lgkmcnt(2)
  v_mfma_f32_32x32x16_bf16 v[32:47], a[232:235], v[60:63], v[32:47]
  ds_read_b128 v[56:59], v12 offset:24576
  v_rcp_f32 v77, v77
  v_exp_f32 v78, v78
  v_fma_f32 v79, v79, s53, v15
  v_mfma_f32_32x32x16_bf16 v[32:47], a[236:239], v[64:67], v[32:47]
  ds_read_b128 v[60:63], v13 offset:24576
  v_mul_f32 v25, v25, v77
  v_add_f32 v78, 1.0, v78
  v_mul_f32 v79, v79, v27
  v_mul_f32 v76, v28, v28
  s_waitcnt lgkmcnt(2)
  v_mfma_f32_32x32x16_bf16 v[32:47], a[240:243], v[48:51], v[32:47]
  ds_read_b128 v[64:67], v10 offset:28672
  v_cvt_pk_bf16_f32 v72, v24, v25
  v_rcp_f32 v78, v78
  v_exp_f32 v79, v79
  v_mfma_f32_32x32x16_bf16 v[32:47], a[244:247], v[52:55], v[32:47]
  ds_read_b128 v[48:51], v11 offset:28672
  v_fma_f32 v76, v76, s53, v15
  v_mul_f32 v26, v26, v78
  v_add_f32 v79, 1.0, v79
  v_mul_f32 v76, v76, v28
  v_mul_f32 v77, v29, v29
  s_waitcnt lgkmcnt(2)
  v_mfma_f32_32x32x16_bf16 v[32:47], a[248:251], v[56:59], v[32:47]
  ds_read_b128 v[52:55], v12 offset:28672
  v_rcp_f32 v79, v79
  v_exp_f32 v76, v76
  v_fma_f32 v77, v77, s53, v15
  v_mfma_f32_32x32x16_bf16 v[32:47], a[252:255], v[60:63], v[32:47]
  ds_read_b128 v[56:59], v13 offset:28672
  v_mul_f32 v27, v27, v79
  v_add_f32 v76, 1.0, v76
  v_mul_f32 v77, v77, v29
  v_mul_f32 v78, v30, v30
  s_waitcnt lgkmcnt(2)
  v_mfma_f32_32x32x16_bf16 v[32:47], v[80:83], v[64:67], v[32:47]
  ds_read_b128 v[60:63], v10 offset:32768
  v_cvt_pk_bf16_f32 v73, v26, v27
  v_rcp_f32 v76, v76
  v_exp_f32 v77, v77
  v_mfma_f32_32x32x16_bf16 v[32:47], v[84:87], v[48:51], v[32:47]
  ds_read_b128 v[64:67], v11 offset:32768
  v_fma_f32 v78, v78, s53, v15
  v_mul_f32 v28, v28, v76
  v_add_f32 v77, 1.0, v77
  v_mul_f32 v78, v78, v30
  v_mul_f32 v79, v31, v31
  s_waitcnt lgkmcnt(2)
  v_mfma_f32_32x32x16_bf16 v[32:47], v[88:91], v[52:55], v[32:47]
  ds_read_b128 v[48:51], v12 offset:32768
  v_rcp_f32 v77, v77
  v_exp_f32 v78, v78
  v_fma_f32 v79, v79, s53, v15
  v_mfma_f32_32x32x16_bf16 v[32:47], v[92:95], v[56:59], v[32:47]
  ds_read_b128 v[52:55], v13 offset:32768
  v_mul_f32 v29, v29, v77
  v_add_f32 v78, 1.0, v78
  v_mul_f32 v79, v79, v31
  v_cvt_pk_bf16_f32 v74, v28, v29
  s_waitcnt lgkmcnt(2)
  v_mfma_f32_32x32x16_bf16 v[32:47], v[96:99], v[60:63], v[32:47]
  ds_read_b128 v[56:59], v10 offset:0
  v_rcp_f32 v78, v78
  v_exp_f32 v79, v79
  v_mul_f32 v30, v30, v78
  v_mfma_f32_32x32x16_bf16 v[32:47], v[100:103], v[64:67], v[32:47]
  ds_read_b128 v[60:63], v11 offset:0
  v_add_f32 v79, 1.0, v79
  v_rcp_f32 v79, v79
  s_nop 0
  v_mul_f32 v31, v31, v79
  v_cvt_pk_bf16_f32 v75, v30, v31
  s_waitcnt lgkmcnt(2)
  v_mfma_f32_32x32x16_bf16 v[32:47], v[104:107], v[48:51], v[32:47]
  ds_read_b128 v[64:67], v12 offset:0
  s_add_u32 s38, s37, 0
  buffer_store_dwordx4 v[68:71], v1, s[4:7], s38 offen sc1
  ds_read_b128 v[16:19], v3 offset:256
  ds_read_b128 v[20:23], v3 offset:288
  ds_read_b128 v[24:27], v3 offset:320
  ds_read_b128 v[28:31], v3 offset:352
  v_mfma_f32_32x32x16_bf16 v[32:47], v[108:111], v[52:55], v[32:47]
  ds_read_b128 v[48:51], v13 offset:0
  buffer_store_dwordx4 v[72:75], v1, s[4:7], s38 offen offset:1024 sc1
  s_waitcnt lgkmcnt(1)
  v_mfma_f32_32x32x16_bf16 v[16:31], v[112:115], v[56:59], v[16:31]
  ds_read_b128 v[52:55], v10 offset:4096
  v_mfma_f32_32x32x16_bf16 v[16:31], v[116:119], v[60:63], v[16:31]
  ds_read_b128 v[56:59], v11 offset:4096
  s_waitcnt lgkmcnt(2)
  v_mfma_f32_32x32x16_bf16 v[16:31], v[120:123], v[64:67], v[16:31]
  ds_read_b128 v[60:63], v12 offset:4096
  v_mul_f32 v76, v32, v32
  v_fma_f32 v76, v76, s53, v15
  v_mul_f32 v76, v76, v32
  v_mul_f32 v77, v33, v33
  v_mfma_f32_32x32x16_bf16 v[16:31], v[124:127], v[48:51], v[16:31]
  ds_read_b128 v[64:67], v13 offset:4096
  v_exp_f32 v76, v76
  v_fma_f32 v77, v77, s53, v15
  v_add_f32 v76, 1.0, v76
  v_mul_f32 v77, v77, v33
  s_waitcnt lgkmcnt(2)
  v_mfma_f32_32x32x16_bf16 v[16:31], v[128:131], v[52:55], v[16:31]
  ds_read_b128 v[48:51], v10 offset:8192
  v_mul_f32 v78, v34, v34
  v_rcp_f32 v76, v76
  v_exp_f32 v77, v77
  v_mfma_f32_32x32x16_bf16 v[16:31], v[132:135], v[56:59], v[16:31]
  ds_read_b128 v[52:55], v11 offset:8192
  v_fma_f32 v78, v78, s53, v15
  v_mul_f32 v32, v32, v76
  v_add_f32 v77, 1.0, v77
  v_mul_f32 v78, v78, v34
  v_mul_f32 v79, v35, v35
  s_waitcnt lgkmcnt(2)
  v_mfma_f32_32x32x16_bf16 v[16:31], v[136:139], v[60:63], v[16:31]
  ds_read_b128 v[56:59], v12 offset:8192
  v_rcp_f32 v77, v77
  v_exp_f32 v78, v78
  v_fma_f32 v79, v79, s53, v15
  v_mfma_f32_32x32x16_bf16 v[16:31], v[140:143], v[64:67], v[16:31]
  ds_read_b128 v[60:63], v13 offset:8192
  v_mul_f32 v33, v33, v77
  v_add_f32 v78, 1.0, v78
  v_mul_f32 v79, v79, v35
  v_mul_f32 v76, v36, v36
  s_waitcnt lgkmcnt(2)
  v_mfma_f32_32x32x16_bf16 v[16:31], v[144:147], v[48:51], v[16:31]
  ds_read_b128 v[64:67], v10 offset:12288
  v_cvt_pk_bf16_f32 v68, v32, v33
  v_rcp_f32 v78, v78
  v_exp_f32 v79, v79
  v_mfma_f32_32x32x16_bf16 v[16:31], v[148:151], v[52:55], v[16:31]
  ds_read_b128 v[48:51], v11 offset:12288
  v_fma_f32 v76, v76, s53, v15
  v_mul_f32 v34, v34, v78
  v_add_f32 v79, 1.0, v79
  v_mul_f32 v76, v76, v36
  v_mul_f32 v77, v37, v37
  s_waitcnt lgkmcnt(2)
  v_mfma_f32_32x32x16_bf16 v[16:31], v[152:155], v[56:59], v[16:31]
  ds_read_b128 v[52:55], v12 offset:12288
  v_rcp_f32 v79, v79
  v_exp_f32 v76, v76
  v_fma_f32 v77, v77, s53, v15
  v_mfma_f32_32x32x16_bf16 v[16:31], v[156:159], v[60:63], v[16:31]
  ds_read_b128 v[56:59], v13 offset:12288
  v_mul_f32 v35, v35, v79
  v_add_f32 v76, 1.0, v76
  v_mul_f32 v77, v77, v37
  v_mul_f32 v78, v38, v38
  s_waitcnt lgkmcnt(2)
  v_mfma_f32_32x32x16_bf16 v[16:31], v[160:163], v[64:67], v[16:31]
  ds_read_b128 v[60:63], v10 offset:16384
  v_cvt_pk_bf16_f32 v69, v34, v35
  v_rcp_f32 v76, v76
  v_exp_f32 v77, v77
  v_mfma_f32_32x32x16_bf16 v[16:31], v[164:167], v[48:51], v[16:31]
  ds_read_b128 v[64:67], v11 offset:16384
  v_fma_f32 v78, v78, s53, v15
  v_mul_f32 v36, v36, v76
  v_add_f32 v77, 1.0, v77
  v_mul_f32 v78, v78, v38
  v_mul_f32 v79, v39, v39
  s_waitcnt lgkmcnt(2)
  v_mfma_f32_32x32x16_bf16 v[16:31], v[168:171], v[52:55], v[16:31]
  ds_read_b128 v[48:51], v12 offset:16384
  v_rcp_f32 v77, v77
  v_exp_f32 v78, v78
  v_fma_f32 v79, v79, s53, v15
  v_mfma_f32_32x32x16_bf16 v[16:31], v[172:175], v[56:59], v[16:31]
  ds_read_b128 v[52:55], v13 offset:16384
  v_mul_f32 v37, v37, v77
  v_add_f32 v78, 1.0, v78
  v_mul_f32 v79, v79, v39
  v_mul_f32 v76, v40, v40
  s_waitcnt lgkmcnt(2)
  v_mfma_f32_32x32x16_bf16 v[16:31], v[176:179], v[60:63], v[16:31]
  ds_read_b128 v[56:59], v10 offset:20480
  v_cvt_pk_bf16_f32 v70, v36, v37
  v_rcp_f32 v78, v78
  v_exp_f32 v79, v79
  v_mfma_f32_32x32x16_bf16 v[16:31], v[180:183], v[64:67], v[16:31]
  ds_read_b128 v[60:63], v11 offset:20480
  v_fma_f32 v76, v76, s53, v15
  v_mul_f32 v38, v38, v78
  v_add_f32 v79, 1.0, v79
  v_mul_f32 v76, v76, v40
  v_mul_f32 v77, v41, v41
  s_waitcnt lgkmcnt(2)
  v_mfma_f32_32x32x16_bf16 v[16:31], v[184:187], v[48:51], v[16:31]
  ds_read_b128 v[64:67], v12 offset:20480
  v_rcp_f32 v79, v79
  v_exp_f32 v76, v76
  v_fma_f32 v77, v77, s53, v15
  v_mfma_f32_32x32x16_bf16 v[16:31], v[188:191], v[52:55], v[16:31]
  ds_read_b128 v[48:51], v13 offset:20480
  v_mul_f32 v39, v39, v79
  v_add_f32 v76, 1.0, v76
  v_mul_f32 v77, v77, v41
  v_mul_f32 v78, v42, v42
  s_waitcnt lgkmcnt(2)
  v_mfma_f32_32x32x16_bf16 v[16:31], v[192:195], v[56:59], v[16:31]
  ds_read_b128 v[52:55], v10 offset:24576
  s_mov_b64 exec, s[48:49]
  buffer_load_dword v9, v7, s[4:7], 0 offen sc1
  s_mov_b64 exec, -1
  v_cvt_pk_bf16_f32 v71, v38, v39
  v_rcp_f32 v76, v76
  v_exp_f32 v77, v77
  v_mfma_f32_32x32x16_bf16 v[16:31], v[196:199], v[60:63], v[16:31]
  ds_read_b128 v[56:59], v11 offset:24576
  v_fma_f32 v78, v78, s53, v15
  v_mul_f32 v40, v40, v76
  v_add_f32 v77, 1.0, v77
  v_mul_f32 v78, v78, v42
  v_mul_f32 v79, v43, v43
  s_waitcnt lgkmcnt(2)
  v_mfma_f32_32x32x16_bf16 v[16:31], v[200:203], v[64:67], v[16:31]
  ds_read_b128 v[60:63], v12 offset:24576
  v_rcp_f32 v77, v77
  v_exp_f32 v78, v78
  v_fma_f32 v79, v79, s53, v15
  v_mfma_f32_32x32x16_bf16 v[16:31], v[204:207], v[48:51], v[16:31]
  ds_read_b128 v[64:67], v13 offset:24576
  v_mul_f32 v41, v41, v77
  v_add_f32 v78, 1.0, v78
  v_mul_f32 v79, v79, v43
  v_mul_f32 v76, v44, v44
  s_waitcnt lgkmcnt(2)
  v_mfma_f32_32x32x16_bf16 v[16:31], v[208:211], v[52:55], v[16:31]
  ds_read_b128 v[48:51], v10 offset:28672
  v_cvt_pk_bf16_f32 v72, v40, v41
  v_rcp_f32 v78, v78
  v_exp_f32 v79, v79
  v_mfma_f32_32x32x16_bf16 v[16:31], v[212:215], v[56:59], v[16:31]
  ds_read_b128 v[52:55], v11 offset:28672
  v_fma_f32 v76, v76, s53, v15
  v_mul_f32 v42, v42, v78
  v_add_f32 v79, 1.0, v79
  v_mul_f32 v76, v76, v44
  v_mul_f32 v77, v45, v45
  s_waitcnt lgkmcnt(2)
  v_mfma_f32_32x32x16_bf16 v[16:31], v[216:219], v[60:63], v[16:31]
  ds_read_b128 v[56:59], v12 offset:28672
  v_rcp_f32 v79, v79
  v_exp_f32 v76, v76
  v_fma_f32 v77, v77, s53, v15
  v_mfma_f32_32x32x16_bf16 v[16:31], v[220:223], v[64:67], v[16:31]
  ds_read_b128 v[60:63], v13 offset:28672
  v_mul_f32 v43, v43, v79
  v_add_f32 v76, 1.0, v76
  v_mul_f32 v77, v77, v45
  v_mul_f32 v78, v46, v46
  s_waitcnt lgkmcnt(2)
  v_mfma_f32_32x32x16_bf16 v[16:31], v[224:227], v[48:51], v[16:31]
  ds_read_b128 v[64:67], v10 offset:32768
  v_cvt_pk_bf16_f32 v73, v42, v43
  v_rcp_f32 v76, v76
  v_exp_f32 v77, v77
  v_mfma_f32_32x32x16_bf16 v[16:31], v[228:231], v[52:55], v[16:31]
  ds_read_b128 v[48:51], v11 offset:32768
  v_fma_f32 v78, v78, s53, v15
  v_mul_f32 v44, v44, v76
  v_add_f32 v77, 1.0, v77
  v_mul_f32 v78, v78, v46
  v_mul_f32 v79, v47, v47
  s_waitcnt lgkmcnt(2)
  v_mfma_f32_32x32x16_bf16 v[16:31], v[232:235], v[56:59], v[16:31]
  ds_read_b128 v[52:55], v12 offset:32768
  v_rcp_f32 v77, v77
  v_exp_f32 v78, v78
  v_fma_f32 v79, v79, s53, v15
  v_mfma_f32_32x32x16_bf16 v[16:31], v[236:239], v[60:63], v[16:31]
  ds_read_b128 v[56:59], v13 offset:32768
  v_mul_f32 v45, v45, v77
  v_add_f32 v78, 1.0, v78
  v_mul_f32 v79, v79, v47
  v_cvt_pk_bf16_f32 v74, v44, v45
  s_waitcnt lgkmcnt(2)
  v_mfma_f32_32x32x16_bf16 v[16:31], v[240:243], v[64:67], v[16:31]
  v_rcp_f32 v78, v78
  v_exp_f32 v79, v79
  v_mul_f32 v46, v46, v78
  v_mfma_f32_32x32x16_bf16 v[16:31], v[244:247], v[48:51], v[16:31]
  v_add_f32 v79, 1.0, v79
  v_rcp_f32 v79, v79
  s_nop 0
  v_mul_f32 v47, v47, v79
  v_cvt_pk_bf16_f32 v75, v46, v47
  s_waitcnt lgkmcnt(0)
  v_mfma_f32_32x32x16_bf16 v[16:31], v[248:251], v[52:55], v[16:31]
  s_add_u32 s38, s37, 2048
  buffer_store_dwordx4 v[68:71], v1, s[4:7], s38 offen sc1
  v_mfma_f32_32x32x16_bf16 v[16:31], v[252:255], v[56:59], v[16:31]
  buffer_store_dwordx4 v[72:75], v1, s[4:7], s38 offen offset:1024 sc1
  s_nop 10
  v_pk_mul_f32 v[48:49], v[16:17], v[16:17]
  v_pk_mul_f32 v[50:51], v[18:19], v[18:19]
  v_pk_mul_f32 v[52:53], v[20:21], v[20:21]
  v_pk_mul_f32 v[54:55], v[22:23], v[22:23]
  v_pk_fma_f32 v[48:49], v[48:49], s[54:55], v[14:15] op_sel:[0,0,1] op_sel_hi:[1,1,1]
  v_pk_fma_f32 v[50:51], v[50:51], s[54:55], v[14:15] op_sel:[0,0,1] op_sel_hi:[1,1,1]
  v_pk_fma_f32 v[52:53], v[52:53], s[54:55], v[14:15] op_sel:[0,0,1] op_sel_hi:[1,1,1]
  v_pk_fma_f32 v[54:55], v[54:55], s[54:55], v[14:15] op_sel:[0,0,1] op_sel_hi:[1,1,1]
  v_pk_mul_f32 v[48:49], v[48:49], v[16:17]
  v_pk_mul_f32 v[50:51], v[50:51], v[18:19]
  v_pk_mul_f32 v[52:53], v[52:53], v[20:21]
  v_pk_mul_f32 v[54:55], v[54:55], v[22:23]
  v_exp_f32 v48, v48
  v_exp_f32 v49, v49
  v_exp_f32 v50, v50
  v_exp_f32 v51, v51
  v_exp_f32 v52, v52
  v_exp_f32 v53, v53
  v_exp_f32 v54, v54
  v_exp_f32 v55, v55
  v_pk_add_f32 v[48:49], v[48:49], s[56:57]
  v_pk_add_f32 v[50:51], v[50:51], s[56:57]
  v_pk_add_f32 v[52:53], v[52:53], s[56:57]
  v_pk_add_f32 v[54:55], v[54:55], s[56:57]
  v_rcp_f32 v48, v48
  v_rcp_f32 v49, v49
  v_rcp_f32 v50, v50
  v_rcp_f32 v51, v51
  v_rcp_f32 v52, v52
  v_rcp_f32 v53, v53
  v_rcp_f32 v54, v54
  v_rcp_f32 v55, v55
  v_pk_mul_f32 v[16:17], v[16:17], v[48:49]
  v_pk_mul_f32 v[18:19], v[18:19], v[50:51]
  v_pk_mul_f32 v[20:21], v[20:21], v[52:53]
  v_pk_mul_f32 v[22:23], v[22:23], v[54:55]
  v_cvt_pk_bf16_f32 v68, v16, v17
  v_cvt_pk_bf16_f32 v69, v18, v19
  v_cvt_pk_bf16_f32 v70, v20, v21
  v_cvt_pk_bf16_f32 v71, v22, v23
  s_add_u32 s38, s37, 4096
  buffer_store_dwordx4 v[68:71], v1, s[4:7], s38 offen offset:0 sc1
  v_pk_mul_f32 v[48:49], v[24:25], v[24:25]
  v_pk_mul_f32 v[50:51], v[26:27], v[26:27]
  v_pk_mul_f32 v[52:53], v[28:29], v[28:29]
  v_pk_mul_f32 v[54:55], v[30:31], v[30:31]
  v_pk_fma_f32 v[48:49], v[48:49], s[54:55], v[14:15] op_sel:[0,0,1] op_sel_hi:[1,1,1]
  v_pk_fma_f32 v[50:51], v[50:51], s[54:55], v[14:15] op_sel:[0,0,1] op_sel_hi:[1,1,1]
  v_pk_fma_f32 v[52:53], v[52:53], s[54:55], v[14:15] op_sel:[0,0,1] op_sel_hi:[1,1,1]
  v_pk_fma_f32 v[54:55], v[54:55], s[54:55], v[14:15] op_sel:[0,0,1] op_sel_hi:[1,1,1]
  v_pk_mul_f32 v[48:49], v[48:49], v[24:25]
  v_pk_mul_f32 v[50:51], v[50:51], v[26:27]
  v_pk_mul_f32 v[52:53], v[52:53], v[28:29]
  v_pk_mul_f32 v[54:55], v[54:55], v[30:31]
  v_exp_f32 v48, v48
  v_exp_f32 v49, v49
  v_exp_f32 v50, v50
  v_exp_f32 v51, v51
  v_exp_f32 v52, v52
  v_exp_f32 v53, v53
  v_exp_f32 v54, v54
  v_exp_f32 v55, v55
  v_pk_add_f32 v[48:49], v[48:49], s[56:57]
  v_pk_add_f32 v[50:51], v[50:51], s[56:57]
  v_pk_add_f32 v[52:53], v[52:53], s[56:57]
  v_pk_add_f32 v[54:55], v[54:55], s[56:57]
  v_rcp_f32 v48, v48
  v_rcp_f32 v49, v49
  v_rcp_f32 v50, v50
  v_rcp_f32 v51, v51
  v_rcp_f32 v52, v52
  v_rcp_f32 v53, v53
  v_rcp_f32 v54, v54
  v_rcp_f32 v55, v55
  v_pk_mul_f32 v[24:25], v[24:25], v[48:49]
  v_pk_mul_f32 v[26:27], v[26:27], v[50:51]
  v_pk_mul_f32 v[28:29], v[28:29], v[52:53]
  v_pk_mul_f32 v[30:31], v[30:31], v[54:55]
  v_cvt_pk_bf16_f32 v72, v24, v25
  v_cvt_pk_bf16_f32 v73, v26, v27
  v_cvt_pk_bf16_f32 v74, v28, v29
  v_cvt_pk_bf16_f32 v75, v30, v31
  buffer_store_dwordx4 v[72:75], v1, s[4:7], s38 offen offset:1024 sc1
  v_add_u32 v10, s45, v10
  v_add_u32 v11, s45, v11
  v_add_u32 v12, s45, v12
  v_add_u32 v13, s45, v13
  s_sub_u32 s45, 0, s45
  s_bfe_u32 s35, s32, 0x10006
  s_lshl_b32 s35, s35, 2
  s_add_u32 s47, s46, s35
  s_and_b32 s50, s32, 63
  s_add_u32 s50, s50, 1
  s_waitcnt vmcnt(7)
  s_branch L_ffn1_run
L_ffn1_w36:
  v_mfma_f32_32x32x16_bf16 v[32:47], a[144:147], v[52:55], v[32:47]
  ds_read_b128 v[48:51], v10 offset:4096
  s_add_u32 m0, s34, 0
  s_add_u32 s35, s33, 0
  buffer_load_dwordx4 v2, s[4:7], s35 offen sc1 lds
  v_mfma_f32_32x32x16_bf16 v[32:47], a[148:151], v[56:59], v[32:47]
  ds_read_b128 v[52:55], v11 offset:4096
  s_waitcnt lgkmcnt(2)
  v_mfma_f32_32x32x16_bf16 v[32:47], a[152:155], v[60:63], v[32:47]
  ds_read_b128 v[56:59], v12 offset:4096
  v_mul_f32 v76, v16, v16
  v_fma_f32 v76, v76, s53, v15
  v_mul_f32 v76, v76, v16
  v_mul_f32 v77, v17, v17
  v_mfma_f32_32x32x16_bf16 v[32:47], a[156:159], v[64:67], v[32:47]
  ds_read_b128 v[60:63], v13 offset:4096
  s_add_u32 m0, s34, 4096
  s_add_u32 s35, s33, 128
  buffer_load_dwordx4 v2, s[4:7], s35 offen sc1 lds
  v_exp_f32 v76, v76
  v_fma_f32 v77, v77, s53, v15
  v_add_f32 v76, 1.0, v76
  v_mul_f32 v77, v77, v17
  s_waitcnt lgkmcnt(2)
  v_mfma_f32_32x32x16_bf16 v[32:47], a[160:163], v[48:51], v[32:47]
  ds_read_b128 v[64:67], v10 offset:8192
  v_mul_f32 v78, v18, v18
  v_rcp_f32 v76, v76
  v_exp_f32 v77, v77
  v_mfma_f32_32x32x16_bf16 v[32:47], a[164:167], v[52:55], v[32:47]
  ds_read_b128 v[48:51], v11 offset:8192
  v_fma_f32 v78, v78, s53, v15
  v_mul_f32 v16, v16, v76
  v_add_f32 v77, 1.0, v77
  v_mul_f32 v78, v78, v18
  v_mul_f32 v79, v19, v19
  s_waitcnt lgkmcnt(2)
  v_mfma_f32_32x32x16_bf16 v[32:47], a[168:171], v[56:59], v[32:47]
  ds_read_b128 v[52:55], v12 offset:8192
  s_add_u32 m0, s34, 8192
  s_add_u32 s35, s33, 256
  buffer_load_dwordx4 v2, s[4:7], s35 offen sc1 lds
  v_rcp_f32 v77, v77
  v_exp_f32 v78, v78
  v_fma_f32 v79, v79, s53, v15
  v_mfma_f32_32x32x16_bf16 v[32:47], a[172:175], v[60:63], v[32:47]
  ds_read_b128 v[56:59], v13 offset:8192
  v_mul_f32 v17, v17, v77
  v_add_f32 v78, 1.0, v78
  v_mul_f32 v79, v79, v19
  v_mul_f32 v76, v20, v20
  s_waitcnt lgkmcnt(2)
  v_mfma_f32_32x32x16_bf16 v[32:47], a[176:179], v[64:67], v[32:47]
  ds_read_b128 v[60:63], v10 offset:12288
  v_cvt_pk_bf16_f32 v68, v16, v17
  v_rcp_f32 v78, v78
  v_exp_f32 v79, v79
  v_mfma_f32_32x32x16_bf16 v[32:47], a[180:183], v[48:51], v[32:47]
  ds_read_b128 v[64:67], v11 offset:12288
  s_add_u32 m0, s34, 12288
  s_add_u32 s35, s33, 384
  buffer_load_dwordx4 v2, s[4:7], s35 offen sc1 lds
  v_fma_f32 v76, v76, s53, v15
  v_mul_f32 v18, v18, v78
  v_add_f32 v79, 1.0, v79
  v_mul_f32 v76, v76, v20
  v_mul_f32 v77, v21, v21
  s_waitcnt lgkmcnt(2)
  v_mfma_f32_32x32x16_bf16 v[32:47], a[184:187], v[52:55], v[32:47]
  ds_read_b128 v[48:51], v12 offset:12288
  v_rcp_f32 v79, v79
  v_exp_f32 v76, v76
  v_fma_f32 v77, v77, s53, v15
  v_mfma_f32_32x32x16_bf16 v[32:47], a[188:191], v[56:59], v[32:47]
  ds_read_b128 v[52:55], v13 offset:12288
  v_mul_f32 v19, v19, v79
  v_add_f32 v76, 1.0, v76
  v_mul_f32 v77, v77, v21
  v_mul_f32 v78, v22, v22
  s_waitcnt lgkmcnt(2)
  v_mfma_f32_32x32x16_bf16 v[32:47], a[192:195], v[60:63], v[32:47]
  ds_read_b128 v[56:59], v10 offset:16384
  s_add_u32 m0, s34, 16384
  s_add_u32 s35, s33, 512
  buffer_load_dwordx4 v2, s[4:7], s35 offen sc1 lds
  v_cvt_pk_bf16_f32 v69, v18, v19
  v_rcp_f32 v76, v76
  v_exp_f32 v77, v77
  v_mfma_f32_32x32x16_bf16 v[32:47], a[196:199], v[64:67], v[32:47]
  ds_read_b128 v[60:63], v11 offset:16384
  v_fma_f32 v78, v78, s53, v15
  v_mul_f32 v20, v20, v76
  v_add_f32 v77, 1.0, v77
  v_mul_f32 v78, v78, v22
  v_mul_f32 v79, v23, v23
  s_waitcnt lgkmcnt(2)
  v_mfma_f32_32x32x16_bf16 v[32:47], a[200:203], v[48:51], v[32:47]
  ds_read_b128 v[64:67], v12 offset:16384
  v_rcp_f32 v77, v77
  v_exp_f32 v78, v78
  v_fma_f32 v79, v79, s53, v15
  v_mfma_f32_32x32x16_bf16 v[32:47], a[204:207], v[52:55], v[32:47]
  ds_read_b128 v[48:51], v13 offset:16384
  s_add_u32 m0, s34, 20480
  s_add_u32 s35, s33, 640
  buffer_load_dwordx4 v2, s[4:7], s35 offen sc1 lds
  v_mul_f32 v21, v21, v77
  v_add_f32 v78, 1.0, v78
  v_mul_f32 v79, v79, v23
  v_mul_f32 v76, v24, v24
  s_waitcnt lgkmcnt(2)
  v_mfma_f32_32x32x16_bf16 v[32:47], a[208:211], v[56:59], v[32:47]
  ds_read_b128 v[52:55], v10 offset:20480
  v_cvt_pk_bf16_f32 v70, v20, v21
  v_rcp_f32 v78, v78
  v_exp_f32 v79, v79
  v_mfma_f32_32x32x16_bf16 v[32:47], a[212:215], v[60:63], v[32:47]
  ds_read_b128 v[56:59], v11 offset:20480
  v_fma_f32 v76, v76, s53, v15
  v_mul_f32 v22, v22, v78
  v_add_f32 v79, 1.0, v79
  v_mul_f32 v76, v76, v24
  v_mul_f32 v77, v25, v25
  s_waitcnt lgkmcnt(2)
  v_mfma_f32_32x32x16_bf16 v[32:47], a[216:219], v[64:67], v[32:47]
  ds_read_b128 v[60:63], v12 offset:20480
  s_add_u32 m0, s34, 24576
  s_add_u32 s35, s33, 768
  buffer_load_dwordx4 v2, s[4:7], s35 offen sc1 lds
  v_rcp_f32 v79, v79
  v_exp_f32 v76, v76
  v_fma_f32 v77, v77, s53, v15
  v_mfma_f32_32x32x16_bf16 v[32:47], a[220:223], v[48:51], v[32:47]
  ds_read_b128 v[64:67], v13 offset:20480
  v_mul_f32 v23, v23, v79
  v_add_f32 v76, 1.0, v76
  v_mul_f32 v77, v77, v25
  v_mul_f32 v78, v26, v26
  s_waitcnt lgkmcnt(2)
  v_mfma_f32_32x32x16_bf16 v[32:47], a[224:227], v[52:55], v[32:47]
  ds_read_b128 v[48:51], v10 offset:24576
  v_cvt_pk_bf16_f32 v71, v22, v23
  v_rcp_f32 v76, v76
  v_exp_f32 v77, v77
  v_mfma_f32_32x32x16_bf16 v[32:47], a[228:231], v[56:59], v[32:47]
  ds_read_b128 v[52:55], v11 offset:24576
  s_add_u32 m0, s34, 28672
  s_add_u32 s35, s33, 896
  buffer_load_dwordx4 v2, s[4:7], s35 offen sc1 lds
  v_fma_f32 v78, v78, s53, v15
  v_mul_f32 v24, v24, v76
  v_add_f32 v77, 1.0, v77
  v_mul_f32 v78, v78, v26
  v_mul_f32 v79, v27, v27
  s_waitcnt lgkmcnt(2)
  v_mfma_f32_32x32x16_bf16 v[32:47], a[232:235], v[60:63], v[32:47]
  ds_read_b128 v[56:59], v12 offset:24576
  v_rcp_f32 v77, v77
  v_exp_f32 v78, v78
  v_fma_f32 v79, v79, s53, v15
  v_mfma_f32_32x32x16_bf16 v[32:47], a[236:239], v[64:67], v[32:47]
  ds_read_b128 v[60:63], v13 offset:24576
  v_mul_f32 v25, v25, v77
  v_add_f32 v78, 1.0, v78
  v_mul_f32 v79, v79, v27
  v_mul_f32 v76, v28, v28
  s_waitcnt lgkmcnt(2)
  v_mfma_f32_32x32x16_bf16 v[32:47], a[240:243], v[48:51], v[32:47]
  ds_read_b128 v[64:67], v10 offset:28672
  s_add_u32 m0, s34, 32768
  s_add_u32 s35, s33, 1024
  buffer_load_dwordx4 v2, s[4:7], s35 offen sc1 lds
  v_cvt_pk_bf16_f32 v72, v24, v25
  v_rcp_f32 v78, v78
  v_exp_f32 v79, v79
  v_mfma_f32_32x32x16_bf16 v[32:47], a[244:247], v[52:55], v[32:47]
  ds_read_b128 v[48:51], v11 offset:28672
  v_fma_f32 v76, v76, s53, v15
  v_mul_f32 v26, v26, v78
  v_add_f32 v79, 1.0, v79
  v_mul_f32 v76, v76, v28
  v_mul_f32 v77, v29, v29
  s_waitcnt lgkmcnt(2)
  v_mfma_f32_32x32x16_bf16 v[32:47], a[248:251], v[56:59], v[32:47]
  ds_read_b128 v[52:55], v12 offset:28672
  v_rcp_f32 v79, v79
  v_exp_f32 v76, v76
  v_fma_f32 v77, v77, s53, v15
  v_mfma_f32_32x32x16_bf16 v[32:47], a[252:255], v[60:63], v[32:47]
  ds_read_b128 v[56:59], v13 offset:28672
  v_mul_f32 v27, v27, v79
  v_add_f32 v76, 1.0, v76
  v_mul_f32 v77, v77, v29
  v_mul_f32 v78, v30, v30
  s_waitcnt lgkmcnt(2)
  v_mfma_f32_32x32x16_bf16 v[32:47], v[80:83], v[64:67], v[32:47]
  ds_read_b128 v[60:63], v10 offset:32768
  v_cvt_pk_bf16_f32 v73, v26, v27
  v_rcp_f32 v76, v76
  v_exp_f32 v77, v77
  v_mfma_f32_32x32x16_bf16 v[32:47], v[84:87], v[48:51], v[32:47]
  ds_read_b128 v[64:67], v11 offset:32768
  v_fma_f32 v78, v78, s53, v15
  v_mul_f32 v28, v28, v76
  v_add_f32 v77, 1.0, v77
  v_mul_f32 v78, v78, v30
  v_mul_f32 v79, v31, v31
  s_waitcnt lgkmcnt(2)
  v_mfma_f32_32x32x16_bf16 v[32:47], v[88:91], v[52:55], v[32:47]
  ds_read_b128 v[48:51], v12 offset:32768
  v_rcp_f32 v77, v77
  v_exp_f32 v78, v78
  v_fma_f32 v79, v79, s53, v15
  v_mfma_f32_32x32x16_bf16 v[32:47], v[92:95], v[56:59], v[32:47]
  ds_read_b128 v[52:55], v13 offset:32768
  v_mul_f32 v29, v29, v77
  v_add_f32 v78, 1.0, v78
  v_mul_f32 v79, v79, v31
  v_cvt_pk_bf16_f32 v74, v28, v29
  s_waitcnt lgkmcnt(2)
  v_mfma_f32_32x32x16_bf16 v[32:47], v[96:99], v[60:63], v[32:47]
  ds_read_b128 v[56:59], v10 offset:0
  v_rcp_f32 v78, v78
  v_exp_f32 v79, v79
  v_mul_f32 v30, v30, v78
  v_mfma_f32_32x32x16_bf16 v[32:47], v[100:103], v[64:67], v[32:47]
  ds_read_b128 v[60:63], v11 offset:0
  v_add_f32 v79, 1.0, v79
  v_rcp_f32 v79, v79
  s_nop 0
  v_mul_f32 v31, v31, v79
  v_cvt_pk_bf16_f32 v75, v30, v31
  s_waitcnt lgkmcnt(2)
  v_mfma_f32_32x32x16_bf16 v[32:47], v[104:107], v[48:51], v[32:47]
  ds_read_b128 v[64:67], v12 offset:0
  s_add_u32 s38, s37, 0
  buffer_store_dwordx4 v[68:71], v1, s[4:7], s38 offen sc1
  ds_read_b128 v[16:19], v3 offset:256
  ds_read_b128 v[20:23], v3 offset:288
  ds_read_b128 v[24:27], v3 offset:320
  ds_read_b128 v[28:31], v3 offset:352
  v_mfma_f32_32x32x16_bf16 v[32:47], v[108:111], v[52:55], v[32:47]
  ds_read_b128 v[48:51], v13 offset:0
  buffer_store_dwordx4 v[72:75], v1, s[4:7], s38 offen offset:1024 sc1
  s_waitcnt lgkmcnt(1)
  v_mfma_f32_32x32x16_bf16 v[16:31], v[112:115], v[56:59], v[16:31]
  ds_read_b128 v[52:55], v10 offset:4096
  v_mfma_f32_32x32x16_bf16 v[16:31], v[116:119], v[60:63], v[16:31]
  ds_read_b128 v[56:59], v11 offset:4096
  s_waitcnt lgkmcnt(2)
  v_mfma_f32_32x32x16_bf16 v[16:31], v[120:123], v[64:67], v[16:31]
  ds_read_b128 v[60:63], v12 offset:4096
  v_mul_f32 v76, v32, v32
  v_fma_f32 v76, v76, s53, v15
  v_mul_f32 v76, v76, v32
  v_mul_f32 v77, v33, v33
  v_mfma_f32_32x32x16_bf16 v[16:31], v[124:127], v[48:51], v[16:31]
  ds_read_b128 v[64:67], v13 offset:4096
  v_exp_f32 v76, v76
  v_fma_f32 v77, v77, s53, v15
  v_add_f32 v76, 1.0, v76
  v_mul_f32 v77, v77, v33
  s_waitcnt lgkmcnt(2)
  v_mfma_f32_32x32x16_bf16 v[16:31], v[128:131], v[52:55], v[16:31]
  ds_read_b128 v[48:51], v10 offset:8192
  v_mul_f32 v78, v34, v34
  v_rcp_f32 v76, v76
  v_exp_f32 v77, v77
  v_mfma_f32_32x32x16_bf16 v[16:31], v[132:135], v[56:59], v[16:31]
  ds_read_b128 v[52:55], v11 offset:8192
  v_fma_f32 v78, v78, s53, v15
  v_mul_f32 v32, v32, v76
  v_add_f32 v77, 1.0, v77
  v_mul_f32 v78, v78, v34
  v_mul_f32 v79, v35, v35
  s_waitcnt lgkmcnt(2)
  v_mfma_f32_32x32x16_bf16 v[16:31], v[136:139], v[60:63], v[16:31]
  ds_read_b128 v[56:59], v12 offset:8192
  v_rcp_f32 v77, v77
  v_exp_f32 v78, v78
  v_fma_f32 v79, v79, s53, v15
  v_mfma_f32_32x32x16_bf16 v[16:31], v[140:143], v[64:67], v[16:31]
  ds_read_b128 v[60:63], v13 offset:8192
  v_mul_f32 v33, v33, v77
  v_add_f32 v78, 1.0, v78
  v_mul_f32 v79, v79, v35
  v_mul_f32 v76, v36, v36
  s_waitcnt lgkmcnt(2)
  v_mfma_f32_32x32x16_bf16 v[16:31], v[144:147], v[48:51], v[16:31]
  ds_read_b128 v[64:67], v10 offset:12288
  v_cvt_pk_bf16_f32 v68, v32, v33
  v_rcp_f32 v78, v78
  v_exp_f32 v79, v79
  v_mfma_f32_32x32x16_bf16 v[16:31], v[148:151], v[52:55], v[16:31]
  ds_read_b128 v[48:51], v11 offset:12288
  v_fma_f32 v76, v76, s53, v15
  v_mul_f32 v34, v34, v78
  v_add_f32 v79, 1.0, v79
  v_mul_f32 v76, v76, v36
  v_mul_f32 v77, v37, v37
  s_waitcnt lgkmcnt(2)
  v_mfma_f32_32x32x16_bf16 v[16:31], v[152:155], v[56:59], v[16:31]
  ds_read_b128 v[52:55], v12 offset:12288
  v_rcp_f32 v79, v79
  v_exp_f32 v76, v76
  v_fma_f32 v77, v77, s53, v15
  v_mfma_f32_32x32x16_bf16 v[16:31], v[156:159], v[60:63], v[16:31]
  ds_read_b128 v[56:59], v13 offset:12288
  v_mul_f32 v35, v35, v79
  v_add_f32 v76, 1.0, v76
  v_mul_f32 v77, v77, v37
  v_mul_f32 v78, v38, v38
  s_waitcnt lgkmcnt(2)
  v_mfma_f32_32x32x16_bf16 v[16:31], v[160:163], v[64:67], v[16:31]
  ds_read_b128 v[60:63], v10 offset:16384
  v_cvt_pk_bf16_f32 v69, v34, v35
  v_rcp_f32 v76, v76
  v_exp_f32 v77, v77
  v_mfma_f32_32x32x16_bf16 v[16:31], v[164:167], v[48:51], v[16:31]
  ds_read_b128 v[64:67], v11 offset:16384
  v_fma_f32 v78, v78, s53, v15
  v_mul_f32 v36, v36, v76
  v_add_f32 v77, 1.0, v77
  v_mul_f32 v78, v78, v38
  v_mul_f32 v79, v39, v39
  s_waitcnt lgkmcnt(2)
  v_mfma_f32_32x32x16_bf16 v[16:31], v[168:171], v[52:55], v[16:31]
  ds_read_b128 v[48:51], v12 offset:16384
  v_rcp_f32 v77, v77
  v_exp_f32 v78, v78
  v_fma_f32 v79, v79, s53, v15
  v_mfma_f32_32x32x16_bf16 v[16:31], v[172:175], v[56:59], v[16:31]
  ds_read_b128 v[52:55], v13 offset:16384
  v_mul_f32 v37, v37, v77
  v_add_f32 v78, 1.0, v78
  v_mul_f32 v79, v79, v39
  v_mul_f32 v76, v40, v40
  s_waitcnt lgkmcnt(2)
  v_mfma_f32_32x32x16_bf16 v[16:31], v[176:179], v[60:63], v[16:31]
  ds_read_b128 v[56:59], v10 offset:20480
  v_cvt_pk_bf16_f32 v70, v36, v37
  v_rcp_f32 v78, v78
  v_exp_f32 v79, v79
  v_mfma_f32_32x32x16_bf16 v[16:31], v[180:183], v[64:67], v[16:31]
  ds_read_b128 v[60:63], v11 offset:20480
  v_fma_f32 v76, v76, s53, v15
  v_mul_f32 v38, v38, v78
  v_add_f32 v79, 1.0, v79
  v_mul_f32 v76, v76, v40
  v_mul_f32 v77, v41, v41
  s_waitcnt lgkmcnt(2)
  v_mfma_f32_32x32x16_bf16 v[16:31], v[184:187], v[48:51], v[16:31]
  ds_read_b128 v[64:67], v12 offset:20480
  v_rcp_f32 v79, v79
  v_exp_f32 v76, v76
  v_fma_f32 v77, v77, s53, v15
  v_mfma_f32_32x32x16_bf16 v[16:31], v[188:191], v[52:55], v[16:31]
  ds_read_b128 v[48:51], v13 offset:20480
  v_mul_f32 v39, v39, v79
  v_add_f32 v76, 1.0, v76
  v_mul_f32 v77, v77, v41
  v_mul_f32 v78, v42, v42
  s_waitcnt lgkmcnt(2)
  v_mfma_f32_32x32x16_bf16 v[16:31], v[192:195], v[56:59], v[16:31]
  ds_read_b128 v[52:55], v10 offset:24576
  s_mov_b64 exec, s[48:49]
  buffer_load_dword v9, v7, s[4:7], 0 offen sc1
  s_mov_b64 exec, -1
  v_cvt_pk_bf16_f32 v71, v38, v39
  v_rcp_f32 v76, v76
  v_exp_f32 v77, v77
  v_mfma_f32_32x32x16_bf16 v[16:31], v[196:199], v[60:63], v[16:31]
  ds_read_b128 v[56:59], v11 offset:24576
  v_fma_f32 v78, v78, s53, v15
  v_mul_f32 v40, v40, v76
  v_add_f32 v77, 1.0, v77
  v_mul_f32 v78, v78, v42
  v_mul_f32 v79, v43, v43
  s_waitcnt lgkmcnt(2)
  v_mfma_f32_32x32x16_bf16 v[16:31], v[200:203], v[64:67], v[16:31]
  ds_read_b128 v[60:63], v12 offset:24576
  v_rcp_f32 v77, v77
  v_exp_f32 v78, v78
  v_fma_f32 v79, v79, s53, v15
  v_mfma_f32_32x32x16_bf16 v[16:31], v[204:207], v[48:51], v[16:31]
  ds_read_b128 v[64:67], v13 offset:24576
  v_mul_f32 v41, v41, v77
  v_add_f32 v78, 1.0, v78
  v_mul_f32 v79, v79, v43
  v_mul_f32 v76, v44, v44
  s_waitcnt lgkmcnt(2)
  v_mfma_f32_32x32x16_bf16 v[16:31], v[208:211], v[52:55], v[16:31]
  ds_read_b128 v[48:51], v10 offset:28672
  v_cvt_pk_bf16_f32 v72, v40, v41
  v_rcp_f32 v78, v78
  v_exp_f32 v79, v79
  v_mfma_f32_32x32x16_bf16 v[16:31], v[212:215], v[56:59], v[16:31]
  ds_read_b128 v[52:55], v11 offset:28672
  v_fma_f32 v76, v76, s53, v15
  v_mul_f32 v42, v42, v78
  v_add_f32 v79, 1.0, v79
  v_mul_f32 v76, v76, v44
  v_mul_f32 v77, v45, v45
  s_waitcnt lgkmcnt(2)
  v_mfma_f32_32x32x16_bf16 v[16:31], v[216:219], v[60:63], v[16:31]
  ds_read_b128 v[56:59], v12 offset:28672
  v_rcp_f32 v79, v79
  v_exp_f32 v76, v76
  v_fma_f32 v77, v77, s53, v15
  v_mfma_f32_32x32x16_bf16 v[16:31], v[220:223], v[64:67], v[16:31]
  ds_read_b128 v[60:63], v13 offset:28672
  v_mul_f32 v43, v43, v79
  v_add_f32 v76, 1.0, v76
  v_mul_f32 v77, v77, v45
  v_mul_f32 v78, v46, v46
  s_waitcnt lgkmcnt(2)
  v_mfma_f32_32x32x16_bf16 v[16:31], v[224:227], v[48:51], v[16:31]
  ds_read_b128 v[64:67], v10 offset:32768
  v_cvt_pk_bf16_f32 v73, v42, v43
  v_rcp_f32 v76, v76
  v_exp_f32 v77, v77
  v_mfma_f32_32x32x16_bf16 v[16:31], v[228:231], v[52:55], v[16:31]
  ds_read_b128 v[48:51], v11 offset:32768
  v_fma_f32 v78, v78, s53, v15
  v_mul_f32 v44, v44, v76
  v_add_f32 v77, 1.0, v77
  v_mul_f32 v78, v78, v46
  v_mul_f32 v79, v47, v47
  s_waitcnt lgkmcnt(2)
  v_mfma_f32_32x32x16_bf16 v[16:31], v[232:235], v[56:59], v[16:31]
  ds_read_b128 v[52:55], v12 offset:32768
  v_rcp_f32 v77, v77
  v_exp_f32 v78, v78
  v_fma_f32 v79, v79, s53, v15
  v_mfma_f32_32x32x16_bf16 v[16:31], v[236:239], v[60:63], v[16:31]
  ds_read_b128 v[56:59], v13 offset:32768
  v_mul_f32 v45, v45, v77
  v_add_f32 v78, 1.0, v78
  v_mul_f32 v79, v79, v47
  v_cvt_pk_bf16_f32 v74, v44, v45
  s_waitcnt lgkmcnt(2)
  v_mfma_f32_32x32x16_bf16 v[16:31], v[240:243], v[64:67], v[16:31]
  v_rcp_f32 v78, v78
  v_exp_f32 v79, v79
  v_mul_f32 v46, v46, v78
  v_mfma_f32_32x32x16_bf16 v[16:31], v[244:247], v[48:51], v[16:31]
  v_add_f32 v79, 1.0, v79
  v_rcp_f32 v79, v79
  s_nop 0
  v_mul_f32 v47, v47, v79
  v_cvt_pk_bf16_f32 v75, v46, v47
  s_waitcnt lgkmcnt(0)
  v_mfma_f32_32x32x16_bf16 v[16:31], v[248:251], v[52:55], v[16:31]
  s_add_u32 s38, s37, 2048
  buffer_store_dwordx4 v[68:71], v1, s[4:7], s38 offen sc1
  v_mfma_f32_32x32x16_bf16 v[16:31], v[252:255], v[56:59], v[16:31]
  buffer_store_dwordx4 v[72:75], v1, s[4:7], s38 offen offset:1024 sc1
  s_nop 10
  v_pk_mul_f32 v[48:49], v[16:17], v[16:17]
  v_pk_mul_f32 v[50:51], v[18:19], v[18:19]
  v_pk_mul_f32 v[52:53], v[20:21], v[20:21]
  v_pk_mul_f32 v[54:55], v[22:23], v[22:23]
  v_pk_fma_f32 v[48:49], v[48:49], s[54:55], v[14:15] op_sel:[0,0,1] op_sel_hi:[1,1,1]
  v_pk_fma_f32 v[50:51], v[50:51], s[54:55], v[14:15] op_sel:[0,0,1] op_sel_hi:[1,1,1]
  v_pk_fma_f32 v[52:53], v[52:53], s[54:55], v[14:15] op_sel:[0,0,1] op_sel_hi:[1,1,1]
  v_pk_fma_f32 v[54:55], v[54:55], s[54:55], v[14:15] op_sel:[0,0,1] op_sel_hi:[1,1,1]
  v_pk_mul_f32 v[48:49], v[48:49], v[16:17]
  v_pk_mul_f32 v[50:51], v[50:51], v[18:19]
  v_pk_mul_f32 v[52:53], v[52:53], v[20:21]
  v_pk_mul_f32 v[54:55], v[54:55], v[22:23]
  v_exp_f32 v48, v48
  v_exp_f32 v49, v49
  v_exp_f32 v50, v50
  v_exp_f32 v51, v51
  v_exp_f32 v52, v52
  v_exp_f32 v53, v53
  v_exp_f32 v54, v54
  v_exp_f32 v55, v55
  v_pk_add_f32 v[48:49], v[48:49], s[56:57]
  v_pk_add_f32 v[50:51], v[50:51], s[56:57]
  v_pk_add_f32 v[52:53], v[52:53], s[56:57]
  v_pk_add_f32 v[54:55], v[54:55], s[56:57]
  v_rcp_f32 v48, v48
  v_rcp_f32 v49, v49
  v_rcp_f32 v50, v50
  v_rcp_f32 v51, v51
  v_rcp_f32 v52, v52
  v_rcp_f32 v53, v53
  v_rcp_f32 v54, v54
  v_rcp_f32 v55, v55
  v_pk_mul_f32 v[16:17], v[16:17], v[48:49]
  v_pk_mul_f32 v[18:19], v[18:19], v[50:51]
  v_pk_mul_f32 v[20:21], v[20:21], v[52:53]
  v_pk_mul_f32 v[22:23], v[22:23], v[54:55]
  v_cvt_pk_bf16_f32 v68, v16, v17
  v_cvt_pk_bf16_f32 v69, v18, v19
  v_cvt_pk_bf16_f32 v70, v20, v21
  v_cvt_pk_bf16_f32 v71, v22, v23
  s_add_u32 s38, s37, 4096
  buffer_store_dwordx4 v[68:71], v1, s[4:7], s38 offen offset:0 sc1
  v_pk_mul_f32 v[48:49], v[24:25], v[24:25]
  v_pk_mul_f32 v[50:51], v[26:27], v[26:27]
  v_pk_mul_f32 v[52:53], v[28:29], v[28:29]
  v_pk_mul_f32 v[54:55], v[30:31], v[30:31]
  v_pk_fma_f32 v[48:49], v[48:49], s[54:55], v[14:15] op_sel:[0,0,1] op_sel_hi:[1,1,1]
  v_pk_fma_f32 v[50:51], v[50:51], s[54:55], v[14:15] op_sel:[0,0,1] op_sel_hi:[1,1,1]
  v_pk_fma_f32 v[52:53], v[52:53], s[54:55], v[14:15] op_sel:[0,0,1] op_sel_hi:[1,1,1]
  v_pk_fma_f32 v[54:55], v[54:55], s[54:55], v[14:15] op_sel:[0,0,1] op_sel_hi:[1,1,1]
  v_pk_mul_f32 v[48:49], v[48:49], v[24:25]
  v_pk_mul_f32 v[50:51], v[50:51], v[26:27]
  v_pk_mul_f32 v[52:53], v[52:53], v[28:29]
  v_pk_mul_f32 v[54:55], v[54:55], v[30:31]
  v_exp_f32 v48, v48
  v_exp_f32 v49, v49
  v_exp_f32 v50, v50
  v_exp_f32 v51, v51
  v_exp_f32 v52, v52
  v_exp_f32 v53, v53
  v_exp_f32 v54, v54
  v_exp_f32 v55, v55
  v_pk_add_f32 v[48:49], v[48:49], s[56:57]
  v_pk_add_f32 v[50:51], v[50:51], s[56:57]
  v_pk_add_f32 v[52:53], v[52:53], s[56:57]
  v_pk_add_f32 v[54:55], v[54:55], s[56:57]
  v_rcp_f32 v48, v48
  v_rcp_f32 v49, v49
  v_rcp_f32 v50, v50
  v_rcp_f32 v51, v51
  v_rcp_f32 v52, v52
  v_rcp_f32 v53, v53
  v_rcp_f32 v54, v54
  v_rcp_f32 v55, v55
  v_pk_mul_f32 v[24:25], v[24:25], v[48:49]
  v_pk_mul_f32 v[26:27], v[26:27], v[50:51]
  v_pk_mul_f32 v[28:29], v[28:29], v[52:53]
  v_pk_mul_f32 v[30:31], v[30:31], v[54:55]
  v_cvt_pk_bf16_f32 v72, v24, v25
  v_cvt_pk_bf16_f32 v73, v26, v27
  v_cvt_pk_bf16_f32 v74, v28, v29
  v_cvt_pk_bf16_f32 v75, v30, v31
  buffer_store_dwordx4 v[72:75], v1, s[4:7], s38 offen offset:1024 sc1
  v_add_u32 v10, s45, v10
  v_add_u32 v11, s45, v11
  v_add_u32 v12, s45, v12
  v_add_u32 v13, s45, v13
  s_sub_u32 s45, 0, s45
  s_bfe_u32 s35, s32, 0x10006
  s_lshl_b32 s35, s35, 2
  s_add_u32 s47, s46, s35
  s_and_b32 s50, s32, 63
  s_add_u32 s50, s50, 1
  s_waitcnt vmcnt(7)
  s_branch L_ffn1_run
L_ffn1_w60:
  v_mfma_f32_32x32x16_bf16 v[32:47], a[240:243], v[48:51], v[32:47]
  ds_read_b128 v[64:67], v10 offset:28672
  s_add_u32 m0, s34, 0
  s_add_u32 s35, s33, 0
  buffer_load_dwordx4 v2, s[4:7], s35 offen sc1 lds
  v_cvt_pk_bf16_f32 v72, v24, v25
  v_rcp_f32 v78, v78
  v_exp_f32 v79, v79
  v_mfma_f32_32x32x16_bf16 v[32:47], a[244:247], v[52:55], v[32:47]
  ds_read_b128 v[48:51], v11 offset:28672
  v_fma_f32 v76, v76, s53, v15
  v_mul_f32 v26, v26, v78
  v_add_f32 v79, 1.0, v79
  v_mul_f32 v76, v76, v28
  v_mul_f32 v77, v29, v29
  s_waitcnt lgkmcnt(2)
  v_mfma_f32_32x32x16_bf16 v[32:47], a[248:251], v[56:59], v[32:47]
  ds_read_b128 v[52:55], v12 offset:28672
  v_rcp_f32 v79, v79
  v_exp_f32 v76, v76
  v_fma_f32 v77, v77, s53, v15
  v_mfma_f32_32x32x16_bf16 v[32:47], a[252:255], v[60:63], v[32:47]
  ds_read_b128 v[56:59], v13 offset:28672
  s_add_u32 m0, s34, 4096
  s_add_u32 s35, s33, 128
  buffer_load_dwordx4 v2, s[4:7], s35 offen sc1 lds
  v_mul_f32 v27, v27, v79
  v_add_f32 v76, 1.0, v76
  v_mul_f32 v77, v77, v29
  v_mul_f32 v78, v30, v30
  s_waitcnt lgkmcnt(2)
  v_mfma_f32_32x32x16_bf16 v[32:47], v[80:83], v[64:67], v[32:47]
  ds_read_b128 v[60:63], v10 offset:32768
  v_cvt_pk_bf16_f32 v73, v26, v27
  v_rcp_f32 v76, v76
  v_exp_f32 v77, v77
  v_mfma_f32_32x32x16_bf16 v[32:47], v[84:87], v[48:51], v[32:47]
  ds_read_b128 v[64:67], v11 offset:32768
  v_fma_f32 v78, v78, s53, v15
  v_mul_f32 v28, v28, v76
  v_add_f32 v77, 1.0, v77
  v_mul_f32 v78, v78, v30
  v_mul_f32 v79, v31, v31
  s_waitcnt lgkmcnt(2)
  v_mfma_f32_32x32x16_bf16 v[32:47], v[88:91], v[52:55], v[32:47]
  ds_read_b128 v[48:51], v12 offset:32768
  s_add_u32 m0, s34, 8192
  s_add_u32 s35, s33, 256
  buffer_load_dwordx4 v2, s[4:7], s35 offen sc1 lds
  v_rcp_f32 v77, v77
  v_exp_f32 v78, v78
  v_fma_f32 v79, v79, s53, v15
  v_mfma_f32_32x32x16_bf16 v[32:47], v[92:95], v[56:59], v[32:47]
  ds_read_b128 v[52:55], v13 offset:32768
  v_mul_f32 v29, v29, v77
  v_add_f32 v78, 1.0, v78
  v_mul_f32 v79, v79, v31
  v_cvt_pk_bf16_f32 v74, v28, v29
  s_waitcnt lgkmcnt(2)
  v_mfma_f32_32x32x16_bf16 v[32:47], v[96:99], v[60:63], v[32:47]
  ds_read_b128 v[56:59], v10 offset:0
  v_rcp_f32 v78, v78
  v_exp_f32 v79, v79
  v_mul_f32 v30, v30, v78
  v_mfma_f32_32x32x16_bf16 v[32:47], v[100:103], v[64:67], v[32:47]
  ds_read_b128 v[60:63], v11 offset:0
  s_add_u32 m0, s34, 12288
  s_add_u32 s35, s33, 384
  buffer_load_dwordx4 v2, s[4:7], s35 offen sc1 lds
  v_add_f32 v79, 1.0, v79
  v_rcp_f32 v79, v79
  s_nop 0
  v_mul_f32 v31, v31, v79
  v_cvt_pk_bf16_f32 v75, v30, v31
  s_waitcnt lgkmcnt(2)
  v_mfma_f32_32x32x16_bf16 v[32:47], v[104:107], v[48:51], v[32:47]
  ds_read_b128 v[64:67], v12 offset:0
  s_add_u32 s38, s37, 0
  buffer_store_dwordx4 v[68:71], v1, s[4:7], s38 offen sc1
  ds_read_b128 v[16:19], v3 offset:256
  ds_read_b128 v[20:23], v3 offset:288
  ds_read_b128 v[24:27], v3 offset:320
  ds_read_b128 v[28:31], v3 offset:352
  v_mfma_f32_32x32x16_bf16 v[32:47], v[108:111], v[52:55], v[32:47]
  ds_read_b128 v[48:51], v13 offset:0
  buffer_store_dwordx4 v[72:75], v1, s[4:7], s38 offen offset:1024 sc1
  s_waitcnt lgkmcnt(1)
  v_mfma_f32_32x32x16_bf16 v[16:31], v[112:115], v[56:59], v[16:31]
  ds_read_b128 v[52:55], v10 offset:4096
  s_add_u32 m0, s34, 16384
  s_add_u32 s35, s33, 512
  buffer_load_dwordx4 v2, s[4:7], s35 offen sc1 lds
  v_mfma_f32_32x32x16_bf16 v[16:31], v[116:119], v[60:63], v[16:31]
  ds_read_b128 v[56:59], v11 offset:4096
  s_waitcnt lgkmcnt(2)
  v_mfma_f32_32x32x16_bf16 v[16:31], v[120:123], v[64:67], v[16:31]
  ds_read_b128 v[60:63], v12 offset:4096
  v_mul_f32 v76, v32, v32
  v_fma_f32 v76, v76, s53, v15
  v_mul_f32 v76, v76, v32
  v_mul_f32 v77, v33, v33
  v_mfma_f32_32x32x16_bf16 v[16:31], v[124:127], v[48:51], v[16:31]
  ds_read_b128 v[64:67], v13 offset:4096
  s_add_u32 m0, s34, 20480
  s_add_u32 s35, s33, 640
  buffer_load_dwordx4 v2, s[4:7], s35 offen sc1 lds
  v_exp_f32 v76, v76
  v_fma_f32 v77, v77, s53, v15
  v_add_f32 v76, 1.0, v76
  v_mul_f32 v77, v77, v33
  s_waitcnt lgkmcnt(2)
  v_mfma_f32_32x32x16_bf16 v[16:31], v[128:131], v[52:55], v[16:31]
  ds_read_b128 v[48:51], v10 offset:8192
  v_mul_f32 v78, v34, v34
  v_rcp_f32 v76, v76
  v_exp_f32 v77, v77
  v_mfma_f32_32x32x16_bf16 v[16:31], v[132:135], v[56:59], v[16:31]
  ds_read_b128 v[52:55], v11 offset:8192
  v_fma_f32 v78, v78, s53, v15
  v_mul_f32 v32, v32, v76
  v_add_f32 v77, 1.0, v77
  v_mul_f32 v78, v78, v34
  v_mul_f32 v79, v35, v35
  s_waitcnt lgkmcnt(2)
  v_mfma_f32_32x32x16_bf16 v[16:31], v[136:139], v[60:63], v[16:31]
  ds_read_b128 v[56:59], v12 offset:8192
  s_add_u32 m0, s34, 24576
  s_add_u32 s35, s33, 768
  buffer_load_dwordx4 v2, s[4:7], s35 offen sc1 lds
  v_rcp_f32 v77, v77
  v_exp_f32 v78, v78
  v_fma_f32 v79, v79, s53, v15
  v_mfma_f32_32x32x16_bf16 v[16:31], v[140:143], v[64:67], v[16:31]
  ds_read_b128 v[60:63], v13 offset:8192
  v_mul_f32 v33, v33, v77
  v_add_f32 v78, 1.0, v78
  v_mul_f32 v79, v79, v35
  v_mul_f32 v76, v36, v36
  s_waitcnt lgkmcnt(2)
  v_mfma_f32_32x32x16_bf16 v[16:31], v[144:147], v[48:51], v[16:31]
  ds_read_b128 v[64:67], v10 offset:12288
  v_cvt_pk_bf16_f32 v68, v32, v33
  v_rcp_f32 v78, v78
  v_exp_f32 v79, v79
  v_mfma_f32_32x32x16_bf16 v[16:31], v[148:151], v[52:55], v[16:31]
  ds_read_b128 v[48:51], v11 offset:12288
  s_add_u32 m0, s34, 28672
  s_add_u32 s35, s33, 896
  buffer_load_dwordx4 v2, s[4:7], s35 offen sc1 lds
  v_fma_f32 v76, v76, s53, v15
  v_mul_f32 v34, v34, v78
  v_add_f32 v79, 1.0, v79
  v_mul_f32 v76, v76, v36
  v_mul_f32 v77, v37, v37
  s_waitcnt lgkmcnt(2)
  v_mfma_f32_32x32x16_bf16 v[16:31], v[152:155], v[56:59], v[16:31]
  ds_read_b128 v[52:55], v12 offset:12288
  v_rcp_f32 v79, v79
  v_exp_f32 v76, v76
  v_fma_f32 v77, v77, s53, v15
  v_mfma_f32_32x32x16_bf16 v[16:31], v[156:159], v[60:63], v[16:31]
  ds_read_b128 v[56:59], v13 offset:12288
  v_mul_f32 v35, v35, v79
  v_add_f32 v76, 1.0, v76
  v_mul_f32 v77, v77, v37
  v_mul_f32 v78, v38, v38
  s_waitcnt lgkmcnt(2)
  v_mfma_f32_32x32x16_bf16 v[16:31], v[160:163], v[64:67], v[16:31]
  ds_read_b128 v[60:63], v10 offset:16384
  s_add_u32 m0, s34, 32768
  s_add_u32 s35, s33, 1024
  buffer_load_dwordx4 v2, s[4:7], s35 offen sc1 lds
  v_cvt_pk_bf16_f32 v69, v34, v35
  v_rcp_f32 v76, v76
  v_exp_f32 v77, v77
  v_mfma_f32_32x32x16_bf16 v[16:31], v[164:167], v[48:51], v[16:31]
  ds_read_b128 v[64:67], v11 offset:16384
  v_fma_f32 v78, v78, s53, v15
  v_mul_f32 v36, v36, v76
  v_add_f32 v77, 1.0, v77
  v_mul_f32 v78, v78, v38
  v_mul_f32 v79, v39, v39
  s_waitcnt lgkmcnt(2)
  v_mfma_f32_32x32x16_bf16 v[16:31], v[168:171], v[52:55], v[16:31]
  ds_read_b128 v[48:51], v12 offset:16384
  v_rcp_f32 v77, v77
  v_exp_f32 v78, v78
  v_fma_f32 v79, v79, s53, v15
  v_mfma_f32_32x32x16_bf16 v[16:31], v[172:175], v[56:59], v[16:31]
  ds_read_b128 v[52:55], v13 offset:16384
  v_mul_f32 v37, v37, v77
  v_add_f32 v78, 1.0, v78
  v_mul_f32 v79, v79, v39
  v_mul_f32 v76, v40, v40
  s_waitcnt lgkmcnt(2)
  v_mfma_f32_32x32x16_bf16 v[16:31], v[176:179], v[60:63], v[16:31]
  ds_read_b128 v[56:59], v10 offset:20480
  v_cvt_pk_bf16_f32 v70, v36, v37
  v_rcp_f32 v78, v78
  v_exp_f32 v79, v79
  v_mfma_f32_32x32x16_bf16 v[16:31], v[180:183], v[64:67], v[16:31]
  ds_read_b128 v[60:63], v11 offset:20480
  v_fma_f32 v76, v76, s53, v15
  v_mul_f32 v38, v38, v78
  v_add_f32 v79, 1.0, v79
  v_mul_f32 v76, v76, v40
  v_mul_f32 v77, v41, v41
  s_waitcnt lgkmcnt(2)
  v_mfma_f32_32x32x16_bf16 v[16:31], v[184:187], v[48:51], v[16:31]
  ds_read_b128 v[64:67], v12 offset:20480
  v_rcp_f32 v79, v79
  v_exp_f32 v76, v76
  v_fma_f32 v77, v77, s53, v15
  v_mfma_f32_32x32x16_bf16 v[16:31], v[188:191], v[52:55], v[16:31]
  ds_read_b128 v[48:51], v13 offset:20480
  v_mul_f32 v39, v39, v79
  v_add_f32 v76, 1.0, v76
  v_mul_f32 v77, v77, v41
  v_mul_f32 v78, v42, v42
  s_waitcnt lgkmcnt(2)
  v_mfma_f32_32x32x16_bf16 v[16:31], v[192:195], v[56:59], v[16:31]
  ds_read_b128 v[52:55], v10 offset:24576
  s_mov_b64 exec, s[48:49]
  buffer_load_dword v9, v7, s[4:7], 0 offen sc1
  s_mov_b64 exec, -1
  v_cvt_pk_bf16_f32 v71, v38, v39
  v_rcp_f32 v76, v76
  v_exp_f32 v77, v77
  v_mfma_f32_32x32x16_bf16 v[16:31], v[196:199], v[60:63], v[16:31]
  ds_read_b128 v[56:59], v11 offset:24576
  v_fma_f32 v78, v78, s53, v15
  v_mul_f32 v40, v40, v76
  v_add_f32 v77, 1.0, v77
  v_mul_f32 v78, v78, v42
  v_mul_f32 v79, v43, v43
  s_waitcnt lgkmcnt(2)
  v_mfma_f32_32x32x16_bf16 v[16:31], v[200:203], v[64:67], v[16:31]
  ds_read_b128 v[60:63], v12 offset:24576
  v_rcp_f32 v77, v77
  v_exp_f32 v78, v78
  v_fma_f32 v79, v79, s53, v15
  v_mfma_f32_32x32x16_bf16 v[16:31], v[204:207], v[48:51], v[16:31]
  ds_read_b128 v[64:67], v13 offset:24576
  v_mul_f32 v41, v41, v77
  v_add_f32 v78, 1.0, v78
  v_mul_f32 v79, v79, v43
  v_mul_f32 v76, v44, v44
  s_waitcnt lgkmcnt(2)
  v_mfma_f32_32x32x16_bf16 v[16:31], v[208:211], v[52:55], v[16:31]
  ds_read_b128 v[48:51], v10 offset:28672
  v_cvt_pk_bf16_f32 v72, v40, v41
  v_rcp_f32 v78, v78
  v_exp_f32 v79, v79
  v_mfma_f32_32x32x16_bf16 v[16:31], v[212:215], v[56:59], v[16:31]
  ds_read_b128 v[52:55], v11 offset:28672
  v_fma_f32 v76, v76, s53, v15
  v_mul_f32 v42, v42, v78
  v_add_f32 v79, 1.0, v79
  v_mul_f32 v76, v76, v44
  v_mul_f32 v77, v45, v45
  s_waitcnt lgkmcnt(2)
  v_mfma_f32_32x32x16_bf16 v[16:31], v[216:219], v[60:63], v[16:31]
  ds_read_b128 v[56:59], v12 offset:28672
  v_rcp_f32 v79, v79
  v_exp_f32 v76, v76
  v_fma_f32 v77, v77, s53, v15
  v_mfma_f32_32x32x16_bf16 v[16:31], v[220:223], v[64:67], v[16:31]
  ds_read_b128 v[60:63], v13 offset:28672
  v_mul_f32 v43, v43, v79
  v_add_f32 v76, 1.0, v76
  v_mul_f32 v77, v77, v45
  v_mul_f32 v78, v46, v46
  s_waitcnt lgkmcnt(2)
  v_mfma_f32_32x32x16_bf16 v[16:31], v[224:227], v[48:51], v[16:31]
  ds_read_b128 v[64:67], v10 offset:32768
  v_cvt_pk_bf16_f32 v73, v42, v43
  v_rcp_f32 v76, v76
  v_exp_f32 v77, v77
  v_mfma_f32_32x32x16_bf16 v[16:31], v[228:231], v[52:55], v[16:31]
  ds_read_b128 v[48:51], v11 offset:32768
  v_fma_f32 v78, v78, s53, v15
  v_mul_f32 v44, v44, v76
  v_add_f32 v77, 1.0, v77
  v_mul_f32 v78, v78, v46
  v_mul_f32 v79, v47, v47
  s_waitcnt lgkmcnt(2)
  v_mfma_f32_32x32x16_bf16 v[16:31], v[232:235], v[56:59], v[16:31]
  ds_read_b128 v[52:55], v12 offset:32768
  v_rcp_f32 v77, v77
  v_exp_f32 v78, v78
  v_fma_f32 v79, v79, s53, v15
  v_mfma_f32_32x32x16_bf16 v[16:31], v[236:239], v[60:63], v[16:31]
  ds_read_b128 v[56:59], v13 offset:32768
  v_mul_f32 v45, v45, v77
  v_add_f32 v78, 1.0, v78
  v_mul_f32 v79, v79, v47
  v_cvt_pk_bf16_f32 v74, v44, v45
  s_waitcnt lgkmcnt(2)
  v_mfma_f32_32x32x16_bf16 v[16:31], v[240:243], v[64:67], v[16:31]
  v_rcp_f32 v78, v78
  v_exp_f32 v79, v79
  v_mul_f32 v46, v46, v78
  v_mfma_f32_32x32x16_bf16 v[16:31], v[244:247], v[48:51], v[16:31]
  v_add_f32 v79, 1.0, v79
  v_rcp_f32 v79, v79
  s_nop 0
  v_mul_f32 v47, v47, v79
  v_cvt_pk_bf16_f32 v75, v46, v47
  s_waitcnt lgkmcnt(0)
  v_mfma_f32_32x32x16_bf16 v[16:31], v[248:251], v[52:55], v[16:31]
  s_add_u32 s38, s37, 2048
  buffer_store_dwordx4 v[68:71], v1, s[4:7], s38 offen sc1
  v_mfma_f32_32x32x16_bf16 v[16:31], v[252:255], v[56:59], v[16:31]
  buffer_store_dwordx4 v[72:75], v1, s[4:7], s38 offen offset:1024 sc1
  s_nop 10
  v_pk_mul_f32 v[48:49], v[16:17], v[16:17]
  v_pk_mul_f32 v[50:51], v[18:19], v[18:19]
  v_pk_mul_f32 v[52:53], v[20:21], v[20:21]
  v_pk_mul_f32 v[54:55], v[22:23], v[22:23]
  v_pk_fma_f32 v[48:49], v[48:49], s[54:55], v[14:15] op_sel:[0,0,1] op_sel_hi:[1,1,1]
  v_pk_fma_f32 v[50:51], v[50:51], s[54:55], v[14:15] op_sel:[0,0,1] op_sel_hi:[1,1,1]
  v_pk_fma_f32 v[52:53], v[52:53], s[54:55], v[14:15] op_sel:[0,0,1] op_sel_hi:[1,1,1]
  v_pk_fma_f32 v[54:55], v[54:55], s[54:55], v[14:15] op_sel:[0,0,1] op_sel_hi:[1,1,1]
  v_pk_mul_f32 v[48:49], v[48:49], v[16:17]
  v_pk_mul_f32 v[50:51], v[50:51], v[18:19]
  v_pk_mul_f32 v[52:53], v[52:53], v[20:21]
  v_pk_mul_f32 v[54:55], v[54:55], v[22:23]
  v_exp_f32 v48, v48
  v_exp_f32 v49, v49
  v_exp_f32 v50, v50
  v_exp_f32 v51, v51
  v_exp_f32 v52, v52
  v_exp_f32 v53, v53
  v_exp_f32 v54, v54
  v_exp_f32 v55, v55
  v_pk_add_f32 v[48:49], v[48:49], s[56:57]
  v_pk_add_f32 v[50:51], v[50:51], s[56:57]
  v_pk_add_f32 v[52:53], v[52:53], s[56:57]
  v_pk_add_f32 v[54:55], v[54:55], s[56:57]
  v_rcp_f32 v48, v48
  v_rcp_f32 v49, v49
  v_rcp_f32 v50, v50
  v_rcp_f32 v51, v51
  v_rcp_f32 v52, v52
  v_rcp_f32 v53, v53
  v_rcp_f32 v54, v54
  v_rcp_f32 v55, v55
  v_pk_mul_f32 v[16:17], v[16:17], v[48:49]
  v_pk_mul_f32 v[18:19], v[18:19], v[50:51]
  v_pk_mul_f32 v[20:21], v[20:21], v[52:53]
  v_pk_mul_f32 v[22:23], v[22:23], v[54:55]
  v_cvt_pk_bf16_f32 v68, v16, v17
  v_cvt_pk_bf16_f32 v69, v18, v19
  v_cvt_pk_bf16_f32 v70, v20, v21
  v_cvt_pk_bf16_f32 v71, v22, v23
  s_add_u32 s38, s37, 4096
  buffer_store_dwordx4 v[68:71], v1, s[4:7], s38 offen offset:0 sc1
  v_pk_mul_f32 v[48:49], v[24:25], v[24:25]
  v_pk_mul_f32 v[50:51], v[26:27], v[26:27]
  v_pk_mul_f32 v[52:53], v[28:29], v[28:29]
  v_pk_mul_f32 v[54:55], v[30:31], v[30:31]
  v_pk_fma_f32 v[48:49], v[48:49], s[54:55], v[14:15] op_sel:[0,0,1] op_sel_hi:[1,1,1]
  v_pk_fma_f32 v[50:51], v[50:51], s[54:55], v[14:15] op_sel:[0,0,1] op_sel_hi:[1,1,1]
  v_pk_fma_f32 v[52:53], v[52:53], s[54:55], v[14:15] op_sel:[0,0,1] op_sel_hi:[1,1,1]
  v_pk_fma_f32 v[54:55], v[54:55], s[54:55], v[14:15] op_sel:[0,0,1] op_sel_hi:[1,1,1]
  v_pk_mul_f32 v[48:49], v[48:49], v[24:25]
  v_pk_mul_f32 v[50:51], v[50:51], v[26:27]
  v_pk_mul_f32 v[52:53], v[52:53], v[28:29]
  v_pk_mul_f32 v[54:55], v[54:55], v[30:31]
  v_exp_f32 v48, v48
  v_exp_f32 v49, v49
  v_exp_f32 v50, v50
  v_exp_f32 v51, v51
  v_exp_f32 v52, v52
  v_exp_f32 v53, v53
  v_exp_f32 v54, v54
  v_exp_f32 v55, v55
  v_pk_add_f32 v[48:49], v[48:49], s[56:57]
  v_pk_add_f32 v[50:51], v[50:51], s[56:57]
  v_pk_add_f32 v[52:53], v[52:53], s[56:57]
  v_pk_add_f32 v[54:55], v[54:55], s[56:57]
  v_rcp_f32 v48, v48
  v_rcp_f32 v49, v49
  v_rcp_f32 v50, v50
  v_rcp_f32 v51, v51
  v_rcp_f32 v52, v52
  v_rcp_f32 v53, v53
  v_rcp_f32 v54, v54
  v_rcp_f32 v55, v55
  v_pk_mul_f32 v[24:25], v[24:25], v[48:49]
  v_pk_mul_f32 v[26:27], v[26:27], v[50:51]
  v_pk_mul_f32 v[28:29], v[28:29], v[52:53]
  v_pk_mul_f32 v[30:31], v[30:31], v[54:55]
  v_cvt_pk_bf16_f32 v72, v24, v25
  v_cvt_pk_bf16_f32 v73, v26, v27
  v_cvt_pk_bf16_f32 v74, v28, v29
  v_cvt_pk_bf16_f32 v75, v30, v31
  buffer_store_dwordx4 v[72:75], v1, s[4:7], s38 offen offset:1024 sc1
  v_add_u32 v10, s45, v10
  v_add_u32 v11, s45, v11
  v_add_u32 v12, s45, v12
  v_add_u32 v13, s45, v13
  s_sub_u32 s45, 0, s45
  s_bfe_u32 s35, s32, 0x10006
  s_lshl_b32 s35, s35, 2
  s_add_u32 s47, s46, s35
  s_and_b32 s50, s32, 63
  s_add_u32 s50, s50, 1
  s_waitcnt vmcnt(5)
  s_branch L_ffn1_run
L_ffn1_w84:
  v_mfma_f32_32x32x16_bf16 v[16:31], v[160:163], v[64:67], v[16:31]
  ds_read_b128 v[60:63], v10 offset:16384
  s_add_u32 m0, s34, 0
  s_add_u32 s35, s33, 0
  buffer_load_dwordx4 v2, s[4:7], s35 offen sc1 lds
  v_cvt_pk_bf16_f32 v69, v34, v35
  v_rcp_f32 v76, v76
  v_exp_f32 v77, v77
  v_mfma_f32_32x32x16_bf16 v[16:31], v[164:167], v[48:51], v[16:31]
  ds_read_b128 v[64:67], v11 offset:16384
  v_fma_f32 v78, v78, s53, v15
  v_mul_f32 v36, v36, v76
  v_add_f32 v77, 1.0, v77
  v_mul_f32 v78, v78, v38
  v_mul_f32 v79, v39, v39
  s_waitcnt lgkmcnt(2)
  v_mfma_f32_32x32x16_bf16 v[16:31], v[168:171], v[52:55], v[16:31]
  ds_read_b128 v[48:51], v12 offset:16384
  s_add_u32 m0, s34, 4096
  s_add_u32 s35, s33, 128
  buffer_load_dwordx4 v2, s[4:7], s35 offen sc1 lds
  v_rcp_f32 v77, v77
  v_exp_f32 v78, v78
  v_fma_f32 v79, v79, s53, v15
  v_mfma_f32_32x32x16_bf16 v[16:31], v[172:175], v[56:59], v[16:31]
  ds_read_b128 v[52:55], v13 offset:16384
  v_mul_f32 v37, v37, v77
  v_add_f32 v78, 1.0, v78
  v_mul_f32 v79, v79, v39
  v_mul_f32 v76, v40, v40
  s_waitcnt lgkmcnt(2)
  v_mfma_f32_32x32x16_bf16 v[16:31], v[176:179], v[60:63], v[16:31]
  ds_read_b128 v[56:59], v10 offset:20480
  s_add_u32 m0, s34, 8192
  s_add_u32 s35, s33, 256
  buffer_load_dwordx4 v2, s[4:7], s35 offen sc1 lds
  v_cvt_pk_bf16_f32 v70, v36, v37
  v_rcp_f32 v78, v78
  v_exp_f32 v79, v79
  v_mfma_f32_32x32x16_bf16 v[16:31], v[180:183], v[64:67], v[16:31]
  ds_read_b128 v[60:63], v11 offset:20480
  v_fma_f32 v76, v76, s53, v15
  v_mul_f32 v38, v38, v78
  v_add_f32 v79, 1.0, v79
  v_mul_f32 v76, v76, v40
  v_mul_f32 v77, v41, v41
  s_waitcnt lgkmcnt(2)
  v_mfma_f32_32x32x16_bf16 v[16:31], v[184:187], v[48:51], v[16:31]
  ds_read_b128 v[64:67], v12 offset:20480
  s_add_u32 m0, s34, 12288
  s_add_u32 s35, s33, 384
  buffer_load_dwordx4 v2, s[4:7], s35 offen sc1 lds
  v_rcp_f32 v79, v79
  v_exp_f32 v76, v76
  v_fma_f32 v77, v77, s53, v15
  v_mfma_f32_32x32x16_bf16 v[16:31], v[188:191], v[52:55], v[16:31]
  ds_read_b128 v[48:51], v13 offset:20480
  v_mul_f32 v39, v39, v79
  v_add_f32 v76, 1.0, v76
  v_mul_f32 v77, v77, v41
  v_mul_f32 v78, v42, v42
  s_waitcnt lgkmcnt(2)
  v_mfma_f32_32x32x16_bf16 v[16:31], v[192:195], v[56:59], v[16:31]
  ds_read_b128 v[52:55], v10 offset:24576
  s_add_u32 m0, s34, 16384
  s_add_u32 s35, s33, 512
  buffer_load_dwordx4 v2, s[4:7], s35 offen sc1 lds
  s_mov_b64 exec, s[48:49]
  buffer_load_dword v9, v7, s[4:7], 0 offen sc1
  s_mov_b64 exec, -1
  v_cvt_pk_bf16_f32 v71, v38, v39
  v_rcp_f32 v76, v76
  v_exp_f32 v77, v77
  v_mfma_f32_32x32x16_bf16 v[16:31], v[196:199], v[60:63], v[16:31]
  ds_read_b128 v[56:59], v11 offset:24576
  v_fma_f32 v78, v78, s53, v15
  v_mul_f32 v40, v40, v76
  v_add_f32 v77, 1.0, v77
  v_mul_f32 v78, v78, v42
  v_mul_f32 v79, v43, v43
  s_waitcnt lgkmcnt(2)
  v_mfma_f32_32x32x16_bf16 v[16:31], v[200:203], v[64:67], v[16:31]
  ds_read_b128 v[60:63], v12 offset:24576
  s_add_u32 m0, s34, 20480
  s_add_u32 s35, s33, 640
  buffer_load_dwordx4 v2, s[4:7], s35 offen sc1 lds
  v_rcp_f32 v77, v77
  v_exp_f32 v78, v78
  v_fma_f32 v79, v79, s53, v15
  v_mfma_f32_32x32x16_bf16 v[16:31], v[204:207], v[48:51], v[16:31]
  ds_read_b128 v[64:67], v13 offset:24576
  v_mul_f32 v41, v41, v77
  v_add_f32 v78, 1.0, v78
  v_mul_f32 v79, v79, v43
  v_mul_f32 v76, v44, v44
  s_waitcnt lgkmcnt(2)
  v_mfma_f32_32x32x16_bf16 v[16:31], v[208:211], v[52:55], v[16:31]
  ds_read_b128 v[48:51], v10 offset:28672
  s_add_u32 m0, s34, 24576
  s_add_u32 s35, s33, 768
  buffer_load_dwordx4 v2, s[4:7], s35 offen sc1 lds
  v_cvt_pk_bf16_f32 v72, v40, v41
  v_rcp_f32 v78, v78
  v_exp_f32 v79, v79
  v_mfma_f32_32x32x16_bf16 v[16:31], v[212:215], v[56:59], v[16:31]
  ds_read_b128 v[52:55], v11 offset:28672
  v_fma_f32 v76, v76, s53, v15
  v_mul_f32 v42, v42, v78
  v_add_f32 v79, 1.0, v79
  v_mul_f32 v76, v76, v44
  v_mul_f32 v77, v45, v45
  s_waitcnt lgkmcnt(2)
  v_mfma_f32_32x32x16_bf16 v[16:31], v[216:219], v[60:63], v[16:31]
  ds_read_b128 v[56:59], v12 offset:28672
  s_add_u32 m0, s34, 28672
  s_add_u32 s35, s33, 896
  buffer_load_dwordx4 v2, s[4:7], s35 offen sc1 lds
  v_rcp_f32 v79, v79
  v_exp_f32 v76, v76
  v_fma_f32 v77, v77, s53, v15
  v_mfma_f32_32x32x16_bf16 v[16:31], v[220:223], v[64:67], v[16:31]
  ds_read_b128 v[60:63], v13 offset:28672
  v_mul_f32 v43, v43, v79
  v_add_f32 v76, 1.0, v76
  v_mul_f32 v77, v77, v45
  v_mul_f32 v78, v46, v46
  s_waitcnt lgkmcnt(2)
  v_mfma_f32_32x32x16_bf16 v[16:31], v[224:227], v[48:51], v[16:31]
  ds_read_b128 v[64:67], v10 offset:32768
  s_add_u32 m0, s34, 32768
  s_add_u32 s35, s33, 1024
  buffer_load_dwordx4 v2, s[4:7], s35 offen sc1 lds
  v_cvt_pk_bf16_f32 v73, v42, v43
  v_rcp_f32 v76, v76
  v_exp_f32 v77, v77
  v_mfma_f32_32x32x16_bf16 v[16:31], v[228:231], v[52:55], v[16:31]
  ds_read_b128 v[48:51], v11 offset:32768
  v_fma_f32 v78, v78, s53, v15
  v_mul_f32 v44, v44, v76
  v_add_f32 v77, 1.0, v77
  v_mul_f32 v78, v78, v46
  v_mul_f32 v79, v47, v47
  s_waitcnt lgkmcnt(2)
  v_mfma_f32_32x32x16_bf16 v[16:31], v[232:235], v[56:59], v[16:31]
  ds_read_b128 v[52:55], v12 offset:32768
  v_rcp_f32 v77, v77
  v_exp_f32 v78, v78
  v_fma_f32 v79, v79, s53, v15
  v_mfma_f32_32x32x16_bf16 v[16:31], v[236:239], v[60:63], v[16:31]
  ds_read_b128 v[56:59], v13 offset:32768
  v_mul_f32 v45, v45, v77
  v_add_f32 v78, 1.0, v78
  v_mul_f32 v79, v79, v47
  v_cvt_pk_bf16_f32 v74, v44, v45
  s_waitcnt lgkmcnt(2)
  v_mfma_f32_32x32x16_bf16 v[16:31], v[240:243], v[64:67], v[16:31]
  v_rcp_f32 v78, v78
  v_exp_f32 v79, v79
  v_mul_f32 v46, v46, v78
  v_mfma_f32_32x32x16_bf16 v[16:31], v[244:247], v[48:51], v[16:31]
  v_add_f32 v79, 1.0, v79
  v_rcp_f32 v79, v79
  s_nop 0
  v_mul_f32 v47, v47, v79
  v_cvt_pk_bf16_f32 v75, v46, v47
  s_waitcnt lgkmcnt(0)
  v_mfma_f32_32x32x16_bf16 v[16:31], v[248:251], v[52:55], v[16:31]
  s_add_u32 s38, s37, 2048
  buffer_store_dwordx4 v[68:71], v1, s[4:7], s38 offen sc1
  v_mfma_f32_32x32x16_bf16 v[16:31], v[252:255], v[56:59], v[16:31]
  buffer_store_dwordx4 v[72:75], v1, s[4:7], s38 offen offset:1024 sc1
  s_nop 10
  v_pk_mul_f32 v[48:49], v[16:17], v[16:17]
  v_pk_mul_f32 v[50:51], v[18:19], v[18:19]
  v_pk_mul_f32 v[52:53], v[20:21], v[20:21]
  v_pk_mul_f32 v[54:55], v[22:23], v[22:23]
  v_pk_fma_f32 v[48:49], v[48:49], s[54:55], v[14:15] op_sel:[0,0,1] op_sel_hi:[1,1,1]
  v_pk_fma_f32 v[50:51], v[50:51], s[54:55], v[14:15] op_sel:[0,0,1] op_sel_hi:[1,1,1]
  v_pk_fma_f32 v[52:53], v[52:53], s[54:55], v[14:15] op_sel:[0,0,1] op_sel_hi:[1,1,1]
  v_pk_fma_f32 v[54:55], v[54:55], s[54:55], v[14:15] op_sel:[0,0,1] op_sel_hi:[1,1,1]
  v_pk_mul_f32 v[48:49], v[48:49], v[16:17]
  v_pk_mul_f32 v[50:51], v[50:51], v[18:19]
  v_pk_mul_f32 v[52:53], v[52:53], v[20:21]
  v_pk_mul_f32 v[54:55], v[54:55], v[22:23]
  v_exp_f32 v48, v48
  v_exp_f32 v49, v49
  v_exp_f32 v50, v50
  v_exp_f32 v51, v51
  v_exp_f32 v52, v52
  v_exp_f32 v53, v53
  v_exp_f32 v54, v54
  v_exp_f32 v55, v55
  v_pk_add_f32 v[48:49], v[48:49], s[56:57]
  v_pk_add_f32 v[50:51], v[50:51], s[56:57]
  v_pk_add_f32 v[52:53], v[52:53], s[56:57]
  v_pk_add_f32 v[54:55], v[54:55], s[56:57]
  v_rcp_f32 v48, v48
  v_rcp_f32 v49, v49
  v_rcp_f32 v50, v50
  v_rcp_f32 v51, v51
  v_rcp_f32 v52, v52
  v_rcp_f32 v53, v53
  v_rcp_f32 v54, v54
  v_rcp_f32 v55, v55
  v_pk_mul_f32 v[16:17], v[16:17], v[48:49]
  v_pk_mul_f32 v[18:19], v[18:19], v[50:51]
  v_pk_mul_f32 v[20:21], v[20:21], v[52:53]
  v_pk_mul_f32 v[22:23], v[22:23], v[54:55]
  v_cvt_pk_bf16_f32 v68, v16, v17
  v_cvt_pk_bf16_f32 v69, v18, v19
  v_cvt_pk_bf16_f32 v70, v20, v21
  v_cvt_pk_bf16_f32 v71, v22, v23
  s_add_u32 s38, s37, 4096
  buffer_store_dwordx4 v[68:71], v1, s[4:7], s38 offen offset:0 sc1
  v_pk_mul_f32 v[48:49], v[24:25], v[24:25]
  v_pk_mul_f32 v[50:51], v[26:27], v[26:27]
  v_pk_mul_f32 v[52:53], v[28:29], v[28:29]
  v_pk_mul_f32 v[54:55], v[30:31], v[30:31]
  v_pk_fma_f32 v[48:49], v[48:49], s[54:55], v[14:15] op_sel:[0,0,1] op_sel_hi:[1,1,1]
  v_pk_fma_f32 v[50:51], v[50:51], s[54:55], v[14:15] op_sel:[0,0,1] op_sel_hi:[1,1,1]
  v_pk_fma_f32 v[52:53], v[52:53], s[54:55], v[14:15] op_sel:[0,0,1] op_sel_hi:[1,1,1]
  v_pk_fma_f32 v[54:55], v[54:55], s[54:55], v[14:15] op_sel:[0,0,1] op_sel_hi:[1,1,1]
  v_pk_mul_f32 v[48:49], v[48:49], v[24:25]
  v_pk_mul_f32 v[50:51], v[50:51], v[26:27]
  v_pk_mul_f32 v[52:53], v[52:53], v[28:29]
  v_pk_mul_f32 v[54:55], v[54:55], v[30:31]
  v_exp_f32 v48, v48
  v_exp_f32 v49, v49
  v_exp_f32 v50, v50
  v_exp_f32 v51, v51
  v_exp_f32 v52, v52
  v_exp_f32 v53, v53
  v_exp_f32 v54, v54
  v_exp_f32 v55, v55
  v_pk_add_f32 v[48:49], v[48:49], s[56:57]
  v_pk_add_f32 v[50:51], v[50:51], s[56:57]
  v_pk_add_f32 v[52:53], v[52:53], s[56:57]
  v_pk_add_f32 v[54:55], v[54:55], s[56:57]
  v_rcp_f32 v48, v48
  v_rcp_f32 v49, v49
  v_rcp_f32 v50, v50
  v_rcp_f32 v51, v51
  v_rcp_f32 v52, v52
  v_rcp_f32 v53, v53
  v_rcp_f32 v54, v54
  v_rcp_f32 v55, v55
  v_pk_mul_f32 v[24:25], v[24:25], v[48:49]
  v_pk_mul_f32 v[26:27], v[26:27], v[50:51]
  v_pk_mul_f32 v[28:29], v[28:29], v[52:53]
  v_pk_mul_f32 v[30:31], v[30:31], v[54:55]
  v_cvt_pk_bf16_f32 v72, v24, v25
  v_cvt_pk_bf16_f32 v73, v26, v27
  v_cvt_pk_bf16_f32 v74, v28, v29
  v_cvt_pk_bf16_f32 v75, v30, v31
  buffer_store_dwordx4 v[72:75], v1, s[4:7], s38 offen offset:1024 sc1
  v_add_u32 v10, s45, v10
  v_add_u32 v11, s45, v11
  v_add_u32 v12, s45, v12
  v_add_u32 v13, s45, v13
  s_sub_u32 s45, 0, s45
  s_bfe_u32 s35, s32, 0x10006
  s_lshl_b32 s35, s35, 2
  s_add_u32 s47, s46, s35
  s_and_b32 s50, s32, 63
  s_add_u32 s50, s50, 1
  s_waitcnt vmcnt(4)
  s_branch L_ffn1_run
L_fail_ffn1:
  s_mov_b64 exec, 1
  v_mov_b32 v0, 80
  v_mov_b32 v1, 1
  buffer_atomic_add v1, v0, s[20:23], 0 offen
  s_endpgm
L_ffn2:
  s_waitcnt vmcnt(0)
  s_barrier
  s_cmp_lg_u32 s24, 0
  s_cbranch_scc1 Lsi_21
  s_mov_b64 exec, 1
  v_mov_b32 v1, 128
  v_mov_b32 v2, 1
  buffer_atomic_add v2, v1, s[20:23], 0 offen
  s_mov_b64 exec, -1
Lsi_21:
  s_mul_i32 s30, s28, 12
  s_mul_i32 s31, s29, 3
  s_add_u32 s30, s30, s31
  s_add_u32 s30, s30, s62
  s_add_u32 s30, s30, 36
  s_lshl_b32 s30, s30, 2
  s_add_u32 s30, s30, s24
  s_lshl_b32 s30, s30, 13
  v_lshlrev_b32 v1, 7, v0
  s_mov_b32 s8, s68
  s_and_b32 s9, s69, 0xffff
  s_mov_b32 s10, 0x480000
  s_mov_b32 s11, 0x20000
  s_add_u32 s31, s30, 0
  buffer_load_dword v3, v1, s[8:11], s31 offen
  s_mov_b32 s8, s70
  s_and_b32 s9, s71, 0xffff
  s_mov_b32 s10, 0x480000
  s_mov_b32 s11, 0x20000
  s_add_u32 s31, s30, 0
  buffer_load_dword v3, v1, s[8:11], s31 offen
  s_mov_b32 s8, s72
  s_and_b32 s9, s73, 0xffff
  s_mov_b32 s10, 0x480000
  s_mov_b32 s11, 0x20000
  s_add_u32 s31, s30, 0
  buffer_load_dword v3, v1, s[8:11], s31 offen
  s_mov_b32 s8, s74
  s_and_b32 s9, s75, 0xffff
  s_mov_b32 s10, 0x480000
  s_mov_b32 s11, 0x20000
  s_add_u32 s31, s30, 0
  buffer_load_dword v3, v1, s[8:11], s31 offen
  s_mov_b32 s8, s68
  s_and_b32 s9, s69, 0xffff
  s_mov_b32 s10, 0x480000
  s_mov_b32 s11, 0x20000
  s_add_u32 s31, s30, 2359296
  buffer_load_dword v3, v1, s[8:11], s31 offen
  s_mov_b32 s8, s70
  s_and_b32 s9, s71, 0xffff
  s_mov_b32 s10, 0x480000
  s_mov_b32 s11, 0x20000
  s_add_u32 s31, s30, 2359296
  buffer_load_dword v3, v1, s[8:11], s31 offen
  s_mov_b32 s8, s72
  s_and_b32 s9, s73, 0xffff
  s_mov_b32 s10, 0x480000
  s_mov_b32 s11, 0x20000
  s_add_u32 s31, s30, 2359296
  buffer_load_dword v3, v1, s[8:11], s31 offen
  s_mov_b32 s8, s74
  s_and_b32 s9, s75, 0xffff
  s_mov_b32 s10, 0x480000
  s_mov_b32 s11, 0x20000
  s_add_u32 s31, s30, 2359296
  buffer_load_dword v3, v1, s[8:11], s31 offen
  s_waitcnt vmcnt(0)
  s_mov_b32 s8, s84
  s_and_b32 s9, s85, 0xffff
  s_mov_b32 s10, 0x510000
  s_mov_b32 s11, 0x20000
  s_mul_i32 s33, s29, 1327104
  s_mul_i32 s34, s62, 384
  s_add_u32 s33, s33, s34
  s_mul_i32 s34, s24, 96
  s_add_u32 s33, s33, s34
  v_add_u32 v8, 0, v0
  v_mul_u32_u24 v9, 43691, v8
  v_lshrrev_b32 v9, 18, v9
  v_mul_u32_u24 v14, 6, v9
  v_sub_u32 v14, v8, v14
  v_mul_u32_u24 v10, 1152, v9
  v_lshl_add_u32 v10, v14, 4, v10
  v_add_u32 v10, s33, v10
  v_add_u32 v8, 64, v0
  v_mul_u32_u24 v9, 43691, v8
  v_lshrrev_b32 v9, 18, v9
  v_mul_u32_u24 v14, 6, v9
  v_sub_u32 v14, v8, v14
  v_mul_u32_u24 v12, 1152, v9
  v_lshl_add_u32 v12, v14, 4, v12
  v_add_u32 v12, s33, v12
  v_add_u32 v8, 128, v0
  v_mul_u32_u24 v9, 43691, v8
  v_lshrrev_b32 v9, 18, v9
  v_mul_u32_u24 v14, 6, v9
  v_sub_u32 v14, v8, v14
  v_mul_u32_u24 v13, 1152, v9
  v_lshl_add_u32 v13, v14, 4, v13
  v_add_u32 v13, s33, v13
  s_mul_i32 s35, s24, 39936
  v_lshrrev_b32 v8, 5, v0
  v_lshlrev_b32 v8, 4, v8
  v_bfe_u32 v9, v0, 2, 3
  v_add_u32 v8, v8, v9
  v_mul_u32_u24 v11, 96, v8
  v_and_b32 v9, 3, v0
  v_lshl_add_u32 v11, v9, 3, v11
  v_add_u32 v11, s35, v11
  s_mov_b32 s36, 0
  s_add_u32 m0, s35, 0
  s_nop 0
  buffer_load_dwordx4 v10, s[8:11], s36 offen lds
  s_add_u32 m0, s35, 1024
  s_nop 0
  buffer_load_dwordx4 v12, s[8:11], s36 offen lds
  s_add_u32 m0, s35, 2048
  s_nop 0
  buffer_load_dwordx4 v13, s[8:11], s36 offen lds
  s_mov_b32 s36, 36864
  s_add_u32 m0, s35, 3072
  s_nop 0
  buffer_load_dwordx4 v10, s[8:11], s36 offen lds
  s_add_u32 m0, s35, 4096
  s_nop 0
  buffer_load_dwordx4 v12, s[8:11], s36 offen lds
  s_add_u32 m0, s35, 5120
  s_nop 0
  buffer_load_dwordx4 v13, s[8:11], s36 offen lds
  s_mov_b32 s36, 73728
  s_add_u32 m0, s35, 6144
  s_nop 0
  buffer_load_dwordx4 v10, s[8:11], s36 offen lds
  s_add_u32 m0, s35, 7168
  s_nop 0
  buffer_load_dwordx4 v12, s[8:11], s36 offen lds
  s_add_u32 m0, s35, 8192
  s_nop 0
  buffer_load_dwordx4 v13, s[8:11], s36 offen lds
  s_mov_b32 s36, 110592
  s_add_u32 m0, s35, 9216
  s_nop 0
  buffer_load_dwordx4 v10, s[8:11], s36 offen lds
  s_add_u32 m0, s35, 10240
  s_nop 0
  buffer_load_dwordx4 v12, s[8:11], s36 offen lds
  s_add_u32 m0, s35, 11264
  s_nop 0
  buffer_load_dwordx4 v13, s[8:11], s36 offen lds
  s_mov_b32 s36, 147456
  s_add_u32 m0, s35, 12288
  s_nop 0
  buffer_load_dwordx4 v10, s[8:11], s36 offen lds
  s_add_u32 m0, s35, 13312
  s_nop 0
  buffer_load_dwordx4 v12, s[8:11], s36 offen lds
  s_add_u32 m0, s35, 14336
  s_nop 0
  buffer_load_dwordx4 v13, s[8:11], s36 offen lds
  s_mov_b32 s36, 184320
  s_add_u32 m0, s35, 15360
  s_nop 0
  buffer_load_dwordx4 v10, s[8:11], s36 offen lds
  s_add_u32 m0, s35, 16384
  s_nop 0
  buffer_load_dwordx4 v12, s[8:11], s36 offen lds
  s_add_u32 m0, s35, 17408
  s_nop 0
  buffer_load_dwordx4 v13, s[8:11], s36 offen lds
  s_mov_b32 s36, 221184
  s_add_u32 m0, s35, 18432
  s_nop 0
  buffer_load_dwordx4 v10, s[8:11], s36 offen lds
  s_add_u32 m0, s35, 19456
  s_nop 0
  buffer_load_dwordx4 v12, s[8:11], s36 offen lds
  s_add_u32 m0, s35, 20480
  s_nop 0
  buffer_load_dwordx4 v13, s[8:11], s36 offen lds
  s_mov_b32 s36, 258048
  s_add_u32 m0, s35, 21504
  s_nop 0
  buffer_load_dwordx4 v10, s[8:11], s36 offen lds
  s_add_u32 m0, s35, 22528
  s_nop 0
  buffer_load_dwordx4 v12, s[8:11], s36 offen lds
  s_add_u32 m0, s35, 23552
  s_nop 0
  buffer_load_dwordx4 v13, s[8:11], s36 offen lds
  s_mov_b32 s36, 294912
  s_add_u32 m0, s35, 24576
  s_nop 0
  buffer_load_dwordx4 v10, s[8:11], s36 offen lds
  s_add_u32 m0, s35, 25600
  s_nop 0
  buffer_load_dwordx4 v12, s[8:11], s36 offen lds
  s_add_u32 m0, s35, 26624
  s_nop 0
  buffer_load_dwordx4 v13, s[8:11], s36 offen lds
  s_mov_b32 s36, 331776
  s_add_u32 m0, s35, 27648
  s_nop 0
  buffer_load_dwordx4 v10, s[8:11], s36 offen lds
  s_add_u32 m0, s35, 28672
  s_nop 0
  buffer_load_dwordx4 v12, s[8:11], s36 offen lds
  s_add_u32 m0, s35, 29696
  s_nop 0
  buffer_load_dwordx4 v13, s[8:11], s36 offen lds
  s_mov_b32 s36, 368640
  s_add_u32 m0, s35, 30720
  s_nop 0
  buffer_load_dwordx4 v10, s[8:11], s36 offen lds
  s_add_u32 m0, s35, 31744
  s_nop 0
  buffer_load_dwordx4 v12, s[8:11], s36 offen lds
  s_add_u32 m0, s35, 32768
  s_nop 0
  buffer_load_dwordx4 v13, s[8:11], s36 offen lds
  s_waitcnt vmcnt(30)
  ds_read_b64_tr_b16 a[0:1], v11 offset:0
  ds_read_b64_tr_b16 a[2:3], v11 offset:768
  ds_read_b64_tr_b16 a[4:5], v11 offset:32
  ds_read_b64_tr_b16 a[6:7], v11 offset:800
  ds_read_b64_tr_b16 a[8:9], v11 offset:64
  ds_read_b64_tr_b16 a[10:11], v11 offset:832
  s_waitcnt lgkmcnt(6)
  s_mov_b32 s36, 405504
  s_add_u32 m0, s35, 33792
  s_nop 0
  buffer_load_dwordx4 v10, s[8:11], s36 offen lds
  s_add_u32 m0, s35, 34816
  s_nop 0
  buffer_load_dwordx4 v12, s[8:11], s36 offen lds
  s_add_u32 m0, s35, 35840
  s_nop 0
  buffer_load_dwordx4 v13, s[8:11], s36 offen lds
  s_waitcnt vmcnt(30)
  ds_read_b64_tr_b16 a[12:13], v11 offset:3072
  ds_read_b64_tr_b16 a[14:15], v11 offset:3840
  ds_read_b64_tr_b16 a[16:17], v11 offset:3104
  ds_read_b64_tr_b16 a[18:19], v11 offset:3872
  ds_read_b64_tr_b16 a[20:21], v11 offset:3136
  ds_read_b64_tr_b16 a[22:23], v11 offset:3904
  s_waitcnt lgkmcnt(6)
  s_mov_b32 s36, 442368
  s_add_u32 m0, s35, 36864
  s_nop 0
  buffer_load_dwordx4 v10, s[8:11], s36 offen lds
  s_add_u32 m0, s35, 37888
  s_nop 0
  buffer_load_dwordx4 v12, s[8:11], s36 offen lds
  s_add_u32 m0, s35, 38912
  s_nop 0
  buffer_load_dwordx4 v13, s[8:11], s36 offen lds
  s_waitcnt vmcnt(30)
  ds_read_b64_tr_b16 a[24:25], v11 offset:6144
  ds_read_b64_tr_b16 a[26:27], v11 offset:6912
  ds_read_b64_tr_b16 a[28:29], v11 offset:6176
  ds_read_b64_tr_b16 a[30:31], v11 offset:6944
  ds_read_b64_tr_b16 a[32:33], v11 offset:6208
  ds_read_b64_tr_b16 a[34:35], v11 offset:6976
  s_waitcnt lgkmcnt(6)
  s_mov_b32 s36, 479232
  s_add_u32 m0, s35, 0
  s_nop 0
  buffer_load_dwordx4 v10, s[8:11], s36 offen lds
  s_add_u32 m0, s35, 1024
  s_nop 0
  buffer_load_dwordx4 v12, s[8:11], s36 offen lds
  s_add_u32 m0, s35, 2048
  s_nop 0
  buffer_load_dwordx4 v13, s[8:11], s36 offen lds
  s_waitcnt vmcnt(30)
  ds_read_b64_tr_b16 a[36:37], v11 offset:9216
  ds_read_b64_tr_b16 a[38:39], v11 offset:9984
  ds_read_b64_tr_b16 a[40:41], v11 offset:9248
  ds_read_b64_tr_b16 a[42:43], v11 offset:10016
  ds_read_b64_tr_b16 a[44:45], v11 offset:9280
  ds_read_b64_tr_b16 a[46:47], v11 offset:10048
  s_waitcnt lgkmcnt(6)
  s_mov_b32 s36, 516096
  s_add_u32 m0, s35, 3072
  s_nop 0
  buffer_load_dwordx4 v10, s[8:11], s36 offen lds
  s_add_u32 m0, s35, 4096
  s_nop 0
  buffer_load_dwordx4 v12, s[8:11], s36 offen lds
  s_add_u32 m0, s35, 5120
  s_nop 0
  buffer_load_dwordx4 v13, s[8:11], s36 offen lds
  s_waitcnt vmcnt(30)
  ds_read_b64_tr_b16 a[48:49], v11 offset:12288
  ds_read_b64_tr_b16 a[50:51], v11 offset:13056
  ds_read_b64_tr_b16 a[52:53], v11 offset:12320
  ds_read_b64_tr_b16 a[54:55], v11 offset:13088
  ds_read_b64_tr_b16 a[56:57], v11 offset:12352
  ds_read_b64_tr_b16 a[58:59], v11 offset:13120
  s_waitcnt lgkmcnt(6)
  s_mov_b32 s36, 552960
  s_add_u32 m0, s35, 6144
  s_nop 0
  buffer_load_dwordx4 v10, s[8:11], s36 offen lds
  s_add_u32 m0, s35, 7168
  s_nop 0
  buffer_load_dwordx4 v12, s[8:11], s36 offen lds
  s_add_u32 m0, s35, 8192
  s_nop 0
  buffer_load_dwordx4 v13, s[8:11], s36 offen lds
  s_waitcnt vmcnt(30)
  ds_read_b64_tr_b16 a[60:61], v11 offset:15360
  ds_read_b64_tr_b16 a[62:63], v11 offset:16128
  ds_read_b64_tr_b16 a[64:65], v11 offset:15392
  ds_read_b64_tr_b16 a[66:67], v11 offset:16160
  ds_read_b64_tr_b16 a[68:69], v11 offset:15424
  ds_read_b64_tr_b16 a[70:71], v11 offset:16192
  s_waitcnt lgkmcnt(6)
  s_mov_b32 s36, 589824
  s_add_u32 m0, s35, 9216
  s_nop 0
  buffer_load_dwordx4 v10, s[8:11], s36 offen lds
  s_add_u32 m0, s35, 10240
  s_nop 0
  buffer_load_dwordx4 v12, s[8:11], s36 offen lds
  s_add_u32 m0, s35, 11264
  s_nop 0
  buffer_load_dwordx4 v13, s[8:11], s36 offen lds
  s_waitcnt vmcnt(30)
  ds_read_b64_tr_b16 a[72:73], v11 offset:18432
  ds_read_b64_tr_b16 a[74:75], v11 offset:19200
  ds_read_b64_tr_b16 a[76:77], v11 offset:18464
  ds_read_b64_tr_b16 a[78:79], v11 offset:19232
  ds_read_b64_tr_b16 a[80:81], v11 offset:18496
  ds_read_b64_tr_b16 a[82:83], v11 offset:19264
  s_waitcnt lgkmcnt(6)
  s_mov_b32 s36, 626688
  s_add_u32 m0, s35, 12288
  s_nop 0
  buffer_load_dwordx4 v10, s[8:11], s36 offen lds
  s_add_u32 m0, s35, 13312
  s_nop 0
  buffer_load_dwordx4 v12, s[8:11], s36 offen lds
  s_add_u32 m0, s35, 14336
  s_nop 0
  buffer_load_dwordx4 v13, s[8:11], s36 offen lds
  s_waitcnt vmcnt(30)
  ds_read_b64_tr_b16 a[84:85], v11 offset:21504
  ds_read_b64_tr_b16 a[86:87], v11 offset:22272
  ds_read_b64_tr_b16 a[88:89], v11 offset:21536
  ds_read_b64_tr_b16 a[90:91], v11 offset:22304
  ds_read_b64_tr_b16 a[92:93], v11 offset:21568
  ds_read_b64_tr_b16 a[94:95], v11 offset:22336
  s_waitcnt lgkmcnt(6)
  s_mov_b32 s36, 663552
  s_add_u32 m0, s35, 15360
  s_nop 0
  buffer_load_dwordx4 v10, s[8:11], s36 offen lds
  s_add_u32 m0, s35, 16384
  s_nop 0
  buffer_load_dwordx4 v12, s[8:11], s36 offen lds
  s_add_u32 m0, s35, 17408
  s_nop 0
  buffer_load_dwordx4 v13, s[8:11], s36 offen lds
  s_waitcnt vmcnt(30)
  ds_read_b64_tr_b16 a[96:97], v11 offset:24576
  ds_read_b64_tr_b16 a[98:99], v11 offset:25344
  ds_read_b64_tr_b16 a[100:101], v11 offset:24608
  ds_read_b64_tr_b16 a[102:103], v11 offset:25376
  ds_read_b64_tr_b16 a[104:105], v11 offset:24640
  ds_read_b64_tr_b16 a[106:107], v11 offset:25408
  s_waitcnt lgkmcnt(6)
  s_mov_b32 s36, 700416
  s_add_u32 m0, s35, 18432
  s_nop 0
  buffer_load_dwordx4 v10, s[8:11], s36 offen lds
  s_add_u32 m0, s35, 19456
  s_nop 0
  buffer_load_dwordx4 v12, s[8:11], s36 offen lds
  s_add_u32 m0, s35, 20480
  s_nop 0
  buffer_load_dwordx4 v13, s[8:11], s36 offen lds
  s_waitcnt vmcnt(30)
  ds_read_b64_tr_b16 a[108:109], v11 offset:27648
  ds_read_b64_tr_b16 a[110:111], v11 offset:28416
  ds_read_b64_tr_b16 a[112:113], v11 offset:27680
  ds_read_b64_tr_b16 a[114:115], v11 offset:28448
  ds_read_b64_tr_b16 a[116:117], v11 offset:27712
  ds_read_b64_tr_b16 a[118:119], v11 offset:28480
  s_waitcnt lgkmcnt(6)
  s_mov_b32 s36, 737280
  s_add_u32 m0, s35, 21504
  s_nop 0
  buffer_load_dwordx4 v10, s[8:11], s36 offen lds
  s_add_u32 m0, s35, 22528
  s_nop 0
  buffer_load_dwordx4 v12, s[8:11], s36 offen lds
  s_add_u32 m0, s35, 23552
  s_nop 0
  buffer_load_dwordx4 v13, s[8:11], s36 offen lds
  s_waitcnt vmcnt(30)
  ds_read_b64_tr_b16 a[120:121], v11 offset:30720
  ds_read_b64_tr_b16 a[122:123], v11 offset:31488
  ds_read_b64_tr_b16 a[124:125], v11 offset:30752
  ds_read_b64_tr_b16 a[126:127], v11 offset:31520
  ds_read_b64_tr_b16 a[128:129], v11 offset:30784
  ds_read_b64_tr_b16 a[130:131], v11 offset:31552
  s_waitcnt lgkmcnt(6)
  s_mov_b32 s36, 774144
  s_add_u32 m0, s35, 24576
  s_nop 0
  buffer_load_dwordx4 v10, s[8:11], s36 offen lds
  s_add_u32 m0, s35, 25600
  s_nop 0
  buffer_load_dwordx4 v12, s[8:11], s36 offen lds
  s_add_u32 m0, s35, 26624
  s_nop 0
  buffer_load_dwordx4 v13, s[8:11], s36 offen lds
  s_waitcnt vmcnt(30)
  ds_read_b64_tr_b16 a[132:133], v11 offset:33792
  ds_read_b64_tr_b16 a[134:135], v11 offset:34560
  ds_read_b64_tr_b16 a[136:137], v11 offset:33824
  ds_read_b64_tr_b16 a[138:139], v11 offset:34592
  ds_read_b64_tr_b16 a[140:141], v11 offset:33856
  ds_read_b64_tr_b16 a[142:143], v11 offset:34624
  s_waitcnt lgkmcnt(6)
  s_mov_b32 s36, 811008
  s_add_u32 m0, s35, 27648
  s_nop 0
  buffer_load_dwordx4 v10, s[8:11], s36 offen lds
  s_add_u32 m0, s35, 28672
  s_nop 0
  buffer_load_dwordx4 v12, s[8:11], s36 offen lds
  s_add_u32 m0, s35, 29696
  s_nop 0
  buffer_load_dwordx4 v13, s[8:11], s36 offen lds
  s_waitcnt vmcnt(30)
  ds_read_b64_tr_b16 a[144:145], v11 offset:36864
  ds_read_b64_tr_b16 a[146:147], v11 offset:37632
  ds_read_b64_tr_b16 a[148:149], v11 offset:36896
  ds_read_b64_tr_b16 a[150:151], v11 offset:37664
  ds_read_b64_tr_b16 a[152:153], v11 offset:36928
  ds_read_b64_tr_b16 a[154:155], v11 offset:37696
  s_waitcnt lgkmcnt(6)
  s_mov_b32 s36, 847872
  s_add_u32 m0, s35, 30720
  s_nop 0
  buffer_load_dwordx4 v10, s[8:11], s36 offen lds
  s_add_u32 m0, s35, 31744
  s_nop 0
  buffer_load_dwordx4 v12, s[8:11], s36 offen lds
  s_add_u32 m0, s35, 32768
  s_nop 0
  buffer_load_dwordx4 v13, s[8:11], s36 offen lds
  s_waitcnt vmcnt(30)
  ds_read_b64_tr_b16 a[156:157], v11 offset:0
  ds_read_b64_tr_b16 a[158:159], v11 offset:768
  ds_read_b64_tr_b16 a[160:161], v11 offset:32
  ds_read_b64_tr_b16 a[162:163], v11 offset:800
  ds_read_b64_tr_b16 a[164:165], v11 offset:64
  ds_read_b64_tr_b16 a[166:167], v11 offset:832
  s_waitcnt lgkmcnt(6)
  s_mov_b32 s36, 884736
  s_add_u32 m0, s35, 33792
  s_nop 0
  buffer_load_dwordx4 v10, s[8:11], s36 offen lds
  s_add_u32 m0, s35, 34816
  s_nop 0
  buffer_load_dwordx4 v12, s[8:11], s36 offen lds
  s_add_u32 m0, s35, 35840
  s_nop 0
  buffer_load_dwordx4 v13, s[8:11], s36 offen lds
  s_waitcnt vmcnt(30)
  ds_read_b64_tr_b16 a[168:169], v11 offset:3072
  ds_read_b64_tr_b16 a[170:171], v11 offset:3840
  ds_read_b64_tr_b16 a[172:173], v11 offset:3104
  ds_read_b64_tr_b16 a[174:175], v11 offset:3872
  ds_read_b64_tr_b16 a[176:177], v11 offset:3136
  ds_read_b64_tr_b16 a[178:179], v11 offset:3904
  s_waitcnt lgkmcnt(6)
  s_mov_b32 s36, 921600
  s_add_u32 m0, s35, 36864
  s_nop 0
  buffer_load_dwordx4 v10, s[8:11], s36 offen lds
  s_add_u32 m0, s35, 37888
  s_nop 0
  buffer_load_dwordx4 v12, s[8:11], s36 offen lds
  s_add_u32 m0, s35, 38912
  s_nop 0
  buffer_load_dwordx4 v13, s[8:11], s36 offen lds
  s_waitcnt vmcnt(30)
  ds_read_b64_tr_b16 a[180:181], v11 offset:6144
  ds_read_b64_tr_b16 a[182:183], v11 offset:6912
  ds_read_b64_tr_b16 a[184:185], v11 offset:6176
  ds_read_b64_tr_b16 a[186:187], v11 offset:6944
  ds_read_b64_tr_b16 a[188:189], v11 offset:6208
  ds_read_b64_tr_b16 a[190:191], v11 offset:6976
  s_waitcnt lgkmcnt(6)
  s_mov_b32 s36, 958464
  s_add_u32 m0, s35, 0
  s_nop 0
  buffer_load_dwordx4 v10, s[8:11], s36 offen lds
  s_add_u32 m0, s35, 1024
  s_nop 0
  buffer_load_dwordx4 v12, s[8:11], s36 offen lds
  s_add_u32 m0, s35, 2048
  s_nop 0
  buffer_load_dwordx4 v13, s[8:11], s36 offen lds
  s_waitcnt vmcnt(30)
  ds_read_b64_tr_b16 a[192:193], v11 offset:9216
  ds_read_b64_tr_b16 a[194:195], v11 offset:9984
  ds_read_b64_tr_b16 a[196:197], v11 offset:9248
  ds_read_b64_tr_b16 a[198:199], v11 offset:10016
  ds_read_b64_tr_b16 a[200:201], v11 offset:9280
  ds_read_b64_tr_b16 a[202:203], v11 offset:10048
  s_waitcnt lgkmcnt(6)
  s_mov_b32 s36, 995328
  s_add_u32 m0, s35, 3072
  s_nop 0
  buffer_load_dwordx4 v10, s[8:11], s36 offen lds
  s_add_u32 m0, s35, 4096
  s_nop 0
  buffer_load_dwordx4 v12, s[8:11], s36 offen lds
  s_add_u32 m0, s35, 5120
  s_nop 0
  buffer_load_dwordx4 v13, s[8:11], s36 offen lds
  s_waitcnt vmcnt(30)
  ds_read_b64_tr_b16 a[204:205], v11 offset:12288
  ds_read_b64_tr_b16 a[206:207], v11 offset:13056
  ds_read_b64_tr_b16 a[208:209], v11 offset:12320
  ds_read_b64_tr_b16 a[210:211], v11 offset:13088
  ds_read_b64_tr_b16 a[212:213], v11 offset:12352
  ds_read_b64_tr_b16 a[214:215], v11 offset:13120
  s_waitcnt lgkmcnt(6)
  s_mov_b32 s36, 1032192
  s_add_u32 m0, s35, 6144
  s_nop 0
  buffer_load_dwordx4 v10, s[8:11], s36 offen lds
  s_add_u32 m0, s35, 7168
  s_nop 0
  buffer_load_dwordx4 v12, s[8:11], s36 offen lds
  s_add_u32 m0, s35, 8192
  s_nop 0
  buffer_load_dwordx4 v13, s[8:11], s36 offen lds
  s_waitcnt vmcnt(30)
  ds_read_b64_tr_b16 a[216:217], v11 offset:15360
  ds_read_b64_tr_b16 a[218:219], v11 offset:16128
  ds_read_b64_tr_b16 a[220:221], v11 offset:15392
  ds_read_b64_tr_b16 a[222:223], v11 offset:16160
  ds_read_b64_tr_b16 a[224:225], v11 offset:15424
  ds_read_b64_tr_b16 a[226:227], v11 offset:16192
  s_waitcnt lgkmcnt(6)
  s_mov_b32 s36, 1069056
  s_add_u32 m0, s35, 9216
  s_nop 0
  buffer_load_dwordx4 v10, s[8:11], s36 offen lds
  s_add_u32 m0, s35, 10240
  s_nop 0
  buffer_load_dwordx4 v12, s[8:11], s36 offen lds
  s_add_u32 m0, s35, 11264
  s_nop 0
  buffer_load_dwordx4 v13, s[8:11], s36 offen lds
  s_waitcnt vmcnt(30)
  ds_read_b64_tr_b16 a[228:229], v11 offset:18432
  ds_read_b64_tr_b16 a[230:231], v11 offset:19200
  ds_read_b64_tr_b16 a[232:233], v11 offset:18464
  ds_read_b64_tr_b16 a[234:235], v11 offset:19232
  ds_read_b64_tr_b16 a[236:237], v11 offset:18496
  ds_read_b64_tr_b16 a[238:239], v11 offset:19264
  s_waitcnt lgkmcnt(6)
  s_mov_b32 s36, 1105920
  s_add_u32 m0, s35, 12288
  s_nop 0
  buffer_load_dwordx4 v10, s[8:11], s36 offen lds
  s_add_u32 m0, s35, 13312
  s_nop 0
  buffer_load_dwordx4 v12, s[8:11], s36 offen lds
  s_add_u32 m0, s35, 14336
  s_nop 0
  buffer_load_dwordx4 v13, s[8:11], s36 offen lds
  s_waitcnt vmcnt(30)
  ds_read_b64_tr_b16 a[240:241], v11 offset:21504
  ds_read_b64_tr_b16 a[242:243], v11 offset:22272
  ds_read_b64_tr_b16 a[244:245], v11 offset:21536
  ds_read_b64_tr_b16 a[246:247], v11 offset:22304
  ds_read_b64_tr_b16 a[248:249], v11 offset:21568
  ds_read_b64_tr_b16 a[250:251], v11 offset:22336
  s_waitcnt lgkmcnt(6)
  s_mov_b32 s36, 1142784
  s_add_u32 m0, s35, 15360
  s_nop 0
  buffer_load_dwordx4 v10, s[8:11], s36 offen lds
  s_add_u32 m0, s35, 16384
  s_nop 0
  buffer_load_dwordx4 v12, s[8:11], s36 offen lds
  s_add_u32 m0, s35, 17408
  s_nop 0
  buffer_load_dwordx4 v13, s[8:11], s36 offen lds
  s_waitcnt vmcnt(30)
  ds_read_b64_tr_b16 a[252:253], v11 offset:24576
  ds_read_b64_tr_b16 a[254:255], v11 offset:25344
  ds_read_b64_tr_b16 v[80:81], v11 offset:24608
  ds_read_b64_tr_b16 v[82:83], v11 offset:25376
  ds_read_b64_tr_b16 v[84:85], v11 offset:24640
  ds_read_b64_tr_b16 v[86:87], v11 offset:25408
  s_waitcnt lgkmcnt(6)
  s_mov_b32 s36, 1179648
  s_add_u32 m0, s35, 18432
  s_nop 0
  buffer_load_dwordx4 v10, s[8:11], s36 offen lds
  s_add_u32 m0, s35, 19456
  s_nop 0
  buffer_load_dwordx4 v12, s[8:11], s36 offen lds
  s_add_u32 m0, s35, 20480
  s_nop 0
  buffer_load_dwordx4 v13, s[8:11], s36 offen lds
  s_waitcnt vmcnt(30)
  ds_read_b64_tr_b16 v[88:89], v11 offset:27648
  ds_read_b64_tr_b16 v[90:91], v11 offset:28416
  ds_read_b64_tr_b16 v[92:93], v11 offset:27680
  ds_read_b64_tr_b16 v[94:95], v11 offset:28448
  ds_read_b64_tr_b16 v[96:97], v11 offset:27712
  ds_read_b64_tr_b16 v[98:99], v11 offset:28480
  s_waitcnt lgkmcnt(6)
  s_mov_b32 s36, 1216512
  s_add_u32 m0, s35, 21504
  s_nop 0
  buffer_load_dwordx4 v10, s[8:11], s36 offen lds
  s_add_u32 m0, s35, 22528
  s_nop 0
  buffer_load_dwordx4 v12, s[8:11], s36 offen lds
  s_add_u32 m0, s35, 23552
  s_nop 0
  buffer_load_dwordx4 v13, s[8:11], s36 offen lds
  s_waitcnt vmcnt(30)
  ds_read_b64_tr_b16 v[100:101], v11 offset:30720
  ds_read_b64_tr_b16 v[102:103], v11 offset:31488
  ds_read_b64_tr_b16 v[104:105], v11 offset:30752
  ds_read_b64_tr_b16 v[106:107], v11 offset:31520
  ds_read_b64_tr_b16 v[108:109], v11 offset:30784
  ds_read_b64_tr_b16 v[110:111], v11 offset:31552
  s_waitcnt lgkmcnt(6)
  s_mov_b32 s36, 1253376
  s_add_u32 m0, s35, 24576
  s_nop 0
  buffer_load_dwordx4 v10, s[8:11], s36 offen lds
  s_add_u32 m0, s35, 25600
  s_nop 0
  buffer_load_dwordx4 v12, s[8:11], s36 offen lds
  s_add_u32 m0, s35, 26624
  s_nop 0
  buffer_load_dwordx4 v13, s[8:11], s36 offen lds
  s_waitcnt vmcnt(30)
  ds_read_b64_tr_b16 v[112:113], v11 offset:33792
  ds_read_b64_tr_b16 v[114:115], v11 offset:34560
  ds_read_b64_tr_b16 v[116:117], v11 offset:33824
  ds_read_b64_tr_b16 v[118:119], v11 offset:34592
  ds_read_b64_tr_b16 v[120:121], v11 offset:33856
  ds_read_b64_tr_b16 v[122:123], v11 offset:34624
  s_waitcnt lgkmcnt(6)
  s_mov_b32 s36, 1290240
  s_add_u32 m0, s35, 27648
  s_nop 0
  buffer_load_dwordx4 v10, s[8:11], s36 offen lds
  s_add_u32 m0, s35, 28672
  s_nop 0
  buffer_load_dwordx4 v12, s[8:11], s36 offen lds
  s_add_u32 m0, s35, 29696
  s_nop 0
  buffer_load_dwordx4 v13, s[8:11], s36 offen lds
  s_waitcnt vmcnt(30)
  ds_read_b64_tr_b16 v[124:125], v11 offset:36864
  ds_read_b64_tr_b16 v[126:127], v11 offset:37632
  ds_read_b64_tr_b16 v[128:129], v11 offset:36896
  ds_read_b64_tr_b16 v[130:131], v11 offset:37664
  ds_read_b64_tr_b16 v[132:133], v11 offset:36928
  ds_read_b64_tr_b16 v[134:135], v11 offset:37696
  s_waitcnt vmcnt(27)
  ds_read_b64_tr_b16 v[136:137], v11 offset:0
  ds_read_b64_tr_b16 v[138:139], v11 offset:768
  ds_read_b64_tr_b16 v[140:141], v11 offset:32
  ds_read_b64_tr_b16 v[142:143], v11 offset:800
  ds_read_b64_tr_b16 v[144:145], v11 offset:64
  ds_read_b64_tr_b16 v[146:147], v11 offset:832
  s_waitcnt vmcnt(24)
  ds_read_b64_tr_b16 v[148:149], v11 offset:3072
  ds_read_b64_tr_b16 v[150:151], v11 offset:3840
  ds_read_b64_tr_b16 v[152:153], v11 offset:3104
  ds_read_b64_tr_b16 v[154:155], v11 offset:3872
  ds_read_b64_tr_b16 v[156:157], v11 offset:3136
  ds_read_b64_tr_b16 v[158:159], v11 offset:3904
  s_waitcnt vmcnt(21)
  ds_read_b64_tr_b16 v[160:161], v11 offset:6144
  ds_read_b64_tr_b16 v[162:163], v11 offset:6912
  ds_read_b64_tr_b16 v[164:165], v11 offset:6176
  ds_read_b64_tr_b16 v[166:167], v11 offset:6944
  ds_read_b64_tr_b16 v[168:169], v11 offset:6208
  ds_read_b64_tr_b16 v[170:171], v11 offset:6976
  s_waitcnt vmcnt(18)
  ds_read_b64_tr_b16 v[172:173], v11 offset:9216
  ds_read_b64_tr_b16 v[174:175], v11 offset:9984
  ds_read_b64_tr_b16 v[176:177], v11 offset:9248
  ds_read_b64_tr_b16 v[178:179], v11 offset:10016
  ds_read_b64_tr_b16 v[180:181], v11 offset:9280
  ds_read_b64_tr_b16 v[182:183], v11 offset:10048
  s_waitcnt vmcnt(15)
  ds_read_b64_tr_b16 v[184:185], v11 offset:12288
  ds_read_b64_tr_b16 v[186:187], v11 offset:13056
  ds_read_b64_tr_b16 v[188:189], v11 offset:12320
  ds_read_b64_tr_b16 v[190:191], v11 offset:13088
  ds_read_b64_tr_b16 v[192:193], v11 offset:12352
  ds_read_b64_tr_b16 v[194:195], v11 offset:13120
  s_waitcnt vmcnt(12)
  ds_read_b64_tr_b16 v[196:197], v11 offset:15360
  ds_read_b64_tr_b16 v[198:199], v11 offset:16128
  ds_read_b64_tr_b16 v[200:201], v11 offset:15392
  ds_read_b64_tr_b16 v[202:203], v11 offset:16160
  ds_read_b64_tr_b16 v[204:205], v11 offset:15424
  ds_read_b64_tr_b16 v[206:207], v11 offset:16192
  s_waitcnt vmcnt(9)
  ds_read_b64_tr_b16 v[208:209], v11 offset:18432
  ds_read_b64_tr_b16 v[210:211], v11 offset:19200
  ds_read_b64_tr_b16 v[212:213], v11 offset:18464
  ds_read_b64_tr_b16 v[214:215], v11 offset:19232
  ds_read_b64_tr_b16 v[216:217], v11 offset:18496
  ds_read_b64_tr_b16 v[218:219], v11 offset:19264
  s_waitcnt vmcnt(6)
  ds_read_b64_tr_b16 v[220:221], v11 offset:21504
  ds_read_b64_tr_b16 v[222:223], v11 offset:22272
  ds_read_b64_tr_b16 v[224:225], v11 offset:21536
  ds_read_b64_tr_b16 v[226:227], v11 offset:22304
  ds_read_b64_tr_b16 v[228:229], v11 offset:21568
  ds_read_b64_tr_b16 v[230:231], v11 offset:22336
  s_waitcnt vmcnt(3)
  ds_read_b64_tr_b16 v[232:233], v11 offset:24576
  ds_read_b64_tr_b16 v[234:235], v11 offset:25344
  ds_read_b64_tr_b16 v[236:237], v11 offset:24608
  ds_read_b64_tr_b16 v[238:239], v11 offset:25376
  ds_read_b64_tr_b16 v[240:241], v11 offset:24640
  ds_read_b64_tr_b16 v[242:243], v11 offset:25408
  s_waitcnt vmcnt(0)
  ds_read_b64_tr_b16 v[244:245], v11 offset:27648
  ds_read_b64_tr_b16 v[246:247], v11 offset:28416
  ds_read_b64_tr_b16 v[248:249], v11 offset:27680
  ds_read_b64_tr_b16 v[250:251], v11 offset:28448
  ds_read_b64_tr_b16 v[252:253], v11 offset:27712
  ds_read_b64_tr_b16 v[254:255], v11 offset:28480
  s_waitcnt lgkmcnt(0)
  s_barrier
  v_mov_b32 v5, 0
  v_mov_b32 v6, 1
  v_lshlrev_b32 v1, 4, v0
  s_mov_b32 s48, 0
  s_mov_b32 s49, -1
  s_mul_i32 s33, s29, 12
  s_mul_i32 s34, s24, 3
  s_add_u32 s33, s33, s34
  s_lshl_b32 s33, s33, 7
  v_and_b32 v8, 3, v0
  v_bfe_u32 v7, v0, 2, 2
  v_mul_u32_u24 v7, 6144, v7
  v_lshl_add_u32 v7, v8, 7, v7
  s_add_u32 s33, s33, 128000
  v_add_u32 v7, s33, v7
  v_add_u32 v8, 4, v7
  v_cndmask_b32 v7, v7, v8, s[48:49]
  s_mul_i32 s46, s28, 12
  s_mul_i32 s34, s29, 3
  s_add_u32 s46, s46, s34
  s_add_u32 s46, s46, s62
  s_lshl_b32 s46, s46, 9
  s_lshl_b32 s34, s24, 7
  s_add_u32 s46, s46, s34
  s_add_u32 s46, s46, 146432
  v_lshrrev_b32 v8, 5, v0
  v_lshlrev_b32 v10, 10, v8
  v_bfe_u32 v8, v0, 4, 1
  v_lshl_add_u32 v10, v8, 9, v10
  v_and_b32 v8, 15, v0
  v_lshl_add_u32 v10, v8, 4, v10
  v_add_u32 v11, 36864, v10
  s_mul_i32 s35, s24, 192
  s_add_u32 s35, s35, 147456
  v_mul_u32_u24 v3, 784, v8
  v_lshrrev_b32 v8, 4, v0
  v_lshl_add_u32 v3, v8, 4, v3
  v_add_u32 v3, s35, v3
  s_mul_i32 s33, s62, 768
  s_mul_i32 s34, s24, 9216
  s_add_u32 s33, s33, s34
  s_mul_i32 s34, s29, 36864
  s_add_u32 s33, s33, s34
  s_mul_i32 s35, s24, 3136
  s_add_u32 s35, s35, 147456
  v_add_u32 v8, 0, v0
  v_mul_u32_u24 v9, 43691, v8
  v_lshrrev_b32 v9, 21, v9
  v_mul_u32_u24 v14, 48, v9
  v_sub_u32 v14, v8, v14
  v_lshlrev_b32 v14, 4, v14
  v_mul_u32_u24 v72, 784, v9
  v_add3_u32 v72, v72, v14, s35
  v_mul_u32_u24 v75, 2304, v9
  v_add3_u32 v75, v75, v14, s33
  v_add_u32 v8, 64, v0
  v_mul_u32_u24 v9, 43691, v8
  v_lshrrev_b32 v9, 21, v9
  v_mul_u32_u24 v14, 48, v9
  v_sub_u32 v14, v8, v14
  v_lshlrev_b32 v14, 4, v14
  v_mul_u32_u24 v73, 784, v9
  v_add3_u32 v73, v73, v14, s35
  v_mul_u32_u24 v76, 2304, v9
  v_add3_u32 v76, v76, v14, s33
  v_add_u32 v8, 128, v0
  v_mul_u32_u24 v9, 43691, v8
  v_lshrrev_b32 v9, 21, v9
  v_mul_u32_u24 v14, 48, v9
  v_sub_u32 v14, v8, v14
  v_lshlrev_b32 v14, 4, v14
  v_mul_u32_u24 v74, 784, v9
  v_add3_u32 v74, v74, v14, s35
  v_mul_u32_u24 v77, 2304, v9
  v_add3_u32 v77, v77, v14, s33
  v_mov_b32 v8, 128
Lwi_22:
  buffer_load_dword v9, v8, s[20:23], 0 offen sc1
  s_waitcnt vmcnt(0)
  v_cmp_gt_u32 vcc, 0x100, v9
  s_cbranch_vccz Lwiok_23
  s_add_u32 s60, s60, 1
  s_cmp_gt_u32 s60, 262144
  s_cbranch_scc1 L_fail_ffn2
  s_sleep 4
  s_branch Lwi_22
Lwiok_23:
  s_mov_b32 s30, s28
  s_mov_b32 s31, s28
  s_mov_b32 s44, 0
  s_mov_b32 s45, 73728
  s_mov_b32 s47, 0x40000000
  s_mov_b32 s50, 0
  s_mov_b32 s58, -1
  s_mov_b32 s38, 0x40000000
  s_mul_i32 s51, s29, 12
  s_lshl_b32 s34, s62, 2
  s_add_u32 s51, s51, s34
  s_add_u32 s51, s51, s24
  s_mul_i32 s40, s24, 18432
  s_mul_i32 s39, s29, 9510912
  s_add_u32 s39, s39, s40
  s_add_u32 s39, s39, 209403904
  s_mov_b32 s41, 190529536
  s_mov_b32 s48, 0x777
  s_mov_b32 s49, 0x777
  v_mov_b32 v9, 0
  s_mul_i32 s33, s31, 18
  s_lshr_b32 s33, s33, 4
  s_add_i32 s33, s33, 22
  s_cmp_le_i32 s33, s30
  s_cselect_b32 s34, 1, 0
  s_cmp_ge_u32 s30, 64
  s_cselect_b32 s34, 1, s34
  s_cmp_ge_u32 s31, 64
  s_cselect_b32 s34, 0, s34
  s_cmp_eq_u32 s34, 1
  s_cselect_b32 s59, s31, s30
  s_cselect_b32 s43, 64, 0
  s_cmp_eq_u32 s34, 1
  s_cselect_b32 s35, 3, 0
  s_cselect_b32 s36, 0, 3
  s_add_u32 s31, s31, s35
  s_add_u32 s30, s30, s36
  s_add_u32 s43, s43, s59
  s_mul_i32 s35, s59, 43
  s_lshr_b32 s35, s35, 7
  s_mul_i32 s35, s35, 3
  s_sub_u32 s35, s59, s35
  s_lshl_b32 s35, s35, 2
  s_lshl_b32 s35, 7, s35
  s_cmp_eq_u32 s34, 1
  s_cselect_b32 s62, 0, s35
  s_cselect_b32 s63, s35, 0
  s_mul_i32 s33, s59, 73728
  s_add_u32 s33, s33, s39
  s_add_u32 s34, s40, s44
  s_cmp_ge_u32 s59, 64
  s_cselect_b32 s43, -1, s43
  s_cselect_b32 s42, 1, 0
L_ffn2_fetch:
  s_mov_b64 exec, s[62:63]
  buffer_load_dword v9, v7, s[4:7], 0 offen sc1
  s_mov_b64 exec, -1
  s_waitcnt vmcnt(0)
  v_cmp_ge_u32 vcc, s59, v9
  s_and_b64 vcc, vcc, s[62:63]
  s_cbranch_scc0 L_ffn2_fgo
  s_add_u32 s60, s60, 1
  s_cmp_gt_u32 s60, 262144
  s_cbranch_scc1 L_fail_ffn2
  s_sleep 2
  s_branch L_ffn2_fetch
L_ffn2_fgo:
  s_add_u32 m0, s34, 0
  s_add_u32 s35, s33, 0
  buffer_load_dwordx4 v1, s[4:7], s35 offen offset:0 sc1 lds
  buffer_load_dwordx4 v1, s[4:7], s35 offen offset:1024 sc1 lds
  buffer_load_dwordx4 v1, s[4:7], s35 offen offset:2048 sc1 lds
  buffer_load_dwordx4 v1, s[4:7], s35 offen offset:3072 sc1 lds
  s_add_u32 m0, s34, 4096
  s_add_u32 s35, s33, 4096
  buffer_load_dwordx4 v1, s[4:7], s35 offen offset:0 sc1 lds
  buffer_load_dwordx4 v1, s[4:7], s35 offen offset:1024 sc1 lds
  buffer_load_dwordx4 v1, s[4:7], s35 offen offset:2048 sc1 lds
  buffer_load_dwordx4 v1, s[4:7], s35 offen offset:3072 sc1 lds
  s_add_u32 m0, s34, 8192
  s_add_u32 s35, s33, 8192
  buffer_load_dwordx4 v1, s[4:7], s35 offen offset:0 sc1 lds
  buffer_load_dwordx4 v1, s[4:7], s35 offen offset:1024 sc1 lds
  buffer_load_dwordx4 v1, s[4:7], s35 offen offset:2048 sc1 lds
  buffer_load_dwordx4 v1, s[4:7], s35 offen offset:3072 sc1 lds
  s_add_u32 m0, s34, 12288
  s_add_u32 s35, s33, 12288
  buffer_load_dwordx4 v1, s[4:7], s35 offen offset:0 sc1 lds
  buffer_load_dwordx4 v1, s[4:7], s35 offen offset:1024 sc1 lds
  buffer_load_dwordx4 v1, s[4:7], s35 offen offset:2048 sc1 lds
  buffer_load_dwordx4 v1, s[4:7], s35 offen offset:3072 sc1 lds
  s_add_u32 m0, s34, 16384
  s_add_u32 s35, s33, 16384
  buffer_load_dwordx4 v1, s[4:7], s35 offen offset:0 sc1 lds
  buffer_load_dwordx4 v1, s[4:7], s35 offen offset:1024 sc1 lds
  s_waitcnt vmcnt(0)
L_ffn2_run:
  s_mov_b32 s32, s43
  s_add_u32 s44, s44, s45
  s_mul_i32 s37, s59, 147456
  s_add_u32 s37, s37, s41
  s_barrier
  ds_read_b128 v[40:43], v10 offset:0
  ds_read_b128 v[44:47], v10 offset:256
  ds_read_b128 v[64:67], v72
  ds_read_b128 v[68:71], v73
  ds_read_b128 v[12:15], v74
  ds_read_b128 v[48:51], v10 offset:2048
  ds_read_b128 v[52:55], v10 offset:2304
  s_waitcnt lgkmcnt(5)
  v_mfma_f32_16x16x32_bf16 v[16:19], a[0:3], v[40:43], 0
  ds_read_b128 v[56:59], v10 offset:4096
  v_mfma_f32_16x16x32_bf16 v[24:27], a[4:7], v[40:43], 0
  s_mul_i32 s33, s31, 18
  s_lshr_b32 s33, s33, 4
  s_add_i32 s33, s33, 22
  s_cmp_le_i32 s33, s30
  s_cselect_b32 s34, 1, 0
  v_mfma_f32_16x16x32_bf16 v[32:35], a[8:11], v[40:43], 0
  v_mfma_f32_16x16x32_bf16 v[20:23], a[0:3], v[44:47], 0
  ds_read_b128 v[60:63], v10 offset:4352
  v_mfma_f32_16x16x32_bf16 v[28:31], a[4:7], v[44:47], 0
  s_cmp_ge_u32 s30, 64
  s_cselect_b32 s34, 1, s34
  s_cmp_ge_u32 s31, 64
  s_cselect_b32 s34, 0, s34
  v_mfma_f32_16x16x32_bf16 v[36:39], a[8:11], v[44:47], 0
  s_waitcnt lgkmcnt(2)
  v_mfma_f32_16x16x32_bf16 v[16:19], a[12:15], v[48:51], v[16:19]
  ds_read_b128 v[40:43], v10 offset:6144
  v_mfma_f32_16x16x32_bf16 v[24:27], a[16:19], v[48:51], v[24:27]
  s_cmp_eq_u32 s34, 1
  s_cselect_b32 s59, s31, s30
  s_cselect_b32 s43, 64, 0
  s_cmp_eq_u32 s34, 1
  s_cselect_b32 s35, 3, 0
  s_cselect_b32 s36, 0, 3
  v_mfma_f32_16x16x32_bf16 v[32:35], a[20:23], v[48:51], v[32:35]
  buffer_store_dwordx4 v[64:67], v75, s[4:7], s38 offen sc1
  v_mfma_f32_16x16x32_bf16 v[20:23], a[12:15], v[52:55], v[20:23]
  ds_read_b128 v[44:47], v10 offset:6400
  v_mfma_f32_16x16x32_bf16 v[28:31], a[16:19], v[52:55], v[28:31]
  s_add_u32 s31, s31, s35
  s_add_u32 s30, s30, s36
  s_add_u32 s43, s43, s59
  s_mul_i32 s35, s59, 43
  s_lshr_b32 s35, s35, 7
  s_mul_i32 s35, s35, 3
  v_mfma_f32_16x16x32_bf16 v[36:39], a[20:23], v[52:55], v[36:39]
  buffer_store_dwordx4 v[68:71], v76, s[4:7], s38 offen sc1
  s_waitcnt lgkmcnt(2)
  v_mfma_f32_16x16x32_bf16 v[16:19], a[24:27], v[56:59], v[16:19]
  ds_read_b128 v[48:51], v10 offset:8192
  v_mfma_f32_16x16x32_bf16 v[24:27], a[28:31], v[56:59], v[24:27]
  s_sub_u32 s35, s59, s35
  s_lshl_b32 s35, s35, 2
  s_lshl_b32 s35, 7, s35
  s_cmp_eq_u32 s34, 1
  s_cselect_b32 s62, 0, s35
  s_cselect_b32 s63, s35, 0
  v_mfma_f32_16x16x32_bf16 v[32:35], a[32:35], v[56:59], v[32:35]
  buffer_store_dwordx4 v[12:15], v77, s[4:7], s38 offen sc1
  v_mfma_f32_16x16x32_bf16 v[20:23], a[24:27], v[60:63], v[20:23]
  ds_read_b128 v[52:55], v10 offset:8448
  v_mfma_f32_16x16x32_bf16 v[28:31], a[28:31], v[60:63], v[28:31]
  s_mul_i32 s33, s59, 73728
  s_add_u32 s33, s33, s39
  s_add_u32 s34, s40, s44
  s_cmp_ge_u32 s59, 64
  s_cselect_b32 s43, -1, s43
  s_cselect_b32 s42, 1, 0
  v_mfma_f32_16x16x32_bf16 v[36:39], a[32:35], v[60:63], v[36:39]
  s_waitcnt lgkmcnt(2)
  v_mfma_f32_16x16x32_bf16 v[16:19], a[36:39], v[40:43], v[16:19]
  ds_read_b128 v[56:59], v10 offset:10240
  v_mfma_f32_16x16x32_bf16 v[24:27], a[40:43], v[40:43], v[24:27]
  v_cmp_ge_u32 vcc, s59, v9
  v_mfma_f32_16x16x32_bf16 v[32:35], a[44:47], v[40:43], v[32:35]
  v_mfma_f32_16x16x32_bf16 v[20:23], a[36:39], v[44:47], v[20:23]
  ds_read_b128 v[60:63], v10 offset:10496
  v_mfma_f32_16x16x32_bf16 v[28:31], a[40:43], v[44:47], v[28:31]
  v_mfma_f32_16x16x32_bf16 v[36:39], a[44:47], v[44:47], v[36:39]
  s_waitcnt lgkmcnt(2)
  s_and_b64 vcc, vcc, s[62:63]
  s_cbranch_scc0 L_ffn2_w8
  v_mfma_f32_16x16x32_bf16 v[16:19], a[48:51], v[48:51], v[16:19]
  ds_read_b128 v[40:43], v10 offset:12288
  v_mfma_f32_16x16x32_bf16 v[24:27], a[52:55], v[48:51], v[24:27]
  v_mfma_f32_16x16x32_bf16 v[32:35], a[56:59], v[48:51], v[32:35]
  v_mfma_f32_16x16x32_bf16 v[20:23], a[48:51], v[52:55], v[20:23]
  ds_read_b128 v[44:47], v10 offset:12544
  v_mfma_f32_16x16x32_bf16 v[28:31], a[52:55], v[52:55], v[28:31]
  v_mfma_f32_16x16x32_bf16 v[36:39], a[56:59], v[52:55], v[36:39]
  s_waitcnt lgkmcnt(2)
  v_mfma_f32_16x16x32_bf16 v[16:19], a[60:63], v[56:59], v[16:19]
  ds_read_b128 v[48:51], v10 offset:14336
  v_mfma_f32_16x16x32_bf16 v[24:27], a[64:67], v[56:59], v[24:27]
  v_mfma_f32_16x16x32_bf16 v[32:35], a[68:71], v[56:59], v[32:35]
  v_mfma_f32_16x16x32_bf16 v[20:23], a[60:63], v[60:63], v[20:23]
  ds_read_b128 v[52:55], v10 offset:14592
  v_mfma_f32_16x16x32_bf16 v[28:31], a[64:67], v[60:63], v[28:31]
  s_mov_b64 exec, s[48:49]
  buffer_load_dword v9, v7, s[4:7], 0 offen sc1
  s_mov_b64 exec, -1
  v_mfma_f32_16x16x32_bf16 v[36:39], a[68:71], v[60:63], v[36:39]
  s_waitcnt lgkmcnt(2)
  v_mfma_f32_16x16x32_bf16 v[16:19], a[72:75], v[40:43], v[16:19]
  ds_read_b128 v[56:59], v10 offset:16384
  v_mfma_f32_16x16x32_bf16 v[24:27], a[76:79], v[40:43], v[24:27]
  v_mfma_f32_16x16x32_bf16 v[32:35], a[80:83], v[40:43], v[32:35]
  v_mfma_f32_16x16x32_bf16 v[20:23], a[72:75], v[44:47], v[20:23]
  ds_read_b128 v[60:63], v10 offset:16640
  v_mfma_f32_16x16x32_bf16 v[28:31], a[76:79], v[44:47], v[28:31]
  v_mfma_f32_16x16x32_bf16 v[36:39], a[80:83], v[44:47], v[36:39]
  s_waitcnt lgkmcnt(2)
  v_mfma_f32_16x16x32_bf16 v[16:19], a[84:87], v[48:51], v[16:19]
  ds_read_b128 v[40:43], v10 offset:18432
  v_mfma_f32_16x16x32_bf16 v[24:27], a[88:91], v[48:51], v[24:27]
  v_mfma_f32_16x16x32_bf16 v[32:35], a[92:95], v[48:51], v[32:35]
  v_mfma_f32_16x16x32_bf16 v[20:23], a[84:87], v[52:55], v[20:23]
  ds_read_b128 v[44:47], v10 offset:18688
  v_mfma_f32_16x16x32_bf16 v[28:31], a[88:91], v[52:55], v[28:31]
  v_mfma_f32_16x16x32_bf16 v[36:39], a[92:95], v[52:55], v[36:39]
  s_waitcnt lgkmcnt(2)
  v_mfma_f32_16x16x32_bf16 v[16:19], a[96:99], v[56:59], v[16:19]
  ds_read_b128 v[48:51], v10 offset:20480
  v_mfma_f32_16x16x32_bf16 v[24:27], a[100:103], v[56:59], v[24:27]
  v_mfma_f32_16x16x32_bf16 v[32:35], a[104:107], v[56:59], v[32:35]
  v_mfma_f32_16x16x32_bf16 v[20:23], a[96:99], v[60:63], v[20:23]
  ds_read_b128 v[52:55], v10 offset:20736
  v_mfma_f32_16x16x32_bf16 v[28:31], a[100:103], v[60:63], v[28:31]
  v_mfma_f32_16x16x32_bf16 v[36:39], a[104:107], v[60:63], v[36:39]
  s_waitcnt lgkmcnt(2)
  v_mfma_f32_16x16x32_bf16 v[16:19], a[108:111], v[40:43], v[16:19]
  ds_read_b128 v[56:59], v10 offset:22528
  v_mfma_f32_16x16x32_bf16 v[24:27], a[112:115], v[40:43], v[24:27]
  v_mfma_f32_16x16x32_bf16 v[32:35], a[116:119], v[40:43], v[32:35]
  v_mfma_f32_16x16x32_bf16 v[20:23], a[108:111], v[44:47], v[20:23]
  ds_read_b128 v[60:63], v10 offset:22784
  v_mfma_f32_16x16x32_bf16 v[28:31], a[112:115], v[44:47], v[28:31]
  s_waitcnt vmcnt(1)
  v_mov_b32 v6, s50
  s_mov_b64 exec, 1
  buffer_store_dword v6, v5, s[4:7], s47 offen sc1
  s_mov_b64 exec, -1
  v_mfma_f32_16x16x32_bf16 v[36:39], a[116:119], v[44:47], v[36:39]
  s_waitcnt lgkmcnt(2)
  v_mfma_f32_16x16x32_bf16 v[16:19], a[120:123], v[48:51], v[16:19]
  ds_read_b128 v[40:43], v10 offset:24576
  v_mfma_f32_16x16x32_bf16 v[24:27], a[124:127], v[48:51], v[24:27]
  v_cmp_ge_u32 vcc, s59, v9
  v_mfma_f32_16x16x32_bf16 v[32:35], a[128:131], v[48:51], v[32:35]
  v_mfma_f32_16x16x32_bf16 v[20:23], a[120:123], v[52:55], v[20:23]
  ds_read_b128 v[44:47], v10 offset:24832
  v_mfma_f32_16x16x32_bf16 v[28:31], a[124:127], v[52:55], v[28:31]
  v_mfma_f32_16x16x32_bf16 v[36:39], a[128:131], v[52:55], v[36:39]
  s_waitcnt lgkmcnt(2)
  s_and_b64 vcc, vcc, s[62:63]
  s_cbranch_scc0 L_ffn2_w22
  v_mfma_f32_16x16x32_bf16 v[16:19], a[132:135], v[56:59], v[16:19]
  ds_read_b128 v[48:51], v10 offset:26624
  v_mfma_f32_16x16x32_bf16 v[24:27], a[136:139], v[56:59], v[24:27]
  v_mfma_f32_16x16x32_bf16 v[32:35], a[140:143], v[56:59], v[32:35]
  v_mfma_f32_16x16x32_bf16 v[20:23], a[132:135], v[60:63], v[20:23]
  ds_read_b128 v[52:55], v10 offset:26880
  v_mfma_f32_16x16x32_bf16 v[28:31], a[136:139], v[60:63], v[28:31]
  v_mfma_f32_16x16x32_bf16 v[36:39], a[140:143], v[60:63], v[36:39]
  s_waitcnt lgkmcnt(2)
  v_mfma_f32_16x16x32_bf16 v[16:19], a[144:147], v[40:43], v[16:19]
  ds_read_b128 v[56:59], v10 offset:28672
  v_mfma_f32_16x16x32_bf16 v[24:27], a[148:151], v[40:43], v[24:27]
  v_mfma_f32_16x16x32_bf16 v[32:35], a[152:155], v[40:43], v[32:35]
  v_mfma_f32_16x16x32_bf16 v[20:23], a[144:147], v[44:47], v[20:23]
  ds_read_b128 v[60:63], v10 offset:28928
  v_mfma_f32_16x16x32_bf16 v[28:31], a[148:151], v[44:47], v[28:31]
  s_mov_b64 exec, s[48:49]
  buffer_load_dword v9, v7, s[4:7], 0 offen sc1
  s_mov_b64 exec, -1
  v_mfma_f32_16x16x32_bf16 v[36:39], a[152:155], v[44:47], v[36:39]
  s_waitcnt lgkmcnt(2)
  v_mfma_f32_16x16x32_bf16 v[16:19], a[156:159], v[48:51], v[16:19]
  ds_read_b128 v[40:43], v10 offset:30720
  v_mfma_f32_16x16x32_bf16 v[24:27], a[160:163], v[48:51], v[24:27]
  v_mfma_f32_16x16x32_bf16 v[32:35], a[164:167], v[48:51], v[32:35]
  v_mfma_f32_16x16x32_bf16 v[20:23], a[156:159], v[52:55], v[20:23]
  ds_read_b128 v[44:47], v10 offset:30976
  v_mfma_f32_16x16x32_bf16 v[28:31], a[160:163], v[52:55], v[28:31]
  v_mfma_f32_16x16x32_bf16 v[36:39], a[164:167], v[52:55], v[36:39]
  s_waitcnt lgkmcnt(2)
  v_mfma_f32_16x16x32_bf16 v[16:19], a[168:171], v[56:59], v[16:19]
  ds_read_b128 v[48:51], v10 offset:32768
  v_mfma_f32_16x16x32_bf16 v[24:27], a[172:175], v[56:59], v[24:27]
  v_mfma_f32_16x16x32_bf16 v[32:35], a[176:179], v[56:59], v[32:35]
  v_mfma_f32_16x16x32_bf16 v[20:23], a[168:171], v[60:63], v[20:23]
  ds_read_b128 v[52:55], v10 offset:33024
  v_mfma_f32_16x16x32_bf16 v[28:31], a[172:175], v[60:63], v[28:31]
  v_mfma_f32_16x16x32_bf16 v[36:39], a[176:179], v[60:63], v[36:39]
  s_waitcnt lgkmcnt(2)
  v_mfma_f32_16x16x32_bf16 v[16:19], a[180:183], v[40:43], v[16:19]
  ds_read_b128 v[56:59], v10 offset:34816
  v_mfma_f32_16x16x32_bf16 v[24:27], a[184:187], v[40:43], v[24:27]
  v_mfma_f32_16x16x32_bf16 v[32:35], a[188:191], v[40:43], v[32:35]
  v_mfma_f32_16x16x32_bf16 v[20:23], a[180:183], v[44:47], v[20:23]
  ds_read_b128 v[60:63], v10 offset:35072
  v_mfma_f32_16x16x32_bf16 v[28:31], a[184:187], v[44:47], v[28:31]
  v_mfma_f32_16x16x32_bf16 v[36:39], a[188:191], v[44:47], v[36:39]
  s_waitcnt lgkmcnt(2)
  v_mfma_f32_16x16x32_bf16 v[16:19], a[192:195], v[48:51], v[16:19]
  ds_read_b128 v[40:43], v11 offset:0
  v_mfma_f32_16x16x32_bf16 v[24:27], a[196:199], v[48:51], v[24:27]
  v_mfma_f32_16x16x32_bf16 v[32:35], a[200:203], v[48:51], v[32:35]
  v_mfma_f32_16x16x32_bf16 v[20:23], a[192:195], v[52:55], v[20:23]
  ds_read_b128 v[44:47], v11 offset:256
  v_mfma_f32_16x16x32_bf16 v[28:31], a[196:199], v[52:55], v[28:31]
  v_mfma_f32_16x16x32_bf16 v[36:39], a[200:203], v[52:55], v[36:39]
  s_waitcnt lgkmcnt(2)
  v_mfma_f32_16x16x32_bf16 v[16:19], a[204:207], v[56:59], v[16:19]
  ds_read_b128 v[48:51], v11 offset:2048
  v_mfma_f32_16x16x32_bf16 v[24:27], a[208:211], v[56:59], v[24:27]
  v_cmp_ge_u32 vcc, s59, v9
  v_mfma_f32_16x16x32_bf16 v[32:35], a[212:215], v[56:59], v[32:35]
  v_mfma_f32_16x16x32_bf16 v[20:23], a[204:207], v[60:63], v[20:23]
  ds_read_b128 v[52:55], v11 offset:2304
  v_mfma_f32_16x16x32_bf16 v[28:31], a[208:211], v[60:63], v[28:31]
  v_mfma_f32_16x16x32_bf16 v[36:39], a[212:215], v[60:63], v[36:39]
  s_waitcnt lgkmcnt(2)
  s_and_b64 vcc, vcc, s[62:63]
  s_cbranch_scc0 L_ffn2_w36
  v_mfma_f32_16x16x32_bf16 v[16:19], a[216:219], v[40:43], v[16:19]
  ds_read_b128 v[56:59], v11 offset:4096
  v_mfma_f32_16x16x32_bf16 v[24:27], a[220:223], v[40:43], v[24:27]
  v_mfma_f32_16x16x32_bf16 v[32:35], a[224:227], v[40:43], v[32:35]
  v_mfma_f32_16x16x32_bf16 v[20:23], a[216:219], v[44:47], v[20:23]
  ds_read_b128 v[60:63], v11 offset:4352
  v_mfma_f32_16x16x32_bf16 v[28:31], a[220:223], v[44:47], v[28:31]
  v_mfma_f32_16x16x32_bf16 v[36:39], a[224:227], v[44:47], v[36:39]
  s_waitcnt lgkmcnt(2)
  v_mfma_f32_16x16x32_bf16 v[16:19], a[228:231], v[48:51], v[16:19]
  ds_read_b128 v[40:43], v11 offset:6144
  v_mfma_f32_16x16x32_bf16 v[24:27], a[232:235], v[48:51], v[24:27]
  v_mfma_f32_16x16x32_bf16 v[32:35], a[236:239], v[48:51], v[32:35]
  v_mfma_f32_16x16x32_bf16 v[20:23], a[228:231], v[52:55], v[20:23]
  ds_read_b128 v[44:47], v11 offset:6400
  v_mfma_f32_16x16x32_bf16 v[28:31], a[232:235], v[52:55], v[28:31]
  v_mfma_f32_16x16x32_bf16 v[36:39], a[236:239], v[52:55], v[36:39]
  s_waitcnt lgkmcnt(2)
  v_mfma_f32_16x16x32_bf16 v[16:19], a[240:243], v[56:59], v[16:19]
  ds_read_b128 v[48:51], v11 offset:8192
  v_mfma_f32_16x16x32_bf16 v[24:27], a[244:247], v[56:59], v[24:27]
  v_mfma_f32_16x16x32_bf16 v[32:35], a[248:251], v[56:59], v[32:35]
  v_mfma_f32_16x16x32_bf16 v[20:23], a[240:243], v[60:63], v[20:23]
  ds_read_b128 v[52:55], v11 offset:8448
  v_mfma_f32_16x16x32_bf16 v[28:31], a[244:247], v[60:63], v[28:31]
  v_mfma_f32_16x16x32_bf16 v[36:39], a[248:251], v[60:63], v[36:39]
  s_waitcnt lgkmcnt(2)
  v_mfma_f32_16x16x32_bf16 v[16:19], a[252:255], v[40:43], v[16:19]
  ds_read_b128 v[56:59], v11 offset:10240
  v_mfma_f32_16x16x32_bf16 v[24:27], v[80:83], v[40:43], v[24:27]
  v_mfma_f32_16x16x32_bf16 v[32:35], v[84:87], v[40:43], v[32:35]
  v_mfma_f32_16x16x32_bf16 v[20:23], a[252:255], v[44:47], v[20:23]
  ds_read_b128 v[60:63], v11 offset:10496
  v_mfma_f32_16x16x32_bf16 v[28:31], v[80:83], v[44:47], v[28:31]
  s_mov_b64 exec, s[48:49]
  buffer_load_dword v9, v7, s[4:7], 0 offen sc1
  s_mov_b64 exec, -1
  v_mfma_f32_16x16x32_bf16 v[36:39], v[84:87], v[44:47], v[36:39]
  s_waitcnt lgkmcnt(2)
  v_mfma_f32_16x16x32_bf16 v[16:19], v[88:91], v[48:51], v[16:19]
  ds_read_b128 v[40:43], v11 offset:12288
  v_mfma_f32_16x16x32_bf16 v[24:27], v[92:95], v[48:51], v[24:27]
  v_mfma_f32_16x16x32_bf16 v[32:35], v[96:99], v[48:51], v[32:35]
  v_mfma_f32_16x16x32_bf16 v[20:23], v[88:91], v[52:55], v[20:23]
  ds_read_b128 v[44:47], v11 offset:12544
  v_mfma_f32_16x16x32_bf16 v[28:31], v[92:95], v[52:55], v[28:31]
  v_mfma_f32_16x16x32_bf16 v[36:39], v[96:99], v[52:55], v[36:39]
  s_waitcnt lgkmcnt(2)
  v_mfma_f32_16x16x32_bf16 v[16:19], v[100:103], v[56:59], v[16:19]
  ds_read_b128 v[48:51], v11 offset:14336
  v_mfma_f32_16x16x32_bf16 v[24:27], v[104:107], v[56:59], v[24:27]
  v_mfma_f32_16x16x32_bf16 v[32:35], v[108:111], v[56:59], v[32:35]
  v_mfma_f32_16x16x32_bf16 v[20:23], v[100:103], v[60:63], v[20:23]
  ds_read_b128 v[52:55], v11 offset:14592
  v_mfma_f32_16x16x32_bf16 v[28:31], v[104:107], v[60:63], v[28:31]
  v_mfma_f32_16x16x32_bf16 v[36:39], v[108:111], v[60:63], v[36:39]
  s_waitcnt lgkmcnt(2)
  v_mfma_f32_16x16x32_bf16 v[16:19], v[112:115], v[40:43], v[16:19]
  ds_read_b128 v[56:59], v11 offset:16384
  v_mfma_f32_16x16x32_bf16 v[24:27], v[116:119], v[40:43], v[24:27]
  v_mfma_f32_16x16x32_bf16 v[32:35], v[120:123], v[40:43], v[32:35]
  v_mfma_f32_16x16x32_bf16 v[20:23], v[112:115], v[44:47], v[20:23]
  ds_read_b128 v[60:63], v11 offset:16640
  v_mfma_f32_16x16x32_bf16 v[28:31], v[116:119], v[44:47], v[28:31]
  v_mfma_f32_16x16x32_bf16 v[36:39], v[120:123], v[44:47], v[36:39]
  s_waitcnt lgkmcnt(2)
  v_mfma_f32_16x16x32_bf16 v[16:19], v[124:127], v[48:51], v[16:19]
  ds_read_b128 v[40:43], v11 offset:18432
  v_mfma_f32_16x16x32_bf16 v[24:27], v[128:131], v[48:51], v[24:27]
  v_mfma_f32_16x16x32_bf16 v[32:35], v[132:135], v[48:51], v[32:35]
  v_mfma_f32_16x16x32_bf16 v[20:23], v[124:127], v[52:55], v[20:23]
  ds_read_b128 v[44:47], v11 offset:18688
  v_mfma_f32_16x16x32_bf16 v[28:31], v[128:131], v[52:55], v[28:31]
  v_mfma_f32_16x16x32_bf16 v[36:39], v[132:135], v[52:55], v[36:39]
  s_waitcnt lgkmcnt(2)
  v_mfma_f32_16x16x32_bf16 v[16:19], v[136:139], v[56:59], v[16:19]
  ds_read_b128 v[48:51], v11 offset:20480
  v_mfma_f32_16x16x32_bf16 v[24:27], v[140:143], v[56:59], v[24:27]
  v_cmp_ge_u32 vcc, s59, v9
  v_mfma_f32_16x16x32_bf16 v[32:35], v[144:147], v[56:59], v[32:35]
  v_mfma_f32_16x16x32_bf16 v[20:23], v[136:139], v[60:63], v[20:23]
  ds_read_b128 v[52:55], v11 offset:20736
  v_mfma_f32_16x16x32_bf16 v[28:31], v[140:143], v[60:63], v[28:31]
  v_mfma_f32_16x16x32_bf16 v[36:39], v[144:147], v[60:63], v[36:39]
  s_waitcnt lgkmcnt(2)
  s_and_b64 vcc, vcc, s[62:63]
  s_cbranch_scc0 L_ffn2_w54
  v_mfma_f32_16x16x32_bf16 v[16:19], v[148:151], v[40:43], v[16:19]
  ds_read_b128 v[56:59], v11 offset:22528
  v_mfma_f32_16x16x32_bf16 v[24:27], v[152:155], v[40:43], v[24:27]
  v_mfma_f32_16x16x32_bf16 v[32:35], v[156:159], v[40:43], v[32:35]
  v_mfma_f32_16x16x32_bf16 v[20:23], v[148:151], v[44:47], v[20:23]
  ds_read_b128 v[60:63], v11 offset:22784
  v_mfma_f32_16x16x32_bf16 v[28:31], v[152:155], v[44:47], v[28:31]
  v_mfma_f32_16x16x32_bf16 v[36:39], v[156:159], v[44:47], v[36:39]
  s_waitcnt lgkmcnt(2)
  v_mfma_f32_16x16x32_bf16 v[16:19], v[160:163], v[48:51], v[16:19]
  ds_read_b128 v[40:43], v11 offset:24576
  v_mfma_f32_16x16x32_bf16 v[24:27], v[164:167], v[48:51], v[24:27]
  v_mfma_f32_16x16x32_bf16 v[32:35], v[168:171], v[48:51], v[32:35]
  v_mfma_f32_16x16x32_bf16 v[20:23], v[160:163], v[52:55], v[20:23]
  ds_read_b128 v[44:47], v11 offset:24832
  v_mfma_f32_16x16x32_bf16 v[28:31], v[164:167], v[52:55], v[28:31]
  v_mfma_f32_16x16x32_bf16 v[36:39], v[168:171], v[52:55], v[36:39]
  s_waitcnt lgkmcnt(2)
  v_mfma_f32_16x16x32_bf16 v[16:19], v[172:175], v[56:59], v[16:19]
  ds_read_b128 v[48:51], v11 offset:26624
  v_mfma_f32_16x16x32_bf16 v[24:27], v[176:179], v[56:59], v[24:27]
  v_mfma_f32_16x16x32_bf16 v[32:35], v[180:183], v[56:59], v[32:35]
  v_mfma_f32_16x16x32_bf16 v[20:23], v[172:175], v[60:63], v[20:23]
  ds_read_b128 v[52:55], v11 offset:26880
  v_mfma_f32_16x16x32_bf16 v[28:31], v[176:179], v[60:63], v[28:31]
  v_mfma_f32_16x16x32_bf16 v[36:39], v[180:183], v[60:63], v[36:39]
  s_waitcnt lgkmcnt(2)
  v_mfma_f32_16x16x32_bf16 v[16:19], v[184:187], v[40:43], v[16:19]
  ds_read_b128 v[56:59], v11 offset:28672
  v_mfma_f32_16x16x32_bf16 v[24:27], v[188:191], v[40:43], v[24:27]
  v_mfma_f32_16x16x32_bf16 v[32:35], v[192:195], v[40:43], v[32:35]
  v_mfma_f32_16x16x32_bf16 v[20:23], v[184:187], v[44:47], v[20:23]
  ds_read_b128 v[60:63], v11 offset:28928
  v_mfma_f32_16x16x32_bf16 v[28:31], v[188:191], v[44:47], v[28:31]
  s_mov_b64 exec, s[48:49]
  buffer_load_dword v9, v7, s[4:7], 0 offen sc1
  s_mov_b64 exec, -1
  v_mfma_f32_16x16x32_bf16 v[36:39], v[192:195], v[44:47], v[36:39]
  s_waitcnt lgkmcnt(2)
  v_mfma_f32_16x16x32_bf16 v[16:19], v[196:199], v[48:51], v[16:19]
  ds_read_b128 v[40:43], v11 offset:30720
  v_mfma_f32_16x16x32_bf16 v[24:27], v[200:203], v[48:51], v[24:27]
  v_mfma_f32_16x16x32_bf16 v[32:35], v[204:207], v[48:51], v[32:35]
  v_mfma_f32_16x16x32_bf16 v[20:23], v[196:199], v[52:55], v[20:23]
  ds_read_b128 v[44:47], v11 offset:30976
  v_mfma_f32_16x16x32_bf16 v[28:31], v[200:203], v[52:55], v[28:31]
  v_mfma_f32_16x16x32_bf16 v[36:39], v[204:207], v[52:55], v[36:39]
  s_waitcnt lgkmcnt(2)
  v_mfma_f32_16x16x32_bf16 v[16:19], v[208:211], v[56:59], v[16:19]
  ds_read_b128 v[48:51], v11 offset:32768
  v_mfma_f32_16x16x32_bf16 v[24:27], v[212:215], v[56:59], v[24:27]
  v_mfma_f32_16x16x32_bf16 v[32:35], v[216:219], v[56:59], v[32:35]
  v_mfma_f32_16x16x32_bf16 v[20:23], v[208:211], v[60:63], v[20:23]
  ds_read_b128 v[52:55], v11 offset:33024
  v_mfma_f32_16x16x32_bf16 v[28:31], v[212:215], v[60:63], v[28:31]
  v_mfma_f32_16x16x32_bf16 v[36:39], v[216:219], v[60:63], v[36:39]
  s_waitcnt lgkmcnt(2)
  v_mfma_f32_16x16x32_bf16 v[16:19], v[220:223], v[40:43], v[16:19]
  ds_read_b128 v[56:59], v11 offset:34816
  v_mfma_f32_16x16x32_bf16 v[24:27], v[224:227], v[40:43], v[24:27]
  v_mfma_f32_16x16x32_bf16 v[32:35], v[228:231], v[40:43], v[32:35]
  v_mfma_f32_16x16x32_bf16 v[20:23], v[220:223], v[44:47], v[20:23]
  ds_read_b128 v[60:63], v11 offset:35072
  v_mfma_f32_16x16x32_bf16 v[28:31], v[224:227], v[44:47], v[28:31]
  v_mfma_f32_16x16x32_bf16 v[36:39], v[228:231], v[44:47], v[36:39]
  s_waitcnt lgkmcnt(2)
  v_mfma_f32_16x16x32_bf16 v[16:19], v[232:235], v[48:51], v[16:19]
  v_mfma_f32_16x16x32_bf16 v[24:27], v[236:239], v[48:51], v[24:27]
  v_mfma_f32_16x16x32_bf16 v[32:35], v[240:243], v[48:51], v[32:35]
  v_mfma_f32_16x16x32_bf16 v[20:23], v[232:235], v[52:55], v[20:23]
  v_mfma_f32_16x16x32_bf16 v[28:31], v[236:239], v[52:55], v[28:31]
  v_mfma_f32_16x16x32_bf16 v[36:39], v[240:243], v[52:55], v[36:39]
  s_waitcnt lgkmcnt(0)
  v_mfma_f32_16x16x32_bf16 v[16:19], v[244:247], v[56:59], v[16:19]
  v_mfma_f32_16x16x32_bf16 v[24:27], v[248:251], v[56:59], v[24:27]
  v_mfma_f32_16x16x32_bf16 v[32:35], v[252:255], v[56:59], v[32:35]
  v_mfma_f32_16x16x32_bf16 v[20:23], v[244:247], v[60:63], v[20:23]
  v_mfma_f32_16x16x32_bf16 v[28:31], v[248:251], v[60:63], v[28:31]
  v_mfma_f32_16x16x32_bf16 v[36:39], v[252:255], v[60:63], v[36:39]
  v_cvt_pk_bf16_f32 v40, v16, v17
  v_cvt_pk_bf16_f32 v41, v18, v19
  v_cvt_pk_bf16_f32 v42, v20, v21
  v_cvt_pk_bf16_f32 v43, v22, v23
  ds_write_b128 v3, v[40:43] offset:0
  v_cvt_pk_bf16_f32 v44, v24, v25
  v_cvt_pk_bf16_f32 v45, v26, v27
  v_cvt_pk_bf16_f32 v46, v28, v29
  v_cvt_pk_bf16_f32 v47, v30, v31
  ds_write_b128 v3, v[44:47] offset:64
  v_cvt_pk_bf16_f32 v48, v32, v33
  v_cvt_pk_bf16_f32 v49, v34, v35
  v_cvt_pk_bf16_f32 v50, v36, v37
  v_cvt_pk_bf16_f32 v51, v38, v39
  ds_write_b128 v3, v[48:51] offset:128
  s_mov_b32 s38, s37
  v_add_u32 v10, s45, v10
  v_add_u32 v11, s45, v11
  s_sub_u32 s45, 0, s45
  s_bfe_u32 s35, s32, 0x10006
  s_lshl_b32 s35, s35, 2
  s_add_u32 s47, s46, s35
  s_and_b32 s50, s32, 63
  s_add_u32 s50, s50, 1
  s_waitcnt lgkmcnt(0)
  s_barrier
  ds_read_b128 v[64:67], v72
  ds_read_b128 v[68:71], v73
  ds_read_b128 v[12:15], v74
  s_waitcnt lgkmcnt(2)
  buffer_store_dwordx4 v[64:67], v75, s[4:7], s38 offen sc1
  s_waitcnt lgkmcnt(1)
  buffer_store_dwordx4 v[68:71], v76, s[4:7], s38 offen sc1
  s_waitcnt lgkmcnt(0)
  buffer_store_dwordx4 v[12:15], v77, s[4:7], s38 offen sc1
  s_mov_b32 s38, 0x40000000
  s_waitcnt vmcnt(3)
  v_cmp_ge_u32 vcc, s59, v9
  s_and_b64 vcc, vcc, s[62:63]
  s_cbranch_scc1 L_ffn2_drain
  s_add_u32 m0, s34, 0
  s_add_u32 s35, s33, 0
  buffer_load_dwordx4 v1, s[4:7], s35 offen offset:0 sc1 lds
  buffer_load_dwordx4 v1, s[4:7], s35 offen offset:1024 sc1 lds
  buffer_load_dwordx4 v1, s[4:7], s35 offen offset:2048 sc1 lds
  buffer_load_dwordx4 v1, s[4:7], s35 offen offset:3072 sc1 lds
  s_add_u32 m0, s34, 4096
  s_add_u32 s35, s33, 4096
  buffer_load_dwordx4 v1, s[4:7], s35 offen offset:0 sc1 lds
  buffer_load_dwordx4 v1, s[4:7], s35 offen offset:1024 sc1 lds
  buffer_load_dwordx4 v1, s[4:7], s35 offen offset:2048 sc1 lds
  buffer_load_dwordx4 v1, s[4:7], s35 offen offset:3072 sc1 lds
  s_add_u32 m0, s34, 8192
  s_add_u32 s35, s33, 8192
  buffer_load_dwordx4 v1, s[4:7], s35 offen offset:0 sc1 lds
  buffer_load_dwordx4 v1, s[4:7], s35 offen offset:1024 sc1 lds
  buffer_load_dwordx4 v1, s[4:7], s35 offen offset:2048 sc1 lds
  buffer_load_dwordx4 v1, s[4:7], s35 offen offset:3072 sc1 lds
  s_add_u32 m0, s34, 12288
  s_add_u32 s35, s33, 12288
  buffer_load_dwordx4 v1, s[4:7], s35 offen offset:0 sc1 lds
  buffer_load_dwordx4 v1, s[4:7], s35 offen offset:1024 sc1 lds
  buffer_load_dwordx4 v1, s[4:7], s35 offen offset:2048 sc1 lds
  buffer_load_dwordx4 v1, s[4:7], s35 offen offset:3072 sc1 lds
  s_add_u32 m0, s34, 16384
  s_add_u32 s35, s33, 16384
  buffer_load_dwordx4 v1, s[4:7], s35 offen offset:0 sc1 lds
  buffer_load_dwordx4 v1, s[4:7], s35 offen offset:1024 sc1 lds
  s_waitcnt vmcnt(18)
  v_mov_b32 v6, s50
  s_mov_b64 exec, 1
  buffer_store_dword v6, v5, s[4:7], s47 offen sc1
  s_mov_b64 exec, -1
  s_mov_b32 s47, 0x40000000
  s_waitcnt vmcnt(1)
  s_branch L_ffn2_run
L_ffn2_drain:
  s_waitcnt vmcnt(0)
  v_mov_b32 v6, s50
  s_mov_b64 exec, 1
  buffer_store_dword v6, v5, s[4:7], s47 offen sc1
  s_mov_b64 exec, -1
  s_mov_b32 s47, 0x40000000
  s_cmp_eq_u32 s42, 0
  s_cbranch_scc1 L_ffn2_fetch
  s_endpgm
L_ffn2_w8:
  v_mfma_f32_16x16x32_bf16 v[16:19], a[48:51], v[48:51], v[16:19]
  ds_read_b128 v[40:43], v10 offset:12288
  v_mfma_f32_16x16x32_bf16 v[24:27], a[52:55], v[48:51], v[24:27]
  s_add_u32 m0, s34, 0
  s_add_u32 s35, s33, 0
  buffer_load_dwordx4 v1, s[4:7], s35 offen offset:0 sc1 lds
  v_mfma_f32_16x16x32_bf16 v[32:35], a[56:59], v[48:51], v[32:35]
  v_mfma_f32_16x16x32_bf16 v[20:23], a[48:51], v[52:55], v[20:23]
  ds_read_b128 v[44:47], v10 offset:12544
  v_mfma_f32_16x16x32_bf16 v[28:31], a[52:55], v[52:55], v[28:31]
  v_mfma_f32_16x16x32_bf16 v[36:39], a[56:59], v[52:55], v[36:39]
  s_waitcnt lgkmcnt(2)
  v_mfma_f32_16x16x32_bf16 v[16:19], a[60:63], v[56:59], v[16:19]
  ds_read_b128 v[48:51], v10 offset:14336
  v_mfma_f32_16x16x32_bf16 v[24:27], a[64:67], v[56:59], v[24:27]
  buffer_load_dwordx4 v1, s[4:7], s35 offen offset:1024 sc1 lds
  v_mfma_f32_16x16x32_bf16 v[32:35], a[68:71], v[56:59], v[32:35]
  v_mfma_f32_16x16x32_bf16 v[20:23], a[60:63], v[60:63], v[20:23]
  ds_read_b128 v[52:55], v10 offset:14592
  v_mfma_f32_16x16x32_bf16 v[28:31], a[64:67], v[60:63], v[28:31]
  v_mfma_f32_16x16x32_bf16 v[36:39], a[68:71], v[60:63], v[36:39]
  s_waitcnt lgkmcnt(2)
  v_mfma_f32_16x16x32_bf16 v[16:19], a[72:75], v[40:43], v[16:19]
  ds_read_b128 v[56:59], v10 offset:16384
  v_mfma_f32_16x16x32_bf16 v[24:27], a[76:79], v[40:43], v[24:27]
  buffer_load_dwordx4 v1, s[4:7], s35 offen offset:2048 sc1 lds
  v_mfma_f32_16x16x32_bf16 v[32:35], a[80:83], v[40:43], v[32:35]
  v_mfma_f32_16x16x32_bf16 v[20:23], a[72:75], v[44:47], v[20:23]
  ds_read_b128 v[60:63], v10 offset:16640
  v_mfma_f32_16x16x32_bf16 v[28:31], a[76:79], v[44:47], v[28:31]
  v_mfma_f32_16x16x32_bf16 v[36:39], a[80:83], v[44:47], v[36:39]
  s_waitcnt lgkmcnt(2)
  v_mfma_f32_16x16x32_bf16 v[16:19], a[84:87], v[48:51], v[16:19]
  ds_read_b128 v[40:43], v10 offset:18432
  v_mfma_f32_16x16x32_bf16 v[24:27], a[88:91], v[48:51], v[24:27]
  buffer_load_dwordx4 v1, s[4:7], s35 offen offset:3072 sc1 lds
  v_mfma_f32_16x16x32_bf16 v[32:35], a[92:95], v[48:51], v[32:35]
  v_mfma_f32_16x16x32_bf16 v[20:23], a[84:87], v[52:55], v[20:23]
  ds_read_b128 v[44:47], v10 offset:18688
  v_mfma_f32_16x16x32_bf16 v[28:31], a[88:91], v[52:55], v[28:31]
  v_mfma_f32_16x16x32_bf16 v[36:39], a[92:95], v[52:55], v[36:39]
  s_waitcnt lgkmcnt(2)
  v_mfma_f32_16x16x32_bf16 v[16:19], a[96:99], v[56:59], v[16:19]
  ds_read_b128 v[48:51], v10 offset:20480
  v_mfma_f32_16x16x32_bf16 v[24:27], a[100:103], v[56:59], v[24:27]
  s_add_u32 m0, s34, 4096
  s_add_u32 s35, s33, 4096
  buffer_load_dwordx4 v1, s[4:7], s35 offen offset:0 sc1 lds
  v_mfma_f32_16x16x32_bf16 v[32:35], a[104:107], v[56:59], v[32:35]
  v_mfma_f32_16x16x32_bf16 v[20:23], a[96:99], v[60:63], v[20:23]
  ds_read_b128 v[52:55], v10 offset:20736
  v_mfma_f32_16x16x32_bf16 v[28:31], a[100:103], v[60:63], v[28:31]
  v_mfma_f32_16x16x32_bf16 v[36:39], a[104:107], v[60:63], v[36:39]
  s_waitcnt lgkmcnt(2)
  v_mfma_f32_16x16x32_bf16 v[16:19], a[108:111], v[40:43], v[16:19]
  ds_read_b128 v[56:59], v10 offset:22528
  v_mfma_f32_16x16x32_bf16 v[24:27], a[112:115], v[40:43], v[24:27]
  buffer_load_dwordx4 v1, s[4:7], s35 offen offset:1024 sc1 lds
  v_mfma_f32_16x16x32_bf16 v[32:35], a[116:119], v[40:43], v[32:35]
  v_mfma_f32_16x16x32_bf16 v[20:23], a[108:111], v[44:47], v[20:23]
  ds_read_b128 v[60:63], v10 offset:22784
  v_mfma_f32_16x16x32_bf16 v[28:31], a[112:115], v[44:47], v[28:31]
  s_waitcnt vmcnt(6)
  v_mov_b32 v6, s50
  s_mov_b64 exec, 1
  buffer_store_dword v6, v5, s[4:7], s47 offen sc1
  s_mov_b64 exec, -1
  v_mfma_f32_16x16x32_bf16 v[36:39], a[116:119], v[44:47], v[36:39]
  s_waitcnt lgkmcnt(2)
  v_mfma_f32_16x16x32_bf16 v[16:19], a[120:123], v[48:51], v[16:19]
  ds_read_b128 v[40:43], v10 offset:24576
  v_mfma_f32_16x16x32_bf16 v[24:27], a[124:127], v[48:51], v[24:27]
  buffer_load_dwordx4 v1, s[4:7], s35 offen offset:2048 sc1 lds
  v_mfma_f32_16x16x32_bf16 v[32:35], a[128:131], v[48:51], v[32:35]
  v_mfma_f32_16x16x32_bf16 v[20:23], a[120:123], v[52:55], v[20:23]
  ds_read_b128 v[44:47], v10 offset:24832
  v_mfma_f32_16x16x32_bf16 v[28:31], a[124:127], v[52:55], v[28:31]
  v_mfma_f32_16x16x32_bf16 v[36:39], a[128:131], v[52:55], v[36:39]
  s_waitcnt lgkmcnt(2)
  v_mfma_f32_16x16x32_bf16 v[16:19], a[132:135], v[56:59], v[16:19]
  ds_read_b128 v[48:51], v10 offset:26624
  v_mfma_f32_16x16x32_bf16 v[24:27], a[136:139], v[56:59], v[24:27]
  buffer_load_dwordx4 v1, s[4:7], s35 offen offset:3072 sc1 lds
  v_mfma_f32_16x16x32_bf16 v[32:35], a[140:143], v[56:59], v[32:35]
  v_mfma_f32_16x16x32_bf16 v[20:23], a[132:135], v[60:63], v[20:23]
  ds_read_b128 v[52:55], v10 offset:26880
  v_mfma_f32_16x16x32_bf16 v[28:31], a[136:139], v[60:63], v[28:31]
  v_mfma_f32_16x16x32_bf16 v[36:39], a[140:143], v[60:63], v[36:39]
  s_waitcnt lgkmcnt(2)
  v_mfma_f32_16x16x32_bf16 v[16:19], a[144:147], v[40:43], v[16:19]
  ds_read_b128 v[56:59], v10 offset:28672
  v_mfma_f32_16x16x32_bf16 v[24:27], a[148:151], v[40:43], v[24:27]
  s_add_u32 m0, s34, 8192
  s_add_u32 s35, s33, 8192
  buffer_load_dwordx4 v1, s[4:7], s35 offen offset:0 sc1 lds
  v_mfma_f32_16x16x32_bf16 v[32:35], a[152:155], v[40:43], v[32:35]
  v_mfma_f32_16x16x32_bf16 v[20:23], a[144:147], v[44:47], v[20:23]
  ds_read_b128 v[60:63], v10 offset:28928
  v_mfma_f32_16x16x32_bf16 v[28:31], a[148:151], v[44:47], v[28:31]
  v_mfma_f32_16x16x32_bf16 v[36:39], a[152:155], v[44:47], v[36:39]
  s_waitcnt lgkmcnt(2)
  v_mfma_f32_16x16x32_bf16 v[16:19], a[156:159], v[48:51], v[16:19]
  ds_read_b128 v[40:43], v10 offset:30720
  v_mfma_f32_16x16x32_bf16 v[24:27], a[160:163], v[48:51], v[24:27]
  buffer_load_dwordx4 v1, s[4:7], s35 offen offset:1024 sc1 lds
  v_mfma_f32_16x16x32_bf16 v[32:35], a[164:167], v[48:51], v[32:35]
  v_mfma_f32_16x16x32_bf16 v[20:23], a[156:159], v[52:55], v[20:23]
  ds_read_b128 v[44:47], v10 offset:30976
  v_mfma_f32_16x16x32_bf16 v[28:31], a[160:163], v[52:55], v[28:31]
  v_mfma_f32_16x16x32_bf16 v[36:39], a[164:167], v[52:55], v[36:39]
  s_waitcnt lgkmcnt(2)
  v_mfma_f32_16x16x32_bf16 v[16:19], a[168:171], v[56:59], v[16:19]
  ds_read_b128 v[48:51], v10 offset:32768
  v_mfma_f32_16x16x32_bf16 v[24:27], a[172:175], v[56:59], v[24:27]
  buffer_load_dwordx4 v1, s[4:7], s35 offen offset:2048 sc1 lds
  v_mfma_f32_16x16x32_bf16 v[32:35], a[176:179], v[56:59], v[32:35]
  v_mfma_f32_16x16x32_bf16 v[20:23], a[168:171], v[60:63], v[20:23]
  ds_read_b128 v[52:55], v10 offset:33024
  v_mfma_f32_16x16x32_bf16 v[28:31], a[172:175], v[60:63], v[28:31]
  v_mfma_f32_16x16x32_bf16 v[36:39], a[176:179], v[60:63], v[36:39]
  s_waitcnt lgkmcnt(2)
  v_mfma_f32_16x16x32_bf16 v[16:19], a[180:183], v[40:43], v[16:19]
  ds_read_b128 v[56:59], v10 offset:34816
  v_mfma_f32_16x16x32_bf16 v[24:27], a[184:187], v[40:43], v[24:27]
  buffer_load_dwordx4 v1, s[4:7], s35 offen offset:3072 sc1 lds
  v_mfma_f32_16x16x32_bf16 v[32:35], a[188:191], v[40:43], v[32:35]
  v_mfma_f32_16x16x32_bf16 v[20:23], a[180:183], v[44:47], v[20:23]
  ds_read_b128 v[60:63], v10 offset:35072
  v_mfma_f32_16x16x32_bf16 v[28:31], a[184:187], v[44:47], v[28:31]
  v_mfma_f32_16x16x32_bf16 v[36:39], a[188:191], v[44:47], v[36:39]
  s_waitcnt lgkmcnt(2)
  v_mfma_f32_16x16x32_bf16 v[16:19], a[192:195], v[48:51], v[16:19]
  ds_read_b128 v[40:43], v11 offset:0
  v_mfma_f32_16x16x32_bf16 v[24:27], a[196:199], v[48:51], v[24:27]
  s_add_u32 m0, s34, 12288
  s_add_u32 s35, s33, 12288
  buffer_load_dwordx4 v1, s[4:7], s35 offen offset:0 sc1 lds
  v_mfma_f32_16x16x32_bf16 v[32:35], a[200:203], v[48:51], v[32:35]
  v_mfma_f32_16x16x32_bf16 v[20:23], a[192:195], v[52:55], v[20:23]
  ds_read_b128 v[44:47], v11 offset:256
  v_mfma_f32_16x16x32_bf16 v[28:31], a[196:199], v[52:55], v[28:31]
  v_mfma_f32_16x16x32_bf16 v[36:39], a[200:203], v[52:55], v[36:39]
  s_waitcnt lgkmcnt(2)
  v_mfma_f32_16x16x32_bf16 v[16:19], a[204:207], v[56:59], v[16:19]
  ds_read_b128 v[48:51], v11 offset:2048
  v_mfma_f32_16x16x32_bf16 v[24:27], a[208:211], v[56:59], v[24:27]
  buffer_load_dwordx4 v1, s[4:7], s35 offen offset:1024 sc1 lds
  v_mfma_f32_16x16x32_bf16 v[32:35], a[212:215], v[56:59], v[32:35]
  v_mfma_f32_16x16x32_bf16 v[20:23], a[204:207], v[60:63], v[20:23]
  ds_read_b128 v[52:55], v11 offset:2304
  v_mfma_f32_16x16x32_bf16 v[28:31], a[208:211], v[60:63], v[28:31]
  v_mfma_f32_16x16x32_bf16 v[36:39], a[212:215], v[60:63], v[36:39]
  s_waitcnt lgkmcnt(2)
  v_mfma_f32_16x16x32_bf16 v[16:19], a[216:219], v[40:43], v[16:19]
  ds_read_b128 v[56:59], v11 offset:4096
  v_mfma_f32_16x16x32_bf16 v[24:27], a[220:223], v[40:43], v[24:27]
  buffer_load_dwordx4 v1, s[4:7], s35 offen offset:2048 sc1 lds
  v_mfma_f32_16x16x32_bf16 v[32:35], a[224:227], v[40:43], v[32:35]
  v_mfma_f32_16x16x32_bf16 v[20:23], a[216:219], v[44:47], v[20:23]
  ds_read_b128 v[60:63], v11 offset:4352
  v_mfma_f32_16x16x32_bf16 v[28:31], a[220:223], v[44:47], v[28:31]
  v_mfma_f32_16x16x32_bf16 v[36:39], a[224:227], v[44:47], v[36:39]
  s_waitcnt lgkmcnt(2)
  v_mfma_f32_16x16x32_bf16 v[16:19], a[228:231], v[48:51], v[16:19]
  ds_read_b128 v[40:43], v11 offset:6144
  v_mfma_f32_16x16x32_bf16 v[24:27], a[232:235], v[48:51], v[24:27]
  buffer_load_dwordx4 v1, s[4:7], s35 offen offset:3072 sc1 lds
  v_mfma_f32_16x16x32_bf16 v[32:35], a[236:239], v[48:51], v[32:35]
  v_mfma_f32_16x16x32_bf16 v[20:23], a[228:231], v[52:55], v[20:23]
  ds_read_b128 v[44:47], v11 offset:6400
  v_mfma_f32_16x16x32_bf16 v[28:31], a[232:235], v[52:55], v[28:31]
  v_mfma_f32_16x16x32_bf16 v[36:39], a[236:239], v[52:55], v[36:39]
  s_waitcnt lgkmcnt(2)
  v_mfma_f32_16x16x32_bf16 v[16:19], a[240:243], v[56:59], v[16:19]
  ds_read_b128 v[48:51], v11 offset:8192
  v_mfma_f32_16x16x32_bf16 v[24:27], a[244:247], v[56:59], v[24:27]
  s_add_u32 m0, s34, 16384
  s_add_u32 s35, s33, 16384
  buffer_load_dwordx4 v1, s[4:7], s35 offen offset:0 sc1 lds
  v_mfma_f32_16x16x32_bf16 v[32:35], a[248:251], v[56:59], v[32:35]
  v_mfma_f32_16x16x32_bf16 v[20:23], a[240:243], v[60:63], v[20:23]
  ds_read_b128 v[52:55], v11 offset:8448
  v_mfma_f32_16x16x32_bf16 v[28:31], a[244:247], v[60:63], v[28:31]
  v_mfma_f32_16x16x32_bf16 v[36:39], a[248:251], v[60:63], v[36:39]
  s_waitcnt lgkmcnt(2)
  v_mfma_f32_16x16x32_bf16 v[16:19], a[252:255], v[40:43], v[16:19]
  ds_read_b128 v[56:59], v11 offset:10240
  v_mfma_f32_16x16x32_bf16 v[24:27], v[80:83], v[40:43], v[24:27]
  buffer_load_dwordx4 v1, s[4:7], s35 offen offset:1024 sc1 lds
  v_mfma_f32_16x16x32_bf16 v[32:35], v[84:87], v[40:43], v[32:35]
  v_mfma_f32_16x16x32_bf16 v[20:23], a[252:255], v[44:47], v[20:23]
  ds_read_b128 v[60:63], v11 offset:10496
  v_mfma_f32_16x16x32_bf16 v[28:31], v[80:83], v[44:47], v[28:31]
  v_mfma_f32_16x16x32_bf16 v[36:39], v[84:87], v[44:47], v[36:39]
  s_waitcnt lgkmcnt(2)
  v_mfma_f32_16x16x32_bf16 v[16:19], v[88:91], v[48:51], v[16:19]
  ds_read_b128 v[40:43], v11 offset:12288
  v_mfma_f32_16x16x32_bf16 v[24:27], v[92:95], v[48:51], v[24:27]
  v_mfma_f32_16x16x32_bf16 v[32:35], v[96:99], v[48:51], v[32:35]
  v_mfma_f32_16x16x32_bf16 v[20:23], v[88:91], v[52:55], v[20:23]
  ds_read_b128 v[44:47], v11 offset:12544
  v_mfma_f32_16x16x32_bf16 v[28:31], v[92:95], v[52:55], v[28:31]
  v_mfma_f32_16x16x32_bf16 v[36:39], v[96:99], v[52:55], v[36:39]
  s_waitcnt lgkmcnt(2)
  v_mfma_f32_16x16x32_bf16 v[16:19], v[100:103], v[56:59], v[16:19]
  ds_read_b128 v[48:51], v11 offset:14336
  v_mfma_f32_16x16x32_bf16 v[24:27], v[104:107], v[56:59], v[24:27]
  v_mfma_f32_16x16x32_bf16 v[32:35], v[108:111], v[56:59], v[32:35]
  v_mfma_f32_16x16x32_bf16 v[20:23], v[100:103], v[60:63], v[20:23]
  ds_read_b128 v[52:55], v11 offset:14592
  v_mfma_f32_16x16x32_bf16 v[28:31], v[104:107], v[60:63], v[28:31]
  v_mfma_f32_16x16x32_bf16 v[36:39], v[108:111], v[60:63], v[36:39]
  s_waitcnt lgkmcnt(2)
  v_mfma_f32_16x16x32_bf16 v[16:19], v[112:115], v[40:43], v[16:19]
  ds_read_b128 v[56:59], v11 offset:16384
  v_mfma_f32_16x16x32_bf16 v[24:27], v[116:119], v[40:43], v[24:27]
  v_mfma_f32_16x16x32_bf16 v[32:35], v[120:123], v[40:43], v[32:35]
  v_mfma_f32_16x16x32_bf16 v[20:23], v[112:115], v[44:47], v[20:23]
  ds_read_b128 v[60:63], v11 offset:16640
  v_mfma_f32_16x16x32_bf16 v[28:31], v[116:119], v[44:47], v[28:31]
  v_mfma_f32_16x16x32_bf16 v[36:39], v[120:123], v[44:47], v[36:39]
  s_waitcnt lgkmcnt(2)
  v_mfma_f32_16x16x32_bf16 v[16:19], v[124:127], v[48:51], v[16:19]
  ds_read_b128 v[40:43], v11 offset:18432
  v_mfma_f32_16x16x32_bf16 v[24:27], v[128:131], v[48:51], v[24:27]
  v_mfma_f32_16x16x32_bf16 v[32:35], v[132:135], v[48:51], v[32:35]
  v_mfma_f32_16x16x32_bf16 v[20:23], v[124:127], v[52:55], v[20:23]
  ds_read_b128 v[44:47], v11 offset:18688
  v_mfma_f32_16x16x32_bf16 v[28:31], v[128:131], v[52:55], v[28:31]
  v_mfma_f32_16x16x32_bf16 v[36:39], v[132:135], v[52:55], v[36:39]
  s_waitcnt lgkmcnt(2)
  v_mfma_f32_16x16x32_bf16 v[16:19], v[136:139], v[56:59], v[16:19]
  ds_read_b128 v[48:51], v11 offset:20480
  v_mfma_f32_16x16x32_bf16 v[24:27], v[140:143], v[56:59], v[24:27]
  v_mfma_f32_16x16x32_bf16 v[32:35], v[144:147], v[56:59], v[32:35]
  v_mfma_f32_16x16x32_bf16 v[20:23], v[136:139], v[60:63], v[20:23]
  ds_read_b128 v[52:55], v11 offset:20736
  v_mfma_f32_16x16x32_bf16 v[28:31], v[140:143], v[60:63], v[28:31]
  v_mfma_f32_16x16x32_bf16 v[36:39], v[144:147], v[60:63], v[36:39]
  s_waitcnt lgkmcnt(2)
  v_mfma_f32_16x16x32_bf16 v[16:19], v[148:151], v[40:43], v[16:19]
  ds_read_b128 v[56:59], v11 offset:22528
  v_mfma_f32_16x16x32_bf16 v[24:27], v[152:155], v[40:43], v[24:27]
  v_mfma_f32_16x16x32_bf16 v[32:35], v[156:159], v[40:43], v[32:35]
  v_mfma_f32_16x16x32_bf16 v[20:23], v[148:151], v[44:47], v[20:23]
  ds_read_b128 v[60:63], v11 offset:22784
  v_mfma_f32_16x16x32_bf16 v[28:31], v[152:155], v[44:47], v[28:31]
  v_mfma_f32_16x16x32_bf16 v[36:39], v[156:159], v[44:47], v[36:39]
  s_waitcnt lgkmcnt(2)
  v_mfma_f32_16x16x32_bf16 v[16:19], v[160:163], v[48:51], v[16:19]
  ds_read_b128 v[40:43], v11 offset:24576
  v_mfma_f32_16x16x32_bf16 v[24:27], v[164:167], v[48:51], v[24:27]
  v_mfma_f32_16x16x32_bf16 v[32:35], v[168:171], v[48:51], v[32:35]
  v_mfma_f32_16x16x32_bf16 v[20:23], v[160:163], v[52:55], v[20:23]
  ds_read_b128 v[44:47], v11 offset:24832
  v_mfma_f32_16x16x32_bf16 v[28:31], v[164:167], v[52:55], v[28:31]
  v_mfma_f32_16x16x32_bf16 v[36:39], v[168:171], v[52:55], v[36:39]
  s_waitcnt lgkmcnt(2)
  v_mfma_f32_16x16x32_bf16 v[16:19], v[172:175], v[56:59], v[16:19]
  ds_read_b128 v[48:51], v11 offset:26624
  v_mfma_f32_16x16x32_bf16 v[24:27], v[176:179], v[56:59], v[24:27]
  v_mfma_f32_16x16x32_bf16 v[32:35], v[180:183], v[56:59], v[32:35]
  v_mfma_f32_16x16x32_bf16 v[20:23], v[172:175], v[60:63], v[20:23]
  ds_read_b128 v[52:55], v11 offset:26880
  v_mfma_f32_16x16x32_bf16 v[28:31], v[176:179], v[60:63], v[28:31]
  v_mfma_f32_16x16x32_bf16 v[36:39], v[180:183], v[60:63], v[36:39]
  s_waitcnt lgkmcnt(2)
  v_mfma_f32_16x16x32_bf16 v[16:19], v[184:187], v[40:43], v[16:19]
  ds_read_b128 v[56:59], v11 offset:28672
  v_mfma_f32_16x16x32_bf16 v[24:27], v[188:191], v[40:43], v[24:27]
  v_mfma_f32_16x16x32_bf16 v[32:35], v[192:195], v[40:43], v[32:35]
  v_mfma_f32_16x16x32_bf16 v[20:23], v[184:187], v[44:47], v[20:23]
  ds_read_b128 v[60:63], v11 offset:28928
  v_mfma_f32_16x16x32_bf16 v[28:31], v[188:191], v[44:47], v[28:31]
  s_mov_b64 exec, s[48:49]
  buffer_load_dword v9, v7, s[4:7], 0 offen sc1
  s_mov_b64 exec, -1
  v_mfma_f32_16x16x32_bf16 v[36:39], v[192:195], v[44:47], v[36:39]
  s_waitcnt lgkmcnt(2)
  v_mfma_f32_16x16x32_bf16 v[16:19], v[196:199], v[48:51], v[16:19]
  ds_read_b128 v[40:43], v11 offset:30720
  v_mfma_f32_16x16x32_bf16 v[24:27], v[200:203], v[48:51], v[24:27]
  v_mfma_f32_16x16x32_bf16 v[32:35], v[204:207], v[48:51], v[32:35]
  v_mfma_f32_16x16x32_bf16 v[20:23], v[196:199], v[52:55], v[20:23]
  ds_read_b128 v[44:47], v11 offset:30976
  v_mfma_f32_16x16x32_bf16 v[28:31], v[200:203], v[52:55], v[28:31]
  v_mfma_f32_16x16x32_bf16 v[36:39], v[204:207], v[52:55], v[36:39]
  s_waitcnt lgkmcnt(2)
  v_mfma_f32_16x16x32_bf16 v[16:19], v[208:211], v[56:59], v[16:19]
  ds_read_b128 v[48:51], v11 offset:32768
  v_mfma_f32_16x16x32_bf16 v[24:27], v[212:215], v[56:59], v[24:27]
  v_mfma_f32_16x16x32_bf16 v[32:35], v[216:219], v[56:59], v[32:35]
  v_mfma_f32_16x16x32_bf16 v[20:23], v[208:211], v[60:63], v[20:23]
  ds_read_b128 v[52:55], v11 offset:33024
  v_mfma_f32_16x16x32_bf16 v[28:31], v[212:215], v[60:63], v[28:31]
  v_mfma_f32_16x16x32_bf16 v[36:39], v[216:219], v[60:63], v[36:39]
  s_waitcnt lgkmcnt(2)
  v_mfma_f32_16x16x32_bf16 v[16:19], v[220:223], v[40:43], v[16:19]
  ds_read_b128 v[56:59], v11 offset:34816
  v_mfma_f32_16x16x32_bf16 v[24:27], v[224:227], v[40:43], v[24:27]
  v_mfma_f32_16x16x32_bf16 v[32:35], v[228:231], v[40:43], v[32:35]
  v_mfma_f32_16x16x32_bf16 v[20:23], v[220:223], v[44:47], v[20:23]
  ds_read_b128 v[60:63], v11 offset:35072
  v_mfma_f32_16x16x32_bf16 v[28:31], v[224:227], v[44:47], v[28:31]
  v_mfma_f32_16x16x32_bf16 v[36:39], v[228:231], v[44:47], v[36:39]
  s_waitcnt lgkmcnt(2)
  v_mfma_f32_16x16x32_bf16 v[16:19], v[232:235], v[48:51], v[16:19]
  v_mfma_f32_16x16x32_bf16 v[24:27], v[236:239], v[48:51], v[24:27]
  v_mfma_f32_16x16x32_bf16 v[32:35], v[240:243], v[48:51], v[32:35]
  v_mfma_f32_16x16x32_bf16 v[20:23], v[232:235], v[52:55], v[20:23]
  v_mfma_f32_16x16x32_bf16 v[28:31], v[236:239], v[52:55], v[28:31]
  v_mfma_f32_16x16x32_bf16 v[36:39], v[240:243], v[52:55], v[36:39]
  s_waitcnt lgkmcnt(0)
  v_mfma_f32_16x16x32_bf16 v[16:19], v[244:247], v[56:59], v[16:19]
  v_mfma_f32_16x16x32_bf16 v[24:27], v[248:251], v[56:59], v[24:27]
  v_mfma_f32_16x16x32_bf16 v[32:35], v[252:255], v[56:59], v[32:35]
  v_mfma_f32_16x16x32_bf16 v[20:23], v[244:247], v[60:63], v[20:23]
  v_mfma_f32_16x16x32_bf16 v[28:31], v[248:251], v[60:63], v[28:31]
  v_mfma_f32_16x16x32_bf16 v[36:39], v[252:255], v[60:63], v[36:39]
  v_cvt_pk_bf16_f32 v40, v16, v17
  v_cvt_pk_bf16_f32 v41, v18, v19
  v_cvt_pk_bf16_f32 v42, v20, v21
  v_cvt_pk_bf16_f32 v43, v22, v23
  ds_write_b128 v3, v[40:43] offset:0
  v_cvt_pk_bf16_f32 v44, v24, v25
  v_cvt_pk_bf16_f32 v45, v26, v27
  v_cvt_pk_bf16_f32 v46, v28, v29
  v_cvt_pk_bf16_f32 v47, v30, v31
  ds_write_b128 v3, v[44:47] offset:64
  v_cvt_pk_bf16_f32 v48, v32, v33
  v_cvt_pk_bf16_f32 v49, v34, v35
  v_cvt_pk_bf16_f32 v50, v36, v37
  v_cvt_pk_bf16_f32 v51, v38, v39
  ds_write_b128 v3, v[48:51] offset:128
  s_mov_b32 s38, s37
  v_add_u32 v10, s45, v10
  v_add_u32 v11, s45, v11
  s_sub_u32 s45, 0, s45
  s_bfe_u32 s35, s32, 0x10006
  s_lshl_b32 s35, s35, 2
  s_add_u32 s47, s46, s35
  s_and_b32 s50, s32, 63
  s_add_u32 s50, s50, 1
  s_waitcnt lgkmcnt(0)
  s_barrier
  s_waitcnt vmcnt(1)
  s_branch L_ffn2_run
L_ffn2_w22:
  v_mfma_f32_16x16x32_bf16 v[16:19], a[132:135], v[56:59], v[16:19]
  ds_read_b128 v[48:51], v10 offset:26624
  v_mfma_f32_16x16x32_bf16 v[24:27], a[136:139], v[56:59], v[24:27]
  s_add_u32 m0, s34, 0
  s_add_u32 s35, s33, 0
  buffer_load_dwordx4 v1, s[4:7], s35 offen offset:0 sc1 lds
  v_mfma_f32_16x16x32_bf16 v[32:35], a[140:143], v[56:59], v[32:35]
  v_mfma_f32_16x16x32_bf16 v[20:23], a[132:135], v[60:63], v[20:23]
  ds_read_b128 v[52:55], v10 offset:26880
  v_mfma_f32_16x16x32_bf16 v[28:31], a[136:139], v[60:63], v[28:31]
  v_mfma_f32_16x16x32_bf16 v[36:39], a[140:143], v[60:63], v[36:39]
  s_waitcnt lgkmcnt(2)
  v_mfma_f32_16x16x32_bf16 v[16:19], a[144:147], v[40:43], v[16:19]
  ds_read_b128 v[56:59], v10 offset:28672
  v_mfma_f32_16x16x32_bf16 v[24:27], a[148:151], v[40:43], v[24:27]
  buffer_load_dwordx4 v1, s[4:7], s35 offen offset:1024 sc1 lds
  v_mfma_f32_16x16x32_bf16 v[32:35], a[152:155], v[40:43], v[32:35]
  v_mfma_f32_16x16x32_bf16 v[20:23], a[144:147], v[44:47], v[20:23]
  ds_read_b128 v[60:63], v10 offset:28928
  v_mfma_f32_16x16x32_bf16 v[28:31], a[148:151], v[44:47], v[28:31]
  v_mfma_f32_16x16x32_bf16 v[36:39], a[152:155], v[44:47], v[36:39]
  s_waitcnt lgkmcnt(2)
  v_mfma_f32_16x16x32_bf16 v[16:19], a[156:159], v[48:51], v[16:19]
  ds_read_b128 v[40:43], v10 offset:30720
  v_mfma_f32_16x16x32_bf16 v[24:27], a[160:163], v[48:51], v[24:27]
  buffer_load_dwordx4 v1, s[4:7], s35 offen offset:2048 sc1 lds
  v_mfma_f32_16x16x32_bf16 v[32:35], a[164:167], v[48:51], v[32:35]
  v_mfma_f32_16x16x32_bf16 v[20:23], a[156:159], v[52:55], v[20:23]
  ds_read_b128 v[44:47], v10 offset:30976
  v_mfma_f32_16x16x32_bf16 v[28:31], a[160:163], v[52:55], v[28:31]
  v_mfma_f32_16x16x32_bf16 v[36:39], a[164:167], v[52:55], v[36:39]
  s_waitcnt lgkmcnt(2)
  v_mfma_f32_16x16x32_bf16 v[16:19], a[168:171], v[56:59], v[16:19]
  ds_read_b128 v[48:51], v10 offset:32768
  v_mfma_f32_16x16x32_bf16 v[24:27], a[172:175], v[56:59], v[24:27]
  buffer_load_dwordx4 v1, s[4:7], s35 offen offset:3072 sc1 lds
  v_mfma_f32_16x16x32_bf16 v[32:35], a[176:179], v[56:59], v[32:35]
  v_mfma_f32_16x16x32_bf16 v[20:23], a[168:171], v[60:63], v[20:23]
  ds_read_b128 v[52:55], v10 offset:33024
  v_mfma_f32_16x16x32_bf16 v[28:31], a[172:175], v[60:63], v[28:31]
  v_mfma_f32_16x16x32_bf16 v[36:39], a[176:179], v[60:63], v[36:39]
  s_waitcnt lgkmcnt(2)
  v_mfma_f32_16x16x32_bf16 v[16:19], a[180:183], v[40:43], v[16:19]
  ds_read_b128 v[56:59], v10 offset:34816
  v_mfma_f32_16x16x32_bf16 v[24:27], a[184:187], v[40:43], v[24:27]
  s_add_u32 m0, s34, 4096
  s_add_u32 s35, s33, 4096
  buffer_load_dwordx4 v1, s[4:7], s35 offen offset:0 sc1 lds
  v_mfma_f32_16x16x32_bf16 v[32:35], a[188:191], v[40:43], v[32:35]
  v_mfma_f32_16x16x32_bf16 v[20:23], a[180:183], v[44:47], v[20:23]
  ds_read_b128 v[60:63], v10 offset:35072
  v_mfma_f32_16x16x32_bf16 v[28:31], a[184:187], v[44:47], v[28:31]
  v_mfma_f32_16x16x32_bf16 v[36:39], a[188:191], v[44:47], v[36:39]
  s_waitcnt lgkmcnt(2)
  v_mfma_f32_16x16x32_bf16 v[16:19], a[192:195], v[48:51], v[16:19]
  ds_read_b128 v[40:43], v11 offset:0
  v_mfma_f32_16x16x32_bf16 v[24:27], a[196:199], v[48:51], v[24:27]
  buffer_load_dwordx4 v1, s[4:7], s35 offen offset:1024 sc1 lds
  v_mfma_f32_16x16x32_bf16 v[32:35], a[200:203], v[48:51], v[32:35]
  v_mfma_f32_16x16x32_bf16 v[20:23], a[192:195], v[52:55], v[20:23]
  ds_read_b128 v[44:47], v11 offset:256
  v_mfma_f32_16x16x32_bf16 v[28:31], a[196:199], v[52:55], v[28:31]
  v_mfma_f32_16x16x32_bf16 v[36:39], a[200:203], v[52:55], v[36:39]
  s_waitcnt lgkmcnt(2)
  v_mfma_f32_16x16x32_bf16 v[16:19], a[204:207], v[56:59], v[16:19]
  ds_read_b128 v[48:51], v11 offset:2048
  v_mfma_f32_16x16x32_bf16 v[24:27], a[208:211], v[56:59], v[24:27]
  buffer_load_dwordx4 v1, s[4:7], s35 offen offset:2048 sc1 lds
  v_mfma_f32_16x16x32_bf16 v[32:35], a[212:215], v[56:59], v[32:35]
  v_mfma_f32_16x16x32_bf16 v[20:23], a[204:207], v[60:63], v[20:23]
  ds_read_b128 v[52:55], v11 offset:2304
  v_mfma_f32_16x16x32_bf16 v[28:31], a[208:211], v[60:63], v[28:31]
  v_mfma_f32_16x16x32_bf16 v[36:39], a[212:215], v[60:63], v[36:39]
  s_waitcnt lgkmcnt(2)
  v_mfma_f32_16x16x32_bf16 v[16:19], a[216:219], v[40:43], v[16:19]
  ds_read_b128 v[56:59], v11 offset:4096
  v_mfma_f32_16x16x32_bf16 v[24:27], a[220:223], v[40:43], v[24:27]
  buffer_load_dwordx4 v1, s[4:7], s35 offen offset:3072 sc1 lds
  v_mfma_f32_16x16x32_bf16 v[32:35], a[224:227], v[40:43], v[32:35]
  v_mfma_f32_16x16x32_bf16 v[20:23], a[216:219], v[44:47], v[20:23]
  ds_read_b128 v[60:63], v11 offset:4352
  v_mfma_f32_16x16x32_bf16 v[28:31], a[220:223], v[44:47], v[28:31]
  v_mfma_f32_16x16x32_bf16 v[36:39], a[224:227], v[44:47], v[36:39]
  s_waitcnt lgkmcnt(2)
  v_mfma_f32_16x16x32_bf16 v[16:19], a[228:231], v[48:51], v[16:19]
  ds_read_b128 v[40:43], v11 offset:6144
  v_mfma_f32_16x16x32_bf16 v[24:27], a[232:235], v[48:51], v[24:27]
  s_add_u32 m0, s34, 8192
  s_add_u32 s35, s33, 8192
  buffer_load_dwordx4 v1, s[4:7], s35 offen offset:0 sc1 lds
  v_mfma_f32_16x16x32_bf16 v[32:35], a[236:239], v[48:51], v[32:35]
  v_mfma_f32_16x16x32_bf16 v[20:23], a[228:231], v[52:55], v[20:23]
  ds_read_b128 v[44:47], v11 offset:6400
  v_mfma_f32_16x16x32_bf16 v[28:31], a[232:235], v[52:55], v[28:31]
  v_mfma_f32_16x16x32_bf16 v[36:39], a[236:239], v[52:55], v[36:39]
  s_waitcnt lgkmcnt(2)
  v_mfma_f32_16x16x32_bf16 v[16:19], a[240:243], v[56:59], v[16:19]
  ds_read_b128 v[48:51], v11 offset:8192
  v_mfma_f32_16x16x32_bf16 v[24:27], a[244:247], v[56:59], v[24:27]
  buffer_load_dwordx4 v1, s[4:7], s35 offen offset:1024 sc1 lds
  v_mfma_f32_16x16x32_bf16 v[32:35], a[248:251], v[56:59], v[32:35]
  v_mfma_f32_16x16x32_bf16 v[20:23], a[240:243], v[60:63], v[20:23]
  ds_read_b128 v[52:55], v11 offset:8448
  v_mfma_f32_16x16x32_bf16 v[28:31], a[244:247], v[60:63], v[28:31]
  v_mfma_f32_16x16x32_bf16 v[36:39], a[248:251], v[60:63], v[36:39]
  s_waitcnt lgkmcnt(2)
  v_mfma_f32_16x16x32_bf16 v[16:19], a[252:255], v[40:43], v[16:19]
  ds_read_b128 v[56:59], v11 offset:10240
  v_mfma_f32_16x16x32_bf16 v[24:27], v[80:83], v[40:43], v[24:27]
  buffer_load_dwordx4 v1, s[4:7], s35 offen offset:2048 sc1 lds
  v_mfma_f32_16x16x32_bf16 v[32:35], v[84:87], v[40:43], v[32:35]
  v_mfma_f32_16x16x32_bf16 v[20:23], a[252:255], v[44:47], v[20:23]
  ds_read_b128 v[60:63], v11 offset:10496
  v_mfma_f32_16x16x32_bf16 v[28:31], v[80:83], v[44:47], v[28:31]
  v_mfma_f32_16x16x32_bf16 v[36:39], v[84:87], v[44:47], v[36:39]
  s_waitcnt lgkmcnt(2)
  v_mfma_f32_16x16x32_bf16 v[16:19], v[88:91], v[48:51], v[16:19]
  ds_read_b128 v[40:43], v11 offset:12288
  v_mfma_f32_16x16x32_bf16 v[24:27], v[92:95], v[48:51], v[24:27]
  buffer_load_dwordx4 v1, s[4:7], s35 offen offset:3072 sc1 lds
  v_mfma_f32_16x16x32_bf16 v[32:35], v[96:99], v[48:51], v[32:35]
  v_mfma_f32_16x16x32_bf16 v[20:23], v[88:91], v[52:55], v[20:23]
  ds_read_b128 v[44:47], v11 offset:12544
  v_mfma_f32_16x16x32_bf16 v[28:31], v[92:95], v[52:55], v[28:31]
  v_mfma_f32_16x16x32_bf16 v[36:39], v[96:99], v[52:55], v[36:39]
  s_waitcnt lgkmcnt(2)
  v_mfma_f32_16x16x32_bf16 v[16:19], v[100:103], v[56:59], v[16:19]
  ds_read_b128 v[48:51], v11 offset:14336
  v_mfma_f32_16x16x32_bf16 v[24:27], v[104:107], v[56:59], v[24:27]
  s_add_u32 m0, s34, 12288
  s_add_u32 s35, s33, 12288
  buffer_load_dwordx4 v1, s[4:7], s35 offen offset:0 sc1 lds
  v_mfma_f32_16x16x32_bf16 v[32:35], v[108:111], v[56:59], v[32:35]
  v_mfma_f32_16x16x32_bf16 v[20:23], v[100:103], v[60:63], v[20:23]
  ds_read_b128 v[52:55], v11 offset:14592
  v_mfma_f32_16x16x32_bf16 v[28:31], v[104:107], v[60:63], v[28:31]
  v_mfma_f32_16x16x32_bf16 v[36:39], v[108:111], v[60:63], v[36:39]
  s_waitcnt lgkmcnt(2)
  v_mfma_f32_16x16x32_bf16 v[16:19], v[112:115], v[40:43], v[16:19]
  ds_read_b128 v[56:59], v11 offset:16384
  v_mfma_f32_16x16x32_bf16 v[24:27], v[116:119], v[40:43], v[24:27]
  buffer_load_dwordx4 v1, s[4:7], s35 offen offset:1024 sc1 lds
  v_mfma_f32_16x16x32_bf16 v[32:35], v[120:123], v[40:43], v[32:35]
  v_mfma_f32_16x16x32_bf16 v[20:23], v[112:115], v[44:47], v[20:23]
  ds_read_b128 v[60:63], v11 offset:16640
  v_mfma_f32_16x16x32_bf16 v[28:31], v[116:119], v[44:47], v[28:31]
  v_mfma_f32_16x16x32_bf16 v[36:39], v[120:123], v[44:47], v[36:39]
  s_waitcnt lgkmcnt(2)
  v_mfma_f32_16x16x32_bf16 v[16:19], v[124:127], v[48:51], v[16:19]
  ds_read_b128 v[40:43], v11 offset:18432
  v_mfma_f32_16x16x32_bf16 v[24:27], v[128:131], v[48:51], v[24:27]
  buffer_load_dwordx4 v1, s[4:7], s35 offen offset:2048 sc1 lds
  v_mfma_f32_16x16x32_bf16 v[32:35], v[132:135], v[48:51], v[32:35]
  v_mfma_f32_16x16x32_bf16 v[20:23], v[124:127], v[52:55], v[20:23]
  ds_read_b128 v[44:47], v11 offset:18688
  v_mfma_f32_16x16x32_bf16 v[28:31], v[128:131], v[52:55], v[28:31]
  v_mfma_f32_16x16x32_bf16 v[36:39], v[132:135], v[52:55], v[36:39]
  s_waitcnt lgkmcnt(2)
  v_mfma_f32_16x16x32_bf16 v[16:19], v[136:139], v[56:59], v[16:19]
  ds_read_b128 v[48:51], v11 offset:20480
  v_mfma_f32_16x16x32_bf16 v[24:27], v[140:143], v[56:59], v[24:27]
  buffer_load_dwordx4 v1, s[4:7], s35 offen offset:3072 sc1 lds
  v_mfma_f32_16x16x32_bf16 v[32:35], v[144:147], v[56:59], v[32:35]
  v_mfma_f32_16x16x32_bf16 v[20:23], v[136:139], v[60:63], v[20:23]
  ds_read_b128 v[52:55], v11 offset:20736
  v_mfma_f32_16x16x32_bf16 v[28:31], v[140:143], v[60:63], v[28:31]
  v_mfma_f32_16x16x32_bf16 v[36:39], v[144:147], v[60:63], v[36:39]
  s_waitcnt lgkmcnt(2)
  v_mfma_f32_16x16x32_bf16 v[16:19], v[148:151], v[40:43], v[16:19]
  ds_read_b128 v[56:59], v11 offset:22528
  v_mfma_f32_16x16x32_bf16 v[24:27], v[152:155], v[40:43], v[24:27]
  s_add_u32 m0, s34, 16384
  s_add_u32 s35, s33, 16384
  buffer_load_dwordx4 v1, s[4:7], s35 offen offset:0 sc1 lds
  v_mfma_f32_16x16x32_bf16 v[32:35], v[156:159], v[40:43], v[32:35]
  v_mfma_f32_16x16x32_bf16 v[20:23], v[148:151], v[44:47], v[20:23]
  ds_read_b128 v[60:63], v11 offset:22784
  v_mfma_f32_16x16x32_bf16 v[28:31], v[152:155], v[44:47], v[28:31]
  v_mfma_f32_16x16x32_bf16 v[36:39], v[156:159], v[44:47], v[36:39]
  s_waitcnt lgkmcnt(2)
  v_mfma_f32_16x16x32_bf16 v[16:19], v[160:163], v[48:51], v[16:19]
  ds_read_b128 v[40:43], v11 offset:24576
  v_mfma_f32_16x16x32_bf16 v[24:27], v[164:167], v[48:51], v[24:27]
  buffer_load_dwordx4 v1, s[4:7], s35 offen offset:1024 sc1 lds
  v_mfma_f32_16x16x32_bf16 v[32:35], v[168:171], v[48:51], v[32:35]
  v_mfma_f32_16x16x32_bf16 v[20:23], v[160:163], v[52:55], v[20:23]
  ds_read_b128 v[44:47], v11 offset:24832
  v_mfma_f32_16x16x32_bf16 v[28:31], v[164:167], v[52:55], v[28:31]
  v_mfma_f32_16x16x32_bf16 v[36:39], v[168:171], v[52:55], v[36:39]
  s_waitcnt lgkmcnt(2)
  v_mfma_f32_16x16x32_bf16 v[16:19], v[172:175], v[56:59], v[16:19]
  ds_read_b128 v[48:51], v11 offset:26624
  v_mfma_f32_16x16x32_bf16 v[24:27], v[176:179], v[56:59], v[24:27]
  v_mfma_f32_16x16x32_bf16 v[32:35], v[180:183], v[56:59], v[32:35]
  v_mfma_f32_16x16x32_bf16 v[20:23], v[172:175], v[60:63], v[20:23]
  ds_read_b128 v[52:55], v11 offset:26880
  v_mfma_f32_16x16x32_bf16 v[28:31], v[176:179], v[60:63], v[28:31]
  v_mfma_f32_16x16x32_bf16 v[36:39], v[180:183], v[60:63], v[36:39]
  s_waitcnt lgkmcnt(2)
  v_mfma_f32_16x16x32_bf16 v[16:19], v[184:187], v[40:43], v[16:19]
  ds_read_b128 v[56:59], v11 offset:28672
  v_mfma_f32_16x16x32_bf16 v[24:27], v[188:191], v[40:43], v[24:27]
  v_mfma_f32_16x16x32_bf16 v[32:35], v[192:195], v[40:43], v[32:35]
  v_mfma_f32_16x16x32_bf16 v[20:23], v[184:187], v[44:47], v[20:23]
  ds_read_b128 v[60:63], v11 offset:28928
  v_mfma_f32_16x16x32_bf16 v[28:31], v[188:191], v[44:47], v[28:31]
  s_mov_b64 exec, s[48:49]
  buffer_load_dword v9, v7, s[4:7], 0 offen sc1
  s_mov_b64 exec, -1
  v_mfma_f32_16x16x32_bf16 v[36:39], v[192:195], v[44:47], v[36:39]
  s_waitcnt lgkmcnt(2)
  v_mfma_f32_16x16x32_bf16 v[16:19], v[196:199], v[48:51], v[16:19]
  ds_read_b128 v[40:43], v11 offset:30720
  v_mfma_f32_16x16x32_bf16 v[24:27], v[200:203], v[48:51], v[24:27]
  v_mfma_f32_16x16x32_bf16 v[32:35], v[204:207], v[48:51], v[32:35]
  v_mfma_f32_16x16x32_bf16 v[20:23], v[196:199], v[52:55], v[20:23]
  ds_read_b128 v[44:47], v11 offset:30976
  v_mfma_f32_16x16x32_bf16 v[28:31], v[200:203], v[52:55], v[28:31]
  v_mfma_f32_16x16x32_bf16 v[36:39], v[204:207], v[52:55], v[36:39]
  s_waitcnt lgkmcnt(2)
  v_mfma_f32_16x16x32_bf16 v[16:19], v[208:211], v[56:59], v[16:19]
  ds_read_b128 v[48:51], v11 offset:32768
  v_mfma_f32_16x16x32_bf16 v[24:27], v[212:215], v[56:59], v[24:27]
  v_mfma_f32_16x16x32_bf16 v[32:35], v[216:219], v[56:59], v[32:35]
  v_mfma_f32_16x16x32_bf16 v[20:23], v[208:211], v[60:63], v[20:23]
  ds_read_b128 v[52:55], v11 offset:33024
  v_mfma_f32_16x16x32_bf16 v[28:31], v[212:215], v[60:63], v[28:31]
  v_mfma_f32_16x16x32_bf16 v[36:39], v[216:219], v[60:63], v[36:39]
  s_waitcnt lgkmcnt(2)
  v_mfma_f32_16x16x32_bf16 v[16:19], v[220:223], v[40:43], v[16:19]
  ds_read_b128 v[56:59], v11 offset:34816
  v_mfma_f32_16x16x32_bf16 v[24:27], v[224:227], v[40:43], v[24:27]
  v_mfma_f32_16x16x32_bf16 v[32:35], v[228:231], v[40:43], v[32:35]
  v_mfma_f32_16x16x32_bf16 v[20:23], v[220:223], v[44:47], v[20:23]
  ds_read_b128 v[60:63], v11 offset:35072
  v_mfma_f32_16x16x32_bf16 v[28:31], v[224:227], v[44:47], v[28:31]
  v_mfma_f32_16x16x32_bf16 v[36:39], v[228:231], v[44:47], v[36:39]
  s_waitcnt lgkmcnt(2)
  v_mfma_f32_16x16x32_bf16 v[16:19], v[232:235], v[48:51], v[16:19]
  v_mfma_f32_16x16x32_bf16 v[24:27], v[236:239], v[48:51], v[24:27]
  v_mfma_f32_16x16x32_bf16 v[32:35], v[240:243], v[48:51], v[32:35]
  v_mfma_f32_16x16x32_bf16 v[20:23], v[232:235], v[52:55], v[20:23]
  v_mfma_f32_16x16x32_bf16 v[28:31], v[236:239], v[52:55], v[28:31]
  v_mfma_f32_16x16x32_bf16 v[36:39], v[240:243], v[52:55], v[36:39]
  s_waitcnt lgkmcnt(0)
  v_mfma_f32_16x16x32_bf16 v[16:19], v[244:247], v[56:59], v[16:19]
  v_mfma_f32_16x16x32_bf16 v[24:27], v[248:251], v[56:59], v[24:27]
  v_mfma_f32_16x16x32_bf16 v[32:35], v[252:255], v[56:59], v[32:35]
  v_mfma_f32_16x16x32_bf16 v[20:23], v[244:247], v[60:63], v[20:23]
  v_mfma_f32_16x16x32_bf16 v[28:31], v[248:251], v[60:63], v[28:31]
  v_mfma_f32_16x16x32_bf16 v[36:39], v[252:255], v[60:63], v[36:39]
  v_cvt_pk_bf16_f32 v40, v16, v17
  v_cvt_pk_bf16_f32 v41, v18, v19
  v_cvt_pk_bf16_f32 v42, v20, v21
  v_cvt_pk_bf16_f32 v43, v22, v23
  ds_write_b128 v3, v[40:43] offset:0
  v_cvt_pk_bf16_f32 v44, v24, v25
  v_cvt_pk_bf16_f32 v45, v26, v27
  v_cvt_pk_bf16_f32 v46, v28, v29
  v_cvt_pk_bf16_f32 v47, v30, v31
  ds_write_b128 v3, v[44:47] offset:64
  v_cvt_pk_bf16_f32 v48, v32, v33
  v_cvt_pk_bf16_f32 v49, v34, v35
  v_cvt_pk_bf16_f32 v50, v36, v37
  v_cvt_pk_bf16_f32 v51, v38, v39
  ds_write_b128 v3, v[48:51] offset:128
  s_mov_b32 s38, s37
  v_add_u32 v10, s45, v10
  v_add_u32 v11, s45, v11
  s_sub_u32 s45, 0, s45
  s_bfe_u32 s35, s32, 0x10006
  s_lshl_b32 s35, s35, 2
  s_add_u32 s47, s46, s35
  s_and_b32 s50, s32, 63
  s_add_u32 s50, s50, 1
  s_waitcnt lgkmcnt(0)
  s_barrier
  s_waitcnt vmcnt(1)
  s_branch L_ffn2_run
L_ffn2_w36:
  v_mfma_f32_16x16x32_bf16 v[16:19], a[216:219], v[40:43], v[16:19]
  ds_read_b128 v[56:59], v11 offset:4096
  v_mfma_f32_16x16x32_bf16 v[24:27], a[220:223], v[40:43], v[24:27]
  s_add_u32 m0, s34, 0
  s_add_u32 s35, s33, 0
  buffer_load_dwordx4 v1, s[4:7], s35 offen offset:0 sc1 lds
  v_mfma_f32_16x16x32_bf16 v[32:35], a[224:227], v[40:43], v[32:35]
  v_mfma_f32_16x16x32_bf16 v[20:23], a[216:219], v[44:47], v[20:23]
  ds_read_b128 v[60:63], v11 offset:4352
  v_mfma_f32_16x16x32_bf16 v[28:31], a[220:223], v[44:47], v[28:31]
  v_mfma_f32_16x16x32_bf16 v[36:39], a[224:227], v[44:47], v[36:39]
  s_waitcnt lgkmcnt(2)
  v_mfma_f32_16x16x32_bf16 v[16:19], a[228:231], v[48:51], v[16:19]
  ds_read_b128 v[40:43], v11 offset:6144
  v_mfma_f32_16x16x32_bf16 v[24:27], a[232:235], v[48:51], v[24:27]
  buffer_load_dwordx4 v1, s[4:7], s35 offen offset:1024 sc1 lds
  v_mfma_f32_16x16x32_bf16 v[32:35], a[236:239], v[48:51], v[32:35]
  v_mfma_f32_16x16x32_bf16 v[20:23], a[228:231], v[52:55], v[20:23]
  ds_read_b128 v[44:47], v11 offset:6400
  v_mfma_f32_16x16x32_bf16 v[28:31], a[232:235], v[52:55], v[28:31]
  v_mfma_f32_16x16x32_bf16 v[36:39], a[236:239], v[52:55], v[36:39]
  s_waitcnt lgkmcnt(2)
  v_mfma_f32_16x16x32_bf16 v[16:19], a[240:243], v[56:59], v[16:19]
  ds_read_b128 v[48:51], v11 offset:8192
  v_mfma_f32_16x16x32_bf16 v[24:27], a[244:247], v[56:59], v[24:27]
  buffer_load_dwordx4 v1, s[4:7], s35 offen offset:2048 sc1 lds
  v_mfma_f32_16x16x32_bf16 v[32:35], a[248:251], v[56:59], v[32:35]
  v_mfma_f32_16x16x32_bf16 v[20:23], a[240:243], v[60:63], v[20:23]
  ds_read_b128 v[52:55], v11 offset:8448
  v_mfma_f32_16x16x32_bf16 v[28:31], a[244:247], v[60:63], v[28:31]
  v_mfma_f32_16x16x32_bf16 v[36:39], a[248:251], v[60:63], v[36:39]
  s_waitcnt lgkmcnt(2)
  v_mfma_f32_16x16x32_bf16 v[16:19], a[252:255], v[40:43], v[16:19]
  ds_read_b128 v[56:59], v11 offset:10240
  v_mfma_f32_16x16x32_bf16 v[24:27], v[80:83], v[40:43], v[24:27]
  buffer_load_dwordx4 v1, s[4:7], s35 offen offset:3072 sc1 lds
  v_mfma_f32_16x16x32_bf16 v[32:35], v[84:87], v[40:43], v[32:35]
  v_mfma_f32_16x16x32_bf16 v[20:23], a[252:255], v[44:47], v[20:23]
  ds_read_b128 v[60:63], v11 offset:10496
  v_mfma_f32_16x16x32_bf16 v[28:31], v[80:83], v[44:47], v[28:31]
  v_mfma_f32_16x16x32_bf16 v[36:39], v[84:87], v[44:47], v[36:39]
  s_waitcnt lgkmcnt(2)
  v_mfma_f32_16x16x32_bf16 v[16:19], v[88:91], v[48:51], v[16:19]
  ds_read_b128 v[40:43], v11 offset:12288
  v_mfma_f32_16x16x32_bf16 v[24:27], v[92:95], v[48:51], v[24:27]
  s_add_u32 m0, s34, 4096
  s_add_u32 s35, s33, 4096
  buffer_load_dwordx4 v1, s[4:7], s35 offen offset:0 sc1 lds
  v_mfma_f32_16x16x32_bf16 v[32:35], v[96:99], v[48:51], v[32:35]
  v_mfma_f32_16x16x32_bf16 v[20:23], v[88:91], v[52:55], v[20:23]
  ds_read_b128 v[44:47], v11 offset:12544
  v_mfma_f32_16x16x32_bf16 v[28:31], v[92:95], v[52:55], v[28:31]
  v_mfma_f32_16x16x32_bf16 v[36:39], v[96:99], v[52:55], v[36:39]
  s_waitcnt lgkmcnt(2)
  v_mfma_f32_16x16x32_bf16 v[16:19], v[100:103], v[56:59], v[16:19]
  ds_read_b128 v[48:51], v11 offset:14336
  v_mfma_f32_16x16x32_bf16 v[24:27], v[104:107], v[56:59], v[24:27]
  buffer_load_dwordx4 v1, s[4:7], s35 offen offset:1024 sc1 lds
  v_mfma_f32_16x16x32_bf16 v[32:35], v[108:111], v[56:59], v[32:35]
  v_mfma_f32_16x16x32_bf16 v[20:23], v[100:103], v[60:63], v[20:23]
  ds_read_b128 v[52:55], v11 offset:14592
  v_mfma_f32_16x16x32_bf16 v[28:31], v[104:107], v[60:63], v[28:31]
  v_mfma_f32_16x16x32_bf16 v[36:39], v[108:111], v[60:63], v[36:39]
  s_waitcnt lgkmcnt(2)
  v_mfma_f32_16x16x32_bf16 v[16:19], v[112:115], v[40:43], v[16:19]
  ds_read_b128 v[56:59], v11 offset:16384
  v_mfma_f32_16x16x32_bf16 v[24:27], v[116:119], v[40:43], v[24:27]
  buffer_load_dwordx4 v1, s[4:7], s35 offen offset:2048 sc1 lds
  v_mfma_f32_16x16x32_bf16 v[32:35], v[120:123], v[40:43], v[32:35]
  v_mfma_f32_16x16x32_bf16 v[20:23], v[112:115], v[44:47], v[20:23]
  ds_read_b128 v[60:63], v11 offset:16640
  v_mfma_f32_16x16x32_bf16 v[28:31], v[116:119], v[44:47], v[28:31]
  v_mfma_f32_16x16x32_bf16 v[36:39], v[120:123], v[44:47], v[36:39]
  s_waitcnt lgkmcnt(2)
  v_mfma_f32_16x16x32_bf16 v[16:19], v[124:127], v[48:51], v[16:19]
  ds_read_b128 v[40:43], v11 offset:18432
  v_mfma_f32_16x16x32_bf16 v[24:27], v[128:131], v[48:51], v[24:27]
  buffer_load_dwordx4 v1, s[4:7], s35 offen offset:3072 sc1 lds
  v_mfma_f32_16x16x32_bf16 v[32:35], v[132:135], v[48:51], v[32:35]
  v_mfma_f32_16x16x32_bf16 v[20:23], v[124:127], v[52:55], v[20:23]
  ds_read_b128 v[44:47], v11 offset:18688
  v_mfma_f32_16x16x32_bf16 v[28:31], v[128:131], v[52:55], v[28:31]
  v_mfma_f32_16x16x32_bf16 v[36:39], v[132:135], v[52:55], v[36:39]
  s_waitcnt lgkmcnt(2)
  v_mfma_f32_16x16x32_bf16 v[16:19], v[136:139], v[56:59], v[16:19]
  ds_read_b128 v[48:51], v11 offset:20480
  v_mfma_f32_16x16x32_bf16 v[24:27], v[140:143], v[56:59], v[24:27]
  s_add_u32 m0, s34, 8192
  s_add_u32 s35, s33, 8192
  buffer_load_dwordx4 v1, s[4:7], s35 offen offset:0 sc1 lds
  v_mfma_f32_16x16x32_bf16 v[32:35], v[144:147], v[56:59], v[32:35]
  v_mfma_f32_16x16x32_bf16 v[20:23], v[136:139], v[60:63], v[20:23]
  ds_read_b128 v[52:55], v11 offset:20736
  v_mfma_f32_16x16x32_bf16 v[28:31], v[140:143], v[60:63], v[28:31]
  v_mfma_f32_16x16x32_bf16 v[36:39], v[144:147], v[60:63], v[36:39]
  s_waitcnt lgkmcnt(2)
  v_mfma_f32_16x16x32_bf16 v[16:19], v[148:151], v[40:43], v[16:19]
  ds_read_b128 v[56:59], v11 offset:22528
  v_mfma_f32_16x16x32_bf16 v[24:27], v[152:155], v[40:43], v[24:27]
  buffer_load_dwordx4 v1, s[4:7], s35 offen offset:1024 sc1 lds
  v_mfma_f32_16x16x32_bf16 v[32:35], v[156:159], v[40:43], v[32:35]
  v_mfma_f32_16x16x32_bf16 v[20:23], v[148:151], v[44:47], v[20:23]
  ds_read_b128 v[60:63], v11 offset:22784
  v_mfma_f32_16x16x32_bf16 v[28:31], v[152:155], v[44:47], v[28:31]
  v_mfma_f32_16x16x32_bf16 v[36:39], v[156:159], v[44:47], v[36:39]
  s_waitcnt lgkmcnt(2)
  v_mfma_f32_16x16x32_bf16 v[16:19], v[160:163], v[48:51], v[16:19]
  ds_read_b128 v[40:43], v11 offset:24576
  v_mfma_f32_16x16x32_bf16 v[24:27], v[164:167], v[48:51], v[24:27]
  buffer_load_dwordx4 v1, s[4:7], s35 offen offset:2048 sc1 lds
  v_mfma_f32_16x16x32_bf16 v[32:35], v[168:171], v[48:51], v[32:35]
  v_mfma_f32_16x16x32_bf16 v[20:23], v[160:163], v[52:55], v[20:23]
  ds_read_b128 v[44:47], v11 offset:24832
  v_mfma_f32_16x16x32_bf16 v[28:31], v[164:167], v[52:55], v[28:31]
  v_mfma_f32_16x16x32_bf16 v[36:39], v[168:171], v[52:55], v[36:39]
  s_waitcnt lgkmcnt(2)
  v_mfma_f32_16x16x32_bf16 v[16:19], v[172:175], v[56:59], v[16:19]
  ds_read_b128 v[48:51], v11 offset:26624
  v_mfma_f32_16x16x32_bf16 v[24:27], v[176:179], v[56:59], v[24:27]
  buffer_load_dwordx4 v1, s[4:7], s35 offen offset:3072 sc1 lds
  v_mfma_f32_16x16x32_bf16 v[32:35], v[180:183], v[56:59], v[32:35]
  v_mfma_f32_16x16x32_bf16 v[20:23], v[172:175], v[60:63], v[20:23]
  ds_read_b128 v[52:55], v11 offset:26880
  v_mfma_f32_16x16x32_bf16 v[28:31], v[176:179], v[60:63], v[28:31]
  v_mfma_f32_16x16x32_bf16 v[36:39], v[180:183], v[60:63], v[36:39]
  s_waitcnt lgkmcnt(2)
  v_mfma_f32_16x16x32_bf16 v[16:19], v[184:187], v[40:43], v[16:19]
  ds_read_b128 v[56:59], v11 offset:28672
  v_mfma_f32_16x16x32_bf16 v[24:27], v[188:191], v[40:43], v[24:27]
  s_add_u32 m0, s34, 12288
  s_add_u32 s35, s33, 12288
  buffer_load_dwordx4 v1, s[4:7], s35 offen offset:0 sc1 lds
  v_mfma_f32_16x16x32_bf16 v[32:35], v[192:195], v[40:43], v[32:35]
  v_mfma_f32_16x16x32_bf16 v[20:23], v[184:187], v[44:47], v[20:23]
  ds_read_b128 v[60:63], v11 offset:28928
  v_mfma_f32_16x16x32_bf16 v[28:31], v[188:191], v[44:47], v[28:31]
  s_mov_b64 exec, s[48:49]
  buffer_load_dword v9, v7, s[4:7], 0 offen sc1
  s_mov_b64 exec, -1
  v_mfma_f32_16x16x32_bf16 v[36:39], v[192:195], v[44:47], v[36:39]
  s_waitcnt lgkmcnt(2)
  v_mfma_f32_16x16x32_bf16 v[16:19], v[196:199], v[48:51], v[16:19]
  ds_read_b128 v[40:43], v11 offset:30720
  v_mfma_f32_16x16x32_bf16 v[24:27], v[200:203], v[48:51], v[24:27]
  buffer_load_dwordx4 v1, s[4:7], s35 offen offset:1024 sc1 lds
  v_mfma_f32_16x16x32_bf16 v[32:35], v[204:207], v[48:51], v[32:35]
  v_mfma_f32_16x16x32_bf16 v[20:23], v[196:199], v[52:55], v[20:23]
  ds_read_b128 v[44:47], v11 offset:30976
  v_mfma_f32_16x16x32_bf16 v[28:31], v[200:203], v[52:55], v[28:31]
  v_mfma_f32_16x16x32_bf16 v[36:39], v[204:207], v[52:55], v[36:39]
  s_waitcnt lgkmcnt(2)
  v_mfma_f32_16x16x32_bf16 v[16:19], v[208:211], v[56:59], v[16:19]
  ds_read_b128 v[48:51], v11 offset:32768
  v_mfma_f32_16x16x32_bf16 v[24:27], v[212:215], v[56:59], v[24:27]
  buffer_load_dwordx4 v1, s[4:7], s35 offen offset:2048 sc1 lds
  v_mfma_f32_16x16x32_bf16 v[32:35], v[216:219], v[56:59], v[32:35]
  v_mfma_f32_16x16x32_bf16 v[20:23], v[208:211], v[60:63], v[20:23]
  ds_read_b128 v[52:55], v11 offset:33024
  v_mfma_f32_16x16x32_bf16 v[28:31], v[212:215], v[60:63], v[28:31]
  v_mfma_f32_16x16x32_bf16 v[36:39], v[216:219], v[60:63], v[36:39]
  s_waitcnt lgkmcnt(2)
  v_mfma_f32_16x16x32_bf16 v[16:19], v[220:223], v[40:43], v[16:19]
  ds_read_b128 v[56:59], v11 offset:34816
  v_mfma_f32_16x16x32_bf16 v[24:27], v[224:227], v[40:43], v[24:27]
  buffer_load_dwordx4 v1, s[4:7], s35 offen offset:3072 sc1 lds
  v_mfma_f32_16x16x32_bf16 v[32:35], v[228:231], v[40:43], v[32:35]
  v_mfma_f32_16x16x32_bf16 v[20:23], v[220:223], v[44:47], v[20:23]
  ds_read_b128 v[60:63], v11 offset:35072
  v_mfma_f32_16x16x32_bf16 v[28:31], v[224:227], v[44:47], v[28:31]
  v_mfma_f32_16x16x32_bf16 v[36:39], v[228:231], v[44:47], v[36:39]
  s_waitcnt lgkmcnt(2)
  v_mfma_f32_16x16x32_bf16 v[16:19], v[232:235], v[48:51], v[16:19]
  v_mfma_f32_16x16x32_bf16 v[24:27], v[236:239], v[48:51], v[24:27]
  s_add_u32 m0, s34, 16384
  s_add_u32 s35, s33, 16384
  buffer_load_dwordx4 v1, s[4:7], s35 offen offset:0 sc1 lds
  v_mfma_f32_16x16x32_bf16 v[32:35], v[240:243], v[48:51], v[32:35]
  v_mfma_f32_16x16x32_bf16 v[20:23], v[232:235], v[52:55], v[20:23]
  v_mfma_f32_16x16x32_bf16 v[28:31], v[236:239], v[52:55], v[28:31]
  v_mfma_f32_16x16x32_bf16 v[36:39], v[240:243], v[52:55], v[36:39]
  s_waitcnt lgkmcnt(0)
  v_mfma_f32_16x16x32_bf16 v[16:19], v[244:247], v[56:59], v[16:19]
  v_mfma_f32_16x16x32_bf16 v[24:27], v[248:251], v[56:59], v[24:27]
  buffer_load_dwordx4 v1, s[4:7], s35 offen offset:1024 sc1 lds
  v_mfma_f32_16x16x32_bf16 v[32:35], v[252:255], v[56:59], v[32:35]
  v_mfma_f32_16x16x32_bf16 v[20:23], v[244:247], v[60:63], v[20:23]
  v_mfma_f32_16x16x32_bf16 v[28:31], v[248:251], v[60:63], v[28:31]
  v_mfma_f32_16x16x32_bf16 v[36:39], v[252:255], v[60:63], v[36:39]
  v_cvt_pk_bf16_f32 v40, v16, v17
  v_cvt_pk_bf16_f32 v41, v18, v19
  v_cvt_pk_bf16_f32 v42, v20, v21
  v_cvt_pk_bf16_f32 v43, v22, v23
  ds_write_b128 v3, v[40:43] offset:0
  v_cvt_pk_bf16_f32 v44, v24, v25
  v_cvt_pk_bf16_f32 v45, v26, v27
  v_cvt_pk_bf16_f32 v46, v28, v29
  v_cvt_pk_bf16_f32 v47, v30, v31
  ds_write_b128 v3, v[44:47] offset:64
  v_cvt_pk_bf16_f32 v48, v32, v33
  v_cvt_pk_bf16_f32 v49, v34, v35
  v_cvt_pk_bf16_f32 v50, v36, v37
  v_cvt_pk_bf16_f32 v51, v38, v39
  ds_write_b128 v3, v[48:51] offset:128
  s_mov_b32 s38, s37
  v_add_u32 v10, s45, v10
  v_add_u32 v11, s45, v11
  s_sub_u32 s45, 0, s45
  s_bfe_u32 s35, s32, 0x10006
  s_lshl_b32 s35, s35, 2
  s_add_u32 s47, s46, s35
  s_and_b32 s50, s32, 63
  s_add_u32 s50, s50, 1
  s_waitcnt lgkmcnt(0)
  s_barrier
  s_waitcnt vmcnt(0)
  s_branch L_ffn2_run
L_ffn2_w54:
  v_mfma_f32_16x16x32_bf16 v[16:19], v[148:151], v[40:43], v[16:19]
  ds_read_b128 v[56:59], v11 offset:22528
  v_mfma_f32_16x16x32_bf16 v[24:27], v[152:155], v[40:43], v[24:27]
  s_add_u32 m0, s34, 0
  s_add_u32 s35, s33, 0
  buffer_load_dwordx4 v1, s[4:7], s35 offen offset:0 sc1 lds
  v_mfma_f32_16x16x32_bf16 v[32:35], v[156:159], v[40:43], v[32:35]
  v_mfma_f32_16x16x32_bf16 v[20:23], v[148:151], v[44:47], v[20:23]
  ds_read_b128 v[60:63], v11 offset:22784
  v_mfma_f32_16x16x32_bf16 v[28:31], v[152:155], v[44:47], v[28:31]
  buffer_load_dwordx4 v1, s[4:7], s35 offen offset:1024 sc1 lds
  v_mfma_f32_16x16x32_bf16 v[36:39], v[156:159], v[44:47], v[36:39]
  s_waitcnt lgkmcnt(2)
  v_mfma_f32_16x16x32_bf16 v[16:19], v[160:163], v[48:51], v[16:19]
  ds_read_b128 v[40:43], v11 offset:24576
  v_mfma_f32_16x16x32_bf16 v[24:27], v[164:167], v[48:51], v[24:27]
  buffer_load_dwordx4 v1, s[4:7], s35 offen offset:2048 sc1 lds
  v_mfma_f32_16x16x32_bf16 v[32:35], v[168:171], v[48:51], v[32:35]
  v_mfma_f32_16x16x32_bf16 v[20:23], v[160:163], v[52:55], v[20:23]
  ds_read_b128 v[44:47], v11 offset:24832
  v_mfma_f32_16x16x32_bf16 v[28:31], v[164:167], v[52:55], v[28:31]
  buffer_load_dwordx4 v1, s[4:7], s35 offen offset:3072 sc1 lds
  v_mfma_f32_16x16x32_bf16 v[36:39], v[168:171], v[52:55], v[36:39]
  s_waitcnt lgkmcnt(2)
  v_mfma_f32_16x16x32_bf16 v[16:19], v[172:175], v[56:59], v[16:19]
  ds_read_b128 v[48:51], v11 offset:26624
  v_mfma_f32_16x16x32_bf16 v[24:27], v[176:179], v[56:59], v[24:27]
  s_add_u32 m0, s34, 4096
  s_add_u32 s35, s33, 4096
  buffer_load_dwordx4 v1, s[4:7], s35 offen offset:0 sc1 lds
  v_mfma_f32_16x16x32_bf16 v[32:35], v[180:183], v[56:59], v[32:35]
  v_mfma_f32_16x16x32_bf16 v[20:23], v[172:175], v[60:63], v[20:23]
  ds_read_b128 v[52:55], v11 offset:26880
  v_mfma_f32_16x16x32_bf16 v[28:31], v[176:179], v[60:63], v[28:31]
  buffer_load_dwordx4 v1, s[4:7], s35 offen offset:1024 sc1 lds
  v_mfma_f32_16x16x32_bf16 v[36:39], v[180:183], v[60:63], v[36:39]
  s_waitcnt lgkmcnt(2)
  v_mfma_f32_16x16x32_bf16 v[16:19], v[184:187], v[40:43], v[16:19]
  ds_read_b128 v[56:59], v11 offset:28672
  v_mfma_f32_16x16x32_bf16 v[24:27], v[188:191], v[40:43], v[24:27]
  buffer_load_dwordx4 v1, s[4:7], s35 offen offset:2048 sc1 lds
  v_mfma_f32_16x16x32_bf16 v[32:35], v[192:195], v[40:43], v[32:35]
  v_mfma_f32_16x16x32_bf16 v[20:23], v[184:187], v[44:47], v[20:23]
  ds_read_b128 v[60:63], v11 offset:28928
  v_mfma_f32_16x16x32_bf16 v[28:31], v[188:191], v[44:47], v[28:31]
  buffer_load_dwordx4 v1, s[4:7], s35 offen offset:3072 sc1 lds
  s_mov_b64 exec, s[48:49]
  buffer_load_dword v9, v7, s[4:7], 0 offen sc1
  s_mov_b64 exec, -1
  v_mfma_f32_16x16x32_bf16 v[36:39], v[192:195], v[44:47], v[36:39]
  s_waitcnt lgkmcnt(2)
  v_mfma_f32_16x16x32_bf16 v[16:19], v[196:199], v[48:51], v[16:19]
  ds_read_b128 v[40:43], v11 offset:30720
  v_mfma_f32_16x16x32_bf16 v[24:27], v[200:203], v[48:51], v[24:27]
  s_add_u32 m0, s34, 8192
  s_add_u32 s35, s33, 8192
  buffer_load_dwordx4 v1, s[4:7], s35 offen offset:0 sc1 lds
  v_mfma_f32_16x16x32_bf16 v[32:35], v[204:207], v[48:51], v[32:35]
  v_mfma_f32_16x16x32_bf16 v[20:23], v[196:199], v[52:55], v[20:23]
  ds_read_b128 v[44:47], v11 offset:30976
  v_mfma_f32_16x16x32_bf16 v[28:31], v[200:203], v[52:55], v[28:31]
  buffer_load_dwordx4 v1, s[4:7], s35 offen offset:1024 sc1 lds
  v_mfma_f32_16x16x32_bf16 v[36:39], v[204:207], v[52:55], v[36:39]
  s_waitcnt lgkmcnt(2)
  v_mfma_f32_16x16x32_bf16 v[16:19], v[208:211], v[56:59], v[16:19]
  ds_read_b128 v[48:51], v11 offset:32768
  v_mfma_f32_16x16x32_bf16 v[24:27], v[212:215], v[56:59], v[24:27]
  buffer_load_dwordx4 v1, s[4:7], s35 offen offset:2048 sc1 lds
  v_mfma_f32_16x16x32_bf16 v[32:35], v[216:219], v[56:59], v[32:35]
  v_mfma_f32_16x16x32_bf16 v[20:23], v[208:211], v[60:63], v[20:23]
  ds_read_b128 v[52:55], v11 offset:33024
  v_mfma_f32_16x16x32_bf16 v[28:31], v[212:215], v[60:63], v[28:31]
  buffer_load_dwordx4 v1, s[4:7], s35 offen offset:3072 sc1 lds
  v_mfma_f32_16x16x32_bf16 v[36:39], v[216:219], v[60:63], v[36:39]
  s_waitcnt lgkmcnt(2)
  v_mfma_f32_16x16x32_bf16 v[16:19], v[220:223], v[40:43], v[16:19]
  ds_read_b128 v[56:59], v11 offset:34816
  v_mfma_f32_16x16x32_bf16 v[24:27], v[224:227], v[40:43], v[24:27]
  s_add_u32 m0, s34, 12288
  s_add_u32 s35, s33, 12288
  buffer_load_dwordx4 v1, s[4:7], s35 offen offset:0 sc1 lds
  v_mfma_f32_16x16x32_bf16 v[32:35], v[228:231], v[40:43], v[32:35]
  v_mfma_f32_16x16x32_bf16 v[20:23], v[220:223], v[44:47], v[20:23]
  ds_read_b128 v[60:63], v11 offset:35072
  v_mfma_f32_16x16x32_bf16 v[28:31], v[224:227], v[44:47], v[28:31]
  buffer_load_dwordx4 v1, s[4:7], s35 offen offset:1024 sc1 lds
  v_mfma_f32_16x16x32_bf16 v[36:39], v[228:231], v[44:47], v[36:39]
  s_waitcnt lgkmcnt(2)
  v_mfma_f32_16x16x32_bf16 v[16:19], v[232:235], v[48:51], v[16:19]
  v_mfma_f32_16x16x32_bf16 v[24:27], v[236:239], v[48:51], v[24:27]
  buffer_load_dwordx4 v1, s[4:7], s35 offen offset:2048 sc1 lds
  v_mfma_f32_16x16x32_bf16 v[32:35], v[240:243], v[48:51], v[32:35]
  v_mfma_f32_16x16x32_bf16 v[20:23], v[232:235], v[52:55], v[20:23]
  v_mfma_f32_16x16x32_bf16 v[28:31], v[236:239], v[52:55], v[28:31]
  buffer_load_dwordx4 v1, s[4:7], s35 offen offset:3072 sc1 lds
  v_mfma_f32_16x16x32_bf16 v[36:39], v[240:243], v[52:55], v[36:39]
  s_waitcnt lgkmcnt(0)
  v_mfma_f32_16x16x32_bf16 v[16:19], v[244:247], v[56:59], v[16:19]
  v_mfma_f32_16x16x32_bf16 v[24:27], v[248:251], v[56:59], v[24:27]
  s_add_u32 m0, s34, 16384
  s_add_u32 s35, s33, 16384
  buffer_load_dwordx4 v1, s[4:7], s35 offen offset:0 sc1 lds
  v_mfma_f32_16x16x32_bf16 v[32:35], v[252:255], v[56:59], v[32:35]
  v_mfma_f32_16x16x32_bf16 v[20:23], v[244:247], v[60:63], v[20:23]
  v_mfma_f32_16x16x32_bf16 v[28:31], v[248:251], v[60:63], v[28:31]
  buffer_load_dwordx4 v1, s[4:7], s35 offen offset:1024 sc1 lds
  v_mfma_f32_16x16x32_bf16 v[36:39], v[252:255], v[60:63], v[36:39]
  v_cvt_pk_bf16_f32 v40, v16, v17
  v_cvt_pk_bf16_f32 v41, v18, v19
  v_cvt_pk_bf16_f32 v42, v20, v21
  v_cvt_pk_bf16_f32 v43, v22, v23
  ds_write_b128 v3, v[40:43] offset:0
  v_cvt_pk_bf16_f32 v44, v24, v25
  v_cvt_pk_bf16_f32 v45, v26, v27
  v_cvt_pk_bf16_f32 v46, v28, v29
  v_cvt_pk_bf16_f32 v47, v30, v31
  ds_write_b128 v3, v[44:47] offset:64
  v_cvt_pk_bf16_f32 v48, v32, v33
  v_cvt_pk_bf16_f32 v49, v34, v35
  v_cvt_pk_bf16_f32 v50, v36, v37
  v_cvt_pk_bf16_f32 v51, v38, v39
  ds_write_b128 v3, v[48:51] offset:128
  s_mov_b32 s38, s37
  v_add_u32 v10, s45, v10
  v_add_u32 v11, s45, v11
  s_sub_u32 s45, 0, s45
  s_bfe_u32 s35, s32, 0x10006
  s_lshl_b32 s35, s35, 2
  s_add_u32 s47, s46, s35
  s_and_b32 s50, s32, 63
  s_add_u32 s50, s50, 1
  s_waitcnt lgkmcnt(0)
  s_barrier
  s_waitcnt vmcnt(0)
  s_branch L_ffn2_run
L_fail_ffn2:
  s_mov_b64 exec, 1
  v_mov_b32 v0, 84
  v_mov_b32 v1, 1
  buffer_atomic_add v1, v0, s[20:23], 0 offen
  s_endpgm
L_wo:
  s_waitcnt vmcnt(0)
  s_barrier
  s_cmp_lg_u32 s24, 0
  s_cbranch_scc1 Lsi_24
  s_mov_b64 exec, 1
  v_mov_b32 v1, 128
  v_mov_b32 v2, 1
  buffer_atomic_add v2, v1, s[20:23], 0 offen
  s_mov_b64 exec, -1
Lsi_24:
  s_mov_b32 s8, s74
  s_and_b32 s9, s75, 0xffff
  s_mov_b32 s10, 0x480000
  s_mov_b32 s11, 0x20000
  s_mul_i32 s33, s29, 1179648
  s_mul_i32 s34, s62, 384
  s_add_u32 s33, s33, s34
  s_mul_i32 s34, s24, 96
  s_add_u32 s33, s33, s34
  v_add_u32 v8, 0, v0
  v_mul_u32_u24 v9, 43691, v8
  v_lshrrev_b32 v9, 18, v9
  v_mul_u32_u24 v14, 6, v9
  v_sub_u32 v14, v8, v14
  v_mul_u32_u24 v10, 1152, v9
  v_lshl_add_u32 v10, v14, 4, v10
  v_add_u32 v10, s33, v10
  v_add_u32 v8, 64, v0
  v_mul_u32_u24 v9, 43691, v8
  v_lshrrev_b32 v9, 18, v9
  v_mul_u32_u24 v14, 6, v9
  v_sub_u32 v14, v8, v14
  v_mul_u32_u24 v12, 1152, v9
  v_lshl_add_u32 v12, v14, 4, v12
  v_add_u32 v12, s33, v12
  v_add_u32 v8, 128, v0
  v_mul_u32_u24 v9, 43691, v8
  v_lshrrev_b32 v9, 18, v9
  v_mul_u32_u24 v14, 6, v9
  v_sub_u32 v14, v8, v14
  v_mul_u32_u24 v13, 1152, v9
  v_lshl_add_u32 v13, v14, 4, v13
  v_add_u32 v13, s33, v13
  s_mul_i32 s35, s24, 39936
  v_lshrrev_b32 v8, 5, v0
  v_lshlrev_b32 v8, 4, v8
  v_bfe_u32 v9, v0, 2, 3
  v_add_u32 v8, v8, v9
  v_mul_u32_u24 v11, 96, v8
  v_and_b32 v9, 3, v0
  v_lshl_add_u32 v11, v9, 3, v11
  v_add_u32 v11, s35, v11
  s_mov_b32 s36, 0
  s_add_u32 m0, s35, 0
  s_nop 0
  buffer_load_dwordx4 v10, s[8:11], s36 offen lds
  s_add_u32 m0, s35, 1024
  s_nop 0
  buffer_load_dwordx4 v12, s[8:11], s36 offen lds
  s_add_u32 m0, s35, 2048
  s_nop 0
  buffer_load_dwordx4 v13, s[8:11], s36 offen lds
  s_mov_b32 s36, 36864
  s_add_u32 m0, s35, 3072
  s_nop 0
  buffer_load_dwordx4 v10, s[8:11], s36 offen lds
  s_add_u32 m0, s35, 4096
  s_nop 0
  buffer_load_dwordx4 v12, s[8:11], s36 offen lds
  s_add_u32 m0, s35, 5120
  s_nop 0
  buffer_load_dwordx4 v13, s[8:11], s36 offen lds
  s_mov_b32 s36, 73728
  s_add_u32 m0, s35, 6144
  s_nop 0
  buffer_load_dwordx4 v10, s[8:11], s36 offen lds
  s_add_u32 m0, s35, 7168
  s_nop 0
  buffer_load_dwordx4 v12, s[8:11], s36 offen lds
  s_add_u32 m0, s35, 8192
  s_nop 0
  buffer_load_dwordx4 v13, s[8:11], s36 offen lds
  s_mov_b32 s36, 110592
  s_add_u32 m0, s35, 9216
  s_nop 0
  buffer_load_dwordx4 v10, s[8:11], s36 offen lds
  s_add_u32 m0, s35, 10240
  s_nop 0
  buffer_load_dwordx4 v12, s[8:11], s36 offen lds
  s_add_u32 m0, s35, 11264
  s_nop 0
  buffer_load_dwordx4 v13, s[8:11], s36 offen lds
  s_mov_b32 s36, 147456
  s_add_u32 m0, s35, 12288
  s_nop 0
  buffer_load_dwordx4 v10, s[8:11], s36 offen lds
  s_add_u32 m0, s35, 13312
  s_nop 0
  buffer_load_dwordx4 v12, s[8:11], s36 offen lds
  s_add_u32 m0, s35, 14336
  s_nop 0
  buffer_load_dwordx4 v13, s[8:11], s36 offen lds
  s_mov_b32 s36, 184320
  s_add_u32 m0, s35, 15360
  s_nop 0
  buffer_load_dwordx4 v10, s[8:11], s36 offen lds
  s_add_u32 m0, s35, 16384
  s_nop 0
  buffer_load_dwordx4 v12, s[8:11], s36 offen lds
  s_add_u32 m0, s35, 17408
  s_nop 0
  buffer_load_dwordx4 v13, s[8:11], s36 offen lds
  s_mov_b32 s36, 221184
  s_add_u32 m0, s35, 18432
  s_nop 0
  buffer_load_dwordx4 v10, s[8:11], s36 offen lds
  s_add_u32 m0, s35, 19456
  s_nop 0
  buffer_load_dwordx4 v12, s[8:11], s36 offen lds
  s_add_u32 m0, s35, 20480
  s_nop 0
  buffer_load_dwordx4 v13, s[8:11], s36 offen lds
  s_mov_b32 s36, 258048
  s_add_u32 m0, s35, 21504
  s_nop 0
  buffer_load_dwordx4 v10, s[8:11], s36 offen lds
  s_add_u32 m0, s35, 22528
  s_nop 0
  buffer_load_dwordx4 v12, s[8:11], s36 offen lds
  s_add_u32 m0, s35, 23552
  s_nop 0
  buffer_load_dwordx4 v13, s[8:11], s36 offen lds
  s_mov_b32 s36, 294912
  s_add_u32 m0, s35, 24576
  s_nop 0
  buffer_load_dwordx4 v10, s[8:11], s36 offen lds
  s_add_u32 m0, s35, 25600
  s_nop 0
  buffer_load_dwordx4 v12, s[8:11], s36 offen lds
  s_add_u32 m0, s35, 26624
  s_nop 0
  buffer_load_dwordx4 v13, s[8:11], s36 offen lds
  s_mov_b32 s36, 331776
  s_add_u32 m0, s35, 27648
  s_nop 0
  buffer_load_dwordx4 v10, s[8:11], s36 offen lds
  s_add_u32 m0, s35, 28672
  s_nop 0
  buffer_load_dwordx4 v12, s[8:11], s36 offen lds
  s_add_u32 m0, s35, 29696
  s_nop 0
  buffer_load_dwordx4 v13, s[8:11], s36 offen lds
  s_mov_b32 s36, 368640
  s_add_u32 m0, s35, 30720
  s_nop 0
  buffer_load_dwordx4 v10, s[8:11], s36 offen lds
  s_add_u32 m0, s35, 31744
  s_nop 0
  buffer_load_dwordx4 v12, s[8:11], s36 offen lds
  s_add_u32 m0, s35, 32768
  s_nop 0
  buffer_load_dwordx4 v13, s[8:11], s36 offen lds
  s_waitcnt vmcnt(30)
  ds_read_b64_tr_b16 a[0:1], v11 offset:0
  ds_read_b64_tr_b16 a[2:3], v11 offset:768
  ds_read_b64_tr_b16 a[4:5], v11 offset:32
  ds_read_b64_tr_b16 a[6:7], v11 offset:800
  ds_read_b64_tr_b16 a[8:9], v11 offset:64
  ds_read_b64_tr_b16 a[10:11], v11 offset:832
  s_waitcnt lgkmcnt(6)
  s_mov_b32 s36, 405504
  s_add_u32 m0, s35, 33792
  s_nop 0
  buffer_load_dwordx4 v10, s[8:11], s36 offen lds
  s_add_u32 m0, s35, 34816
  s_nop 0
  buffer_load_dwordx4 v12, s[8:11], s36 offen lds
  s_add_u32 m0, s35, 35840
  s_nop 0
  buffer_load_dwordx4 v13, s[8:11], s36 offen lds
  s_waitcnt vmcnt(30)
  ds_read_b64_tr_b16 a[12:13], v11 offset:3072
  ds_read_b64_tr_b16 a[14:15], v11 offset:3840
  ds_read_b64_tr_b16 a[16:17], v11 offset:3104
  ds_read_b64_tr_b16 a[18:19], v11 offset:3872
  ds_read_b64_tr_b16 a[20:21], v11 offset:3136
  ds_read_b64_tr_b16 a[22:23], v11 offset:3904
  s_waitcnt lgkmcnt(6)
  s_mov_b32 s36, 442368
  s_add_u32 m0, s35, 36864
  s_nop 0
  buffer_load_dwordx4 v10, s[8:11], s36 offen lds
  s_add_u32 m0, s35, 37888
  s_nop 0
  buffer_load_dwordx4 v12, s[8:11], s36 offen lds
  s_add_u32 m0, s35, 38912
  s_nop 0
  buffer_load_dwordx4 v13, s[8:11], s36 offen lds
  s_waitcnt vmcnt(30)
  ds_read_b64_tr_b16 a[24:25], v11 offset:6144
  ds_read_b64_tr_b16 a[26:27], v11 offset:6912
  ds_read_b64_tr_b16 a[28:29], v11 offset:6176
  ds_read_b64_tr_b16 a[30:31], v11 offset:6944
  ds_read_b64_tr_b16 a[32:33], v11 offset:6208
  ds_read_b64_tr_b16 a[34:35], v11 offset:6976
  s_waitcnt lgkmcnt(6)
  s_mov_b32 s36, 479232
  s_add_u32 m0, s35, 0
  s_nop 0
  buffer_load_dwordx4 v10, s[8:11], s36 offen lds
  s_add_u32 m0, s35, 1024
  s_nop 0
  buffer_load_dwordx4 v12, s[8:11], s36 offen lds
  s_add_u32 m0, s35, 2048
  s_nop 0
  buffer_load_dwordx4 v13, s[8:11], s36 offen lds
  s_waitcnt vmcnt(30)
  ds_read_b64_tr_b16 a[36:37], v11 offset:9216
  ds_read_b64_tr_b16 a[38:39], v11 offset:9984
  ds_read_b64_tr_b16 a[40:41], v11 offset:9248
  ds_read_b64_tr_b16 a[42:43], v11 offset:10016
  ds_read_b64_tr_b16 a[44:45], v11 offset:9280
  ds_read_b64_tr_b16 a[46:47], v11 offset:10048
  s_waitcnt lgkmcnt(6)
  s_mov_b32 s36, 516096
  s_add_u32 m0, s35, 3072
  s_nop 0
  buffer_load_dwordx4 v10, s[8:11], s36 offen lds
  s_add_u32 m0, s35, 4096
  s_nop 0
  buffer_load_dwordx4 v12, s[8:11], s36 offen lds
  s_add_u32 m0, s35, 5120
  s_nop 0
  buffer_load_dwordx4 v13, s[8:11], s36 offen lds
  s_waitcnt vmcnt(30)
  ds_read_b64_tr_b16 a[48:49], v11 offset:12288
  ds_read_b64_tr_b16 a[50:51], v11 offset:13056
  ds_read_b64_tr_b16 a[52:53], v11 offset:12320
  ds_read_b64_tr_b16 a[54:55], v11 offset:13088
  ds_read_b64_tr_b16 a[56:57], v11 offset:12352
  ds_read_b64_tr_b16 a[58:59], v11 offset:13120
  s_waitcnt lgkmcnt(6)
  s_mov_b32 s36, 552960
  s_add_u32 m0, s35, 6144
  s_nop 0
  buffer_load_dwordx4 v10, s[8:11], s36 offen lds
  s_add_u32 m0, s35, 7168
  s_nop 0
  buffer_load_dwordx4 v12, s[8:11], s36 offen lds
  s_add_u32 m0, s35, 8192
  s_nop 0
  buffer_load_dwordx4 v13, s[8:11], s36 offen lds
  s_waitcnt vmcnt(30)
  ds_read_b64_tr_b16 a[60:61], v11 offset:15360
  ds_read_b64_tr_b16 a[62:63], v11 offset:16128
  ds_read_b64_tr_b16 a[64:65], v11 offset:15392
  ds_read_b64_tr_b16 a[66:67], v11 offset:16160
  ds_read_b64_tr_b16 a[68:69], v11 offset:15424
  ds_read_b64_tr_b16 a[70:71], v11 offset:16192
  s_waitcnt lgkmcnt(6)
  s_mov_b32 s36, 589824
  s_add_u32 m0, s35, 9216
  s_nop 0
  buffer_load_dwordx4 v10, s[8:11], s36 offen lds
  s_add_u32 m0, s35, 10240
  s_nop 0
  buffer_load_dwordx4 v12, s[8:11], s36 offen lds
  s_add_u32 m0, s35, 11264
  s_nop 0
  buffer_load_dwordx4 v13, s[8:11], s36 offen lds
  s_waitcnt vmcnt(30)
  ds_read_b64_tr_b16 a[72:73], v11 offset:18432
  ds_read_b64_tr_b16 a[74:75], v11 offset:19200
  ds_read_b64_tr_b16 a[76:77], v11 offset:18464
  ds_read_b64_tr_b16 a[78:79], v11 offset:19232
  ds_read_b64_tr_b16 a[80:81], v11 offset:18496
  ds_read_b64_tr_b16 a[82:83], v11 offset:19264
  s_waitcnt lgkmcnt(6)
  s_mov_b32 s36, 626688
  s_add_u32 m0, s35, 12288
  s_nop 0
  buffer_load_dwordx4 v10, s[8:11], s36 offen lds
  s_add_u32 m0, s35, 13312
  s_nop 0
  buffer_load_dwordx4 v12, s[8:11], s36 offen lds
  s_add_u32 m0, s35, 14336
  s_nop 0
  buffer_load_dwordx4 v13, s[8:11], s36 offen lds
  s_waitcnt vmcnt(30)
  ds_read_b64_tr_b16 a[84:85], v11 offset:21504
  ds_read_b64_tr_b16 a[86:87], v11 offset:22272
  ds_read_b64_tr_b16 a[88:89], v11 offset:21536
  ds_read_b64_tr_b16 a[90:91], v11 offset:22304
  ds_read_b64_tr_b16 a[92:93], v11 offset:21568
  ds_read_b64_tr_b16 a[94:95], v11 offset:22336
  s_waitcnt lgkmcnt(6)
  s_mov_b32 s36, 663552
  s_add_u32 m0, s35, 15360
  s_nop 0
  buffer_load_dwordx4 v10, s[8:11], s36 offen lds
  s_add_u32 m0, s35, 16384
  s_nop 0
  buffer_load_dwordx4 v12, s[8:11], s36 offen lds
  s_add_u32 m0, s35, 17408
  s_nop 0
  buffer_load_dwordx4 v13, s[8:11], s36 offen lds
  s_waitcnt vmcnt(30)
  ds_read_b64_tr_b16 a[96:97], v11 offset:24576
  ds_read_b64_tr_b16 a[98:99], v11 offset:25344
  ds_read_b64_tr_b16 a[100:101], v11 offset:24608
  ds_read_b64_tr_b16 a[102:103], v11 offset:25376
  ds_read_b64_tr_b16 a[104:105], v11 offset:24640
  ds_read_b64_tr_b16 a[106:107], v11 offset:25408
  s_waitcnt lgkmcnt(6)
  s_mov_b32 s36, 700416
  s_add_u32 m0, s35, 18432
  s_nop 0
  buffer_load_dwordx4 v10, s[8:11], s36 offen lds
  s_add_u32 m0, s35, 19456
  s_nop 0
  buffer_load_dwordx4 v12, s[8:11], s36 offen lds
  s_add_u32 m0, s35, 20480
  s_nop 0
  buffer_load_dwordx4 v13, s[8:11], s36 offen lds
  s_waitcnt vmcnt(30)
  ds_read_b64_tr_b16 a[108:109], v11 offset:27648
  ds_read_b64_tr_b16 a[110:111], v11 offset:28416
  ds_read_b64_tr_b16 a[112:113], v11 offset:27680
  ds_read_b64_tr_b16 a[114:115], v11 offset:28448
  ds_read_b64_tr_b16 a[116:117], v11 offset:27712
  ds_read_b64_tr_b16 a[118:119], v11 offset:28480
  s_waitcnt lgkmcnt(6)
  s_mov_b32 s36, 737280
  s_add_u32 m0, s35, 21504
  s_nop 0
  buffer_load_dwordx4 v10, s[8:11], s36 offen lds
  s_add_u32 m0, s35, 22528
  s_nop 0
  buffer_load_dwordx4 v12, s[8:11], s36 offen lds
  s_add_u32 m0, s35, 23552
  s_nop 0
  buffer_load_dwordx4 v13, s[8:11], s36 offen lds
  s_waitcnt vmcnt(30)
  ds_read_b64_tr_b16 a[120:121], v11 offset:30720
  ds_read_b64_tr_b16 a[122:123], v11 offset:31488
  ds_read_b64_tr_b16 a[124:125], v11 offset:30752
  ds_read_b64_tr_b16 a[126:127], v11 offset:31520
  ds_read_b64_tr_b16 a[128:129], v11 offset:30784
  ds_read_b64_tr_b16 a[130:131], v11 offset:31552
  s_waitcnt lgkmcnt(6)
  s_mov_b32 s36, 774144
  s_add_u32 m0, s35, 24576
  s_nop 0
  buffer_load_dwordx4 v10, s[8:11], s36 offen lds
  s_add_u32 m0, s35, 25600
  s_nop 0
  buffer_load_dwordx4 v12, s[8:11], s36 offen lds
  s_add_u32 m0, s35, 26624
  s_nop 0
  buffer_load_dwordx4 v13, s[8:11], s36 offen lds
  s_waitcnt vmcnt(30)
  ds_read_b64_tr_b16 a[132:133], v11 offset:33792
  ds_read_b64_tr_b16 a[134:135], v11 offset:34560
  ds_read_b64_tr_b16 a[136:137], v11 offset:33824
  ds_read_b64_tr_b16 a[138:139], v11 offset:34592
  ds_read_b64_tr_b16 a[140:141], v11 offset:33856
  ds_read_b64_tr_b16 a[142:143], v11 offset:34624
  s_waitcnt lgkmcnt(6)
  s_mov_b32 s36, 811008
  s_add_u32 m0, s35, 27648
  s_nop 0
  buffer_load_dwordx4 v10, s[8:11], s36 offen lds
  s_add_u32 m0, s35, 28672
  s_nop 0
  buffer_load_dwordx4 v12, s[8:11], s36 offen lds
  s_add_u32 m0, s35, 29696
  s_nop 0
  buffer_load_dwordx4 v13, s[8:11], s36 offen lds
  s_waitcnt vmcnt(30)
  ds_read_b64_tr_b16 a[144:145], v11 offset:36864
  ds_read_b64_tr_b16 a[146:147], v11 offset:37632
  ds_read_b64_tr_b16 a[148:149], v11 offset:36896
  ds_read_b64_tr_b16 a[150:151], v11 offset:37664
  ds_read_b64_tr_b16 a[152:153], v11 offset:36928
  ds_read_b64_tr_b16 a[154:155], v11 offset:37696
  s_waitcnt lgkmcnt(6)
  s_mov_b32 s36, 847872
  s_add_u32 m0, s35, 30720
  s_nop 0
  buffer_load_dwordx4 v10, s[8:11], s36 offen lds
  s_add_u32 m0, s35, 31744
  s_nop 0
  buffer_load_dwordx4 v12, s[8:11], s36 offen lds
  s_add_u32 m0, s35, 32768
  s_nop 0
  buffer_load_dwordx4 v13, s[8:11], s36 offen lds
  s_waitcnt vmcnt(30)
  ds_read_b64_tr_b16 a[156:157], v11 offset:0
  ds_read_b64_tr_b16 a[158:159], v11 offset:768
  ds_read_b64_tr_b16 a[160:161], v11 offset:32
  ds_read_b64_tr_b16 a[162:163], v11 offset:800
  ds_read_b64_tr_b16 a[164:165], v11 offset:64
  ds_read_b64_tr_b16 a[166:167], v11 offset:832
  s_waitcnt lgkmcnt(6)
  s_mov_b32 s36, 884736
  s_add_u32 m0, s35, 33792
  s_nop 0
  buffer_load_dwordx4 v10, s[8:11], s36 offen lds
  s_add_u32 m0, s35, 34816
  s_nop 0
  buffer_load_dwordx4 v12, s[8:11], s36 offen lds
  s_add_u32 m0, s35, 35840
  s_nop 0
  buffer_load_dwordx4 v13, s[8:11], s36 offen lds
  s_waitcnt vmcnt(30)
  ds_read_b64_tr_b16 a[168:169], v11 offset:3072
  ds_read_b64_tr_b16 a[170:171], v11 offset:3840
  ds_read_b64_tr_b16 a[172:173], v11 offset:3104
  ds_read_b64_tr_b16 a[174:175], v11 offset:3872
  ds_read_b64_tr_b16 a[176:177], v11 offset:3136
  ds_read_b64_tr_b16 a[178:179], v11 offset:3904
  s_waitcnt lgkmcnt(6)
  s_mov_b32 s36, 921600
  s_add_u32 m0, s35, 36864
  s_nop 0
  buffer_load_dwordx4 v10, s[8:11], s36 offen lds
  s_add_u32 m0, s35, 37888
  s_nop 0
  buffer_load_dwordx4 v12, s[8:11], s36 offen lds
  s_add_u32 m0, s35, 38912
  s_nop 0
  buffer_load_dwordx4 v13, s[8:11], s36 offen lds
  s_waitcnt vmcnt(30)
  ds_read_b64_tr_b16 a[180:181], v11 offset:6144
  ds_read_b64_tr_b16 a[182:183], v11 offset:6912
  ds_read_b64_tr_b16 a[184:185], v11 offset:6176
  ds_read_b64_tr_b16 a[186:187], v11 offset:6944
  ds_read_b64_tr_b16 a[188:189], v11 offset:6208
  ds_read_b64_tr_b16 a[190:191], v11 offset:6976
  s_waitcnt lgkmcnt(6)
  s_mov_b32 s36, 958464
  s_add_u32 m0, s35, 0
  s_nop 0
  buffer_load_dwordx4 v10, s[8:11], s36 offen lds
  s_add_u32 m0, s35, 1024
  s_nop 0
  buffer_load_dwordx4 v12, s[8:11], s36 offen lds
  s_add_u32 m0, s35, 2048
  s_nop 0
  buffer_load_dwordx4 v13, s[8:11], s36 offen lds
  s_waitcnt vmcnt(30)
  ds_read_b64_tr_b16 a[192:193], v11 offset:9216
  ds_read_b64_tr_b16 a[194:195], v11 offset:9984
  ds_read_b64_tr_b16 a[196:197], v11 offset:9248
  ds_read_b64_tr_b16 a[198:199], v11 offset:10016
  ds_read_b64_tr_b16 a[200:201], v11 offset:9280
  ds_read_b64_tr_b16 a[202:203], v11 offset:10048
  s_waitcnt lgkmcnt(6)
  s_mov_b32 s36, 995328
  s_add_u32 m0, s35, 3072
  s_nop 0
  buffer_load_dwordx4 v10, s[8:11], s36 offen lds
  s_add_u32 m0, s35, 4096
  s_nop 0
  buffer_load_dwordx4 v12, s[8:11], s36 offen lds
  s_add_u32 m0, s35, 5120
  s_nop 0
  buffer_load_dwordx4 v13, s[8:11], s36 offen lds
  s_waitcnt vmcnt(30)
  ds_read_b64_tr_b16 a[204:205], v11 offset:12288
  ds_read_b64_tr_b16 a[206:207], v11 offset:13056
  ds_read_b64_tr_b16 a[208:209], v11 offset:12320
  ds_read_b64_tr_b16 a[210:211], v11 offset:13088
  ds_read_b64_tr_b16 a[212:213], v11 offset:12352
  ds_read_b64_tr_b16 a[214:215], v11 offset:13120
  s_waitcnt lgkmcnt(6)
  s_mov_b32 s36, 1032192
  s_add_u32 m0, s35, 6144
  s_nop 0
  buffer_load_dwordx4 v10, s[8:11], s36 offen lds
  s_add_u32 m0, s35, 7168
  s_nop 0
  buffer_load_dwordx4 v12, s[8:11], s36 offen lds
  s_add_u32 m0, s35, 8192
  s_nop 0
  buffer_load_dwordx4 v13, s[8:11], s36 offen lds
  s_waitcnt vmcnt(30)
  ds_read_b64_tr_b16 a[216:217], v11 offset:15360
  ds_read_b64_tr_b16 a[218:219], v11 offset:16128
  ds_read_b64_tr_b16 a[220:221], v11 offset:15392
  ds_read_b64_tr_b16 a[222:223], v11 offset:16160
  ds_read_b64_tr_b16 a[224:225], v11 offset:15424
  ds_read_b64_tr_b16 a[226:227], v11 offset:16192
  s_waitcnt lgkmcnt(6)
  s_mov_b32 s36, 1069056
  s_add_u32 m0, s35, 9216
  s_nop 0
  buffer_load_dwordx4 v10, s[8:11], s36 offen lds
  s_add_u32 m0, s35, 10240
  s_nop 0
  buffer_load_dwordx4 v12, s[8:11], s36 offen lds
  s_add_u32 m0, s35, 11264
  s_nop 0
  buffer_load_dwordx4 v13, s[8:11], s36 offen lds
  s_waitcnt vmcnt(30)
  ds_read_b64_tr_b16 a[228:229], v11 offset:18432
  ds_read_b64_tr_b16 a[230:231], v11 offset:19200
  ds_read_b64_tr_b16 a[232:233], v11 offset:18464
  ds_read_b64_tr_b16 a[234:235], v11 offset:19232
  ds_read_b64_tr_b16 a[236:237], v11 offset:18496
  ds_read_b64_tr_b16 a[238:239], v11 offset:19264
  s_waitcnt lgkmcnt(6)
  s_mov_b32 s36, 1105920
  s_add_u32 m0, s35, 12288
  s_nop 0
  buffer_load_dwordx4 v10, s[8:11], s36 offen lds
  s_add_u32 m0, s35, 13312
  s_nop 0
  buffer_load_dwordx4 v12, s[8:11], s36 offen lds
  s_add_u32 m0, s35, 14336
  s_nop 0
  buffer_load_dwordx4 v13, s[8:11], s36 offen lds
  s_waitcnt vmcnt(30)
  ds_read_b64_tr_b16 a[240:241], v11 offset:21504
  ds_read_b64_tr_b16 a[242:243], v11 offset:22272
  ds_read_b64_tr_b16 a[244:245], v11 offset:21536
  ds_read_b64_tr_b16 a[246:247], v11 offset:22304
  ds_read_b64_tr_b16 a[248:249], v11 offset:21568
  ds_read_b64_tr_b16 a[250:251], v11 offset:22336
  s_waitcnt lgkmcnt(6)
  s_mov_b32 s36, 1142784
  s_add_u32 m0, s35, 15360
  s_nop 0
  buffer_load_dwordx4 v10, s[8:11], s36 offen lds
  s_add_u32 m0, s35, 16384
  s_nop 0
  buffer_load_dwordx4 v12, s[8:11], s36 offen lds
  s_add_u32 m0, s35, 17408
  s_nop 0
  buffer_load_dwordx4 v13, s[8:11], s36 offen lds
  s_waitcnt vmcnt(30)
  ds_read_b64_tr_b16 a[252:253], v11 offset:24576
  ds_read_b64_tr_b16 a[254:255], v11 offset:25344
  ds_read_b64_tr_b16 v[80:81], v11 offset:24608
  ds_read_b64_tr_b16 v[82:83], v11 offset:25376
  ds_read_b64_tr_b16 v[84:85], v11 offset:24640
  ds_read_b64_tr_b16 v[86:87], v11 offset:25408
  s_waitcnt vmcnt(27)
  ds_read_b64_tr_b16 v[88:89], v11 offset:27648
  ds_read_b64_tr_b16 v[90:91], v11 offset:28416
  ds_read_b64_tr_b16 v[92:93], v11 offset:27680
  ds_read_b64_tr_b16 v[94:95], v11 offset:28448
  ds_read_b64_tr_b16 v[96:97], v11 offset:27712
  ds_read_b64_tr_b16 v[98:99], v11 offset:28480
  s_waitcnt vmcnt(24)
  ds_read_b64_tr_b16 v[100:101], v11 offset:30720
  ds_read_b64_tr_b16 v[102:103], v11 offset:31488
  ds_read_b64_tr_b16 v[104:105], v11 offset:30752
  ds_read_b64_tr_b16 v[106:107], v11 offset:31520
  ds_read_b64_tr_b16 v[108:109], v11 offset:30784
  ds_read_b64_tr_b16 v[110:111], v11 offset:31552
  s_waitcnt vmcnt(21)
  ds_read_b64_tr_b16 v[112:113], v11 offset:33792
  ds_read_b64_tr_b16 v[114:115], v11 offset:34560
  ds_read_b64_tr_b16 v[116:117], v11 offset:33824
  ds_read_b64_tr_b16 v[118:119], v11 offset:34592
  ds_read_b64_tr_b16 v[120:121], v11 offset:33856
  ds_read_b64_tr_b16 v[122:123], v11 offset:34624
  s_waitcnt vmcnt(18)
  ds_read_b64_tr_b16 v[124:125], v11 offset:36864
  ds_read_b64_tr_b16 v[126:127], v11 offset:37632
  ds_read_b64_tr_b16 v[128:129], v11 offset:36896
  ds_read_b64_tr_b16 v[130:131], v11 offset:37664
  ds_read_b64_tr_b16 v[132:133], v11 offset:36928
  ds_read_b64_tr_b16 v[134:135], v11 offset:37696
  s_waitcnt vmcnt(15)
  ds_read_b64_tr_b16 v[136:137], v11 offset:0
  ds_read_b64_tr_b16 v[138:139], v11 offset:768
  ds_read_b64_tr_b16 v[140:141], v11 offset:32
  ds_read_b64_tr_b16 v[142:143], v11 offset:800
  ds_read_b64_tr_b16 v[144:145], v11 offset:64
  ds_read_b64_tr_b16 v[146:147], v11 offset:832
  s_waitcnt vmcnt(12)
  ds_read_b64_tr_b16 v[148:149], v11 offset:3072
  ds_read_b64_tr_b16 v[150:151], v11 offset:3840
  ds_read_b64_tr_b16 v[152:153], v11 offset:3104
  ds_read_b64_tr_b16 v[154:155], v11 offset:3872
  ds_read_b64_tr_b16 v[156:157], v11 offset:3136
  ds_read_b64_tr_b16 v[158:159], v11 offset:3904
  s_waitcnt vmcnt(9)
  ds_read_b64_tr_b16 v[160:161], v11 offset:6144
  ds_read_b64_tr_b16 v[162:163], v11 offset:6912
  ds_read_b64_tr_b16 v[164:165], v11 offset:6176
  ds_read_b64_tr_b16 v[166:167], v11 offset:6944
  ds_read_b64_tr_b16 v[168:169], v11 offset:6208
  ds_read_b64_tr_b16 v[170:171], v11 offset:6976
  s_waitcnt vmcnt(6)
  ds_read_b64_tr_b16 v[172:173], v11 offset:9216
  ds_read_b64_tr_b16 v[174:175], v11 offset:9984
  ds_read_b64_tr_b16 v[176:177], v11 offset:9248
  ds_read_b64_tr_b16 v[178:179], v11 offset:10016
  ds_read_b64_tr_b16 v[180:181], v11 offset:9280
  ds_read_b64_tr_b16 v[182:183], v11 offset:10048
  s_waitcnt vmcnt(3)
  ds_read_b64_tr_b16 v[184:185], v11 offset:12288
  ds_read_b64_tr_b16 v[186:187], v11 offset:13056
  ds_read_b64_tr_b16 v[188:189], v11 offset:12320
  ds_read_b64_tr_b16 v[190:191], v11 offset:13088
  ds_read_b64_tr_b16 v[192:193], v11 offset:12352
  ds_read_b64_tr_b16 v[194:195], v11 offset:13120
  s_waitcnt vmcnt(0)
  ds_read_b64_tr_b16 v[196:197], v11 offset:15360
  ds_read_b64_tr_b16 v[198:199], v11 offset:16128
  ds_read_b64_tr_b16 v[200:201], v11 offset:15392
  ds_read_b64_tr_b16 v[202:203], v11 offset:16160
  ds_read_b64_tr_b16 v[204:205], v11 offset:15424
  ds_read_b64_tr_b16 v[206:207], v11 offset:16192
  s_waitcnt lgkmcnt(0)
  s_barrier
  v_mov_b32 v5, 0
  v_mov_b32 v6, 1
  v_lshlrev_b32 v1, 4, v0
  s_mov_b32 s48, 0
  s_mov_b32 s49, -1
  v_and_b32 v7, 1, v0
  v_lshlrev_b32 v7, 7, v7
  s_lshl_b32 s33, s29, 2
  s_add_u32 s33, s33, s24
  s_lshl_b32 s33, s33, 8
  s_add_u32 s33, s33, 40960
  v_add_u32 v7, s33, v7
  v_add_u32 v8, 4096, v7
  v_cndmask_b32 v7, v7, v8, s[48:49]
  s_mul_i32 s46, s28, 12
  s_mul_i32 s34, s29, 3
  s_add_u32 s46, s46, s34
  s_add_u32 s46, s46, s62
  s_lshl_b32 s46, s46, 9
  s_lshl_b32 s34, s24, 7
  s_add_u32 s46, s46, s34
  s_add_u32 s46, s46, 115712
  v_lshrrev_b32 v8, 5, v0
  v_lshlrev_b32 v10, 10, v8
  v_bfe_u32 v8, v0, 4, 1
  v_lshl_add_u32 v10, v8, 9, v10
  v_and_b32 v8, 15, v0
  v_lshl_add_u32 v10, v8, 4, v10
  v_add_u32 v11, 36864, v10
  s_mul_i32 s35, s24, 192
  s_add_u32 s35, s35, 147456
  v_mul_u32_u24 v3, 784, v8
  v_lshrrev_b32 v8, 4, v0
  v_lshl_add_u32 v3, v8, 4, v3
  v_add_u32 v3, s35, v3
  s_mul_i32 s33, s62, 768
  s_mul_i32 s34, s24, 9216
  s_add_u32 s33, s33, s34
  s_mul_i32 s34, s29, 36864
  s_add_u32 s33, s33, s34
  s_mul_i32 s35, s24, 3136
  s_add_u32 s35, s35, 147456
  v_add_u32 v8, 0, v0
  v_mul_u32_u24 v9, 43691, v8
  v_lshrrev_b32 v9, 21, v9
  v_mul_u32_u24 v14, 48, v9
  v_sub_u32 v14, v8, v14
  v_lshlrev_b32 v14, 4, v14
  v_mul_u32_u24 v72, 784, v9
  v_add3_u32 v72, v72, v14, s35
  v_mul_u32_u24 v75, 2304, v9
  v_add3_u32 v75, v75, v14, s33
  v_add_u32 v8, 64, v0
  v_mul_u32_u24 v9, 43691, v8
  v_lshrrev_b32 v9, 21, v9
  v_mul_u32_u24 v14, 48, v9
  v_sub_u32 v14, v8, v14
  v_lshlrev_b32 v14, 4, v14
  v_mul_u32_u24 v73, 784, v9
  v_add3_u32 v73, v73, v14, s35
  v_mul_u32_u24 v76, 2304, v9
  v_add3_u32 v76, v76, v14, s33
  v_add_u32 v8, 128, v0
  v_mul_u32_u24 v9, 43691, v8
  v_lshrrev_b32 v9, 21, v9
  v_mul_u32_u24 v14, 48, v9
  v_sub_u32 v14, v8, v14
  v_lshlrev_b32 v14, 4, v14
  v_mul_u32_u24 v74, 784, v9
  v_add3_u32 v74, v74, v14, s35
  v_mul_u32_u24 v77, 2304, v9
  v_add3_u32 v77, v77, v14, s33
  v_mov_b32 v8, 128
Lwi_25:
  buffer_load_dword v9, v8, s[20:23], 0 offen sc1
  s_waitcnt vmcnt(0)
  v_cmp_gt_u32 vcc, 0x100, v9
  s_cbranch_vccz Lwiok_26
  s_add_u32 s60, s60, 1
  s_cmp_gt_u32 s60, 262144
  s_cbranch_scc1 L_fail_wo
  s_sleep 4
  s_branch Lwi_25
Lwiok_26:
  s_mov_b32 s30, s28
  s_mov_b32 s31, s28
  s_mov_b32 s44, 0
  s_mov_b32 s45, 65536
  s_mov_b32 s47, 0x40000000
  s_mov_b32 s50, 0
  s_mov_b32 s58, -1
  s_mov_b32 s38, 0x40000000
  s_mul_i32 s51, s29, 12
  s_lshl_b32 s34, s62, 2
  s_add_u32 s51, s51, s34
  s_add_u32 s51, s51, s24
  s_mul_i32 s40, s24, 16384
  s_lshl_b32 s39, s29, 2
  s_add_u32 s39, s39, s24
  s_mul_i32 s39, s39, 2113536
  s_add_u32 s39, s39, 137838592
  s_mov_b32 s41, 171655168
  s_mov_b32 s48, 0x3
  s_mov_b32 s49, 0x3
  v_mov_b32 v9, 0
  s_mul_i32 s33, s31, 18
  s_lshr_b32 s33, s33, 4
  s_add_i32 s33, s33, 18
  s_cmp_le_i32 s33, s30
  s_cselect_b32 s34, 1, 0
  s_cmp_ge_u32 s30, 64
  s_cselect_b32 s34, 1, s34
  s_cmp_ge_u32 s31, 64
  s_cselect_b32 s34, 0, s34
  s_cmp_eq_u32 s34, 1
  s_cselect_b32 s59, s31, s30
  s_cselect_b32 s43, 64, 0
  s_cmp_eq_u32 s34, 1
  s_cselect_b32 s35, 2, 0
  s_cselect_b32 s36, 0, 2
  s_add_u32 s31, s31, s35
  s_add_u32 s30, s30, s36
  s_add_u32 s43, s43, s59
  s_cmp_eq_u32 s34, 1
  s_cselect_b32 s62, 0, 0x3
  s_cselect_b32 s63, 0x3, 0
  s_mul_i32 s33, s59, 8192
  s_add_u32 s33, s33, s39
  s_add_u32 s34, s40, s44
  s_cmp_ge_u32 s59, 64
  s_cselect_b32 s43, -1, s43
  s_cselect_b32 s42, 1, 0
L_wo_fetch:
  s_mov_b64 exec, s[62:63]
  buffer_load_dword v9, v7, s[4:7], 0 offen sc1
  s_mov_b64 exec, -1
  s_waitcnt vmcnt(0)
  v_cmp_ge_u32 vcc, s59, v9
  s_and_b64 vcc, vcc, s[62:63]
  s_cbranch_scc0 L_wo_fgo
  s_add_u32 s60, s60, 1
  s_cmp_gt_u32 s60, 262144
  s_cbranch_scc1 L_fail_wo
  s_sleep 2
  s_branch L_wo_fetch
L_wo_fgo:
  s_add_u32 m0, s34, 0
  s_add_u32 s35, s33, 0
  buffer_load_dwordx4 v1, s[4:7], s35 offen offset:0 sc1 lds
  buffer_load_dwordx4 v1, s[4:7], s35 offen offset:1024 sc1 lds
  buffer_load_dwordx4 v1, s[4:7], s35 offen offset:2048 sc1 lds
  buffer_load_dwordx4 v1, s[4:7], s35 offen offset:3072 sc1 lds
  s_add_u32 m0, s34, 4096
  s_add_u32 s35, s33, 4096
  buffer_load_dwordx4 v1, s[4:7], s35 offen offset:0 sc1 lds
  buffer_load_dwordx4 v1, s[4:7], s35 offen offset:1024 sc1 lds
  buffer_load_dwordx4 v1, s[4:7], s35 offen offset:2048 sc1 lds
  buffer_load_dwordx4 v1, s[4:7], s35 offen offset:3072 sc1 lds
  s_add_u32 m0, s34, 8192
  s_add_u32 s35, s33, 1056768
  buffer_load_dwordx4 v1, s[4:7], s35 offen offset:0 sc1 lds
  buffer_load_dwordx4 v1, s[4:7], s35 offen offset:1024 sc1 lds
  buffer_load_dwordx4 v1, s[4:7], s35 offen offset:2048 sc1 lds
  buffer_load_dwordx4 v1, s[4:7], s35 offen offset:3072 sc1 lds
  s_add_u32 m0, s34, 12288
  s_add_u32 s35, s33, 1060864
  buffer_load_dwordx4 v1, s[4:7], s35 offen offset:0 sc1 lds
  buffer_load_dwordx4 v1, s[4:7], s35 offen offset:1024 sc1 lds
  buffer_load_dwordx4 v1, s[4:7], s35 offen offset:2048 sc1 lds
  buffer_load_dwordx4 v1, s[4:7], s35 offen offset:3072 sc1 lds
  s_waitcnt vmcnt(0)
L_wo_run:
  s_mov_b32 s32, s43
  s_add_u32 s44, s44, s45
  s_mul_i32 s37, s59, 147456
  s_add_u32 s37, s37, s41
  s_barrier
  ds_read_b128 v[40:43], v10 offset:0
  ds_read_b128 v[44:47], v10 offset:256
  ds_read_b128 v[64:67], v72
  ds_read_b128 v[68:71], v73
  ds_read_b128 v[12:15], v74
  ds_read_b128 v[48:51], v10 offset:2048
  ds_read_b128 v[52:55], v10 offset:2304
  s_waitcnt lgkmcnt(5)
  v_mfma_f32_16x16x32_bf16 v[16:19], a[0:3], v[40:43], 0
  ds_read_b128 v[56:59], v10 offset:4096
  v_mfma_f32_16x16x32_bf16 v[24:27], a[4:7], v[40:43], 0
  s_mul_i32 s33, s31, 18
  s_lshr_b32 s33, s33, 4
  s_add_i32 s33, s33, 18
  s_cmp_le_i32 s33, s30
  s_cselect_b32 s34, 1, 0
  v_mfma_f32_16x16x32_bf16 v[32:35], a[8:11], v[40:43], 0
  v_mfma_f32_16x16x32_bf16 v[20:23], a[0:3], v[44:47], 0
  ds_read_b128 v[60:63], v10 offset:4352
  v_mfma_f32_16x16x32_bf16 v[28:31], a[4:7], v[44:47], 0
  s_cmp_ge_u32 s30, 64
  s_cselect_b32 s34, 1, s34
  s_cmp_ge_u32 s31, 64
  s_cselect_b32 s34, 0, s34
  v_mfma_f32_16x16x32_bf16 v[36:39], a[8:11], v[44:47], 0
  s_waitcnt lgkmcnt(2)
  v_mfma_f32_16x16x32_bf16 v[16:19], a[12:15], v[48:51], v[16:19]
  ds_read_b128 v[40:43], v10 offset:6144
  v_mfma_f32_16x16x32_bf16 v[24:27], a[16:19], v[48:51], v[24:27]
  s_cmp_eq_u32 s34, 1
  s_cselect_b32 s59, s31, s30
  s_cselect_b32 s43, 64, 0
  s_cmp_eq_u32 s34, 1
  s_cselect_b32 s35, 2, 0
  s_cselect_b32 s36, 0, 2
  v_mfma_f32_16x16x32_bf16 v[32:35], a[20:23], v[48:51], v[32:35]
  buffer_store_dwordx4 v[64:67], v75, s[4:7], s38 offen sc1
  v_mfma_f32_16x16x32_bf16 v[20:23], a[12:15], v[52:55], v[20:23]
  ds_read_b128 v[44:47], v10 offset:6400
  v_mfma_f32_16x16x32_bf16 v[28:31], a[16:19], v[52:55], v[28:31]
  s_add_u32 s31, s31, s35
  s_add_u32 s30, s30, s36
  s_add_u32 s43, s43, s59
  s_cmp_eq_u32 s34, 1
  s_cselect_b32 s62, 0, 0x3
  s_cselect_b32 s63, 0x3, 0
  v_mfma_f32_16x16x32_bf16 v[36:39], a[20:23], v[52:55], v[36:39]
  buffer_store_dwordx4 v[68:71], v76, s[4:7], s38 offen sc1
  s_waitcnt lgkmcnt(2)
  v_mfma_f32_16x16x32_bf16 v[16:19], a[24:27], v[56:59], v[16:19]
  ds_read_b128 v[48:51], v10 offset:8192
  v_mfma_f32_16x16x32_bf16 v[24:27], a[28:31], v[56:59], v[24:27]
  s_mul_i32 s33, s59, 8192
  s_add_u32 s33, s33, s39
  s_add_u32 s34, s40, s44
  s_cmp_ge_u32 s59, 64
  s_cselect_b32 s43, -1, s43
  s_cselect_b32 s42, 1, 0
  v_mfma_f32_16x16x32_bf16 v[32:35], a[32:35], v[56:59], v[32:35]
  buffer_store_dwordx4 v[12:15], v77, s[4:7], s38 offen sc1
  v_mfma_f32_16x16x32_bf16 v[20:23], a[24:27], v[60:63], v[20:23]
  ds_read_b128 v[52:55], v10 offset:8448
  v_mfma_f32_16x16x32_bf16 v[28:31], a[28:31], v[60:63], v[28:31]
  v_cmp_ge_u32 vcc, s59, v9
  v_mfma_f32_16x16x32_bf16 v[36:39], a[32:35], v[60:63], v[36:39]
  s_waitcnt lgkmcnt(2)
  v_mfma_f32_16x16x32_bf16 v[16:19], a[36:39], v[40:43], v[16:19]
  ds_read_b128 v[56:59], v10 offset:10240
  v_mfma_f32_16x16x32_bf16 v[24:27], a[40:43], v[40:43], v[24:27]
  v_mfma_f32_16x16x32_bf16 v[32:35], a[44:47], v[40:43], v[32:35]
  s_and_b64 vcc, vcc, s[62:63]
  s_cbranch_scc0 L_wo_w7
  v_mfma_f32_16x16x32_bf16 v[20:23], a[36:39], v[44:47], v[20:23]
  ds_read_b128 v[60:63], v10 offset:10496
  v_mfma_f32_16x16x32_bf16 v[28:31], a[40:43], v[44:47], v[28:31]
  v_mfma_f32_16x16x32_bf16 v[36:39], a[44:47], v[44:47], v[36:39]
  s_waitcnt lgkmcnt(2)
  v_mfma_f32_16x16x32_bf16 v[16:19], a[48:51], v[48:51], v[16:19]
  ds_read_b128 v[40:43], v10 offset:12288
  v_mfma_f32_16x16x32_bf16 v[24:27], a[52:55], v[48:51], v[24:27]
  v_mfma_f32_16x16x32_bf16 v[32:35], a[56:59], v[48:51], v[32:35]
  v_mfma_f32_16x16x32_bf16 v[20:23], a[48:51], v[52:55], v[20:23]
  ds_read_b128 v[44:47], v10 offset:12544
  v_mfma_f32_16x16x32_bf16 v[28:31], a[52:55], v[52:55], v[28:31]
  s_mov_b64 exec, s[48:49]
  buffer_load_dword v9, v7, s[4:7], 0 offen sc1
  s_mov_b64 exec, -1
  v_mfma_f32_16x16x32_bf16 v[36:39], a[56:59], v[52:55], v[36:39]
  s_waitcnt lgkmcnt(2)
  v_mfma_f32_16x16x32_bf16 v[16:19], a[60:63], v[56:59], v[16:19]
  ds_read_b128 v[48:51], v10 offset:14336
  v_mfma_f32_16x16x32_bf16 v[24:27], a[64:67], v[56:59], v[24:27]
  v_mfma_f32_16x16x32_bf16 v[32:35], a[68:71], v[56:59], v[32:35]
  v_mfma_f32_16x16x32_bf16 v[20:23], a[60:63], v[60:63], v[20:23]
  ds_read_b128 v[52:55], v10 offset:14592
  v_mfma_f32_16x16x32_bf16 v[28:31], a[64:67], v[60:63], v[28:31]
  v_mfma_f32_16x16x32_bf16 v[36:39], a[68:71], v[60:63], v[36:39]
  s_waitcnt lgkmcnt(2)
  v_mfma_f32_16x16x32_bf16 v[16:19], a[72:75], v[40:43], v[16:19]
  ds_read_b128 v[56:59], v10 offset:16384
  v_mfma_f32_16x16x32_bf16 v[24:27], a[76:79], v[40:43], v[24:27]
  v_mfma_f32_16x16x32_bf16 v[32:35], a[80:83], v[40:43], v[32:35]
  v_mfma_f32_16x16x32_bf16 v[20:23], a[72:75], v[44:47], v[20:23]
  ds_read_b128 v[60:63], v10 offset:16640
  v_mfma_f32_16x16x32_bf16 v[28:31], a[76:79], v[44:47], v[28:31]
  v_mfma_f32_16x16x32_bf16 v[36:39], a[80:83], v[44:47], v[36:39]
  s_waitcnt lgkmcnt(2)
  v_mfma_f32_16x16x32_bf16 v[16:19], a[84:87], v[48:51], v[16:19]
  ds_read_b128 v[40:43], v10 offset:18432
  v_mfma_f32_16x16x32_bf16 v[24:27], a[88:91], v[48:51], v[24:27]
  v_mfma_f32_16x16x32_bf16 v[32:35], a[92:95], v[48:51], v[32:35]
  v_mfma_f32_16x16x32_bf16 v[20:23], a[84:87], v[52:55], v[20:23]
  ds_read_b128 v[44:47], v10 offset:18688
  v_mfma_f32_16x16x32_bf16 v[28:31], a[88:91], v[52:55], v[28:31]
  v_mfma_f32_16x16x32_bf16 v[36:39], a[92:95], v[52:55], v[36:39]
  s_waitcnt lgkmcnt(2)
  v_mfma_f32_16x16x32_bf16 v[16:19], a[96:99], v[56:59], v[16:19]
  ds_read_b128 v[48:51], v10 offset:20480
  v_mfma_f32_16x16x32_bf16 v[24:27], a[100:103], v[56:59], v[24:27]
  v_mfma_f32_16x16x32_bf16 v[32:35], a[104:107], v[56:59], v[32:35]
  v_mfma_f32_16x16x32_bf16 v[20:23], a[96:99], v[60:63], v[20:23]
  ds_read_b128 v[52:55], v10 offset:20736
  v_mfma_f32_16x16x32_bf16 v[28:31], a[100:103], v[60:63], v[28:31]
  v_mfma_f32_16x16x32_bf16 v[36:39], a[104:107], v[60:63], v[36:39]
  s_waitcnt lgkmcnt(2)
  v_mfma_f32_16x16x32_bf16 v[16:19], a[108:111], v[40:43], v[16:19]
  ds_read_b128 v[56:59], v10 offset:22528
  v_mfma_f32_16x16x32_bf16 v[24:27], a[112:115], v[40:43], v[24:27]
  v_cmp_ge_u32 vcc, s59, v9
  v_mfma_f32_16x16x32_bf16 v[32:35], a[116:119], v[40:43], v[32:35]
  v_mfma_f32_16x16x32_bf16 v[20:23], a[108:111], v[44:47], v[20:23]
  ds_read_b128 v[60:63], v10 offset:22784
  v_mfma_f32_16x16x32_bf16 v[28:31], a[112:115], v[44:47], v[28:31]
  s_waitcnt vmcnt(1)
  v_mov_b32 v6, s50
  s_mov_b64 exec, 1
  buffer_store_dword v6, v5, s[4:7], s47 offen sc1
  s_mov_b64 exec, -1
  v_mfma_f32_16x16x32_bf16 v[36:39], a[116:119], v[44:47], v[36:39]
  s_waitcnt lgkmcnt(2)
  s_and_b64 vcc, vcc, s[62:63]
  s_cbranch_scc0 L_wo_w20
  v_mfma_f32_16x16x32_bf16 v[16:19], a[120:123], v[48:51], v[16:19]
  ds_read_b128 v[40:43], v10 offset:24576
  v_mfma_f32_16x16x32_bf16 v[24:27], a[124:127], v[48:51], v[24:27]
  v_mfma_f32_16x16x32_bf16 v[32:35], a[128:131], v[48:51], v[32:35]
  v_mfma_f32_16x16x32_bf16 v[20:23], a[120:123], v[52:55], v[20:23]
  ds_read_b128 v[44:47], v10 offset:24832
  v_mfma_f32_16x16x32_bf16 v[28:31], a[124:127], v[52:55], v[28:31]
  s_mov_b64 exec, s[48:49]
  buffer_load_dword v9, v7, s[4:7], 0 offen sc1
  s_mov_b64 exec, -1
  v_mfma_f32_16x16x32_bf16 v[36:39], a[128:131], v[52:55], v[36:39]
  s_waitcnt lgkmcnt(2)
  v_mfma_f32_16x16x32_bf16 v[16:19], a[132:135], v[56:59], v[16:19]
  ds_read_b128 v[48:51], v10 offset:26624
  v_mfma_f32_16x16x32_bf16 v[24:27], a[136:139], v[56:59], v[24:27]
  v_mfma_f32_16x16x32_bf16 v[32:35], a[140:143], v[56:59], v[32:35]
  v_mfma_f32_16x16x32_bf16 v[20:23], a[132:135], v[60:63], v[20:23]
  ds_read_b128 v[52:55], v10 offset:26880
  v_mfma_f32_16x16x32_bf16 v[28:31], a[136:139], v[60:63], v[28:31]
  v_mfma_f32_16x16x32_bf16 v[36:39], a[140:143], v[60:63], v[36:39]
  s_waitcnt lgkmcnt(2)
  v_mfma_f32_16x16x32_bf16 v[16:19], a[144:147], v[40:43], v[16:19]
  ds_read_b128 v[56:59], v10 offset:28672
  v_mfma_f32_16x16x32_bf16 v[24:27], a[148:151], v[40:43], v[24:27]
  v_mfma_f32_16x16x32_bf16 v[32:35], a[152:155], v[40:43], v[32:35]
  v_mfma_f32_16x16x32_bf16 v[20:23], a[144:147], v[44:47], v[20:23]
  ds_read_b128 v[60:63], v10 offset:28928
  v_mfma_f32_16x16x32_bf16 v[28:31], a[148:151], v[44:47], v[28:31]
  v_mfma_f32_16x16x32_bf16 v[36:39], a[152:155], v[44:47], v[36:39]
  s_waitcnt lgkmcnt(2)
  v_mfma_f32_16x16x32_bf16 v[16:19], a[156:159], v[48:51], v[16:19]
  ds_read_b128 v[40:43], v10 offset:30720
  v_mfma_f32_16x16x32_bf16 v[24:27], a[160:163], v[48:51], v[24:27]
  v_mfma_f32_16x16x32_bf16 v[32:35], a[164:167], v[48:51], v[32:35]
  v_mfma_f32_16x16x32_bf16 v[20:23], a[156:159], v[52:55], v[20:23]
  ds_read_b128 v[44:47], v10 offset:30976
  v_mfma_f32_16x16x32_bf16 v[28:31], a[160:163], v[52:55], v[28:31]
  v_mfma_f32_16x16x32_bf16 v[36:39], a[164:167], v[52:55], v[36:39]
  s_waitcnt lgkmcnt(2)
  v_mfma_f32_16x16x32_bf16 v[16:19], a[168:171], v[56:59], v[16:19]
  ds_read_b128 v[48:51], v10 offset:32768
  v_mfma_f32_16x16x32_bf16 v[24:27], a[172:175], v[56:59], v[24:27]
  v_mfma_f32_16x16x32_bf16 v[32:35], a[176:179], v[56:59], v[32:35]
  v_mfma_f32_16x16x32_bf16 v[20:23], a[168:171], v[60:63], v[20:23]
  ds_read_b128 v[52:55], v10 offset:33024
  v_mfma_f32_16x16x32_bf16 v[28:31], a[172:175], v[60:63], v[28:31]
  v_mfma_f32_16x16x32_bf16 v[36:39], a[176:179], v[60:63], v[36:39]
  s_waitcnt lgkmcnt(2)
  v_mfma_f32_16x16x32_bf16 v[16:19], a[180:183], v[40:43], v[16:19]
  ds_read_b128 v[56:59], v10 offset:34816
  v_mfma_f32_16x16x32_bf16 v[24:27], a[184:187], v[40:43], v[24:27]
  v_cmp_ge_u32 vcc, s59, v9
  v_mfma_f32_16x16x32_bf16 v[32:35], a[188:191], v[40:43], v[32:35]
  v_mfma_f32_16x16x32_bf16 v[20:23], a[180:183], v[44:47], v[20:23]
  ds_read_b128 v[60:63], v10 offset:35072
  v_mfma_f32_16x16x32_bf16 v[28:31], a[184:187], v[44:47], v[28:31]
  v_mfma_f32_16x16x32_bf16 v[36:39], a[188:191], v[44:47], v[36:39]
  s_waitcnt lgkmcnt(2)
  s_and_b64 vcc, vcc, s[62:63]
  s_cbranch_scc0 L_wo_w32
  v_mfma_f32_16x16x32_bf16 v[16:19], a[192:195], v[48:51], v[16:19]
  ds_read_b128 v[40:43], v11 offset:0
  v_mfma_f32_16x16x32_bf16 v[24:27], a[196:199], v[48:51], v[24:27]
  v_mfma_f32_16x16x32_bf16 v[32:35], a[200:203], v[48:51], v[32:35]
  v_mfma_f32_16x16x32_bf16 v[20:23], a[192:195], v[52:55], v[20:23]
  ds_read_b128 v[44:47], v11 offset:256
  v_mfma_f32_16x16x32_bf16 v[28:31], a[196:199], v[52:55], v[28:31]
  v_mfma_f32_16x16x32_bf16 v[36:39], a[200:203], v[52:55], v[36:39]
  s_waitcnt lgkmcnt(2)
  v_mfma_f32_16x16x32_bf16 v[16:19], a[204:207], v[56:59], v[16:19]
  ds_read_b128 v[48:51], v11 offset:2048
  v_mfma_f32_16x16x32_bf16 v[24:27], a[208:211], v[56:59], v[24:27]
  v_mfma_f32_16x16x32_bf16 v[32:35], a[212:215], v[56:59], v[32:35]
  v_mfma_f32_16x16x32_bf16 v[20:23], a[204:207], v[60:63], v[20:23]
  ds_read_b128 v[52:55], v11 offset:2304
  v_mfma_f32_16x16x32_bf16 v[28:31], a[208:211], v[60:63], v[28:31]
  v_mfma_f32_16x16x32_bf16 v[36:39], a[212:215], v[60:63], v[36:39]
  s_waitcnt lgkmcnt(2)
  v_mfma_f32_16x16x32_bf16 v[16:19], a[216:219], v[40:43], v[16:19]
  ds_read_b128 v[56:59], v11 offset:4096
  v_mfma_f32_16x16x32_bf16 v[24:27], a[220:223], v[40:43], v[24:27]
  v_mfma_f32_16x16x32_bf16 v[32:35], a[224:227], v[40:43], v[32:35]
  v_mfma_f32_16x16x32_bf16 v[20:23], a[216:219], v[44:47], v[20:23]
  ds_read_b128 v[60:63], v11 offset:4352
  v_mfma_f32_16x16x32_bf16 v[28:31], a[220:223], v[44:47], v[28:31]
  s_mov_b64 exec, s[48:49]
  buffer_load_dword v9, v7, s[4:7], 0 offen sc1
  s_mov_b64 exec, -1
  v_mfma_f32_16x16x32_bf16 v[36:39], a[224:227], v[44:47], v[36:39]
  s_waitcnt lgkmcnt(2)
  v_mfma_f32_16x16x32_bf16 v[16:19], a[228:231], v[48:51], v[16:19]
  ds_read_b128 v[40:43], v11 offset:6144
  v_mfma_f32_16x16x32_bf16 v[24:27], a[232:235], v[48:51], v[24:27]
  v_mfma_f32_16x16x32_bf16 v[32:35], a[236:239], v[48:51], v[32:35]
  v_mfma_f32_16x16x32_bf16 v[20:23], a[228:231], v[52:55], v[20:23]
  ds_read_b128 v[44:47], v11 offset:6400
  v_mfma_f32_16x16x32_bf16 v[28:31], a[232:235], v[52:55], v[28:31]
  v_mfma_f32_16x16x32_bf16 v[36:39], a[236:239], v[52:55], v[36:39]
  s_waitcnt lgkmcnt(2)
  v_mfma_f32_16x16x32_bf16 v[16:19], a[240:243], v[56:59], v[16:19]
  ds_read_b128 v[48:51], v11 offset:8192
  v_mfma_f32_16x16x32_bf16 v[24:27], a[244:247], v[56:59], v[24:27]
  v_mfma_f32_16x16x32_bf16 v[32:35], a[248:251], v[56:59], v[32:35]
  v_mfma_f32_16x16x32_bf16 v[20:23], a[240:243], v[60:63], v[20:23]
  ds_read_b128 v[52:55], v11 offset:8448
  v_mfma_f32_16x16x32_bf16 v[28:31], a[244:247], v[60:63], v[28:31]
  v_mfma_f32_16x16x32_bf16 v[36:39], a[248:251], v[60:63], v[36:39]
  s_waitcnt lgkmcnt(2)
  v_mfma_f32_16x16x32_bf16 v[16:19], a[252:255], v[40:43], v[16:19]
  ds_read_b128 v[56:59], v11 offset:10240
  v_mfma_f32_16x16x32_bf16 v[24:27], v[80:83], v[40:43], v[24:27]
  v_mfma_f32_16x16x32_bf16 v[32:35], v[84:87], v[40:43], v[32:35]
  v_mfma_f32_16x16x32_bf16 v[20:23], a[252:255], v[44:47], v[20:23]
  ds_read_b128 v[60:63], v11 offset:10496
  v_mfma_f32_16x16x32_bf16 v[28:31], v[80:83], v[44:47], v[28:31]
  v_mfma_f32_16x16x32_bf16 v[36:39], v[84:87], v[44:47], v[36:39]
  s_waitcnt lgkmcnt(2)
  v_mfma_f32_16x16x32_bf16 v[16:19], v[88:91], v[48:51], v[16:19]
  ds_read_b128 v[40:43], v11 offset:12288
  v_mfma_f32_16x16x32_bf16 v[24:27], v[92:95], v[48:51], v[24:27]
  v_mfma_f32_16x16x32_bf16 v[32:35], v[96:99], v[48:51], v[32:35]
  v_mfma_f32_16x16x32_bf16 v[20:23], v[88:91], v[52:55], v[20:23]
  ds_read_b128 v[44:47], v11 offset:12544
  v_mfma_f32_16x16x32_bf16 v[28:31], v[92:95], v[52:55], v[28:31]
  v_mfma_f32_16x16x32_bf16 v[36:39], v[96:99], v[52:55], v[36:39]
  s_waitcnt lgkmcnt(2)
  v_mfma_f32_16x16x32_bf16 v[16:19], v[100:103], v[56:59], v[16:19]
  ds_read_b128 v[48:51], v11 offset:14336
  v_mfma_f32_16x16x32_bf16 v[24:27], v[104:107], v[56:59], v[24:27]
  v_cmp_ge_u32 vcc, s59, v9
  v_mfma_f32_16x16x32_bf16 v[32:35], v[108:111], v[56:59], v[32:35]
  v_mfma_f32_16x16x32_bf16 v[20:23], v[100:103], v[60:63], v[20:23]
  ds_read_b128 v[52:55], v11 offset:14592
  v_mfma_f32_16x16x32_bf16 v[28:31], v[104:107], v[60:63], v[28:31]
  v_mfma_f32_16x16x32_bf16 v[36:39], v[108:111], v[60:63], v[36:39]
  s_waitcnt lgkmcnt(2)
  s_and_b64 vcc, vcc, s[62:63]
  s_cbranch_scc0 L_wo_w48
  v_mfma_f32_16x16x32_bf16 v[16:19], v[112:115], v[40:43], v[16:19]
  ds_read_b128 v[56:59], v11 offset:16384
  v_mfma_f32_16x16x32_bf16 v[24:27], v[116:119], v[40:43], v[24:27]
  v_mfma_f32_16x16x32_bf16 v[32:35], v[120:123], v[40:43], v[32:35]
  v_mfma_f32_16x16x32_bf16 v[20:23], v[112:115], v[44:47], v[20:23]
  ds_read_b128 v[60:63], v11 offset:16640
  v_mfma_f32_16x16x32_bf16 v[28:31], v[116:119], v[44:47], v[28:31]
  v_mfma_f32_16x16x32_bf16 v[36:39], v[120:123], v[44:47], v[36:39]
  s_waitcnt lgkmcnt(2)
  v_mfma_f32_16x16x32_bf16 v[16:19], v[124:127], v[48:51], v[16:19]
  ds_read_b128 v[40:43], v11 offset:18432
  v_mfma_f32_16x16x32_bf16 v[24:27], v[128:131], v[48:51], v[24:27]
  v_mfma_f32_16x16x32_bf16 v[32:35], v[132:135], v[48:51], v[32:35]
  v_mfma_f32_16x16x32_bf16 v[20:23], v[124:127], v[52:55], v[20:23]
  ds_read_b128 v[44:47], v11 offset:18688
  v_mfma_f32_16x16x32_bf16 v[28:31], v[128:131], v[52:55], v[28:31]
  v_mfma_f32_16x16x32_bf16 v[36:39], v[132:135], v[52:55], v[36:39]
  s_waitcnt lgkmcnt(2)
  v_mfma_f32_16x16x32_bf16 v[16:19], v[136:139], v[56:59], v[16:19]
  ds_read_b128 v[48:51], v11 offset:20480
  v_mfma_f32_16x16x32_bf16 v[24:27], v[140:143], v[56:59], v[24:27]
  v_mfma_f32_16x16x32_bf16 v[32:35], v[144:147], v[56:59], v[32:35]
  v_mfma_f32_16x16x32_bf16 v[20:23], v[136:139], v[60:63], v[20:23]
  ds_read_b128 v[52:55], v11 offset:20736
  v_mfma_f32_16x16x32_bf16 v[28:31], v[140:143], v[60:63], v[28:31]
  s_mov_b64 exec, s[48:49]
  buffer_load_dword v9, v7, s[4:7], 0 offen sc1
  s_mov_b64 exec, -1
  v_mfma_f32_16x16x32_bf16 v[36:39], v[144:147], v[60:63], v[36:39]
  s_waitcnt lgkmcnt(2)
  v_mfma_f32_16x16x32_bf16 v[16:19], v[148:151], v[40:43], v[16:19]
  ds_read_b128 v[56:59], v11 offset:22528
  v_mfma_f32_16x16x32_bf16 v[24:27], v[152:155], v[40:43], v[24:27]
  v_mfma_f32_16x16x32_bf16 v[32:35], v[156:159], v[40:43], v[32:35]
  v_mfma_f32_16x16x32_bf16 v[20:23], v[148:151], v[44:47], v[20:23]
  ds_read_b128 v[60:63], v11 offset:22784
  v_mfma_f32_16x16x32_bf16 v[28:31], v[152:155], v[44:47], v[28:31]
  v_mfma_f32_16x16x32_bf16 v[36:39], v[156:159], v[44:47], v[36:39]
  s_waitcnt lgkmcnt(2)
  v_mfma_f32_16x16x32_bf16 v[16:19], v[160:163], v[48:51], v[16:19]
  ds_read_b128 v[40:43], v11 offset:24576
  v_mfma_f32_16x16x32_bf16 v[24:27], v[164:167], v[48:51], v[24:27]
  v_mfma_f32_16x16x32_bf16 v[32:35], v[168:171], v[48:51], v[32:35]
  v_mfma_f32_16x16x32_bf16 v[20:23], v[160:163], v[52:55], v[20:23]
  ds_read_b128 v[44:47], v11 offset:24832
  v_mfma_f32_16x16x32_bf16 v[28:31], v[164:167], v[52:55], v[28:31]
  v_mfma_f32_16x16x32_bf16 v[36:39], v[168:171], v[52:55], v[36:39]
  s_waitcnt lgkmcnt(2)
  v_mfma_f32_16x16x32_bf16 v[16:19], v[172:175], v[56:59], v[16:19]
  ds_read_b128 v[48:51], v11 offset:26624
  v_mfma_f32_16x16x32_bf16 v[24:27], v[176:179], v[56:59], v[24:27]
  v_mfma_f32_16x16x32_bf16 v[32:35], v[180:183], v[56:59], v[32:35]
  v_mfma_f32_16x16x32_bf16 v[20:23], v[172:175], v[60:63], v[20:23]
  ds_read_b128 v[52:55], v11 offset:26880
  v_mfma_f32_16x16x32_bf16 v[28:31], v[176:179], v[60:63], v[28:31]
  v_mfma_f32_16x16x32_bf16 v[36:39], v[180:183], v[60:63], v[36:39]
  s_waitcnt lgkmcnt(2)
  v_mfma_f32_16x16x32_bf16 v[16:19], v[184:187], v[40:43], v[16:19]
  v_mfma_f32_16x16x32_bf16 v[24:27], v[188:191], v[40:43], v[24:27]
  v_mfma_f32_16x16x32_bf16 v[32:35], v[192:195], v[40:43], v[32:35]
  v_mfma_f32_16x16x32_bf16 v[20:23], v[184:187], v[44:47], v[20:23]
  v_mfma_f32_16x16x32_bf16 v[28:31], v[188:191], v[44:47], v[28:31]
  v_mfma_f32_16x16x32_bf16 v[36:39], v[192:195], v[44:47], v[36:39]
  s_waitcnt lgkmcnt(0)
  v_mfma_f32_16x16x32_bf16 v[16:19], v[196:199], v[48:51], v[16:19]
  v_mfma_f32_16x16x32_bf16 v[24:27], v[200:203], v[48:51], v[24:27]
  v_mfma_f32_16x16x32_bf16 v[32:35], v[204:207], v[48:51], v[32:35]
  v_mfma_f32_16x16x32_bf16 v[20:23], v[196:199], v[52:55], v[20:23]
  v_mfma_f32_16x16x32_bf16 v[28:31], v[200:203], v[52:55], v[28:31]
  v_mfma_f32_16x16x32_bf16 v[36:39], v[204:207], v[52:55], v[36:39]
  v_cvt_pk_bf16_f32 v40, v16, v17
  v_cvt_pk_bf16_f32 v41, v18, v19
  v_cvt_pk_bf16_f32 v42, v20, v21
  v_cvt_pk_bf16_f32 v43, v22, v23
  ds_write_b128 v3, v[40:43] offset:0
  v_cvt_pk_bf16_f32 v44, v24, v25
  v_cvt_pk_bf16_f32 v45, v26, v27
  v_cvt_pk_bf16_f32 v46, v28, v29
  v_cvt_pk_bf16_f32 v47, v30, v31
  ds_write_b128 v3, v[44:47] offset:64
  v_cvt_pk_bf16_f32 v48, v32, v33
  v_cvt_pk_bf16_f32 v49, v34, v35
  v_cvt_pk_bf16_f32 v50, v36, v37
  v_cvt_pk_bf16_f32 v51, v38, v39
  ds_write_b128 v3, v[48:51] offset:128
  s_mov_b32 s38, s37
  v_add_u32 v10, s45, v10
  v_add_u32 v11, s45, v11
  s_sub_u32 s45, 0, s45
  s_bfe_u32 s35, s32, 0x10006
  s_lshl_b32 s35, s35, 2
  s_add_u32 s47, s46, s35
  s_and_b32 s50, s32, 63
  s_add_u32 s50, s50, 1
  s_waitcnt lgkmcnt(0)
  s_barrier
  ds_read_b128 v[64:67], v72
  ds_read_b128 v[68:71], v73
  ds_read_b128 v[12:15], v74
  s_waitcnt lgkmcnt(2)
  buffer_store_dwordx4 v[64:67], v75, s[4:7], s38 offen sc1
  s_waitcnt lgkmcnt(1)
  buffer_store_dwordx4 v[68:71], v76, s[4:7], s38 offen sc1
  s_waitcnt lgkmcnt(0)
  buffer_store_dwordx4 v[12:15], v77, s[4:7], s38 offen sc1
  s_mov_b32 s38, 0x40000000
  s_waitcnt vmcnt(3)
  v_cmp_ge_u32 vcc, s59, v9
  s_and_b64 vcc, vcc, s[62:63]
  s_cbranch_scc1 L_wo_drain
  s_add_u32 m0, s34, 0
  s_add_u32 s35, s33, 0
  buffer_load_dwordx4 v1, s[4:7], s35 offen offset:0 sc1 lds
  buffer_load_dwordx4 v1, s[4:7], s35 offen offset:1024 sc1 lds
  buffer_load_dwordx4 v1, s[4:7], s35 offen offset:2048 sc1 lds
  buffer_load_dwordx4 v1, s[4:7], s35 offen offset:3072 sc1 lds
  s_add_u32 m0, s34, 4096
  s_add_u32 s35, s33, 4096
  buffer_load_dwordx4 v1, s[4:7], s35 offen offset:0 sc1 lds
  buffer_load_dwordx4 v1, s[4:7], s35 offen offset:1024 sc1 lds
  buffer_load_dwordx4 v1, s[4:7], s35 offen offset:2048 sc1 lds
  buffer_load_dwordx4 v1, s[4:7], s35 offen offset:3072 sc1 lds
  s_add_u32 m0, s34, 8192
  s_add_u32 s35, s33, 1056768
  buffer_load_dwordx4 v1, s[4:7], s35 offen offset:0 sc1 lds
  buffer_load_dwordx4 v1, s[4:7], s35 offen offset:1024 sc1 lds
  buffer_load_dwordx4 v1, s[4:7], s35 offen offset:2048 sc1 lds
  buffer_load_dwordx4 v1, s[4:7], s35 offen offset:3072 sc1 lds
  s_add_u32 m0, s34, 12288
  s_add_u32 s35, s33, 1060864
  buffer_load_dwordx4 v1, s[4:7], s35 offen offset:0 sc1 lds
  buffer_load_dwordx4 v1, s[4:7], s35 offen offset:1024 sc1 lds
  buffer_load_dwordx4 v1, s[4:7], s35 offen offset:2048 sc1 lds
  buffer_load_dwordx4 v1, s[4:7], s35 offen offset:3072 sc1 lds
  s_waitcnt vmcnt(16)
  v_mov_b32 v6, s50
  s_mov_b64 exec, 1
  buffer_store_dword v6, v5, s[4:7], s47 offen sc1
  s_mov_b64 exec, -1
  s_mov_b32 s47, 0x40000000
  s_waitcnt vmcnt(1)
  s_branch L_wo_run
L_wo_drain:
  s_waitcnt vmcnt(0)
  v_mov_b32 v6, s50
  s_mov_b64 exec, 1
  buffer_store_dword v6, v5, s[4:7], s47 offen sc1
  s_mov_b64 exec, -1
  s_mov_b32 s47, 0x40000000
  s_cmp_eq_u32 s42, 0
  s_cbranch_scc1 L_wo_fetch
  s_endpgm
L_wo_w7:
  v_mfma_f32_16x16x32_bf16 v[20:23], a[36:39], v[44:47], v[20:23]
  ds_read_b128 v[60:63], v10 offset:10496
  v_mfma_f32_16x16x32_bf16 v[28:31], a[40:43], v[44:47], v[28:31]
  s_add_u32 m0, s34, 0
  s_add_u32 s35, s33, 0
  buffer_load_dwordx4 v1, s[4:7], s35 offen offset:0 sc1 lds
  v_mfma_f32_16x16x32_bf16 v[36:39], a[44:47], v[44:47], v[36:39]
  s_waitcnt lgkmcnt(2)
  v_mfma_f32_16x16x32_bf16 v[16:19], a[48:51], v[48:51], v[16:19]
  ds_read_b128 v[40:43], v10 offset:12288
  v_mfma_f32_16x16x32_bf16 v[24:27], a[52:55], v[48:51], v[24:27]
  v_mfma_f32_16x16x32_bf16 v[32:35], a[56:59], v[48:51], v[32:35]
  v_mfma_f32_16x16x32_bf16 v[20:23], a[48:51], v[52:55], v[20:23]
  ds_read_b128 v[44:47], v10 offset:12544
  v_mfma_f32_16x16x32_bf16 v[28:31], a[52:55], v[52:55], v[28:31]
  buffer_load_dwordx4 v1, s[4:7], s35 offen offset:1024 sc1 lds
  v_mfma_f32_16x16x32_bf16 v[36:39], a[56:59], v[52:55], v[36:39]
  s_waitcnt lgkmcnt(2)
  v_mfma_f32_16x16x32_bf16 v[16:19], a[60:63], v[56:59], v[16:19]
  ds_read_b128 v[48:51], v10 offset:14336
  v_mfma_f32_16x16x32_bf16 v[24:27], a[64:67], v[56:59], v[24:27]
  v_mfma_f32_16x16x32_bf16 v[32:35], a[68:71], v[56:59], v[32:35]
  v_mfma_f32_16x16x32_bf16 v[20:23], a[60:63], v[60:63], v[20:23]
  ds_read_b128 v[52:55], v10 offset:14592
  v_mfma_f32_16x16x32_bf16 v[28:31], a[64:67], v[60:63], v[28:31]
  buffer_load_dwordx4 v1, s[4:7], s35 offen offset:2048 sc1 lds
  v_mfma_f32_16x16x32_bf16 v[36:39], a[68:71], v[60:63], v[36:39]
  s_waitcnt lgkmcnt(2)
  v_mfma_f32_16x16x32_bf16 v[16:19], a[72:75], v[40:43], v[16:19]
  ds_read_b128 v[56:59], v10 offset:16384
  v_mfma_f32_16x16x32_bf16 v[24:27], a[76:79], v[40:43], v[24:27]
  v_mfma_f32_16x16x32_bf16 v[32:35], a[80:83], v[40:43], v[32:35]
  v_mfma_f32_16x16x32_bf16 v[20:23], a[72:75], v[44:47], v[20:23]
  ds_read_b128 v[60:63], v10 offset:16640
  v_mfma_f32_16x16x32_bf16 v[28:31], a[76:79], v[44:47], v[28:31]
  buffer_load_dwordx4 v1, s[4:7], s35 offen offset:3072 sc1 lds
  v_mfma_f32_16x16x32_bf16 v[36:39], a[80:83], v[44:47], v[36:39]
  s_waitcnt lgkmcnt(2)
  v_mfma_f32_16x16x32_bf16 v[16:19], a[84:87], v[48:51], v[16:19]
  ds_read_b128 v[40:43], v10 offset:18432
  v_mfma_f32_16x16x32_bf16 v[24:27], a[88:91], v[48:51], v[24:27]
  v_mfma_f32_16x16x32_bf16 v[32:35], a[92:95], v[48:51], v[32:35]
  v_mfma_f32_16x16x32_bf16 v[20:23], a[84:87], v[52:55], v[20:23]
  ds_read_b128 v[44:47], v10 offset:18688
  v_mfma_f32_16x16x32_bf16 v[28:31], a[88:91], v[52:55], v[28:31]
  s_add_u32 m0, s34, 4096
  s_add_u32 s35, s33, 4096
  buffer_load_dwordx4 v1, s[4:7], s35 offen offset:0 sc1 lds
  v_mfma_f32_16x16x32_bf16 v[36:39], a[92:95], v[52:55], v[36:39]
  s_waitcnt lgkmcnt(2)
  v_mfma_f32_16x16x32_bf16 v[16:19], a[96:99], v[56:59], v[16:19]
  ds_read_b128 v[48:51], v10 offset:20480
  v_mfma_f32_16x16x32_bf16 v[24:27], a[100:103], v[56:59], v[24:27]
  v_mfma_f32_16x16x32_bf16 v[32:35], a[104:107], v[56:59], v[32:35]
  v_mfma_f32_16x16x32_bf16 v[20:23], a[96:99], v[60:63], v[20:23]
  ds_read_b128 v[52:55], v10 offset:20736
  v_mfma_f32_16x16x32_bf16 v[28:31], a[100:103], v[60:63], v[28:31]
  buffer_load_dwordx4 v1, s[4:7], s35 offen offset:1024 sc1 lds
  v_mfma_f32_16x16x32_bf16 v[36:39], a[104:107], v[60:63], v[36:39]
  s_waitcnt lgkmcnt(2)
  v_mfma_f32_16x16x32_bf16 v[16:19], a[108:111], v[40:43], v[16:19]
  ds_read_b128 v[56:59], v10 offset:22528
  v_mfma_f32_16x16x32_bf16 v[24:27], a[112:115], v[40:43], v[24:27]
  v_mfma_f32_16x16x32_bf16 v[32:35], a[116:119], v[40:43], v[32:35]
  v_mfma_f32_16x16x32_bf16 v[20:23], a[108:111], v[44:47], v[20:23]
  ds_read_b128 v[60:63], v10 offset:22784
  v_mfma_f32_16x16x32_bf16 v[28:31], a[112:115], v[44:47], v[28:31]
  buffer_load_dwordx4 v1, s[4:7], s35 offen offset:2048 sc1 lds
  s_waitcnt vmcnt(7)
  v_mov_b32 v6, s50
  s_mov_b64 exec, 1
  buffer_store_dword v6, v5, s[4:7], s47 offen sc1
  s_mov_b64 exec, -1
  v_mfma_f32_16x16x32_bf16 v[36:39], a[116:119], v[44:47], v[36:39]
  s_waitcnt lgkmcnt(2)
  v_mfma_f32_16x16x32_bf16 v[16:19], a[120:123], v[48:51], v[16:19]
  ds_read_b128 v[40:43], v10 offset:24576
  v_mfma_f32_16x16x32_bf16 v[24:27], a[124:127], v[48:51], v[24:27]
  v_mfma_f32_16x16x32_bf16 v[32:35], a[128:131], v[48:51], v[32:35]
  v_mfma_f32_16x16x32_bf16 v[20:23], a[120:123], v[52:55], v[20:23]
  ds_read_b128 v[44:47], v10 offset:24832
  v_mfma_f32_16x16x32_bf16 v[28:31], a[124:127], v[52:55], v[28:31]
  buffer_load_dwordx4 v1, s[4:7], s35 offen offset:3072 sc1 lds
  v_mfma_f32_16x16x32_bf16 v[36:39], a[128:131], v[52:55], v[36:39]
  s_waitcnt lgkmcnt(2)
  v_mfma_f32_16x16x32_bf16 v[16:19], a[132:135], v[56:59], v[16:19]
  ds_read_b128 v[48:51], v10 offset:26624
  v_mfma_f32_16x16x32_bf16 v[24:27], a[136:139], v[56:59], v[24:27]
  v_mfma_f32_16x16x32_bf16 v[32:35], a[140:143], v[56:59], v[32:35]
  v_mfma_f32_16x16x32_bf16 v[20:23], a[132:135], v[60:63], v[20:23]
  ds_read_b128 v[52:55], v10 offset:26880
  v_mfma_f32_16x16x32_bf16 v[28:31], a[136:139], v[60:63], v[28:31]
  s_add_u32 m0, s34, 8192
  s_add_u32 s35, s33, 1056768
  buffer_load_dwordx4 v1, s[4:7], s35 offen offset:0 sc1 lds
  v_mfma_f32_16x16x32_bf16 v[36:39], a[140:143], v[60:63], v[36:39]
  s_waitcnt lgkmcnt(2)
  v_mfma_f32_16x16x32_bf16 v[16:19], a[144:147], v[40:43], v[16:19]
  ds_read_b128 v[56:59], v10 offset:28672
  v_mfma_f32_16x16x32_bf16 v[24:27], a[148:151], v[40:43], v[24:27]
  v_mfma_f32_16x16x32_bf16 v[32:35], a[152:155], v[40:43], v[32:35]
  v_mfma_f32_16x16x32_bf16 v[20:23], a[144:147], v[44:47], v[20:23]
  ds_read_b128 v[60:63], v10 offset:28928
  v_mfma_f32_16x16x32_bf16 v[28:31], a[148:151], v[44:47], v[28:31]
  buffer_load_dwordx4 v1, s[4:7], s35 offen offset:1024 sc1 lds
  v_mfma_f32_16x16x32_bf16 v[36:39], a[152:155], v[44:47], v[36:39]
  s_waitcnt lgkmcnt(2)
  v_mfma_f32_16x16x32_bf16 v[16:19], a[156:159], v[48:51], v[16:19]
  ds_read_b128 v[40:43], v10 offset:30720
  v_mfma_f32_16x16x32_bf16 v[24:27], a[160:163], v[48:51], v[24:27]
  v_mfma_f32_16x16x32_bf16 v[32:35], a[164:167], v[48:51], v[32:35]
  v_mfma_f32_16x16x32_bf16 v[20:23], a[156:159], v[52:55], v[20:23]
  ds_read_b128 v[44:47], v10 offset:30976
  v_mfma_f32_16x16x32_bf16 v[28:31], a[160:163], v[52:55], v[28:31]
  buffer_load_dwordx4 v1, s[4:7], s35 offen offset:2048 sc1 lds
  v_mfma_f32_16x16x32_bf16 v[36:39], a[164:167], v[52:55], v[36:39]
  s_waitcnt lgkmcnt(2)
  v_mfma_f32_16x16x32_bf16 v[16:19], a[168:171], v[56:59], v[16:19]
  ds_read_b128 v[48:51], v10 offset:32768
  v_mfma_f32_16x16x32_bf16 v[24:27], a[172:175], v[56:59], v[24:27]
  v_mfma_f32_16x16x32_bf16 v[32:35], a[176:179], v[56:59], v[32:35]
  v_mfma_f32_16x16x32_bf16 v[20:23], a[168:171], v[60:63], v[20:23]
  ds_read_b128 v[52:55], v10 offset:33024
  v_mfma_f32_16x16x32_bf16 v[28:31], a[172:175], v[60:63], v[28:31]
  buffer_load_dwordx4 v1, s[4:7], s35 offen offset:3072 sc1 lds
  v_mfma_f32_16x16x32_bf16 v[36:39], a[176:179], v[60:63], v[36:39]
  s_waitcnt lgkmcnt(2)
  v_mfma_f32_16x16x32_bf16 v[16:19], a[180:183], v[40:43], v[16:19]
  ds_read_b128 v[56:59], v10 offset:34816
  v_mfma_f32_16x16x32_bf16 v[24:27], a[184:187], v[40:43], v[24:27]
  v_mfma_f32_16x16x32_bf16 v[32:35], a[188:191], v[40:43], v[32:35]
  v_mfma_f32_16x16x32_bf16 v[20:23], a[180:183], v[44:47], v[20:23]
  ds_read_b128 v[60:63], v10 offset:35072
  v_mfma_f32_16x16x32_bf16 v[28:31], a[184:187], v[44:47], v[28:31]
  s_add_u32 m0, s34, 12288
  s_add_u32 s35, s33, 1060864
  buffer_load_dwordx4 v1, s[4:7], s35 offen offset:0 sc1 lds
  v_mfma_f32_16x16x32_bf16 v[36:39], a[188:191], v[44:47], v[36:39]
  s_waitcnt lgkmcnt(2)
  v_mfma_f32_16x16x32_bf16 v[16:19], a[192:195], v[48:51], v[16:19]
  ds_read_b128 v[40:43], v11 offset:0
  v_mfma_f32_16x16x32_bf16 v[24:27], a[196:199], v[48:51], v[24:27]
  v_mfma_f32_16x16x32_bf16 v[32:35], a[200:203], v[48:51], v[32:35]
  v_mfma_f32_16x16x32_bf16 v[20:23], a[192:195], v[52:55], v[20:23]
  ds_read_b128 v[44:47], v11 offset:256
  v_mfma_f32_16x16x32_bf16 v[28:31], a[196:199], v[52:55], v[28:31]
  buffer_load_dwordx4 v1, s[4:7], s35 offen offset:1024 sc1 lds
  v_mfma_f32_16x16x32_bf16 v[36:39], a[200:203], v[52:55], v[36:39]
  s_waitcnt lgkmcnt(2)
  v_mfma_f32_16x16x32_bf16 v[16:19], a[204:207], v[56:59], v[16:19]
  ds_read_b128 v[48:51], v11 offset:2048
  v_mfma_f32_16x16x32_bf16 v[24:27], a[208:211], v[56:59], v[24:27]
  v_mfma_f32_16x16x32_bf16 v[32:35], a[212:215], v[56:59], v[32:35]
  v_mfma_f32_16x16x32_bf16 v[20:23], a[204:207], v[60:63], v[20:23]
  ds_read_b128 v[52:55], v11 offset:2304
  v_mfma_f32_16x16x32_bf16 v[28:31], a[208:211], v[60:63], v[28:31]
  buffer_load_dwordx4 v1, s[4:7], s35 offen offset:2048 sc1 lds
  v_mfma_f32_16x16x32_bf16 v[36:39], a[212:215], v[60:63], v[36:39]
  s_waitcnt lgkmcnt(2)
  v_mfma_f32_16x16x32_bf16 v[16:19], a[216:219], v[40:43], v[16:19]
  ds_read_b128 v[56:59], v11 offset:4096
  v_mfma_f32_16x16x32_bf16 v[24:27], a[220:223], v[40:43], v[24:27]
  v_mfma_f32_16x16x32_bf16 v[32:35], a[224:227], v[40:43], v[32:35]
  v_mfma_f32_16x16x32_bf16 v[20:23], a[216:219], v[44:47], v[20:23]
  ds_read_b128 v[60:63], v11 offset:4352
  v_mfma_f32_16x16x32_bf16 v[28:31], a[220:223], v[44:47], v[28:31]
  buffer_load_dwordx4 v1, s[4:7], s35 offen offset:3072 sc1 lds
  v_mfma_f32_16x16x32_bf16 v[36:39], a[224:227], v[44:47], v[36:39]
  s_waitcnt lgkmcnt(2)
  v_mfma_f32_16x16x32_bf16 v[16:19], a[228:231], v[48:51], v[16:19]
  ds_read_b128 v[40:43], v11 offset:6144
  v_mfma_f32_16x16x32_bf16 v[24:27], a[232:235], v[48:51], v[24:27]
  v_mfma_f32_16x16x32_bf16 v[32:35], a[236:239], v[48:51], v[32:35]
  v_mfma_f32_16x16x32_bf16 v[20:23], a[228:231], v[52:55], v[20:23]
  ds_read_b128 v[44:47], v11 offset:6400
  v_mfma_f32_16x16x32_bf16 v[28:31], a[232:235], v[52:55], v[28:31]
  v_mfma_f32_16x16x32_bf16 v[36:39], a[236:239], v[52:55], v[36:39]
  s_waitcnt lgkmcnt(2)
  v_mfma_f32_16x16x32_bf16 v[16:19], a[240:243], v[56:59], v[16:19]
  ds_read_b128 v[48:51], v11 offset:8192
  v_mfma_f32_16x16x32_bf16 v[24:27], a[244:247], v[56:59], v[24:27]
  v_mfma_f32_16x16x32_bf16 v[32:35], a[248:251], v[56:59], v[32:35]
  v_mfma_f32_16x16x32_bf16 v[20:23], a[240:243], v[60:63], v[20:23]
  ds_read_b128 v[52:55], v11 offset:8448
  v_mfma_f32_16x16x32_bf16 v[28:31], a[244:247], v[60:63], v[28:31]
  v_mfma_f32_16x16x32_bf16 v[36:39], a[248:251], v[60:63], v[36:39]
  s_waitcnt lgkmcnt(2)
  v_mfma_f32_16x16x32_bf16 v[16:19], a[252:255], v[40:43], v[16:19]
  ds_read_b128 v[56:59], v11 offset:10240
  v_mfma_f32_16x16x32_bf16 v[24:27], v[80:83], v[40:43], v[24:27]
  v_mfma_f32_16x16x32_bf16 v[32:35], v[84:87], v[40:43], v[32:35]
  v_mfma_f32_16x16x32_bf16 v[20:23], a[252:255], v[44:47], v[20:23]
  ds_read_b128 v[60:63], v11 offset:10496
  v_mfma_f32_16x16x32_bf16 v[28:31], v[80:83], v[44:47], v[28:31]
  v_mfma_f32_16x16x32_bf16 v[36:39], v[84:87], v[44:47], v[36:39]
  s_waitcnt lgkmcnt(2)
  v_mfma_f32_16x16x32_bf16 v[16:19], v[88:91], v[48:51], v[16:19]
  ds_read_b128 v[40:43], v11 offset:12288
  v_mfma_f32_16x16x32_bf16 v[24:27], v[92:95], v[48:51], v[24:27]
  v_mfma_f32_16x16x32_bf16 v[32:35], v[96:99], v[48:51], v[32:35]
  v_mfma_f32_16x16x32_bf16 v[20:23], v[88:91], v[52:55], v[20:23]
  ds_read_b128 v[44:47], v11 offset:12544
  v_mfma_f32_16x16x32_bf16 v[28:31], v[92:95], v[52:55], v[28:31]
  v_mfma_f32_16x16x32_bf16 v[36:39], v[96:99], v[52:55], v[36:39]
  s_waitcnt lgkmcnt(2)
  v_mfma_f32_16x16x32_bf16 v[16:19], v[100:103], v[56:59], v[16:19]
  ds_read_b128 v[48:51], v11 offset:14336
  v_mfma_f32_16x16x32_bf16 v[24:27], v[104:107], v[56:59], v[24:27]
  v_mfma_f32_16x16x32_bf16 v[32:35], v[108:111], v[56:59], v[32:35]
  v_mfma_f32_16x16x32_bf16 v[20:23], v[100:103], v[60:63], v[20:23]
  ds_read_b128 v[52:55], v11 offset:14592
  v_mfma_f32_16x16x32_bf16 v[28:31], v[104:107], v[60:63], v[28:31]
  v_mfma_f32_16x16x32_bf16 v[36:39], v[108:111], v[60:63], v[36:39]
  s_waitcnt lgkmcnt(2)
  v_mfma_f32_16x16x32_bf16 v[16:19], v[112:115], v[40:43], v[16:19]
  ds_read_b128 v[56:59], v11 offset:16384
  v_mfma_f32_16x16x32_bf16 v[24:27], v[116:119], v[40:43], v[24:27]
  v_mfma_f32_16x16x32_bf16 v[32:35], v[120:123], v[40:43], v[32:35]
  v_mfma_f32_16x16x32_bf16 v[20:23], v[112:115], v[44:47], v[20:23]
  ds_read_b128 v[60:63], v11 offset:16640
  v_mfma_f32_16x16x32_bf16 v[28:31], v[116:119], v[44:47], v[28:31]
  v_mfma_f32_16x16x32_bf16 v[36:39], v[120:123], v[44:47], v[36:39]
  s_waitcnt lgkmcnt(2)
  v_mfma_f32_16x16x32_bf16 v[16:19], v[124:127], v[48:51], v[16:19]
  ds_read_b128 v[40:43], v11 offset:18432
  v_mfma_f32_16x16x32_bf16 v[24:27], v[128:131], v[48:51], v[24:27]
  v_mfma_f32_16x16x32_bf16 v[32:35], v[132:135], v[48:51], v[32:35]
  v_mfma_f32_16x16x32_bf16 v[20:23], v[124:127], v[52:55], v[20:23]
  ds_read_b128 v[44:47], v11 offset:18688
  v_mfma_f32_16x16x32_bf16 v[28:31], v[128:131], v[52:55], v[28:31]
  v_mfma_f32_16x16x32_bf16 v[36:39], v[132:135], v[52:55], v[36:39]
  s_waitcnt lgkmcnt(2)
  v_mfma_f32_16x16x32_bf16 v[16:19], v[136:139], v[56:59], v[16:19]
  ds_read_b128 v[48:51], v11 offset:20480
  v_mfma_f32_16x16x32_bf16 v[24:27], v[140:143], v[56:59], v[24:27]
  v_mfma_f32_16x16x32_bf16 v[32:35], v[144:147], v[56:59], v[32:35]
  v_mfma_f32_16x16x32_bf16 v[20:23], v[136:139], v[60:63], v[20:23]
  ds_read_b128 v[52:55], v11 offset:20736
  v_mfma_f32_16x16x32_bf16 v[28:31], v[140:143], v[60:63], v[28:31]
  s_mov_b64 exec, s[48:49]
  buffer_load_dword v9, v7, s[4:7], 0 offen sc1
  s_mov_b64 exec, -1
  v_mfma_f32_16x16x32_bf16 v[36:39], v[144:147], v[60:63], v[36:39]
  s_waitcnt lgkmcnt(2)
  v_mfma_f32_16x16x32_bf16 v[16:19], v[148:151], v[40:43], v[16:19]
  ds_read_b128 v[56:59], v11 offset:22528
  v_mfma_f32_16x16x32_bf16 v[24:27], v[152:155], v[40:43], v[24:27]
  v_mfma_f32_16x16x32_bf16 v[32:35], v[156:159], v[40:43], v[32:35]
  v_mfma_f32_16x16x32_bf16 v[20:23], v[148:151], v[44:47], v[20:23]
  ds_read_b128 v[60:63], v11 offset:22784
  v_mfma_f32_16x16x32_bf16 v[28:31], v[152:155], v[44:47], v[28:31]
  v_mfma_f32_16x16x32_bf16 v[36:39], v[156:159], v[44:47], v[36:39]
  s_waitcnt lgkmcnt(2)
  v_mfma_f32_16x16x32_bf16 v[16:19], v[160:163], v[48:51], v[16:19]
  ds_read_b128 v[40:43], v11 offset:24576
  v_mfma_f32_16x16x32_bf16 v[24:27], v[164:167], v[48:51], v[24:27]
  v_mfma_f32_16x16x32_bf16 v[32:35], v[168:171], v[48:51], v[32:35]
  v_mfma_f32_16x16x32_bf16 v[20:23], v[160:163], v[52:55], v[20:23]
  ds_read_b128 v[44:47], v11 offset:24832
  v_mfma_f32_16x16x32_bf16 v[28:31], v[164:167], v[52:55], v[28:31]
  v_mfma_f32_16x16x32_bf16 v[36:39], v[168:171], v[52:55], v[36:39]
  s_waitcnt lgkmcnt(2)
  v_mfma_f32_16x16x32_bf16 v[16:19], v[172:175], v[56:59], v[16:19]
  ds_read_b128 v[48:51], v11 offset:26624
  v_mfma_f32_16x16x32_bf16 v[24:27], v[176:179], v[56:59], v[24:27]
  v_mfma_f32_16x16x32_bf16 v[32:35], v[180:183], v[56:59], v[32:35]
  v_mfma_f32_16x16x32_bf16 v[20:23], v[172:175], v[60:63], v[20:23]
  ds_read_b128 v[52:55], v11 offset:26880
  v_mfma_f32_16x16x32_bf16 v[28:31], v[176:179], v[60:63], v[28:31]
  v_mfma_f32_16x16x32_bf16 v[36:39], v[180:183], v[60:63], v[36:39]
  s_waitcnt lgkmcnt(2)
  v_mfma_f32_16x16x32_bf16 v[16:19], v[184:187], v[40:43], v[16:19]
  v_mfma_f32_16x16x32_bf16 v[24:27], v[188:191], v[40:43], v[24:27]
  v_mfma_f32_16x16x32_bf16 v[32:35], v[192:195], v[40:43], v[32:35]
  v_mfma_f32_16x16x32_bf16 v[20:23], v[184:187], v[44:47], v[20:23]
  v_mfma_f32_16x16x32_bf16 v[28:31], v[188:191], v[44:47], v[28:31]
  v_mfma_f32_16x16x32_bf16 v[36:39], v[192:195], v[44:47], v[36:39]
  s_waitcnt lgkmcnt(0)
  v_mfma_f32_16x16x32_bf16 v[16:19], v[196:199], v[48:51], v[16:19]
  v_mfma_f32_16x16x32_bf16 v[24:27], v[200:203], v[48:51], v[24:27]
  v_mfma_f32_16x16x32_bf16 v[32:35], v[204:207], v[48:51], v[32:35]
  v_mfma_f32_16x16x32_bf16 v[20:23], v[196:199], v[52:55], v[20:23]
  v_mfma_f32_16x16x32_bf16 v[28:31], v[200:203], v[52:55], v[28:31]
  v_mfma_f32_16x16x32_bf16 v[36:39], v[204:207], v[52:55], v[36:39]
  v_cvt_pk_bf16_f32 v40, v16, v17
  v_cvt_pk_bf16_f32 v41, v18, v19
  v_cvt_pk_bf16_f32 v42, v20, v21
  v_cvt_pk_bf16_f32 v43, v22, v23
  ds_write_b128 v3, v[40:43] offset:0
  v_cvt_pk_bf16_f32 v44, v24, v25
  v_cvt_pk_bf16_f32 v45, v26, v27
  v_cvt_pk_bf16_f32 v46, v28, v29
  v_cvt_pk_bf16_f32 v47, v30, v31
  ds_write_b128 v3, v[44:47] offset:64
  v_cvt_pk_bf16_f32 v48, v32, v33
  v_cvt_pk_bf16_f32 v49, v34, v35
  v_cvt_pk_bf16_f32 v50, v36, v37
  v_cvt_pk_bf16_f32 v51, v38, v39
  ds_write_b128 v3, v[48:51] offset:128
  s_mov_b32 s38, s37
  v_add_u32 v10, s45, v10
  v_add_u32 v11, s45, v11
  s_sub_u32 s45, 0, s45
  s_bfe_u32 s35, s32, 0x10006
  s_lshl_b32 s35, s35, 2
  s_add_u32 s47, s46, s35
  s_and_b32 s50, s32, 63
  s_add_u32 s50, s50, 1
  s_waitcnt lgkmcnt(0)
  s_barrier
  s_waitcnt vmcnt(1)
  s_branch L_wo_run
L_wo_w20:
  v_mfma_f32_16x16x32_bf16 v[16:19], a[120:123], v[48:51], v[16:19]
  ds_read_b128 v[40:43], v10 offset:24576
  v_mfma_f32_16x16x32_bf16 v[24:27], a[124:127], v[48:51], v[24:27]
  s_add_u32 m0, s34, 0
  s_add_u32 s35, s33, 0
  buffer_load_dwordx4 v1, s[4:7], s35 offen offset:0 sc1 lds
  v_mfma_f32_16x16x32_bf16 v[32:35], a[128:131], v[48:51], v[32:35]
  v_mfma_f32_16x16x32_bf16 v[20:23], a[120:123], v[52:55], v[20:23]
  ds_read_b128 v[44:47], v10 offset:24832
  v_mfma_f32_16x16x32_bf16 v[28:31], a[124:127], v[52:55], v[28:31]
  v_mfma_f32_16x16x32_bf16 v[36:39], a[128:131], v[52:55], v[36:39]
  s_waitcnt lgkmcnt(2)
  v_mfma_f32_16x16x32_bf16 v[16:19], a[132:135], v[56:59], v[16:19]
  ds_read_b128 v[48:51], v10 offset:26624
  v_mfma_f32_16x16x32_bf16 v[24:27], a[136:139], v[56:59], v[24:27]
  buffer_load_dwordx4 v1, s[4:7], s35 offen offset:1024 sc1 lds
  v_mfma_f32_16x16x32_bf16 v[32:35], a[140:143], v[56:59], v[32:35]
  v_mfma_f32_16x16x32_bf16 v[20:23], a[132:135], v[60:63], v[20:23]
  ds_read_b128 v[52:55], v10 offset:26880
  v_mfma_f32_16x16x32_bf16 v[28:31], a[136:139], v[60:63], v[28:31]
  v_mfma_f32_16x16x32_bf16 v[36:39], a[140:143], v[60:63], v[36:39]
  s_waitcnt lgkmcnt(2)
  v_mfma_f32_16x16x32_bf16 v[16:19], a[144:147], v[40:43], v[16:19]
  ds_read_b128 v[56:59], v10 offset:28672
  v_mfma_f32_16x16x32_bf16 v[24:27], a[148:151], v[40:43], v[24:27]
  buffer_load_dwordx4 v1, s[4:7], s35 offen offset:2048 sc1 lds
  v_mfma_f32_16x16x32_bf16 v[32:35], a[152:155], v[40:43], v[32:35]
  v_mfma_f32_16x16x32_bf16 v[20:23], a[144:147], v[44:47], v[20:23]
  ds_read_b128 v[60:63], v10 offset:28928
  v_mfma_f32_16x16x32_bf16 v[28:31], a[148:151], v[44:47], v[28:31]
  v_mfma_f32_16x16x32_bf16 v[36:39], a[152:155], v[44:47], v[36:39]
  s_waitcnt lgkmcnt(2)
  v_mfma_f32_16x16x32_bf16 v[16:19], a[156:159], v[48:51], v[16:19]
  ds_read_b128 v[40:43], v10 offset:30720
  v_mfma_f32_16x16x32_bf16 v[24:27], a[160:163], v[48:51], v[24:27]
  buffer_load_dwordx4 v1, s[4:7], s35 offen offset:3072 sc1 lds
  v_mfma_f32_16x16x32_bf16 v[32:35], a[164:167], v[48:51], v[32:35]
  v_mfma_f32_16x16x32_bf16 v[20:23], a[156:159], v[52:55], v[20:23]
  ds_read_b128 v[44:47], v10 offset:30976
  v_mfma_f32_16x16x32_bf16 v[28:31], a[160:163], v[52:55], v[28:31]
  v_mfma_f32_16x16x32_bf16 v[36:39], a[164:167], v[52:55], v[36:39]
  s_waitcnt lgkmcnt(2)
  v_mfma_f32_16x16x32_bf16 v[16:19], a[168:171], v[56:59], v[16:19]
  ds_read_b128 v[48:51], v10 offset:32768
  v_mfma_f32_16x16x32_bf16 v[24:27], a[172:175], v[56:59], v[24:27]
  s_add_u32 m0, s34, 4096
  s_add_u32 s35, s33, 4096
  buffer_load_dwordx4 v1, s[4:7], s35 offen offset:0 sc1 lds
  v_mfma_f32_16x16x32_bf16 v[32:35], a[176:179], v[56:59], v[32:35]
  v_mfma_f32_16x16x32_bf16 v[20:23], a[168:171], v[60:63], v[20:23]
  ds_read_b128 v[52:55], v10 offset:33024
  v_mfma_f32_16x16x32_bf16 v[28:31], a[172:175], v[60:63], v[28:31]
  v_mfma_f32_16x16x32_bf16 v[36:39], a[176:179], v[60:63], v[36:39]
  s_waitcnt lgkmcnt(2)
  v_mfma_f32_16x16x32_bf16 v[16:19], a[180:183], v[40:43], v[16:19]
  ds_read_b128 v[56:59], v10 offset:34816
  v_mfma_f32_16x16x32_bf16 v[24:27], a[184:187], v[40:43], v[24:27]
  buffer_load_dwordx4 v1, s[4:7], s35 offen offset:1024 sc1 lds
  v_mfma_f32_16x16x32_bf16 v[32:35], a[188:191], v[40:43], v[32:35]
  v_mfma_f32_16x16x32_bf16 v[20:23], a[180:183], v[44:47], v[20:23]
  ds_read_b128 v[60:63], v10 offset:35072
  v_mfma_f32_16x16x32_bf16 v[28:31], a[184:187], v[44:47], v[28:31]
  v_mfma_f32_16x16x32_bf16 v[36:39], a[188:191], v[44:47], v[36:39]
  s_waitcnt lgkmcnt(2)
  v_mfma_f32_16x16x32_bf16 v[16:19], a[192:195], v[48:51], v[16:19]
  ds_read_b128 v[40:43], v11 offset:0
  v_mfma_f32_16x16x32_bf16 v[24:27], a[196:199], v[48:51], v[24:27]
  buffer_load_dwordx4 v1, s[4:7], s35 offen offset:2048 sc1 lds
  v_mfma_f32_16x16x32_bf16 v[32:35], a[200:203], v[48:51], v[32:35]
  v_mfma_f32_16x16x32_bf16 v[20:23], a[192:195], v[52:55], v[20:23]
  ds_read_b128 v[44:47], v11 offset:256
  v_mfma_f32_16x16x32_bf16 v[28:31], a[196:199], v[52:55], v[28:31]
  v_mfma_f32_16x16x32_bf16 v[36:39], a[200:203], v[52:55], v[36:39]
  s_waitcnt lgkmcnt(2)
  v_mfma_f32_16x16x32_bf16 v[16:19], a[204:207], v[56:59], v[16:19]
  ds_read_b128 v[48:51], v11 offset:2048
  v_mfma_f32_16x16x32_bf16 v[24:27], a[208:211], v[56:59], v[24:27]
  buffer_load_dwordx4 v1, s[4:7], s35 offen offset:3072 sc1 lds
  v_mfma_f32_16x16x32_bf16 v[32:35], a[212:215], v[56:59], v[32:35]
  v_mfma_f32_16x16x32_bf16 v[20:23], a[204:207], v[60:63], v[20:23]
  ds_read_b128 v[52:55], v11 offset:2304
  v_mfma_f32_16x16x32_bf16 v[28:31], a[208:211], v[60:63], v[28:31]
  v_mfma_f32_16x16x32_bf16 v[36:39], a[212:215], v[60:63], v[36:39]
  s_waitcnt lgkmcnt(2)
  v_mfma_f32_16x16x32_bf16 v[16:19], a[216:219], v[40:43], v[16:19]
  ds_read_b128 v[56:59], v11 offset:4096
  v_mfma_f32_16x16x32_bf16 v[24:27], a[220:223], v[40:43], v[24:27]
  s_add_u32 m0, s34, 8192
  s_add_u32 s35, s33, 1056768
  buffer_load_dwordx4 v1, s[4:7], s35 offen offset:0 sc1 lds
  v_mfma_f32_16x16x32_bf16 v[32:35], a[224:227], v[40:43], v[32:35]
  v_mfma_f32_16x16x32_bf16 v[20:23], a[216:219], v[44:47], v[20:23]
  ds_read_b128 v[60:63], v11 offset:4352
  v_mfma_f32_16x16x32_bf16 v[28:31], a[220:223], v[44:47], v[28:31]
  v_mfma_f32_16x16x32_bf16 v[36:39], a[224:227], v[44:47], v[36:39]
  s_waitcnt lgkmcnt(2)
  v_mfma_f32_16x16x32_bf16 v[16:19], a[228:231], v[48:51], v[16:19]
  ds_read_b128 v[40:43], v11 offset:6144
  v_mfma_f32_16x16x32_bf16 v[24:27], a[232:235], v[48:51], v[24:27]
  buffer_load_dwordx4 v1, s[4:7], s35 offen offset:1024 sc1 lds
  v_mfma_f32_16x16x32_bf16 v[32:35], a[236:239], v[48:51], v[32:35]
  v_mfma_f32_16x16x32_bf16 v[20:23], a[228:231], v[52:55], v[20:23]
  ds_read_b128 v[44:47], v11 offset:6400
  v_mfma_f32_16x16x32_bf16 v[28:31], a[232:235], v[52:55], v[28:31]
  v_mfma_f32_16x16x32_bf16 v[36:39], a[236:239], v[52:55], v[36:39]
  s_waitcnt lgkmcnt(2)
  v_mfma_f32_16x16x32_bf16 v[16:19], a[240:243], v[56:59], v[16:19]
  ds_read_b128 v[48:51], v11 offset:8192
  v_mfma_f32_16x16x32_bf16 v[24:27], a[244:247], v[56:59], v[24:27]
  buffer_load_dwordx4 v1, s[4:7], s35 offen offset:2048 sc1 lds
  v_mfma_f32_16x16x32_bf16 v[32:35], a[248:251], v[56:59], v[32:35]
  v_mfma_f32_16x16x32_bf16 v[20:23], a[240:243], v[60:63], v[20:23]
  ds_read_b128 v[52:55], v11 offset:8448
  v_mfma_f32_16x16x32_bf16 v[28:31], a[244:247], v[60:63], v[28:31]
  v_mfma_f32_16x16x32_bf16 v[36:39], a[248:251], v[60:63], v[36:39]
  s_waitcnt lgkmcnt(2)
  v_mfma_f32_16x16x32_bf16 v[16:19], a[252:255], v[40:43], v[16:19]
  ds_read_b128 v[56:59], v11 offset:10240
  v_mfma_f32_16x16x32_bf16 v[24:27], v[80:83], v[40:43], v[24:27]
  buffer_load_dwordx4 v1, s[4:7], s35 offen offset:3072 sc1 lds
  v_mfma_f32_16x16x32_bf16 v[32:35], v[84:87], v[40:43], v[32:35]
  v_mfma_f32_16x16x32_bf16 v[20:23], a[252:255], v[44:47], v[20:23]
  ds_read_b128 v[60:63], v11 offset:10496
  v_mfma_f32_16x16x32_bf16 v[28:31], v[80:83], v[44:47], v[28:31]
  v_mfma_f32_16x16x32_bf16 v[36:39], v[84:87], v[44:47], v[36:39]
  s_waitcnt lgkmcnt(2)
  v_mfma_f32_16x16x32_bf16 v[16:19], v[88:91], v[48:51], v[16:19]
  ds_read_b128 v[40:43], v11 offset:12288
  v_mfma_f32_16x16x32_bf16 v[24:27], v[92:95], v[48:51], v[24:27]
  s_add_u32 m0, s34, 12288
  s_add_u32 s35, s33, 1060864
  buffer_load_dwordx4 v1, s[4:7], s35 offen offset:0 sc1 lds
  v_mfma_f32_16x16x32_bf16 v[32:35], v[96:99], v[48:51], v[32:35]
  v_mfma_f32_16x16x32_bf16 v[20:23], v[88:91], v[52:55], v[20:23]
  ds_read_b128 v[44:47], v11 offset:12544
  v_mfma_f32_16x16x32_bf16 v[28:31], v[92:95], v[52:55], v[28:31]
  v_mfma_f32_16x16x32_bf16 v[36:39], v[96:99], v[52:55], v[36:39]
  s_waitcnt lgkmcnt(2)
  v_mfma_f32_16x16x32_bf16 v[16:19], v[100:103], v[56:59], v[16:19]
  ds_read_b128 v[48:51], v11 offset:14336
  v_mfma_f32_16x16x32_bf16 v[24:27], v[104:107], v[56:59], v[24:27]
  buffer_load_dwordx4 v1, s[4:7], s35 offen offset:1024 sc1 lds
  v_mfma_f32_16x16x32_bf16 v[32:35], v[108:111], v[56:59], v[32:35]
  v_mfma_f32_16x16x32_bf16 v[20:23], v[100:103], v[60:63], v[20:23]
  ds_read_b128 v[52:55], v11 offset:14592
  v_mfma_f32_16x16x32_bf16 v[28:31], v[104:107], v[60:63], v[28:31]
  v_mfma_f32_16x16x32_bf16 v[36:39], v[108:111], v[60:63], v[36:39]
  s_waitcnt lgkmcnt(2)
  v_mfma_f32_16x16x32_bf16 v[16:19], v[112:115], v[40:43], v[16:19]
  ds_read_b128 v[56:59], v11 offset:16384
  v_mfma_f32_16x16x32_bf16 v[24:27], v[116:119], v[40:43], v[24:27]
  buffer_load_dwordx4 v1, s[4:7], s35 offen offset:2048 sc1 lds
  v_mfma_f32_16x16x32_bf16 v[32:35], v[120:123], v[40:43], v[32:35]
  v_mfma_f32_16x16x32_bf16 v[20:23], v[112:115], v[44:47], v[20:23]
  ds_read_b128 v[60:63], v11 offset:16640
  v_mfma_f32_16x16x32_bf16 v[28:31], v[116:119], v[44:47], v[28:31]
  v_mfma_f32_16x16x32_bf16 v[36:39], v[120:123], v[44:47], v[36:39]
  s_waitcnt lgkmcnt(2)
  v_mfma_f32_16x16x32_bf16 v[16:19], v[124:127], v[48:51], v[16:19]
  ds_read_b128 v[40:43], v11 offset:18432
  v_mfma_f32_16x16x32_bf16 v[24:27], v[128:131], v[48:51], v[24:27]
  buffer_load_dwordx4 v1, s[4:7], s35 offen offset:3072 sc1 lds
  v_mfma_f32_16x16x32_bf16 v[32:35], v[132:135], v[48:51], v[32:35]
  v_mfma_f32_16x16x32_bf16 v[20:23], v[124:127], v[52:55], v[20:23]
  ds_read_b128 v[44:47], v11 offset:18688
  v_mfma_f32_16x16x32_bf16 v[28:31], v[128:131], v[52:55], v[28:31]
  v_mfma_f32_16x16x32_bf16 v[36:39], v[132:135], v[52:55], v[36:39]
  s_waitcnt lgkmcnt(2)
  v_mfma_f32_16x16x32_bf16 v[16:19], v[136:139], v[56:59], v[16:19]
  ds_read_b128 v[48:51], v11 offset:20480
  v_mfma_f32_16x16x32_bf16 v[24:27], v[140:143], v[56:59], v[24:27]
  v_mfma_f32_16x16x32_bf16 v[32:35], v[144:147], v[56:59], v[32:35]
  v_mfma_f32_16x16x32_bf16 v[20:23], v[136:139], v[60:63], v[20:23]
  ds_read_b128 v[52:55], v11 offset:20736
  v_mfma_f32_16x16x32_bf16 v[28:31], v[140:143], v[60:63], v[28:31]
  s_mov_b64 exec, s[48:49]
  buffer_load_dword v9, v7, s[4:7], 0 offen sc1
  s_mov_b64 exec, -1
  v_mfma_f32_16x16x32_bf16 v[36:39], v[144:147], v[60:63], v[36:39]
  s_waitcnt lgkmcnt(2)
  v_mfma_f32_16x16x32_bf16 v[16:19], v[148:151], v[40:43], v[16:19]
  ds_read_b128 v[56:59], v11 offset:22528
  v_mfma_f32_16x16x32_bf16 v[24:27], v[152:155], v[40:43], v[24:27]
  v_mfma_f32_16x16x32_bf16 v[32:35], v[156:159], v[40:43], v[32:35]
  v_mfma_f32_16x16x32_bf16 v[20:23], v[148:151], v[44:47], v[20:23]
  ds_read_b128 v[60:63], v11 offset:22784
  v_mfma_f32_16x16x32_bf16 v[28:31], v[152:155], v[44:47], v[28:31]
  v_mfma_f32_16x16x32_bf16 v[36:39], v[156:159], v[44:47], v[36:39]
  s_waitcnt lgkmcnt(2)
  v_mfma_f32_16x16x32_bf16 v[16:19], v[160:163], v[48:51], v[16:19]
  ds_read_b128 v[40:43], v11 offset:24576
  v_mfma_f32_16x16x32_bf16 v[24:27], v[164:167], v[48:51], v[24:27]
  v_mfma_f32_16x16x32_bf16 v[32:35], v[168:171], v[48:51], v[32:35]
  v_mfma_f32_16x16x32_bf16 v[20:23], v[160:163], v[52:55], v[20:23]
  ds_read_b128 v[44:47], v11 offset:24832
  v_mfma_f32_16x16x32_bf16 v[28:31], v[164:167], v[52:55], v[28:31]
  v_mfma_f32_16x16x32_bf16 v[36:39], v[168:171], v[52:55], v[36:39]
  s_waitcnt lgkmcnt(2)
  v_mfma_f32_16x16x32_bf16 v[16:19], v[172:175], v[56:59], v[16:19]
  ds_read_b128 v[48:51], v11 offset:26624
  v_mfma_f32_16x16x32_bf16 v[24:27], v[176:179], v[56:59], v[24:27]
  v_mfma_f32_16x16x32_bf16 v[32:35], v[180:183], v[56:59], v[32:35]
  v_mfma_f32_16x16x32_bf16 v[20:23], v[172:175], v[60:63], v[20:23]
  ds_read_b128 v[52:55], v11 offset:26880
  v_mfma_f32_16x16x32_bf16 v[28:31], v[176:179], v[60:63], v[28:31]
  v_mfma_f32_16x16x32_bf16 v[36:39], v[180:183], v[60:63], v[36:39]
  s_waitcnt lgkmcnt(2)
  v_mfma_f32_16x16x32_bf16 v[16:19], v[184:187], v[40:43], v[16:19]
  v_mfma_f32_16x16x32_bf16 v[24:27], v[188:191], v[40:43], v[24:27]
  v_mfma_f32_16x16x32_bf16 v[32:35], v[192:195], v[40:43], v[32:35]
  v_mfma_f32_16x16x32_bf16 v[20:23], v[184:187], v[44:47], v[20:23]
  v_mfma_f32_16x16x32_bf16 v[28:31], v[188:191], v[44:47], v[28:31]
  v_mfma_f32_16x16x32_bf16 v[36:39], v[192:195], v[44:47], v[36:39]
  s_waitcnt lgkmcnt(0)
  v_mfma_f32_16x16x32_bf16 v[16:19], v[196:199], v[48:51], v[16:19]
  v_mfma_f32_16x16x32_bf16 v[24:27], v[200:203], v[48:51], v[24:27]
  v_mfma_f32_16x16x32_bf16 v[32:35], v[204:207], v[48:51], v[32:35]
  v_mfma_f32_16x16x32_bf16 v[20:23], v[196:199], v[52:55], v[20:23]
  v_mfma_f32_16x16x32_bf16 v[28:31], v[200:203], v[52:55], v[28:31]
  v_mfma_f32_16x16x32_bf16 v[36:39], v[204:207], v[52:55], v[36:39]
  v_cvt_pk_bf16_f32 v40, v16, v17
  v_cvt_pk_bf16_f32 v41, v18, v19
  v_cvt_pk_bf16_f32 v42, v20, v21
  v_cvt_pk_bf16_f32 v43, v22, v23
  ds_write_b128 v3, v[40:43] offset:0
  v_cvt_pk_bf16_f32 v44, v24, v25
  v_cvt_pk_bf16_f32 v45, v26, v27
  v_cvt_pk_bf16_f32 v46, v28, v29
  v_cvt_pk_bf16_f32 v47, v30, v31
  ds_write_b128 v3, v[44:47] offset:64
  v_cvt_pk_bf16_f32 v48, v32, v33
  v_cvt_pk_bf16_f32 v49, v34, v35
  v_cvt_pk_bf16_f32 v50, v36, v37
  v_cvt_pk_bf16_f32 v51, v38, v39
  ds_write_b128 v3, v[48:51] offset:128
  s_mov_b32 s38, s37
  v_add_u32 v10, s45, v10
  v_add_u32 v11, s45, v11
  s_sub_u32 s45, 0, s45
  s_bfe_u32 s35, s32, 0x10006
  s_lshl_b32 s35, s35, 2
  s_add_u32 s47, s46, s35
  s_and_b32 s50, s32, 63
  s_add_u32 s50, s50, 1
  s_waitcnt lgkmcnt(0)
  s_barrier
  s_waitcnt vmcnt(1)
  s_branch L_wo_run
L_wo_w32:
  v_mfma_f32_16x16x32_bf16 v[16:19], a[192:195], v[48:51], v[16:19]
  ds_read_b128 v[40:43], v11 offset:0
  v_mfma_f32_16x16x32_bf16 v[24:27], a[196:199], v[48:51], v[24:27]
  s_add_u32 m0, s34, 0
  s_add_u32 s35, s33, 0
  buffer_load_dwordx4 v1, s[4:7], s35 offen offset:0 sc1 lds
  v_mfma_f32_16x16x32_bf16 v[32:35], a[200:203], v[48:51], v[32:35]
  v_mfma_f32_16x16x32_bf16 v[20:23], a[192:195], v[52:55], v[20:23]
  ds_read_b128 v[44:47], v11 offset:256
  v_mfma_f32_16x16x32_bf16 v[28:31], a[196:199], v[52:55], v[28:31]
  v_mfma_f32_16x16x32_bf16 v[36:39], a[200:203], v[52:55], v[36:39]
  s_waitcnt lgkmcnt(2)
  v_mfma_f32_16x16x32_bf16 v[16:19], a[204:207], v[56:59], v[16:19]
  ds_read_b128 v[48:51], v11 offset:2048
  v_mfma_f32_16x16x32_bf16 v[24:27], a[208:211], v[56:59], v[24:27]
  buffer_load_dwordx4 v1, s[4:7], s35 offen offset:1024 sc1 lds
  v_mfma_f32_16x16x32_bf16 v[32:35], a[212:215], v[56:59], v[32:35]
  v_mfma_f32_16x16x32_bf16 v[20:23], a[204:207], v[60:63], v[20:23]
  ds_read_b128 v[52:55], v11 offset:2304
  v_mfma_f32_16x16x32_bf16 v[28:31], a[208:211], v[60:63], v[28:31]
  v_mfma_f32_16x16x32_bf16 v[36:39], a[212:215], v[60:63], v[36:39]
  s_waitcnt lgkmcnt(2)
  v_mfma_f32_16x16x32_bf16 v[16:19], a[216:219], v[40:43], v[16:19]
  ds_read_b128 v[56:59], v11 offset:4096
  v_mfma_f32_16x16x32_bf16 v[24:27], a[220:223], v[40:43], v[24:27]
  buffer_load_dwordx4 v1, s[4:7], s35 offen offset:2048 sc1 lds
  v_mfma_f32_16x16x32_bf16 v[32:35], a[224:227], v[40:43], v[32:35]
  v_mfma_f32_16x16x32_bf16 v[20:23], a[216:219], v[44:47], v[20:23]
  ds_read_b128 v[60:63], v11 offset:4352
  v_mfma_f32_16x16x32_bf16 v[28:31], a[220:223], v[44:47], v[28:31]
  v_mfma_f32_16x16x32_bf16 v[36:39], a[224:227], v[44:47], v[36:39]
  s_waitcnt lgkmcnt(2)
  v_mfma_f32_16x16x32_bf16 v[16:19], a[228:231], v[48:51], v[16:19]
  ds_read_b128 v[40:43], v11 offset:6144
  v_mfma_f32_16x16x32_bf16 v[24:27], a[232:235], v[48:51], v[24:27]
  buffer_load_dwordx4 v1, s[4:7], s35 offen offset:3072 sc1 lds
  v_mfma_f32_16x16x32_bf16 v[32:35], a[236:239], v[48:51], v[32:35]
  v_mfma_f32_16x16x32_bf16 v[20:23], a[228:231], v[52:55], v[20:23]
  ds_read_b128 v[44:47], v11 offset:6400
  v_mfma_f32_16x16x32_bf16 v[28:31], a[232:235], v[52:55], v[28:31]
  v_mfma_f32_16x16x32_bf16 v[36:39], a[236:239], v[52:55], v[36:39]
  s_waitcnt lgkmcnt(2)
  v_mfma_f32_16x16x32_bf16 v[16:19], a[240:243], v[56:59], v[16:19]
  ds_read_b128 v[48:51], v11 offset:8192
  v_mfma_f32_16x16x32_bf16 v[24:27], a[244:247], v[56:59], v[24:27]
  s_add_u32 m0, s34, 4096
  s_add_u32 s35, s33, 4096
  buffer_load_dwordx4 v1, s[4:7], s35 offen offset:0 sc1 lds
  v_mfma_f32_16x16x32_bf16 v[32:35], a[248:251], v[56:59], v[32:35]
  v_mfma_f32_16x16x32_bf16 v[20:23], a[240:243], v[60:63], v[20:23]
  ds_read_b128 v[52:55], v11 offset:8448
  v_mfma_f32_16x16x32_bf16 v[28:31], a[244:247], v[60:63], v[28:31]
  v_mfma_f32_16x16x32_bf16 v[36:39], a[248:251], v[60:63], v[36:39]
  s_waitcnt lgkmcnt(2)
  v_mfma_f32_16x16x32_bf16 v[16:19], a[252:255], v[40:43], v[16:19]
  ds_read_b128 v[56:59], v11 offset:10240
  v_mfma_f32_16x16x32_bf16 v[24:27], v[80:83], v[40:43], v[24:27]
  buffer_load_dwordx4 v1, s[4:7], s35 offen offset:1024 sc1 lds
  v_mfma_f32_16x16x32_bf16 v[32:35], v[84:87], v[40:43], v[32:35]
  v_mfma_f32_16x16x32_bf16 v[20:23], a[252:255], v[44:47], v[20:23]
  ds_read_b128 v[60:63], v11 offset:10496
  v_mfma_f32_16x16x32_bf16 v[28:31], v[80:83], v[44:47], v[28:31]
  v_mfma_f32_16x16x32_bf16 v[36:39], v[84:87], v[44:47], v[36:39]
  s_waitcnt lgkmcnt(2)
  v_mfma_f32_16x16x32_bf16 v[16:19], v[88:91], v[48:51], v[16:19]
  ds_read_b128 v[40:43], v11 offset:12288
  v_mfma_f32_16x16x32_bf16 v[24:27], v[92:95], v[48:51], v[24:27]
  buffer_load_dwordx4 v1, s[4:7], s35 offen offset:2048 sc1 lds
  v_mfma_f32_16x16x32_bf16 v[32:35], v[96:99], v[48:51], v[32:35]
  v_mfma_f32_16x16x32_bf16 v[20:23], v[88:91], v[52:55], v[20:23]
  ds_read_b128 v[44:47], v11 offset:12544
  v_mfma_f32_16x16x32_bf16 v[28:31], v[92:95], v[52:55], v[28:31]
  v_mfma_f32_16x16x32_bf16 v[36:39], v[96:99], v[52:55], v[36:39]
  s_waitcnt lgkmcnt(2)
  v_mfma_f32_16x16x32_bf16 v[16:19], v[100:103], v[56:59], v[16:19]
  ds_read_b128 v[48:51], v11 offset:14336
  v_mfma_f32_16x16x32_bf16 v[24:27], v[104:107], v[56:59], v[24:27]
  buffer_load_dwordx4 v1, s[4:7], s35 offen offset:3072 sc1 lds
  v_mfma_f32_16x16x32_bf16 v[32:35], v[108:111], v[56:59], v[32:35]
  v_mfma_f32_16x16x32_bf16 v[20:23], v[100:103], v[60:63], v[20:23]
  ds_read_b128 v[52:55], v11 offset:14592
  v_mfma_f32_16x16x32_bf16 v[28:31], v[104:107], v[60:63], v[28:31]
  v_mfma_f32_16x16x32_bf16 v[36:39], v[108:111], v[60:63], v[36:39]
  s_waitcnt lgkmcnt(2)
  v_mfma_f32_16x16x32_bf16 v[16:19], v[112:115], v[40:43], v[16:19]
  ds_read_b128 v[56:59], v11 offset:16384
  v_mfma_f32_16x16x32_bf16 v[24:27], v[116:119], v[40:43], v[24:27]
  s_add_u32 m0, s34, 8192
  s_add_u32 s35, s33, 1056768
  buffer_load_dwordx4 v1, s[4:7], s35 offen offset:0 sc1 lds
  v_mfma_f32_16x16x32_bf16 v[32:35], v[120:123], v[40:43], v[32:35]
  v_mfma_f32_16x16x32_bf16 v[20:23], v[112:115], v[44:47], v[20:23]
  ds_read_b128 v[60:63], v11 offset:16640
  v_mfma_f32_16x16x32_bf16 v[28:31], v[116:119], v[44:47], v[28:31]
  v_mfma_f32_16x16x32_bf16 v[36:39], v[120:123], v[44:47], v[36:39]
  s_waitcnt lgkmcnt(2)
  v_mfma_f32_16x16x32_bf16 v[16:19], v[124:127], v[48:51], v[16:19]
  ds_read_b128 v[40:43], v11 offset:18432
  v_mfma_f32_16x16x32_bf16 v[24:27], v[128:131], v[48:51], v[24:27]
  buffer_load_dwordx4 v1, s[4:7], s35 offen offset:1024 sc1 lds
  v_mfma_f32_16x16x32_bf16 v[32:35], v[132:135], v[48:51], v[32:35]
  v_mfma_f32_16x16x32_bf16 v[20:23], v[124:127], v[52:55], v[20:23]
  ds_read_b128 v[44:47], v11 offset:18688
  v_mfma_f32_16x16x32_bf16 v[28:31], v[128:131], v[52:55], v[28:31]
  v_mfma_f32_16x16x32_bf16 v[36:39], v[132:135], v[52:55], v[36:39]
  s_waitcnt lgkmcnt(2)
  v_mfma_f32_16x16x32_bf16 v[16:19], v[136:139], v[56:59], v[16:19]
  ds_read_b128 v[48:51], v11 offset:20480
  v_mfma_f32_16x16x32_bf16 v[24:27], v[140:143], v[56:59], v[24:27]
  buffer_load_dwordx4 v1, s[4:7], s35 offen offset:2048 sc1 lds
  v_mfma_f32_16x16x32_bf16 v[32:35], v[144:147], v[56:59], v[32:35]
  v_mfma_f32_16x16x32_bf16 v[20:23], v[136:139], v[60:63], v[20:23]
  ds_read_b128 v[52:55], v11 offset:20736
  v_mfma_f32_16x16x32_bf16 v[28:31], v[140:143], v[60:63], v[28:31]
  s_mov_b64 exec, s[48:49]
  buffer_load_dword v9, v7, s[4:7], 0 offen sc1
  s_mov_b64 exec, -1
  v_mfma_f32_16x16x32_bf16 v[36:39], v[144:147], v[60:63], v[36:39]
  s_waitcnt lgkmcnt(2)
  v_mfma_f32_16x16x32_bf16 v[16:19], v[148:151], v[40:43], v[16:19]
  ds_read_b128 v[56:59], v11 offset:22528
  v_mfma_f32_16x16x32_bf16 v[24:27], v[152:155], v[40:43], v[24:27]
  buffer_load_dwordx4 v1, s[4:7], s35 offen offset:3072 sc1 lds
  v_mfma_f32_16x16x32_bf16 v[32:35], v[156:159], v[40:43], v[32:35]
  v_mfma_f32_16x16x32_bf16 v[20:23], v[148:151], v[44:47], v[20:23]
  ds_read_b128 v[60:63], v11 offset:22784
  v_mfma_f32_16x16x32_bf16 v[28:31], v[152:155], v[44:47], v[28:31]
  v_mfma_f32_16x16x32_bf16 v[36:39], v[156:159], v[44:47], v[36:39]
  s_waitcnt lgkmcnt(2)
  v_mfma_f32_16x16x32_bf16 v[16:19], v[160:163], v[48:51], v[16:19]
  ds_read_b128 v[40:43], v11 offset:24576
  v_mfma_f32_16x16x32_bf16 v[24:27], v[164:167], v[48:51], v[24:27]
  s_add_u32 m0, s34, 12288
  s_add_u32 s35, s33, 1060864
  buffer_load_dwordx4 v1, s[4:7], s35 offen offset:0 sc1 lds
  v_mfma_f32_16x16x32_bf16 v[32:35], v[168:171], v[48:51], v[32:35]
  v_mfma_f32_16x16x32_bf16 v[20:23], v[160:163], v[52:55], v[20:23]
  ds_read_b128 v[44:47], v11 offset:24832
  v_mfma_f32_16x16x32_bf16 v[28:31], v[164:167], v[52:55], v[28:31]
  v_mfma_f32_16x16x32_bf16 v[36:39], v[168:171], v[52:55], v[36:39]
  s_waitcnt lgkmcnt(2)
  v_mfma_f32_16x16x32_bf16 v[16:19], v[172:175], v[56:59], v[16:19]
  ds_read_b128 v[48:51], v11 offset:26624
  v_mfma_f32_16x16x32_bf16 v[24:27], v[176:179], v[56:59], v[24:27]
  buffer_load_dwordx4 v1, s[4:7], s35 offen offset:1024 sc1 lds
  v_mfma_f32_16x16x32_bf16 v[32:35], v[180:183], v[56:59], v[32:35]
  v_mfma_f32_16x16x32_bf16 v[20:23], v[172:175], v[60:63], v[20:23]
  ds_read_b128 v[52:55], v11 offset:26880
  v_mfma_f32_16x16x32_bf16 v[28:31], v[176:179], v[60:63], v[28:31]
  v_mfma_f32_16x16x32_bf16 v[36:39], v[180:183], v[60:63], v[36:39]
  s_waitcnt lgkmcnt(2)
  v_mfma_f32_16x16x32_bf16 v[16:19], v[184:187], v[40:43], v[16:19]
  v_mfma_f32_16x16x32_bf16 v[24:27], v[188:191], v[40:43], v[24:27]
  buffer_load_dwordx4 v1, s[4:7], s35 offen offset:2048 sc1 lds
  v_mfma_f32_16x16x32_bf16 v[32:35], v[192:195], v[40:43], v[32:35]
  v_mfma_f32_16x16x32_bf16 v[20:23], v[184:187], v[44:47], v[20:23]
  v_mfma_f32_16x16x32_bf16 v[28:31], v[188:191], v[44:47], v[28:31]
  v_mfma_f32_16x16x32_bf16 v[36:39], v[192:195], v[44:47], v[36:39]
  s_waitcnt lgkmcnt(0)
  v_mfma_f32_16x16x32_bf16 v[16:19], v[196:199], v[48:51], v[16:19]
  v_mfma_f32_16x16x32_bf16 v[24:27], v[200:203], v[48:51], v[24:27]
  buffer_load_dwordx4 v1, s[4:7], s35 offen offset:3072 sc1 lds
  v_mfma_f32_16x16x32_bf16 v[32:35], v[204:207], v[48:51], v[32:35]
  v_mfma_f32_16x16x32_bf16 v[20:23], v[196:199], v[52:55], v[20:23]
  v_mfma_f32_16x16x32_bf16 v[28:31], v[200:203], v[52:55], v[28:31]
  v_mfma_f32_16x16x32_bf16 v[36:39], v[204:207], v[52:55], v[36:39]
  v_cvt_pk_bf16_f32 v40, v16, v17
  v_cvt_pk_bf16_f32 v41, v18, v19
  v_cvt_pk_bf16_f32 v42, v20, v21
  v_cvt_pk_bf16_f32 v43, v22, v23
  ds_write_b128 v3, v[40:43] offset:0
  v_cvt_pk_bf16_f32 v44, v24, v25
  v_cvt_pk_bf16_f32 v45, v26, v27
  v_cvt_pk_bf16_f32 v46, v28, v29
  v_cvt_pk_bf16_f32 v47, v30, v31
  ds_write_b128 v3, v[44:47] offset:64
  v_cvt_pk_bf16_f32 v48, v32, v33
  v_cvt_pk_bf16_f32 v49, v34, v35
  v_cvt_pk_bf16_f32 v50, v36, v37
  v_cvt_pk_bf16_f32 v51, v38, v39
  ds_write_b128 v3, v[48:51] offset:128
  s_mov_b32 s38, s37
  v_add_u32 v10, s45, v10
  v_add_u32 v11, s45, v11
  s_sub_u32 s45, 0, s45
  s_bfe_u32 s35, s32, 0x10006
  s_lshl_b32 s35, s35, 2
  s_add_u32 s47, s46, s35
  s_and_b32 s50, s32, 63
  s_add_u32 s50, s50, 1
  s_waitcnt lgkmcnt(0)
  s_barrier
  s_waitcnt vmcnt(0)
  s_branch L_wo_run
L_wo_w48:
  v_mfma_f32_16x16x32_bf16 v[16:19], v[112:115], v[40:43], v[16:19]
  ds_read_b128 v[56:59], v11 offset:16384
  v_mfma_f32_16x16x32_bf16 v[24:27], v[116:119], v[40:43], v[24:27]
  s_add_u32 m0, s34, 0
  s_add_u32 s35, s33, 0
  buffer_load_dwordx4 v1, s[4:7], s35 offen offset:0 sc1 lds
  v_mfma_f32_16x16x32_bf16 v[32:35], v[120:123], v[40:43], v[32:35]
  v_mfma_f32_16x16x32_bf16 v[20:23], v[112:115], v[44:47], v[20:23]
  ds_read_b128 v[60:63], v11 offset:16640
  v_mfma_f32_16x16x32_bf16 v[28:31], v[116:119], v[44:47], v[28:31]
  buffer_load_dwordx4 v1, s[4:7], s35 offen offset:1024 sc1 lds
  v_mfma_f32_16x16x32_bf16 v[36:39], v[120:123], v[44:47], v[36:39]
  s_waitcnt lgkmcnt(2)
  v_mfma_f32_16x16x32_bf16 v[16:19], v[124:127], v[48:51], v[16:19]
  ds_read_b128 v[40:43], v11 offset:18432
  v_mfma_f32_16x16x32_bf16 v[24:27], v[128:131], v[48:51], v[24:27]
  buffer_load_dwordx4 v1, s[4:7], s35 offen offset:2048 sc1 lds
  v_mfma_f32_16x16x32_bf16 v[32:35], v[132:135], v[48:51], v[32:35]
  v_mfma_f32_16x16x32_bf16 v[20:23], v[124:127], v[52:55], v[20:23]
  ds_read_b128 v[44:47], v11 offset:18688
  v_mfma_f32_16x16x32_bf16 v[28:31], v[128:131], v[52:55], v[28:31]
  buffer_load_dwordx4 v1, s[4:7], s35 offen offset:3072 sc1 lds
  v_mfma_f32_16x16x32_bf16 v[36:39], v[132:135], v[52:55], v[36:39]
  s_waitcnt lgkmcnt(2)
  v_mfma_f32_16x16x32_bf16 v[16:19], v[136:139], v[56:59], v[16:19]
  ds_read_b128 v[48:51], v11 offset:20480
  v_mfma_f32_16x16x32_bf16 v[24:27], v[140:143], v[56:59], v[24:27]
  s_add_u32 m0, s34, 4096
  s_add_u32 s35, s33, 4096
  buffer_load_dwordx4 v1, s[4:7], s35 offen offset:0 sc1 lds
  v_mfma_f32_16x16x32_bf16 v[32:35], v[144:147], v[56:59], v[32:35]
  v_mfma_f32_16x16x32_bf16 v[20:23], v[136:139], v[60:63], v[20:23]
  ds_read_b128 v[52:55], v11 offset:20736
  v_mfma_f32_16x16x32_bf16 v[28:31], v[140:143], v[60:63], v[28:31]
  buffer_load_dwordx4 v1, s[4:7], s35 offen offset:1024 sc1 lds
  s_mov_b64 exec, s[48:49]
  buffer_load_dword v9, v7, s[4:7], 0 offen sc1
  s_mov_b64 exec, -1
  v_mfma_f32_16x16x32_bf16 v[36:39], v[144:147], v[60:63], v[36:39]
  s_waitcnt lgkmcnt(2)
  v_mfma_f32_16x16x32_bf16 v[16:19], v[148:151], v[40:43], v[16:19]
  ds_read_b128 v[56:59], v11 offset:22528
  v_mfma_f32_16x16x32_bf16 v[24:27], v[152:155], v[40:43], v[24:27]
  buffer_load_dwordx4 v1, s[4:7], s35 offen offset:2048 sc1 lds
  v_mfma_f32_16x16x32_bf16 v[32:35], v[156:159], v[40:43], v[32:35]
  v_mfma_f32_16x16x32_bf16 v[20:23], v[148:151], v[44:47], v[20:23]
  ds_read_b128 v[60:63], v11 offset:22784
  v_mfma_f32_16x16x32_bf16 v[28:31], v[152:155], v[44:47], v[28:31]
  buffer_load_dwordx4 v1, s[4:7], s35 offen offset:3072 sc1 lds
  v_mfma_f32_16x16x32_bf16 v[36:39], v[156:159], v[44:47], v[36:39]
  s_waitcnt lgkmcnt(2)
  v_mfma_f32_16x16x32_bf16 v[16:19], v[160:163], v[48:51], v[16:19]
  ds_read_b128 v[40:43], v11 offset:24576
  v_mfma_f32_16x16x32_bf16 v[24:27], v[164:167], v[48:51], v[24:27]
  s_add_u32 m0, s34, 8192
  s_add_u32 s35, s33, 1056768
  buffer_load_dwordx4 v1, s[4:7], s35 offen offset:0 sc1 lds
  v_mfma_f32_16x16x32_bf16 v[32:35], v[168:171], v[48:51], v[32:35]
  v_mfma_f32_16x16x32_bf16 v[20:23], v[160:163], v[52:55], v[20:23]
  ds_read_b128 v[44:47], v11 offset:24832
  v_mfma_f32_16x16x32_bf16 v[28:31], v[164:167], v[52:55], v[28:31]
  buffer_load_dwordx4 v1, s[4:7], s35 offen offset:1024 sc1 lds
  v_mfma_f32_16x16x32_bf16 v[36:39], v[168:171], v[52:55], v[36:39]
  s_waitcnt lgkmcnt(2)
  v_mfma_f32_16x16x32_bf16 v[16:19], v[172:175], v[56:59], v[16:19]
  ds_read_b128 v[48:51], v11 offset:26624
  v_mfma_f32_16x16x32_bf16 v[24:27], v[176:179], v[56:59], v[24:27]
  buffer_load_dwordx4 v1, s[4:7], s35 offen offset:2048 sc1 lds
  v_mfma_f32_16x16x32_bf16 v[32:35], v[180:183], v[56:59], v[32:35]
  v_mfma_f32_16x16x32_bf16 v[20:23], v[172:175], v[60:63], v[20:23]
  ds_read_b128 v[52:55], v11 offset:26880
  v_mfma_f32_16x16x32_bf16 v[28:31], v[176:179], v[60:63], v[28:31]
  buffer_load_dwordx4 v1, s[4:7], s35 offen offset:3072 sc1 lds
  v_mfma_f32_16x16x32_bf16 v[36:39], v[180:183], v[60:63], v[36:39]
  s_waitcnt lgkmcnt(2)
  v_mfma_f32_16x16x32_bf16 v[16:19], v[184:187], v[40:43], v[16:19]
  v_mfma_f32_16x16x32_bf16 v[24:27], v[188:191], v[40:43], v[24:27]
  s_add_u32 m0, s34, 12288
  s_add_u32 s35, s33, 1060864
  buffer_load_dwordx4 v1, s[4:7], s35 offen offset:0 sc1 lds
  v_mfma_f32_16x16x32_bf16 v[32:35], v[192:195], v[40:43], v[32:35]
  v_mfma_f32_16x16x32_bf16 v[20:23], v[184:187], v[44:47], v[20:23]
  v_mfma_f32_16x16x32_bf16 v[28:31], v[188:191], v[44:47], v[28:31]
  buffer_load_dwordx4 v1, s[4:7], s35 offen offset:1024 sc1 lds
  v_mfma_f32_16x16x32_bf16 v[36:39], v[192:195], v[44:47], v[36:39]
  s_waitcnt lgkmcnt(0)
  v_mfma_f32_16x16x32_bf16 v[16:19], v[196:199], v[48:51], v[16:19]
  v_mfma_f32_16x16x32_bf16 v[24:27], v[200:203], v[48:51], v[24:27]
  buffer_load_dwordx4 v1, s[4:7], s35 offen offset:2048 sc1 lds
  v_mfma_f32_16x16x32_bf16 v[32:35], v[204:207], v[48:51], v[32:35]
  v_mfma_f32_16x16x32_bf16 v[20:23], v[196:199], v[52:55], v[20:23]
  v_mfma_f32_16x16x32_bf16 v[28:31], v[200:203], v[52:55], v[28:31]
  buffer_load_dwordx4 v1, s[4:7], s35 offen offset:3072 sc1 lds
  v_mfma_f32_16x16x32_bf16 v[36:39], v[204:207], v[52:55], v[36:39]
  v_cvt_pk_bf16_f32 v40, v16, v17
  v_cvt_pk_bf16_f32 v41, v18, v19
  v_cvt_pk_bf16_f32 v42, v20, v21
  v_cvt_pk_bf16_f32 v43, v22, v23
  ds_write_b128 v3, v[40:43] offset:0
  v_cvt_pk_bf16_f32 v44, v24, v25
  v_cvt_pk_bf16_f32 v45, v26, v27
  v_cvt_pk_bf16_f32 v46, v28, v29
  v_cvt_pk_bf16_f32 v47, v30, v31
  ds_write_b128 v3, v[44:47] offset:64
  v_cvt_pk_bf16_f32 v48, v32, v33
  v_cvt_pk_bf16_f32 v49, v34, v35
  v_cvt_pk_bf16_f32 v50, v36, v37
  v_cvt_pk_bf16_f32 v51, v38, v39
  ds_write_b128 v3, v[48:51] offset:128
  s_mov_b32 s38, s37
  v_add_u32 v10, s45, v10
  v_add_u32 v11, s45, v11
  s_sub_u32 s45, 0, s45
  s_bfe_u32 s35, s32, 0x10006
  s_lshl_b32 s35, s35, 2
  s_add_u32 s47, s46, s35
  s_and_b32 s50, s32, 63
  s_add_u32 s50, s50, 1
  s_waitcnt lgkmcnt(0)
  s_barrier
  s_waitcnt vmcnt(0)
  s_branch L_wo_run
L_fail_wo:
  s_mov_b64 exec, 1
  v_mov_b32 v0, 88
  v_mov_b32 v1, 1
  buffer_atomic_add v1, v0, s[20:23], 0 offen
  s_endpgm
L_util:
  s_waitcnt vmcnt(0)
  s_barrier
  s_cmp_lg_u32 s24, 0
  s_cbranch_scc1 Lsi_27
  s_mov_b64 exec, 1
  v_mov_b32 v1, 128
  v_mov_b32 v2, 1
  buffer_atomic_add v2, v1, s[20:23], 0 offen
  s_mov_b64 exec, -1
Lsi_27:
  s_and_b32 s30, s28, 1
  s_lshl_b32 s30, s30, 1
  s_add_u32 s30, s30, s24
  s_cmp_lt_u32 s30, 2
  s_cbranch_scc1 L_att
  s_add_u32 s30, s62, s24
  s_and_b32 s31, s28, 1
  s_lshl_b32 s31, s31, 1
  s_add_u32 s30, s30, s31
  s_sub_u32 s30, s30, 2
  s_cmp_ge_u32 s30, 64
  s_cbranch_scc1 L_red0_end
  s_and_b32 s31, s30, 3
  s_lshr_b32 s32, s30, 2
  s_mov_b32 s50, 0x00003f80
  s_mov_b32 s51, 0x3f800000
  s_mov_b32 s52, 0x3f803f80
  s_mov_b32 s8, s64
  s_and_b32 s9, s65, 0xffff
  s_mov_b32 s10, 0x240000
  s_mov_b32 s11, 0x20000
  s_mov_b32 s12, s88
  s_and_b32 s13, s89, 0xffff
  s_mov_b32 s14, 0x240000
  s_mov_b32 s15, 0x20000
  s_mov_b32 s16, s86
  s_and_b32 s17, s87, 0xffff
  s_mov_b32 s18, 0x480
  s_mov_b32 s19, 0x20000
  v_lshrrev_b32 v8, 5, v0
  v_and_b32 v9, 15, v0
  v_lshrrev_b32 v7, 4, v0
  s_mul_i32 s34, s32, 2304
  v_mul_u32_u24 v3, 36864, v7
  v_lshl_add_u32 v3, v9, 4, v3
  v_add_u32 v3, s34, v3
  v_lshl_add_u32 v2, v0, 4, s34
  s_add_u32 s33, s34, 2048
  v_lshl_add_u32 v11, v0, 2, s33
  v_and_b32 v15, 1, v7
  v_lshlrev_b32 v15, 2, v15
  v_lshl_add_u32 v15, v9, 3, v15
  s_mul_i32 s34, s32, 1152
  v_mul_u32_u24 v1, 18432, v8
  v_add3_u32 v10, v1, v15, s34
  s_lshl_b32 s33, s24, 12
  v_mul_u32_u24 v14, 1152, v8
  v_add3_u32 v13, v14, v15, s33
  v_and_b32 v9, 31, v0
  v_lshl_add_u32 v14, v9, 4, v14
  v_add_u32 v14, s33, v14
  v_lshl_add_u32 v1, v9, 4, v1
  v_add_u32 v1, s34, v1
  v_mov_b32 v6, 0x40000000
  v_cmp_gt_u32 vcc, 24, v9
  s_nop 1
  v_cndmask_b32 v1, v6, v1, vcc
  v_mov_b32 v12, 0x3727c5ac
  v_mov_b32 v6, 0x3f80
  v_and_b32 v9, 1, v0
  v_cmp_eq_u32 vcc, 1, v9
  s_nop 1
  v_cndmask_b32 v6, v6, 1.0, vcc
  s_mov_b32 s54, 0x30003
  s_mov_b32 s55, s54
  v_cndmask_b32 v144, 0, v6, s[54:55]
  s_mov_b32 s54, 0x300030
  s_mov_b32 s55, s54
  v_cndmask_b32 v145, 0, v6, s[54:55]
  s_mov_b32 s54, 0x3000300
  s_mov_b32 s55, s54
  v_cndmask_b32 v146, 0, v6, s[54:55]
  s_mov_b32 s54, 0x30003000
  s_mov_b32 s55, s54
  v_cndmask_b32 v147, 0, v6, s[54:55]
  v_mov_b64 v[66:67], 0
  v_mov_b64 v[70:71], 0
  v_mov_b64 v[74:75], 0
  v_mov_b64 v[78:79], 0
  v_mov_b64 v[82:83], 0
  v_mov_b64 v[86:87], 0
  v_mov_b64 v[90:91], 0
  v_mov_b64 v[94:95], 0
  v_mov_b64 v[98:99], 0
  v_lshlrev_b32 v4, 9, v0
  s_lshr_b32 s34, s32, 2
  s_lshl_b32 s34, s34, 7
  v_add_u32 v4, s34, v4
  s_add_u32 s58, s92, s34
  s_addc_u32 s59, s93, 0
  s_lshl_b32 s46, s31, 4
  s_add_u32 s46, s46, s32
  s_lshl_b32 s46, s46, 7
  s_add_u32 s46, s46, 49152
  v_mov_b32 v5, 0
  buffer_load_dword v16, v15, s[16:19], 0 offen offset:0
  buffer_load_dword v17, v15, s[16:19], 0 offen offset:128
  buffer_load_dword v18, v15, s[16:19], 0 offen offset:256
  buffer_load_dword v19, v15, s[16:19], 0 offen offset:384
  buffer_load_dword v20, v15, s[16:19], 0 offen offset:512
  buffer_load_dword v21, v15, s[16:19], 0 offen offset:640
  buffer_load_dword v22, v15, s[16:19], 0 offen offset:768
  buffer_load_dword v23, v15, s[16:19], 0 offen offset:896
  buffer_load_dword v24, v15, s[16:19], 0 offen offset:1024
  s_waitcnt vmcnt(0)
  v_lshlrev_b32 v100, 16, v16
  v_and_b32 v101, 0xffff0000, v16
  v_lshlrev_b32 v102, 16, v17
  v_and_b32 v103, 0xffff0000, v17
  v_lshlrev_b32 v104, 16, v18
  v_and_b32 v105, 0xffff0000, v18
  v_lshlrev_b32 v106, 16, v19
  v_and_b32 v107, 0xffff0000, v19
  v_lshlrev_b32 v108, 16, v20
  v_and_b32 v109, 0xffff0000, v20
  v_lshlrev_b32 v110, 16, v21
  v_and_b32 v111, 0xffff0000, v21
  v_lshlrev_b32 v112, 16, v22
  v_and_b32 v113, 0xffff0000, v22
  v_lshlrev_b32 v114, 16, v23
  v_and_b32 v115, 0xffff0000, v23
  v_lshlrev_b32 v116, 16, v24
  v_and_b32 v117, 0xffff0000, v24
  v_mov_b32 v190, -1
  v_mul_u32_u24 v191, 8320, v0
  s_mov_b32 s35, s31
  s_mul_i32 s37, s35, 36864
  v_mov_b32 v192, 128
  v_mov_b32 v193, 0
  s_add_u32 s40, s46, 4
  buffer_load_dword v16, v10, s[8:11], s37 offen offset:0
  buffer_load_dword v17, v10, s[8:11], s37 offen offset:128
  buffer_load_dword v18, v10, s[8:11], s37 offen offset:256
  buffer_load_dword v19, v10, s[8:11], s37 offen offset:384
  buffer_load_dword v20, v10, s[8:11], s37 offen offset:512
  buffer_load_dword v21, v10, s[8:11], s37 offen offset:640
  buffer_load_dword v22, v10, s[8:11], s37 offen offset:768
  buffer_load_dword v23, v10, s[8:11], s37 offen offset:896
  buffer_load_dword v24, v10, s[8:11], s37 offen offset:1024
L_ln0:
  s_add_u32 s36, s37, 147456
  buffer_load_dword v28, v10, s[8:11], s36 offen offset:0
  buffer_load_dword v29, v10, s[8:11], s36 offen offset:128
  buffer_load_dword v30, v10, s[8:11], s36 offen offset:256
  buffer_load_dword v31, v10, s[8:11], s36 offen offset:384
  buffer_load_dword v32, v10, s[8:11], s36 offen offset:512
  buffer_load_dword v33, v10, s[8:11], s36 offen offset:640
  buffer_load_dword v34, v10, s[8:11], s36 offen offset:768
  buffer_load_dword v35, v10, s[8:11], s36 offen offset:896
  buffer_load_dword v36, v10, s[8:11], s36 offen offset:1024
  s_waitcnt vmcnt(9)
  v_readfirstlane_b32 s38, v193
  s_cmp_ge_u32 s38, 0x100
  s_cselect_b32 s41, s40, 0x40000000
  s_sub_u32 s39, s35, 4
  s_add_u32 s98, s39, 1
  v_mov_b32 v6, s98
  s_mov_b64 exec, 255
  buffer_store_dword v6, v191, s[4:7], s41 offen sc1
  s_mov_b64 exec, -1
  s_mov_b64 exec, 1
  buffer_load_dword v193, v192, s[20:23], 0 offen sc1
  s_mov_b64 exec, -1
  s_add_u32 s38, s37, 2965504
  s_add_u32 s37, s37, 17121280
  buffer_store_dwordx4 v[16:19], v2, s[4:7], s37 offen offset:0 sc1
  buffer_store_dwordx4 v[20:23], v2, s[4:7], s37 offen offset:1024 sc1
  buffer_store_dword v24, v11, s[4:7], s37 offen sc1
  v_dot2_f32_bf16 v8, v16, s52, 0
  v_dot2_f32_bf16 v9, v17, s52, 0
  v_dot2_f32_bf16 v8, v18, s52, v8
  v_dot2_f32_bf16 v9, v19, s52, v9
  v_dot2_f32_bf16 v8, v20, s52, v8
  v_dot2_f32_bf16 v9, v21, s52, v9
  v_dot2_f32_bf16 v8, v22, s52, v8
  v_dot2_f32_bf16 v9, v23, s52, v9
  v_dot2_f32_bf16 v8, v24, s52, v8
  s_nop 2
  v_add_f32 v8, v8, v9
  s_nop 1
  v_add_f32_dpp v8, v8, v8 row_ror:8 row_mask:0xf bank_mask:0xf
  s_nop 1
  v_add_f32_dpp v8, v8, v8 row_ror:4 row_mask:0xf bank_mask:0xf
  s_nop 1
  v_add_f32_dpp v8, v8, v8 row_ror:2 row_mask:0xf bank_mask:0xf
  s_nop 1
  v_add_f32_dpp v8, v8, v8 row_ror:1 row_mask:0xf bank_mask:0xf
  v_mov_b32 v9, v8
  s_nop 1
  v_permlane16_swap_b32 v8, v9
  v_add_f32 v8, v8, v9
  v_mul_f32 v8, 0xbae38e39, v8
  v_dot2_f32_bf16 v160, v16, s50, v8
  v_dot2_f32_bf16 v161, v16, s51, v8
  v_dot2_f32_bf16 v162, v17, s50, v8
  v_dot2_f32_bf16 v163, v17, s51, v8
  v_dot2_f32_bf16 v164, v18, s50, v8
  v_dot2_f32_bf16 v165, v18, s51, v8
  v_dot2_f32_bf16 v166, v19, s50, v8
  v_dot2_f32_bf16 v167, v19, s51, v8
  v_dot2_f32_bf16 v168, v20, s50, v8
  v_dot2_f32_bf16 v169, v20, s51, v8
  v_dot2_f32_bf16 v170, v21, s50, v8
  v_dot2_f32_bf16 v171, v21, s51, v8
  v_dot2_f32_bf16 v172, v22, s50, v8
  v_dot2_f32_bf16 v173, v22, s51, v8
  v_dot2_f32_bf16 v174, v23, s50, v8
  v_dot2_f32_bf16 v175, v23, s51, v8
  v_dot2_f32_bf16 v176, v24, s50, v8
  v_dot2_f32_bf16 v177, v24, s51, v8
  v_pk_mul_f32 v[180:181], v[160:161], v[160:161]
  v_pk_mul_f32 v[182:183], v[162:163], v[162:163]
  v_pk_fma_f32 v[180:181], v[164:165], v[164:165], v[180:181]
  v_pk_fma_f32 v[182:183], v[166:167], v[166:167], v[182:183]
  v_pk_fma_f32 v[180:181], v[168:169], v[168:169], v[180:181]
  v_pk_fma_f32 v[182:183], v[170:171], v[170:171], v[182:183]
  v_pk_fma_f32 v[180:181], v[172:173], v[172:173], v[180:181]
  v_pk_fma_f32 v[182:183], v[174:175], v[174:175], v[182:183]
  v_pk_fma_f32 v[180:181], v[176:177], v[176:177], v[180:181]
  v_pk_add_f32 v[180:181], v[180:181], v[182:183]
  v_add_f32 v8, v180, v181
  s_nop 1
  v_add_f32_dpp v8, v8, v8 row_ror:8 row_mask:0xf bank_mask:0xf
  s_nop 1
  v_add_f32_dpp v8, v8, v8 row_ror:4 row_mask:0xf bank_mask:0xf
  s_nop 1
  v_add_f32_dpp v8, v8, v8 row_ror:2 row_mask:0xf bank_mask:0xf
  s_nop 1
  v_add_f32_dpp v8, v8, v8 row_ror:1 row_mask:0xf bank_mask:0xf
  v_mov_b32 v9, v8
  s_nop 1
  v_permlane16_swap_b32 v8, v9
  v_add_f32 v8, v8, v9
  v_fmamk_f32 v8, v8, 0x3ae38e39, v12
  v_rsq_f32 v8, v8
  s_nop 0
  v_pk_mul_f32 v[160:161], v[160:161], v[8:9] op_sel_hi:[1,0]
  v_pk_mul_f32 v[162:163], v[162:163], v[8:9] op_sel_hi:[1,0]
  v_pk_mul_f32 v[164:165], v[164:165], v[8:9] op_sel_hi:[1,0]
  v_pk_mul_f32 v[166:167], v[166:167], v[8:9] op_sel_hi:[1,0]
  v_pk_mul_f32 v[168:169], v[168:169], v[8:9] op_sel_hi:[1,0]
  v_pk_mul_f32 v[170:171], v[170:171], v[8:9] op_sel_hi:[1,0]
  v_pk_mul_f32 v[172:173], v[172:173], v[8:9] op_sel_hi:[1,0]
  v_pk_mul_f32 v[174:175], v[174:175], v[8:9] op_sel_hi:[1,0]
  v_pk_mul_f32 v[176:177], v[176:177], v[8:9] op_sel_hi:[1,0]
  v_cvt_pk_bf16_f32 v132, v160, v161
  v_cvt_pk_bf16_f32 v133, v162, v163
  v_cvt_pk_bf16_f32 v134, v164, v165
  v_cvt_pk_bf16_f32 v135, v166, v167
  v_cvt_pk_bf16_f32 v136, v168, v169
  v_cvt_pk_bf16_f32 v137, v170, v171
  v_cvt_pk_bf16_f32 v138, v172, v173
  v_cvt_pk_bf16_f32 v139, v174, v175
  v_cvt_pk_bf16_f32 v140, v176, v177
  ds_write2_b32 v13, v132, v133 offset0:0 offset1:32
  ds_write2_b32 v13, v134, v135 offset0:64 offset1:96
  ds_write2_b32 v13, v136, v137 offset0:128 offset1:160
  ds_write2_b32 v13, v138, v139 offset0:192 offset1:224
  ds_write_b32 v13, v140 offset:1024
  ds_read_b128 v[148:151], v14 offset:0
  ds_read_b128 v[152:155], v14 offset:384
  ds_read_b128 v[156:159], v14 offset:768
  s_waitcnt lgkmcnt(2)
  buffer_store_dwordx4 v[148:151], v1, s[4:7], s38 offen offset:0 sc1
  s_waitcnt lgkmcnt(1)
  buffer_store_dwordx4 v[152:155], v1, s[4:7], s38 offen offset:384 sc1
  s_waitcnt lgkmcnt(0)
  buffer_store_dwordx4 v[156:159], v1, s[4:7], s38 offen offset:768 sc1
  s_mov_b32 s37, s36
  s_add_u32 s35, s35, 4
  s_add_u32 s36, s37, 147456
  buffer_load_dword v16, v10, s[8:11], s36 offen offset:0
  buffer_load_dword v17, v10, s[8:11], s36 offen offset:128
  buffer_load_dword v18, v10, s[8:11], s36 offen offset:256
  buffer_load_dword v19, v10, s[8:11], s36 offen offset:384
  buffer_load_dword v20, v10, s[8:11], s36 offen offset:512
  buffer_load_dword v21, v10, s[8:11], s36 offen offset:640
  buffer_load_dword v22, v10, s[8:11], s36 offen offset:768
  buffer_load_dword v23, v10, s[8:11], s36 offen offset:896
  buffer_load_dword v24, v10, s[8:11], s36 offen offset:1024
  s_waitcnt vmcnt(9)
  v_readfirstlane_b32 s38, v193
  s_cmp_ge_u32 s38, 0x100
  s_cselect_b32 s41, s40, 0x40000000
  s_sub_u32 s39, s35, 4
  s_add_u32 s98, s39, 1
  v_mov_b32 v6, s98
  s_mov_b64 exec, 255
  buffer_store_dword v6, v191, s[4:7], s41 offen sc1
  s_mov_b64 exec, -1
  s_mov_b64 exec, 1
  buffer_load_dword v193, v192, s[20:23], 0 offen sc1
  s_mov_b64 exec, -1
  s_add_u32 s38, s37, 2965504
  s_add_u32 s37, s37, 17121280
  buffer_store_dwordx4 v[28:31], v2, s[4:7], s37 offen offset:0 sc1
  buffer_store_dwordx4 v[32:35], v2, s[4:7], s37 offen offset:1024 sc1
  buffer_store_dword v36, v11, s[4:7], s37 offen sc1
  v_dot2_f32_bf16 v8, v28, s52, 0
  v_dot2_f32_bf16 v9, v29, s52, 0
  v_dot2_f32_bf16 v8, v30, s52, v8
  v_dot2_f32_bf16 v9, v31, s52, v9
  v_dot2_f32_bf16 v8, v32, s52, v8
  v_dot2_f32_bf16 v9, v33, s52, v9
  v_dot2_f32_bf16 v8, v34, s52, v8
  v_dot2_f32_bf16 v9, v35, s52, v9
  v_dot2_f32_bf16 v8, v36, s52, v8
  s_nop 2
  v_add_f32 v8, v8, v9
  s_nop 1
  v_add_f32_dpp v8, v8, v8 row_ror:8 row_mask:0xf bank_mask:0xf
  s_nop 1
  v_add_f32_dpp v8, v8, v8 row_ror:4 row_mask:0xf bank_mask:0xf
  s_nop 1
  v_add_f32_dpp v8, v8, v8 row_ror:2 row_mask:0xf bank_mask:0xf
  s_nop 1
  v_add_f32_dpp v8, v8, v8 row_ror:1 row_mask:0xf bank_mask:0xf
  v_mov_b32 v9, v8
  s_nop 1
  v_permlane16_swap_b32 v8, v9
  v_add_f32 v8, v8, v9
  v_mul_f32 v8, 0xbae38e39, v8
  v_dot2_f32_bf16 v160, v28, s50, v8
  v_dot2_f32_bf16 v161, v28, s51, v8
  v_dot2_f32_bf16 v162, v29, s50, v8
  v_dot2_f32_bf16 v163, v29, s51, v8
  v_dot2_f32_bf16 v164, v30, s50, v8
  v_dot2_f32_bf16 v165, v30, s51, v8
  v_dot2_f32_bf16 v166, v31, s50, v8
  v_dot2_f32_bf16 v167, v31, s51, v8
  v_dot2_f32_bf16 v168, v32, s50, v8
  v_dot2_f32_bf16 v169, v32, s51, v8
  v_dot2_f32_bf16 v170, v33, s50, v8
  v_dot2_f32_bf16 v171, v33, s51, v8
  v_dot2_f32_bf16 v172, v34, s50, v8
  v_dot2_f32_bf16 v173, v34, s51, v8
  v_dot2_f32_bf16 v174, v35, s50, v8
  v_dot2_f32_bf16 v175, v35, s51, v8
  v_dot2_f32_bf16 v176, v36, s50, v8
  v_dot2_f32_bf16 v177, v36, s51, v8
  v_pk_mul_f32 v[180:181], v[160:161], v[160:161]
  v_pk_mul_f32 v[182:183], v[162:163], v[162:163]
  v_pk_fma_f32 v[180:181], v[164:165], v[164:165], v[180:181]
  v_pk_fma_f32 v[182:183], v[166:167], v[166:167], v[182:183]
  v_pk_fma_f32 v[180:181], v[168:169], v[168:169], v[180:181]
  v_pk_fma_f32 v[182:183], v[170:171], v[170:171], v[182:183]
  v_pk_fma_f32 v[180:181], v[172:173], v[172:173], v[180:181]
  v_pk_fma_f32 v[182:183], v[174:175], v[174:175], v[182:183]
  v_pk_fma_f32 v[180:181], v[176:177], v[176:177], v[180:181]
  v_pk_add_f32 v[180:181], v[180:181], v[182:183]
  v_add_f32 v8, v180, v181
  s_nop 1
  v_add_f32_dpp v8, v8, v8 row_ror:8 row_mask:0xf bank_mask:0xf
  s_nop 1
  v_add_f32_dpp v8, v8, v8 row_ror:4 row_mask:0xf bank_mask:0xf
  s_nop 1
  v_add_f32_dpp v8, v8, v8 row_ror:2 row_mask:0xf bank_mask:0xf
  s_nop 1
  v_add_f32_dpp v8, v8, v8 row_ror:1 row_mask:0xf bank_mask:0xf
  v_mov_b32 v9, v8
  s_nop 1
  v_permlane16_swap_b32 v8, v9
  v_add_f32 v8, v8, v9
  v_fmamk_f32 v8, v8, 0x3ae38e39, v12
  v_rsq_f32 v8, v8
  s_nop 0
  v_pk_mul_f32 v[160:161], v[160:161], v[8:9] op_sel_hi:[1,0]
  v_pk_mul_f32 v[162:163], v[162:163], v[8:9] op_sel_hi:[1,0]
  v_pk_mul_f32 v[164:165], v[164:165], v[8:9] op_sel_hi:[1,0]
  v_pk_mul_f32 v[166:167], v[166:167], v[8:9] op_sel_hi:[1,0]
  v_pk_mul_f32 v[168:169], v[168:169], v[8:9] op_sel_hi:[1,0]
  v_pk_mul_f32 v[170:171], v[170:171], v[8:9] op_sel_hi:[1,0]
  v_pk_mul_f32 v[172:173], v[172:173], v[8:9] op_sel_hi:[1,0]
  v_pk_mul_f32 v[174:175], v[174:175], v[8:9] op_sel_hi:[1,0]
  v_pk_mul_f32 v[176:177], v[176:177], v[8:9] op_sel_hi:[1,0]
  v_cvt_pk_bf16_f32 v132, v160, v161
  v_cvt_pk_bf16_f32 v133, v162, v163
  v_cvt_pk_bf16_f32 v134, v164, v165
  v_cvt_pk_bf16_f32 v135, v166, v167
  v_cvt_pk_bf16_f32 v136, v168, v169
  v_cvt_pk_bf16_f32 v137, v170, v171
  v_cvt_pk_bf16_f32 v138, v172, v173
  v_cvt_pk_bf16_f32 v139, v174, v175
  v_cvt_pk_bf16_f32 v140, v176, v177
  ds_write2_b32 v13, v132, v133 offset0:0 offset1:32
  ds_write2_b32 v13, v134, v135 offset0:64 offset1:96
  ds_write2_b32 v13, v136, v137 offset0:128 offset1:160
  ds_write2_b32 v13, v138, v139 offset0:192 offset1:224
  ds_write_b32 v13, v140 offset:1024
  ds_read_b128 v[148:151], v14 offset:0
  ds_read_b128 v[152:155], v14 offset:384
  ds_read_b128 v[156:159], v14 offset:768
  s_waitcnt lgkmcnt(2)
  buffer_store_dwordx4 v[148:151], v1, s[4:7], s38 offen offset:0 sc1
  s_waitcnt lgkmcnt(1)
  buffer_store_dwordx4 v[152:155], v1, s[4:7], s38 offen offset:384 sc1
  s_waitcnt lgkmcnt(0)
  buffer_store_dwordx4 v[156:159], v1, s[4:7], s38 offen offset:768 sc1
  s_mov_b32 s37, s36
  s_add_u32 s35, s35, 4
  s_cmp_lt_u32 s35, 64
  s_cbranch_scc1 L_ln0
  v_mov_b32 v8, 128
Lwi_28:
  buffer_load_dword v9, v8, s[20:23], 0 offen sc1
  s_waitcnt vmcnt(0)
  v_cmp_gt_u32 vcc, 0x100, v9
  s_cbranch_vccz Lwiok_29
  s_add_u32 s60, s60, 1
  s_cmp_gt_u32 s60, 262144
  s_cbranch_scc1 L_fail_red
  s_sleep 4
  s_branch Lwi_28
Lwiok_29:
  s_mov_b32 s41, s40
  s_sub_u32 s39, s35, 4
  s_add_u32 s98, s39, 1
  v_mov_b32 v6, s98
  s_mov_b64 exec, 255
  buffer_store_dword v6, v191, s[4:7], s41 offen sc1
  s_mov_b64 exec, -1
  s_cmp_eq_u32 s31, 1
  s_cbranch_scc1 L_red_g1
  s_cmp_eq_u32 s31, 2
  s_cbranch_scc1 L_red_g2
  s_cmp_eq_u32 s31, 3
  s_cbranch_scc1 L_red_g3
L_red_g0:
  s_mov_b32 s35, 0
  s_mov_b32 s47, 115712
L_red0_poll:
  s_add_u32 s56, s58, s47
  s_addc_u32 s57, s59, 0
  s_load_dword s64, s[56:57], 0 glc
  s_load_dword s65, s[56:57], 512 glc
  s_load_dword s66, s[56:57], 1024 glc
  s_load_dword s67, s[56:57], 1536 glc
  s_load_dword s68, s[56:57], 2048 glc
  s_load_dword s69, s[56:57], 2560 glc
  s_load_dword s70, s[56:57], 3072 glc
  s_load_dword s71, s[56:57], 3584 glc
  s_load_dword s72, s[56:57], 4096 glc
  s_load_dword s73, s[56:57], 4608 glc
  s_load_dword s74, s[56:57], 5120 glc
  s_load_dword s75, s[56:57], 5632 glc
  s_waitcnt lgkmcnt(0)
  s_min_u32 s64, s64, s65
  s_min_u32 s64, s64, s66
  s_min_u32 s64, s64, s67
  s_min_u32 s64, s64, s68
  s_min_u32 s64, s64, s69
  s_min_u32 s64, s64, s70
  s_min_u32 s64, s64, s71
  s_min_u32 s64, s64, s72
  s_min_u32 s64, s64, s73
  s_min_u32 s64, s64, s74
  s_min_u32 s64, s64, s75
  s_cmp_ge_u32 s35, s64
  s_cselect_b64 vcc, -1, 0
  s_cbranch_vccz L_red0_go
  s_add_u32 s60, s60, 1
  s_cmp_gt_u32 s60, 262144
  s_cbranch_scc1 L_fail_red
  s_branch L_red0_poll
L_red0_go:
  s_add_u32 s47, s47, 6144
  s_cmp_ge_u32 s47, 128000
  s_cselect_b32 s47, 115712, s47
  s_mul_i32 s43, s35, 36864
  s_mul_i32 s42, s35, 147456
  s_add_u32 s42, s42, 171655168
  s_add_u32 s43, s43, 17121280
  buffer_load_dwordx4 v[16:19], v2, s[4:7], s43 offen offset:0 sc1
  buffer_load_dwordx4 v[20:23], v2, s[4:7], s43 offen offset:1024 sc1
  buffer_load_dword v24, v11, s[4:7], s43 offen sc1
  buffer_load_dwordx4 v[28:31], v3, s[4:7], s42 offen offset:0 sc1
  buffer_load_dwordx4 v[32:35], v3, s[4:7], s42 offen offset:256 sc1
  buffer_load_dwordx4 v[36:39], v3, s[4:7], s42 offen offset:512 sc1
  buffer_load_dwordx4 v[40:43], v3, s[4:7], s42 offen offset:768 sc1
  buffer_load_dwordx4 v[44:47], v3, s[4:7], s42 offen offset:1024 sc1
  buffer_load_dwordx4 v[48:51], v3, s[4:7], s42 offen offset:1280 sc1
  buffer_load_dwordx4 v[52:55], v3, s[4:7], s42 offen offset:1536 sc1
  buffer_load_dwordx4 v[56:59], v3, s[4:7], s42 offen offset:1792 sc1
  buffer_load_dwordx4 v[60:63], v3, s[4:7], s42 offen offset:2048 sc1
  s_add_u32 s56, s58, s47
  s_addc_u32 s57, s59, 0
  s_load_dword s64, s[56:57], 0 glc
  s_load_dword s65, s[56:57], 512 glc
  s_load_dword s66, s[56:57], 1024 glc
  s_load_dword s67, s[56:57], 1536 glc
  s_load_dword s68, s[56:57], 2048 glc
  s_load_dword s69, s[56:57], 2560 glc
  s_load_dword s70, s[56:57], 3072 glc
  s_load_dword s71, s[56:57], 3584 glc
  s_load_dword s72, s[56:57], 4096 glc
  s_load_dword s73, s[56:57], 4608 glc
  s_load_dword s74, s[56:57], 5120 glc
  s_load_dword s75, s[56:57], 5632 glc
L_red0_sum:
  s_waitcnt vmcnt(9)
  v_dot2_f32_bf16 v64, v16, s50, 0
  v_dot2_f32_bf16 v65, v16, s51, 0
  v_dot2_f32_bf16 v68, v17, s50, 0
  v_dot2_f32_bf16 v69, v17, s51, 0
  v_dot2_f32_bf16 v72, v18, s50, 0
  v_dot2_f32_bf16 v73, v18, s51, 0
  v_dot2_f32_bf16 v76, v19, s50, 0
  v_dot2_f32_bf16 v77, v19, s51, 0
  v_dot2_f32_bf16 v80, v20, s50, 0
  v_dot2_f32_bf16 v81, v20, s51, 0
  v_dot2_f32_bf16 v84, v21, s50, 0
  v_dot2_f32_bf16 v85, v21, s51, 0
  v_dot2_f32_bf16 v88, v22, s50, 0
  v_dot2_f32_bf16 v89, v22, s51, 0
  v_dot2_f32_bf16 v92, v23, s50, 0
  v_dot2_f32_bf16 v93, v23, s51, 0
  v_dot2_f32_bf16 v96, v24, s50, 0
  v_dot2_f32_bf16 v97, v24, s51, 0
  s_waitcnt vmcnt(8)
  v_mfma_f32_16x16x32_bf16 v[64:67], v[144:147], v[28:31], v[64:67]
  s_waitcnt vmcnt(7)
  v_mfma_f32_16x16x32_bf16 v[68:71], v[144:147], v[32:35], v[68:71]
  s_waitcnt vmcnt(6)
  v_mfma_f32_16x16x32_bf16 v[72:75], v[144:147], v[36:39], v[72:75]
  s_waitcnt vmcnt(5)
  v_mfma_f32_16x16x32_bf16 v[76:79], v[144:147], v[40:43], v[76:79]
  s_waitcnt vmcnt(4)
  v_mfma_f32_16x16x32_bf16 v[80:83], v[144:147], v[44:47], v[80:83]
  s_waitcnt vmcnt(3)
  v_mfma_f32_16x16x32_bf16 v[84:87], v[144:147], v[48:51], v[84:87]
  s_waitcnt vmcnt(2)
  v_mfma_f32_16x16x32_bf16 v[88:91], v[144:147], v[52:55], v[88:91]
  s_waitcnt vmcnt(1)
  v_mfma_f32_16x16x32_bf16 v[92:95], v[144:147], v[56:59], v[92:95]
  s_waitcnt vmcnt(0)
  v_mfma_f32_16x16x32_bf16 v[96:99], v[144:147], v[60:63], v[96:99]
  v_cvt_pk_bf16_f32 v120, v64, v65
  v_cvt_pk_bf16_f32 v121, v68, v69
  v_cvt_pk_bf16_f32 v122, v72, v73
  v_cvt_pk_bf16_f32 v123, v76, v77
  v_cvt_pk_bf16_f32 v124, v80, v81
  v_cvt_pk_bf16_f32 v125, v84, v85
  v_cvt_pk_bf16_f32 v126, v88, v89
  v_cvt_pk_bf16_f32 v127, v92, v93
  v_cvt_pk_bf16_f32 v128, v96, v97
  s_add_u32 s36, s35, 1
  s_waitcnt vmcnt(0)
  s_waitcnt lgkmcnt(0)
  s_min_u32 s64, s64, s65
  s_min_u32 s64, s64, s66
  s_min_u32 s64, s64, s67
  s_min_u32 s64, s64, s68
  s_min_u32 s64, s64, s69
  s_min_u32 s64, s64, s70
  s_min_u32 s64, s64, s71
  s_min_u32 s64, s64, s72
  s_min_u32 s64, s64, s73
  s_min_u32 s64, s64, s74
  s_min_u32 s64, s64, s75
  s_cmp_ge_u32 s36, s64
  s_cselect_b64 vcc, -1, 0
  s_cbranch_vccnz L_red0_fin
  s_add_u32 s47, s47, 6144
  s_cmp_ge_u32 s47, 128000
  s_cselect_b32 s47, 115712, s47
  s_mul_i32 s43, s36, 36864
  s_mul_i32 s42, s36, 147456
  s_add_u32 s42, s42, 171655168
  s_add_u32 s43, s43, 17121280
  buffer_load_dwordx4 v[16:19], v2, s[4:7], s43 offen offset:0 sc1
  buffer_load_dwordx4 v[20:23], v2, s[4:7], s43 offen offset:1024 sc1
  buffer_load_dword v24, v11, s[4:7], s43 offen sc1
  buffer_load_dwordx4 v[28:31], v3, s[4:7], s42 offen offset:0 sc1
  buffer_load_dwordx4 v[32:35], v3, s[4:7], s42 offen offset:256 sc1
  buffer_load_dwordx4 v[36:39], v3, s[4:7], s42 offen offset:512 sc1
  buffer_load_dwordx4 v[40:43], v3, s[4:7], s42 offen offset:768 sc1
  buffer_load_dwordx4 v[44:47], v3, s[4:7], s42 offen offset:1024 sc1
  buffer_load_dwordx4 v[48:51], v3, s[4:7], s42 offen offset:1280 sc1
  buffer_load_dwordx4 v[52:55], v3, s[4:7], s42 offen offset:1536 sc1
  buffer_load_dwordx4 v[56:59], v3, s[4:7], s42 offen offset:1792 sc1
  buffer_load_dwordx4 v[60:63], v3, s[4:7], s42 offen offset:2048 sc1
  s_add_u32 s56, s58, s47
  s_addc_u32 s57, s59, 0
  s_load_dword s64, s[56:57], 0 glc
  s_load_dword s65, s[56:57], 512 glc
  s_load_dword s66, s[56:57], 1024 glc
  s_load_dword s67, s[56:57], 1536 glc
  s_load_dword s68, s[56:57], 2048 glc
  s_load_dword s69, s[56:57], 2560 glc
  s_load_dword s70, s[56:57], 3072 glc
  s_load_dword s71, s[56:57], 3584 glc
  s_load_dword s72, s[56:57], 4096 glc
  s_load_dword s73, s[56:57], 4608 glc
  s_load_dword s74, s[56:57], 5120 glc
  s_load_dword s75, s[56:57], 5632 glc
  s_mul_i32 s40, s35, 36864
  s_add_u32 s44, s40, 12402688
  s_add_u32 s45, s40, 7684096
  buffer_store_dwordx4 v[120:123], v2, s[4:7], s44 offen offset:0 sc1
  buffer_store_dwordx4 v[124:127], v2, s[4:7], s44 offen offset:1024 sc1
  buffer_store_dword v128, v11, s[4:7], s44 offen sc1
  v_dot2_f32_bf16 v8, v120, s52, 0
  v_dot2_f32_bf16 v9, v121, s52, 0
  v_dot2_f32_bf16 v8, v122, s52, v8
  v_dot2_f32_bf16 v9, v123, s52, v9
  v_dot2_f32_bf16 v8, v124, s52, v8
  v_dot2_f32_bf16 v9, v125, s52, v9
  v_dot2_f32_bf16 v8, v126, s52, v8
  v_dot2_f32_bf16 v9, v127, s52, v9
  v_dot2_f32_bf16 v8, v128, s52, v8
  s_nop 2
  v_add_f32 v8, v8, v9
  s_nop 1
  v_add_f32_dpp v8, v8, v8 row_ror:8 row_mask:0xf bank_mask:0xf
  s_nop 1
  v_add_f32_dpp v8, v8, v8 row_ror:4 row_mask:0xf bank_mask:0xf
  s_nop 1
  v_add_f32_dpp v8, v8, v8 row_ror:2 row_mask:0xf bank_mask:0xf
  s_nop 1
  v_add_f32_dpp v8, v8, v8 row_ror:1 row_mask:0xf bank_mask:0xf
  v_mov_b32 v9, v8
  s_nop 1
  v_permlane16_swap_b32 v8, v9
  v_add_f32 v8, v8, v9
  v_mul_f32 v8, 0xbae38e39, v8
  v_dot2_f32_bf16 v160, v120, s50, v8
  v_dot2_f32_bf16 v161, v120, s51, v8
  v_dot2_f32_bf16 v162, v121, s50, v8
  v_dot2_f32_bf16 v163, v121, s51, v8
  v_dot2_f32_bf16 v164, v122, s50, v8
  v_dot2_f32_bf16 v165, v122, s51, v8
  v_dot2_f32_bf16 v166, v123, s50, v8
  v_dot2_f32_bf16 v167, v123, s51, v8
  v_dot2_f32_bf16 v168, v124, s50, v8
  v_dot2_f32_bf16 v169, v124, s51, v8
  v_dot2_f32_bf16 v170, v125, s50, v8
  v_dot2_f32_bf16 v171, v125, s51, v8
  v_dot2_f32_bf16 v172, v126, s50, v8
  v_dot2_f32_bf16 v173, v126, s51, v8
  v_dot2_f32_bf16 v174, v127, s50, v8
  v_dot2_f32_bf16 v175, v127, s51, v8
  v_dot2_f32_bf16 v176, v128, s50, v8
  v_dot2_f32_bf16 v177, v128, s51, v8
  v_pk_mul_f32 v[180:181], v[160:161], v[160:161]
  v_pk_mul_f32 v[182:183], v[162:163], v[162:163]
  v_pk_fma_f32 v[180:181], v[164:165], v[164:165], v[180:181]
  v_pk_fma_f32 v[182:183], v[166:167], v[166:167], v[182:183]
  v_pk_fma_f32 v[180:181], v[168:169], v[168:169], v[180:181]
  v_pk_fma_f32 v[182:183], v[170:171], v[170:171], v[182:183]
  v_pk_fma_f32 v[180:181], v[172:173], v[172:173], v[180:181]
  v_pk_fma_f32 v[182:183], v[174:175], v[174:175], v[182:183]
  v_pk_fma_f32 v[180:181], v[176:177], v[176:177], v[180:181]
  v_pk_add_f32 v[180:181], v[180:181], v[182:183]
  v_add_f32 v8, v180, v181
  s_nop 1
  v_add_f32_dpp v8, v8, v8 row_ror:8 row_mask:0xf bank_mask:0xf
  s_nop 1
  v_add_f32_dpp v8, v8, v8 row_ror:4 row_mask:0xf bank_mask:0xf
  s_nop 1
  v_add_f32_dpp v8, v8, v8 row_ror:2 row_mask:0xf bank_mask:0xf
  s_nop 1
  v_add_f32_dpp v8, v8, v8 row_ror:1 row_mask:0xf bank_mask:0xf
  v_mov_b32 v9, v8
  s_nop 1
  v_permlane16_swap_b32 v8, v9
  v_add_f32 v8, v8, v9
  v_fmamk_f32 v8, v8, 0x3ae38e39, v12
  v_rsq_f32 v8, v8
  s_nop 0
  v_pk_mul_f32 v[160:161], v[160:161], v[8:9] op_sel_hi:[1,0]
  v_pk_mul_f32 v[162:163], v[162:163], v[8:9] op_sel_hi:[1,0]
  v_pk_mul_f32 v[164:165], v[164:165], v[8:9] op_sel_hi:[1,0]
  v_pk_mul_f32 v[166:167], v[166:167], v[8:9] op_sel_hi:[1,0]
  v_pk_mul_f32 v[168:169], v[168:169], v[8:9] op_sel_hi:[1,0]
  v_pk_mul_f32 v[170:171], v[170:171], v[8:9] op_sel_hi:[1,0]
  v_pk_mul_f32 v[172:173], v[172:173], v[8:9] op_sel_hi:[1,0]
  v_pk_mul_f32 v[174:175], v[174:175], v[8:9] op_sel_hi:[1,0]
  v_pk_mul_f32 v[176:177], v[176:177], v[8:9] op_sel_hi:[1,0]
  v_cvt_pk_bf16_f32 v132, v160, v161
  v_cvt_pk_bf16_f32 v133, v162, v163
  v_cvt_pk_bf16_f32 v134, v164, v165
  v_cvt_pk_bf16_f32 v135, v166, v167
  v_cvt_pk_bf16_f32 v136, v168, v169
  v_cvt_pk_bf16_f32 v137, v170, v171
  v_cvt_pk_bf16_f32 v138, v172, v173
  v_cvt_pk_bf16_f32 v139, v174, v175
  v_cvt_pk_bf16_f32 v140, v176, v177
  ds_write2_b32 v13, v132, v133 offset0:0 offset1:32
  ds_write2_b32 v13, v134, v135 offset0:64 offset1:96
  ds_write2_b32 v13, v136, v137 offset0:128 offset1:160
  ds_write2_b32 v13, v138, v139 offset0:192 offset1:224
  ds_write_b32 v13, v140 offset:1024
  ds_read_b128 v[148:151], v14 offset:0
  ds_read_b128 v[152:155], v14 offset:384
  ds_read_b128 v[156:159], v14 offset:768
  s_waitcnt lgkmcnt(2)
  buffer_store_dwordx4 v[148:151], v1, s[4:7], s45 offen offset:0 sc1
  s_waitcnt lgkmcnt(1)
  buffer_store_dwordx4 v[152:155], v1, s[4:7], s45 offen offset:384 sc1
  s_waitcnt lgkmcnt(0)
  buffer_store_dwordx4 v[156:159], v1, s[4:7], s45 offen offset:768 sc1
  s_waitcnt vmcnt(0)
  s_add_u32 s98, s35, 1
  v_mov_b32 v6, s98
  s_mov_b64 exec, 255
  buffer_store_dword v6, v191, s[4:7], s46 offen sc1
  s_mov_b64 exec, -1
  s_mov_b32 s35, s36
  s_branch L_red0_sum2
L_red0_fin:
  s_mul_i32 s40, s35, 36864
  s_add_u32 s44, s40, 12402688
  s_add_u32 s45, s40, 7684096
  buffer_store_dwordx4 v[120:123], v2, s[4:7], s44 offen offset:0 sc1
  buffer_store_dwordx4 v[124:127], v2, s[4:7], s44 offen offset:1024 sc1
  buffer_store_dword v128, v11, s[4:7], s44 offen sc1
  v_dot2_f32_bf16 v8, v120, s52, 0
  v_dot2_f32_bf16 v9, v121, s52, 0
  v_dot2_f32_bf16 v8, v122, s52, v8
  v_dot2_f32_bf16 v9, v123, s52, v9
  v_dot2_f32_bf16 v8, v124, s52, v8
  v_dot2_f32_bf16 v9, v125, s52, v9
  v_dot2_f32_bf16 v8, v126, s52, v8
  v_dot2_f32_bf16 v9, v127, s52, v9
  v_dot2_f32_bf16 v8, v128, s52, v8
  s_nop 2
  v_add_f32 v8, v8, v9
  s_nop 1
  v_add_f32_dpp v8, v8, v8 row_ror:8 row_mask:0xf bank_mask:0xf
  s_nop 1
  v_add_f32_dpp v8, v8, v8 row_ror:4 row_mask:0xf bank_mask:0xf
  s_nop 1
  v_add_f32_dpp v8, v8, v8 row_ror:2 row_mask:0xf bank_mask:0xf
  s_nop 1
  v_add_f32_dpp v8, v8, v8 row_ror:1 row_mask:0xf bank_mask:0xf
  v_mov_b32 v9, v8
  s_nop 1
  v_permlane16_swap_b32 v8, v9
  v_add_f32 v8, v8, v9
  v_mul_f32 v8, 0xbae38e39, v8
  v_dot2_f32_bf16 v160, v120, s50, v8
  v_dot2_f32_bf16 v161, v120, s51, v8
  v_dot2_f32_bf16 v162, v121, s50, v8
  v_dot2_f32_bf16 v163, v121, s51, v8
  v_dot2_f32_bf16 v164, v122, s50, v8
  v_dot2_f32_bf16 v165, v122, s51, v8
  v_dot2_f32_bf16 v166, v123, s50, v8
  v_dot2_f32_bf16 v167, v123, s51, v8
  v_dot2_f32_bf16 v168, v124, s50, v8
  v_dot2_f32_bf16 v169, v124, s51, v8
  v_dot2_f32_bf16 v170, v125, s50, v8
  v_dot2_f32_bf16 v171, v125, s51, v8
  v_dot2_f32_bf16 v172, v126, s50, v8
  v_dot2_f32_bf16 v173, v126, s51, v8
  v_dot2_f32_bf16 v174, v127, s50, v8
  v_dot2_f32_bf16 v175, v127, s51, v8
  v_dot2_f32_bf16 v176, v128, s50, v8
  v_dot2_f32_bf16 v177, v128, s51, v8
  v_pk_mul_f32 v[180:181], v[160:161], v[160:161]
  v_pk_mul_f32 v[182:183], v[162:163], v[162:163]
  v_pk_fma_f32 v[180:181], v[164:165], v[164:165], v[180:181]
  v_pk_fma_f32 v[182:183], v[166:167], v[166:167], v[182:183]
  v_pk_fma_f32 v[180:181], v[168:169], v[168:169], v[180:181]
  v_pk_fma_f32 v[182:183], v[170:171], v[170:171], v[182:183]
  v_pk_fma_f32 v[180:181], v[172:173], v[172:173], v[180:181]
  v_pk_fma_f32 v[182:183], v[174:175], v[174:175], v[182:183]
  v_pk_fma_f32 v[180:181], v[176:177], v[176:177], v[180:181]
  v_pk_add_f32 v[180:181], v[180:181], v[182:183]
  v_add_f32 v8, v180, v181
  s_nop 1
  v_add_f32_dpp v8, v8, v8 row_ror:8 row_mask:0xf bank_mask:0xf
  s_nop 1
  v_add_f32_dpp v8, v8, v8 row_ror:4 row_mask:0xf bank_mask:0xf
  s_nop 1
  v_add_f32_dpp v8, v8, v8 row_ror:2 row_mask:0xf bank_mask:0xf
  s_nop 1
  v_add_f32_dpp v8, v8, v8 row_ror:1 row_mask:0xf bank_mask:0xf
  v_mov_b32 v9, v8
  s_nop 1
  v_permlane16_swap_b32 v8, v9
  v_add_f32 v8, v8, v9
  v_fmamk_f32 v8, v8, 0x3ae38e39, v12
  v_rsq_f32 v8, v8
  s_nop 0
  v_pk_mul_f32 v[160:161], v[160:161], v[8:9] op_sel_hi:[1,0]
  v_pk_mul_f32 v[162:163], v[162:163], v[8:9] op_sel_hi:[1,0]
  v_pk_mul_f32 v[164:165], v[164:165], v[8:9] op_sel_hi:[1,0]
  v_pk_mul_f32 v[166:167], v[166:167], v[8:9] op_sel_hi:[1,0]
  v_pk_mul_f32 v[168:169], v[168:169], v[8:9] op_sel_hi:[1,0]
  v_pk_mul_f32 v[170:171], v[170:171], v[8:9] op_sel_hi:[1,0]
  v_pk_mul_f32 v[172:173], v[172:173], v[8:9] op_sel_hi:[1,0]
  v_pk_mul_f32 v[174:175], v[174:175], v[8:9] op_sel_hi:[1,0]
  v_pk_mul_f32 v[176:177], v[176:177], v[8:9] op_sel_hi:[1,0]
  v_cvt_pk_bf16_f32 v132, v160, v161
  v_cvt_pk_bf16_f32 v133, v162, v163
  v_cvt_pk_bf16_f32 v134, v164, v165
  v_cvt_pk_bf16_f32 v135, v166, v167
  v_cvt_pk_bf16_f32 v136, v168, v169
  v_cvt_pk_bf16_f32 v137, v170, v171
  v_cvt_pk_bf16_f32 v138, v172, v173
  v_cvt_pk_bf16_f32 v139, v174, v175
  v_cvt_pk_bf16_f32 v140, v176, v177
  ds_write2_b32 v13, v132, v133 offset0:0 offset1:32
  ds_write2_b32 v13, v134, v135 offset0:64 offset1:96
  ds_write2_b32 v13, v136, v137 offset0:128 offset1:160
  ds_write2_b32 v13, v138, v139 offset0:192 offset1:224
  ds_write_b32 v13, v140 offset:1024
  ds_read_b128 v[148:151], v14 offset:0
  ds_read_b128 v[152:155], v14 offset:384
  ds_read_b128 v[156:159], v14 offset:768
  s_waitcnt lgkmcnt(2)
  buffer_store_dwordx4 v[148:151], v1, s[4:7], s45 offen offset:0 sc1
  s_waitcnt lgkmcnt(1)
  buffer_store_dwordx4 v[152:155], v1, s[4:7], s45 offen offset:384 sc1
  s_waitcnt lgkmcnt(0)
  buffer_store_dwordx4 v[156:159], v1, s[4:7], s45 offen offset:768 sc1
  s_add_u32 s56, s58, s47
  s_addc_u32 s57, s59, 0
  s_load_dword s64, s[56:57], 0 glc
  s_load_dword s65, s[56:57], 512 glc
  s_load_dword s66, s[56:57], 1024 glc
  s_load_dword s67, s[56:57], 1536 glc
  s_load_dword s68, s[56:57], 2048 glc
  s_load_dword s69, s[56:57], 2560 glc
  s_load_dword s70, s[56:57], 3072 glc
  s_load_dword s71, s[56:57], 3584 glc
  s_load_dword s72, s[56:57], 4096 glc
  s_load_dword s73, s[56:57], 4608 glc
  s_load_dword s74, s[56:57], 5120 glc
  s_load_dword s75, s[56:57], 5632 glc
  s_waitcnt vmcnt(0)
  s_add_u32 s98, s35, 1
  v_mov_b32 v6, s98
  s_mov_b64 exec, 255
  buffer_store_dword v6, v191, s[4:7], s46 offen sc1
  s_mov_b64 exec, -1
  s_add_u32 s35, s35, 1
  s_cmp_ge_u32 s35, 64
  s_cbranch_scc1 L_red0_end
  s_waitcnt lgkmcnt(0)
  s_min_u32 s64, s64, s65
  s_min_u32 s64, s64, s66
  s_min_u32 s64, s64, s67
  s_min_u32 s64, s64, s68
  s_min_u32 s64, s64, s69
  s_min_u32 s64, s64, s70
  s_min_u32 s64, s64, s71
  s_min_u32 s64, s64, s72
  s_min_u32 s64, s64, s73
  s_min_u32 s64, s64, s74
  s_min_u32 s64, s64, s75
  s_cmp_ge_u32 s35, s64
  s_cselect_b64 vcc, -1, 0
  s_cbranch_vccz L_red0_go
  s_branch L_red0_poll
L_red0_end:
  s_endpgm
L_red0_sum2:
  s_waitcnt vmcnt(29)
  v_dot2_f32_bf16 v64, v16, s50, 0
  v_dot2_f32_bf16 v65, v16, s51, 0
  v_dot2_f32_bf16 v68, v17, s50, 0
  v_dot2_f32_bf16 v69, v17, s51, 0
  v_dot2_f32_bf16 v72, v18, s50, 0
  v_dot2_f32_bf16 v73, v18, s51, 0
  v_dot2_f32_bf16 v76, v19, s50, 0
  v_dot2_f32_bf16 v77, v19, s51, 0
  v_dot2_f32_bf16 v80, v20, s50, 0
  v_dot2_f32_bf16 v81, v20, s51, 0
  v_dot2_f32_bf16 v84, v21, s50, 0
  v_dot2_f32_bf16 v85, v21, s51, 0
  v_dot2_f32_bf16 v88, v22, s50, 0
  v_dot2_f32_bf16 v89, v22, s51, 0
  v_dot2_f32_bf16 v92, v23, s50, 0
  v_dot2_f32_bf16 v93, v23, s51, 0
  v_dot2_f32_bf16 v96, v24, s50, 0
  v_dot2_f32_bf16 v97, v24, s51, 0
  s_waitcnt vmcnt(28)
  v_mfma_f32_16x16x32_bf16 v[64:67], v[144:147], v[28:31], v[64:67]
  s_waitcnt vmcnt(27)
  v_mfma_f32_16x16x32_bf16 v[68:71], v[144:147], v[32:35], v[68:71]
  s_waitcnt vmcnt(26)
  v_mfma_f32_16x16x32_bf16 v[72:75], v[144:147], v[36:39], v[72:75]
  s_waitcnt vmcnt(25)
  v_mfma_f32_16x16x32_bf16 v[76:79], v[144:147], v[40:43], v[76:79]
  s_waitcnt vmcnt(24)
  v_mfma_f32_16x16x32_bf16 v[80:83], v[144:147], v[44:47], v[80:83]
  s_waitcnt vmcnt(23)
  v_mfma_f32_16x16x32_bf16 v[84:87], v[144:147], v[48:51], v[84:87]
  s_waitcnt vmcnt(22)
  v_mfma_f32_16x16x32_bf16 v[88:91], v[144:147], v[52:55], v[88:91]
  s_waitcnt vmcnt(21)
  v_mfma_f32_16x16x32_bf16 v[92:95], v[144:147], v[56:59], v[92:95]
  s_waitcnt vmcnt(20)
  v_mfma_f32_16x16x32_bf16 v[96:99], v[144:147], v[60:63], v[96:99]
  v_cvt_pk_bf16_f32 v120, v64, v65
  v_cvt_pk_bf16_f32 v121, v68, v69
  v_cvt_pk_bf16_f32 v122, v72, v73
  v_cvt_pk_bf16_f32 v123, v76, v77
  v_cvt_pk_bf16_f32 v124, v80, v81
  v_cvt_pk_bf16_f32 v125, v84, v85
  v_cvt_pk_bf16_f32 v126, v88, v89
  v_cvt_pk_bf16_f32 v127, v92, v93
  v_cvt_pk_bf16_f32 v128, v96, v97
  s_add_u32 s36, s35, 1
  s_waitcnt lgkmcnt(0)
  s_min_u32 s64, s64, s65
  s_min_u32 s64, s64, s66
  s_min_u32 s64, s64, s67
  s_min_u32 s64, s64, s68
  s_min_u32 s64, s64, s69
  s_min_u32 s64, s64, s70
  s_min_u32 s64, s64, s71
  s_min_u32 s64, s64, s72
  s_min_u32 s64, s64, s73
  s_min_u32 s64, s64, s74
  s_min_u32 s64, s64, s75
  s_cmp_ge_u32 s36, s64
  s_cselect_b64 vcc, -1, 0
  s_cbranch_vccnz L_red0_fin
  s_add_u32 s47, s47, 6144
  s_cmp_ge_u32 s47, 128000
  s_cselect_b32 s47, 115712, s47
  s_mul_i32 s43, s36, 36864
  s_mul_i32 s42, s36, 147456
  s_add_u32 s42, s42, 171655168
  s_add_u32 s43, s43, 17121280
  buffer_load_dwordx4 v[16:19], v2, s[4:7], s43 offen offset:0 sc1
  buffer_load_dwordx4 v[20:23], v2, s[4:7], s43 offen offset:1024 sc1
  buffer_load_dword v24, v11, s[4:7], s43 offen sc1
  buffer_load_dwordx4 v[28:31], v3, s[4:7], s42 offen offset:0 sc1
  buffer_load_dwordx4 v[32:35], v3, s[4:7], s42 offen offset:256 sc1
  buffer_load_dwordx4 v[36:39], v3, s[4:7], s42 offen offset:512 sc1
  buffer_load_dwordx4 v[40:43], v3, s[4:7], s42 offen offset:768 sc1
  buffer_load_dwordx4 v[44:47], v3, s[4:7], s42 offen offset:1024 sc1
  buffer_load_dwordx4 v[48:51], v3, s[4:7], s42 offen offset:1280 sc1
  buffer_load_dwordx4 v[52:55], v3, s[4:7], s42 offen offset:1536 sc1
  buffer_load_dwordx4 v[56:59], v3, s[4:7], s42 offen offset:1792 sc1
  buffer_load_dwordx4 v[60:63], v3, s[4:7], s42 offen offset:2048 sc1
  s_add_u32 s56, s58, s47
  s_addc_u32 s57, s59, 0
  s_load_dword s64, s[56:57], 0 glc
  s_load_dword s65, s[56:57], 512 glc
  s_load_dword s66, s[56:57], 1024 glc
  s_load_dword s67, s[56:57], 1536 glc
  s_load_dword s68, s[56:57], 2048 glc
  s_load_dword s69, s[56:57], 2560 glc
  s_load_dword s70, s[56:57], 3072 glc
  s_load_dword s71, s[56:57], 3584 glc
  s_load_dword s72, s[56:57], 4096 glc
  s_load_dword s73, s[56:57], 4608 glc
  s_load_dword s74, s[56:57], 5120 glc
  s_load_dword s75, s[56:57], 5632 glc
  s_mul_i32 s40, s35, 36864
  s_add_u32 s44, s40, 12402688
  s_add_u32 s45, s40, 7684096
  buffer_store_dwordx4 v[120:123], v2, s[4:7], s44 offen offset:0 sc1
  buffer_store_dwordx4 v[124:127], v2, s[4:7], s44 offen offset:1024 sc1
  buffer_store_dword v128, v11, s[4:7], s44 offen sc1
  v_dot2_f32_bf16 v8, v120, s52, 0
  v_dot2_f32_bf16 v9, v121, s52, 0
  v_dot2_f32_bf16 v8, v122, s52, v8
  v_dot2_f32_bf16 v9, v123, s52, v9
  v_dot2_f32_bf16 v8, v124, s52, v8
  v_dot2_f32_bf16 v9, v125, s52, v9
  v_dot2_f32_bf16 v8, v126, s52, v8
  v_dot2_f32_bf16 v9, v127, s52, v9
  v_dot2_f32_bf16 v8, v128, s52, v8
  s_nop 2
  v_add_f32 v8, v8, v9
  s_nop 1
  v_add_f32_dpp v8, v8, v8 row_ror:8 row_mask:0xf bank_mask:0xf
  s_nop 1
  v_add_f32_dpp v8, v8, v8 row_ror:4 row_mask:0xf bank_mask:0xf
  s_nop 1
  v_add_f32_dpp v8, v8, v8 row_ror:2 row_mask:0xf bank_mask:0xf
  s_nop 1
  v_add_f32_dpp v8, v8, v8 row_ror:1 row_mask:0xf bank_mask:0xf
  v_mov_b32 v9, v8
  s_nop 1
  v_permlane16_swap_b32 v8, v9
  v_add_f32 v8, v8, v9
  v_mul_f32 v8, 0xbae38e39, v8
  v_dot2_f32_bf16 v160, v120, s50, v8
  v_dot2_f32_bf16 v161, v120, s51, v8
  v_dot2_f32_bf16 v162, v121, s50, v8
  v_dot2_f32_bf16 v163, v121, s51, v8
  v_dot2_f32_bf16 v164, v122, s50, v8
  v_dot2_f32_bf16 v165, v122, s51, v8
  v_dot2_f32_bf16 v166, v123, s50, v8
  v_dot2_f32_bf16 v167, v123, s51, v8
  v_dot2_f32_bf16 v168, v124, s50, v8
  v_dot2_f32_bf16 v169, v124, s51, v8
  v_dot2_f32_bf16 v170, v125, s50, v8
  v_dot2_f32_bf16 v171, v125, s51, v8
  v_dot2_f32_bf16 v172, v126, s50, v8
  v_dot2_f32_bf16 v173, v126, s51, v8
  v_dot2_f32_bf16 v174, v127, s50, v8
  v_dot2_f32_bf16 v175, v127, s51, v8
  v_dot2_f32_bf16 v176, v128, s50, v8
  v_dot2_f32_bf16 v177, v128, s51, v8
  v_pk_mul_f32 v[180:181], v[160:161], v[160:161]
  v_pk_mul_f32 v[182:183], v[162:163], v[162:163]
  v_pk_fma_f32 v[180:181], v[164:165], v[164:165], v[180:181]
  v_pk_fma_f32 v[182:183], v[166:167], v[166:167], v[182:183]
  v_pk_fma_f32 v[180:181], v[168:169], v[168:169], v[180:181]
  v_pk_fma_f32 v[182:183], v[170:171], v[170:171], v[182:183]
  v_pk_fma_f32 v[180:181], v[172:173], v[172:173], v[180:181]
  v_pk_fma_f32 v[182:183], v[174:175], v[174:175], v[182:183]
  v_pk_fma_f32 v[180:181], v[176:177], v[176:177], v[180:181]
  v_pk_add_f32 v[180:181], v[180:181], v[182:183]
  v_add_f32 v8, v180, v181
  s_nop 1
  v_add_f32_dpp v8, v8, v8 row_ror:8 row_mask:0xf bank_mask:0xf
  s_nop 1
  v_add_f32_dpp v8, v8, v8 row_ror:4 row_mask:0xf bank_mask:0xf
  s_nop 1
  v_add_f32_dpp v8, v8, v8 row_ror:2 row_mask:0xf bank_mask:0xf
  s_nop 1
  v_add_f32_dpp v8, v8, v8 row_ror:1 row_mask:0xf bank_mask:0xf
  v_mov_b32 v9, v8
  s_nop 1
  v_permlane16_swap_b32 v8, v9
  v_add_f32 v8, v8, v9
  v_fmamk_f32 v8, v8, 0x3ae38e39, v12
  v_rsq_f32 v8, v8
  s_nop 0
  v_pk_mul_f32 v[160:161], v[160:161], v[8:9] op_sel_hi:[1,0]
  v_pk_mul_f32 v[162:163], v[162:163], v[8:9] op_sel_hi:[1,0]
  v_pk_mul_f32 v[164:165], v[164:165], v[8:9] op_sel_hi:[1,0]
  v_pk_mul_f32 v[166:167], v[166:167], v[8:9] op_sel_hi:[1,0]
  v_pk_mul_f32 v[168:169], v[168:169], v[8:9] op_sel_hi:[1,0]
  v_pk_mul_f32 v[170:171], v[170:171], v[8:9] op_sel_hi:[1,0]
  v_pk_mul_f32 v[172:173], v[172:173], v[8:9] op_sel_hi:[1,0]
  v_pk_mul_f32 v[174:175], v[174:175], v[8:9] op_sel_hi:[1,0]
  v_pk_mul_f32 v[176:177], v[176:177], v[8:9] op_sel_hi:[1,0]
  v_cvt_pk_bf16_f32 v132, v160, v161
  v_cvt_pk_bf16_f32 v133, v162, v163
  v_cvt_pk_bf16_f32 v134, v164, v165
  v_cvt_pk_bf16_f32 v135, v166, v167
  v_cvt_pk_bf16_f32 v136, v168, v169
  v_cvt_pk_bf16_f32 v137, v170, v171
  v_cvt_pk_bf16_f32 v138, v172, v173
  v_cvt_pk_bf16_f32 v139, v174, v175
  v_cvt_pk_bf16_f32 v140, v176, v177
  ds_write2_b32 v13, v132, v133 offset0:0 offset1:32
  ds_write2_b32 v13, v134, v135 offset0:64 offset1:96
  ds_write2_b32 v13, v136, v137 offset0:128 offset1:160
  ds_write2_b32 v13, v138, v139 offset0:192 offset1:224
  ds_write_b32 v13, v140 offset:1024
  ds_read_b128 v[148:151], v14 offset:0
  ds_read_b128 v[152:155], v14 offset:384
  ds_read_b128 v[156:159], v14 offset:768
  s_waitcnt lgkmcnt(2)
  buffer_store_dwordx4 v[148:151], v1, s[4:7], s45 offen offset:0 sc1
  s_waitcnt lgkmcnt(1)
  buffer_store_dwordx4 v[152:155], v1, s[4:7], s45 offen offset:384 sc1
  s_waitcnt lgkmcnt(0)
  buffer_store_dwordx4 v[156:159], v1, s[4:7], s45 offen offset:768 sc1
  s_waitcnt vmcnt(0)
  s_add_u32 s98, s35, 1
  v_mov_b32 v6, s98
  s_mov_b64 exec, 255
  buffer_store_dword v6, v191, s[4:7], s46 offen sc1
  s_mov_b64 exec, -1
  s_mov_b32 s35, s36
  s_branch L_red0_sum2
L_red_g1:
  s_mov_b32 s35, 0
  s_mov_b32 s47, 115716
L_red1_poll:
  s_add_u32 s56, s58, s47
  s_addc_u32 s57, s59, 0
  s_load_dword s64, s[56:57], 0 glc
  s_load_dword s65, s[56:57], 512 glc
  s_load_dword s66, s[56:57], 1024 glc
  s_load_dword s67, s[56:57], 1536 glc
  s_load_dword s68, s[56:57], 2048 glc
  s_load_dword s69, s[56:57], 2560 glc
  s_load_dword s70, s[56:57], 3072 glc
  s_load_dword s71, s[56:57], 3584 glc
  s_load_dword s72, s[56:57], 4096 glc
  s_load_dword s73, s[56:57], 4608 glc
  s_load_dword s74, s[56:57], 5120 glc
  s_load_dword s75, s[56:57], 5632 glc
  s_waitcnt lgkmcnt(0)
  s_min_u32 s64, s64, s65
  s_min_u32 s64, s64, s66
  s_min_u32 s64, s64, s67
  s_min_u32 s64, s64, s68
  s_min_u32 s64, s64, s69
  s_min_u32 s64, s64, s70
  s_min_u32 s64, s64, s71
  s_min_u32 s64, s64, s72
  s_min_u32 s64, s64, s73
  s_min_u32 s64, s64, s74
  s_min_u32 s64, s64, s75
  s_cmp_ge_u32 s35, s64
  s_cselect_b64 vcc, -1, 0
  s_cbranch_vccz L_red1_go
  s_add_u32 s60, s60, 1
  s_cmp_gt_u32 s60, 262144
  s_cbranch_scc1 L_fail_red
  s_branch L_red1_poll
L_red1_go:
  s_add_u32 s47, s47, 6144
  s_cmp_ge_u32 s47, 128004
  s_cselect_b32 s47, 115716, s47
  s_mul_i32 s43, s35, 36864
  s_mul_i32 s42, s35, 147456
  s_add_u32 s42, s42, 171655168
  s_add_u32 s43, s43, 17121280
  buffer_load_dwordx4 v[16:19], v2, s[4:7], s43 offen offset:0 sc1
  buffer_load_dwordx4 v[20:23], v2, s[4:7], s43 offen offset:1024 sc1
  buffer_load_dword v24, v11, s[4:7], s43 offen sc1
  buffer_load_dwordx4 v[28:31], v3, s[4:7], s42 offen offset:0 sc1
  buffer_load_dwordx4 v[32:35], v3, s[4:7], s42 offen offset:256 sc1
  buffer_load_dwordx4 v[36:39], v3, s[4:7], s42 offen offset:512 sc1
  buffer_load_dwordx4 v[40:43], v3, s[4:7], s42 offen offset:768 sc1
  buffer_load_dwordx4 v[44:47], v3, s[4:7], s42 offen offset:1024 sc1
  buffer_load_dwordx4 v[48:51], v3, s[4:7], s42 offen offset:1280 sc1
  buffer_load_dwordx4 v[52:55], v3, s[4:7], s42 offen offset:1536 sc1
  buffer_load_dwordx4 v[56:59], v3, s[4:7], s42 offen offset:1792 sc1
  buffer_load_dwordx4 v[60:63], v3, s[4:7], s42 offen offset:2048 sc1
  s_add_u32 s56, s58, s47
  s_addc_u32 s57, s59, 0
  s_load_dword s64, s[56:57], 0 glc
  s_load_dword s65, s[56:57], 512 glc
  s_load_dword s66, s[56:57], 1024 glc
  s_load_dword s67, s[56:57], 1536 glc
  s_load_dword s68, s[56:57], 2048 glc
  s_load_dword s69, s[56:57], 2560 glc
  s_load_dword s70, s[56:57], 3072 glc
  s_load_dword s71, s[56:57], 3584 glc
  s_load_dword s72, s[56:57], 4096 glc
  s_load_dword s73, s[56:57], 4608 glc
  s_load_dword s74, s[56:57], 5120 glc
  s_load_dword s75, s[56:57], 5632 glc
L_red1_sum:
  s_waitcnt vmcnt(9)
  v_dot2_f32_bf16 v64, v16, s50, 0
  v_dot2_f32_bf16 v65, v16, s51, 0
  v_dot2_f32_bf16 v68, v17, s50, 0
  v_dot2_f32_bf16 v69, v17, s51, 0
  v_dot2_f32_bf16 v72, v18, s50, 0
  v_dot2_f32_bf16 v73, v18, s51, 0
  v_dot2_f32_bf16 v76, v19, s50, 0
  v_dot2_f32_bf16 v77, v19, s51, 0
  v_dot2_f32_bf16 v80, v20, s50, 0
  v_dot2_f32_bf16 v81, v20, s51, 0
  v_dot2_f32_bf16 v84, v21, s50, 0
  v_dot2_f32_bf16 v85, v21, s51, 0
  v_dot2_f32_bf16 v88, v22, s50, 0
  v_dot2_f32_bf16 v89, v22, s51, 0
  v_dot2_f32_bf16 v92, v23, s50, 0
  v_dot2_f32_bf16 v93, v23, s51, 0
  v_dot2_f32_bf16 v96, v24, s50, 0
  v_dot2_f32_bf16 v97, v24, s51, 0
  s_waitcnt vmcnt(8)
  v_mfma_f32_16x16x32_bf16 v[64:67], v[144:147], v[28:31], v[64:67]
  s_waitcnt vmcnt(7)
  v_mfma_f32_16x16x32_bf16 v[68:71], v[144:147], v[32:35], v[68:71]
  s_waitcnt vmcnt(6)
  v_mfma_f32_16x16x32_bf16 v[72:75], v[144:147], v[36:39], v[72:75]
  s_waitcnt vmcnt(5)
  v_mfma_f32_16x16x32_bf16 v[76:79], v[144:147], v[40:43], v[76:79]
  s_waitcnt vmcnt(4)
  v_mfma_f32_16x16x32_bf16 v[80:83], v[144:147], v[44:47], v[80:83]
  s_waitcnt vmcnt(3)
  v_mfma_f32_16x16x32_bf16 v[84:87], v[144:147], v[48:51], v[84:87]
  s_waitcnt vmcnt(2)
  v_mfma_f32_16x16x32_bf16 v[88:91], v[144:147], v[52:55], v[88:91]
  s_waitcnt vmcnt(1)
  v_mfma_f32_16x16x32_bf16 v[92:95], v[144:147], v[56:59], v[92:95]
  s_waitcnt vmcnt(0)
  v_mfma_f32_16x16x32_bf16 v[96:99], v[144:147], v[60:63], v[96:99]
  v_cvt_pk_bf16_f32 v120, v64, v65
  v_cvt_pk_bf16_f32 v121, v68, v69
  v_cvt_pk_bf16_f32 v122, v72, v73
  v_cvt_pk_bf16_f32 v123, v76, v77
  v_cvt_pk_bf16_f32 v124, v80, v81
  v_cvt_pk_bf16_f32 v125, v84, v85
  v_cvt_pk_bf16_f32 v126, v88, v89
  v_cvt_pk_bf16_f32 v127, v92, v93
  v_cvt_pk_bf16_f32 v128, v96, v97
  s_add_u32 s36, s35, 1
  s_waitcnt vmcnt(0)
  s_waitcnt lgkmcnt(0)
  s_min_u32 s64, s64, s65
  s_min_u32 s64, s64, s66
  s_min_u32 s64, s64, s67
  s_min_u32 s64, s64, s68
  s_min_u32 s64, s64, s69
  s_min_u32 s64, s64, s70
  s_min_u32 s64, s64, s71
  s_min_u32 s64, s64, s72
  s_min_u32 s64, s64, s73
  s_min_u32 s64, s64, s74
  s_min_u32 s64, s64, s75
  s_cmp_ge_u32 s36, s64
  s_cselect_b64 vcc, -1, 0
  s_cbranch_vccnz L_red1_fin
  s_add_u32 s47, s47, 6144
  s_cmp_ge_u32 s47, 128004
  s_cselect_b32 s47, 115716, s47
  s_mul_i32 s43, s36, 36864
  s_mul_i32 s42, s36, 147456
  s_add_u32 s42, s42, 171655168
  s_add_u32 s43, s43, 17121280
  buffer_load_dwordx4 v[16:19], v2, s[4:7], s43 offen offset:0 sc1
  buffer_load_dwordx4 v[20:23], v2, s[4:7], s43 offen offset:1024 sc1
  buffer_load_dword v24, v11, s[4:7], s43 offen sc1
  buffer_load_dwordx4 v[28:31], v3, s[4:7], s42 offen offset:0 sc1
  buffer_load_dwordx4 v[32:35], v3, s[4:7], s42 offen offset:256 sc1
  buffer_load_dwordx4 v[36:39], v3, s[4:7], s42 offen offset:512 sc1
  buffer_load_dwordx4 v[40:43], v3, s[4:7], s42 offen offset:768 sc1
  buffer_load_dwordx4 v[44:47], v3, s[4:7], s42 offen offset:1024 sc1
  buffer_load_dwordx4 v[48:51], v3, s[4:7], s42 offen offset:1280 sc1
  buffer_load_dwordx4 v[52:55], v3, s[4:7], s42 offen offset:1536 sc1
  buffer_load_dwordx4 v[56:59], v3, s[4:7], s42 offen offset:1792 sc1
  buffer_load_dwordx4 v[60:63], v3, s[4:7], s42 offen offset:2048 sc1
  s_add_u32 s56, s58, s47
  s_addc_u32 s57, s59, 0
  s_load_dword s64, s[56:57], 0 glc
  s_load_dword s65, s[56:57], 512 glc
  s_load_dword s66, s[56:57], 1024 glc
  s_load_dword s67, s[56:57], 1536 glc
  s_load_dword s68, s[56:57], 2048 glc
  s_load_dword s69, s[56:57], 2560 glc
  s_load_dword s70, s[56:57], 3072 glc
  s_load_dword s71, s[56:57], 3584 glc
  s_load_dword s72, s[56:57], 4096 glc
  s_load_dword s73, s[56:57], 4608 glc
  s_load_dword s74, s[56:57], 5120 glc
  s_load_dword s75, s[56:57], 5632 glc
  s_mul_i32 s40, s35, 36864
  s_add_u32 s44, s40, 12402688
  s_add_u32 s45, s40, 7684096
  buffer_store_dwordx4 v[120:123], v2, s[4:7], s44 offen offset:0 sc1
  buffer_store_dwordx4 v[124:127], v2, s[4:7], s44 offen offset:1024 sc1
  buffer_store_dword v128, v11, s[4:7], s44 offen sc1
  v_dot2_f32_bf16 v8, v120, s52, 0
  v_dot2_f32_bf16 v9, v121, s52, 0
  v_dot2_f32_bf16 v8, v122, s52, v8
  v_dot2_f32_bf16 v9, v123, s52, v9
  v_dot2_f32_bf16 v8, v124, s52, v8
  v_dot2_f32_bf16 v9, v125, s52, v9
  v_dot2_f32_bf16 v8, v126, s52, v8
  v_dot2_f32_bf16 v9, v127, s52, v9
  v_dot2_f32_bf16 v8, v128, s52, v8
  s_nop 2
  v_add_f32 v8, v8, v9
  s_nop 1
  v_add_f32_dpp v8, v8, v8 row_ror:8 row_mask:0xf bank_mask:0xf
  s_nop 1
  v_add_f32_dpp v8, v8, v8 row_ror:4 row_mask:0xf bank_mask:0xf
  s_nop 1
  v_add_f32_dpp v8, v8, v8 row_ror:2 row_mask:0xf bank_mask:0xf
  s_nop 1
  v_add_f32_dpp v8, v8, v8 row_ror:1 row_mask:0xf bank_mask:0xf
  v_mov_b32 v9, v8
  s_nop 1
  v_permlane16_swap_b32 v8, v9
  v_add_f32 v8, v8, v9
  v_mul_f32 v8, 0xbae38e39, v8
  v_dot2_f32_bf16 v160, v120, s50, v8
  v_dot2_f32_bf16 v161, v120, s51, v8
  v_dot2_f32_bf16 v162, v121, s50, v8
  v_dot2_f32_bf16 v163, v121, s51, v8
  v_dot2_f32_bf16 v164, v122, s50, v8
  v_dot2_f32_bf16 v165, v122, s51, v8
  v_dot2_f32_bf16 v166, v123, s50, v8
  v_dot2_f32_bf16 v167, v123, s51, v8
  v_dot2_f32_bf16 v168, v124, s50, v8
  v_dot2_f32_bf16 v169, v124, s51, v8
  v_dot2_f32_bf16 v170, v125, s50, v8
  v_dot2_f32_bf16 v171, v125, s51, v8
  v_dot2_f32_bf16 v172, v126, s50, v8
  v_dot2_f32_bf16 v173, v126, s51, v8
  v_dot2_f32_bf16 v174, v127, s50, v8
  v_dot2_f32_bf16 v175, v127, s51, v8
  v_dot2_f32_bf16 v176, v128, s50, v8
  v_dot2_f32_bf16 v177, v128, s51, v8
  v_pk_mul_f32 v[180:181], v[160:161], v[160:161]
  v_pk_mul_f32 v[182:183], v[162:163], v[162:163]
  v_pk_fma_f32 v[180:181], v[164:165], v[164:165], v[180:181]
  v_pk_fma_f32 v[182:183], v[166:167], v[166:167], v[182:183]
  v_pk_fma_f32 v[180:181], v[168:169], v[168:169], v[180:181]
  v_pk_fma_f32 v[182:183], v[170:171], v[170:171], v[182:183]
  v_pk_fma_f32 v[180:181], v[172:173], v[172:173], v[180:181]
  v_pk_fma_f32 v[182:183], v[174:175], v[174:175], v[182:183]
  v_pk_fma_f32 v[180:181], v[176:177], v[176:177], v[180:181]
  v_pk_add_f32 v[180:181], v[180:181], v[182:183]
  v_add_f32 v8, v180, v181
  s_nop 1
  v_add_f32_dpp v8, v8, v8 row_ror:8 row_mask:0xf bank_mask:0xf
  s_nop 1
  v_add_f32_dpp v8, v8, v8 row_ror:4 row_mask:0xf bank_mask:0xf
  s_nop 1
  v_add_f32_dpp v8, v8, v8 row_ror:2 row_mask:0xf bank_mask:0xf
  s_nop 1
  v_add_f32_dpp v8, v8, v8 row_ror:1 row_mask:0xf bank_mask:0xf
  v_mov_b32 v9, v8
  s_nop 1
  v_permlane16_swap_b32 v8, v9
  v_add_f32 v8, v8, v9
  v_fmamk_f32 v8, v8, 0x3ae38e39, v12
  v_rsq_f32 v8, v8
  s_nop 0
  v_pk_mul_f32 v[160:161], v[160:161], v[8:9] op_sel_hi:[1,0]
  v_pk_mul_f32 v[162:163], v[162:163], v[8:9] op_sel_hi:[1,0]
  v_pk_mul_f32 v[164:165], v[164:165], v[8:9] op_sel_hi:[1,0]
  v_pk_mul_f32 v[166:167], v[166:167], v[8:9] op_sel_hi:[1,0]
  v_pk_mul_f32 v[168:169], v[168:169], v[8:9] op_sel_hi:[1,0]
  v_pk_mul_f32 v[170:171], v[170:171], v[8:9] op_sel_hi:[1,0]
  v_pk_mul_f32 v[172:173], v[172:173], v[8:9] op_sel_hi:[1,0]
  v_pk_mul_f32 v[174:175], v[174:175], v[8:9] op_sel_hi:[1,0]
  v_pk_mul_f32 v[176:177], v[176:177], v[8:9] op_sel_hi:[1,0]
  v_cvt_pk_bf16_f32 v132, v160, v161
  v_cvt_pk_bf16_f32 v133, v162, v163
  v_cvt_pk_bf16_f32 v134, v164, v165
  v_cvt_pk_bf16_f32 v135, v166, v167
  v_cvt_pk_bf16_f32 v136, v168, v169
  v_cvt_pk_bf16_f32 v137, v170, v171
  v_cvt_pk_bf16_f32 v138, v172, v173
  v_cvt_pk_bf16_f32 v139, v174, v175
  v_cvt_pk_bf16_f32 v140, v176, v177
  ds_write2_b32 v13, v132, v133 offset0:0 offset1:32
  ds_write2_b32 v13, v134, v135 offset0:64 offset1:96
  ds_write2_b32 v13, v136, v137 offset0:128 offset1:160
  ds_write2_b32 v13, v138, v139 offset0:192 offset1:224
  ds_write_b32 v13, v140 offset:1024
  ds_read_b128 v[148:151], v14 offset:0
  ds_read_b128 v[152:155], v14 offset:384
  ds_read_b128 v[156:159], v14 offset:768
  s_waitcnt lgkmcnt(2)
  buffer_store_dwordx4 v[148:151], v1, s[4:7], s45 offen offset:0 sc1
  s_waitcnt lgkmcnt(1)
  buffer_store_dwordx4 v[152:155], v1, s[4:7], s45 offen offset:384 sc1
  s_waitcnt lgkmcnt(0)
  buffer_store_dwordx4 v[156:159], v1, s[4:7], s45 offen offset:768 sc1
  s_waitcnt vmcnt(0)
  s_add_u32 s98, s35, 1
  v_mov_b32 v6, s98
  s_mov_b64 exec, 255
  buffer_store_dword v6, v191, s[4:7], s46 offen sc1
  s_mov_b64 exec, -1
  s_mov_b32 s35, s36
  s_branch L_red1_sum2
L_red1_fin:
  s_mul_i32 s40, s35, 36864
  s_add_u32 s44, s40, 12402688
  s_add_u32 s45, s40, 7684096
  buffer_store_dwordx4 v[120:123], v2, s[4:7], s44 offen offset:0 sc1
  buffer_store_dwordx4 v[124:127], v2, s[4:7], s44 offen offset:1024 sc1
  buffer_store_dword v128, v11, s[4:7], s44 offen sc1
  v_dot2_f32_bf16 v8, v120, s52, 0
  v_dot2_f32_bf16 v9, v121, s52, 0
  v_dot2_f32_bf16 v8, v122, s52, v8
  v_dot2_f32_bf16 v9, v123, s52, v9
  v_dot2_f32_bf16 v8, v124, s52, v8
  v_dot2_f32_bf16 v9, v125, s52, v9
  v_dot2_f32_bf16 v8, v126, s52, v8
  v_dot2_f32_bf16 v9, v127, s52, v9
  v_dot2_f32_bf16 v8, v128, s52, v8
  s_nop 2
  v_add_f32 v8, v8, v9
  s_nop 1
  v_add_f32_dpp v8, v8, v8 row_ror:8 row_mask:0xf bank_mask:0xf
  s_nop 1
  v_add_f32_dpp v8, v8, v8 row_ror:4 row_mask:0xf bank_mask:0xf
  s_nop 1
  v_add_f32_dpp v8, v8, v8 row_ror:2 row_mask:0xf bank_mask:0xf
  s_nop 1
  v_add_f32_dpp v8, v8, v8 row_ror:1 row_mask:0xf bank_mask:0xf
  v_mov_b32 v9, v8
  s_nop 1
  v_permlane16_swap_b32 v8, v9
  v_add_f32 v8, v8, v9
  v_mul_f32 v8, 0xbae38e39, v8
  v_dot2_f32_bf16 v160, v120, s50, v8
  v_dot2_f32_bf16 v161, v120, s51, v8
  v_dot2_f32_bf16 v162, v121, s50, v8
  v_dot2_f32_bf16 v163, v121, s51, v8
  v_dot2_f32_bf16 v164, v122, s50, v8
  v_dot2_f32_bf16 v165, v122, s51, v8
  v_dot2_f32_bf16 v166, v123, s50, v8
  v_dot2_f32_bf16 v167, v123, s51, v8
  v_dot2_f32_bf16 v168, v124, s50, v8
  v_dot2_f32_bf16 v169, v124, s51, v8
  v_dot2_f32_bf16 v170, v125, s50, v8
  v_dot2_f32_bf16 v171, v125, s51, v8
  v_dot2_f32_bf16 v172, v126, s50, v8
  v_dot2_f32_bf16 v173, v126, s51, v8
  v_dot2_f32_bf16 v174, v127, s50, v8
  v_dot2_f32_bf16 v175, v127, s51, v8
  v_dot2_f32_bf16 v176, v128, s50, v8
  v_dot2_f32_bf16 v177, v128, s51, v8
  v_pk_mul_f32 v[180:181], v[160:161], v[160:161]
  v_pk_mul_f32 v[182:183], v[162:163], v[162:163]
  v_pk_fma_f32 v[180:181], v[164:165], v[164:165], v[180:181]
  v_pk_fma_f32 v[182:183], v[166:167], v[166:167], v[182:183]
  v_pk_fma_f32 v[180:181], v[168:169], v[168:169], v[180:181]
  v_pk_fma_f32 v[182:183], v[170:171], v[170:171], v[182:183]
  v_pk_fma_f32 v[180:181], v[172:173], v[172:173], v[180:181]
  v_pk_fma_f32 v[182:183], v[174:175], v[174:175], v[182:183]
  v_pk_fma_f32 v[180:181], v[176:177], v[176:177], v[180:181]
  v_pk_add_f32 v[180:181], v[180:181], v[182:183]
  v_add_f32 v8, v180, v181
  s_nop 1
  v_add_f32_dpp v8, v8, v8 row_ror:8 row_mask:0xf bank_mask:0xf
  s_nop 1
  v_add_f32_dpp v8, v8, v8 row_ror:4 row_mask:0xf bank_mask:0xf
  s_nop 1
  v_add_f32_dpp v8, v8, v8 row_ror:2 row_mask:0xf bank_mask:0xf
  s_nop 1
  v_add_f32_dpp v8, v8, v8 row_ror:1 row_mask:0xf bank_mask:0xf
  v_mov_b32 v9, v8
  s_nop 1
  v_permlane16_swap_b32 v8, v9
  v_add_f32 v8, v8, v9
  v_fmamk_f32 v8, v8, 0x3ae38e39, v12
  v_rsq_f32 v8, v8
  s_nop 0
  v_pk_mul_f32 v[160:161], v[160:161], v[8:9] op_sel_hi:[1,0]
  v_pk_mul_f32 v[162:163], v[162:163], v[8:9] op_sel_hi:[1,0]
  v_pk_mul_f32 v[164:165], v[164:165], v[8:9] op_sel_hi:[1,0]
  v_pk_mul_f32 v[166:167], v[166:167], v[8:9] op_sel_hi:[1,0]
  v_pk_mul_f32 v[168:169], v[168:169], v[8:9] op_sel_hi:[1,0]
  v_pk_mul_f32 v[170:171], v[170:171], v[8:9] op_sel_hi:[1,0]
  v_pk_mul_f32 v[172:173], v[172:173], v[8:9] op_sel_hi:[1,0]
  v_pk_mul_f32 v[174:175], v[174:175], v[8:9] op_sel_hi:[1,0]
  v_pk_mul_f32 v[176:177], v[176:177], v[8:9] op_sel_hi:[1,0]
  v_cvt_pk_bf16_f32 v132, v160, v161
  v_cvt_pk_bf16_f32 v133, v162, v163
  v_cvt_pk_bf16_f32 v134, v164, v165
  v_cvt_pk_bf16_f32 v135, v166, v167
  v_cvt_pk_bf16_f32 v136, v168, v169
  v_cvt_pk_bf16_f32 v137, v170, v171
  v_cvt_pk_bf16_f32 v138, v172, v173
  v_cvt_pk_bf16_f32 v139, v174, v175
  v_cvt_pk_bf16_f32 v140, v176, v177
  ds_write2_b32 v13, v132, v133 offset0:0 offset1:32
  ds_write2_b32 v13, v134, v135 offset0:64 offset1:96
  ds_write2_b32 v13, v136, v137 offset0:128 offset1:160
  ds_write2_b32 v13, v138, v139 offset0:192 offset1:224
  ds_write_b32 v13, v140 offset:1024
  ds_read_b128 v[148:151], v14 offset:0
  ds_read_b128 v[152:155], v14 offset:384
  ds_read_b128 v[156:159], v14 offset:768
  s_waitcnt lgkmcnt(2)
  buffer_store_dwordx4 v[148:151], v1, s[4:7], s45 offen offset:0 sc1
  s_waitcnt lgkmcnt(1)
  buffer_store_dwordx4 v[152:155], v1, s[4:7], s45 offen offset:384 sc1
  s_waitcnt lgkmcnt(0)
  buffer_store_dwordx4 v[156:159], v1, s[4:7], s45 offen offset:768 sc1
  s_add_u32 s56, s58, s47
  s_addc_u32 s57, s59, 0
  s_load_dword s64, s[56:57], 0 glc
  s_load_dword s65, s[56:57], 512 glc
  s_load_dword s66, s[56:57], 1024 glc
  s_load_dword s67, s[56:57], 1536 glc
  s_load_dword s68, s[56:57], 2048 glc
  s_load_dword s69, s[56:57], 2560 glc
  s_load_dword s70, s[56:57], 3072 glc
  s_load_dword s71, s[56:57], 3584 glc
  s_load_dword s72, s[56:57], 4096 glc
  s_load_dword s73, s[56:57], 4608 glc
  s_load_dword s74, s[56:57], 5120 glc
  s_load_dword s75, s[56:57], 5632 glc
  s_waitcnt vmcnt(0)
  s_add_u32 s98, s35, 1
  v_mov_b32 v6, s98
  s_mov_b64 exec, 255
  buffer_store_dword v6, v191, s[4:7], s46 offen sc1
  s_mov_b64 exec, -1
  s_add_u32 s35, s35, 1
  s_cmp_ge_u32 s35, 64
  s_cbranch_scc1 L_red1_end
  s_waitcnt lgkmcnt(0)
  s_min_u32 s64, s64, s65
  s_min_u32 s64, s64, s66
  s_min_u32 s64, s64, s67
  s_min_u32 s64, s64, s68
  s_min_u32 s64, s64, s69
  s_min_u32 s64, s64, s70
  s_min_u32 s64, s64, s71
  s_min_u32 s64, s64, s72
  s_min_u32 s64, s64, s73
  s_min_u32 s64, s64, s74
  s_min_u32 s64, s64, s75
  s_cmp_ge_u32 s35, s64
  s_cselect_b64 vcc, -1, 0
  s_cbranch_vccz L_red1_go
  s_branch L_red1_poll
L_red1_end:
  s_endpgm
L_red1_sum2:
  s_waitcnt vmcnt(29)
  v_dot2_f32_bf16 v64, v16, s50, 0
  v_dot2_f32_bf16 v65, v16, s51, 0
  v_dot2_f32_bf16 v68, v17, s50, 0
  v_dot2_f32_bf16 v69, v17, s51, 0
  v_dot2_f32_bf16 v72, v18, s50, 0
  v_dot2_f32_bf16 v73, v18, s51, 0
  v_dot2_f32_bf16 v76, v19, s50, 0
  v_dot2_f32_bf16 v77, v19, s51, 0
  v_dot2_f32_bf16 v80, v20, s50, 0
  v_dot2_f32_bf16 v81, v20, s51, 0
  v_dot2_f32_bf16 v84, v21, s50, 0
  v_dot2_f32_bf16 v85, v21, s51, 0
  v_dot2_f32_bf16 v88, v22, s50, 0
  v_dot2_f32_bf16 v89, v22, s51, 0
  v_dot2_f32_bf16 v92, v23, s50, 0
  v_dot2_f32_bf16 v93, v23, s51, 0
  v_dot2_f32_bf16 v96, v24, s50, 0
  v_dot2_f32_bf16 v97, v24, s51, 0
  s_waitcnt vmcnt(28)
  v_mfma_f32_16x16x32_bf16 v[64:67], v[144:147], v[28:31], v[64:67]
  s_waitcnt vmcnt(27)
  v_mfma_f32_16x16x32_bf16 v[68:71], v[144:147], v[32:35], v[68:71]
  s_waitcnt vmcnt(26)
  v_mfma_f32_16x16x32_bf16 v[72:75], v[144:147], v[36:39], v[72:75]
  s_waitcnt vmcnt(25)
  v_mfma_f32_16x16x32_bf16 v[76:79], v[144:147], v[40:43], v[76:79]
  s_waitcnt vmcnt(24)
  v_mfma_f32_16x16x32_bf16 v[80:83], v[144:147], v[44:47], v[80:83]
  s_waitcnt vmcnt(23)
  v_mfma_f32_16x16x32_bf16 v[84:87], v[144:147], v[48:51], v[84:87]
  s_waitcnt vmcnt(22)
  v_mfma_f32_16x16x32_bf16 v[88:91], v[144:147], v[52:55], v[88:91]
  s_waitcnt vmcnt(21)
  v_mfma_f32_16x16x32_bf16 v[92:95], v[144:147], v[56:59], v[92:95]
  s_waitcnt vmcnt(20)
  v_mfma_f32_16x16x32_bf16 v[96:99], v[144:147], v[60:63], v[96:99]
  v_cvt_pk_bf16_f32 v120, v64, v65
  v_cvt_pk_bf16_f32 v121, v68, v69
  v_cvt_pk_bf16_f32 v122, v72, v73
  v_cvt_pk_bf16_f32 v123, v76, v77
  v_cvt_pk_bf16_f32 v124, v80, v81
  v_cvt_pk_bf16_f32 v125, v84, v85
  v_cvt_pk_bf16_f32 v126, v88, v89
  v_cvt_pk_bf16_f32 v127, v92, v93
  v_cvt_pk_bf16_f32 v128, v96, v97
  s_add_u32 s36, s35, 1
  s_waitcnt lgkmcnt(0)
  s_min_u32 s64, s64, s65
  s_min_u32 s64, s64, s66
  s_min_u32 s64, s64, s67
  s_min_u32 s64, s64, s68
  s_min_u32 s64, s64, s69
  s_min_u32 s64, s64, s70
  s_min_u32 s64, s64, s71
  s_min_u32 s64, s64, s72
  s_min_u32 s64, s64, s73
  s_min_u32 s64, s64, s74
  s_min_u32 s64, s64, s75
  s_cmp_ge_u32 s36, s64
  s_cselect_b64 vcc, -1, 0
  s_cbranch_vccnz L_red1_fin
  s_add_u32 s47, s47, 6144
  s_cmp_ge_u32 s47, 128004
  s_cselect_b32 s47, 115716, s47
  s_mul_i32 s43, s36, 36864
  s_mul_i32 s42, s36, 147456
  s_add_u32 s42, s42, 171655168
  s_add_u32 s43, s43, 17121280
  buffer_load_dwordx4 v[16:19], v2, s[4:7], s43 offen offset:0 sc1
  buffer_load_dwordx4 v[20:23], v2, s[4:7], s43 offen offset:1024 sc1
  buffer_load_dword v24, v11, s[4:7], s43 offen sc1
  buffer_load_dwordx4 v[28:31], v3, s[4:7], s42 offen offset:0 sc1
  buffer_load_dwordx4 v[32:35], v3, s[4:7], s42 offen offset:256 sc1
  buffer_load_dwordx4 v[36:39], v3, s[4:7], s42 offen offset:512 sc1
  buffer_load_dwordx4 v[40:43], v3, s[4:7], s42 offen offset:768 sc1
  buffer_load_dwordx4 v[44:47], v3, s[4:7], s42 offen offset:1024 sc1
  buffer_load_dwordx4 v[48:51], v3, s[4:7], s42 offen offset:1280 sc1
  buffer_load_dwordx4 v[52:55], v3, s[4:7], s42 offen offset:1536 sc1
  buffer_load_dwordx4 v[56:59], v3, s[4:7], s42 offen offset:1792 sc1
  buffer_load_dwordx4 v[60:63], v3, s[4:7], s42 offen offset:2048 sc1
  s_add_u32 s56, s58, s47
  s_addc_u32 s57, s59, 0
  s_load_dword s64, s[56:57], 0 glc
  s_load_dword s65, s[56:57], 512 glc
  s_load_dword s66, s[56:57], 1024 glc
  s_load_dword s67, s[56:57], 1536 glc
  s_load_dword s68, s[56:57], 2048 glc
  s_load_dword s69, s[56:57], 2560 glc
  s_load_dword s70, s[56:57], 3072 glc
  s_load_dword s71, s[56:57], 3584 glc
  s_load_dword s72, s[56:57], 4096 glc
  s_load_dword s73, s[56:57], 4608 glc
  s_load_dword s74, s[56:57], 5120 glc
  s_load_dword s75, s[56:57], 5632 glc
  s_mul_i32 s40, s35, 36864
  s_add_u32 s44, s40, 12402688
  s_add_u32 s45, s40, 7684096
  buffer_store_dwordx4 v[120:123], v2, s[4:7], s44 offen offset:0 sc1
  buffer_store_dwordx4 v[124:127], v2, s[4:7], s44 offen offset:1024 sc1
  buffer_store_dword v128, v11, s[4:7], s44 offen sc1
  v_dot2_f32_bf16 v8, v120, s52, 0
  v_dot2_f32_bf16 v9, v121, s52, 0
  v_dot2_f32_bf16 v8, v122, s52, v8
  v_dot2_f32_bf16 v9, v123, s52, v9
  v_dot2_f32_bf16 v8, v124, s52, v8
  v_dot2_f32_bf16 v9, v125, s52, v9
  v_dot2_f32_bf16 v8, v126, s52, v8
  v_dot2_f32_bf16 v9, v127, s52, v9
  v_dot2_f32_bf16 v8, v128, s52, v8
  s_nop 2
  v_add_f32 v8, v8, v9
  s_nop 1
  v_add_f32_dpp v8, v8, v8 row_ror:8 row_mask:0xf bank_mask:0xf
  s_nop 1
  v_add_f32_dpp v8, v8, v8 row_ror:4 row_mask:0xf bank_mask:0xf
  s_nop 1
  v_add_f32_dpp v8, v8, v8 row_ror:2 row_mask:0xf bank_mask:0xf
  s_nop 1
  v_add_f32_dpp v8, v8, v8 row_ror:1 row_mask:0xf bank_mask:0xf
  v_mov_b32 v9, v8
  s_nop 1
  v_permlane16_swap_b32 v8, v9
  v_add_f32 v8, v8, v9
  v_mul_f32 v8, 0xbae38e39, v8
  v_dot2_f32_bf16 v160, v120, s50, v8
  v_dot2_f32_bf16 v161, v120, s51, v8
  v_dot2_f32_bf16 v162, v121, s50, v8
  v_dot2_f32_bf16 v163, v121, s51, v8
  v_dot2_f32_bf16 v164, v122, s50, v8
  v_dot2_f32_bf16 v165, v122, s51, v8
  v_dot2_f32_bf16 v166, v123, s50, v8
  v_dot2_f32_bf16 v167, v123, s51, v8
  v_dot2_f32_bf16 v168, v124, s50, v8
  v_dot2_f32_bf16 v169, v124, s51, v8
  v_dot2_f32_bf16 v170, v125, s50, v8
  v_dot2_f32_bf16 v171, v125, s51, v8
  v_dot2_f32_bf16 v172, v126, s50, v8
  v_dot2_f32_bf16 v173, v126, s51, v8
  v_dot2_f32_bf16 v174, v127, s50, v8
  v_dot2_f32_bf16 v175, v127, s51, v8
  v_dot2_f32_bf16 v176, v128, s50, v8
  v_dot2_f32_bf16 v177, v128, s51, v8
  v_pk_mul_f32 v[180:181], v[160:161], v[160:161]
  v_pk_mul_f32 v[182:183], v[162:163], v[162:163]
  v_pk_fma_f32 v[180:181], v[164:165], v[164:165], v[180:181]
  v_pk_fma_f32 v[182:183], v[166:167], v[166:167], v[182:183]
  v_pk_fma_f32 v[180:181], v[168:169], v[168:169], v[180:181]
  v_pk_fma_f32 v[182:183], v[170:171], v[170:171], v[182:183]
  v_pk_fma_f32 v[180:181], v[172:173], v[172:173], v[180:181]
  v_pk_fma_f32 v[182:183], v[174:175], v[174:175], v[182:183]
  v_pk_fma_f32 v[180:181], v[176:177], v[176:177], v[180:181]
  v_pk_add_f32 v[180:181], v[180:181], v[182:183]
  v_add_f32 v8, v180, v181
  s_nop 1
  v_add_f32_dpp v8, v8, v8 row_ror:8 row_mask:0xf bank_mask:0xf
  s_nop 1
  v_add_f32_dpp v8, v8, v8 row_ror:4 row_mask:0xf bank_mask:0xf
  s_nop 1
  v_add_f32_dpp v8, v8, v8 row_ror:2 row_mask:0xf bank_mask:0xf
  s_nop 1
  v_add_f32_dpp v8, v8, v8 row_ror:1 row_mask:0xf bank_mask:0xf
  v_mov_b32 v9, v8
  s_nop 1
  v_permlane16_swap_b32 v8, v9
  v_add_f32 v8, v8, v9
  v_fmamk_f32 v8, v8, 0x3ae38e39, v12
  v_rsq_f32 v8, v8
  s_nop 0
  v_pk_mul_f32 v[160:161], v[160:161], v[8:9] op_sel_hi:[1,0]
  v_pk_mul_f32 v[162:163], v[162:163], v[8:9] op_sel_hi:[1,0]
  v_pk_mul_f32 v[164:165], v[164:165], v[8:9] op_sel_hi:[1,0]
  v_pk_mul_f32 v[166:167], v[166:167], v[8:9] op_sel_hi:[1,0]
  v_pk_mul_f32 v[168:169], v[168:169], v[8:9] op_sel_hi:[1,0]
  v_pk_mul_f32 v[170:171], v[170:171], v[8:9] op_sel_hi:[1,0]
  v_pk_mul_f32 v[172:173], v[172:173], v[8:9] op_sel_hi:[1,0]
  v_pk_mul_f32 v[174:175], v[174:175], v[8:9] op_sel_hi:[1,0]
  v_pk_mul_f32 v[176:177], v[176:177], v[8:9] op_sel_hi:[1,0]
  v_cvt_pk_bf16_f32 v132, v160, v161
  v_cvt_pk_bf16_f32 v133, v162, v163
  v_cvt_pk_bf16_f32 v134, v164, v165
  v_cvt_pk_bf16_f32 v135, v166, v167
  v_cvt_pk_bf16_f32 v136, v168, v169
  v_cvt_pk_bf16_f32 v137, v170, v171
  v_cvt_pk_bf16_f32 v138, v172, v173
  v_cvt_pk_bf16_f32 v139, v174, v175
  v_cvt_pk_bf16_f32 v140, v176, v177
  ds_write2_b32 v13, v132, v133 offset0:0 offset1:32
  ds_write2_b32 v13, v134, v135 offset0:64 offset1:96
  ds_write2_b32 v13, v136, v137 offset0:128 offset1:160
  ds_write2_b32 v13, v138, v139 offset0:192 offset1:224
  ds_write_b32 v13, v140 offset:1024
  ds_read_b128 v[148:151], v14 offset:0
  ds_read_b128 v[152:155], v14 offset:384
  ds_read_b128 v[156:159], v14 offset:768
  s_waitcnt lgkmcnt(2)
  buffer_store_dwordx4 v[148:151], v1, s[4:7], s45 offen offset:0 sc1
  s_waitcnt lgkmcnt(1)
  buffer_store_dwordx4 v[152:155], v1, s[4:7], s45 offen offset:384 sc1
  s_waitcnt lgkmcnt(0)
  buffer_store_dwordx4 v[156:159], v1, s[4:7], s45 offen offset:768 sc1
  s_waitcnt vmcnt(0)
  s_add_u32 s98, s35, 1
  v_mov_b32 v6, s98
  s_mov_b64 exec, 255
  buffer_store_dword v6, v191, s[4:7], s46 offen sc1
  s_mov_b64 exec, -1
  s_mov_b32 s35, s36
  s_branch L_red1_sum2
L_red_g2:
  s_mov_b32 s35, 0
  s_mov_b32 s47, 146432
L_red2_poll:
  s_add_u32 s56, s58, s47
  s_addc_u32 s57, s59, 0
  s_load_dword s64, s[56:57], 0 glc
  s_load_dword s65, s[56:57], 512 glc
  s_load_dword s66, s[56:57], 1024 glc
  s_load_dword s67, s[56:57], 1536 glc
  s_load_dword s68, s[56:57], 2048 glc
  s_load_dword s69, s[56:57], 2560 glc
  s_load_dword s70, s[56:57], 3072 glc
  s_load_dword s71, s[56:57], 3584 glc
  s_load_dword s72, s[56:57], 4096 glc
  s_load_dword s73, s[56:57], 4608 glc
  s_load_dword s74, s[56:57], 5120 glc
  s_load_dword s75, s[56:57], 5632 glc
  s_waitcnt lgkmcnt(0)
  s_min_u32 s64, s64, s65
  s_min_u32 s64, s64, s66
  s_min_u32 s64, s64, s67
  s_min_u32 s64, s64, s68
  s_min_u32 s64, s64, s69
  s_min_u32 s64, s64, s70
  s_min_u32 s64, s64, s71
  s_min_u32 s64, s64, s72
  s_min_u32 s64, s64, s73
  s_min_u32 s64, s64, s74
  s_min_u32 s64, s64, s75
  s_cmp_ge_u32 s35, s64
  s_cselect_b64 vcc, -1, 0
  s_cbranch_vccz L_red2_go
  s_add_u32 s60, s60, 1
  s_cmp_gt_u32 s60, 262144
  s_cbranch_scc1 L_fail_red
  s_branch L_red2_poll
L_red2_go:
  s_add_u32 s47, s47, 6144
  s_cmp_ge_u32 s47, 164864
  s_cselect_b32 s47, 146432, s47
  s_mul_i32 s43, s35, 36864
  s_mul_i32 s42, s35, 147456
  s_add_u32 s42, s42, 190529536
  s_add_u32 s43, s43, 12402688
  buffer_load_dwordx4 v[16:19], v2, s[4:7], s43 offen offset:0 sc1
  buffer_load_dwordx4 v[20:23], v2, s[4:7], s43 offen offset:1024 sc1
  buffer_load_dword v24, v11, s[4:7], s43 offen sc1
  buffer_load_dwordx4 v[28:31], v3, s[4:7], s42 offen offset:0 sc1
  buffer_load_dwordx4 v[32:35], v3, s[4:7], s42 offen offset:256 sc1
  buffer_load_dwordx4 v[36:39], v3, s[4:7], s42 offen offset:512 sc1
  buffer_load_dwordx4 v[40:43], v3, s[4:7], s42 offen offset:768 sc1
  buffer_load_dwordx4 v[44:47], v3, s[4:7], s42 offen offset:1024 sc1
  buffer_load_dwordx4 v[48:51], v3, s[4:7], s42 offen offset:1280 sc1
  buffer_load_dwordx4 v[52:55], v3, s[4:7], s42 offen offset:1536 sc1
  buffer_load_dwordx4 v[56:59], v3, s[4:7], s42 offen offset:1792 sc1
  buffer_load_dwordx4 v[60:63], v3, s[4:7], s42 offen offset:2048 sc1
  s_add_u32 s56, s58, s47
  s_addc_u32 s57, s59, 0
  s_load_dword s64, s[56:57], 0 glc
  s_load_dword s65, s[56:57], 512 glc
  s_load_dword s66, s[56:57], 1024 glc
  s_load_dword s67, s[56:57], 1536 glc
  s_load_dword s68, s[56:57], 2048 glc
  s_load_dword s69, s[56:57], 2560 glc
  s_load_dword s70, s[56:57], 3072 glc
  s_load_dword s71, s[56:57], 3584 glc
  s_load_dword s72, s[56:57], 4096 glc
  s_load_dword s73, s[56:57], 4608 glc
  s_load_dword s74, s[56:57], 5120 glc
  s_load_dword s75, s[56:57], 5632 glc
L_red2_sum:
  s_waitcnt vmcnt(9)
  v_dot2_f32_bf16 v64, v16, s50, v100
  v_dot2_f32_bf16 v65, v16, s51, v101
  v_dot2_f32_bf16 v68, v17, s50, v102
  v_dot2_f32_bf16 v69, v17, s51, v103
  v_dot2_f32_bf16 v72, v18, s50, v104
  v_dot2_f32_bf16 v73, v18, s51, v105
  v_dot2_f32_bf16 v76, v19, s50, v106
  v_dot2_f32_bf16 v77, v19, s51, v107
  v_dot2_f32_bf16 v80, v20, s50, v108
  v_dot2_f32_bf16 v81, v20, s51, v109
  v_dot2_f32_bf16 v84, v21, s50, v110
  v_dot2_f32_bf16 v85, v21, s51, v111
  v_dot2_f32_bf16 v88, v22, s50, v112
  v_dot2_f32_bf16 v89, v22, s51, v113
  v_dot2_f32_bf16 v92, v23, s50, v114
  v_dot2_f32_bf16 v93, v23, s51, v115
  v_dot2_f32_bf16 v96, v24, s50, v116
  v_dot2_f32_bf16 v97, v24, s51, v117
  s_waitcnt vmcnt(8)
  v_mfma_f32_16x16x32_bf16 v[64:67], v[144:147], v[28:31], v[64:67]
  s_waitcnt vmcnt(7)
  v_mfma_f32_16x16x32_bf16 v[68:71], v[144:147], v[32:35], v[68:71]
  s_waitcnt vmcnt(6)
  v_mfma_f32_16x16x32_bf16 v[72:75], v[144:147], v[36:39], v[72:75]
  s_waitcnt vmcnt(5)
  v_mfma_f32_16x16x32_bf16 v[76:79], v[144:147], v[40:43], v[76:79]
  s_waitcnt vmcnt(4)
  v_mfma_f32_16x16x32_bf16 v[80:83], v[144:147], v[44:47], v[80:83]
  s_waitcnt vmcnt(3)
  v_mfma_f32_16x16x32_bf16 v[84:87], v[144:147], v[48:51], v[84:87]
  s_waitcnt vmcnt(2)
  v_mfma_f32_16x16x32_bf16 v[88:91], v[144:147], v[52:55], v[88:91]
  s_waitcnt vmcnt(1)
  v_mfma_f32_16x16x32_bf16 v[92:95], v[144:147], v[56:59], v[92:95]
  s_waitcnt vmcnt(0)
  v_mfma_f32_16x16x32_bf16 v[96:99], v[144:147], v[60:63], v[96:99]
  v_cvt_pk_bf16_f32 v120, v64, v65
  v_cvt_pk_bf16_f32 v121, v68, v69
  v_cvt_pk_bf16_f32 v122, v72, v73
  v_cvt_pk_bf16_f32 v123, v76, v77
  v_cvt_pk_bf16_f32 v124, v80, v81
  v_cvt_pk_bf16_f32 v125, v84, v85
  v_cvt_pk_bf16_f32 v126, v88, v89
  v_cvt_pk_bf16_f32 v127, v92, v93
  v_cvt_pk_bf16_f32 v128, v96, v97
  s_add_u32 s36, s35, 1
  s_waitcnt vmcnt(0)
  s_waitcnt lgkmcnt(0)
  s_min_u32 s64, s64, s65
  s_min_u32 s64, s64, s66
  s_min_u32 s64, s64, s67
  s_min_u32 s64, s64, s68
  s_min_u32 s64, s64, s69
  s_min_u32 s64, s64, s70
  s_min_u32 s64, s64, s71
  s_min_u32 s64, s64, s72
  s_min_u32 s64, s64, s73
  s_min_u32 s64, s64, s74
  s_min_u32 s64, s64, s75
  s_cmp_ge_u32 s36, s64
  s_cselect_b64 vcc, -1, 0
  s_cbranch_vccnz L_red2_fin
  s_add_u32 s47, s47, 6144
  s_cmp_ge_u32 s47, 164864
  s_cselect_b32 s47, 146432, s47
  s_mul_i32 s43, s36, 36864
  s_mul_i32 s42, s36, 147456
  s_add_u32 s42, s42, 190529536
  s_add_u32 s43, s43, 12402688
  buffer_load_dwordx4 v[16:19], v2, s[4:7], s43 offen offset:0 sc1
  buffer_load_dwordx4 v[20:23], v2, s[4:7], s43 offen offset:1024 sc1
  buffer_load_dword v24, v11, s[4:7], s43 offen sc1
  buffer_load_dwordx4 v[28:31], v3, s[4:7], s42 offen offset:0 sc1
  buffer_load_dwordx4 v[32:35], v3, s[4:7], s42 offen offset:256 sc1
  buffer_load_dwordx4 v[36:39], v3, s[4:7], s42 offen offset:512 sc1
  buffer_load_dwordx4 v[40:43], v3, s[4:7], s42 offen offset:768 sc1
  buffer_load_dwordx4 v[44:47], v3, s[4:7], s42 offen offset:1024 sc1
  buffer_load_dwordx4 v[48:51], v3, s[4:7], s42 offen offset:1280 sc1
  buffer_load_dwordx4 v[52:55], v3, s[4:7], s42 offen offset:1536 sc1
  buffer_load_dwordx4 v[56:59], v3, s[4:7], s42 offen offset:1792 sc1
  buffer_load_dwordx4 v[60:63], v3, s[4:7], s42 offen offset:2048 sc1
  s_add_u32 s56, s58, s47
  s_addc_u32 s57, s59, 0
  s_load_dword s64, s[56:57], 0 glc
  s_load_dword s65, s[56:57], 512 glc
  s_load_dword s66, s[56:57], 1024 glc
  s_load_dword s67, s[56:57], 1536 glc
  s_load_dword s68, s[56:57], 2048 glc
  s_load_dword s69, s[56:57], 2560 glc
  s_load_dword s70, s[56:57], 3072 glc
  s_load_dword s71, s[56:57], 3584 glc
  s_load_dword s72, s[56:57], 4096 glc
  s_load_dword s73, s[56:57], 4608 glc
  s_load_dword s74, s[56:57], 5120 glc
  s_load_dword s75, s[56:57], 5632 glc
  s_mul_i32 s40, s35, 36864
  s_add_u32 s44, s40, 17121280
  s_add_u32 s45, s40, 2965504
  buffer_store_dwordx4 v[120:123], v2, s[4:7], s44 offen offset:0 sc1
  buffer_store_dwordx4 v[124:127], v2, s[4:7], s44 offen offset:1024 sc1
  buffer_store_dword v128, v11, s[4:7], s44 offen sc1
  v_dot2_f32_bf16 v8, v120, s52, 0
  v_dot2_f32_bf16 v9, v121, s52, 0
  v_dot2_f32_bf16 v8, v122, s52, v8
  v_dot2_f32_bf16 v9, v123, s52, v9
  v_dot2_f32_bf16 v8, v124, s52, v8
  v_dot2_f32_bf16 v9, v125, s52, v9
  v_dot2_f32_bf16 v8, v126, s52, v8
  v_dot2_f32_bf16 v9, v127, s52, v9
  v_dot2_f32_bf16 v8, v128, s52, v8
  s_nop 2
  v_add_f32 v8, v8, v9
  s_nop 1
  v_add_f32_dpp v8, v8, v8 row_ror:8 row_mask:0xf bank_mask:0xf
  s_nop 1
  v_add_f32_dpp v8, v8, v8 row_ror:4 row_mask:0xf bank_mask:0xf
  s_nop 1
  v_add_f32_dpp v8, v8, v8 row_ror:2 row_mask:0xf bank_mask:0xf
  s_nop 1
  v_add_f32_dpp v8, v8, v8 row_ror:1 row_mask:0xf bank_mask:0xf
  v_mov_b32 v9, v8
  s_nop 1
  v_permlane16_swap_b32 v8, v9
  v_add_f32 v8, v8, v9
  v_mul_f32 v8, 0xbae38e39, v8
  v_dot2_f32_bf16 v160, v120, s50, v8
  v_dot2_f32_bf16 v161, v120, s51, v8
  v_dot2_f32_bf16 v162, v121, s50, v8
  v_dot2_f32_bf16 v163, v121, s51, v8
  v_dot2_f32_bf16 v164, v122, s50, v8
  v_dot2_f32_bf16 v165, v122, s51, v8
  v_dot2_f32_bf16 v166, v123, s50, v8
  v_dot2_f32_bf16 v167, v123, s51, v8
  v_dot2_f32_bf16 v168, v124, s50, v8
  v_dot2_f32_bf16 v169, v124, s51, v8
  v_dot2_f32_bf16 v170, v125, s50, v8
  v_dot2_f32_bf16 v171, v125, s51, v8
  v_dot2_f32_bf16 v172, v126, s50, v8
  v_dot2_f32_bf16 v173, v126, s51, v8
  v_dot2_f32_bf16 v174, v127, s50, v8
  v_dot2_f32_bf16 v175, v127, s51, v8
  v_dot2_f32_bf16 v176, v128, s50, v8
  v_dot2_f32_bf16 v177, v128, s51, v8
  v_pk_mul_f32 v[180:181], v[160:161], v[160:161]
  v_pk_mul_f32 v[182:183], v[162:163], v[162:163]
  v_pk_fma_f32 v[180:181], v[164:165], v[164:165], v[180:181]
  v_pk_fma_f32 v[182:183], v[166:167], v[166:167], v[182:183]
  v_pk_fma_f32 v[180:181], v[168:169], v[168:169], v[180:181]
  v_pk_fma_f32 v[182:183], v[170:171], v[170:171], v[182:183]
  v_pk_fma_f32 v[180:181], v[172:173], v[172:173], v[180:181]
  v_pk_fma_f32 v[182:183], v[174:175], v[174:175], v[182:183]
  v_pk_fma_f32 v[180:181], v[176:177], v[176:177], v[180:181]
  v_pk_add_f32 v[180:181], v[180:181], v[182:183]
  v_add_f32 v8, v180, v181
  s_nop 1
  v_add_f32_dpp v8, v8, v8 row_ror:8 row_mask:0xf bank_mask:0xf
  s_nop 1
  v_add_f32_dpp v8, v8, v8 row_ror:4 row_mask:0xf bank_mask:0xf
  s_nop 1
  v_add_f32_dpp v8, v8, v8 row_ror:2 row_mask:0xf bank_mask:0xf
  s_nop 1
  v_add_f32_dpp v8, v8, v8 row_ror:1 row_mask:0xf bank_mask:0xf
  v_mov_b32 v9, v8
  s_nop 1
  v_permlane16_swap_b32 v8, v9
  v_add_f32 v8, v8, v9
  v_fmamk_f32 v8, v8, 0x3ae38e39, v12
  v_rsq_f32 v8, v8
  s_nop 0
  v_pk_mul_f32 v[160:161], v[160:161], v[8:9] op_sel_hi:[1,0]
  v_pk_mul_f32 v[162:163], v[162:163], v[8:9] op_sel_hi:[1,0]
  v_pk_mul_f32 v[164:165], v[164:165], v[8:9] op_sel_hi:[1,0]
  v_pk_mul_f32 v[166:167], v[166:167], v[8:9] op_sel_hi:[1,0]
  v_pk_mul_f32 v[168:169], v[168:169], v[8:9] op_sel_hi:[1,0]
  v_pk_mul_f32 v[170:171], v[170:171], v[8:9] op_sel_hi:[1,0]
  v_pk_mul_f32 v[172:173], v[172:173], v[8:9] op_sel_hi:[1,0]
  v_pk_mul_f32 v[174:175], v[174:175], v[8:9] op_sel_hi:[1,0]
  v_pk_mul_f32 v[176:177], v[176:177], v[8:9] op_sel_hi:[1,0]
  v_cvt_pk_bf16_f32 v132, v160, v161
  v_cvt_pk_bf16_f32 v133, v162, v163
  v_cvt_pk_bf16_f32 v134, v164, v165
  v_cvt_pk_bf16_f32 v135, v166, v167
  v_cvt_pk_bf16_f32 v136, v168, v169
  v_cvt_pk_bf16_f32 v137, v170, v171
  v_cvt_pk_bf16_f32 v138, v172, v173
  v_cvt_pk_bf16_f32 v139, v174, v175
  v_cvt_pk_bf16_f32 v140, v176, v177
  ds_write2_b32 v13, v132, v133 offset0:0 offset1:32
  ds_write2_b32 v13, v134, v135 offset0:64 offset1:96
  ds_write2_b32 v13, v136, v137 offset0:128 offset1:160
  ds_write2_b32 v13, v138, v139 offset0:192 offset1:224
  ds_write_b32 v13, v140 offset:1024
  ds_read_b128 v[148:151], v14 offset:0
  ds_read_b128 v[152:155], v14 offset:384
  ds_read_b128 v[156:159], v14 offset:768
  s_waitcnt lgkmcnt(2)
  buffer_store_dwordx4 v[148:151], v1, s[4:7], s45 offen offset:0 sc1
  s_waitcnt lgkmcnt(1)
  buffer_store_dwordx4 v[152:155], v1, s[4:7], s45 offen offset:384 sc1
  s_waitcnt lgkmcnt(0)
  buffer_store_dwordx4 v[156:159], v1, s[4:7], s45 offen offset:768 sc1
  s_waitcnt vmcnt(0)
  s_add_u32 s98, s35, 1
  v_mov_b32 v6, s98
  s_mov_b64 exec, 255
  buffer_store_dword v6, v191, s[4:7], s46 offen sc1
  s_mov_b64 exec, -1
  s_mov_b32 s35, s36
  s_branch L_red2_sum2
L_red2_fin:
  s_mul_i32 s40, s35, 36864
  s_add_u32 s44, s40, 17121280
  s_add_u32 s45, s40, 2965504
  buffer_store_dwordx4 v[120:123], v2, s[4:7], s44 offen offset:0 sc1
  buffer_store_dwordx4 v[124:127], v2, s[4:7], s44 offen offset:1024 sc1
  buffer_store_dword v128, v11, s[4:7], s44 offen sc1
  v_dot2_f32_bf16 v8, v120, s52, 0
  v_dot2_f32_bf16 v9, v121, s52, 0
  v_dot2_f32_bf16 v8, v122, s52, v8
  v_dot2_f32_bf16 v9, v123, s52, v9
  v_dot2_f32_bf16 v8, v124, s52, v8
  v_dot2_f32_bf16 v9, v125, s52, v9
  v_dot2_f32_bf16 v8, v126, s52, v8
  v_dot2_f32_bf16 v9, v127, s52, v9
  v_dot2_f32_bf16 v8, v128, s52, v8
  s_nop 2
  v_add_f32 v8, v8, v9
  s_nop 1
  v_add_f32_dpp v8, v8, v8 row_ror:8 row_mask:0xf bank_mask:0xf
  s_nop 1
  v_add_f32_dpp v8, v8, v8 row_ror:4 row_mask:0xf bank_mask:0xf
  s_nop 1
  v_add_f32_dpp v8, v8, v8 row_ror:2 row_mask:0xf bank_mask:0xf
  s_nop 1
  v_add_f32_dpp v8, v8, v8 row_ror:1 row_mask:0xf bank_mask:0xf
  v_mov_b32 v9, v8
  s_nop 1
  v_permlane16_swap_b32 v8, v9
  v_add_f32 v8, v8, v9
  v_mul_f32 v8, 0xbae38e39, v8
  v_dot2_f32_bf16 v160, v120, s50, v8
  v_dot2_f32_bf16 v161, v120, s51, v8
  v_dot2_f32_bf16 v162, v121, s50, v8
  v_dot2_f32_bf16 v163, v121, s51, v8
  v_dot2_f32_bf16 v164, v122, s50, v8
  v_dot2_f32_bf16 v165, v122, s51, v8
  v_dot2_f32_bf16 v166, v123, s50, v8
  v_dot2_f32_bf16 v167, v123, s51, v8
  v_dot2_f32_bf16 v168, v124, s50, v8
  v_dot2_f32_bf16 v169, v124, s51, v8
  v_dot2_f32_bf16 v170, v125, s50, v8
  v_dot2_f32_bf16 v171, v125, s51, v8
  v_dot2_f32_bf16 v172, v126, s50, v8
  v_dot2_f32_bf16 v173, v126, s51, v8
  v_dot2_f32_bf16 v174, v127, s50, v8
  v_dot2_f32_bf16 v175, v127, s51, v8
  v_dot2_f32_bf16 v176, v128, s50, v8
  v_dot2_f32_bf16 v177, v128, s51, v8
  v_pk_mul_f32 v[180:181], v[160:161], v[160:161]
  v_pk_mul_f32 v[182:183], v[162:163], v[162:163]
  v_pk_fma_f32 v[180:181], v[164:165], v[164:165], v[180:181]
  v_pk_fma_f32 v[182:183], v[166:167], v[166:167], v[182:183]
  v_pk_fma_f32 v[180:181], v[168:169], v[168:169], v[180:181]
  v_pk_fma_f32 v[182:183], v[170:171], v[170:171], v[182:183]
  v_pk_fma_f32 v[180:181], v[172:173], v[172:173], v[180:181]
  v_pk_fma_f32 v[182:183], v[174:175], v[174:175], v[182:183]
  v_pk_fma_f32 v[180:181], v[176:177], v[176:177], v[180:181]
  v_pk_add_f32 v[180:181], v[180:181], v[182:183]
  v_add_f32 v8, v180, v181
  s_nop 1
  v_add_f32_dpp v8, v8, v8 row_ror:8 row_mask:0xf bank_mask:0xf
  s_nop 1
  v_add_f32_dpp v8, v8, v8 row_ror:4 row_mask:0xf bank_mask:0xf
  s_nop 1
  v_add_f32_dpp v8, v8, v8 row_ror:2 row_mask:0xf bank_mask:0xf
  s_nop 1
  v_add_f32_dpp v8, v8, v8 row_ror:1 row_mask:0xf bank_mask:0xf
  v_mov_b32 v9, v8
  s_nop 1
  v_permlane16_swap_b32 v8, v9
  v_add_f32 v8, v8, v9
  v_fmamk_f32 v8, v8, 0x3ae38e39, v12
  v_rsq_f32 v8, v8
  s_nop 0
  v_pk_mul_f32 v[160:161], v[160:161], v[8:9] op_sel_hi:[1,0]
  v_pk_mul_f32 v[162:163], v[162:163], v[8:9] op_sel_hi:[1,0]
  v_pk_mul_f32 v[164:165], v[164:165], v[8:9] op_sel_hi:[1,0]
  v_pk_mul_f32 v[166:167], v[166:167], v[8:9] op_sel_hi:[1,0]
  v_pk_mul_f32 v[168:169], v[168:169], v[8:9] op_sel_hi:[1,0]
  v_pk_mul_f32 v[170:171], v[170:171], v[8:9] op_sel_hi:[1,0]
  v_pk_mul_f32 v[172:173], v[172:173], v[8:9] op_sel_hi:[1,0]
  v_pk_mul_f32 v[174:175], v[174:175], v[8:9] op_sel_hi:[1,0]
  v_pk_mul_f32 v[176:177], v[176:177], v[8:9] op_sel_hi:[1,0]
  v_cvt_pk_bf16_f32 v132, v160, v161
  v_cvt_pk_bf16_f32 v133, v162, v163
  v_cvt_pk_bf16_f32 v134, v164, v165
  v_cvt_pk_bf16_f32 v135, v166, v167
  v_cvt_pk_bf16_f32 v136, v168, v169
  v_cvt_pk_bf16_f32 v137, v170, v171
  v_cvt_pk_bf16_f32 v138, v172, v173
  v_cvt_pk_bf16_f32 v139, v174, v175
  v_cvt_pk_bf16_f32 v140, v176, v177
  ds_write2_b32 v13, v132, v133 offset0:0 offset1:32
  ds_write2_b32 v13, v134, v135 offset0:64 offset1:96
  ds_write2_b32 v13, v136, v137 offset0:128 offset1:160
  ds_write2_b32 v13, v138, v139 offset0:192 offset1:224
  ds_write_b32 v13, v140 offset:1024
  ds_read_b128 v[148:151], v14 offset:0
  ds_read_b128 v[152:155], v14 offset:384
  ds_read_b128 v[156:159], v14 offset:768
  s_waitcnt lgkmcnt(2)
  buffer_store_dwordx4 v[148:151], v1, s[4:7], s45 offen offset:0 sc1
  s_waitcnt lgkmcnt(1)
  buffer_store_dwordx4 v[152:155], v1, s[4:7], s45 offen offset:384 sc1
  s_waitcnt lgkmcnt(0)
  buffer_store_dwordx4 v[156:159], v1, s[4:7], s45 offen offset:768 sc1
  s_add_u32 s56, s58, s47
  s_addc_u32 s57, s59, 0
  s_load_dword s64, s[56:57], 0 glc
  s_load_dword s65, s[56:57], 512 glc
  s_load_dword s66, s[56:57], 1024 glc
  s_load_dword s67, s[56:57], 1536 glc
  s_load_dword s68, s[56:57], 2048 glc
  s_load_dword s69, s[56:57], 2560 glc
  s_load_dword s70, s[56:57], 3072 glc
  s_load_dword s71, s[56:57], 3584 glc
  s_load_dword s72, s[56:57], 4096 glc
  s_load_dword s73, s[56:57], 4608 glc
  s_load_dword s74, s[56:57], 5120 glc
  s_load_dword s75, s[56:57], 5632 glc
  s_waitcnt vmcnt(0)
  s_add_u32 s98, s35, 1
  v_mov_b32 v6, s98
  s_mov_b64 exec, 255
  buffer_store_dword v6, v191, s[4:7], s46 offen sc1
  s_mov_b64 exec, -1
  s_add_u32 s35, s35, 1
  s_cmp_ge_u32 s35, 64
  s_cbranch_scc1 L_red2_end
  s_waitcnt lgkmcnt(0)
  s_min_u32 s64, s64, s65
  s_min_u32 s64, s64, s66
  s_min_u32 s64, s64, s67
  s_min_u32 s64, s64, s68
  s_min_u32 s64, s64, s69
  s_min_u32 s64, s64, s70
  s_min_u32 s64, s64, s71
  s_min_u32 s64, s64, s72
  s_min_u32 s64, s64, s73
  s_min_u32 s64, s64, s74
  s_min_u32 s64, s64, s75
  s_cmp_ge_u32 s35, s64
  s_cselect_b64 vcc, -1, 0
  s_cbranch_vccz L_red2_go
  s_branch L_red2_poll
L_red2_end:
  s_endpgm
L_red2_sum2:
  s_waitcnt vmcnt(29)
  v_dot2_f32_bf16 v64, v16, s50, v100
  v_dot2_f32_bf16 v65, v16, s51, v101
  v_dot2_f32_bf16 v68, v17, s50, v102
  v_dot2_f32_bf16 v69, v17, s51, v103
  v_dot2_f32_bf16 v72, v18, s50, v104
  v_dot2_f32_bf16 v73, v18, s51, v105
  v_dot2_f32_bf16 v76, v19, s50, v106
  v_dot2_f32_bf16 v77, v19, s51, v107
  v_dot2_f32_bf16 v80, v20, s50, v108
  v_dot2_f32_bf16 v81, v20, s51, v109
  v_dot2_f32_bf16 v84, v21, s50, v110
  v_dot2_f32_bf16 v85, v21, s51, v111
  v_dot2_f32_bf16 v88, v22, s50, v112
  v_dot2_f32_bf16 v89, v22, s51, v113
  v_dot2_f32_bf16 v92, v23, s50, v114
  v_dot2_f32_bf16 v93, v23, s51, v115
  v_dot2_f32_bf16 v96, v24, s50, v116
  v_dot2_f32_bf16 v97, v24, s51, v117
  s_waitcnt vmcnt(28)
  v_mfma_f32_16x16x32_bf16 v[64:67], v[144:147], v[28:31], v[64:67]
  s_waitcnt vmcnt(27)
  v_mfma_f32_16x16x32_bf16 v[68:71], v[144:147], v[32:35], v[68:71]
  s_waitcnt vmcnt(26)
  v_mfma_f32_16x16x32_bf16 v[72:75], v[144:147], v[36:39], v[72:75]
  s_waitcnt vmcnt(25)
  v_mfma_f32_16x16x32_bf16 v[76:79], v[144:147], v[40:43], v[76:79]
  s_waitcnt vmcnt(24)
  v_mfma_f32_16x16x32_bf16 v[80:83], v[144:147], v[44:47], v[80:83]
  s_waitcnt vmcnt(23)
  v_mfma_f32_16x16x32_bf16 v[84:87], v[144:147], v[48:51], v[84:87]
  s_waitcnt vmcnt(22)
  v_mfma_f32_16x16x32_bf16 v[88:91], v[144:147], v[52:55], v[88:91]
  s_waitcnt vmcnt(21)
  v_mfma_f32_16x16x32_bf16 v[92:95], v[144:147], v[56:59], v[92:95]
  s_waitcnt vmcnt(20)
  v_mfma_f32_16x16x32_bf16 v[96:99], v[144:147], v[60:63], v[96:99]
  v_cvt_pk_bf16_f32 v120, v64, v65
  v_cvt_pk_bf16_f32 v121, v68, v69
  v_cvt_pk_bf16_f32 v122, v72, v73
  v_cvt_pk_bf16_f32 v123, v76, v77
  v_cvt_pk_bf16_f32 v124, v80, v81
  v_cvt_pk_bf16_f32 v125, v84, v85
  v_cvt_pk_bf16_f32 v126, v88, v89
  v_cvt_pk_bf16_f32 v127, v92, v93
  v_cvt_pk_bf16_f32 v128, v96, v97
  s_add_u32 s36, s35, 1
  s_waitcnt lgkmcnt(0)
  s_min_u32 s64, s64, s65
  s_min_u32 s64, s64, s66
  s_min_u32 s64, s64, s67
  s_min_u32 s64, s64, s68
  s_min_u32 s64, s64, s69
  s_min_u32 s64, s64, s70
  s_min_u32 s64, s64, s71
  s_min_u32 s64, s64, s72
  s_min_u32 s64, s64, s73
  s_min_u32 s64, s64, s74
  s_min_u32 s64, s64, s75
  s_cmp_ge_u32 s36, s64
  s_cselect_b64 vcc, -1, 0
  s_cbranch_vccnz L_red2_fin
  s_add_u32 s47, s47, 6144
  s_cmp_ge_u32 s47, 164864
  s_cselect_b32 s47, 146432, s47
  s_mul_i32 s43, s36, 36864
  s_mul_i32 s42, s36, 147456
  s_add_u32 s42, s42, 190529536
  s_add_u32 s43, s43, 12402688
  buffer_load_dwordx4 v[16:19], v2, s[4:7], s43 offen offset:0 sc1
  buffer_load_dwordx4 v[20:23], v2, s[4:7], s43 offen offset:1024 sc1
  buffer_load_dword v24, v11, s[4:7], s43 offen sc1
  buffer_load_dwordx4 v[28:31], v3, s[4:7], s42 offen offset:0 sc1
  buffer_load_dwordx4 v[32:35], v3, s[4:7], s42 offen offset:256 sc1
  buffer_load_dwordx4 v[36:39], v3, s[4:7], s42 offen offset:512 sc1
  buffer_load_dwordx4 v[40:43], v3, s[4:7], s42 offen offset:768 sc1
  buffer_load_dwordx4 v[44:47], v3, s[4:7], s42 offen offset:1024 sc1
  buffer_load_dwordx4 v[48:51], v3, s[4:7], s42 offen offset:1280 sc1
  buffer_load_dwordx4 v[52:55], v3, s[4:7], s42 offen offset:1536 sc1
  buffer_load_dwordx4 v[56:59], v3, s[4:7], s42 offen offset:1792 sc1
  buffer_load_dwordx4 v[60:63], v3, s[4:7], s42 offen offset:2048 sc1
  s_add_u32 s56, s58, s47
  s_addc_u32 s57, s59, 0
  s_load_dword s64, s[56:57], 0 glc
  s_load_dword s65, s[56:57], 512 glc
  s_load_dword s66, s[56:57], 1024 glc
  s_load_dword s67, s[56:57], 1536 glc
  s_load_dword s68, s[56:57], 2048 glc
  s_load_dword s69, s[56:57], 2560 glc
  s_load_dword s70, s[56:57], 3072 glc
  s_load_dword s71, s[56:57], 3584 glc
  s_load_dword s72, s[56:57], 4096 glc
  s_load_dword s73, s[56:57], 4608 glc
  s_load_dword s74, s[56:57], 5120 glc
  s_load_dword s75, s[56:57], 5632 glc
  s_mul_i32 s40, s35, 36864
  s_add_u32 s44, s40, 17121280
  s_add_u32 s45, s40, 2965504
  buffer_store_dwordx4 v[120:123], v2, s[4:7], s44 offen offset:0 sc1
  buffer_store_dwordx4 v[124:127], v2, s[4:7], s44 offen offset:1024 sc1
  buffer_store_dword v128, v11, s[4:7], s44 offen sc1
  v_dot2_f32_bf16 v8, v120, s52, 0
  v_dot2_f32_bf16 v9, v121, s52, 0
  v_dot2_f32_bf16 v8, v122, s52, v8
  v_dot2_f32_bf16 v9, v123, s52, v9
  v_dot2_f32_bf16 v8, v124, s52, v8
  v_dot2_f32_bf16 v9, v125, s52, v9
  v_dot2_f32_bf16 v8, v126, s52, v8
  v_dot2_f32_bf16 v9, v127, s52, v9
  v_dot2_f32_bf16 v8, v128, s52, v8
  s_nop 2
  v_add_f32 v8, v8, v9
  s_nop 1
  v_add_f32_dpp v8, v8, v8 row_ror:8 row_mask:0xf bank_mask:0xf
  s_nop 1
  v_add_f32_dpp v8, v8, v8 row_ror:4 row_mask:0xf bank_mask:0xf
  s_nop 1
  v_add_f32_dpp v8, v8, v8 row_ror:2 row_mask:0xf bank_mask:0xf
  s_nop 1
  v_add_f32_dpp v8, v8, v8 row_ror:1 row_mask:0xf bank_mask:0xf
  v_mov_b32 v9, v8
  s_nop 1
  v_permlane16_swap_b32 v8, v9
  v_add_f32 v8, v8, v9
  v_mul_f32 v8, 0xbae38e39, v8
  v_dot2_f32_bf16 v160, v120, s50, v8
  v_dot2_f32_bf16 v161, v120, s51, v8
  v_dot2_f32_bf16 v162, v121, s50, v8
  v_dot2_f32_bf16 v163, v121, s51, v8
  v_dot2_f32_bf16 v164, v122, s50, v8
  v_dot2_f32_bf16 v165, v122, s51, v8
  v_dot2_f32_bf16 v166, v123, s50, v8
  v_dot2_f32_bf16 v167, v123, s51, v8
  v_dot2_f32_bf16 v168, v124, s50, v8
  v_dot2_f32_bf16 v169, v124, s51, v8
  v_dot2_f32_bf16 v170, v125, s50, v8
  v_dot2_f32_bf16 v171, v125, s51, v8
  v_dot2_f32_bf16 v172, v126, s50, v8
  v_dot2_f32_bf16 v173, v126, s51, v8
  v_dot2_f32_bf16 v174, v127, s50, v8
  v_dot2_f32_bf16 v175, v127, s51, v8
  v_dot2_f32_bf16 v176, v128, s50, v8
  v_dot2_f32_bf16 v177, v128, s51, v8
  v_pk_mul_f32 v[180:181], v[160:161], v[160:161]
  v_pk_mul_f32 v[182:183], v[162:163], v[162:163]
  v_pk_fma_f32 v[180:181], v[164:165], v[164:165], v[180:181]
  v_pk_fma_f32 v[182:183], v[166:167], v[166:167], v[182:183]
  v_pk_fma_f32 v[180:181], v[168:169], v[168:169], v[180:181]
  v_pk_fma_f32 v[182:183], v[170:171], v[170:171], v[182:183]
  v_pk_fma_f32 v[180:181], v[172:173], v[172:173], v[180:181]
  v_pk_fma_f32 v[182:183], v[174:175], v[174:175], v[182:183]
  v_pk_fma_f32 v[180:181], v[176:177], v[176:177], v[180:181]
  v_pk_add_f32 v[180:181], v[180:181], v[182:183]
  v_add_f32 v8, v180, v181
  s_nop 1
  v_add_f32_dpp v8, v8, v8 row_ror:8 row_mask:0xf bank_mask:0xf
  s_nop 1
  v_add_f32_dpp v8, v8, v8 row_ror:4 row_mask:0xf bank_mask:0xf
  s_nop 1
  v_add_f32_dpp v8, v8, v8 row_ror:2 row_mask:0xf bank_mask:0xf
  s_nop 1
  v_add_f32_dpp v8, v8, v8 row_ror:1 row_mask:0xf bank_mask:0xf
  v_mov_b32 v9, v8
  s_nop 1
  v_permlane16_swap_b32 v8, v9
  v_add_f32 v8, v8, v9
  v_fmamk_f32 v8, v8, 0x3ae38e39, v12
  v_rsq_f32 v8, v8
  s_nop 0
  v_pk_mul_f32 v[160:161], v[160:161], v[8:9] op_sel_hi:[1,0]
  v_pk_mul_f32 v[162:163], v[162:163], v[8:9] op_sel_hi:[1,0]
  v_pk_mul_f32 v[164:165], v[164:165], v[8:9] op_sel_hi:[1,0]
  v_pk_mul_f32 v[166:167], v[166:167], v[8:9] op_sel_hi:[1,0]
  v_pk_mul_f32 v[168:169], v[168:169], v[8:9] op_sel_hi:[1,0]
  v_pk_mul_f32 v[170:171], v[170:171], v[8:9] op_sel_hi:[1,0]
  v_pk_mul_f32 v[172:173], v[172:173], v[8:9] op_sel_hi:[1,0]
  v_pk_mul_f32 v[174:175], v[174:175], v[8:9] op_sel_hi:[1,0]
  v_pk_mul_f32 v[176:177], v[176:177], v[8:9] op_sel_hi:[1,0]
  v_cvt_pk_bf16_f32 v132, v160, v161
  v_cvt_pk_bf16_f32 v133, v162, v163
  v_cvt_pk_bf16_f32 v134, v164, v165
  v_cvt_pk_bf16_f32 v135, v166, v167
  v_cvt_pk_bf16_f32 v136, v168, v169
  v_cvt_pk_bf16_f32 v137, v170, v171
  v_cvt_pk_bf16_f32 v138, v172, v173
  v_cvt_pk_bf16_f32 v139, v174, v175
  v_cvt_pk_bf16_f32 v140, v176, v177
  ds_write2_b32 v13, v132, v133 offset0:0 offset1:32
  ds_write2_b32 v13, v134, v135 offset0:64 offset1:96
  ds_write2_b32 v13, v136, v137 offset0:128 offset1:160
  ds_write2_b32 v13, v138, v139 offset0:192 offset1:224
  ds_write_b32 v13, v140 offset:1024
  ds_read_b128 v[148:151], v14 offset:0
  ds_read_b128 v[152:155], v14 offset:384
  ds_read_b128 v[156:159], v14 offset:768
  s_waitcnt lgkmcnt(2)
  buffer_store_dwordx4 v[148:151], v1, s[4:7], s45 offen offset:0 sc1
  s_waitcnt lgkmcnt(1)
  buffer_store_dwordx4 v[152:155], v1, s[4:7], s45 offen offset:384 sc1
  s_waitcnt lgkmcnt(0)
  buffer_store_dwordx4 v[156:159], v1, s[4:7], s45 offen offset:768 sc1
  s_waitcnt vmcnt(0)
  s_add_u32 s98, s35, 1
  v_mov_b32 v6, s98
  s_mov_b64 exec, 255
  buffer_store_dword v6, v191, s[4:7], s46 offen sc1
  s_mov_b64 exec, -1
  s_mov_b32 s35, s36
  s_branch L_red2_sum2
L_red_g3:
  s_mov_b32 s35, 0
  s_mov_b32 s47, 146436
L_red3_poll:
  s_add_u32 s56, s58, s47
  s_addc_u32 s57, s59, 0
  s_load_dword s64, s[56:57], 0 glc
  s_load_dword s65, s[56:57], 512 glc
  s_load_dword s66, s[56:57], 1024 glc
  s_load_dword s67, s[56:57], 1536 glc
  s_load_dword s68, s[56:57], 2048 glc
  s_load_dword s69, s[56:57], 2560 glc
  s_load_dword s70, s[56:57], 3072 glc
  s_load_dword s71, s[56:57], 3584 glc
  s_load_dword s72, s[56:57], 4096 glc
  s_load_dword s73, s[56:57], 4608 glc
  s_load_dword s74, s[56:57], 5120 glc
  s_load_dword s75, s[56:57], 5632 glc
  s_waitcnt lgkmcnt(0)
  s_min_u32 s64, s64, s65
  s_min_u32 s64, s64, s66
  s_min_u32 s64, s64, s67
  s_min_u32 s64, s64, s68
  s_min_u32 s64, s64, s69
  s_min_u32 s64, s64, s70
  s_min_u32 s64, s64, s71
  s_min_u32 s64, s64, s72
  s_min_u32 s64, s64, s73
  s_min_u32 s64, s64, s74
  s_min_u32 s64, s64, s75
  s_cmp_ge_u32 s35, s64
  s_cselect_b64 vcc, -1, 0
  s_cbranch_vccz L_red3_go
  s_add_u32 s60, s60, 1
  s_cmp_gt_u32 s60, 262144
  s_cbranch_scc1 L_fail_red
  s_branch L_red3_poll
L_red3_go:
  s_add_u32 s47, s47, 6144
  s_cmp_ge_u32 s47, 164868
  s_cselect_b32 s47, 146436, s47
  s_mul_i32 s43, s35, 36864
  s_mul_i32 s42, s35, 147456
  s_add_u32 s42, s42, 190529536
  s_add_u32 s43, s43, 12402688
  buffer_load_dwordx4 v[16:19], v2, s[4:7], s43 offen offset:0 sc1
  buffer_load_dwordx4 v[20:23], v2, s[4:7], s43 offen offset:1024 sc1
  buffer_load_dword v24, v11, s[4:7], s43 offen sc1
  buffer_load_dwordx4 v[28:31], v3, s[4:7], s42 offen offset:0 sc1
  buffer_load_dwordx4 v[32:35], v3, s[4:7], s42 offen offset:256 sc1
  buffer_load_dwordx4 v[36:39], v3, s[4:7], s42 offen offset:512 sc1
  buffer_load_dwordx4 v[40:43], v3, s[4:7], s42 offen offset:768 sc1
  buffer_load_dwordx4 v[44:47], v3, s[4:7], s42 offen offset:1024 sc1
  buffer_load_dwordx4 v[48:51], v3, s[4:7], s42 offen offset:1280 sc1
  buffer_load_dwordx4 v[52:55], v3, s[4:7], s42 offen offset:1536 sc1
  buffer_load_dwordx4 v[56:59], v3, s[4:7], s42 offen offset:1792 sc1
  buffer_load_dwordx4 v[60:63], v3, s[4:7], s42 offen offset:2048 sc1
  s_add_u32 s56, s58, s47
  s_addc_u32 s57, s59, 0
  s_load_dword s64, s[56:57], 0 glc
  s_load_dword s65, s[56:57], 512 glc
  s_load_dword s66, s[56:57], 1024 glc
  s_load_dword s67, s[56:57], 1536 glc
  s_load_dword s68, s[56:57], 2048 glc
  s_load_dword s69, s[56:57], 2560 glc
  s_load_dword s70, s[56:57], 3072 glc
  s_load_dword s71, s[56:57], 3584 glc
  s_load_dword s72, s[56:57], 4096 glc
  s_load_dword s73, s[56:57], 4608 glc
  s_load_dword s74, s[56:57], 5120 glc
  s_load_dword s75, s[56:57], 5632 glc
L_red3_sum:
  s_waitcnt vmcnt(9)
  v_dot2_f32_bf16 v64, v16, s50, v100
  v_dot2_f32_bf16 v65, v16, s51, v101
  v_dot2_f32_bf16 v68, v17, s50, v102
  v_dot2_f32_bf16 v69, v17, s51, v103
  v_dot2_f32_bf16 v72, v18, s50, v104
  v_dot2_f32_bf16 v73, v18, s51, v105
  v_dot2_f32_bf16 v76, v19, s50, v106
  v_dot2_f32_bf16 v77, v19, s51, v107
  v_dot2_f32_bf16 v80, v20, s50, v108
  v_dot2_f32_bf16 v81, v20, s51, v109
  v_dot2_f32_bf16 v84, v21, s50, v110
  v_dot2_f32_bf16 v85, v21, s51, v111
  v_dot2_f32_bf16 v88, v22, s50, v112
  v_dot2_f32_bf16 v89, v22, s51, v113
  v_dot2_f32_bf16 v92, v23, s50, v114
  v_dot2_f32_bf16 v93, v23, s51, v115
  v_dot2_f32_bf16 v96, v24, s50, v116
  v_dot2_f32_bf16 v97, v24, s51, v117
  s_waitcnt vmcnt(8)
  v_mfma_f32_16x16x32_bf16 v[64:67], v[144:147], v[28:31], v[64:67]
  s_waitcnt vmcnt(7)
  v_mfma_f32_16x16x32_bf16 v[68:71], v[144:147], v[32:35], v[68:71]
  s_waitcnt vmcnt(6)
  v_mfma_f32_16x16x32_bf16 v[72:75], v[144:147], v[36:39], v[72:75]
  s_waitcnt vmcnt(5)
  v_mfma_f32_16x16x32_bf16 v[76:79], v[144:147], v[40:43], v[76:79]
  s_waitcnt vmcnt(4)
  v_mfma_f32_16x16x32_bf16 v[80:83], v[144:147], v[44:47], v[80:83]
  s_waitcnt vmcnt(3)
  v_mfma_f32_16x16x32_bf16 v[84:87], v[144:147], v[48:51], v[84:87]
  s_waitcnt vmcnt(2)
  v_mfma_f32_16x16x32_bf16 v[88:91], v[144:147], v[52:55], v[88:91]
  s_waitcnt vmcnt(1)
  v_mfma_f32_16x16x32_bf16 v[92:95], v[144:147], v[56:59], v[92:95]
  s_waitcnt vmcnt(0)
  v_mfma_f32_16x16x32_bf16 v[96:99], v[144:147], v[60:63], v[96:99]
  v_cvt_pk_bf16_f32 v120, v64, v65
  v_cvt_pk_bf16_f32 v121, v68, v69
  v_cvt_pk_bf16_f32 v122, v72, v73
  v_cvt_pk_bf16_f32 v123, v76, v77
  v_cvt_pk_bf16_f32 v124, v80, v81
  v_cvt_pk_bf16_f32 v125, v84, v85
  v_cvt_pk_bf16_f32 v126, v88, v89
  v_cvt_pk_bf16_f32 v127, v92, v93
  v_cvt_pk_bf16_f32 v128, v96, v97
  s_add_u32 s36, s35, 1
  s_waitcnt vmcnt(0)
  s_waitcnt lgkmcnt(0)
  s_min_u32 s64, s64, s65
  s_min_u32 s64, s64, s66
  s_min_u32 s64, s64, s67
  s_min_u32 s64, s64, s68
  s_min_u32 s64, s64, s69
  s_min_u32 s64, s64, s70
  s_min_u32 s64, s64, s71
  s_min_u32 s64, s64, s72
  s_min_u32 s64, s64, s73
  s_min_u32 s64, s64, s74
  s_min_u32 s64, s64, s75
  s_cmp_ge_u32 s36, s64
  s_cselect_b64 vcc, -1, 0
  s_cbranch_vccnz L_red3_fin
  s_add_u32 s47, s47, 6144
  s_cmp_ge_u32 s47, 164868
  s_cselect_b32 s47, 146436, s47
  s_mul_i32 s43, s36, 36864
  s_mul_i32 s42, s36, 147456
  s_add_u32 s42, s42, 190529536
  s_add_u32 s43, s43, 12402688
  buffer_load_dwordx4 v[16:19], v2, s[4:7], s43 offen offset:0 sc1
  buffer_load_dwordx4 v[20:23], v2, s[4:7], s43 offen offset:1024 sc1
  buffer_load_dword v24, v11, s[4:7], s43 offen sc1
  buffer_load_dwordx4 v[28:31], v3, s[4:7], s42 offen offset:0 sc1
  buffer_load_dwordx4 v[32:35], v3, s[4:7], s42 offen offset:256 sc1
  buffer_load_dwordx4 v[36:39], v3, s[4:7], s42 offen offset:512 sc1
  buffer_load_dwordx4 v[40:43], v3, s[4:7], s42 offen offset:768 sc1
  buffer_load_dwordx4 v[44:47], v3, s[4:7], s42 offen offset:1024 sc1
  buffer_load_dwordx4 v[48:51], v3, s[4:7], s42 offen offset:1280 sc1
  buffer_load_dwordx4 v[52:55], v3, s[4:7], s42 offen offset:1536 sc1
  buffer_load_dwordx4 v[56:59], v3, s[4:7], s42 offen offset:1792 sc1
  buffer_load_dwordx4 v[60:63], v3, s[4:7], s42 offen offset:2048 sc1
  s_add_u32 s56, s58, s47
  s_addc_u32 s57, s59, 0
  s_load_dword s64, s[56:57], 0 glc
  s_load_dword s65, s[56:57], 512 glc
  s_load_dword s66, s[56:57], 1024 glc
  s_load_dword s67, s[56:57], 1536 glc
  s_load_dword s68, s[56:57], 2048 glc
  s_load_dword s69, s[56:57], 2560 glc
  s_load_dword s70, s[56:57], 3072 glc
  s_load_dword s71, s[56:57], 3584 glc
  s_load_dword s72, s[56:57], 4096 glc
  s_load_dword s73, s[56:57], 4608 glc
  s_load_dword s74, s[56:57], 5120 glc
  s_load_dword s75, s[56:57], 5632 glc
  s_mul_i32 s40, s35, 36864
  ds_write2_b32 v13, v120, v121 offset0:0 offset1:32
  ds_write2_b32 v13, v122, v123 offset0:64 offset1:96
  ds_write2_b32 v13, v124, v125 offset0:128 offset1:160
  ds_write2_b32 v13, v126, v127 offset0:192 offset1:224
  ds_write_b32 v13, v128 offset:1024
  ds_read_b128 v[148:151], v14 offset:0
  ds_read_b128 v[152:155], v14 offset:384
  ds_read_b128 v[156:159], v14 offset:768
  s_waitcnt lgkmcnt(2)
  buffer_store_dwordx4 v[148:151], v1, s[12:15], s40 offen offset:0 sc1
  s_waitcnt lgkmcnt(1)
  buffer_store_dwordx4 v[152:155], v1, s[12:15], s40 offen offset:384 sc1
  s_waitcnt lgkmcnt(0)
  buffer_store_dwordx4 v[156:159], v1, s[12:15], s40 offen offset:768 sc1
  s_waitcnt vmcnt(0)
  s_mov_b32 s35, s36
  s_branch L_red3_sum2
L_red3_fin:
  s_mul_i32 s40, s35, 36864
  ds_write2_b32 v13, v120, v121 offset0:0 offset1:32
  ds_write2_b32 v13, v122, v123 offset0:64 offset1:96
  ds_write2_b32 v13, v124, v125 offset0:128 offset1:160
  ds_write2_b32 v13, v126, v127 offset0:192 offset1:224
  ds_write_b32 v13, v128 offset:1024
  ds_read_b128 v[148:151], v14 offset:0
  ds_read_b128 v[152:155], v14 offset:384
  ds_read_b128 v[156:159], v14 offset:768
  s_waitcnt lgkmcnt(2)
  buffer_store_dwordx4 v[148:151], v1, s[12:15], s40 offen offset:0 sc1
  s_waitcnt lgkmcnt(1)
  buffer_store_dwordx4 v[152:155], v1, s[12:15], s40 offen offset:384 sc1
  s_waitcnt lgkmcnt(0)
  buffer_store_dwordx4 v[156:159], v1, s[12:15], s40 offen offset:768 sc1
  s_add_u32 s56, s58, s47
  s_addc_u32 s57, s59, 0
  s_load_dword s64, s[56:57], 0 glc
  s_load_dword s65, s[56:57], 512 glc
  s_load_dword s66, s[56:57], 1024 glc
  s_load_dword s67, s[56:57], 1536 glc
  s_load_dword s68, s[56:57], 2048 glc
  s_load_dword s69, s[56:57], 2560 glc
  s_load_dword s70, s[56:57], 3072 glc
  s_load_dword s71, s[56:57], 3584 glc
  s_load_dword s72, s[56:57], 4096 glc
  s_load_dword s73, s[56:57], 4608 glc
  s_load_dword s74, s[56:57], 5120 glc
  s_load_dword s75, s[56:57], 5632 glc
  s_waitcnt vmcnt(0)
  s_add_u32 s35, s35, 1
  s_cmp_ge_u32 s35, 64
  s_cbranch_scc1 L_red3_end
  s_waitcnt lgkmcnt(0)
  s_min_u32 s64, s64, s65
  s_min_u32 s64, s64, s66
  s_min_u32 s64, s64, s67
  s_min_u32 s64, s64, s68
  s_min_u32 s64, s64, s69
  s_min_u32 s64, s64, s70
  s_min_u32 s64, s64, s71
  s_min_u32 s64, s64, s72
  s_min_u32 s64, s64, s73
  s_min_u32 s64, s64, s74
  s_min_u32 s64, s64, s75
  s_cmp_ge_u32 s35, s64
  s_cselect_b64 vcc, -1, 0
  s_cbranch_vccz L_red3_go
  s_branch L_red3_poll
L_red3_end:
  s_endpgm
L_red3_sum2:
  s_waitcnt vmcnt(29)
  v_dot2_f32_bf16 v64, v16, s50, v100
  v_dot2_f32_bf16 v65, v16, s51, v101
  v_dot2_f32_bf16 v68, v17, s50, v102
  v_dot2_f32_bf16 v69, v17, s51, v103
  v_dot2_f32_bf16 v72, v18, s50, v104
  v_dot2_f32_bf16 v73, v18, s51, v105
  v_dot2_f32_bf16 v76, v19, s50, v106
  v_dot2_f32_bf16 v77, v19, s51, v107
  v_dot2_f32_bf16 v80, v20, s50, v108
  v_dot2_f32_bf16 v81, v20, s51, v109
  v_dot2_f32_bf16 v84, v21, s50, v110
  v_dot2_f32_bf16 v85, v21, s51, v111
  v_dot2_f32_bf16 v88, v22, s50, v112
  v_dot2_f32_bf16 v89, v22, s51, v113
  v_dot2_f32_bf16 v92, v23, s50, v114
  v_dot2_f32_bf16 v93, v23, s51, v115
  v_dot2_f32_bf16 v96, v24, s50, v116
  v_dot2_f32_bf16 v97, v24, s51, v117
  s_waitcnt vmcnt(28)
  v_mfma_f32_16x16x32_bf16 v[64:67], v[144:147], v[28:31], v[64:67]
  s_waitcnt vmcnt(27)
  v_mfma_f32_16x16x32_bf16 v[68:71], v[144:147], v[32:35], v[68:71]
  s_waitcnt vmcnt(26)
  v_mfma_f32_16x16x32_bf16 v[72:75], v[144:147], v[36:39], v[72:75]
  s_waitcnt vmcnt(25)
  v_mfma_f32_16x16x32_bf16 v[76:79], v[144:147], v[40:43], v[76:79]
  s_waitcnt vmcnt(24)
  v_mfma_f32_16x16x32_bf16 v[80:83], v[144:147], v[44:47], v[80:83]
  s_waitcnt vmcnt(23)
  v_mfma_f32_16x16x32_bf16 v[84:87], v[144:147], v[48:51], v[84:87]
  s_waitcnt vmcnt(22)
  v_mfma_f32_16x16x32_bf16 v[88:91], v[144:147], v[52:55], v[88:91]
  s_waitcnt vmcnt(21)
  v_mfma_f32_16x16x32_bf16 v[92:95], v[144:147], v[56:59], v[92:95]
  s_waitcnt vmcnt(20)
  v_mfma_f32_16x16x32_bf16 v[96:99], v[144:147], v[60:63], v[96:99]
  v_cvt_pk_bf16_f32 v120, v64, v65
  v_cvt_pk_bf16_f32 v121, v68, v69
  v_cvt_pk_bf16_f32 v122, v72, v73
  v_cvt_pk_bf16_f32 v123, v76, v77
  v_cvt_pk_bf16_f32 v124, v80, v81
  v_cvt_pk_bf16_f32 v125, v84, v85
  v_cvt_pk_bf16_f32 v126, v88, v89
  v_cvt_pk_bf16_f32 v127, v92, v93
  v_cvt_pk_bf16_f32 v128, v96, v97
  s_add_u32 s36, s35, 1
  s_waitcnt lgkmcnt(0)
  s_min_u32 s64, s64, s65
  s_min_u32 s64, s64, s66
  s_min_u32 s64, s64, s67
  s_min_u32 s64, s64, s68
  s_min_u32 s64, s64, s69
  s_min_u32 s64, s64, s70
  s_min_u32 s64, s64, s71
  s_min_u32 s64, s64, s72
  s_min_u32 s64, s64, s73
  s_min_u32 s64, s64, s74
  s_min_u32 s64, s64, s75
  s_cmp_ge_u32 s36, s64
  s_cselect_b64 vcc, -1, 0
  s_cbranch_vccnz L_red3_fin
  s_add_u32 s47, s47, 6144
  s_cmp_ge_u32 s47, 164868
  s_cselect_b32 s47, 146436, s47
  s_mul_i32 s43, s36, 36864
  s_mul_i32 s42, s36, 147456
  s_add_u32 s42, s42, 190529536
  s_add_u32 s43, s43, 12402688
  buffer_load_dwordx4 v[16:19], v2, s[4:7], s43 offen offset:0 sc1
  buffer_load_dwordx4 v[20:23], v2, s[4:7], s43 offen offset:1024 sc1
  buffer_load_dword v24, v11, s[4:7], s43 offen sc1
  buffer_load_dwordx4 v[28:31], v3, s[4:7], s42 offen offset:0 sc1
  buffer_load_dwordx4 v[32:35], v3, s[4:7], s42 offen offset:256 sc1
  buffer_load_dwordx4 v[36:39], v3, s[4:7], s42 offen offset:512 sc1
  buffer_load_dwordx4 v[40:43], v3, s[4:7], s42 offen offset:768 sc1
  buffer_load_dwordx4 v[44:47], v3, s[4:7], s42 offen offset:1024 sc1
  buffer_load_dwordx4 v[48:51], v3, s[4:7], s42 offen offset:1280 sc1
  buffer_load_dwordx4 v[52:55], v3, s[4:7], s42 offen offset:1536 sc1
  buffer_load_dwordx4 v[56:59], v3, s[4:7], s42 offen offset:1792 sc1
  buffer_load_dwordx4 v[60:63], v3, s[4:7], s42 offen offset:2048 sc1
  s_add_u32 s56, s58, s47
  s_addc_u32 s57, s59, 0
  s_load_dword s64, s[56:57], 0 glc
  s_load_dword s65, s[56:57], 512 glc
  s_load_dword s66, s[56:57], 1024 glc
  s_load_dword s67, s[56:57], 1536 glc
  s_load_dword s68, s[56:57], 2048 glc
  s_load_dword s69, s[56:57], 2560 glc
  s_load_dword s70, s[56:57], 3072 glc
  s_load_dword s71, s[56:57], 3584 glc
  s_load_dword s72, s[56:57], 4096 glc
  s_load_dword s73, s[56:57], 4608 glc
  s_load_dword s74, s[56:57], 5120 glc
  s_load_dword s75, s[56:57], 5632 glc
  s_mul_i32 s40, s35, 36864
  ds_write2_b32 v13, v120, v121 offset0:0 offset1:32
  ds_write2_b32 v13, v122, v123 offset0:64 offset1:96
  ds_write2_b32 v13, v124, v125 offset0:128 offset1:160
  ds_write2_b32 v13, v126, v127 offset0:192 offset1:224
  ds_write_b32 v13, v128 offset:1024
  ds_read_b128 v[148:151], v14 offset:0
  ds_read_b128 v[152:155], v14 offset:384
  ds_read_b128 v[156:159], v14 offset:768
  s_waitcnt lgkmcnt(2)
  buffer_store_dwordx4 v[148:151], v1, s[12:15], s40 offen offset:0 sc1
  s_waitcnt lgkmcnt(1)
  buffer_store_dwordx4 v[152:155], v1, s[12:15], s40 offen offset:384 sc1
  s_waitcnt lgkmcnt(0)
  buffer_store_dwordx4 v[156:159], v1, s[12:15], s40 offen offset:768 sc1
  s_waitcnt vmcnt(0)
  s_mov_b32 s35, s36
  s_branch L_red3_sum2
L_fail_red:
  s_mov_b64 exec, 1
  v_mov_b32 v0, 68
  v_mov_b32 v1, 1
  buffer_atomic_add v1, v0, s[20:23], 0 offen
  s_endpgm
L_att:
  v_lshlrev_b32 v1, 4, v0
  v_and_b32 v8, 3, v0
  v_lshlrev_b32 v2, 7, v8
  v_mov_b32 v5, 0
  v_lshrrev_b32 v9, 5, v0
  v_and_b32 v10, 7, v0
  v_lshlrev_b32 v3, 4, v10
  v_lshl_add_u32 v3, v9, 7, v3
  v_bfe_u32 v10, v0, 3, 2
  v_lshl_add_u32 v3, v10, 8, v3
  v_and_b32 v10, 31, v0
  v_and_b32 v4, 15, v0
  v_lshlrev_b32 v4, 2, v4
  v_bfe_u32 v8, v0, 4, 1
  v_lshl_add_u32 v4, v8, 8, v4
  v_lshl_add_u32 v4, v9, 7, v4
  v_lshlrev_b32 v7, 2, v9
  v_sub_u32 v7, v10, v7
  s_mov_b64 s[56:57], s[92:93]
  s_mov_b64 s[58:59], s[92:93]
  v_cmp_le_i32 s[64:65], 0, v7
  v_cmp_le_i32 s[66:67], 1, v7
  v_cmp_le_i32 s[68:69], 2, v7
  v_cmp_le_i32 s[70:71], 3, v7
  v_cmp_le_i32 s[72:73], 8, v7
  v_cmp_le_i32 s[74:75], 9, v7
  v_cmp_le_i32 s[76:77], 10, v7
  v_cmp_le_i32 s[78:79], 11, v7
  v_cmp_le_i32 s[80:81], 16, v7
  v_cmp_le_i32 s[82:83], 17, v7
  v_cmp_le_i32 s[84:85], 18, v7
  v_cmp_le_i32 s[86:87], 19, v7
  v_cmp_le_i32 s[88:89], 24, v7
  v_cmp_le_i32 s[90:91], 25, v7
  v_cmp_le_i32 s[92:93], 26, v7
  v_cmp_le_i32 s[94:95], 27, v7
  v_mov_b32 v154, 0
  v_mov_b32 v155, 0
  v_mov_b32 v158, 0
  v_mov_b32 v159, 0
  v_mov_b32 v162, 0
  v_mov_b32 v163, 0
  v_mov_b32 v166, 0
  v_mov_b32 v167, 0
  v_mov_b32 v194, 0
  v_mov_b32 v195, 0
  s_mov_b32 s50, 0x3e0293ee
  v_mov_b32 v7, 0xf149f2ca
  v_mov_b32 v8, 128
Lwi_30:
  buffer_load_dword v9, v8, s[20:23], 0 offen sc1
  s_waitcnt vmcnt(0)
  v_cmp_gt_u32 vcc, 0x100, v9
  s_cbranch_vccz Lwiok_31
  s_add_u32 s60, s60, 1
  s_cmp_gt_u32 s60, 262144
  s_cbranch_scc1 L_fail_att
  s_sleep 4
  s_branch Lwi_30
Lwiok_31:
  s_lshl_b32 s35, s24, 6
  s_mov_b32 s31, s35
  s_lshl_b32 s40, s24, 5
  s_add_u32 s40, s40, s29
  s_lshl_b32 s40, s40, 7
  s_add_u32 s41, s40, 32768
  s_add_u32 s42, s40, 40960
  s_lshl_b32 s43, s29, 9
  s_lshl_b32 s44, s24, 2
  s_add_u32 s43, s43, s44
  s_add_u32 s43, s43, 0
  s_mov_b32 s48, 0
  s_mov_b32 s49, -1
  s_add_u32 s56, s56, s41
  s_addc_u32 s57, s57, 0
  s_add_u32 s58, s58, s43
  s_addc_u32 s59, s59, 0
  s_mov_b32 s45, 0
  s_mov_b32 s34, -1
Lwf_32:
  s_mov_b64 exec, 15
  buffer_load_dword v8, v2, s[4:7], s43 offen sc1
  s_waitcnt vmcnt(0)
  v_cmp_ge_u32 vcc, 0, v8
  s_mov_b64 exec, -1
  s_cbranch_vccz Lwfok_33
  s_add_u32 s60, s60, 1
  s_cmp_gt_u32 s60, 262144
  s_cbranch_scc1 L_fail_att
  s_sleep 1
  s_branch Lwf_32
Lwfok_33:
  s_mul_i32 s37, s29, 129
  s_add_u32 s37, s37, s35
  s_sub_u32 s37, s37, s31
  s_mul_i32 s37, s37, 24576
  s_add_u32 s37, s37, 19480576
  buffer_load_dwordx4 a[0:3], v1, s[4:7], s37 offen offset:0 sc1
  buffer_load_dwordx4 a[4:7], v1, s[4:7], s37 offen offset:1024 sc1
  buffer_load_dwordx4 a[8:11], v1, s[4:7], s37 offen offset:2048 sc1
  buffer_load_dwordx4 a[12:15], v1, s[4:7], s37 offen offset:3072 sc1
  s_add_u32 s37, s37, 4096
  buffer_load_dwordx4 a[16:19], v1, s[4:7], s37 offen offset:0 sc1
  buffer_load_dwordx4 a[20:23], v1, s[4:7], s37 offen offset:1024 sc1
  buffer_load_dwordx4 a[24:27], v1, s[4:7], s37 offen offset:2048 sc1
  buffer_load_dwordx4 a[28:31], v1, s[4:7], s37 offen offset:3072 sc1
  s_add_u32 s37, s37, 4096
  buffer_load_dwordx4 a[32:35], v1, s[4:7], s37 offen offset:0 sc1
  buffer_load_dwordx4 a[36:39], v1, s[4:7], s37 offen offset:1024 sc1
  buffer_load_dwordx4 a[40:43], v1, s[4:7], s37 offen offset:2048 sc1
  buffer_load_dwordx4 a[44:47], v1, s[4:7], s37 offen offset:3072 sc1
  s_add_u32 s37, s37, 4096
  buffer_load_dwordx4 a[48:51], v1, s[4:7], s37 offen offset:0 sc1
  buffer_load_dwordx4 a[52:55], v1, s[4:7], s37 offen offset:1024 sc1
  buffer_load_dwordx4 a[56:59], v1, s[4:7], s37 offen offset:2048 sc1
  buffer_load_dwordx4 a[60:63], v1, s[4:7], s37 offen offset:3072 sc1
  s_add_u32 s37, s37, 4096
  buffer_load_dwordx4 a[64:67], v1, s[4:7], s37 offen offset:0 sc1
  buffer_load_dwordx4 a[68:71], v1, s[4:7], s37 offen offset:1024 sc1
  buffer_load_dwordx4 a[72:75], v1, s[4:7], s37 offen offset:2048 sc1
  buffer_load_dwordx4 a[76:79], v1, s[4:7], s37 offen offset:3072 sc1
  s_add_u32 s37, s37, 4096
  buffer_load_dwordx4 a[80:83], v1, s[4:7], s37 offen offset:0 sc1
  buffer_load_dwordx4 a[84:87], v1, s[4:7], s37 offen offset:1024 sc1
  buffer_load_dwordx4 a[88:91], v1, s[4:7], s37 offen offset:2048 sc1
  buffer_load_dwordx4 a[92:95], v1, s[4:7], s37 offen offset:3072 sc1
  s_load_dword s52, s[56:57], 0 glc
  s_load_dword s53, s[58:59], 16384 glc
  s_load_dword s54, s[58:59], 16512 glc
  s_load_dword s55, s[58:59], 16640 glc
  s_load_dword s61, s[58:59], 16768 glc
  s_waitcnt vmcnt(0)
L_att_loop:
  s_mul_i32 s39, s29, 129
  s_add_u32 s39, s39, s35
  s_sub_u32 s39, s39, s31
  s_lshl_b32 s36, s39, 12
  s_add_u32 s36, s36, 120930304
  s_add_u32 s38, s35, 1
  s_mul_i32 s37, s29, 129
  s_add_u32 s37, s37, s38
  s_sub_u32 s37, s37, s31
  s_mul_i32 s37, s37, 24576
  s_add_u32 s37, s37, 19480576
  s_waitcnt lgkmcnt(0)
  s_min_u32 s53, s53, s54
  s_min_u32 s55, s55, s61
  s_min_u32 s53, s53, s55
  s_add_u32 s46, s45, 1
  s_cmp_gt_u32 s53, s46
  s_cselect_b32 s37, s37, 0x40000000
  s_cselect_b32 s47, 0, 1
  s_cmp_gt_u32 s52, s45
  s_cbranch_scc1 L_att0_kmq
  v_mfma_f32_32x32x16_bf16 v[168:183], a[32:35], a[0:3], 0
  buffer_load_dwordx4 a[96:99], v1, s[4:7], s37 offen offset:0 sc1
  v_mfma_f32_32x32x16_bf16 v[168:183], a[36:39], a[4:7], v[168:183]
  buffer_load_dwordx4 a[100:103], v1, s[4:7], s37 offen offset:1024 sc1
  v_mfma_f32_32x32x16_bf16 v[168:183], a[40:43], a[8:11], v[168:183]
  buffer_load_dwordx4 a[104:107], v1, s[4:7], s37 offen offset:2048 sc1
  v_mfma_f32_32x32x16_bf16 v[168:183], a[44:47], a[12:15], v[168:183]
  buffer_load_dwordx4 a[108:111], v1, s[4:7], s37 offen offset:3072 sc1
  v_mfma_f32_32x32x16_bf16 v[168:183], a[48:51], a[16:19], v[168:183]
  s_add_u32 s37, s37, 4096
  buffer_load_dwordx4 a[112:115], v1, s[4:7], s37 offen offset:0 sc1
  v_mfma_f32_32x32x16_bf16 v[168:183], a[52:55], a[20:23], v[168:183]
  buffer_load_dwordx4 a[116:119], v1, s[4:7], s37 offen offset:1024 sc1
  v_mfma_f32_32x32x16_bf16 v[168:183], a[56:59], a[24:27], v[168:183]
  buffer_load_dwordx4 a[120:123], v1, s[4:7], s37 offen offset:2048 sc1
  v_mfma_f32_32x32x16_bf16 v[168:183], a[60:63], a[28:31], v[168:183]
  buffer_load_dwordx4 a[124:127], v1, s[4:7], s37 offen offset:3072 sc1
  s_add_u32 s37, s37, 4096
  buffer_load_dwordx4 a[128:131], v1, s[4:7], s37 offen offset:0 sc1
  buffer_load_dwordx4 a[132:135], v1, s[4:7], s37 offen offset:1024 sc1
  s_nop 7
  v_cndmask_b32 v168, v7, v168, s[64:65]
  v_cndmask_b32 v169, v7, v169, s[66:67]
  v_cndmask_b32 v170, v7, v170, s[68:69]
  v_cndmask_b32 v171, v7, v171, s[70:71]
  v_cndmask_b32 v172, v7, v172, s[72:73]
  v_cndmask_b32 v173, v7, v173, s[74:75]
  v_cndmask_b32 v174, v7, v174, s[76:77]
  v_cndmask_b32 v175, v7, v175, s[78:79]
  v_cndmask_b32 v176, v7, v176, s[80:81]
  v_cndmask_b32 v177, v7, v177, s[82:83]
  v_cndmask_b32 v178, v7, v178, s[84:85]
  v_cndmask_b32 v179, v7, v179, s[86:87]
  v_cndmask_b32 v180, v7, v180, s[88:89]
  v_cndmask_b32 v181, v7, v181, s[90:91]
  v_cndmask_b32 v182, v7, v182, s[92:93]
  v_cndmask_b32 v183, v7, v183, s[94:95]
  v_max3_f32 v9, v168, v169, v170
  v_max3_f32 v9, v9, v171, v172
  v_max3_f32 v9, v9, v173, v174
  v_max3_f32 v9, v9, v175, v176
  v_max3_f32 v9, v9, v177, v178
  v_max3_f32 v9, v9, v179, v180
  v_max3_f32 v9, v9, v181, v182
  v_max_f32 v9, v9, v183
  v_mov_b32 v10, v9
  buffer_load_dwordx4 a[136:139], v1, s[4:7], s37 offen offset:2048 sc1
  buffer_load_dwordx4 a[140:143], v1, s[4:7], s37 offen offset:3072 sc1
  v_permlane32_swap_b32 v9, v10
  v_max_f32 v9, v9, v10
  v_mul_f32 v9, s50, v9
  v_fma_f32 v168, v168, s50, -v9
  v_fma_f32 v169, v169, s50, -v9
  v_fma_f32 v170, v170, s50, -v9
  v_fma_f32 v171, v171, s50, -v9
  v_fma_f32 v172, v172, s50, -v9
  v_fma_f32 v173, v173, s50, -v9
  v_fma_f32 v174, v174, s50, -v9
  v_fma_f32 v175, v175, s50, -v9
  v_fma_f32 v176, v176, s50, -v9
  v_fma_f32 v177, v177, s50, -v9
  v_fma_f32 v178, v178, s50, -v9
  v_fma_f32 v179, v179, s50, -v9
  v_fma_f32 v180, v180, s50, -v9
  v_fma_f32 v181, v181, s50, -v9
  v_fma_f32 v182, v182, s50, -v9
  v_fma_f32 v183, v183, s50, -v9
  s_load_dword s52, s[56:57], 0 glc
  s_waitcnt vmcnt(12)
  v_mov_b32 v6, s45
  s_mov_b64 exec, 1
  buffer_store_dword v6, v5, s[4:7], s42 offen sc1
  s_mov_b64 exec, -1
  v_exp_f32 v168, v168
  v_exp_f32 v169, v169
  v_exp_f32 v170, v170
  v_exp_f32 v171, v171
  s_add_u32 s37, s37, 4096
  buffer_load_dwordx4 a[144:147], v1, s[4:7], s37 offen offset:0 sc1
  v_exp_f32 v172, v172
  v_exp_f32 v173, v173
  v_exp_f32 v174, v174
  v_exp_f32 v175, v175
  buffer_load_dwordx4 a[148:151], v1, s[4:7], s37 offen offset:1024 sc1
  v_exp_f32 v176, v176
  v_exp_f32 v177, v177
  v_exp_f32 v178, v178
  v_exp_f32 v179, v179
  buffer_load_dwordx4 a[152:155], v1, s[4:7], s37 offen offset:2048 sc1
  v_exp_f32 v180, v180
  v_exp_f32 v181, v181
  v_exp_f32 v182, v182
  v_exp_f32 v183, v183
  buffer_load_dwordx4 a[156:159], v1, s[4:7], s37 offen offset:3072 sc1
  v_cvt_pk_bf16_f32 v184, v168, v169
  v_cvt_pk_bf16_f32 v185, v170, v171
  v_cvt_pk_bf16_f32 v186, v172, v173
  v_cvt_pk_bf16_f32 v187, v174, v175
  v_cvt_pk_bf16_f32 v188, v176, v177
  v_cvt_pk_bf16_f32 v189, v178, v179
  v_cvt_pk_bf16_f32 v190, v180, v181
  v_cvt_pk_bf16_f32 v191, v182, v183
  v_mfma_f32_32x32x16_bf16 v[16:31], a[64:67], v[184:187], 0
  s_add_u32 s37, s37, 4096
  buffer_load_dwordx4 a[160:163], v1, s[4:7], s37 offen offset:0 sc1
  v_mov_b32 v11, v168
  v_add_f32 v11, v169, v11
  v_mfma_f32_32x32x16_bf16 v[16:31], a[68:71], v[188:191], v[16:31]
  buffer_load_dwordx4 a[164:167], v1, s[4:7], s37 offen offset:1024 sc1
  v_add_f32 v11, v170, v11
  v_add_f32 v11, v171, v11
  v_mfma_f32_32x32x16_bf16 v[32:47], a[72:75], v[184:187], 0
  buffer_load_dwordx4 a[168:171], v1, s[4:7], s37 offen offset:2048 sc1
  v_add_f32 v11, v172, v11
  v_add_f32 v11, v173, v11
  v_mfma_f32_32x32x16_bf16 v[32:47], a[76:79], v[188:191], v[32:47]
  buffer_load_dwordx4 a[172:175], v1, s[4:7], s37 offen offset:3072 sc1
  v_add_f32 v11, v174, v11
  v_add_f32 v11, v175, v11
  v_mfma_f32_32x32x16_bf16 v[48:63], a[80:83], v[184:187], 0
  s_add_u32 s37, s37, 4096
  buffer_load_dwordx4 a[176:179], v1, s[4:7], s37 offen offset:0 sc1
  v_add_f32 v11, v176, v11
  v_add_f32 v11, v177, v11
  v_mfma_f32_32x32x16_bf16 v[48:63], a[84:87], v[188:191], v[48:63]
  buffer_load_dwordx4 a[180:183], v1, s[4:7], s37 offen offset:1024 sc1
  v_add_f32 v11, v178, v11
  v_add_f32 v11, v179, v11
  v_mfma_f32_32x32x16_bf16 v[64:79], a[88:91], v[184:187], 0
  buffer_load_dwordx4 a[184:187], v1, s[4:7], s37 offen offset:2048 sc1
  v_add_f32 v11, v180, v11
  v_add_f32 v11, v181, v11
  v_mfma_f32_32x32x16_bf16 v[64:79], a[92:95], v[188:191], v[64:79]
  buffer_load_dwordx4 a[188:191], v1, s[4:7], s37 offen offset:3072 sc1
  v_add_f32 v11, v182, v11
  v_add_f32 v11, v183, v11
  s_branch L_att0_chk
L_att0_poll:
  s_load_dword s52, s[56:57], 0 glc
  s_add_u32 s60, s60, 1
  s_cmp_gt_u32 s60, 262144
  s_cbranch_scc1 L_fail_att
L_att0_chk:
  s_waitcnt lgkmcnt(0)
  s_cmp_le_u32 s52, s45
  s_cbranch_scc1 L_att0_poll
  buffer_load_dwordx4 v[144:147], v3, s[4:7], s36 offen offset:0 sc1
  buffer_load_dwordx4 v[148:151], v3, s[4:7], s36 offen offset:1024 sc1
  buffer_load_dword v152, v4, s[4:7], s36 offen offset:2048 sc1
  buffer_load_dword v153, v4, s[4:7], s36 offen offset:2112 sc1
  buffer_load_dword v156, v4, s[4:7], s36 offen offset:2560 sc1
  buffer_load_dword v157, v4, s[4:7], s36 offen offset:2624 sc1
  buffer_load_dword v160, v4, s[4:7], s36 offen offset:3072 sc1
  buffer_load_dword v161, v4, s[4:7], s36 offen offset:3136 sc1
  buffer_load_dword v164, v4, s[4:7], s36 offen offset:3584 sc1
  buffer_load_dword v165, v4, s[4:7], s36 offen offset:3648 sc1
  s_waitcnt vmcnt(0)
  s_branch L_att0_km
L_att0_kmq:
  buffer_load_dwordx4 v[144:147], v3, s[4:7], s36 offen offset:0 sc1
  buffer_load_dwordx4 v[148:151], v3, s[4:7], s36 offen offset:1024 sc1
  buffer_load_dword v152, v4, s[4:7], s36 offen offset:2048 sc1
  buffer_load_dword v153, v4, s[4:7], s36 offen offset:2112 sc1
  buffer_load_dword v156, v4, s[4:7], s36 offen offset:2560 sc1
  buffer_load_dword v157, v4, s[4:7], s36 offen offset:2624 sc1
  buffer_load_dword v160, v4, s[4:7], s36 offen offset:3072 sc1
  buffer_load_dword v161, v4, s[4:7], s36 offen offset:3136 sc1
  buffer_load_dword v164, v4, s[4:7], s36 offen offset:3584 sc1
  buffer_load_dword v165, v4, s[4:7], s36 offen offset:3648 sc1
  v_mfma_f32_32x32x16_bf16 v[168:183], a[32:35], a[0:3], 0
  buffer_load_dwordx4 a[96:99], v1, s[4:7], s37 offen offset:0 sc1
  v_mfma_f32_32x32x16_bf16 v[168:183], a[36:39], a[4:7], v[168:183]
  buffer_load_dwordx4 a[100:103], v1, s[4:7], s37 offen offset:1024 sc1
  v_mfma_f32_32x32x16_bf16 v[168:183], a[40:43], a[8:11], v[168:183]
  buffer_load_dwordx4 a[104:107], v1, s[4:7], s37 offen offset:2048 sc1
  v_mfma_f32_32x32x16_bf16 v[168:183], a[44:47], a[12:15], v[168:183]
  buffer_load_dwordx4 a[108:111], v1, s[4:7], s37 offen offset:3072 sc1
  v_mfma_f32_32x32x16_bf16 v[168:183], a[48:51], a[16:19], v[168:183]
  s_add_u32 s37, s37, 4096
  buffer_load_dwordx4 a[112:115], v1, s[4:7], s37 offen offset:0 sc1
  v_mfma_f32_32x32x16_bf16 v[168:183], a[52:55], a[20:23], v[168:183]
  buffer_load_dwordx4 a[116:119], v1, s[4:7], s37 offen offset:1024 sc1
  v_mfma_f32_32x32x16_bf16 v[168:183], a[56:59], a[24:27], v[168:183]
  buffer_load_dwordx4 a[120:123], v1, s[4:7], s37 offen offset:2048 sc1
  v_mfma_f32_32x32x16_bf16 v[168:183], a[60:63], a[28:31], v[168:183]
  buffer_load_dwordx4 a[124:127], v1, s[4:7], s37 offen offset:3072 sc1
  s_add_u32 s37, s37, 4096
  buffer_load_dwordx4 a[128:131], v1, s[4:7], s37 offen offset:0 sc1
  buffer_load_dwordx4 a[132:135], v1, s[4:7], s37 offen offset:1024 sc1
  s_nop 7
  v_cndmask_b32 v168, v7, v168, s[64:65]
  v_cndmask_b32 v169, v7, v169, s[66:67]
  v_cndmask_b32 v170, v7, v170, s[68:69]
  v_cndmask_b32 v171, v7, v171, s[70:71]
  v_cndmask_b32 v172, v7, v172, s[72:73]
  v_cndmask_b32 v173, v7, v173, s[74:75]
  v_cndmask_b32 v174, v7, v174, s[76:77]
  v_cndmask_b32 v175, v7, v175, s[78:79]
  v_cndmask_b32 v176, v7, v176, s[80:81]
  v_cndmask_b32 v177, v7, v177, s[82:83]
  v_cndmask_b32 v178, v7, v178, s[84:85]
  v_cndmask_b32 v179, v7, v179, s[86:87]
  v_cndmask_b32 v180, v7, v180, s[88:89]
  v_cndmask_b32 v181, v7, v181, s[90:91]
  v_cndmask_b32 v182, v7, v182, s[92:93]
  v_cndmask_b32 v183, v7, v183, s[94:95]
  v_max3_f32 v9, v168, v169, v170
  v_max3_f32 v9, v9, v171, v172
  v_max3_f32 v9, v9, v173, v174
  v_max3_f32 v9, v9, v175, v176
  v_max3_f32 v9, v9, v177, v178
  v_max3_f32 v9, v9, v179, v180
  v_max3_f32 v9, v9, v181, v182
  v_max_f32 v9, v9, v183
  v_mov_b32 v10, v9
  buffer_load_dwordx4 a[136:139], v1, s[4:7], s37 offen offset:2048 sc1
  buffer_load_dwordx4 a[140:143], v1, s[4:7], s37 offen offset:3072 sc1
  v_permlane32_swap_b32 v9, v10
  v_max_f32 v9, v9, v10
  v_mul_f32 v9, s50, v9
  v_fma_f32 v168, v168, s50, -v9
  v_fma_f32 v169, v169, s50, -v9
  v_fma_f32 v170, v170, s50, -v9
  v_fma_f32 v171, v171, s50, -v9
  v_fma_f32 v172, v172, s50, -v9
  v_fma_f32 v173, v173, s50, -v9
  v_fma_f32 v174, v174, s50, -v9
  v_fma_f32 v175, v175, s50, -v9
  v_fma_f32 v176, v176, s50, -v9
  v_fma_f32 v177, v177, s50, -v9
  v_fma_f32 v178, v178, s50, -v9
  v_fma_f32 v179, v179, s50, -v9
  v_fma_f32 v180, v180, s50, -v9
  v_fma_f32 v181, v181, s50, -v9
  v_fma_f32 v182, v182, s50, -v9
  v_fma_f32 v183, v183, s50, -v9
  s_waitcnt vmcnt(22)
  v_mov_b32 v6, s45
  s_mov_b64 exec, 1
  buffer_store_dword v6, v5, s[4:7], s42 offen sc1
  s_mov_b64 exec, -1
  v_exp_f32 v168, v168
  v_exp_f32 v169, v169
  v_exp_f32 v170, v170
  v_exp_f32 v171, v171
  s_add_u32 s37, s37, 4096
  buffer_load_dwordx4 a[144:147], v1, s[4:7], s37 offen offset:0 sc1
  v_exp_f32 v172, v172
  v_exp_f32 v173, v173
  v_exp_f32 v174, v174
  v_exp_f32 v175, v175
  buffer_load_dwordx4 a[148:151], v1, s[4:7], s37 offen offset:1024 sc1
  v_exp_f32 v176, v176
  v_exp_f32 v177, v177
  v_exp_f32 v178, v178
  v_exp_f32 v179, v179
  buffer_load_dwordx4 a[152:155], v1, s[4:7], s37 offen offset:2048 sc1
  v_exp_f32 v180, v180
  v_exp_f32 v181, v181
  v_exp_f32 v182, v182
  v_exp_f32 v183, v183
  buffer_load_dwordx4 a[156:159], v1, s[4:7], s37 offen offset:3072 sc1
  v_cvt_pk_bf16_f32 v184, v168, v169
  v_cvt_pk_bf16_f32 v185, v170, v171
  v_cvt_pk_bf16_f32 v186, v172, v173
  v_cvt_pk_bf16_f32 v187, v174, v175
  v_cvt_pk_bf16_f32 v188, v176, v177
  v_cvt_pk_bf16_f32 v189, v178, v179
  v_cvt_pk_bf16_f32 v190, v180, v181
  v_cvt_pk_bf16_f32 v191, v182, v183
  v_mfma_f32_32x32x16_bf16 v[16:31], a[64:67], v[184:187], 0
  s_add_u32 s37, s37, 4096
  buffer_load_dwordx4 a[160:163], v1, s[4:7], s37 offen offset:0 sc1
  v_mov_b32 v11, v168
  v_add_f32 v11, v169, v11
  v_mfma_f32_32x32x16_bf16 v[16:31], a[68:71], v[188:191], v[16:31]
  buffer_load_dwordx4 a[164:167], v1, s[4:7], s37 offen offset:1024 sc1
  v_add_f32 v11, v170, v11
  v_add_f32 v11, v171, v11
  v_mfma_f32_32x32x16_bf16 v[32:47], a[72:75], v[184:187], 0
  buffer_load_dwordx4 a[168:171], v1, s[4:7], s37 offen offset:2048 sc1
  v_add_f32 v11, v172, v11
  v_add_f32 v11, v173, v11
  v_mfma_f32_32x32x16_bf16 v[32:47], a[76:79], v[188:191], v[32:47]
  buffer_load_dwordx4 a[172:175], v1, s[4:7], s37 offen offset:3072 sc1
  v_add_f32 v11, v174, v11
  v_add_f32 v11, v175, v11
  v_mfma_f32_32x32x16_bf16 v[48:63], a[80:83], v[184:187], 0
  s_add_u32 s37, s37, 4096
  buffer_load_dwordx4 a[176:179], v1, s[4:7], s37 offen offset:0 sc1
  v_add_f32 v11, v176, v11
  v_add_f32 v11, v177, v11
  v_mfma_f32_32x32x16_bf16 v[48:63], a[84:87], v[188:191], v[48:63]
  buffer_load_dwordx4 a[180:183], v1, s[4:7], s37 offen offset:1024 sc1
  v_add_f32 v11, v178, v11
  v_add_f32 v11, v179, v11
  v_mfma_f32_32x32x16_bf16 v[64:79], a[88:91], v[184:187], 0
  buffer_load_dwordx4 a[184:187], v1, s[4:7], s37 offen offset:2048 sc1
  v_add_f32 v11, v180, v11
  v_add_f32 v11, v181, v11
  v_mfma_f32_32x32x16_bf16 v[64:79], a[92:95], v[188:191], v[64:79]
  buffer_load_dwordx4 a[188:191], v1, s[4:7], s37 offen offset:3072 sc1
  v_add_f32 v11, v182, v11
  v_add_f32 v11, v183, v11
  s_waitcnt vmcnt(25)
L_att0_km:
  v_mfma_f32_32x32x16_bf16 v[80:95], v[144:147], a[0:3], 0
  v_mfma_f32_32x32x16_bf16 v[96:111], v[144:147], a[4:7], 0
  v_mfma_f32_32x32x16_bf16 v[112:127], v[144:147], a[8:11], 0
  v_mfma_f32_32x32x16_bf16 v[128:143], v[144:147], a[12:15], 0
  v_mfma_f32_32x32x16_bf16 v[80:95], v[148:151], a[16:19], v[80:95]
  v_mfma_f32_32x32x16_bf16 v[96:111], v[148:151], a[20:23], v[96:111]
  v_mfma_f32_32x32x16_bf16 v[112:127], v[148:151], a[24:27], v[112:127]
  v_mfma_f32_32x32x16_bf16 v[128:143], v[148:151], a[28:31], v[128:143]
  s_lshl_b32 s37, s39, 13
  s_add_u32 s37, s37, 137838592
  s_add_u32 s38, s37, 4096
  v_pk_add_f32 v[196:197], v[80:81], v[100:101]
  v_pk_add_f32 v[198:199], v[82:83], v[102:103]
  s_nop 6
  v_pk_add_f32 v[200:201], v[120:121], v[140:141]
  v_pk_add_f32 v[202:203], v[122:123], v[142:143]
  v_pk_add_f32 v[196:197], v[196:197], v[200:201]
  v_pk_add_f32 v[198:199], v[198:199], v[202:203]
  v_mul_f32 v196, s50, v196
  v_mul_f32 v197, s50, v197
  v_mul_f32 v198, s50, v198
  v_mul_f32 v199, s50, v199
  v_max3_f32 v8, v196, v197, v198
  v_max3_f32 v8, v8, v199, v9
  v_mov_b32 v10, v8
  s_nop 1
  v_permlane32_swap_b32 v8, v10
  v_max_f32 v8, v8, v10
  v_sub_f32 v9, v9, v8
  v_sub_f32 v196, v196, v8
  v_sub_f32 v197, v197, v8
  v_sub_f32 v198, v198, v8
  v_sub_f32 v199, v199, v8
  v_exp_f32 v9, v9
  v_exp_f32 v196, v196
  v_exp_f32 v197, v197
  v_exp_f32 v198, v198
  v_exp_f32 v199, v199
  v_fma_f32 v11, v11, v9, v196
  v_add_f32 v10, v197, v198
  v_add_f32 v11, v11, v199
  v_add_f32 v11, v11, v10
  v_mov_b32 v10, v11
  s_nop 1
  v_permlane32_swap_b32 v11, v10
  v_add_f32 v11, v11, v10
  v_rcp_f32 v11, v11
  s_nop 0
  v_mul_f32 v8, v9, v11
  v_mul_f32 v196, v11, v196
  v_mul_f32 v197, v11, v197
  v_mul_f32 v198, v11, v198
  v_mul_f32 v199, v11, v199
  v_cvt_pk_bf16_f32 v192, v196, v197
  v_cvt_pk_bf16_f32 v193, v198, v199
  v_pk_mul_f32 v[16:17], v[16:17], v[8:9] op_sel_hi:[1,0]
  v_pk_mul_f32 v[18:19], v[18:19], v[8:9] op_sel_hi:[1,0]
  v_pk_mul_f32 v[20:21], v[20:21], v[8:9] op_sel_hi:[1,0]
  v_pk_mul_f32 v[22:23], v[22:23], v[8:9] op_sel_hi:[1,0]
  v_pk_mul_f32 v[24:25], v[24:25], v[8:9] op_sel_hi:[1,0]
  v_pk_mul_f32 v[26:27], v[26:27], v[8:9] op_sel_hi:[1,0]
  v_pk_mul_f32 v[28:29], v[28:29], v[8:9] op_sel_hi:[1,0]
  v_pk_mul_f32 v[30:31], v[30:31], v[8:9] op_sel_hi:[1,0]
  v_pk_mul_f32 v[32:33], v[32:33], v[8:9] op_sel_hi:[1,0]
  v_pk_mul_f32 v[34:35], v[34:35], v[8:9] op_sel_hi:[1,0]
  v_pk_mul_f32 v[36:37], v[36:37], v[8:9] op_sel_hi:[1,0]
  v_pk_mul_f32 v[38:39], v[38:39], v[8:9] op_sel_hi:[1,0]
  v_pk_mul_f32 v[40:41], v[40:41], v[8:9] op_sel_hi:[1,0]
  v_pk_mul_f32 v[42:43], v[42:43], v[8:9] op_sel_hi:[1,0]
  v_pk_mul_f32 v[44:45], v[44:45], v[8:9] op_sel_hi:[1,0]
  v_pk_mul_f32 v[46:47], v[46:47], v[8:9] op_sel_hi:[1,0]
  v_pk_mul_f32 v[48:49], v[48:49], v[8:9] op_sel_hi:[1,0]
  v_pk_mul_f32 v[50:51], v[50:51], v[8:9] op_sel_hi:[1,0]
  v_pk_mul_f32 v[52:53], v[52:53], v[8:9] op_sel_hi:[1,0]
  v_pk_mul_f32 v[54:55], v[54:55], v[8:9] op_sel_hi:[1,0]
  v_pk_mul_f32 v[56:57], v[56:57], v[8:9] op_sel_hi:[1,0]
  v_pk_mul_f32 v[58:59], v[58:59], v[8:9] op_sel_hi:[1,0]
  v_pk_mul_f32 v[60:61], v[60:61], v[8:9] op_sel_hi:[1,0]
  v_pk_mul_f32 v[62:63], v[62:63], v[8:9] op_sel_hi:[1,0]
  v_pk_mul_f32 v[64:65], v[64:65], v[8:9] op_sel_hi:[1,0]
  v_pk_mul_f32 v[66:67], v[66:67], v[8:9] op_sel_hi:[1,0]
  v_pk_mul_f32 v[68:69], v[68:69], v[8:9] op_sel_hi:[1,0]
  v_pk_mul_f32 v[70:71], v[70:71], v[8:9] op_sel_hi:[1,0]
  v_pk_mul_f32 v[72:73], v[72:73], v[8:9] op_sel_hi:[1,0]
  v_pk_mul_f32 v[74:75], v[74:75], v[8:9] op_sel_hi:[1,0]
  v_pk_mul_f32 v[76:77], v[76:77], v[8:9] op_sel_hi:[1,0]
  v_pk_mul_f32 v[78:79], v[78:79], v[8:9] op_sel_hi:[1,0]
  s_load_dword s52, s[56:57], 0 glc
  s_load_dword s53, s[58:59], 0 glc
  s_load_dword s54, s[58:59], 128 glc
  s_load_dword s55, s[58:59], 256 glc
  s_load_dword s61, s[58:59], 384 glc
  v_mfma_f32_32x32x16_bf16 v[16:31], v[152:155], v[192:195], v[16:31]
  v_mfma_f32_32x32x16_bf16 v[32:47], v[156:159], v[192:195], v[32:47]
  v_mfma_f32_32x32x16_bf16 v[48:63], v[160:163], v[192:195], v[48:63]
  v_mfma_f32_32x32x16_bf16 v[64:79], v[164:167], v[192:195], v[64:79]
  v_cvt_pk_bf16_f32 v208, v16, v17
  v_cvt_pk_bf16_f32 v209, v18, v19
  v_cvt_pk_bf16_f32 v210, v20, v21
  v_cvt_pk_bf16_f32 v211, v22, v23
  v_cvt_pk_bf16_f32 v212, v24, v25
  v_cvt_pk_bf16_f32 v213, v26, v27
  v_cvt_pk_bf16_f32 v214, v28, v29
  v_cvt_pk_bf16_f32 v215, v30, v31
  buffer_store_dwordx4 v[208:211], v1, s[4:7], s37 offen offset:0 sc1
  buffer_store_dwordx4 v[212:215], v1, s[4:7], s37 offen offset:1024 sc1
  v_cvt_pk_bf16_f32 v216, v32, v33
  v_cvt_pk_bf16_f32 v217, v34, v35
  v_cvt_pk_bf16_f32 v218, v36, v37
  v_cvt_pk_bf16_f32 v219, v38, v39
  v_cvt_pk_bf16_f32 v220, v40, v41
  v_cvt_pk_bf16_f32 v221, v42, v43
  v_cvt_pk_bf16_f32 v222, v44, v45
  v_cvt_pk_bf16_f32 v223, v46, v47
  buffer_store_dwordx4 v[216:219], v1, s[4:7], s37 offen offset:2048 sc1
  buffer_store_dwordx4 v[220:223], v1, s[4:7], s37 offen offset:3072 sc1
  v_cvt_pk_bf16_f32 v224, v48, v49
  v_cvt_pk_bf16_f32 v225, v50, v51
  v_cvt_pk_bf16_f32 v226, v52, v53
  v_cvt_pk_bf16_f32 v227, v54, v55
  v_cvt_pk_bf16_f32 v228, v56, v57
  v_cvt_pk_bf16_f32 v229, v58, v59
  v_cvt_pk_bf16_f32 v230, v60, v61
  v_cvt_pk_bf16_f32 v231, v62, v63
  buffer_store_dwordx4 v[224:227], v1, s[4:7], s38 offen offset:0 sc1
  buffer_store_dwordx4 v[228:231], v1, s[4:7], s38 offen offset:1024 sc1
  v_cvt_pk_bf16_f32 v232, v64, v65
  v_cvt_pk_bf16_f32 v233, v66, v67
  v_cvt_pk_bf16_f32 v234, v68, v69
  v_cvt_pk_bf16_f32 v235, v70, v71
  v_cvt_pk_bf16_f32 v236, v72, v73
  v_cvt_pk_bf16_f32 v237, v74, v75
  v_cvt_pk_bf16_f32 v238, v76, v77
  v_cvt_pk_bf16_f32 v239, v78, v79
  buffer_store_dwordx4 v[232:235], v1, s[4:7], s38 offen offset:2048 sc1
  buffer_store_dwordx4 v[236:239], v1, s[4:7], s38 offen offset:3072 sc1
  s_mov_b32 s34, s35
  s_add_u32 s35, s35, 1
  s_add_u32 s45, s45, 1
  s_cmp_eq_u32 s47, 0
  s_cbranch_scc1 L_att0_next
  s_waitcnt vmcnt(0)
  v_mov_b32 v6, s45
  s_mov_b64 exec, 1
  buffer_store_dword v6, v5, s[4:7], s42 offen sc1
  s_mov_b64 exec, -1
  s_cmp_ge_u32 s45, 64
  s_cbranch_scc1 L_att_done
  s_add_u32 s37, s43, 16384
Lwf_34:
  s_mov_b64 exec, 15
  buffer_load_dword v8, v2, s[4:7], s37 offen sc1
  s_waitcnt vmcnt(0)
  v_cmp_ge_u32 vcc, s45, v8
  s_mov_b64 exec, -1
  s_cbranch_vccz Lwfok_35
  s_add_u32 s60, s60, 1
  s_cmp_gt_u32 s60, 262144
  s_cbranch_scc1 L_fail_att
  s_branch Lwf_34
Lwfok_35:
  s_mul_i32 s37, s29, 129
  s_add_u32 s37, s37, s35
  s_sub_u32 s37, s37, s31
  s_mul_i32 s37, s37, 24576
  s_add_u32 s37, s37, 19480576
  buffer_load_dwordx4 a[96:99], v1, s[4:7], s37 offen offset:0 sc1
  buffer_load_dwordx4 a[100:103], v1, s[4:7], s37 offen offset:1024 sc1
  buffer_load_dwordx4 a[104:107], v1, s[4:7], s37 offen offset:2048 sc1
  buffer_load_dwordx4 a[108:111], v1, s[4:7], s37 offen offset:3072 sc1
  s_add_u32 s37, s37, 4096
  buffer_load_dwordx4 a[112:115], v1, s[4:7], s37 offen offset:0 sc1
  buffer_load_dwordx4 a[116:119], v1, s[4:7], s37 offen offset:1024 sc1
  buffer_load_dwordx4 a[120:123], v1, s[4:7], s37 offen offset:2048 sc1
  buffer_load_dwordx4 a[124:127], v1, s[4:7], s37 offen offset:3072 sc1
  s_add_u32 s37, s37, 4096
  buffer_load_dwordx4 a[128:131], v1, s[4:7], s37 offen offset:0 sc1
  buffer_load_dwordx4 a[132:135], v1, s[4:7], s37 offen offset:1024 sc1
  buffer_load_dwordx4 a[136:139], v1, s[4:7], s37 offen offset:2048 sc1
  buffer_load_dwordx4 a[140:143], v1, s[4:7], s37 offen offset:3072 sc1
  s_add_u32 s37, s37, 4096
  buffer_load_dwordx4 a[144:147], v1, s[4:7], s37 offen offset:0 sc1
  buffer_load_dwordx4 a[148:151], v1, s[4:7], s37 offen offset:1024 sc1
  buffer_load_dwordx4 a[152:155], v1, s[4:7], s37 offen offset:2048 sc1
  buffer_load_dwordx4 a[156:159], v1, s[4:7], s37 offen offset:3072 sc1
  s_add_u32 s37, s37, 4096
  buffer_load_dwordx4 a[160:163], v1, s[4:7], s37 offen offset:0 sc1
  buffer_load_dwordx4 a[164:167], v1, s[4:7], s37 offen offset:1024 sc1
  buffer_load_dwordx4 a[168:171], v1, s[4:7], s37 offen offset:2048 sc1
  buffer_load_dwordx4 a[172:175], v1, s[4:7], s37 offen offset:3072 sc1
  s_add_u32 s37, s37, 4096
  buffer_load_dwordx4 a[176:179], v1, s[4:7], s37 offen offset:0 sc1
  buffer_load_dwordx4 a[180:183], v1, s[4:7], s37 offen offset:1024 sc1
  buffer_load_dwordx4 a[184:187], v1, s[4:7], s37 offen offset:2048 sc1
  buffer_load_dwordx4 a[188:191], v1, s[4:7], s37 offen offset:3072 sc1
  s_waitcnt lgkmcnt(0)
  s_load_dword s52, s[56:57], 0 glc
  s_load_dword s53, s[58:59], 0 glc
  s_load_dword s54, s[58:59], 128 glc
  s_load_dword s55, s[58:59], 256 glc
  s_load_dword s61, s[58:59], 384 glc
  s_waitcnt vmcnt(0)
L_att0_next:
  s_waitcnt vmcnt(8)
  s_mul_i32 s39, s29, 129
  s_add_u32 s39, s39, s35
  s_sub_u32 s39, s39, s31
  s_lshl_b32 s36, s39, 12
  s_add_u32 s36, s36, 120930304
  s_add_u32 s38, s35, 1
  s_mul_i32 s37, s29, 129
  s_add_u32 s37, s37, s38
  s_sub_u32 s37, s37, s31
  s_mul_i32 s37, s37, 24576
  s_add_u32 s37, s37, 19480576
  s_waitcnt lgkmcnt(0)
  s_min_u32 s53, s53, s54
  s_min_u32 s55, s55, s61
  s_min_u32 s53, s53, s55
  s_add_u32 s46, s45, 1
  s_cmp_gt_u32 s53, s46
  s_cselect_b32 s37, s37, 0x40000000
  s_cselect_b32 s47, 0, 1
  s_cmp_gt_u32 s52, s45
  s_cbranch_scc1 L_att1_kmq
  v_mfma_f32_32x32x16_bf16 v[168:183], a[128:131], a[96:99], 0
  buffer_load_dwordx4 a[0:3], v1, s[4:7], s37 offen offset:0 sc1
  v_mfma_f32_32x32x16_bf16 v[168:183], a[132:135], a[100:103], v[168:183]
  buffer_load_dwordx4 a[4:7], v1, s[4:7], s37 offen offset:1024 sc1
  v_mfma_f32_32x32x16_bf16 v[168:183], a[136:139], a[104:107], v[168:183]
  buffer_load_dwordx4 a[8:11], v1, s[4:7], s37 offen offset:2048 sc1
  v_mfma_f32_32x32x16_bf16 v[168:183], a[140:143], a[108:111], v[168:183]
  buffer_load_dwordx4 a[12:15], v1, s[4:7], s37 offen offset:3072 sc1
  v_mfma_f32_32x32x16_bf16 v[168:183], a[144:147], a[112:115], v[168:183]
  s_add_u32 s37, s37, 4096
  buffer_load_dwordx4 a[16:19], v1, s[4:7], s37 offen offset:0 sc1
  v_mfma_f32_32x32x16_bf16 v[168:183], a[148:151], a[116:119], v[168:183]
  buffer_load_dwordx4 a[20:23], v1, s[4:7], s37 offen offset:1024 sc1
  v_mfma_f32_32x32x16_bf16 v[168:183], a[152:155], a[120:123], v[168:183]
  buffer_load_dwordx4 a[24:27], v1, s[4:7], s37 offen offset:2048 sc1
  v_mfma_f32_32x32x16_bf16 v[168:183], a[156:159], a[124:127], v[168:183]
  buffer_load_dwordx4 a[28:31], v1, s[4:7], s37 offen offset:3072 sc1
  s_add_u32 s37, s37, 4096
  buffer_load_dwordx4 a[32:35], v1, s[4:7], s37 offen offset:0 sc1
  buffer_load_dwordx4 a[36:39], v1, s[4:7], s37 offen offset:1024 sc1
  s_nop 7
  v_cndmask_b32 v168, v7, v168, s[64:65]
  v_cndmask_b32 v169, v7, v169, s[66:67]
  v_cndmask_b32 v170, v7, v170, s[68:69]
  v_cndmask_b32 v171, v7, v171, s[70:71]
  v_cndmask_b32 v172, v7, v172, s[72:73]
  v_cndmask_b32 v173, v7, v173, s[74:75]
  v_cndmask_b32 v174, v7, v174, s[76:77]
  v_cndmask_b32 v175, v7, v175, s[78:79]
  v_cndmask_b32 v176, v7, v176, s[80:81]
  v_cndmask_b32 v177, v7, v177, s[82:83]
  v_cndmask_b32 v178, v7, v178, s[84:85]
  v_cndmask_b32 v179, v7, v179, s[86:87]
  v_cndmask_b32 v180, v7, v180, s[88:89]
  v_cndmask_b32 v181, v7, v181, s[90:91]
  v_cndmask_b32 v182, v7, v182, s[92:93]
  v_cndmask_b32 v183, v7, v183, s[94:95]
  v_max3_f32 v9, v168, v169, v170
  v_max3_f32 v9, v9, v171, v172
  v_max3_f32 v9, v9, v173, v174
  v_max3_f32 v9, v9, v175, v176
  v_max3_f32 v9, v9, v177, v178
  v_max3_f32 v9, v9, v179, v180
  v_max3_f32 v9, v9, v181, v182
  v_max_f32 v9, v9, v183
  v_mov_b32 v10, v9
  buffer_load_dwordx4 a[40:43], v1, s[4:7], s37 offen offset:2048 sc1
  buffer_load_dwordx4 a[44:47], v1, s[4:7], s37 offen offset:3072 sc1
  v_permlane32_swap_b32 v9, v10
  v_max_f32 v9, v9, v10
  v_mul_f32 v9, s50, v9
  v_fma_f32 v168, v168, s50, -v9
  v_fma_f32 v169, v169, s50, -v9
  v_fma_f32 v170, v170, s50, -v9
  v_fma_f32 v171, v171, s50, -v9
  v_fma_f32 v172, v172, s50, -v9
  v_fma_f32 v173, v173, s50, -v9
  v_fma_f32 v174, v174, s50, -v9
  v_fma_f32 v175, v175, s50, -v9
  v_fma_f32 v176, v176, s50, -v9
  v_fma_f32 v177, v177, s50, -v9
  v_fma_f32 v178, v178, s50, -v9
  v_fma_f32 v179, v179, s50, -v9
  v_fma_f32 v180, v180, s50, -v9
  v_fma_f32 v181, v181, s50, -v9
  v_fma_f32 v182, v182, s50, -v9
  v_fma_f32 v183, v183, s50, -v9
  s_load_dword s52, s[56:57], 0 glc
  s_waitcnt vmcnt(12)
  v_mov_b32 v6, s45
  s_mov_b64 exec, 1
  buffer_store_dword v6, v5, s[4:7], s42 offen sc1
  s_mov_b64 exec, -1
  v_exp_f32 v168, v168
  v_exp_f32 v169, v169
  v_exp_f32 v170, v170
  v_exp_f32 v171, v171
  s_add_u32 s37, s37, 4096
  buffer_load_dwordx4 a[48:51], v1, s[4:7], s37 offen offset:0 sc1
  v_exp_f32 v172, v172
  v_exp_f32 v173, v173
  v_exp_f32 v174, v174
  v_exp_f32 v175, v175
  buffer_load_dwordx4 a[52:55], v1, s[4:7], s37 offen offset:1024 sc1
  v_exp_f32 v176, v176
  v_exp_f32 v177, v177
  v_exp_f32 v178, v178
  v_exp_f32 v179, v179
  buffer_load_dwordx4 a[56:59], v1, s[4:7], s37 offen offset:2048 sc1
  v_exp_f32 v180, v180
  v_exp_f32 v181, v181
  v_exp_f32 v182, v182
  v_exp_f32 v183, v183
  buffer_load_dwordx4 a[60:63], v1, s[4:7], s37 offen offset:3072 sc1
  v_cvt_pk_bf16_f32 v184, v168, v169
  v_cvt_pk_bf16_f32 v185, v170, v171
  v_cvt_pk_bf16_f32 v186, v172, v173
  v_cvt_pk_bf16_f32 v187, v174, v175
  v_cvt_pk_bf16_f32 v188, v176, v177
  v_cvt_pk_bf16_f32 v189, v178, v179
  v_cvt_pk_bf16_f32 v190, v180, v181
  v_cvt_pk_bf16_f32 v191, v182, v183
  v_mfma_f32_32x32x16_bf16 v[16:31], a[160:163], v[184:187], 0
  s_add_u32 s37, s37, 4096
  buffer_load_dwordx4 a[64:67], v1, s[4:7], s37 offen offset:0 sc1
  v_mov_b32 v11, v168
  v_add_f32 v11, v169, v11
  v_mfma_f32_32x32x16_bf16 v[16:31], a[164:167], v[188:191], v[16:31]
  buffer_load_dwordx4 a[68:71], v1, s[4:7], s37 offen offset:1024 sc1
  v_add_f32 v11, v170, v11
  v_add_f32 v11, v171, v11
  v_mfma_f32_32x32x16_bf16 v[32:47], a[168:171], v[184:187], 0
  buffer_load_dwordx4 a[72:75], v1, s[4:7], s37 offen offset:2048 sc1
  v_add_f32 v11, v172, v11
  v_add_f32 v11, v173, v11
  v_mfma_f32_32x32x16_bf16 v[32:47], a[172:175], v[188:191], v[32:47]
  buffer_load_dwordx4 a[76:79], v1, s[4:7], s37 offen offset:3072 sc1
  v_add_f32 v11, v174, v11
  v_add_f32 v11, v175, v11
  v_mfma_f32_32x32x16_bf16 v[48:63], a[176:179], v[184:187], 0
  s_add_u32 s37, s37, 4096
  buffer_load_dwordx4 a[80:83], v1, s[4:7], s37 offen offset:0 sc1
  v_add_f32 v11, v176, v11
  v_add_f32 v11, v177, v11
  v_mfma_f32_32x32x16_bf16 v[48:63], a[180:183], v[188:191], v[48:63]
  buffer_load_dwordx4 a[84:87], v1, s[4:7], s37 offen offset:1024 sc1
  v_add_f32 v11, v178, v11
  v_add_f32 v11, v179, v11
  v_mfma_f32_32x32x16_bf16 v[64:79], a[184:187], v[184:187], 0
  buffer_load_dwordx4 a[88:91], v1, s[4:7], s37 offen offset:2048 sc1
  v_add_f32 v11, v180, v11
  v_add_f32 v11, v181, v11
  v_mfma_f32_32x32x16_bf16 v[64:79], a[188:191], v[188:191], v[64:79]
  buffer_load_dwordx4 a[92:95], v1, s[4:7], s37 offen offset:3072 sc1
  v_add_f32 v11, v182, v11
  v_add_f32 v11, v183, v11
  s_branch L_att1_chk
L_att1_poll:
  s_load_dword s52, s[56:57], 0 glc
  s_add_u32 s60, s60, 1
  s_cmp_gt_u32 s60, 262144
  s_cbranch_scc1 L_fail_att
L_att1_chk:
  s_waitcnt lgkmcnt(0)
  s_cmp_le_u32 s52, s45
  s_cbranch_scc1 L_att1_poll
  buffer_load_dwordx4 v[144:147], v3, s[4:7], s36 offen offset:0 sc1
  buffer_load_dwordx4 v[148:151], v3, s[4:7], s36 offen offset:1024 sc1
  buffer_load_dword v152, v4, s[4:7], s36 offen offset:2048 sc1
  buffer_load_dword v153, v4, s[4:7], s36 offen offset:2112 sc1
  buffer_load_dword v156, v4, s[4:7], s36 offen offset:2560 sc1
  buffer_load_dword v157, v4, s[4:7], s36 offen offset:2624 sc1
  buffer_load_dword v160, v4, s[4:7], s36 offen offset:3072 sc1
  buffer_load_dword v161, v4, s[4:7], s36 offen offset:3136 sc1
  buffer_load_dword v164, v4, s[4:7], s36 offen offset:3584 sc1
  buffer_load_dword v165, v4, s[4:7], s36 offen offset:3648 sc1
  s_waitcnt vmcnt(0)
  s_branch L_att1_km
L_att1_kmq:
  buffer_load_dwordx4 v[144:147], v3, s[4:7], s36 offen offset:0 sc1
  buffer_load_dwordx4 v[148:151], v3, s[4:7], s36 offen offset:1024 sc1
  buffer_load_dword v152, v4, s[4:7], s36 offen offset:2048 sc1
  buffer_load_dword v153, v4, s[4:7], s36 offen offset:2112 sc1
  buffer_load_dword v156, v4, s[4:7], s36 offen offset:2560 sc1
  buffer_load_dword v157, v4, s[4:7], s36 offen offset:2624 sc1
  buffer_load_dword v160, v4, s[4:7], s36 offen offset:3072 sc1
  buffer_load_dword v161, v4, s[4:7], s36 offen offset:3136 sc1
  buffer_load_dword v164, v4, s[4:7], s36 offen offset:3584 sc1
  buffer_load_dword v165, v4, s[4:7], s36 offen offset:3648 sc1
  v_mfma_f32_32x32x16_bf16 v[168:183], a[128:131], a[96:99], 0
  buffer_load_dwordx4 a[0:3], v1, s[4:7], s37 offen offset:0 sc1
  v_mfma_f32_32x32x16_bf16 v[168:183], a[132:135], a[100:103], v[168:183]
  buffer_load_dwordx4 a[4:7], v1, s[4:7], s37 offen offset:1024 sc1
  v_mfma_f32_32x32x16_bf16 v[168:183], a[136:139], a[104:107], v[168:183]
  buffer_load_dwordx4 a[8:11], v1, s[4:7], s37 offen offset:2048 sc1
  v_mfma_f32_32x32x16_bf16 v[168:183], a[140:143], a[108:111], v[168:183]
  buffer_load_dwordx4 a[12:15], v1, s[4:7], s37 offen offset:3072 sc1
  v_mfma_f32_32x32x16_bf16 v[168:183], a[144:147], a[112:115], v[168:183]
  s_add_u32 s37, s37, 4096
  buffer_load_dwordx4 a[16:19], v1, s[4:7], s37 offen offset:0 sc1
  v_mfma_f32_32x32x16_bf16 v[168:183], a[148:151], a[116:119], v[168:183]
  buffer_load_dwordx4 a[20:23], v1, s[4:7], s37 offen offset:1024 sc1
  v_mfma_f32_32x32x16_bf16 v[168:183], a[152:155], a[120:123], v[168:183]
  buffer_load_dwordx4 a[24:27], v1, s[4:7], s37 offen offset:2048 sc1
  v_mfma_f32_32x32x16_bf16 v[168:183], a[156:159], a[124:127], v[168:183]
  buffer_load_dwordx4 a[28:31], v1, s[4:7], s37 offen offset:3072 sc1
  s_add_u32 s37, s37, 4096
  buffer_load_dwordx4 a[32:35], v1, s[4:7], s37 offen offset:0 sc1
  buffer_load_dwordx4 a[36:39], v1, s[4:7], s37 offen offset:1024 sc1
  s_nop 7
  v_cndmask_b32 v168, v7, v168, s[64:65]
  v_cndmask_b32 v169, v7, v169, s[66:67]
  v_cndmask_b32 v170, v7, v170, s[68:69]
  v_cndmask_b32 v171, v7, v171, s[70:71]
  v_cndmask_b32 v172, v7, v172, s[72:73]
  v_cndmask_b32 v173, v7, v173, s[74:75]
  v_cndmask_b32 v174, v7, v174, s[76:77]
  v_cndmask_b32 v175, v7, v175, s[78:79]
  v_cndmask_b32 v176, v7, v176, s[80:81]
  v_cndmask_b32 v177, v7, v177, s[82:83]
  v_cndmask_b32 v178, v7, v178, s[84:85]
  v_cndmask_b32 v179, v7, v179, s[86:87]
  v_cndmask_b32 v180, v7, v180, s[88:89]
  v_cndmask_b32 v181, v7, v181, s[90:91]
  v_cndmask_b32 v182, v7, v182, s[92:93]
  v_cndmask_b32 v183, v7, v183, s[94:95]
  v_max3_f32 v9, v168, v169, v170
  v_max3_f32 v9, v9, v171, v172
  v_max3_f32 v9, v9, v173, v174
  v_max3_f32 v9, v9, v175, v176
  v_max3_f32 v9, v9, v177, v178
  v_max3_f32 v9, v9, v179, v180
  v_max3_f32 v9, v9, v181, v182
  v_max_f32 v9, v9, v183
  v_mov_b32 v10, v9
  buffer_load_dwordx4 a[40:43], v1, s[4:7], s37 offen offset:2048 sc1
  buffer_load_dwordx4 a[44:47], v1, s[4:7], s37 offen offset:3072 sc1
  v_permlane32_swap_b32 v9, v10
  v_max_f32 v9, v9, v10
  v_mul_f32 v9, s50, v9
  v_fma_f32 v168, v168, s50, -v9
  v_fma_f32 v169, v169, s50, -v9
  v_fma_f32 v170, v170, s50, -v9
  v_fma_f32 v171, v171, s50, -v9
  v_fma_f32 v172, v172, s50, -v9
  v_fma_f32 v173, v173, s50, -v9
  v_fma_f32 v174, v174, s50, -v9
  v_fma_f32 v175, v175, s50, -v9
  v_fma_f32 v176, v176, s50, -v9
  v_fma_f32 v177, v177, s50, -v9
  v_fma_f32 v178, v178, s50, -v9
  v_fma_f32 v179, v179, s50, -v9
  v_fma_f32 v180, v180, s50, -v9
  v_fma_f32 v181, v181, s50, -v9
  v_fma_f32 v182, v182, s50, -v9
  v_fma_f32 v183, v183, s50, -v9
  s_waitcnt vmcnt(22)
  v_mov_b32 v6, s45
  s_mov_b64 exec, 1
  buffer_store_dword v6, v5, s[4:7], s42 offen sc1
  s_mov_b64 exec, -1
  v_exp_f32 v168, v168
  v_exp_f32 v169, v169
  v_exp_f32 v170, v170
  v_exp_f32 v171, v171
  s_add_u32 s37, s37, 4096
  buffer_load_dwordx4 a[48:51], v1, s[4:7], s37 offen offset:0 sc1
  v_exp_f32 v172, v172
  v_exp_f32 v173, v173
  v_exp_f32 v174, v174
  v_exp_f32 v175, v175
  buffer_load_dwordx4 a[52:55], v1, s[4:7], s37 offen offset:1024 sc1
  v_exp_f32 v176, v176
  v_exp_f32 v177, v177
  v_exp_f32 v178, v178
  v_exp_f32 v179, v179
  buffer_load_dwordx4 a[56:59], v1, s[4:7], s37 offen offset:2048 sc1
  v_exp_f32 v180, v180
  v_exp_f32 v181, v181
  v_exp_f32 v182, v182
  v_exp_f32 v183, v183
  buffer_load_dwordx4 a[60:63], v1, s[4:7], s37 offen offset:3072 sc1
  v_cvt_pk_bf16_f32 v184, v168, v169
  v_cvt_pk_bf16_f32 v185, v170, v171
  v_cvt_pk_bf16_f32 v186, v172, v173
  v_cvt_pk_bf16_f32 v187, v174, v175
  v_cvt_pk_bf16_f32 v188, v176, v177
  v_cvt_pk_bf16_f32 v189, v178, v179
  v_cvt_pk_bf16_f32 v190, v180, v181
  v_cvt_pk_bf16_f32 v191, v182, v183
  v_mfma_f32_32x32x16_bf16 v[16:31], a[160:163], v[184:187], 0
  s_add_u32 s37, s37, 4096
  buffer_load_dwordx4 a[64:67], v1, s[4:7], s37 offen offset:0 sc1
  v_mov_b32 v11, v168
  v_add_f32 v11, v169, v11
  v_mfma_f32_32x32x16_bf16 v[16:31], a[164:167], v[188:191], v[16:31]
  buffer_load_dwordx4 a[68:71], v1, s[4:7], s37 offen offset:1024 sc1
  v_add_f32 v11, v170, v11
  v_add_f32 v11, v171, v11
  v_mfma_f32_32x32x16_bf16 v[32:47], a[168:171], v[184:187], 0
  buffer_load_dwordx4 a[72:75], v1, s[4:7], s37 offen offset:2048 sc1
  v_add_f32 v11, v172, v11
  v_add_f32 v11, v173, v11
  v_mfma_f32_32x32x16_bf16 v[32:47], a[172:175], v[188:191], v[32:47]
  buffer_load_dwordx4 a[76:79], v1, s[4:7], s37 offen offset:3072 sc1
  v_add_f32 v11, v174, v11
  v_add_f32 v11, v175, v11
  v_mfma_f32_32x32x16_bf16 v[48:63], a[176:179], v[184:187], 0
  s_add_u32 s37, s37, 4096
  buffer_load_dwordx4 a[80:83], v1, s[4:7], s37 offen offset:0 sc1
  v_add_f32 v11, v176, v11
  v_add_f32 v11, v177, v11
  v_mfma_f32_32x32x16_bf16 v[48:63], a[180:183], v[188:191], v[48:63]
  buffer_load_dwordx4 a[84:87], v1, s[4:7], s37 offen offset:1024 sc1
  v_add_f32 v11, v178, v11
  v_add_f32 v11, v179, v11
  v_mfma_f32_32x32x16_bf16 v[64:79], a[184:187], v[184:187], 0
  buffer_load_dwordx4 a[88:91], v1, s[4:7], s37 offen offset:2048 sc1
  v_add_f32 v11, v180, v11
  v_add_f32 v11, v181, v11
  v_mfma_f32_32x32x16_bf16 v[64:79], a[188:191], v[188:191], v[64:79]
  buffer_load_dwordx4 a[92:95], v1, s[4:7], s37 offen offset:3072 sc1
  v_add_f32 v11, v182, v11
  v_add_f32 v11, v183, v11
  s_waitcnt vmcnt(25)
L_att1_km:
  v_mfma_f32_32x32x16_bf16 v[80:95], v[144:147], a[96:99], 0
  v_mfma_f32_32x32x16_bf16 v[96:111], v[144:147], a[100:103], 0
  v_mfma_f32_32x32x16_bf16 v[112:127], v[144:147], a[104:107], 0
  v_mfma_f32_32x32x16_bf16 v[128:143], v[144:147], a[108:111], 0
  v_mfma_f32_32x32x16_bf16 v[80:95], v[148:151], a[112:115], v[80:95]
  v_mfma_f32_32x32x16_bf16 v[96:111], v[148:151], a[116:119], v[96:111]
  v_mfma_f32_32x32x16_bf16 v[112:127], v[148:151], a[120:123], v[112:127]
  v_mfma_f32_32x32x16_bf16 v[128:143], v[148:151], a[124:127], v[128:143]
  s_lshl_b32 s37, s39, 13
  s_add_u32 s37, s37, 137838592
  s_add_u32 s38, s37, 4096
  v_pk_add_f32 v[196:197], v[80:81], v[100:101]
  v_pk_add_f32 v[198:199], v[82:83], v[102:103]
  s_nop 6
  v_pk_add_f32 v[200:201], v[120:121], v[140:141]
  v_pk_add_f32 v[202:203], v[122:123], v[142:143]
  v_pk_add_f32 v[196:197], v[196:197], v[200:201]
  v_pk_add_f32 v[198:199], v[198:199], v[202:203]
  v_mul_f32 v196, s50, v196
  v_mul_f32 v197, s50, v197
  v_mul_f32 v198, s50, v198
  v_mul_f32 v199, s50, v199
  v_max3_f32 v8, v196, v197, v198
  v_max3_f32 v8, v8, v199, v9
  v_mov_b32 v10, v8
  s_nop 1
  v_permlane32_swap_b32 v8, v10
  v_max_f32 v8, v8, v10
  v_sub_f32 v9, v9, v8
  v_sub_f32 v196, v196, v8
  v_sub_f32 v197, v197, v8
  v_sub_f32 v198, v198, v8
  v_sub_f32 v199, v199, v8
  v_exp_f32 v9, v9
  v_exp_f32 v196, v196
  v_exp_f32 v197, v197
  v_exp_f32 v198, v198
  v_exp_f32 v199, v199
  v_fma_f32 v11, v11, v9, v196
  v_add_f32 v10, v197, v198
  v_add_f32 v11, v11, v199
  v_add_f32 v11, v11, v10
  v_mov_b32 v10, v11
  s_nop 1
  v_permlane32_swap_b32 v11, v10
  v_add_f32 v11, v11, v10
  v_rcp_f32 v11, v11
  s_nop 0
  v_mul_f32 v8, v9, v11
  v_mul_f32 v196, v11, v196
  v_mul_f32 v197, v11, v197
  v_mul_f32 v198, v11, v198
  v_mul_f32 v199, v11, v199
  v_cvt_pk_bf16_f32 v192, v196, v197
  v_cvt_pk_bf16_f32 v193, v198, v199
  v_pk_mul_f32 v[16:17], v[16:17], v[8:9] op_sel_hi:[1,0]
  v_pk_mul_f32 v[18:19], v[18:19], v[8:9] op_sel_hi:[1,0]
  v_pk_mul_f32 v[20:21], v[20:21], v[8:9] op_sel_hi:[1,0]
  v_pk_mul_f32 v[22:23], v[22:23], v[8:9] op_sel_hi:[1,0]
  v_pk_mul_f32 v[24:25], v[24:25], v[8:9] op_sel_hi:[1,0]
  v_pk_mul_f32 v[26:27], v[26:27], v[8:9] op_sel_hi:[1,0]
  v_pk_mul_f32 v[28:29], v[28:29], v[8:9] op_sel_hi:[1,0]
  v_pk_mul_f32 v[30:31], v[30:31], v[8:9] op_sel_hi:[1,0]
  v_pk_mul_f32 v[32:33], v[32:33], v[8:9] op_sel_hi:[1,0]
  v_pk_mul_f32 v[34:35], v[34:35], v[8:9] op_sel_hi:[1,0]
  v_pk_mul_f32 v[36:37], v[36:37], v[8:9] op_sel_hi:[1,0]
  v_pk_mul_f32 v[38:39], v[38:39], v[8:9] op_sel_hi:[1,0]
  v_pk_mul_f32 v[40:41], v[40:41], v[8:9] op_sel_hi:[1,0]
  v_pk_mul_f32 v[42:43], v[42:43], v[8:9] op_sel_hi:[1,0]
  v_pk_mul_f32 v[44:45], v[44:45], v[8:9] op_sel_hi:[1,0]
  v_pk_mul_f32 v[46:47], v[46:47], v[8:9] op_sel_hi:[1,0]
  v_pk_mul_f32 v[48:49], v[48:49], v[8:9] op_sel_hi:[1,0]
  v_pk_mul_f32 v[50:51], v[50:51], v[8:9] op_sel_hi:[1,0]
  v_pk_mul_f32 v[52:53], v[52:53], v[8:9] op_sel_hi:[1,0]
  v_pk_mul_f32 v[54:55], v[54:55], v[8:9] op_sel_hi:[1,0]
  v_pk_mul_f32 v[56:57], v[56:57], v[8:9] op_sel_hi:[1,0]
  v_pk_mul_f32 v[58:59], v[58:59], v[8:9] op_sel_hi:[1,0]
  v_pk_mul_f32 v[60:61], v[60:61], v[8:9] op_sel_hi:[1,0]
  v_pk_mul_f32 v[62:63], v[62:63], v[8:9] op_sel_hi:[1,0]
  v_pk_mul_f32 v[64:65], v[64:65], v[8:9] op_sel_hi:[1,0]
  v_pk_mul_f32 v[66:67], v[66:67], v[8:9] op_sel_hi:[1,0]
  v_pk_mul_f32 v[68:69], v[68:69], v[8:9] op_sel_hi:[1,0]
  v_pk_mul_f32 v[70:71], v[70:71], v[8:9] op_sel_hi:[1,0]
  v_pk_mul_f32 v[72:73], v[72:73], v[8:9] op_sel_hi:[1,0]
  v_pk_mul_f32 v[74:75], v[74:75], v[8:9] op_sel_hi:[1,0]
  v_pk_mul_f32 v[76:77], v[76:77], v[8:9] op_sel_hi:[1,0]
  v_pk_mul_f32 v[78:79], v[78:79], v[8:9] op_sel_hi:[1,0]
  s_load_dword s52, s[56:57], 0 glc
  s_load_dword s53, s[58:59], 16384 glc
  s_load_dword s54, s[58:59], 16512 glc
  s_load_dword s55, s[58:59], 16640 glc
  s_load_dword s61, s[58:59], 16768 glc
  v_mfma_f32_32x32x16_bf16 v[16:31], v[152:155], v[192:195], v[16:31]
  v_mfma_f32_32x32x16_bf16 v[32:47], v[156:159], v[192:195], v[32:47]
  v_mfma_f32_32x32x16_bf16 v[48:63], v[160:163], v[192:195], v[48:63]
  v_mfma_f32_32x32x16_bf16 v[64:79], v[164:167], v[192:195], v[64:79]
  v_cvt_pk_bf16_f32 v208, v16, v17
  v_cvt_pk_bf16_f32 v209, v18, v19
  v_cvt_pk_bf16_f32 v210, v20, v21
  v_cvt_pk_bf16_f32 v211, v22, v23
  v_cvt_pk_bf16_f32 v212, v24, v25
  v_cvt_pk_bf16_f32 v213, v26, v27
  v_cvt_pk_bf16_f32 v214, v28, v29
  v_cvt_pk_bf16_f32 v215, v30, v31
  buffer_store_dwordx4 v[208:211], v1, s[4:7], s37 offen offset:0 sc1
  buffer_store_dwordx4 v[212:215], v1, s[4:7], s37 offen offset:1024 sc1
  v_cvt_pk_bf16_f32 v216, v32, v33
  v_cvt_pk_bf16_f32 v217, v34, v35
  v_cvt_pk_bf16_f32 v218, v36, v37
  v_cvt_pk_bf16_f32 v219, v38, v39
  v_cvt_pk_bf16_f32 v220, v40, v41
  v_cvt_pk_bf16_f32 v221, v42, v43
  v_cvt_pk_bf16_f32 v222, v44, v45
  v_cvt_pk_bf16_f32 v223, v46, v47
  buffer_store_dwordx4 v[216:219], v1, s[4:7], s37 offen offset:2048 sc1
  buffer_store_dwordx4 v[220:223], v1, s[4:7], s37 offen offset:3072 sc1
  v_cvt_pk_bf16_f32 v224, v48, v49
  v_cvt_pk_bf16_f32 v225, v50, v51
  v_cvt_pk_bf16_f32 v226, v52, v53
  v_cvt_pk_bf16_f32 v227, v54, v55
  v_cvt_pk_bf16_f32 v228, v56, v57
  v_cvt_pk_bf16_f32 v229, v58, v59
  v_cvt_pk_bf16_f32 v230, v60, v61
  v_cvt_pk_bf16_f32 v231, v62, v63
  buffer_store_dwordx4 v[224:227], v1, s[4:7], s38 offen offset:0 sc1
  buffer_store_dwordx4 v[228:231], v1, s[4:7], s38 offen offset:1024 sc1
  v_cvt_pk_bf16_f32 v232, v64, v65
  v_cvt_pk_bf16_f32 v233, v66, v67
  v_cvt_pk_bf16_f32 v234, v68, v69
  v_cvt_pk_bf16_f32 v235, v70, v71
  v_cvt_pk_bf16_f32 v236, v72, v73
  v_cvt_pk_bf16_f32 v237, v74, v75
  v_cvt_pk_bf16_f32 v238, v76, v77
  v_cvt_pk_bf16_f32 v239, v78, v79
  buffer_store_dwordx4 v[232:235], v1, s[4:7], s38 offen offset:2048 sc1
  buffer_store_dwordx4 v[236:239], v1, s[4:7], s38 offen offset:3072 sc1
  s_mov_b32 s34, s35
  s_add_u32 s35, s35, 1
  s_add_u32 s45, s45, 1
  s_cmp_eq_u32 s47, 0
  s_cbranch_scc1 L_att1_next
  s_waitcnt vmcnt(0)
  v_mov_b32 v6, s45
  s_mov_b64 exec, 1
  buffer_store_dword v6, v5, s[4:7], s42 offen sc1
  s_mov_b64 exec, -1
  s_cmp_ge_u32 s45, 64
  s_cbranch_scc1 L_att_done
  s_add_u32 s37, s43, 0
Lwf_36:
  s_mov_b64 exec, 15
  buffer_load_dword v8, v2, s[4:7], s37 offen sc1
  s_waitcnt vmcnt(0)
  v_cmp_ge_u32 vcc, s45, v8
  s_mov_b64 exec, -1
  s_cbranch_vccz Lwfok_37
  s_add_u32 s60, s60, 1
  s_cmp_gt_u32 s60, 262144
  s_cbranch_scc1 L_fail_att
  s_branch Lwf_36
Lwfok_37:
  s_mul_i32 s37, s29, 129
  s_add_u32 s37, s37, s35
  s_sub_u32 s37, s37, s31
  s_mul_i32 s37, s37, 24576
  s_add_u32 s37, s37, 19480576
  buffer_load_dwordx4 a[0:3], v1, s[4:7], s37 offen offset:0 sc1
  buffer_load_dwordx4 a[4:7], v1, s[4:7], s37 offen offset:1024 sc1
  buffer_load_dwordx4 a[8:11], v1, s[4:7], s37 offen offset:2048 sc1
  buffer_load_dwordx4 a[12:15], v1, s[4:7], s37 offen offset:3072 sc1
  s_add_u32 s37, s37, 4096
  buffer_load_dwordx4 a[16:19], v1, s[4:7], s37 offen offset:0 sc1
  buffer_load_dwordx4 a[20:23], v1, s[4:7], s37 offen offset:1024 sc1
  buffer_load_dwordx4 a[24:27], v1, s[4:7], s37 offen offset:2048 sc1
  buffer_load_dwordx4 a[28:31], v1, s[4:7], s37 offen offset:3072 sc1
  s_add_u32 s37, s37, 4096
  buffer_load_dwordx4 a[32:35], v1, s[4:7], s37 offen offset:0 sc1
  buffer_load_dwordx4 a[36:39], v1, s[4:7], s37 offen offset:1024 sc1
  buffer_load_dwordx4 a[40:43], v1, s[4:7], s37 offen offset:2048 sc1
  buffer_load_dwordx4 a[44:47], v1, s[4:7], s37 offen offset:3072 sc1
  s_add_u32 s37, s37, 4096
  buffer_load_dwordx4 a[48:51], v1, s[4:7], s37 offen offset:0 sc1
  buffer_load_dwordx4 a[52:55], v1, s[4:7], s37 offen offset:1024 sc1
  buffer_load_dwordx4 a[56:59], v1, s[4:7], s37 offen offset:2048 sc1
  buffer_load_dwordx4 a[60:63], v1, s[4:7], s37 offen offset:3072 sc1
  s_add_u32 s37, s37, 4096
  buffer_load_dwordx4 a[64:67], v1, s[4:7], s37 offen offset:0 sc1
  buffer_load_dwordx4 a[68:71], v1, s[4:7], s37 offen offset:1024 sc1
  buffer_load_dwordx4 a[72:75], v1, s[4:7], s37 offen offset:2048 sc1
  buffer_load_dwordx4 a[76:79], v1, s[4:7], s37 offen offset:3072 sc1
  s_add_u32 s37, s37, 4096
  buffer_load_dwordx4 a[80:83], v1, s[4:7], s37 offen offset:0 sc1
  buffer_load_dwordx4 a[84:87], v1, s[4:7], s37 offen offset:1024 sc1
  buffer_load_dwordx4 a[88:91], v1, s[4:7], s37 offen offset:2048 sc1
  buffer_load_dwordx4 a[92:95], v1, s[4:7], s37 offen offset:3072 sc1
  s_waitcnt lgkmcnt(0)
  s_load_dword s52, s[56:57], 0 glc
  s_load_dword s53, s[58:59], 16384 glc
  s_load_dword s54, s[58:59], 16512 glc
  s_load_dword s55, s[58:59], 16640 glc
  s_load_dword s61, s[58:59], 16768 glc
  s_waitcnt vmcnt(0)
L_att1_next:
  s_waitcnt vmcnt(8)
  s_branch L_att_loop
L_att_done:
  s_endpgm
L_fail_att:
  s_mov_b64 exec, 1
  v_mov_b32 v0, 72
  v_mov_b32 v1, 1
  buffer_atomic_add v1, v0, s[20:23], 0 offen
  s_endpgm
.p2align 2
.type role_table,@object
role_table:
.long 0x0
.long 0x10000
.long 0x20000
.long 0x30000
.long 0x40000
.long 0x50000
.long 0x60000
.long 0x70000
.long 0x80000
.long 0x90000
.long 0xa0000
.long 0xb0000
.long 0xc0000
.long 0xd0000
.long 0xe0000
.long 0xf0000
.long 0x100000
.long 0x110000
.long 0x120000
.long 0x130000
.long 0x140000
.long 0x150000
.long 0x160000
.long 0x170000
.long 0x180000
.long 0x190000
.long 0x1a0000
.long 0x1b0000
.long 0x1c0000
.long 0x1d0000
.long 0x1e0000
.long 0x1f0000
.long 0x100
.long 0x10100
.long 0x20100
.long 0x30100
.long 0x40100
.long 0x50100
.long 0x60100
.long 0x70100
.long 0x80100
.long 0x90100
.long 0xa0100
.long 0xb0100
.long 0xc0100
.long 0xd0100
.long 0xe0100
.long 0xf0100
.long 0x100100
.long 0x110100
.long 0x120100
.long 0x130100
.long 0x140100
.long 0x150100
.long 0x160100
.long 0x170100
.long 0x180100
.long 0x190100
.long 0x1a0100
.long 0x1b0100
.long 0x1c0100
.long 0x1d0100
.long 0x1e0100
.long 0x1f0100
.long 0x2
.long 0x10002
.long 0x20002
.long 0x30002
.long 0x40002
.long 0x50002
.long 0x60002
.long 0x70002
.long 0x80002
.long 0x90002
.long 0xa0002
.long 0xb0002
.long 0x3
.long 0x1000003
.long 0x2000003
.long 0x10003
.long 0x1010003
.long 0x2010003
.long 0x20003
.long 0x1020003
.long 0x2020003
.long 0x30003
.long 0x1030003
.long 0x2030003
.long 0x5
.long 0x2010005
.long 0x4020005
.long 0x6030005
.long 0x8040005
.long 0xa050005
.long 0xc060005
.long 0xe070005
.long 0x4
.long 0x1000004
.long 0x2000004
.long 0x10004
.long 0x1010004
.long 0x2010004
.long 0x20004
.long 0x1020004
.long 0x2020004
.long 0x10080005
.long 0x12090005
.long 0x140a0005
.long 0x1
.long 0x101
.long 0x10001
.long 0x10101
.long 0x20001
.long 0x20101
.long 0x30001
.long 0x30101
.long 0x40001
.long 0x40101
.long 0x50001
.long 0x50101
.long 0x60001
.long 0x60101
.long 0x70001
.long 0x70101
.long 0x80001
.long 0x80101
.long 0x90001
.long 0x90101
.long 0x102
.long 0x10102
.long 0x20102
.long 0x30102
.long 0x40102
.long 0x50102
.long 0x60102
.long 0x70102
.long 0x80102
.long 0x90102
.long 0xa0102
.long 0xb0102
.long 0x103
.long 0x1000103
.long 0x2000103
.long 0x10103
.long 0x1010103
.long 0x2010103
.long 0x20103
.long 0x1020103
.long 0x2020103
.long 0x30103
.long 0x1030103
.long 0x2030103
.long 0x160b0005
.long 0x180c0005
.long 0x1a0d0005
.long 0x1c0e0005
.long 0x1e0f0005
.long 0x20100005
.long 0x22110005
.long 0x24120005
.long 0x30004
.long 0x1030004
.long 0x2030004
.long 0x104
.long 0x1000104
.long 0x2000104
.long 0x10104
.long 0x1010104
.long 0x2010104
.long 0x26130005
.long 0x28140005
.long 0x2a150005
.long 0xa0001
.long 0xa0101
.long 0xb0001
.long 0xb0101
.long 0xc0001
.long 0xc0101
.long 0xd0001
.long 0xd0101
.long 0xe0001
.long 0xe0101
.long 0xf0001
.long 0xf0101
.long 0x100001
.long 0x100101
.long 0x110001
.long 0x110101
.long 0x120001
.long 0x120101
.long 0x130001
.long 0x130101
.long 0x202
.long 0x10202
.long 0x20202
.long 0x30202
.long 0x40202
.long 0x50202
.long 0x60202
.long 0x70202
.long 0x80202
.long 0x90202
.long 0xa0202
.long 0xb0202
.long 0x203
.long 0x1000203
.long 0x2000203
.long 0x10203
.long 0x1010203
.long 0x2010203
.long 0x20203
.long 0x1020203
.long 0x2020203
.long 0x30203
.long 0x1030203
.long 0x2030203
.long 0x2c160005
.long 0x2e170005
.long 0x30180005
.long 0x32190005
.long 0x341a0005
.long 0x361b0005
.long 0x381c0005
.long 0x3a1d0005
.long 0x20104
.long 0x1020104
.long 0x2020104
.long 0x30104
.long 0x1030104
.long 0x2030104
.long 0x3c1e0005
.long 0x3e1f0005
.long 0x140001
.long 0x140101
.long 0x150001
.long 0x150101
.long 0x160001
.long 0x160101
.long 0x170001
.long 0x170101
.long 0x180001
.long 0x180101
.long 0x190001
.long 0x190101
.long 0x1a0001
.long 0x1a0101
.long 0x1b0001
.long 0x1b0101
.long 0x1c0001
.long 0x1c0101
.long 0x1d0001
.long 0x1d0101
.long 0x1e0001
.long 0x1e0101
.long 0x1f0001
.long 0x1f0101
.size role_table, 1024
.section .rodata,"a"
.p2align 6
.amdhsa_kernel interleave_layers__memory_aug_recurrent_mem_tr__dense_activation_gelu__prompt_kernel
  .amdhsa_next_free_vgpr 512
  .amdhsa_next_free_sgpr 102
  .amdhsa_accum_offset 256
  .amdhsa_group_segment_fixed_size 0
  .amdhsa_kernarg_size 120
  .amdhsa_user_sgpr_count 2
  .amdhsa_user_sgpr_kernarg_segment_ptr 1
  .amdhsa_system_sgpr_workgroup_id_x 1
.end_amdhsa_kernel
```
